```python
import torch

def _softmax(x, axis=-1):
    return torch.softmax(x, dim=axis)
def _gelu(x):
    return torch.nn.functional.gelu(x, approximate="tanh")
def _silu(x):
    return torch.nn.functional.silu(x)
def _sigmoid(x):
    return torch.sigmoid(x)
def _layernorm(x, axis=-1, eps=1e-5):
    m = x.mean(dim=axis, keepdim=True)
    v = x.var(dim=axis, keepdim=True, unbiased=False)
    return (x - m) / torch.sqrt(v + eps)
def _scatter_add(tgt, idx, src, axis=0):
    return tgt.clone().index_add_(axis, idx, src)
def _segment_sum(src, seg, n):
    out = torch.zeros((n,) + src.shape[1:], dtype=src.dtype)
    return out.index_add_(0, seg, src)
def _pad(x, pw):
    flat = tuple(v for pair in reversed(pw) for v in pair)
    return torch.nn.functional.pad(x, flat)

kernel_name = 'concat_heads__sliding_block_cached__compressed_kv_cla__decode'

def setup_inputs():

    _w = (lambda a: (lambda t: t.to(torch.bfloat16) if t.is_floating_point() else t)(torch.as_tensor(a)))
    def _A_setup():
        B, Sq, D = 4, 1, 512
        Hq, Hkv, Sk, Dh = 32, 32, 4096, 128
        assert Hq % Hkv == 0, (Hq, Hkv)
        return {
            "x": _w((lambda *s: torch.randn(*s, dtype=torch.bfloat16) * 0.8)(B, Sq, D)),
            "k_cache": _w((lambda *s: torch.randn(*s, dtype=torch.bfloat16) * 0.8)(B, Hkv, Sk, Dh)),
            "v_cache": _w((lambda *s: torch.randn(*s, dtype=torch.bfloat16) * 0.05)(B, Hkv, Sk, Dh)),
            "wq": _w((lambda *s: torch.randn(*s, dtype=torch.bfloat16) * 0.8)(D, Hq * Dh) * (D ** -0.5)),
            "wo": _w((lambda *s: torch.randn(*s, dtype=torch.bfloat16) * 0.05)(Hq * Dh, D) * ((Hq * Dh) ** -0.5)),
        }
    _A_in = _A_setup()

    def _B_setup():
        B, H, Sq, Sk, D, M = 4, 32, 1, 4096, 128, 512
        Dc = 4 * D
        return {
            "x": _w((lambda *s: torch.randn(*s, dtype=torch.bfloat16) * 1.6)(B, Sq, M)),
            "c_kv": _w((lambda *s: torch.randn(*s, dtype=torch.bfloat16) * 0.1)(B, Sk, Dc)),
            "w_q": _w((lambda *s: torch.randn(*s, dtype=torch.bfloat16) * 3.2)(M, H, D) * (M ** -0.5)),
            "w_uk": _w((lambda *s: torch.randn(*s, dtype=torch.bfloat16) * 3.2)(Dc, H, D) * (Dc ** -0.5)),
            "w_uv": _w((lambda *s: torch.randn(*s, dtype=torch.bfloat16) * 0.1)(Dc, H, D) * (Dc ** -0.5)),
            "w_o": _w((lambda *s: torch.randn(*s, dtype=torch.bfloat16) * 0.1)(H, D, M) * ((H * D) ** -0.5)),
        }
    _B_in = _B_setup()

    return {
        "A_x": _A_in["x"],
        "A_k_cache": _A_in["k_cache"],
        "A_v_cache": _A_in["v_cache"],
        "A_wq": _A_in["wq"],
        "A_wo": _A_in["wo"],
        "B_x": _B_in["x"],
        "B_c_kv": _B_in["c_kv"],
        "B_w_q": _B_in["w_q"],
        "B_w_uk": _B_in["w_uk"],
        "B_w_uv": _B_in["w_uv"],
        "B_w_o": _B_in["w_o"],
    }

def reference(A_x, A_k_cache, A_v_cache, A_wq, A_wo, B_x, B_c_kv, B_w_q, B_w_uk, B_w_uv, B_w_o):
    def _A_ref(x, k_cache, v_cache, wq, wo):
        B, Sq, D = x.shape
        Hq, Dh = 32, 128
        Hkv, Sk = k_cache.shape[1], k_cache.shape[2]
        W = min(4096, max(256, Sk // 4))
        rep = Hq // Hkv
        q = (lambda x, *d: x.permute(*d))((x @ wq).reshape(B, Sq, Hq, Dh), 0, 2, 1, 3)
        k = (lambda x, n, axis: torch.repeat_interleave(x, n, dim=axis))(k_cache[:, :, Sk - W:, :], rep, axis=1)
        v = (lambda x, n, axis: torch.repeat_interleave(x, n, dim=axis))(v_cache[:, :, Sk - W:, :], rep, axis=1)
        scores = torch.einsum("bhqd,bhkd->bhqk", q, k) * (Dh ** -0.5)
        p = _softmax(scores, axis=-1)
        o = torch.einsum("bhqk,bhkd->bhqd", p, v)
        return (lambda x, *d: x.permute(*d))(o, 0, 2, 1, 3).reshape(B, Sq, Hq * Dh) @ wo

    def _B_ref(x, c_kv, w_q, w_uk, w_uv, w_o):
        B, Sq, M = x.shape[0], x.shape[1], x.shape[2]
        Sk = c_kv.shape[1]
        H, D = w_q.shape[1], w_q.shape[2]
        q = torch.einsum("bqm,mhd->bhqd", x, w_q)
        k = torch.einsum("bkc,chd->bhkd", c_kv, w_uk)
        v = torch.einsum("bkc,chd->bhkd", c_kv, w_uv)
        scores = torch.einsum("bhqd,bhkd->bhqk", q, k) * (D ** -0.5)
        off = Sk - Sq
        qi = torch.arange(Sq)[:, None]
        kj = torch.arange(Sk)[None, :]
        cmask = kj <= (qi + off)
        scores = torch.where(cmask[None, None], scores, -1e9)
        p = _softmax(scores, axis=-1)
        ctx = torch.einsum("bhqk,bhkd->bhqd", p, v)
        return torch.einsum("bhqd,hdm->bqm", ctx, w_o)

    a = _A_ref(A_x, A_k_cache, A_v_cache, A_wq, A_wo)
    b = _B_ref(B_x, B_c_kv, B_w_q, B_w_uk, B_w_uv, B_w_o)
    return torch.concatenate([a, b], axis=-1)
```

```asm
; @launch grid=(256,1,1) block=(576,1,1) lds=163840
.amdgcn_target "amdgcn-amd-amdhsa--gfx950"
.text
.globl concat_heads__sliding_block_cached__compressed_kv_cla__decode_kernel
.p2align 8
.type concat_heads__sliding_block_cached__compressed_kv_cla__decode_kernel,@function
concat_heads__sliding_block_cached__compressed_kv_cla__decode_kernel:
    s_cmp_ge_u32 s2, 256
    s_cbranch_scc1 L_END
    s_load_dwordx16 s[8:23], s[0:1], 0
    s_load_dwordx8 s[24:31], s[0:1], 64
    s_load_dwordx4 s[32:35], s[0:1], 96
    s_memrealtime s[94:95]
    v_lshrrev_b32 v1, 6, v0
    s_nop 0
    v_readfirstlane_b32 s3, v1
    v_and_b32 v1, 63, v0
    v_lshrrev_b32 v2, 4, v1
    v_and_b32 v3, 15, v1
    s_and_b32 s4, s2, 7
    s_lshr_b32 s7, s2, 6
    s_lshl_b32 s7, s7, 3
    s_or_b32 s4, s4, s7
    s_bfe_u32 s5, s2, 0x30003
    s_getreg_b32 s78, hwreg(HW_REG_XCC_ID, 0, 4)
    s_xor_b32 s6, s3, 4
    s_cmp_eq_u32 s3, 8
    s_cbranch_scc1 L_LOAD
    s_lshr_b32 s60, s6, 2
    s_and_b32 s61, s6, 3
    v_lshrrev_b32 v10, 1, v1
    v_xor_b32 v10, v10, v2
    v_and_b32 v10, 1, v10
    v_lshlrev_b32 v10, 5, v10
    v_lshrrev_b32 v11, 2, v1
    v_lshl_add_u32 v10, v11, 13, v10
    v_and_b32 v11, 1, v1
    v_lshl_add_u32 v10, v11, 4, v10
    s_lshl_b32 s63, s5, 19
    s_lshl_b32 s7, s4, 8
    s_add_u32 s63, s63, s7
    s_lshl_b32 s7, s61, 6
    s_add_u32 s63, s63, s7
    s_lshl_b32 s64, s61, 12
    s_add_u32 s64, s64, 0x1c000
    s_mov_b32 s81, 0
    s_lshr_b32 s7, s6, 1
    s_cmp_eq_u32 s7, 2
    s_cselect_b32 s74, 1, 0
    s_cmp_eq_u32 s6, 2
    s_cselect_b32 s77, 1, 0
    s_cmp_lt_u32 s5, 4
    s_cselect_b32 s74, s74, 0
    s_cselect_b32 s77, s77, 0
    v_and_b32 v8, 3, v1
    v_lshlrev_b32 v9, 10, v8
    v_lshl_add_u32 v9, v2, 3, v9
    s_lshl_b32 s62, s5, 7
    s_lshr_b32 s76, s5, 2
    s_andn2_b32 s76, s76, s60
    s_sub_u32 s7, s62, 512
    s_mul_i32 s7, s7, s76
    s_add_u32 s62, s62, s7
    s_waitcnt lgkmcnt(0)
    s_cmp_eq_u32 s60, 0
    s_cbranch_scc1 WQ_1
    s_mov_b32 s48, s22
    s_and_b32 s49, s23, 0xffff
    s_mov_b32 s50, 0x400000
    s_mov_b32 s51, 0x20000
    s_mov_b32 m0, s64
    s_add_u32 s64, s64, 1024
    buffer_load_dwordx4 v10, s[48:51], s63 offen nt lds
    s_add_u32 s63, s63, 131072
    s_mov_b32 m0, s64
    s_add_u32 s64, s64, 1024
    buffer_load_dwordx4 v10, s[48:51], s63 offen nt lds
    s_add_u32 s63, s63, 131072
    s_mov_b32 m0, s64
    s_add_u32 s64, s64, 1024
    buffer_load_dwordx4 v10, s[48:51], s63 offen nt lds
    s_add_u32 s63, s63, 131072
    s_mov_b32 m0, s64
    s_add_u32 s64, s64, 1024
    buffer_load_dwordx4 v10, s[48:51], s63 offen nt lds
    s_add_u32 s63, s63, 131072
    s_mov_b32 s44, s18
    s_and_b32 s45, s19, 0xffff
    s_mov_b32 s46, 0x1000
    s_mov_b32 s47, 0x20000
    buffer_load_dwordx2 v[128:129], v9, s[44:47], s62 offen offset:0
    buffer_load_dwordx2 v[130:131], v9, s[44:47], s62 offen offset:32
    buffer_load_dwordx2 v[132:133], v9, s[44:47], s62 offen offset:64
    buffer_load_dwordx2 v[134:135], v9, s[44:47], s62 offen offset:96
    s_barrier
    s_mov_b32 s36, s34
    s_and_b32 s37, s35, 0xffff
    s_mov_b32 s38, 0x1000000
    s_mov_b32 s39, 0x20000
    s_branch WR_2
WQ_1:
    v_lshlrev_b32 v10, 2, v0
    v_mov_b32 v24, 0
    v_add_u32 v10, 0x23c00, v10
    ds_write_b32 v10, v24
    s_mov_b32 s40, s32
    s_and_b32 s41, s33, 0xffff
    s_mov_b32 s42, 0x100
    s_mov_b32 s43, 0x20000
    s_or_b32 s7, s6, s2
    s_cbranch_scc1 NC_3
    s_lshl_b64 s[92:93], s[94:95], 5
    s_or_b32 s93, s93, 0x80000000
    v_mov_b32 v12, s92
    v_mov_b32 v13, s93
    s_mov_b64 exec, 1
    buffer_store_dwordx2 v[12:13], v24, s[40:43], 0 offen sc1
    s_mov_b64 exec, -1
NC_3:
    s_waitcnt lgkmcnt(0)
    s_barrier
    s_mov_b32 s44, s8
    s_and_b32 s45, s9, 0xffff
    s_mov_b32 s46, 0x1000
    s_mov_b32 s47, 0x20000
    s_mov_b32 s36, s34
    s_and_b32 s37, s35, 0xffff
    s_mov_b32 s38, 0x1000000
    s_mov_b32 s39, 0x20000
    s_cmp_eq_u32 s77, 0
    s_cbranch_scc1 NQ_5
    s_lshl_b32 s7, s4, 2
    s_add_u32 s7, s7, s5
    s_lshl_b32 s7, s7, 8
    v_lshl_add_u32 v10, v3, 4, s7
    v_lshl_add_u32 v10, v2, 15, v10
    v_mov_b32 v28, -1
    v_mov_b32 v29, -1
    v_mov_b32 v30, -1
    v_mov_b32 v31, -1
    buffer_store_dwordx4 v[28:31], v10, s[36:39], 0 offen sc1
NQ_5:
    buffer_load_dwordx2 v[128:129], v9, s[44:47], s62 offen offset:0
    buffer_load_dwordx2 v[130:131], v9, s[44:47], s62 offen offset:32
    buffer_load_dwordx2 v[132:133], v9, s[44:47], s62 offen offset:64
    buffer_load_dwordx2 v[134:135], v9, s[44:47], s62 offen offset:96
    s_cmp_eq_u32 s76, 0
    s_cbranch_scc1 NX_6
    buffer_load_dwordx2 v[136:137], v9, s[44:47], s62 offen offset:128
    buffer_load_dwordx2 v[138:139], v9, s[44:47], s62 offen offset:160
    buffer_load_dwordx2 v[140:141], v9, s[44:47], s62 offen offset:192
    buffer_load_dwordx2 v[142:143], v9, s[44:47], s62 offen offset:224
NX_6:
    s_cmp_lg_u32 s6, 0
    s_cbranch_scc1 NP_7
    s_mov_b32 s80, 800000
    s_sleep 4
NL_8:
    s_mov_b64 exec, 1
    buffer_load_dwordx2 v[12:13], v24, s[40:43], 0 offen sc1
    s_mov_b64 exec, -1
    s_waitcnt vmcnt(0)
    v_readfirstlane_b32 s92, v12
    v_readfirstlane_b32 s93, v13
    s_sub_u32 s80, s80, 1
    s_cbranch_scc1 NH_9
    s_cmp_eq_u32 s93, 0
    s_cbranch_scc1 NL_8
NH_9:
    v_mov_b32 v11, 0x24248
    v_mov_b32 v12, s92
    v_mov_b32 v13, s93
    ds_write_b64 v11, v[12:13]
    v_mov_b32 v11, 0x24204
    v_mov_b32 v14, 1
    s_mov_b64 exec, 1
    ds_add_u32 v11, v14
    s_mov_b64 exec, -1
    s_cmp_lt_u32 s5, 6
    s_cbranch_scc1 NP_7
    s_and_b32 s64, s4, 7
    s_lshl_b32 s64, s64, 3
    s_lshr_b32 s7, s4, 3
    s_lshl_b32 s7, s7, 1
    s_add_u32 s64, s64, s7
    s_add_u32 s64, s64, s5
    s_sub_u32 s64, s64, 6
    s_lshr_b32 s7, s64, 3
    s_lshl_b32 s7, s7, 7
    s_and_b32 s64, s64, 7
    s_lshl_b32 s64, s64, 3
    s_add_u32 s7, s7, s64
    s_add_u32 s7, s7, 0x22000
    v_mov_b32 v11, s7
    v_or_b32 v12, s78, v12
    s_mov_b64 exec, 1
    buffer_store_dwordx2 v[12:13], v11, s[36:39], 0 offen sc1
    s_mov_b64 exec, -1
NP_7:
    s_cmp_ge_u32 s5, 6
    s_cbranch_scc1 L_BATT
    s_cmp_eq_u32 s77, 0
    s_cbranch_scc1 WR_2
    s_lshl_b32 s7, s4, 2
    s_add_u32 s7, s7, s5
    s_lshl_b32 s7, s7, 3
    s_add_u32 s7, s7, 0x20000
    v_mov_b32 v11, s7
    s_waitcnt vmcnt(0)
    v_mov_b32 v12, 0x2421c
    v_mov_b32 v13, 1
    s_mov_b64 exec, 1
    ds_add_u32 v12, v13
    s_mov_b64 exec, -1
    v_mov_b32 v12, 0x24204
    s_mov_b32 s80, 1600000
LW_10:
    ds_read_b32 v13, v12
    s_waitcnt lgkmcnt(0)
    v_readfirstlane_b32 s79, v13
    s_cmp_ge_u32 s79, 1
    s_cbranch_scc1 LWD_11
    s_sleep 1
    s_sub_u32 s80, s80, 1
    s_cmp_lg_u32 s80, 0
    s_cbranch_scc1 LW_10
LWD_11:
    v_mov_b32 v12, 0x24248
    ds_read_b64 v[14:15], v12
    s_waitcnt lgkmcnt(0)
    v_readfirstlane_b32 s92, v14
    v_readfirstlane_b32 s93, v15
    s_mov_b64 exec, 1
    buffer_store_dwordx2 v[14:15], v11, s[36:39], 0 offen sc1
    s_mov_b64 exec, -1
WR_2:
    v_lshlrev_b32 v5, 15, v8
    v_lshl_add_u32 v5, v2, 3, v5
    v_lshrrev_b32 v10, 2, v3
    v_lshl_add_u32 v5, v10, 5, v5
    s_lshl_b32 s7, s4, 2
    s_add_u32 s7, s7, s5
    s_lshl_b32 s7, s7, 1
    s_add_u32 s7, s7, s61
    s_lshl_b32 s7, s7, 7
    v_add_u32 v5, s7, v5
    s_lshl_b32 s75, s78, 26
    s_or_b32 s95, s95, s75
    s_add_u32 s72, s94, 0x10000
    s_addc_u32 s73, s95, 0
    s_mov_b32 s96, 0x6010600
    s_mov_b32 s97, 0x5030502
    s_cmp_eq_u32 s5, 1
    s_cselect_b32 s96, 0x6170616, s96
    s_cselect_b32 s97, 0x5190518, s97
    s_cmp_eq_u32 s5, 2
    s_cselect_b32 s96, 0x62d062c, s96
    s_cselect_b32 s97, 0x52f052e, s97
    s_cmp_eq_u32 s5, 3
    s_cselect_b32 s96, 0x6430642, s96
    s_cselect_b32 s97, 0x5450544, s97
    s_cmp_eq_u32 s5, 4
    s_cselect_b32 s96, 0x5590558, s96
    s_cselect_b32 s97, 0x55b055a, s97
    s_cmp_eq_u32 s5, 5
    s_cselect_b32 s96, 0x56d056c, s96
    s_cselect_b32 s97, 0x56f056e, s97
    v_lshrrev_b32 v10, 2, v1
    v_and_b32 v11, 7, v10
    s_lshl_b32 s7, s61, 1
    v_xor_b32 v11, s7, v11
    v_lshlrev_b32 v10, 8, v10
    v_lshl_add_u32 v10, v11, 5, v10
    v_lshl_add_u32 v10, v8, 3, v10
    s_cmp_lt_u32 s5, 4
    s_cselect_b32 s65, 48, 32
    s_cmp_eq_u32 s60, 0
    s_cselect_b32 s64, 8, 0
    v_add_u32 v10, 0x20000, v10
    v_xor_b32 v11, 32, v10
    s_add_u32 s64, s64, 0x24138
    s_lshl_b32 s7, s60, 5
    s_add_u32 s7, s7, s4
    s_lshl_b32 s63, s7, 14
    s_add_u32 s63, s63, 0x200000
    s_lshl_b32 s7, s5, 11
    s_lshl_b32 s62, s61, 7
    s_add_u32 s7, s7, s62
    s_add_u32 s7, s7, s63
    v_lshlrev_b32 v4, 9, v8
    v_lshl_add_u32 v4, v2, 4, v4
    v_and_b32 v12, 4, v1
    v_lshl_add_u32 v4, v12, 4, v4
    v_add_u32 v4, s7, v4
    v_cmp_gt_u32 s[84:85], 8, v3
    s_lshl_b32 s7, s61, 4
    s_lshr_b64 s[90:91], s[96:97], s7
    s_and_b32 s66, s90, 3
    s_bfe_u32 s67, s90, 0x50002
    s_bfe_u32 s68, s90, 0x40008
    s_cmp_eq_u32 s60, 1
    s_cselect_b32 s66, s61, s66
    s_lshl_b32 s7, s66, 9
    s_add_u32 s7, s7, s63
    v_and_b32 v12, 31, v1
    v_lshl_add_u32 v7, v12, 4, s7
    v_lshrrev_b32 v13, 5, v1
    v_lshl_add_u32 v7, v13, 11, v7
    s_lshl_b32 s7, s60, 2
    s_add_u32 s7, s7, s66
    s_mul_i32 s7, s7, 320
    s_add_u32 s63, s7, 0x24400
    v_lshl_add_u32 v6, v12, 3, s63
    s_mov_b32 s70, 0x3f80
    s_mov_b32 s71, 0x3f800000
    s_mov_b64 s[86:87], -1
    s_lshr_b32 s7, s5, 2
    s_and_b32 s7, s7, s60
    s_cselect_b32 s86, 1, s86
    s_cselect_b32 s87, 1, s87
    s_cmp_eq_u32 s60, 0
    s_cbranch_scc1 RA_12
    v_lshrrev_b32 v10, 2, v1
    v_lshlrev_b32 v10, 6, v10
    v_and_b32 v11, 1, v2
    v_lshl_add_u32 v10, v11, 5, v10
    v_lshl_add_u32 v10, v8, 3, v10
    s_lshl_b32 s7, s61, 12
    s_add_u32 s7, s7, 0x1c000
    v_add_u32 v10, s7, v10
    v_xor_b32 v11, 32, v10
    s_waitcnt vmcnt(0)
    ds_read_b64_tr_b16 v[32:33], v10 offset:0
    ds_read_b64_tr_b16 v[34:35], v10 offset:1024
    ds_read_b64_tr_b16 v[36:37], v11 offset:0
    ds_read_b64_tr_b16 v[38:39], v11 offset:1024
    ds_read_b64_tr_b16 v[40:41], v10 offset:2048
    ds_read_b64_tr_b16 v[42:43], v10 offset:3072
    ds_read_b64_tr_b16 v[44:45], v11 offset:2048
    ds_read_b64_tr_b16 v[46:47], v11 offset:3072
RB_13:
    v_lshl_add_u32 v12, v1, 2, s64
    v_mov_b32 v13, 1
    s_mov_b64 exec, 3
    ds_add_u32 v12, v13
    s_mov_b64 exec, -1
    s_memrealtime s[88:89]
    s_waitcnt lgkmcnt(0)
    v_mfma_f32_16x16x32_bf16 v[24:27], v[32:35], v[128:131], 0
    v_mfma_f32_16x16x32_bf16 v[28:31], v[36:39], v[128:131], 0
    v_mfma_f32_16x16x32_bf16 v[24:27], v[40:43], v[132:135], v[24:27]
    v_mfma_f32_16x16x32_bf16 v[28:31], v[44:47], v[132:135], v[28:31]
    s_cmp_lg_u32 s76, 0
    s_cbranch_scc1 E2_14
E3_15:
    s_or_b32 s89, s89, s75
    s_mov_b32 s101, 1
    s_cmp_eq_u32 s60, 1
    s_cbranch_scc1 VD_16
    v_mov_b32 v10, 0x24208
    s_mov_b32 s80, 1600000
LW_17:
    ds_read_b32 v11, v10
    s_waitcnt lgkmcnt(0)
    v_readfirstlane_b32 s79, v11
    s_cmp_ge_u32 s79, 64
    s_cbranch_scc1 LWD_18
    s_sleep 1
    s_sub_u32 s80, s80, 1
    s_cmp_lg_u32 s80, 0
    s_cbranch_scc1 LW_17
LWD_18:
    s_and_b32 s101, s79, 15
    v_mov_b32 v12, 0x24204
    s_mov_b32 s80, 1600000
LW_19:
    ds_read_b32 v13, v12
    s_waitcnt lgkmcnt(0)
    v_readfirstlane_b32 s79, v13
    s_cmp_ge_u32 s79, 1
    s_cbranch_scc1 LWD_20
    s_sleep 1
    s_sub_u32 s80, s80, 1
    s_cmp_lg_u32 s80, 0
    s_cbranch_scc1 LW_19
LWD_20:
    v_mov_b32 v12, 0x24248
    ds_read_b64 v[14:15], v12
    s_waitcnt lgkmcnt(0)
    v_readfirstlane_b32 s92, v14
    v_readfirstlane_b32 s93, v15
    s_mov_b64 s[88:89], s[92:93]
    s_mov_b64 s[94:95], s[92:93]
    s_or_b64 s[72:73], s[92:93], 1
VD_16:
    s_nop 2
    v_cvt_pk_bf16_f32 v40, v24, v25
    v_cvt_pk_bf16_f32 v41, v26, v27
    v_cvt_pk_bf16_f32 v44, v28, v29
    v_cvt_pk_bf16_f32 v45, v30, v31
    v_mov_b32 v42, s88
    v_mov_b32 v43, s89
    v_mov_b32_dpp v40, v44 quad_perm:[0,1,2,3] row_mask:0xf bank_mask:0x2
    v_mov_b32_dpp v41, v45 quad_perm:[0,1,2,3] row_mask:0xf bank_mask:0x2
    s_mov_b64 exec, s[84:85]
    s_cmp_eq_u32 s101, 0
    s_cbranch_scc1 SU_21
    buffer_store_dwordx4 v[40:43], v4, s[36:39], 0 offen
SV_22:
    s_mov_b64 exec, -1
    v_mov_b32 v12, 0x24200
    v_mov_b32 v13, 1
    s_mov_b64 exec, 1
    ds_add_u32 v12, v13
    s_mov_b64 exec, -1
    s_sleep 4
    s_cmp_eq_u32 s60, 1
    s_cbranch_scc1 GDL_23
    s_sleep 16
GDL_23:
    v_add_u32 v9, 8192, v7
    s_mov_b32 s62, 4096
    s_lshl_b32 s76, s60, 12
    s_mov_b32 s64, 17
    s_mov_b64 exec, s[86:87]
    buffer_load_dwordx4 v[48:51], v7, s[36:39], 0 offen sc1 nt
    buffer_load_dwordx4 v[52:55], v7, s[36:39], s62 offen sc1 nt
    buffer_load_dwordx4 v[56:59], v9, s[36:39], 0 offen sc1 nt
    buffer_load_dwordx4 v[60:63], v9, s[36:39], s76 offen sc1 nt
    s_mov_b32 s80, 200000
MC_26:
    s_mov_b64 exec, s[86:87]
    s_waitcnt vmcnt(0)
    v_cmp_gt_u64 s[44:45], s[94:95], v[50:51]
    v_cmp_le_u64 vcc, s[72:73], v[50:51]
    s_or_b64 s[44:45], s[44:45], vcc
    v_cmp_gt_u64 s[46:47], s[94:95], v[54:55]
    v_cmp_le_u64 vcc, s[72:73], v[54:55]
    s_or_b64 s[46:47], s[46:47], vcc
    v_cmp_gt_u64 s[48:49], s[94:95], v[58:59]
    v_cmp_le_u64 vcc, s[72:73], v[58:59]
    s_or_b64 s[48:49], s[48:49], vcc
    v_cmp_gt_u64 s[50:51], s[94:95], v[62:63]
    v_cmp_le_u64 vcc, s[72:73], v[62:63]
    s_or_b64 s[50:51], s[50:51], vcc
    s_or_b64 s[90:91], s[44:45], s[46:47]
    s_or_b64 s[90:91], s[90:91], s[48:49]
    s_or_b64 s[90:91], s[90:91], s[50:51]
    s_cbranch_scc1 M_25
MD_27:
    s_mov_b64 exec, -1
    s_cmp_eq_u32 s86, 1
    s_cbranch_scc1 QS_28
    v_dot2_f32_bf16 v24, v48, s70, 0
    v_dot2_f32_bf16 v25, v48, s71, 0
    v_dot2_f32_bf16 v26, v49, s70, 0
    v_dot2_f32_bf16 v27, v49, s71, 0
    v_dot2_f32_bf16 v24, v52, s70, v24
    v_dot2_f32_bf16 v25, v52, s71, v25
    v_dot2_f32_bf16 v26, v53, s70, v26
    v_dot2_f32_bf16 v27, v53, s71, v27
    v_dot2_f32_bf16 v24, v56, s70, v24
    v_dot2_f32_bf16 v25, v56, s71, v25
    v_dot2_f32_bf16 v26, v57, s70, v26
    v_dot2_f32_bf16 v27, v57, s71, v27
    s_mul_i32 s70, s70, s60
    s_mul_i32 s71, s71, s60
    v_dot2_f32_bf16 v24, v60, s70, v24
    v_dot2_f32_bf16 v25, v60, s71, v25
    v_dot2_f32_bf16 v26, v61, s70, v26
    v_dot2_f32_bf16 v27, v61, s71, v27
    s_nop 1
    v_permlane32_swap_b32 v24, v26
    v_permlane32_swap_b32 v25, v27
    v_lshrrev_b32 v28, 5, v1
    v_add_f32 v24, v24, v26
    v_add_f32 v25, v25, v27
    v_lshl_add_u32 v6, v28, 2, v6
    v_cvt_pk_bf16_f32 v24, v24, v25
    ds_write_b32 v6, v24
    s_cmp_eq_u32 s60, 0
    s_cbranch_scc1 L_AATT
QS_28:
    v_mov_b32 v48, 0x24208
    v_mov_b32 v49, s64
    s_mov_b64 exec, 1
    ds_add_u32 v48, v49
    s_mov_b64 exec, -1
    s_cmp_lg_u32 s64, 17
    s_cbranch_scc1 RT_29
    s_memrealtime s[88:89]
    s_waitcnt lgkmcnt(0)
    s_or_b32 s89, s89, s75
    v_mov_b32 v42, s88
    v_mov_b32 v43, s89
    s_mov_b64 exec, s[84:85]
    buffer_store_dwordx4 v[40:43], v4, s[36:39], 0 offen
    s_mov_b64 exec, -1
RT_29:
    s_cmp_ge_u32 s5, 6
    s_cbranch_scc1 L_BATT
    s_cmp_ge_u32 s5, 4
    s_cbranch_scc1 L_ESVC
    s_cmp_eq_u32 s74, 0
    s_cbranch_scc1 L_ASVC
    v_xor_b32 v10, v3, v2
    v_lshlrev_b32 v10, 4, v10
    v_lshl_add_u32 v10, v3, 8, v10
    s_lshl_b32 s7, s61, 14
    s_add_u32 s7, s7, 0x14000
    v_add_u32 v10, s7, v10
    s_lshl_b32 s65, s61, 4
    s_add_u32 s65, s65, 16
    s_lshl_b32 s64, s61, 3
    s_add_u32 s64, s64, 0x24128
    v_mov_b32 v12, 0x24000
    s_mov_b32 s80, 1600000
LW_30:
    ds_read_b32 v13, v12
    s_waitcnt lgkmcnt(0)
    v_readfirstlane_b32 s79, v13
    s_cmp_ge_u32 s79, s65
    s_cbranch_scc1 LWD_31
    s_sub_u32 s80, s80, 1
    s_cmp_lg_u32 s80, 0
    s_cbranch_scc1 LW_30
LWD_31:
    v_xor_b32 v11, 0x0, v10
    ds_read_b128 v[64:67], v11 offset:0
    ds_read_b128 v[80:83], v11 offset:4096
    ds_read_b128 v[96:99], v11 offset:8192
    ds_read_b128 v[112:115], v11 offset:12288
    v_xor_b32 v11, 0x40, v10
    ds_read_b128 v[68:71], v11 offset:0
    ds_read_b128 v[84:87], v11 offset:4096
    ds_read_b128 v[100:103], v11 offset:8192
    ds_read_b128 v[116:119], v11 offset:12288
    v_xor_b32 v11, 0x80, v10
    ds_read_b128 v[72:75], v11 offset:0
    ds_read_b128 v[88:91], v11 offset:4096
    ds_read_b128 v[104:107], v11 offset:8192
    ds_read_b128 v[120:123], v11 offset:12288
    v_xor_b32 v11, 0xc0, v10
    ds_read_b128 v[76:79], v11 offset:0
    ds_read_b128 v[92:95], v11 offset:4096
    ds_read_b128 v[108:111], v11 offset:8192
    ds_read_b128 v[124:127], v11 offset:12288
    v_lshl_add_u32 v12, v1, 2, s64
    v_mov_b32 v13, 4
    s_mov_b64 exec, 3
    ds_add_u32 v12, v13
    s_mov_b64 exec, -1
    v_mov_b32 v12, 0x2421c
    s_mov_b32 s80, 1600000
LW_32:
    ds_read_b32 v13, v12
    s_waitcnt lgkmcnt(0)
    v_readfirstlane_b32 s79, v13
    s_cmp_ge_u32 s79, 1
    s_cbranch_scc1 LWD_33
    s_sub_u32 s80, s80, 1
    s_cmp_lg_u32 s80, 0
    s_cbranch_scc1 LW_32
LWD_33:
    v_mul_u32_u24 v10, 320, v8
    v_lshl_add_u32 v10, v2, 4, v10
    v_add_u32 v10, 0x24900, v10
    v_mov_b32 v12, 0x24208
    s_mov_b32 s80, 1600000
LW_34:
    ds_read_b32 v13, v12
    s_waitcnt lgkmcnt(0)
    v_readfirstlane_b32 s79, v13
    s_cmp_ge_u32 s79, 64
    s_cbranch_scc1 LWD_35
    s_sub_u32 s80, s80, 1
    s_cmp_lg_u32 s80, 0
    s_cbranch_scc1 LW_34
LWD_35:
    ds_read_b128 v[48:51], v10 offset:0
    ds_read_b128 v[52:55], v10 offset:64
    ds_read_b128 v[56:59], v10 offset:128
    ds_read_b128 v[60:63], v10 offset:192
    s_waitcnt lgkmcnt(3)
    v_mfma_f32_16x16x32_bf16 v[128:131], v[64:67], v[48:51], 0
    v_mfma_f32_16x16x32_bf16 v[132:135], v[80:83], v[48:51], 0
    v_mfma_f32_16x16x32_bf16 v[136:139], v[96:99], v[48:51], 0
    v_mfma_f32_16x16x32_bf16 v[140:143], v[112:115], v[48:51], 0
    s_waitcnt lgkmcnt(2)
    v_mfma_f32_16x16x32_bf16 v[128:131], v[68:71], v[52:55], v[128:131]
    v_mfma_f32_16x16x32_bf16 v[132:135], v[84:87], v[52:55], v[132:135]
    v_mfma_f32_16x16x32_bf16 v[136:139], v[100:103], v[52:55], v[136:139]
    v_mfma_f32_16x16x32_bf16 v[140:143], v[116:119], v[52:55], v[140:143]
    s_waitcnt lgkmcnt(1)
    v_mfma_f32_16x16x32_bf16 v[128:131], v[72:75], v[56:59], v[128:131]
    v_mfma_f32_16x16x32_bf16 v[132:135], v[88:91], v[56:59], v[132:135]
    v_mfma_f32_16x16x32_bf16 v[136:139], v[104:107], v[56:59], v[136:139]
    v_mfma_f32_16x16x32_bf16 v[140:143], v[120:123], v[56:59], v[140:143]
    s_waitcnt lgkmcnt(0)
    v_mfma_f32_16x16x32_bf16 v[128:131], v[76:79], v[60:63], v[128:131]
    v_mfma_f32_16x16x32_bf16 v[132:135], v[92:95], v[60:63], v[132:135]
    v_mfma_f32_16x16x32_bf16 v[136:139], v[108:111], v[60:63], v[136:139]
    v_mfma_f32_16x16x32_bf16 v[140:143], v[124:127], v[60:63], v[140:143]
    s_nop 4
    v_cvt_pk_bf16_f32 v24, v128, v129
    v_cvt_pk_bf16_f32 v25, v130, v131
    v_cvt_pk_bf16_f32 v26, v132, v133
    v_cvt_pk_bf16_f32 v27, v134, v135
    v_cvt_pk_bf16_f32 v28, v136, v137
    v_cvt_pk_bf16_f32 v29, v138, v139
    v_cvt_pk_bf16_f32 v30, v140, v141
    v_cvt_pk_bf16_f32 v31, v142, v143
    v_mov_b32_dpp v24, v26 quad_perm:[0,1,2,3] row_mask:0xf bank_mask:0x2
    v_mov_b32_dpp v25, v27 quad_perm:[0,1,2,3] row_mask:0xf bank_mask:0x2
    v_mov_b32_dpp v24, v28 quad_perm:[0,1,2,3] row_mask:0xf bank_mask:0x4
    v_mov_b32_dpp v25, v29 quad_perm:[0,1,2,3] row_mask:0xf bank_mask:0x4
    v_mov_b32_dpp v24, v30 quad_perm:[0,1,2,3] row_mask:0xf bank_mask:0x8
    v_mov_b32_dpp v25, v31 quad_perm:[0,1,2,3] row_mask:0xf bank_mask:0x8
    buffer_store_dwordx2 v[24:25], v5, s[36:39], 0 offen sc1
    s_branch L_ASVC
L_LOAD:
    s_setprio 3
    s_lshl_b32 s65, s5, 19
    s_lshl_b32 s7, s4, 8
    s_add_u32 s67, s65, s7
    s_add_u32 s65, s65, s67
    s_mov_b32 s61, 0
    s_mov_b32 s60, 0
    s_mov_b32 s63, 0
    v_lshlrev_b32 v16, 2, v1
    v_add_u32 v17, 0x24100, v16
    v_add_u32 v16, 0x24000, v16
    v_mov_b32 v18, 0
    s_cmp_ge_u32 s5, 4
    s_cbranch_scc1 L_LDE
    v_xor_b32 v6, v3, v2
    v_lshlrev_b32 v6, 4, v6
    v_lshl_add_u32 v6, v2, 13, v6
    v_xor_b32 v7, 0x40, v6
    v_xor_b32 v8, 0x80, v6
    v_xor_b32 v9, 0xc0, v6
    s_mov_b32 s64, 0x14000
    s_waitcnt lgkmcnt(0)
    s_mov_b32 s48, s24
    s_and_b32 s49, s25, 0xffff
    s_mov_b32 s50, 0x400000
    s_mov_b32 s51, 0x20000
    s_barrier
    s_mov_b32 m0, s64
    s_add_u32 s64, s64, 1024
    buffer_load_dwordx4 v6, s[48:51], s65 offen nt lds
    s_add_u32 s65, s65, 32768
    s_mov_b32 m0, s64
    s_add_u32 s64, s64, 1024
    buffer_load_dwordx4 v7, s[48:51], s65 offen nt lds
    s_add_u32 s65, s65, 32768
    s_mov_b32 m0, s64
    s_add_u32 s64, s64, 1024
    buffer_load_dwordx4 v8, s[48:51], s65 offen nt lds
    s_add_u32 s65, s65, 32768
    s_mov_b32 m0, s64
    s_add_u32 s64, s64, 1024
    buffer_load_dwordx4 v9, s[48:51], s65 offen nt lds
    s_add_u32 s65, s65, 32768
    s_mov_b32 m0, s64
    s_add_u32 s64, s64, 1024
    buffer_load_dwordx4 v6, s[48:51], s65 offen nt lds
    s_add_u32 s65, s65, 32768
    s_mov_b32 m0, s64
    s_add_u32 s64, s64, 1024
    buffer_load_dwordx4 v7, s[48:51], s65 offen nt lds
    s_add_u32 s65, s65, 32768
    s_mov_b32 m0, s64
    s_add_u32 s64, s64, 1024
    buffer_load_dwordx4 v8, s[48:51], s65 offen nt lds
    s_add_u32 s65, s65, 32768
    s_mov_b32 m0, s64
    s_add_u32 s64, s64, 1024
    buffer_load_dwordx4 v9, s[48:51], s65 offen nt lds
    s_add_u32 s65, s65, 32768
    s_mov_b32 m0, s64
    s_add_u32 s64, s64, 1024
    buffer_load_dwordx4 v6, s[48:51], s65 offen nt lds
    s_add_u32 s65, s65, 32768
    s_mov_b32 m0, s64
    s_add_u32 s64, s64, 1024
    buffer_load_dwordx4 v7, s[48:51], s65 offen nt lds
    s_add_u32 s65, s65, 32768
    s_mov_b32 m0, s64
    s_add_u32 s64, s64, 1024
    buffer_load_dwordx4 v8, s[48:51], s65 offen nt lds
    s_add_u32 s65, s65, 32768
    s_mov_b32 m0, s64
    s_add_u32 s64, s64, 1024
    buffer_load_dwordx4 v9, s[48:51], s65 offen nt lds
    s_add_u32 s65, s65, 32768
    s_mov_b32 m0, s64
    s_add_u32 s64, s64, 1024
    buffer_load_dwordx4 v6, s[48:51], s65 offen nt lds
    s_add_u32 s65, s65, 32768
    s_mov_b32 m0, s64
    s_add_u32 s64, s64, 1024
    buffer_load_dwordx4 v7, s[48:51], s65 offen nt lds
    s_add_u32 s65, s65, 32768
    s_mov_b32 m0, s64
    s_add_u32 s64, s64, 1024
    buffer_load_dwordx4 v8, s[48:51], s65 offen nt lds
    s_add_u32 s65, s65, 32768
    s_mov_b32 m0, s64
    s_add_u32 s64, s64, 1024
    buffer_load_dwordx4 v9, s[48:51], s65 offen nt lds
    s_add_u32 s65, s65, 32768
    s_mov_b32 m0, s64
    s_add_u32 s64, s64, 1024
    buffer_load_dwordx4 v6, s[48:51], s65 offen nt lds
    s_add_u32 s65, s65, 32768
    s_mov_b32 m0, s64
    s_add_u32 s64, s64, 1024
    buffer_load_dwordx4 v7, s[48:51], s65 offen nt lds
    s_add_u32 s65, s65, 32768
    s_mov_b32 m0, s64
    s_add_u32 s64, s64, 1024
    buffer_load_dwordx4 v8, s[48:51], s65 offen nt lds
    s_add_u32 s65, s65, 32768
    s_mov_b32 m0, s64
    s_add_u32 s64, s64, 1024
    buffer_load_dwordx4 v9, s[48:51], s65 offen nt lds
    s_add_u32 s65, s65, 32768
    s_mov_b32 m0, s64
    s_add_u32 s64, s64, 1024
    buffer_load_dwordx4 v6, s[48:51], s65 offen nt lds
    s_add_u32 s65, s65, 32768
    s_mov_b32 m0, s64
    s_add_u32 s64, s64, 1024
    buffer_load_dwordx4 v7, s[48:51], s65 offen nt lds
    s_add_u32 s65, s65, 32768
    s_mov_b32 m0, s64
    s_add_u32 s64, s64, 1024
    buffer_load_dwordx4 v8, s[48:51], s65 offen nt lds
    s_add_u32 s65, s65, 32768
    s_mov_b32 m0, s64
    s_add_u32 s64, s64, 1024
    buffer_load_dwordx4 v9, s[48:51], s65 offen nt lds
    s_add_u32 s65, s65, 32768
    s_mov_b32 m0, s64
    s_add_u32 s64, s64, 1024
    buffer_load_dwordx4 v6, s[48:51], s65 offen nt lds
    s_add_u32 s65, s65, 32768
    s_mov_b32 m0, s64
    s_add_u32 s64, s64, 1024
    buffer_load_dwordx4 v7, s[48:51], s65 offen nt lds
    s_add_u32 s65, s65, 32768
    s_mov_b32 m0, s64
    s_add_u32 s64, s64, 1024
    buffer_load_dwordx4 v8, s[48:51], s65 offen nt lds
    s_add_u32 s65, s65, 32768
    s_mov_b32 m0, s64
    s_add_u32 s64, s64, 1024
    buffer_load_dwordx4 v9, s[48:51], s65 offen nt lds
    s_add_u32 s65, s65, 32768
    s_mov_b32 m0, s64
    s_add_u32 s64, s64, 1024
    buffer_load_dwordx4 v6, s[48:51], s65 offen nt lds
    s_add_u32 s65, s65, 32768
    s_mov_b32 m0, s64
    s_add_u32 s64, s64, 1024
    buffer_load_dwordx4 v7, s[48:51], s65 offen nt lds
    s_add_u32 s65, s65, 32768
    s_mov_b32 m0, s64
    s_add_u32 s64, s64, 1024
    buffer_load_dwordx4 v8, s[48:51], s65 offen nt lds
    s_add_u32 s65, s65, 32768
    s_mov_b32 m0, s64
    s_add_u32 s64, s64, 1024
    buffer_load_dwordx4 v9, s[48:51], s65 offen nt lds
    s_add_u32 s65, s65, 32768
    s_mov_b32 s60, 32
    s_mov_b32 s36, s34
    s_and_b32 s37, s35, 0xffff
    s_mov_b32 s38, 0x1000000
    s_mov_b32 s39, 0x20000
    v_lshrrev_b32 v4, 1, v3
    v_xor_b32 v4, v4, v2
    v_lshlrev_b32 v4, 5, v4
    v_lshl_add_u32 v4, v2, 13, v4
    v_and_b32 v40, 1, v1
    v_lshl_add_u32 v4, v40, 4, v4
    v_xor_b32 v5, 0x80, v4
    s_mov_b32 s52, s14
    s_and_b32 s53, s15, 0xffff
    s_mov_b32 s54, 0x400000
    s_mov_b32 s55, 0x20000
    s_mov_b32 s96, 0x6010600
    s_mov_b32 s97, 0x5030502
    s_cmp_eq_u32 s5, 1
    s_cselect_b32 s96, 0x6170616, s96
    s_cselect_b32 s97, 0x5190518, s97
    s_cmp_eq_u32 s5, 2
    s_cselect_b32 s96, 0x62d062c, s96
    s_cselect_b32 s97, 0x52f052e, s97
    s_cmp_eq_u32 s5, 3
    s_cselect_b32 s96, 0x6430642, s96
    s_cselect_b32 s97, 0x5450544, s97
    s_cmp_eq_u32 s5, 4
    s_cselect_b32 s96, 0x5590558, s96
    s_cselect_b32 s97, 0x55b055a, s97
    s_cmp_eq_u32 s5, 5
    s_cselect_b32 s96, 0x56d056c, s96
    s_cselect_b32 s97, 0x56f056e, s97
    v_xor_b32 v10, v3, v2
    v_lshlrev_b32 v10, 4, v10
    v_lshl_add_u32 v10, v2, 8, v10
    v_xor_b32 v11, 0x40, v10
    v_xor_b32 v12, 0x80, v10
    v_xor_b32 v13, 0xc0, v10
    v_lshrrev_b32 v14, 1, v3
    v_xor_b32 v14, v14, v2
    v_lshlrev_b32 v14, 5, v14
    v_lshl_add_u32 v14, v2, 8, v14
    v_and_b32 v40, 1, v1
    v_lshl_add_u32 v14, v40, 4, v14
    v_xor_b32 v15, 0x80, v14
    s_mov_b32 s76, 0
    s_lshl_b32 s7, s76, 4
    s_lshr_b64 s[90:91], s[96:97], s7
    s_and_b32 s68, s90, 3
    s_bfe_u32 s72, s90, 0x50002
    s_lshl_b32 s68, s68, 5
    s_add_u32 s68, s68, s4
    s_lshl_b32 s68, s68, 20
    s_lshl_b32 s72, s72, 13
    s_add_u32 s72, s72, s68
    s_add_u32 s72, s72, 0xC0000
    s_mov_b32 s76, 1
    s_lshl_b32 s7, s76, 4
    s_lshr_b64 s[90:91], s[96:97], s7
    s_and_b32 s69, s90, 3
    s_bfe_u32 s73, s90, 0x50002
    s_lshl_b32 s69, s69, 5
    s_add_u32 s69, s69, s4
    s_lshl_b32 s69, s69, 20
    s_lshl_b32 s73, s73, 13
    s_add_u32 s73, s73, s69
    s_add_u32 s73, s73, 0xC0000
    s_mov_b32 s76, 2
    s_lshl_b32 s7, s76, 4
    s_lshr_b64 s[90:91], s[96:97], s7
    s_and_b32 s70, s90, 3
    s_bfe_u32 s74, s90, 0x50002
    s_lshl_b32 s70, s70, 5
    s_add_u32 s70, s70, s4
    s_lshl_b32 s70, s70, 20
    s_lshl_b32 s74, s74, 13
    s_add_u32 s74, s74, s70
    s_add_u32 s74, s74, 0xC0000
    s_mov_b32 s76, 3
    s_lshl_b32 s7, s76, 4
    s_lshr_b64 s[90:91], s[96:97], s7
    s_and_b32 s71, s90, 3
    s_bfe_u32 s75, s90, 0x50002
    s_lshl_b32 s71, s71, 5
    s_add_u32 s71, s71, s4
    s_lshl_b32 s71, s71, 20
    s_lshl_b32 s75, s75, 13
    s_add_u32 s75, s75, s71
    s_add_u32 s75, s75, 0xC0000
    v_lshrrev_b32 v20, 1, v3
    v_and_b32 v40, 1, v2
    v_xor_b32 v20, v20, v40
    v_lshlrev_b32 v20, 5, v20
    v_lshl_add_u32 v20, v2, 10, v20
    v_and_b32 v40, 1, v1
    v_lshl_add_u32 v20, v40, 4, v20
    v_xor_b32 v21, 0x40, v20
    v_xor_b32 v22, 0x80, v20
    v_xor_b32 v23, 0xc0, v20
    s_mov_b32 s56, s16
    s_and_b32 s57, s17, 0xffff
    s_mov_b32 s58, 0x400000
    s_mov_b32 s59, 0x20000
    s_waitcnt vmcnt(16)
    s_sub_u32 s7, s60, 16
    s_max_i32 s61, s61, s7
    v_mov_b32 v19, s61
    ds_write_b32 v16, v19
    s_mov_b32 s65, s67
    s_mov_b32 s64, 0x20000
    s_mov_b32 s66, 2
LL_36:
    s_waitcnt vmcnt(15)
    s_mov_b32 m0, s64
    s_add_u32 s64, s64, 1024
    buffer_load_dwordx4 v4, s[52:55], s65 offen nt lds
    s_add_u32 s65, s65, 32768
    s_waitcnt vmcnt(15)
    s_mov_b32 m0, s64
    s_add_u32 s64, s64, 1024
    buffer_load_dwordx4 v5, s[52:55], s65 offen nt lds
    s_add_u32 s65, s65, 32768
    s_waitcnt vmcnt(15)
    s_mov_b32 m0, s64
    s_add_u32 s64, s64, 1024
    buffer_load_dwordx4 v4, s[52:55], s65 offen nt lds
    s_add_u32 s65, s65, 32768
    s_waitcnt vmcnt(15)
    s_mov_b32 m0, s64
    s_add_u32 s64, s64, 1024
    buffer_load_dwordx4 v5, s[52:55], s65 offen nt lds
    s_add_u32 s65, s65, 32768
    s_waitcnt vmcnt(15)
    s_mov_b32 m0, s64
    s_add_u32 s64, s64, 1024
    buffer_load_dwordx4 v4, s[52:55], s65 offen nt lds
    s_add_u32 s65, s65, 32768
    s_waitcnt vmcnt(15)
    s_mov_b32 m0, s64
    s_add_u32 s64, s64, 1024
    buffer_load_dwordx4 v5, s[52:55], s65 offen nt lds
    s_add_u32 s65, s65, 32768
    s_waitcnt vmcnt(15)
    s_mov_b32 m0, s64
    s_add_u32 s64, s64, 1024
    buffer_load_dwordx4 v4, s[52:55], s65 offen nt lds
    s_add_u32 s65, s65, 32768
    s_waitcnt vmcnt(15)
    s_sub_u32 s7, s60, 8
    s_max_i32 s61, s61, s7
    v_mov_b32 v19, s61
    ds_write_b32 v16, v19
    s_mov_b32 m0, s64
    s_add_u32 s64, s64, 1024
    buffer_load_dwordx4 v5, s[52:55], s65 offen nt lds
    s_add_u32 s65, s65, 32768
    s_add_u32 s60, s60, 8
    s_sub_u32 s66, s66, 1
    s_cmp_lg_u32 s66, 0
    s_cbranch_scc1 LL_36
    s_lshl_b32 s65, s4, 17
    s_lshl_b32 s7, s5, 8
    s_add_u32 s65, s65, s7
    s_mov_b32 s64, 0
    s_mov_b32 s66, 2
LL_37:
    s_waitcnt vmcnt(15)
    s_mov_b32 m0, s64
    s_add_u32 s64, s64, 1024
    buffer_load_dwordx4 v20, s[56:59], s65 offen nt lds
    s_add_u32 s65, s65, 4096
    s_waitcnt vmcnt(15)
    s_mov_b32 m0, s64
    s_add_u32 s64, s64, 1024
    buffer_load_dwordx4 v20, s[56:59], s65 offen nt lds
    s_add_u32 s65, s65, 4096
    s_waitcnt vmcnt(15)
    s_mov_b32 m0, s64
    s_add_u32 s64, s64, 1024
    buffer_load_dwordx4 v20, s[56:59], s65 offen nt lds
    s_add_u32 s65, s65, 4096
    s_waitcnt vmcnt(15)
    s_mov_b32 m0, s64
    s_add_u32 s64, s64, 1024
    buffer_load_dwordx4 v20, s[56:59], s65 offen nt lds
    s_add_u32 s65, s65, 4096
    s_waitcnt vmcnt(15)
    s_mov_b32 m0, s64
    s_add_u32 s64, s64, 1024
    buffer_load_dwordx4 v21, s[56:59], s65 offen nt lds
    s_add_u32 s65, s65, 4096
    s_waitcnt vmcnt(15)
    s_mov_b32 m0, s64
    s_add_u32 s64, s64, 1024
    buffer_load_dwordx4 v21, s[56:59], s65 offen nt lds
    s_add_u32 s65, s65, 4096
    s_waitcnt vmcnt(15)
    s_mov_b32 m0, s64
    s_add_u32 s64, s64, 1024
    buffer_load_dwordx4 v21, s[56:59], s65 offen nt lds
    s_add_u32 s65, s65, 4096
    s_waitcnt vmcnt(15)
    s_sub_u32 s7, s60, 8
    s_max_i32 s61, s61, s7
    v_mov_b32 v19, s61
    ds_write_b32 v16, v19
    s_mov_b32 m0, s64
    s_add_u32 s64, s64, 1024
    buffer_load_dwordx4 v21, s[56:59], s65 offen nt lds
    s_add_u32 s65, s65, 4096
    s_waitcnt vmcnt(15)
    s_mov_b32 m0, s64
    s_add_u32 s64, s64, 1024
    buffer_load_dwordx4 v22, s[56:59], s65 offen nt lds
    s_add_u32 s65, s65, 4096
    s_waitcnt vmcnt(15)
    s_mov_b32 m0, s64
    s_add_u32 s64, s64, 1024
    buffer_load_dwordx4 v22, s[56:59], s65 offen nt lds
    s_add_u32 s65, s65, 4096
    s_waitcnt vmcnt(15)
    s_mov_b32 m0, s64
    s_add_u32 s64, s64, 1024
    buffer_load_dwordx4 v22, s[56:59], s65 offen nt lds
    s_add_u32 s65, s65, 4096
    s_waitcnt vmcnt(15)
    s_mov_b32 m0, s64
    s_add_u32 s64, s64, 1024
    buffer_load_dwordx4 v22, s[56:59], s65 offen nt lds
    s_add_u32 s65, s65, 4096
    s_waitcnt vmcnt(15)
    s_mov_b32 m0, s64
    s_add_u32 s64, s64, 1024
    buffer_load_dwordx4 v23, s[56:59], s65 offen nt lds
    s_add_u32 s65, s65, 4096
    s_waitcnt vmcnt(15)
    s_mov_b32 m0, s64
    s_add_u32 s64, s64, 1024
    buffer_load_dwordx4 v23, s[56:59], s65 offen nt lds
    s_add_u32 s65, s65, 4096
    s_waitcnt vmcnt(15)
    s_mov_b32 m0, s64
    s_add_u32 s64, s64, 1024
    buffer_load_dwordx4 v23, s[56:59], s65 offen nt lds
    s_add_u32 s65, s65, 4096
    s_waitcnt vmcnt(15)
    s_mov_b32 s61, s60
    v_mov_b32 v19, s61
    ds_write_b32 v16, v19
    s_mov_b32 m0, s64
    s_add_u32 s64, s64, 1024
    buffer_load_dwordx4 v23, s[56:59], s65 offen nt lds
    s_add_u32 s65, s65, 4096
    s_add_u32 s60, s60, 16
    s_sub_u32 s66, s66, 1
    s_cmp_lg_u32 s66, 0
    s_cbranch_scc1 LL_37
    s_mov_b32 s62, 4
    s_mov_b32 s44, s10
    s_and_b32 s45, s11, 0xffff
    s_mov_b32 s46, 0x8000000
    s_mov_b32 s47, 0x20000
    s_mov_b32 s48, s12
    s_and_b32 s49, s13, 0xffff
    s_mov_b32 s50, 0x8000000
    s_mov_b32 s51, 0x20000
    s_mov_b32 s68, s72
    s_mov_b32 s69, s73
    s_mov_b32 s70, s74
    s_mov_b32 s71, s75
    s_mov_b32 s66, 2
LL_38:
    s_waitcnt lgkmcnt(0)
    v_readlane_b32 s79, v18, s62
    s_cmp_lt_u32 s79, s63
    s_cbranch_scc1 ST_40
GO_39:
    s_waitcnt vmcnt(15)
    s_add_u32 s7, s64, 0
    s_mov_b32 m0, s7
    s_add_u32 s65, s68, 0
    buffer_load_dwordx4 v10, s[44:47], s65 offen offset:0 nt lds
    s_waitcnt vmcnt(15)
    buffer_load_dwordx4 v11, s[44:47], s65 offen offset:1024 nt lds
    s_waitcnt vmcnt(15)
    buffer_load_dwordx4 v12, s[44:47], s65 offen offset:2048 nt lds
    s_waitcnt vmcnt(15)
    buffer_load_dwordx4 v13, s[44:47], s65 offen offset:3072 nt lds
    s_waitcnt vmcnt(15)
    s_add_u32 s7, s64, 4096
    s_mov_b32 m0, s7
    s_add_u32 s65, s68, 4096
    buffer_load_dwordx4 v10, s[44:47], s65 offen offset:0 nt lds
    s_waitcnt vmcnt(15)
    buffer_load_dwordx4 v11, s[44:47], s65 offen offset:1024 nt lds
    ds_read_b32 v18, v17
    s_waitcnt vmcnt(15)
    buffer_load_dwordx4 v12, s[44:47], s65 offen offset:2048 nt lds
    s_waitcnt vmcnt(15)
    s_sub_u32 s7, s60, 8
    s_max_i32 s61, s61, s7
    v_mov_b32 v19, s61
    ds_write_b32 v16, v19
    buffer_load_dwordx4 v13, s[44:47], s65 offen offset:3072 nt lds
    s_add_u32 s60, s60, 8
    s_add_u32 s65, s65, 4096
    s_mov_b32 s68, s69
    s_mov_b32 s69, s70
    s_mov_b32 s70, s71
    s_mov_b32 s71, s65
    s_add_u32 s62, s62, 1
    s_add_u32 s64, s64, 8192
    s_cmp_eq_u32 s62, 10
    s_cselect_b32 s7, 4, 0
    s_add_u32 s63, s63, s7
    s_cmp_eq_u32 s62, 18
    s_cselect_b32 s62, 0, s62
    s_cselect_b32 s64, 0, s64
    s_sub_u32 s66, s66, 1
    s_cmp_lg_u32 s66, 0
    s_cbranch_scc1 LL_38
    s_mov_b32 s66, 20
LL_41:
    s_waitcnt lgkmcnt(0)
    v_readlane_b32 s79, v18, s62
    s_cmp_lt_u32 s79, s63
    s_cbranch_scc1 ST_43
GO_42:
    s_waitcnt vmcnt(19)
    s_add_u32 s7, s64, 0
    s_mov_b32 m0, s7
    s_add_u32 s65, s68, 0
    buffer_load_dwordx4 v10, s[44:47], s65 offen offset:0 nt lds
    s_waitcnt vmcnt(19)
    buffer_load_dwordx4 v11, s[44:47], s65 offen offset:1024 nt lds
    s_waitcnt vmcnt(19)
    buffer_load_dwordx4 v12, s[44:47], s65 offen offset:2048 nt lds
    s_waitcnt vmcnt(19)
    s_sub_u32 s7, s60, 16
    s_max_i32 s61, s61, s7
    v_mov_b32 v19, s61
    ds_write_b32 v16, v19
    buffer_load_dwordx4 v13, s[44:47], s65 offen offset:3072 nt lds
    s_waitcnt vmcnt(19)
    s_add_u32 s7, s64, 4096
    s_mov_b32 m0, s7
    s_add_u32 s65, s68, 4096
    buffer_load_dwordx4 v10, s[44:47], s65 offen offset:0 nt lds
    s_waitcnt vmcnt(19)
    buffer_load_dwordx4 v11, s[44:47], s65 offen offset:1024 nt lds
    ds_read_b32 v18, v17
    s_waitcnt vmcnt(19)
    buffer_load_dwordx4 v12, s[44:47], s65 offen offset:2048 nt lds
    s_waitcnt vmcnt(19)
    buffer_load_dwordx4 v13, s[44:47], s65 offen offset:3072 nt lds
    s_add_u32 s60, s60, 8
    s_add_u32 s65, s65, 4096
    s_mov_b32 s68, s69
    s_mov_b32 s69, s70
    s_mov_b32 s70, s71
    s_mov_b32 s71, s65
    s_add_u32 s62, s62, 1
    s_add_u32 s64, s64, 8192
    s_cmp_eq_u32 s62, 10
    s_cselect_b32 s7, 4, 0
    s_add_u32 s63, s63, s7
    s_cmp_eq_u32 s62, 18
    s_cselect_b32 s62, 0, s62
    s_cselect_b32 s64, 0, s64
    s_sub_u32 s66, s66, 1
    s_cmp_lg_u32 s66, 0
    s_cbranch_scc1 LL_41
    s_mov_b32 s68, s72
    s_mov_b32 s69, s73
    s_mov_b32 s70, s74
    s_mov_b32 s71, s75
    s_mov_b32 s66, 4
LL_44:
    s_waitcnt lgkmcnt(0)
    v_readlane_b32 s79, v18, s62
    s_cmp_lt_u32 s79, s63
    s_cbranch_scc1 ST_46
GO_45:
    s_waitcnt vmcnt(19)
    s_add_u32 s7, s64, 0
    s_mov_b32 m0, s7
    s_add_u32 s65, s68, 0
    buffer_load_dwordx4 v14, s[48:51], s65 offen offset:0 nt lds
    s_waitcnt vmcnt(19)
    buffer_load_dwordx4 v15, s[48:51], s65 offen offset:1024 nt lds
    s_waitcnt vmcnt(19)
    buffer_load_dwordx4 v14, s[48:51], s65 offen offset:2048 nt lds
    s_waitcnt vmcnt(19)
    s_sub_u32 s7, s60, 16
    s_max_i32 s61, s61, s7
    v_mov_b32 v19, s61
    ds_write_b32 v16, v19
    buffer_load_dwordx4 v15, s[48:51], s65 offen offset:3072 nt lds
    s_waitcnt vmcnt(19)
    s_add_u32 s7, s64, 4096
    s_mov_b32 m0, s7
    s_add_u32 s65, s68, 4096
    buffer_load_dwordx4 v14, s[48:51], s65 offen offset:0 nt lds
    s_waitcnt vmcnt(19)
    buffer_load_dwordx4 v15, s[48:51], s65 offen offset:1024 nt lds
    ds_read_b32 v18, v17
    s_waitcnt vmcnt(19)
    buffer_load_dwordx4 v14, s[48:51], s65 offen offset:2048 nt lds
    s_waitcnt vmcnt(19)
    buffer_load_dwordx4 v15, s[48:51], s65 offen offset:3072 nt lds
    s_add_u32 s60, s60, 8
    s_add_u32 s65, s65, 4096
    s_mov_b32 s68, s69
    s_mov_b32 s69, s70
    s_mov_b32 s70, s71
    s_mov_b32 s71, s65
    s_add_u32 s62, s62, 1
    s_add_u32 s64, s64, 8192
    s_cmp_eq_u32 s62, 10
    s_cselect_b32 s7, 4, 0
    s_add_u32 s63, s63, s7
    s_cmp_eq_u32 s62, 18
    s_cselect_b32 s62, 0, s62
    s_cselect_b32 s64, 0, s64
    s_sub_u32 s66, s66, 1
    s_cmp_lg_u32 s66, 0
    s_cbranch_scc1 LL_44
    s_mov_b32 s66, 18
LL_47:
    s_waitcnt lgkmcnt(0)
    v_readlane_b32 s79, v18, s62
    s_cmp_lt_u32 s79, s63
    s_cbranch_scc1 ST_49
GO_48:
    s_waitcnt vmcnt(31)
    s_add_u32 s7, s64, 0
    s_mov_b32 m0, s7
    s_add_u32 s65, s68, 0
    buffer_load_dwordx4 v14, s[48:51], s65 offen offset:0 nt lds
    s_waitcnt vmcnt(31)
    buffer_load_dwordx4 v15, s[48:51], s65 offen offset:1024 nt lds
    s_waitcnt vmcnt(31)
    buffer_load_dwordx4 v14, s[48:51], s65 offen offset:2048 nt lds
    s_waitcnt vmcnt(31)
    buffer_load_dwordx4 v15, s[48:51], s65 offen offset:3072 nt lds
    s_waitcnt vmcnt(31)
    s_add_u32 s7, s64, 4096
    s_mov_b32 m0, s7
    s_add_u32 s65, s68, 4096
    buffer_load_dwordx4 v14, s[48:51], s65 offen offset:0 nt lds
    s_waitcnt vmcnt(31)
    buffer_load_dwordx4 v15, s[48:51], s65 offen offset:1024 nt lds
    ds_read_b32 v18, v17
    s_waitcnt vmcnt(31)
    buffer_load_dwordx4 v14, s[48:51], s65 offen offset:2048 nt lds
    s_waitcnt vmcnt(31)
    s_sub_u32 s7, s60, 24
    s_max_i32 s61, s61, s7
    v_mov_b32 v19, s61
    ds_write_b32 v16, v19
    buffer_load_dwordx4 v15, s[48:51], s65 offen offset:3072 nt lds
    s_add_u32 s60, s60, 8
    s_add_u32 s65, s65, 4096
    s_mov_b32 s68, s69
    s_mov_b32 s69, s70
    s_mov_b32 s70, s71
    s_mov_b32 s71, s65
    s_add_u32 s62, s62, 1
    s_add_u32 s64, s64, 8192
    s_cmp_eq_u32 s62, 10
    s_cselect_b32 s7, 4, 0
    s_add_u32 s63, s63, s7
    s_cmp_eq_u32 s62, 18
    s_cselect_b32 s62, 0, s62
    s_cselect_b32 s64, 0, s64
    s_sub_u32 s66, s66, 1
    s_cmp_lg_u32 s66, 0
    s_cbranch_scc1 LL_47
    s_waitcnt vmcnt(24)
    s_sub_u32 s7, s60, 24
    s_max_i32 s61, s61, s7
    v_mov_b32 v19, s61
    ds_write_b32 v16, v19
    s_waitcnt vmcnt(16)
    s_sub_u32 s7, s60, 16
    s_max_i32 s61, s61, s7
    v_mov_b32 v19, s61
    ds_write_b32 v16, v19
    s_waitcnt vmcnt(8)
    s_sub_u32 s7, s60, 8
    s_max_i32 s61, s61, s7
    v_mov_b32 v19, s61
    ds_write_b32 v16, v19
    s_waitcnt vmcnt(0)
    s_mov_b32 s61, s60
    v_mov_b32 v19, s61
    ds_write_b32 v16, v19
    s_cmp_ge_u32 s5, 2
    s_cbranch_scc1 L_END
    v_mov_b32 v40, 0x24204
    s_mov_b32 s80, 1600000
LW_50:
    ds_read_b32 v41, v40
    s_waitcnt lgkmcnt(0)
    v_readfirstlane_b32 s79, v41
    s_cmp_ge_u32 s79, 1
    s_cbranch_scc1 LWD_51
    s_sleep 1
    s_sub_u32 s80, s80, 1
    s_cmp_lg_u32 s80, 0
    s_cbranch_scc1 LW_50
LWD_51:
    v_mov_b32 v40, 0x24248
    ds_read_b64 v[42:43], v40
    s_waitcnt lgkmcnt(0)
    v_readfirstlane_b32 s92, v42
    v_readfirstlane_b32 s93, v43
    s_mov_b32 s52, s30
    s_and_b32 s53, s31, 0xffff
    s_mov_b32 s54, 0x2000
    s_mov_b32 s55, 0x20000
    s_mov_b32 s84, 0x3f80
    s_mov_b32 s85, 0x3f800000
    s_lshl_b32 s60, s4, 1
    s_add_u32 s60, s60, s5
    s_lshl_b32 s7, s60, 12
    s_add_u32 s7, s7, 0x400000
    v_lshl_add_u32 v36, v1, 4, s7
    s_lshr_b32 s7, s60, 4
    s_lshl_b32 s7, s7, 11
    s_and_b32 s61, s60, 15
    s_lshl_b32 s61, s61, 6
    s_add_u32 s7, s7, s61
    v_lshl_add_u32 v37, v1, 3, s7
    v_mov_b32 v38, 0x24214
    s_mov_b32 s80, 1600000
LW_52:
    ds_read_b32 v39, v38
    s_waitcnt lgkmcnt(0)
    v_readfirstlane_b32 s79, v39
    s_cmp_ge_u32 s79, 4
    s_cbranch_scc1 LWD_53
    s_sleep 1
    s_sub_u32 s80, s80, 1
    s_cmp_lg_u32 s80, 0
    s_cbranch_scc1 LW_52
LWD_53:
    s_mov_b64 exec, -1
    buffer_load_dwordx4 v[48:51], v36, s[36:39], 0 offen offset:0 sc1
    buffer_load_dwordx4 v[52:55], v36, s[36:39], 0 offen offset:1024 sc1
    buffer_load_dwordx4 v[56:59], v36, s[36:39], 0 offen offset:2048 sc1
    buffer_load_dwordx4 v[60:63], v36, s[36:39], 0 offen offset:3072 sc1
    s_mov_b32 s80, 200000
MC_55:
    s_mov_b64 exec, -1
    s_waitcnt vmcnt(0)
    v_cmp_ne_u64 s[62:63], s[92:93], v[50:51]
    v_cmp_ne_u64 s[64:65], s[92:93], v[54:55]
    v_cmp_ne_u64 s[66:67], s[92:93], v[58:59]
    v_cmp_ne_u64 s[68:69], s[92:93], v[62:63]
    s_or_b64 s[90:91], s[62:63], s[64:65]
    s_or_b64 s[90:91], s[90:91], s[66:67]
    s_or_b64 s[90:91], s[90:91], s[68:69]
    s_cbranch_scc1 M_54
MD_56:
    s_mov_b64 exec, -1
    v_dot2_f32_bf16 v44, v48, s84, 0
    v_dot2_f32_bf16 v45, v48, s85, 0
    v_dot2_f32_bf16 v46, v49, s84, 0
    v_dot2_f32_bf16 v47, v49, s85, 0
    v_dot2_f32_bf16 v44, v52, s84, v44
    v_dot2_f32_bf16 v45, v52, s85, v45
    v_dot2_f32_bf16 v46, v53, s84, v46
    v_dot2_f32_bf16 v47, v53, s85, v47
    v_dot2_f32_bf16 v44, v56, s84, v44
    v_dot2_f32_bf16 v45, v56, s85, v45
    v_dot2_f32_bf16 v46, v57, s84, v46
    v_dot2_f32_bf16 v47, v57, s85, v47
    v_dot2_f32_bf16 v44, v60, s84, v44
    v_dot2_f32_bf16 v45, v60, s85, v45
    v_dot2_f32_bf16 v46, v61, s84, v46
    v_dot2_f32_bf16 v47, v61, s85, v47
    v_add_f32_dpp v44, v44, v44 row_ror:8 row_mask:0xf bank_mask:0xf
    v_add_f32_dpp v45, v45, v45 row_ror:8 row_mask:0xf bank_mask:0xf
    v_add_f32_dpp v46, v46, v46 row_ror:8 row_mask:0xf bank_mask:0xf
    v_add_f32_dpp v47, v47, v47 row_ror:8 row_mask:0xf bank_mask:0xf
    s_nop 0
    v_permlane32_swap_b32 v44, v46
    v_permlane32_swap_b32 v45, v47
    v_add_f32 v44, v44, v46
    v_add_f32 v45, v45, v47
    v_mov_b32 v46, v44
    v_mov_b32 v47, v45
    s_nop 0
    v_permlane16_swap_b32 v44, v46
    v_permlane16_swap_b32 v45, v47
    v_add_f32 v44, v44, v46
    v_add_f32 v45, v45, v47
    v_cvt_pk_bf16_f32 v44, v44, v45
    v_mov_b32 v45, v44
    s_nop 1
    v_permlane32_swap_b32 v44, v45
    s_mov_b64 exec, 0xff
    buffer_store_dwordx2 v[44:45], v37, s[52:55], 0 offen
    s_mov_b64 exec, -1
    s_endpgm
L_LDE:
    s_cmp_ge_u32 s5, 6
    s_cbranch_scc1 L_LDB
    v_lshrrev_b32 v4, 1, v3
    v_xor_b32 v4, v4, v2
    v_lshlrev_b32 v4, 5, v4
    v_lshl_add_u32 v4, v2, 13, v4
    v_and_b32 v40, 1, v1
    v_lshl_add_u32 v4, v40, 4, v4
    v_xor_b32 v5, 0x80, v4
    s_sub_u32 s65, s65, 0x200000
    s_mov_b32 s64, 0x20000
    s_waitcnt lgkmcnt(0)
    s_mov_b32 s52, s14
    s_and_b32 s53, s15, 0xffff
    s_mov_b32 s54, 0x400000
    s_mov_b32 s55, 0x20000
    s_barrier
    v_mov_b32 v40, 0x24200
    s_mov_b32 s80, 1600000
LW_57:
    ds_read_b32 v41, v40
    s_waitcnt lgkmcnt(0)
    v_readfirstlane_b32 s79, v41
    s_cmp_ge_u32 s79, 4
    s_cbranch_scc1 LWD_58
    s_sub_u32 s80, s80, 1
    s_cmp_lg_u32 s80, 0
    s_cbranch_scc1 LW_57
LWD_58:
    s_mov_b32 m0, s64
    s_add_u32 s64, s64, 1024
    buffer_load_dwordx4 v4, s[52:55], s65 offen nt lds
    s_add_u32 s65, s65, 32768
    s_mov_b32 m0, s64
    s_add_u32 s64, s64, 1024
    buffer_load_dwordx4 v5, s[52:55], s65 offen nt lds
    s_add_u32 s65, s65, 32768
    s_mov_b32 m0, s64
    s_add_u32 s64, s64, 1024
    buffer_load_dwordx4 v4, s[52:55], s65 offen nt lds
    s_add_u32 s65, s65, 32768
    s_mov_b32 m0, s64
    s_add_u32 s64, s64, 1024
    buffer_load_dwordx4 v5, s[52:55], s65 offen nt lds
    s_add_u32 s65, s65, 32768
    s_mov_b32 m0, s64
    s_add_u32 s64, s64, 1024
    buffer_load_dwordx4 v4, s[52:55], s65 offen nt lds
    s_add_u32 s65, s65, 32768
    s_mov_b32 m0, s64
    s_add_u32 s64, s64, 1024
    buffer_load_dwordx4 v5, s[52:55], s65 offen nt lds
    s_add_u32 s65, s65, 32768
    s_mov_b32 m0, s64
    s_add_u32 s64, s64, 1024
    buffer_load_dwordx4 v4, s[52:55], s65 offen nt lds
    s_add_u32 s65, s65, 32768
    s_mov_b32 m0, s64
    s_add_u32 s64, s64, 1024
    buffer_load_dwordx4 v5, s[52:55], s65 offen nt lds
    s_add_u32 s65, s65, 32768
    s_mov_b32 m0, s64
    s_add_u32 s64, s64, 1024
    buffer_load_dwordx4 v4, s[52:55], s65 offen nt lds
    s_add_u32 s65, s65, 32768
    s_mov_b32 m0, s64
    s_add_u32 s64, s64, 1024
    buffer_load_dwordx4 v5, s[52:55], s65 offen nt lds
    s_add_u32 s65, s65, 32768
    s_mov_b32 m0, s64
    s_add_u32 s64, s64, 1024
    buffer_load_dwordx4 v4, s[52:55], s65 offen nt lds
    s_add_u32 s65, s65, 32768
    s_mov_b32 m0, s64
    s_add_u32 s64, s64, 1024
    buffer_load_dwordx4 v5, s[52:55], s65 offen nt lds
    s_add_u32 s65, s65, 32768
    s_mov_b32 m0, s64
    s_add_u32 s64, s64, 1024
    buffer_load_dwordx4 v4, s[52:55], s65 offen nt lds
    s_add_u32 s65, s65, 32768
    s_mov_b32 m0, s64
    s_add_u32 s64, s64, 1024
    buffer_load_dwordx4 v5, s[52:55], s65 offen nt lds
    s_add_u32 s65, s65, 32768
    s_mov_b32 m0, s64
    s_add_u32 s64, s64, 1024
    buffer_load_dwordx4 v4, s[52:55], s65 offen nt lds
    s_add_u32 s65, s65, 32768
    s_mov_b32 m0, s64
    s_add_u32 s64, s64, 1024
    buffer_load_dwordx4 v5, s[52:55], s65 offen nt lds
    s_add_u32 s65, s65, 32768
    s_mov_b32 s60, 16
    s_mov_b32 s36, s34
    s_and_b32 s37, s35, 0xffff
    s_mov_b32 s38, 0x1000000
    s_mov_b32 s39, 0x20000
    s_mov_b32 s44, s26
    s_and_b32 s45, s27, 0xffff
    s_mov_b32 s46, 0x400000
    s_mov_b32 s47, 0x20000
    v_bfe_u32 v20, v1, 1, 2
    v_xor_b32 v20, v20, v2
    v_lshlrev_b32 v20, 5, v20
    v_lshrrev_b32 v40, 3, v1
    v_lshl_add_u32 v20, v40, 13, v20
    v_and_b32 v40, 1, v1
    v_lshl_add_u32 v20, v40, 4, v20
    s_mov_b32 s96, 0x6010600
    s_mov_b32 s97, 0x5030502
    s_cmp_eq_u32 s5, 1
    s_cselect_b32 s96, 0x6170616, s96
    s_cselect_b32 s97, 0x5190518, s97
    s_cmp_eq_u32 s5, 2
    s_cselect_b32 s96, 0x62d062c, s96
    s_cselect_b32 s97, 0x52f052e, s97
    s_cmp_eq_u32 s5, 3
    s_cselect_b32 s96, 0x6430642, s96
    s_cselect_b32 s97, 0x5450544, s97
    s_cmp_eq_u32 s5, 4
    s_cselect_b32 s96, 0x5590558, s96
    s_cselect_b32 s97, 0x55b055a, s97
    s_cmp_eq_u32 s5, 5
    s_cselect_b32 s96, 0x56d056c, s96
    s_cselect_b32 s97, 0x56f056e, s97
    v_xor_b32 v10, v3, v2
    v_lshlrev_b32 v10, 4, v10
    v_lshl_add_u32 v10, v2, 8, v10
    v_xor_b32 v11, 0x40, v10
    v_xor_b32 v12, 0x80, v10
    v_xor_b32 v13, 0xc0, v10
    v_lshrrev_b32 v14, 1, v3
    v_xor_b32 v14, v14, v2
    v_lshlrev_b32 v14, 5, v14
    v_lshl_add_u32 v14, v2, 8, v14
    v_and_b32 v40, 1, v1
    v_lshl_add_u32 v14, v40, 4, v14
    v_xor_b32 v15, 0x80, v14
    s_mov_b32 s76, 0
    s_lshl_b32 s7, s76, 4
    s_lshr_b64 s[90:91], s[96:97], s7
    s_and_b32 s68, s90, 3
    s_bfe_u32 s72, s90, 0x50002
    s_lshl_b32 s68, s68, 5
    s_add_u32 s68, s68, s4
    s_lshl_b32 s68, s68, 20
    s_lshl_b32 s72, s72, 13
    s_add_u32 s72, s72, s68
    s_add_u32 s72, s72, 0xC0000
    s_mov_b32 s76, 1
    s_lshl_b32 s7, s76, 4
    s_lshr_b64 s[90:91], s[96:97], s7
    s_and_b32 s69, s90, 3
    s_bfe_u32 s73, s90, 0x50002
    s_lshl_b32 s69, s69, 5
    s_add_u32 s69, s69, s4
    s_lshl_b32 s69, s69, 20
    s_lshl_b32 s73, s73, 13
    s_add_u32 s73, s73, s69
    s_add_u32 s73, s73, 0xC0000
    s_mov_b32 s76, 2
    s_lshl_b32 s7, s76, 4
    s_lshr_b64 s[90:91], s[96:97], s7
    s_and_b32 s70, s90, 3
    s_bfe_u32 s74, s90, 0x50002
    s_lshl_b32 s70, s70, 5
    s_add_u32 s70, s70, s4
    s_lshl_b32 s70, s70, 20
    s_lshl_b32 s74, s74, 13
    s_add_u32 s74, s74, s70
    s_add_u32 s74, s74, 0xC0000
    s_mov_b32 s76, 3
    s_lshl_b32 s7, s76, 4
    s_lshr_b64 s[90:91], s[96:97], s7
    s_and_b32 s71, s90, 3
    s_bfe_u32 s75, s90, 0x50002
    s_lshl_b32 s71, s71, 5
    s_add_u32 s71, s71, s4
    s_lshl_b32 s71, s71, 20
    s_lshl_b32 s75, s75, 13
    s_add_u32 s75, s75, s71
    s_add_u32 s75, s75, 0xC0000
    s_mov_b32 s64, 0x18000
    s_mov_b32 s66, 2
LL_59:
    s_waitcnt vmcnt(15)
    s_mov_b32 m0, s64
    s_add_u32 s64, s64, 1024
    buffer_load_dwordx4 v4, s[52:55], s65 offen nt lds
    s_add_u32 s65, s65, 32768
    s_waitcnt vmcnt(15)
    s_mov_b32 m0, s64
    s_add_u32 s64, s64, 1024
    buffer_load_dwordx4 v5, s[52:55], s65 offen nt lds
    s_add_u32 s65, s65, 32768
    s_waitcnt vmcnt(15)
    s_mov_b32 m0, s64
    s_add_u32 s64, s64, 1024
    buffer_load_dwordx4 v4, s[52:55], s65 offen nt lds
    s_add_u32 s65, s65, 32768
    s_waitcnt vmcnt(15)
    s_mov_b32 m0, s64
    s_add_u32 s64, s64, 1024
    buffer_load_dwordx4 v5, s[52:55], s65 offen nt lds
    s_add_u32 s65, s65, 32768
    s_waitcnt vmcnt(15)
    s_mov_b32 m0, s64
    s_add_u32 s64, s64, 1024
    buffer_load_dwordx4 v4, s[52:55], s65 offen nt lds
    s_add_u32 s65, s65, 32768
    s_waitcnt vmcnt(15)
    s_mov_b32 m0, s64
    s_add_u32 s64, s64, 1024
    buffer_load_dwordx4 v5, s[52:55], s65 offen nt lds
    s_add_u32 s65, s65, 32768
    s_waitcnt vmcnt(15)
    s_mov_b32 m0, s64
    s_add_u32 s64, s64, 1024
    buffer_load_dwordx4 v4, s[52:55], s65 offen nt lds
    s_add_u32 s65, s65, 32768
    s_waitcnt vmcnt(15)
    s_sub_u32 s7, s60, 8
    s_max_i32 s61, s61, s7
    v_mov_b32 v19, s61
    ds_write_b32 v16, v19
    s_mov_b32 m0, s64
    s_add_u32 s64, s64, 1024
    buffer_load_dwordx4 v5, s[52:55], s65 offen nt lds
    s_add_u32 s65, s65, 32768
    s_add_u32 s60, s60, 8
    s_sub_u32 s66, s66, 1
    s_cmp_lg_u32 s66, 0
    s_cbranch_scc1 LL_59
    s_lshl_b32 s65, s4, 8
    s_lshl_b32 s7, s5, 7
    s_add_u32 s65, s65, s7
    s_sub_u32 s65, s65, 512
    s_mov_b32 s64, 0
    s_mov_b32 s66, 8
LL_60:
    s_waitcnt vmcnt(15)
    s_mov_b32 m0, s64
    s_add_u32 s64, s64, 1024
    buffer_load_dwordx4 v20, s[44:47], s65 offen nt lds
    s_add_u32 s65, s65, 65536
    s_waitcnt vmcnt(15)
    s_mov_b32 m0, s64
    s_add_u32 s64, s64, 1024
    buffer_load_dwordx4 v20, s[44:47], s65 offen nt lds
    s_add_u32 s65, s65, 65536
    s_waitcnt vmcnt(15)
    s_mov_b32 m0, s64
    s_add_u32 s64, s64, 1024
    buffer_load_dwordx4 v20, s[44:47], s65 offen nt lds
    s_add_u32 s65, s65, 65536
    s_waitcnt vmcnt(15)
    s_mov_b32 m0, s64
    s_add_u32 s64, s64, 1024
    buffer_load_dwordx4 v20, s[44:47], s65 offen nt lds
    s_add_u32 s65, s65, 65536
    s_waitcnt vmcnt(15)
    s_mov_b32 m0, s64
    s_add_u32 s64, s64, 1024
    buffer_load_dwordx4 v20, s[44:47], s65 offen nt lds
    s_add_u32 s65, s65, 65536
    s_waitcnt vmcnt(15)
    s_mov_b32 m0, s64
    s_add_u32 s64, s64, 1024
    buffer_load_dwordx4 v20, s[44:47], s65 offen nt lds
    s_add_u32 s65, s65, 65536
    s_waitcnt vmcnt(15)
    s_mov_b32 m0, s64
    s_add_u32 s64, s64, 1024
    buffer_load_dwordx4 v20, s[44:47], s65 offen nt lds
    s_add_u32 s65, s65, 65536
    s_waitcnt vmcnt(15)
    s_sub_u32 s7, s60, 8
    s_max_i32 s61, s61, s7
    v_mov_b32 v19, s61
    ds_write_b32 v16, v19
    s_mov_b32 m0, s64
    s_add_u32 s64, s64, 1024
    buffer_load_dwordx4 v20, s[44:47], s65 offen nt lds
    s_add_u32 s65, s65, 65536
    s_add_u32 s60, s60, 8
    s_sub_u32 s66, s66, 1
    s_cmp_lg_u32 s66, 0
    s_cbranch_scc1 LL_60
    s_mov_b32 s62, 8
    s_mov_b32 s44, s10
    s_and_b32 s45, s11, 0xffff
    s_mov_b32 s46, 0x8000000
    s_mov_b32 s47, 0x20000
    s_mov_b32 s48, s12
    s_and_b32 s49, s13, 0xffff
    s_mov_b32 s50, 0x8000000
    s_mov_b32 s51, 0x20000
    s_mov_b32 s68, s72
    s_mov_b32 s69, s73
    s_mov_b32 s70, s74
    s_mov_b32 s71, s75
    s_mov_b32 s66, 20
LL_61:
    s_waitcnt lgkmcnt(0)
    v_readlane_b32 s79, v18, s62
    s_cmp_lt_u32 s79, s63
    s_cbranch_scc1 ST_63
GO_62:
    s_waitcnt vmcnt(19)
    s_add_u32 s7, s64, 0
    s_mov_b32 m0, s7
    s_add_u32 s65, s68, 0
    buffer_load_dwordx4 v10, s[44:47], s65 offen offset:0 nt lds
    s_waitcnt vmcnt(19)
    buffer_load_dwordx4 v11, s[44:47], s65 offen offset:1024 nt lds
    s_waitcnt vmcnt(19)
    buffer_load_dwordx4 v12, s[44:47], s65 offen offset:2048 nt lds
    s_waitcnt vmcnt(19)
    s_sub_u32 s7, s60, 16
    s_max_i32 s61, s61, s7
    v_mov_b32 v19, s61
    ds_write_b32 v16, v19
    buffer_load_dwordx4 v13, s[44:47], s65 offen offset:3072 nt lds
    s_waitcnt vmcnt(19)
    s_add_u32 s7, s64, 4096
    s_mov_b32 m0, s7
    s_add_u32 s65, s68, 4096
    buffer_load_dwordx4 v10, s[44:47], s65 offen offset:0 nt lds
    s_waitcnt vmcnt(19)
    buffer_load_dwordx4 v11, s[44:47], s65 offen offset:1024 nt lds
    ds_read_b32 v18, v17
    s_waitcnt vmcnt(19)
    buffer_load_dwordx4 v12, s[44:47], s65 offen offset:2048 nt lds
    s_waitcnt vmcnt(19)
    buffer_load_dwordx4 v13, s[44:47], s65 offen offset:3072 nt lds
    s_add_u32 s60, s60, 8
    s_add_u32 s65, s65, 4096
    s_mov_b32 s68, s69
    s_mov_b32 s69, s70
    s_mov_b32 s70, s71
    s_mov_b32 s71, s65
    s_add_u32 s62, s62, 1
    s_add_u32 s64, s64, 8192
    s_cmp_eq_u32 s62, 12
    s_cselect_b32 s7, 4, 0
    s_add_u32 s63, s63, s7
    s_cmp_eq_u32 s62, 18
    s_cselect_b32 s62, 0, s62
    s_cselect_b32 s64, 0, s64
    s_sub_u32 s66, s66, 1
    s_cmp_lg_u32 s66, 0
    s_cbranch_scc1 LL_61
    s_mov_b32 s68, s72
    s_mov_b32 s69, s73
    s_mov_b32 s70, s74
    s_mov_b32 s71, s75
    s_mov_b32 s66, 4
LL_64:
    s_waitcnt lgkmcnt(0)
    v_readlane_b32 s79, v18, s62
    s_cmp_lt_u32 s79, s63
    s_cbranch_scc1 ST_66
GO_65:
    s_waitcnt vmcnt(19)
    s_add_u32 s7, s64, 0
    s_mov_b32 m0, s7
    s_add_u32 s65, s68, 0
    buffer_load_dwordx4 v14, s[48:51], s65 offen offset:0 nt lds
    s_waitcnt vmcnt(19)
    buffer_load_dwordx4 v15, s[48:51], s65 offen offset:1024 nt lds
    s_waitcnt vmcnt(19)
    buffer_load_dwordx4 v14, s[48:51], s65 offen offset:2048 nt lds
    s_waitcnt vmcnt(19)
    s_sub_u32 s7, s60, 16
    s_max_i32 s61, s61, s7
    v_mov_b32 v19, s61
    ds_write_b32 v16, v19
    buffer_load_dwordx4 v15, s[48:51], s65 offen offset:3072 nt lds
    s_waitcnt vmcnt(19)
    s_add_u32 s7, s64, 4096
    s_mov_b32 m0, s7
    s_add_u32 s65, s68, 4096
    buffer_load_dwordx4 v14, s[48:51], s65 offen offset:0 nt lds
    s_waitcnt vmcnt(19)
    buffer_load_dwordx4 v15, s[48:51], s65 offen offset:1024 nt lds
    ds_read_b32 v18, v17
    s_waitcnt vmcnt(19)
    buffer_load_dwordx4 v14, s[48:51], s65 offen offset:2048 nt lds
    s_waitcnt vmcnt(19)
    buffer_load_dwordx4 v15, s[48:51], s65 offen offset:3072 nt lds
    s_add_u32 s60, s60, 8
    s_add_u32 s65, s65, 4096
    s_mov_b32 s68, s69
    s_mov_b32 s69, s70
    s_mov_b32 s70, s71
    s_mov_b32 s71, s65
    s_add_u32 s62, s62, 1
    s_add_u32 s64, s64, 8192
    s_cmp_eq_u32 s62, 12
    s_cselect_b32 s7, 4, 0
    s_add_u32 s63, s63, s7
    s_cmp_eq_u32 s62, 18
    s_cselect_b32 s62, 0, s62
    s_cselect_b32 s64, 0, s64
    s_sub_u32 s66, s66, 1
    s_cmp_lg_u32 s66, 0
    s_cbranch_scc1 LL_64
    s_mov_b32 s66, 16
LL_67:
    s_waitcnt lgkmcnt(0)
    v_readlane_b32 s79, v18, s62
    s_cmp_lt_u32 s79, s63
    s_cbranch_scc1 ST_69
GO_68:
    s_waitcnt vmcnt(31)
    s_add_u32 s7, s64, 0
    s_mov_b32 m0, s7
    s_add_u32 s65, s68, 0
    buffer_load_dwordx4 v14, s[48:51], s65 offen offset:0 nt lds
    s_waitcnt vmcnt(31)
    buffer_load_dwordx4 v15, s[48:51], s65 offen offset:1024 nt lds
    s_waitcnt vmcnt(31)
    buffer_load_dwordx4 v14, s[48:51], s65 offen offset:2048 nt lds
    s_waitcnt vmcnt(31)
    buffer_load_dwordx4 v15, s[48:51], s65 offen offset:3072 nt lds
    s_waitcnt vmcnt(31)
    s_add_u32 s7, s64, 4096
    s_mov_b32 m0, s7
    s_add_u32 s65, s68, 4096
    buffer_load_dwordx4 v14, s[48:51], s65 offen offset:0 nt lds
    s_waitcnt vmcnt(31)
    buffer_load_dwordx4 v15, s[48:51], s65 offen offset:1024 nt lds
    ds_read_b32 v18, v17
    s_waitcnt vmcnt(31)
    buffer_load_dwordx4 v14, s[48:51], s65 offen offset:2048 nt lds
    s_waitcnt vmcnt(31)
    s_sub_u32 s7, s60, 24
    s_max_i32 s61, s61, s7
    v_mov_b32 v19, s61
    ds_write_b32 v16, v19
    buffer_load_dwordx4 v15, s[48:51], s65 offen offset:3072 nt lds
    s_add_u32 s60, s60, 8
    s_add_u32 s65, s65, 4096
    s_mov_b32 s68, s69
    s_mov_b32 s69, s70
    s_mov_b32 s70, s71
    s_mov_b32 s71, s65
    s_add_u32 s62, s62, 1
    s_add_u32 s64, s64, 8192
    s_cmp_eq_u32 s62, 12
    s_cselect_b32 s7, 4, 0
    s_add_u32 s63, s63, s7
    s_cmp_eq_u32 s62, 18
    s_cselect_b32 s62, 0, s62
    s_cselect_b32 s64, 0, s64
    s_sub_u32 s66, s66, 1
    s_cmp_lg_u32 s66, 0
    s_cbranch_scc1 LL_67
    s_waitcnt vmcnt(24)
    s_sub_u32 s7, s60, 24
    s_max_i32 s61, s61, s7
    v_mov_b32 v19, s61
    ds_write_b32 v16, v19
    s_waitcnt vmcnt(16)
    s_sub_u32 s7, s60, 16
    s_max_i32 s61, s61, s7
    v_mov_b32 v19, s61
    ds_write_b32 v16, v19
    s_waitcnt vmcnt(8)
    s_sub_u32 s7, s60, 8
    s_max_i32 s61, s61, s7
    v_mov_b32 v19, s61
    ds_write_b32 v16, v19
    s_waitcnt vmcnt(0)
    s_mov_b32 s61, s60
    v_mov_b32 v19, s61
    ds_write_b32 v16, v19
    s_endpgm
L_LDB:
    v_lshlrev_b32 v20, 4, v1
    v_xor_b32 v21, 0x40, v20
    v_xor_b32 v22, 0x80, v20
    v_xor_b32 v23, 0xc0, v20
    v_xor_b32 v24, 0x10, v20
    v_xor_b32 v25, 0x50, v20
    v_xor_b32 v26, 0x90, v20
    v_xor_b32 v27, 0xd0, v20
    v_xor_b32 v28, 0x20, v20
    v_xor_b32 v29, 0x60, v20
    v_xor_b32 v30, 0xa0, v20
    v_xor_b32 v31, 0xe0, v20
    v_xor_b32 v32, 0x30, v20
    v_xor_b32 v33, 0x70, v20
    v_xor_b32 v34, 0xb0, v20
    v_xor_b32 v35, 0xf0, v20
    s_and_b32 s69, s4, 7
    s_lshl_b32 s69, s69, 3
    s_lshr_b32 s7, s4, 3
    s_lshl_b32 s7, s7, 1
    s_add_u32 s69, s69, s7
    s_add_u32 s69, s69, s5
    s_sub_u32 s69, s69, 6
    s_lshl_b32 s68, s69, 18
    s_mov_b32 s64, 0
    s_waitcnt lgkmcnt(0)
    s_mov_b32 s44, s20
    s_and_b32 s45, s21, 0xffff
    s_mov_b32 s46, 0x1000000
    s_mov_b32 s47, 0x20000
    s_barrier
    v_mov_b32 v40, 0x24200
    s_mov_b32 s80, 1600000
LW_70:
    ds_read_b32 v41, v40
    s_waitcnt lgkmcnt(0)
    v_readfirstlane_b32 s79, v41
    s_cmp_ge_u32 s79, 4
    s_cbranch_scc1 LWD_71
    s_sub_u32 s80, s80, 1
    s_cmp_lg_u32 s80, 0
    s_cbranch_scc1 LW_70
LWD_71:
    s_add_u32 s7, s64, 0
    s_mov_b32 m0, s7
    s_add_u32 s65, s68, 0
    buffer_load_dwordx4 v20, s[44:47], s65 offen offset:0 nt lds
    buffer_load_dwordx4 v21, s[44:47], s65 offen offset:1024 nt lds
    buffer_load_dwordx4 v22, s[44:47], s65 offen offset:2048 nt lds
    buffer_load_dwordx4 v23, s[44:47], s65 offen offset:3072 nt lds
    s_add_u32 s7, s64, 4096
    s_mov_b32 m0, s7
    s_add_u32 s65, s68, 4096
    buffer_load_dwordx4 v24, s[44:47], s65 offen offset:0 nt lds
    buffer_load_dwordx4 v25, s[44:47], s65 offen offset:1024 nt lds
    buffer_load_dwordx4 v26, s[44:47], s65 offen offset:2048 nt lds
    buffer_load_dwordx4 v27, s[44:47], s65 offen offset:3072 nt lds
    s_add_u32 s7, s64, 8192
    s_mov_b32 m0, s7
    s_add_u32 s65, s68, 8192
    buffer_load_dwordx4 v28, s[44:47], s65 offen offset:0 nt lds
    buffer_load_dwordx4 v29, s[44:47], s65 offen offset:1024 nt lds
    buffer_load_dwordx4 v30, s[44:47], s65 offen offset:2048 nt lds
    buffer_load_dwordx4 v31, s[44:47], s65 offen offset:3072 nt lds
    s_add_u32 s7, s64, 12288
    s_mov_b32 m0, s7
    s_add_u32 s65, s68, 12288
    buffer_load_dwordx4 v32, s[44:47], s65 offen offset:0 nt lds
    buffer_load_dwordx4 v33, s[44:47], s65 offen offset:1024 nt lds
    buffer_load_dwordx4 v34, s[44:47], s65 offen offset:2048 nt lds
    buffer_load_dwordx4 v35, s[44:47], s65 offen offset:3072 nt lds
    s_mov_b32 s60, 16
    s_mov_b32 s36, s34
    s_and_b32 s37, s35, 0xffff
    s_mov_b32 s38, 0x1000000
    s_mov_b32 s39, 0x20000
    s_add_u32 s68, s68, 16384
    s_mov_b32 s64, 16384
    s_mov_b32 s48, s28
    s_and_b32 s49, s29, 0xffff
    s_mov_b32 s50, 0x400000
    s_mov_b32 s51, 0x20000
    v_bfe_u32 v10, v1, 1, 2
    v_xor_b32 v10, v10, v2
    v_lshlrev_b32 v10, 5, v10
    v_lshrrev_b32 v40, 3, v1
    v_lshl_add_u32 v10, v40, 10, v10
    v_and_b32 v40, 1, v1
    v_lshl_add_u32 v10, v40, 4, v10
    s_mov_b32 s72, 0x22111155
    s_mov_b32 s73, 0x2
    s_lshl_b32 s7, s69, 9
    s_add_u32 s7, s7, 0x28000
    v_lshl_add_u32 v44, v1, 4, s7
    s_mov_b32 s66, 6
LL_72:
    s_waitcnt vmcnt(27)
    s_add_u32 s7, s64, 0
    s_mov_b32 m0, s7
    s_add_u32 s65, s68, 0
    buffer_load_dwordx4 v20, s[44:47], s65 offen offset:0 nt lds
    s_waitcnt vmcnt(27)
    buffer_load_dwordx4 v21, s[44:47], s65 offen offset:1024 nt lds
    s_waitcnt vmcnt(27)
    buffer_load_dwordx4 v22, s[44:47], s65 offen offset:2048 nt lds
    s_waitcnt vmcnt(27)
    s_sub_u32 s7, s60, 24
    s_max_i32 s61, s61, s7
    v_mov_b32 v19, s61
    ds_write_b32 v16, v19
    buffer_load_dwordx4 v23, s[44:47], s65 offen offset:3072 nt lds
    s_waitcnt vmcnt(27)
    s_add_u32 s7, s64, 4096
    s_mov_b32 m0, s7
    s_add_u32 s65, s68, 4096
    buffer_load_dwordx4 v24, s[44:47], s65 offen offset:0 nt lds
    s_waitcnt vmcnt(27)
    buffer_load_dwordx4 v25, s[44:47], s65 offen offset:1024 nt lds
    s_waitcnt vmcnt(27)
    buffer_load_dwordx4 v26, s[44:47], s65 offen offset:2048 nt lds
    s_waitcnt vmcnt(27)
    buffer_load_dwordx4 v27, s[44:47], s65 offen offset:3072 nt lds
    s_waitcnt vmcnt(27)
    s_add_u32 s7, s64, 8192
    s_mov_b32 m0, s7
    s_add_u32 s65, s68, 8192
    buffer_load_dwordx4 v28, s[44:47], s65 offen offset:0 nt lds
    s_waitcnt vmcnt(27)
    buffer_load_dwordx4 v29, s[44:47], s65 offen offset:1024 nt lds
    s_waitcnt vmcnt(27)
    buffer_load_dwordx4 v30, s[44:47], s65 offen offset:2048 nt lds
    s_waitcnt vmcnt(27)
    s_sub_u32 s7, s60, 16
    s_max_i32 s61, s61, s7
    v_mov_b32 v19, s61
    ds_write_b32 v16, v19
    buffer_load_dwordx4 v31, s[44:47], s65 offen offset:3072 nt lds
    s_waitcnt vmcnt(27)
    s_add_u32 s7, s64, 12288
    s_mov_b32 m0, s7
    s_add_u32 s65, s68, 12288
    buffer_load_dwordx4 v32, s[44:47], s65 offen offset:0 nt lds
    s_waitcnt vmcnt(27)
    buffer_load_dwordx4 v33, s[44:47], s65 offen offset:1024 nt lds
    s_waitcnt vmcnt(27)
    buffer_load_dwordx4 v34, s[44:47], s65 offen offset:2048 nt lds
    s_waitcnt vmcnt(27)
    buffer_load_dwordx4 v35, s[44:47], s65 offen offset:3072 nt lds
    s_add_u32 s60, s60, 16
    s_add_u32 s68, s68, 16384
    s_add_u32 s64, s64, 16384
    s_sub_u32 s66, s66, 1
    s_cmp_lg_u32 s66, 0
    s_cbranch_scc1 LL_72
    v_mov_b32 v45, 0
    s_mov_b64 exec, 0x01010101
    buffer_store_dword v45, v44, s[36:39], 0 offen
    buffer_load_dword v45, v44, s[36:39], 0 offen sc1 nt
    s_mov_b64 exec, -1
    v_mov_b32 v40, 0x24204
    s_mov_b32 s80, 1600000
LW_73:
    ds_read_b32 v41, v40
    s_waitcnt lgkmcnt(0)
    v_readfirstlane_b32 s79, v41
    s_cmp_ge_u32 s79, 1
    s_cbranch_scc1 LWD_74
    s_sleep 1
    s_sub_u32 s80, s80, 1
    s_cmp_lg_u32 s80, 0
    s_cbranch_scc1 LW_73
LWD_74:
    v_mov_b32 v40, 0x24248
    ds_read_b64 v[42:43], v40
    s_waitcnt lgkmcnt(0)
    v_readfirstlane_b32 s92, v42
    v_readfirstlane_b32 s93, v43
    s_lshr_b32 s7, s69, 3
    s_lshl_b32 s7, s7, 7
    s_add_u32 s7, s7, 0x22000
    v_and_b32 v38, 7, v1
    v_lshl_add_u32 v38, v38, 3, s7
    s_mov_b32 s66, 9
LL_75:
    s_and_b32 s63, s72, 3
    s_lshl_b32 s63, s63, 3
    s_bfe_u32 s62, s72, 0x20002
    s_lshr_b64 s[72:73], s[72:73], 4
    s_waitcnt lgkmcnt(0)
    v_readlane_b32 s79, v18, s62
    s_cmp_lt_u32 s79, s63
    s_cbranch_scc1 ST_77
GO_76:
    s_waitcnt vmcnt(31)
    s_add_u32 s7, s64, 0
    s_mov_b32 m0, s7
    s_add_u32 s65, s68, 0
    buffer_load_dwordx4 v20, s[44:47], s65 offen offset:0 nt lds
    s_waitcnt vmcnt(31)
    buffer_load_dwordx4 v21, s[44:47], s65 offen offset:1024 nt lds
    s_waitcnt vmcnt(31)
    buffer_load_dwordx4 v22, s[44:47], s65 offen offset:2048 nt lds
    s_waitcnt vmcnt(31)
    buffer_load_dwordx4 v23, s[44:47], s65 offen offset:3072 nt lds
    s_waitcnt vmcnt(31)
    s_add_u32 s7, s64, 4096
    s_mov_b32 m0, s7
    s_add_u32 s65, s68, 4096
    buffer_load_dwordx4 v24, s[44:47], s65 offen offset:0 nt lds
    s_waitcnt vmcnt(31)
    buffer_load_dwordx4 v25, s[44:47], s65 offen offset:1024 nt lds
    s_waitcnt vmcnt(31)
    buffer_load_dwordx4 v26, s[44:47], s65 offen offset:2048 nt lds
    s_waitcnt vmcnt(31)
    s_sub_u32 s7, s60, 24
    s_max_i32 s61, s61, s7
    v_mov_b32 v19, s61
    ds_write_b32 v16, v19
    buffer_load_dwordx4 v27, s[44:47], s65 offen offset:3072 nt lds
    s_waitcnt vmcnt(31)
    s_add_u32 s7, s64, 8192
    s_mov_b32 m0, s7
    s_add_u32 s65, s68, 8192
    buffer_load_dwordx4 v28, s[44:47], s65 offen offset:0 nt lds
    s_waitcnt vmcnt(31)
    buffer_load_dwordx4 v29, s[44:47], s65 offen offset:1024 nt lds
    s_waitcnt vmcnt(31)
    buffer_load_dwordx4 v30, s[44:47], s65 offen offset:2048 nt lds
    s_waitcnt vmcnt(31)
    buffer_load_dwordx4 v31, s[44:47], s65 offen offset:3072 nt lds
    s_waitcnt vmcnt(31)
    s_add_u32 s7, s64, 12288
    s_mov_b32 m0, s7
    s_add_u32 s65, s68, 12288
    buffer_load_dwordx4 v32, s[44:47], s65 offen offset:0 nt lds
    s_waitcnt vmcnt(31)
    buffer_load_dwordx4 v33, s[44:47], s65 offen offset:1024 nt lds
    ds_read_b32 v18, v17
    s_waitcnt vmcnt(31)
    buffer_load_dwordx4 v34, s[44:47], s65 offen offset:2048 nt lds
    s_waitcnt vmcnt(31)
    s_sub_u32 s7, s60, 16
    s_max_i32 s61, s61, s7
    v_mov_b32 v19, s61
    ds_write_b32 v16, v19
    buffer_load_dwordx4 v35, s[44:47], s65 offen offset:3072 nt lds
    s_add_u32 s60, s60, 16
    s_add_u32 s68, s68, 16384
    s_add_u32 s64, s64, 16384
    s_cmp_eq_u32 s64, 147456
    s_cselect_b32 s64, 0, s64
    s_sub_u32 s66, s66, 1
    s_cmp_lg_u32 s66, 0
    s_cbranch_scc1 LL_75
    buffer_load_dwordx2 v[46:47], v38, s[36:39], 0 offen sc1
    s_lshr_b32 s65, s69, 3
    s_lshl_b32 s65, s65, 17
    s_and_b32 s7, s69, 7
    s_lshl_b32 s7, s7, 7
    s_add_u32 s65, s65, s7
    s_mov_b32 s64, 114688
    s_mov_b32 s63, 24
    s_waitcnt lgkmcnt(0)
    v_readlane_b32 s79, v18, 0
    s_cmp_lt_u32 s79, s63
    s_cbranch_scc1 ST_79
GO_78:
    s_mov_b32 s66, 1
LL_80:
    s_waitcnt vmcnt(31)
    s_mov_b32 m0, s64
    s_add_u32 s64, s64, 1024
    buffer_load_dwordx4 v10, s[48:51], s65 offen nt lds
    s_add_u32 s65, s65, 8192
    s_waitcnt vmcnt(31)
    s_mov_b32 m0, s64
    s_add_u32 s64, s64, 1024
    buffer_load_dwordx4 v10, s[48:51], s65 offen nt lds
    s_add_u32 s65, s65, 8192
    s_waitcnt vmcnt(31)
    s_mov_b32 m0, s64
    s_add_u32 s64, s64, 1024
    buffer_load_dwordx4 v10, s[48:51], s65 offen nt lds
    s_add_u32 s65, s65, 8192
    s_waitcnt vmcnt(31)
    s_mov_b32 m0, s64
    s_add_u32 s64, s64, 1024
    buffer_load_dwordx4 v10, s[48:51], s65 offen nt lds
    s_add_u32 s65, s65, 8192
    s_waitcnt vmcnt(31)
    s_mov_b32 m0, s64
    s_add_u32 s64, s64, 1024
    buffer_load_dwordx4 v10, s[48:51], s65 offen nt lds
    s_add_u32 s65, s65, 8192
    s_waitcnt vmcnt(31)
    s_mov_b32 m0, s64
    s_add_u32 s64, s64, 1024
    buffer_load_dwordx4 v10, s[48:51], s65 offen nt lds
    s_add_u32 s65, s65, 8192
    s_waitcnt vmcnt(31)
    s_mov_b32 m0, s64
    s_add_u32 s64, s64, 1024
    buffer_load_dwordx4 v10, s[48:51], s65 offen nt lds
    s_add_u32 s65, s65, 8192
    s_waitcnt vmcnt(31)
    s_sub_u32 s7, s60, 24
    s_max_i32 s61, s61, s7
    v_mov_b32 v19, s61
    ds_write_b32 v16, v19
    s_mov_b32 m0, s64
    s_add_u32 s64, s64, 1024
    buffer_load_dwordx4 v10, s[48:51], s65 offen nt lds
    s_add_u32 s65, s65, 8192
    s_waitcnt vmcnt(31)
    s_mov_b32 m0, s64
    s_add_u32 s64, s64, 1024
    buffer_load_dwordx4 v10, s[48:51], s65 offen nt lds
    s_add_u32 s65, s65, 8192
    s_waitcnt vmcnt(31)
    s_mov_b32 m0, s64
    s_add_u32 s64, s64, 1024
    buffer_load_dwordx4 v10, s[48:51], s65 offen nt lds
    s_add_u32 s65, s65, 8192
    s_waitcnt vmcnt(31)
    s_mov_b32 m0, s64
    s_add_u32 s64, s64, 1024
    buffer_load_dwordx4 v10, s[48:51], s65 offen nt lds
    s_add_u32 s65, s65, 8192
    s_waitcnt vmcnt(31)
    s_mov_b32 m0, s64
    s_add_u32 s64, s64, 1024
    buffer_load_dwordx4 v10, s[48:51], s65 offen nt lds
    s_add_u32 s65, s65, 8192
    s_waitcnt vmcnt(31)
    s_mov_b32 m0, s64
    s_add_u32 s64, s64, 1024
    buffer_load_dwordx4 v10, s[48:51], s65 offen nt lds
    s_add_u32 s65, s65, 8192
    s_waitcnt vmcnt(31)
    s_mov_b32 m0, s64
    s_add_u32 s64, s64, 1024
    buffer_load_dwordx4 v10, s[48:51], s65 offen nt lds
    s_add_u32 s65, s65, 8192
    s_waitcnt vmcnt(31)
    s_mov_b32 m0, s64
    s_add_u32 s64, s64, 1024
    buffer_load_dwordx4 v10, s[48:51], s65 offen nt lds
    s_add_u32 s65, s65, 8192
    s_waitcnt vmcnt(31)
    s_sub_u32 s7, s60, 16
    s_max_i32 s61, s61, s7
    v_mov_b32 v19, s61
    ds_write_b32 v16, v19
    s_mov_b32 m0, s64
    s_add_u32 s64, s64, 1024
    buffer_load_dwordx4 v10, s[48:51], s65 offen nt lds
    s_add_u32 s65, s65, 8192
    s_add_u32 s60, s60, 16
    s_add_u32 s65, s65, 917504
    s_sub_u32 s66, s66, 1
    s_cmp_lg_u32 s66, 0
    s_cbranch_scc1 LL_80
    s_waitcnt vmcnt(24)
    s_sub_u32 s7, s60, 24
    s_max_i32 s61, s61, s7
    v_mov_b32 v19, s61
    ds_write_b32 v16, v19
    s_waitcnt vmcnt(16)
    s_sub_u32 s7, s60, 16
    s_max_i32 s61, s61, s7
    v_mov_b32 v19, s61
    ds_write_b32 v16, v19
    s_waitcnt vmcnt(8)
    s_sub_u32 s7, s60, 8
    s_max_i32 s61, s61, s7
    v_mov_b32 v19, s61
    ds_write_b32 v16, v19
    s_waitcnt vmcnt(0)
    s_mov_b32 s61, s60
    v_mov_b32 v19, s61
    ds_write_b32 v16, v19
    v_and_b32 v45, 31, v1
    v_lshlrev_b32 v45, 3, v45
    v_lshrrev_b32 v48, 5, v1
    v_lshl_add_u32 v45, v48, 11, v45
    v_add_u32 v45, 0x24400, v45
    s_or_b32 s7, s92, s78
    v_cmp_ne_u32 vcc, s7, v46
    s_cmp_eq_u64 vcc, 0
    s_cselect_b32 s101, 1, 0
    v_mov_b32 v48, 0x2420c
    s_mov_b32 s80, 1600000
LW_82:
    ds_read_b32 v49, v48
    s_waitcnt lgkmcnt(0)
    v_readfirstlane_b32 s79, v49
    s_cmp_ge_u32 s79, 48
    s_cbranch_scc1 LWD_83
    s_sub_u32 s80, s80, 1
    s_cmp_lg_u32 s80, 0
    s_cbranch_scc1 LW_82
LWD_83:
    ds_read_b64 v[48:49], v45 offset:0
    ds_read_b64 v[50:51], v45 offset:256
    ds_read_b64 v[52:53], v45 offset:512
    ds_read_b64 v[54:55], v45 offset:768
    ds_read_b64 v[56:57], v45 offset:1024
    ds_read_b64 v[58:59], v45 offset:1280
    ds_read_b64 v[60:61], v45 offset:1536
    ds_read_b64 v[62:63], v45 offset:1792
    s_waitcnt lgkmcnt(0)
    v_max3_f32 v40, v48, v50, v52
    v_max3_f32 v40, v40, v54, v56
    v_max3_f32 v40, v40, v58, v60
    v_max_f32 v40, v40, v62
    v_mov_b32 v41, v40
    s_nop 1
    v_permlane32_swap_b32 v40, v41
    v_max_f32 v40, v40, v41
    v_sub_f32 v48, v48, v40
    v_sub_f32 v50, v50, v40
    v_sub_f32 v52, v52, v40
    v_sub_f32 v54, v54, v40
    v_sub_f32 v56, v56, v40
    v_sub_f32 v58, v58, v40
    v_sub_f32 v60, v60, v40
    v_sub_f32 v62, v62, v40
    v_exp_f32 v48, v48
    v_exp_f32 v50, v50
    v_exp_f32 v52, v52
    v_exp_f32 v54, v54
    v_exp_f32 v56, v56
    v_exp_f32 v58, v58
    v_exp_f32 v60, v60
    v_exp_f32 v62, v62
    v_mul_f32 v41, v48, v49
    v_fmac_f32 v41, v50, v51
    v_fmac_f32 v41, v52, v53
    v_fmac_f32 v41, v54, v55
    v_fmac_f32 v41, v56, v57
    v_fmac_f32 v41, v58, v59
    v_fmac_f32 v41, v60, v61
    v_fmac_f32 v41, v62, v63
    v_mov_b32 v48, v41
    s_nop 1
    v_permlane32_swap_b32 v41, v48
    v_add_f32 v41, v41, v48
    s_mov_b64 exec, 0xffffffff
    s_cmp_eq_u32 s101, 0
    s_cbranch_scc1 SU_84
    buffer_store_dwordx4 v[40:43], v44, s[36:39], 0 offen
SV_85:
    s_mov_b64 exec, -1
    v_mov_b32 v48, 0x24218
    s_mov_b32 s80, 1600000
LW_86:
    ds_read_b32 v49, v48
    s_waitcnt lgkmcnt(0)
    v_readfirstlane_b32 s79, v49
    s_cmp_ge_u32 s79, 16
    s_cbranch_scc1 LWD_87
    s_sleep 1
    s_sub_u32 s80, s80, 1
    s_cmp_lg_u32 s80, 0
    s_cbranch_scc1 LW_86
LWD_87:
LWO_81:
    s_mov_b32 s66, 1
LL_88:
    s_waitcnt vmcnt(31)
    s_mov_b32 m0, s64
    s_add_u32 s64, s64, 1024
    buffer_load_dwordx4 v10, s[48:51], s65 offen nt lds
    s_add_u32 s65, s65, 8192
    s_waitcnt vmcnt(31)
    s_mov_b32 m0, s64
    s_add_u32 s64, s64, 1024
    buffer_load_dwordx4 v10, s[48:51], s65 offen nt lds
    s_add_u32 s65, s65, 8192
    s_waitcnt vmcnt(31)
    s_mov_b32 m0, s64
    s_add_u32 s64, s64, 1024
    buffer_load_dwordx4 v10, s[48:51], s65 offen nt lds
    s_add_u32 s65, s65, 8192
    s_waitcnt vmcnt(31)
    s_mov_b32 m0, s64
    s_add_u32 s64, s64, 1024
    buffer_load_dwordx4 v10, s[48:51], s65 offen nt lds
    s_add_u32 s65, s65, 8192
    s_waitcnt vmcnt(31)
    s_mov_b32 m0, s64
    s_add_u32 s64, s64, 1024
    buffer_load_dwordx4 v10, s[48:51], s65 offen nt lds
    s_add_u32 s65, s65, 8192
    s_waitcnt vmcnt(31)
    s_mov_b32 m0, s64
    s_add_u32 s64, s64, 1024
    buffer_load_dwordx4 v10, s[48:51], s65 offen nt lds
    s_add_u32 s65, s65, 8192
    s_waitcnt vmcnt(31)
    s_mov_b32 m0, s64
    s_add_u32 s64, s64, 1024
    buffer_load_dwordx4 v10, s[48:51], s65 offen nt lds
    s_add_u32 s65, s65, 8192
    s_waitcnt vmcnt(31)
    s_sub_u32 s7, s60, 24
    s_max_i32 s61, s61, s7
    v_mov_b32 v19, s61
    ds_write_b32 v16, v19
    s_mov_b32 m0, s64
    s_add_u32 s64, s64, 1024
    buffer_load_dwordx4 v10, s[48:51], s65 offen nt lds
    s_add_u32 s65, s65, 8192
    s_waitcnt vmcnt(31)
    s_mov_b32 m0, s64
    s_add_u32 s64, s64, 1024
    buffer_load_dwordx4 v10, s[48:51], s65 offen nt lds
    s_add_u32 s65, s65, 8192
    s_waitcnt vmcnt(31)
    s_mov_b32 m0, s64
    s_add_u32 s64, s64, 1024
    buffer_load_dwordx4 v10, s[48:51], s65 offen nt lds
    s_add_u32 s65, s65, 8192
    s_waitcnt vmcnt(31)
    s_mov_b32 m0, s64
    s_add_u32 s64, s64, 1024
    buffer_load_dwordx4 v10, s[48:51], s65 offen nt lds
    s_add_u32 s65, s65, 8192
    s_waitcnt vmcnt(31)
    s_mov_b32 m0, s64
    s_add_u32 s64, s64, 1024
    buffer_load_dwordx4 v10, s[48:51], s65 offen nt lds
    s_add_u32 s65, s65, 8192
    s_waitcnt vmcnt(31)
    s_mov_b32 m0, s64
    s_add_u32 s64, s64, 1024
    buffer_load_dwordx4 v10, s[48:51], s65 offen nt lds
    s_add_u32 s65, s65, 8192
    s_waitcnt vmcnt(31)
    s_mov_b32 m0, s64
    s_add_u32 s64, s64, 1024
    buffer_load_dwordx4 v10, s[48:51], s65 offen nt lds
    s_add_u32 s65, s65, 8192
    s_waitcnt vmcnt(31)
    s_mov_b32 m0, s64
    s_add_u32 s64, s64, 1024
    buffer_load_dwordx4 v10, s[48:51], s65 offen nt lds
    s_add_u32 s65, s65, 8192
    s_waitcnt vmcnt(31)
    s_sub_u32 s7, s60, 16
    s_max_i32 s61, s61, s7
    v_mov_b32 v19, s61
    ds_write_b32 v16, v19
    s_mov_b32 m0, s64
    s_add_u32 s64, s64, 1024
    buffer_load_dwordx4 v10, s[48:51], s65 offen nt lds
    s_add_u32 s65, s65, 8192
    s_add_u32 s60, s60, 16
    s_add_u32 s65, s65, 917504
    s_sub_u32 s66, s66, 1
    s_cmp_lg_u32 s66, 0
    s_cbranch_scc1 LL_88
    s_mov_b32 s64, 0
    s_mov_b32 s66, 2
LL_89:
    s_waitcnt vmcnt(31)
    s_mov_b32 m0, s64
    s_add_u32 s64, s64, 1024
    buffer_load_dwordx4 v10, s[48:51], s65 offen nt lds
    s_add_u32 s65, s65, 8192
    s_waitcnt vmcnt(31)
    s_mov_b32 m0, s64
    s_add_u32 s64, s64, 1024
    buffer_load_dwordx4 v10, s[48:51], s65 offen nt lds
    s_add_u32 s65, s65, 8192
    s_waitcnt vmcnt(31)
    s_mov_b32 m0, s64
    s_add_u32 s64, s64, 1024
    buffer_load_dwordx4 v10, s[48:51], s65 offen nt lds
    s_add_u32 s65, s65, 8192
    s_waitcnt vmcnt(31)
    s_mov_b32 m0, s64
    s_add_u32 s64, s64, 1024
    buffer_load_dwordx4 v10, s[48:51], s65 offen nt lds
    s_add_u32 s65, s65, 8192
    s_waitcnt vmcnt(31)
    s_mov_b32 m0, s64
    s_add_u32 s64, s64, 1024
    buffer_load_dwordx4 v10, s[48:51], s65 offen nt lds
    s_add_u32 s65, s65, 8192
    s_waitcnt vmcnt(31)
    s_mov_b32 m0, s64
    s_add_u32 s64, s64, 1024
    buffer_load_dwordx4 v10, s[48:51], s65 offen nt lds
    s_add_u32 s65, s65, 8192
    s_waitcnt vmcnt(31)
    s_mov_b32 m0, s64
    s_add_u32 s64, s64, 1024
    buffer_load_dwordx4 v10, s[48:51], s65 offen nt lds
    s_add_u32 s65, s65, 8192
    s_waitcnt vmcnt(31)
    s_sub_u32 s7, s60, 24
    s_max_i32 s61, s61, s7
    v_mov_b32 v19, s61
    ds_write_b32 v16, v19
    s_mov_b32 m0, s64
    s_add_u32 s64, s64, 1024
    buffer_load_dwordx4 v10, s[48:51], s65 offen nt lds
    s_add_u32 s65, s65, 8192
    s_waitcnt vmcnt(31)
    s_mov_b32 m0, s64
    s_add_u32 s64, s64, 1024
    buffer_load_dwordx4 v10, s[48:51], s65 offen nt lds
    s_add_u32 s65, s65, 8192
    s_waitcnt vmcnt(31)
    s_mov_b32 m0, s64
    s_add_u32 s64, s64, 1024
    buffer_load_dwordx4 v10, s[48:51], s65 offen nt lds
    s_add_u32 s65, s65, 8192
    s_waitcnt vmcnt(31)
    s_mov_b32 m0, s64
    s_add_u32 s64, s64, 1024
    buffer_load_dwordx4 v10, s[48:51], s65 offen nt lds
    s_add_u32 s65, s65, 8192
    s_waitcnt vmcnt(31)
    s_mov_b32 m0, s64
    s_add_u32 s64, s64, 1024
    buffer_load_dwordx4 v10, s[48:51], s65 offen nt lds
    s_add_u32 s65, s65, 8192
    s_waitcnt vmcnt(31)
    s_mov_b32 m0, s64
    s_add_u32 s64, s64, 1024
    buffer_load_dwordx4 v10, s[48:51], s65 offen nt lds
    s_add_u32 s65, s65, 8192
    s_waitcnt vmcnt(31)
    s_mov_b32 m0, s64
    s_add_u32 s64, s64, 1024
    buffer_load_dwordx4 v10, s[48:51], s65 offen nt lds
    s_add_u32 s65, s65, 8192
    s_waitcnt vmcnt(31)
    s_mov_b32 m0, s64
    s_add_u32 s64, s64, 1024
    buffer_load_dwordx4 v10, s[48:51], s65 offen nt lds
    s_add_u32 s65, s65, 8192
    s_waitcnt vmcnt(31)
    s_sub_u32 s7, s60, 16
    s_max_i32 s61, s61, s7
    v_mov_b32 v19, s61
    ds_write_b32 v16, v19
    s_mov_b32 m0, s64
    s_add_u32 s64, s64, 1024
    buffer_load_dwordx4 v10, s[48:51], s65 offen nt lds
    s_add_u32 s65, s65, 8192
    s_add_u32 s60, s60, 16
    s_add_u32 s65, s65, 917504
    s_sub_u32 s66, s66, 1
    s_cmp_lg_u32 s66, 0
    s_cbranch_scc1 LL_89
    s_waitcnt vmcnt(24)
    s_sub_u32 s7, s60, 24
    s_max_i32 s61, s61, s7
    v_mov_b32 v19, s61
    ds_write_b32 v16, v19
    s_waitcnt vmcnt(16)
    s_sub_u32 s7, s60, 16
    s_max_i32 s61, s61, s7
    v_mov_b32 v19, s61
    ds_write_b32 v16, v19
    s_waitcnt vmcnt(8)
    s_sub_u32 s7, s60, 8
    s_max_i32 s61, s61, s7
    v_mov_b32 v19, s61
    ds_write_b32 v16, v19
    s_waitcnt vmcnt(0)
    s_mov_b32 s61, s60
    v_mov_b32 v19, s61
    ds_write_b32 v16, v19
    s_cmp_eq_u32 s5, 7
    s_cbranch_scc1 L_END
    s_mov_b32 s52, s30
    s_and_b32 s53, s31, 0xffff
    s_mov_b32 s54, 0x2000
    s_mov_b32 s55, 0x20000
    s_mov_b32 s84, 0x3f80
    s_mov_b32 s85, 0x3f800000
    s_lshl_b32 s7, s4, 11
    s_add_u32 s7, s7, 0x480000
    v_lshl_add_u32 v36, v1, 4, s7
    s_lshl_b32 s7, s4, 5
    s_add_u32 s7, s7, 1024
    v_and_b32 v38, 3, v1
    v_lshl_add_u32 v37, v38, 3, s7
    v_lshrrev_b32 v38, 2, v3
    v_lshl_add_u32 v37, v38, 11, v37
    v_mov_b32 v38, 0x24214
    s_mov_b32 s80, 1600000
LW_90:
    ds_read_b32 v39, v38
    s_waitcnt lgkmcnt(0)
    v_readfirstlane_b32 s79, v39
    s_cmp_ge_u32 s79, 4
    s_cbranch_scc1 LWD_91
    s_sleep 1
    s_sub_u32 s80, s80, 1
    s_cmp_lg_u32 s80, 0
    s_cbranch_scc1 LW_90
LWD_91:
    s_mov_b64 exec, -1
    buffer_load_dwordx4 v[48:51], v36, s[36:39], 0 offen offset:0 sc1
    buffer_load_dwordx4 v[52:55], v36, s[36:39], 0 offen offset:1024 sc1
    s_mov_b32 s80, 200000
MC_93:
    s_mov_b64 exec, -1
    s_waitcnt vmcnt(0)
    v_cmp_ne_u64 s[62:63], s[92:93], v[50:51]
    v_cmp_ne_u64 s[64:65], s[92:93], v[54:55]
    s_or_b64 s[90:91], s[62:63], s[64:65]
    s_cbranch_scc1 M_92
MD_94:
    s_mov_b64 exec, -1
    v_dot2_f32_bf16 v44, v48, s84, 0
    v_dot2_f32_bf16 v45, v48, s85, 0
    v_dot2_f32_bf16 v46, v49, s84, 0
    v_dot2_f32_bf16 v47, v49, s85, 0
    v_dot2_f32_bf16 v44, v52, s84, v44
    v_dot2_f32_bf16 v45, v52, s85, v45
    v_dot2_f32_bf16 v46, v53, s84, v46
    v_dot2_f32_bf16 v47, v53, s85, v47
    s_nop 1
    v_permlane32_swap_b32 v44, v46
    v_permlane32_swap_b32 v45, v47
    v_add_f32 v44, v44, v46
    v_add_f32 v45, v45, v47
    v_mov_b32 v46, v44
    v_mov_b32 v47, v45
    s_nop 0
    v_permlane16_swap_b32 v44, v46
    v_permlane16_swap_b32 v45, v47
    v_add_f32 v44, v44, v46
    v_add_f32 v45, v45, v47
    v_cvt_pk_bf16_f32 v44, v44, v45
    v_mov_b32 v45, v44
    s_nop 1
    v_permlane32_swap_b32 v44, v45
    s_mov_b64 exec, 0xffff
    buffer_store_dwordx2 v[44:45], v37, s[52:55], 0 offen
    s_mov_b64 exec, -1
    s_endpgm
L_AATT:
    v_lshl_add_u32 v8, v2, 4, s63
    s_waitcnt lgkmcnt(0)
    ds_read_b128 v[16:19], v8 offset:0
    ds_read_b128 v[20:23], v8 offset:64
    ds_read_b128 v[24:27], v8 offset:128
    ds_read_b128 v[28:31], v8 offset:192
    v_xor_b32 v4, v3, v2
    v_lshlrev_b32 v4, 4, v4
    v_lshl_add_u32 v4, v3, 8, v4
    v_lshrrev_b32 v9, 2, v1
    v_and_b32 v5, 7, v9
    v_lshlrev_b32 v5, 5, v5
    v_lshl_add_u32 v5, v9, 8, v5
    v_and_b32 v10, 3, v1
    v_lshl_add_u32 v5, v10, 3, v5
    s_lshl_b32 s7, s61, 10
    s_add_u32 s7, s7, 0x24e00
    v_lshl_add_u32 v6, v2, 4, s7
    v_cmp_eq_u32 s[84:85], 0, v3
    s_mov_b32 s72, 0x3e0293ee
    s_cmp_ge_u32 s5, 4
    s_cselect_b32 s73, 10, 8
    s_cselect_b32 s69, 8, 4
    s_cselect_b32 s70, 13, 11
    s_cselect_b32 s74, 20, 22
    s_add_u32 s70, s70, s61
    s_add_u32 s74, s74, s70
    s_lshl_b32 s70, s70, 3
    s_add_u32 s69, s69, s61
    s_cmp_ge_u32 s69, 18
    s_cselect_b32 s7, 18, 0
    s_sub_u32 s69, s69, s7
    s_mov_b32 s71, s68
AK_95:
    s_lshl_b32 s7, s69, 13
    v_add_u32 v104, s7, v4
    v_xor_b32 v105, 0x40, v104
    v_xor_b32 v106, 0x80, v104
    v_xor_b32 v107, 0xc0, v104
    s_lshl_b32 s62, s69, 2
    s_add_u32 s62, s62, 0x24100
    v_mov_b32 v8, 0x24000
    s_mov_b32 s80, 1600000
LW_96:
    ds_read_b32 v9, v8
    s_waitcnt lgkmcnt(0)
    v_readfirstlane_b32 s79, v9
    s_cmp_ge_u32 s79, s70
    s_cbranch_scc1 LWD_97
    s_sleep 2
    s_sub_u32 s80, s80, 1
    s_cmp_lg_u32 s80, 0
    s_cbranch_scc1 LW_96
LWD_97:
    ds_read_b128 v[32:35], v104 offset:0
    ds_read_b128 v[36:39], v104 offset:4096
    ds_read_b128 v[40:43], v105 offset:0
    ds_read_b128 v[44:47], v105 offset:4096
    ds_read_b128 v[48:51], v106 offset:0
    ds_read_b128 v[52:55], v106 offset:4096
    ds_read_b128 v[56:59], v107 offset:0
    ds_read_b128 v[60:63], v107 offset:4096
    s_waitcnt lgkmcnt(6)
    v_mfma_f32_16x16x32_bf16 v[64:67], v[32:35], v[16:19], 0
    v_mfma_f32_16x16x32_bf16 v[68:71], v[36:39], v[16:19], 0
    s_waitcnt lgkmcnt(4)
    v_mfma_f32_16x16x32_bf16 v[64:67], v[40:43], v[20:23], v[64:67]
    v_mfma_f32_16x16x32_bf16 v[68:71], v[44:47], v[20:23], v[68:71]
    s_waitcnt lgkmcnt(2)
    v_mfma_f32_16x16x32_bf16 v[64:67], v[48:51], v[24:27], v[64:67]
    v_mfma_f32_16x16x32_bf16 v[68:71], v[52:55], v[24:27], v[68:71]
    s_waitcnt lgkmcnt(0)
    v_mfma_f32_16x16x32_bf16 v[64:67], v[56:59], v[28:31], v[64:67]
    v_mfma_f32_16x16x32_bf16 v[68:71], v[60:63], v[28:31], v[68:71]
    v_mov_b32 v8, s62
    v_mov_b32 v9, 4
    s_mov_b64 exec, 1
    ds_add_u32 v8, v9
    s_mov_b64 exec, -1
    s_mov_b64 exec, s[84:85]
    s_nop 0
    ds_write_b128 v6, v[64:67] offset:0
    ds_write_b128 v6, v[68:71] offset:64
    s_mov_b64 exec, -1
    v_add_u32 v6, 128, v6
    s_add_u32 s69, s69, 4
    s_cmp_ge_u32 s69, 18
    s_cselect_b32 s7, 18, 0
    s_sub_u32 s69, s69, s7
    s_add_u32 s70, s70, 32
    s_sub_u32 s71, s71, 1
    s_cmp_lg_u32 s71, 0
    s_cbranch_scc1 AK_95
    v_lshrrev_b32 v8, 2, v1
    v_cmp_gt_u32 s[86:87], s68, v8
    v_and_b32 v8, 7, v8
    v_and_b32 v9, 3, v1
    v_lshlrev_b32 v9, 4, v9
    v_lshl_add_u32 v10, v8, 7, v9
    s_lshl_b32 s7, s61, 10
    s_add_u32 s7, s7, 0x24e00
    v_add_u32 v10, s7, v10
    s_waitcnt lgkmcnt(0)
    ds_read_b128 v[32:35], v10
    ds_read_b128 v[36:39], v10 offset:64
    s_lshl_b32 s7, s61, 9
    s_add_u32 s7, s7, 0x25e00
    v_lshl_add_u32 v10, v8, 6, v9
    v_add_u32 v10, s7, v10
    v_lshl_add_u32 v7, v2, 4, s7
    v_mov_b32 v11, 0xff800000
    s_waitcnt lgkmcnt(0)
    v_cndmask_b32 v32, v11, v32, s[86:87]
    v_cndmask_b32 v33, v11, v33, s[86:87]
    v_cndmask_b32 v34, v11, v34, s[86:87]
    v_cndmask_b32 v35, v11, v35, s[86:87]
    v_cndmask_b32 v36, v11, v36, s[86:87]
    v_cndmask_b32 v37, v11, v37, s[86:87]
    v_cndmask_b32 v38, v11, v38, s[86:87]
    v_cndmask_b32 v39, v11, v39, s[86:87]
    v_max3_f32 v64, v32, v33, v34
    v_max3_f32 v64, v64, v35, v36
    v_max3_f32 v64, v64, v37, v38
    v_max_f32 v64, v64, v39
    s_nop 1
    v_max_f32_dpp v64, v64, v64 row_ror:1 row_mask:0xf bank_mask:0xf
    s_nop 1
    v_max_f32_dpp v64, v64, v64 row_ror:2 row_mask:0xf bank_mask:0xf
    s_nop 1
    v_max_f32_dpp v64, v64, v64 row_ror:4 row_mask:0xf bank_mask:0xf
    s_nop 1
    v_max_f32_dpp v64, v64, v64 row_ror:8 row_mask:0xf bank_mask:0xf
    v_mov_b32 v11, v64
    s_nop 1
    v_permlane32_swap_b32 v64, v11
    v_max_f32 v64, v64, v11
    v_mov_b32 v11, v64
    s_nop 1
    v_permlane16_swap_b32 v64, v11
    v_max_f32 v64, v64, v11
    v_mul_f32 v64, s72, v64
    v_fma_f32 v32, v32, s72, -v64
    v_fma_f32 v33, v33, s72, -v64
    v_fma_f32 v34, v34, s72, -v64
    v_fma_f32 v35, v35, s72, -v64
    v_fma_f32 v36, v36, s72, -v64
    v_fma_f32 v37, v37, s72, -v64
    v_fma_f32 v38, v38, s72, -v64
    v_fma_f32 v39, v39, s72, -v64
    v_exp_f32 v32, v32
    v_exp_f32 v33, v33
    v_exp_f32 v34, v34
    v_exp_f32 v35, v35
    v_exp_f32 v36, v36
    v_exp_f32 v37, v37
    v_exp_f32 v38, v38
    v_exp_f32 v39, v39
    v_cvt_pk_bf16_f32 v112, v32, v33
    v_cvt_pk_bf16_f32 v113, v34, v35
    v_cvt_pk_bf16_f32 v114, v36, v37
    v_cvt_pk_bf16_f32 v115, v38, v39
    s_mov_b64 exec, s[86:87]
    ds_write_b128 v10, v[112:115]
    s_mov_b64 exec, -1
    v_add_f32 v32, v32, v36
    v_add_f32 v33, v33, v37
    v_add_f32 v34, v34, v38
    v_add_f32 v35, v35, v39
    v_add_f32 v32, v32, v34
    v_add_f32 v33, v33, v35
    v_add_f32 v32, v32, v33
    v_mov_b32 v65, v32
    s_nop 1
    v_add_f32_dpp v65, v65, v65 row_ror:1 row_mask:0xf bank_mask:0xf
    s_nop 1
    v_add_f32_dpp v65, v65, v65 row_ror:2 row_mask:0xf bank_mask:0xf
    s_nop 1
    v_add_f32_dpp v65, v65, v65 row_ror:4 row_mask:0xf bank_mask:0xf
    s_nop 1
    v_add_f32_dpp v65, v65, v65 row_ror:8 row_mask:0xf bank_mask:0xf
    v_mov_b32 v11, v65
    s_nop 1
    v_permlane32_swap_b32 v65, v11
    v_add_f32 v65, v65, v11
    v_mov_b32 v11, v65
    s_nop 1
    v_permlane16_swap_b32 v65, v11
    v_add_f32 v65, v65, v11
    v_mov_b32 v8, 0x24204
    s_mov_b32 s80, 1600000
LW_98:
    ds_read_b32 v9, v8
    s_waitcnt lgkmcnt(0)
    v_readfirstlane_b32 s79, v9
    s_cmp_ge_u32 s79, 1
    s_cbranch_scc1 LWD_99
    s_sleep 1
    s_sub_u32 s80, s80, 1
    s_cmp_lg_u32 s80, 0
    s_cbranch_scc1 LW_98
LWD_99:
    v_mov_b32 v8, 0x24248
    ds_read_b64 v[10:11], v8
    s_waitcnt lgkmcnt(0)
    v_readfirstlane_b32 s92, v10
    v_readfirstlane_b32 s93, v11
    s_nop 0
    v_mov_b32 v66, s92
    v_mov_b32 v67, s93
    s_lshl_b32 s7, s4, 2
    s_add_u32 s7, s7, s66
    s_lshl_b32 s7, s7, 3
    s_add_u32 s7, s7, s5
    s_lshl_b32 s7, s7, 4
    s_add_u32 s7, s7, 0x24000
    v_mov_b32 v8, s7
    s_mov_b64 exec, 1
    s_cmp_eq_u32 s101, 0
    s_cbranch_scc1 SU_100
    buffer_store_dwordx4 v[64:67], v8, s[36:39], 0 offen
SV_101:
    s_mov_b64 exec, -1
    v_mov_b32 v10, 0x24210
    v_mov_b32 v11, 1
    s_mov_b64 exec, 1
    ds_add_u32 v10, v11
    s_mov_b64 exec, -1
    v_mov_b32 v72, 0
    v_mov_b32 v73, 0
    v_mov_b32 v74, 0
    v_mov_b32 v75, 0
    v_mov_b32 v76, 0
    v_mov_b32 v77, 0
    v_mov_b32 v78, 0
    v_mov_b32 v79, 0
    v_mov_b32 v80, 0
    v_mov_b32 v81, 0
    v_mov_b32 v82, 0
    v_mov_b32 v83, 0
    v_mov_b32 v84, 0
    v_mov_b32 v85, 0
    v_mov_b32 v86, 0
    v_mov_b32 v87, 0
    v_mov_b32 v88, 0
    v_mov_b32 v89, 0
    v_mov_b32 v90, 0
    v_mov_b32 v91, 0
    v_mov_b32 v92, 0
    v_mov_b32 v93, 0
    v_mov_b32 v94, 0
    v_mov_b32 v95, 0
    v_mov_b32 v96, 0
    v_mov_b32 v97, 0
    v_mov_b32 v98, 0
    v_mov_b32 v99, 0
    v_mov_b32 v100, 0
    v_mov_b32 v101, 0
    v_mov_b32 v102, 0
    v_mov_b32 v103, 0
    s_lshl_b32 s7, s4, 3
    s_add_u32 s7, s7, s5
    s_lshl_b32 s7, s7, 2
    s_add_u32 s7, s7, s66
    s_lshl_b32 s7, s7, 9
    s_add_u32 s7, s7, 0x40000
    v_lshl_add_u32 v6, v1, 4, s7
    v_mov_b32 v116, 0
    s_mov_b64 exec, 0x01010101
    buffer_store_dword v116, v6, s[36:39], 0 offen
    buffer_load_dword v116, v6, s[36:39], 0 offen sc1 nt
    s_mov_b64 exec, -1
    s_add_u32 s69, s73, s61
    s_lshl_b32 s70, s74, 3
    s_cmp_ge_u32 s69, 18
    s_cselect_b32 s7, 18, 0
    s_sub_u32 s69, s69, s7
    s_mov_b32 s71, s68
AV_102:
    s_lshl_b32 s7, s69, 13
    v_add_u32 v104, s7, v5
    v_xor_b32 v105, 0x20, v104
    v_xor_b32 v106, 0x40, v104
    v_xor_b32 v107, 0x60, v104
    v_xor_b32 v108, 0x80, v104
    v_xor_b32 v109, 0xa0, v104
    v_xor_b32 v110, 0xc0, v104
    v_xor_b32 v111, 0xe0, v104
    s_lshl_b32 s62, s69, 2
    s_add_u32 s62, s62, 0x24100
    ds_read_b128 v[112:115], v7
    v_add_u32 v7, 64, v7
    v_mov_b32 v8, 0x24000
    s_mov_b32 s80, 1600000
LW_103:
    ds_read_b32 v9, v8
    s_waitcnt lgkmcnt(0)
    v_readfirstlane_b32 s79, v9
    s_cmp_ge_u32 s79, s70
    s_cbranch_scc1 LWD_104
    s_sleep 1
    s_sub_u32 s80, s80, 1
    s_cmp_lg_u32 s80, 0
    s_cbranch_scc1 LW_103
LWD_104:
    ds_read_b64_tr_b16 v[32:33], v104
    ds_read_b64_tr_b16 v[34:35], v104 offset:4096
    ds_read_b64_tr_b16 v[36:37], v105
    ds_read_b64_tr_b16 v[38:39], v105 offset:4096
    ds_read_b64_tr_b16 v[40:41], v106
    ds_read_b64_tr_b16 v[42:43], v106 offset:4096
    ds_read_b64_tr_b16 v[44:45], v107
    ds_read_b64_tr_b16 v[46:47], v107 offset:4096
    ds_read_b64_tr_b16 v[48:49], v108
    ds_read_b64_tr_b16 v[50:51], v108 offset:4096
    ds_read_b64_tr_b16 v[52:53], v109
    ds_read_b64_tr_b16 v[54:55], v109 offset:4096
    ds_read_b64_tr_b16 v[56:57], v110
    ds_read_b64_tr_b16 v[58:59], v110 offset:4096
    s_waitcnt lgkmcnt(12)
    v_mfma_f32_16x16x32_bf16 v[72:75], v[112:115], v[32:35], v[72:75]
    ds_read_b64_tr_b16 v[60:61], v111
    ds_read_b64_tr_b16 v[62:63], v111 offset:4096
    s_waitcnt lgkmcnt(12)
    v_mfma_f32_16x16x32_bf16 v[76:79], v[112:115], v[36:39], v[76:79]
    s_waitcnt lgkmcnt(10)
    v_mfma_f32_16x16x32_bf16 v[80:83], v[112:115], v[40:43], v[80:83]
    s_waitcnt lgkmcnt(8)
    v_mfma_f32_16x16x32_bf16 v[84:87], v[112:115], v[44:47], v[84:87]
    s_waitcnt lgkmcnt(6)
    v_mfma_f32_16x16x32_bf16 v[88:91], v[112:115], v[48:51], v[88:91]
    s_waitcnt lgkmcnt(4)
    v_mfma_f32_16x16x32_bf16 v[92:95], v[112:115], v[52:55], v[92:95]
    s_waitcnt lgkmcnt(2)
    v_mfma_f32_16x16x32_bf16 v[96:99], v[112:115], v[56:59], v[96:99]
    s_waitcnt lgkmcnt(0)
    v_mfma_f32_16x16x32_bf16 v[100:103], v[112:115], v[60:63], v[100:103]
    v_mov_b32 v8, s62
    v_mov_b32 v9, 4
    s_mov_b64 exec, 1
    ds_add_u32 v8, v9
    s_mov_b64 exec, -1
    s_add_u32 s69, s69, 4
    s_cmp_ge_u32 s69, 18
    s_cselect_b32 s7, 18, 0
    s_sub_u32 s69, s69, s7
    s_add_u32 s70, s70, 32
    s_sub_u32 s71, s71, 1
    s_cmp_lg_u32 s71, 0
    s_cbranch_scc1 AV_102
    v_mov_b32_dpp v72, v88 quad_perm:[0,1,2,3] row_mask:0x2 bank_mask:0xf
    v_mov_b32_dpp v76, v92 quad_perm:[0,1,2,3] row_mask:0x2 bank_mask:0xf
    v_mov_b32_dpp v80, v96 quad_perm:[0,1,2,3] row_mask:0x2 bank_mask:0xf
    v_mov_b32_dpp v84, v100 quad_perm:[0,1,2,3] row_mask:0x2 bank_mask:0xf
    v_cvt_pk_bf16_f32 v64, v72, v76
    v_cvt_pk_bf16_f32 v65, v80, v84
    s_mov_b64 exec, 0xffffffff
    s_cmp_eq_u32 s101, 0
    s_cbranch_scc1 SU_105
    buffer_store_dwordx4 v[64:67], v6, s[36:39], 0 offen
SV_106:
    s_mov_b64 exec, -1
    v_mov_b32 v8, 0x24214
    v_mov_b32 v9, 1
    s_mov_b64 exec, 1
    ds_add_u32 v8, v9
    s_mov_b64 exec, -1
    s_endpgm
L_ASVC:
    v_bfe_u32 v24, v1, 2, 2
    v_lshl_add_u32 v4, v24, 4, v2
    v_lshlrev_b32 v4, 8, v4
    v_and_b32 v25, 1, v2
    v_lshl_or_b32 v24, v24, 1, v25
    s_lshl_b32 s7, s61, 1
    v_xor_b32 v24, s7, v24
    v_lshl_add_u32 v4, v24, 5, v4
    v_and_b32 v24, 3, v1
    v_lshl_add_u32 v4, v24, 3, v4
    v_mov_b32 v28, 0x24000
    s_mov_b32 s80, 1600000
LW_107:
    ds_read_b32 v29, v28
    s_waitcnt lgkmcnt(0)
    v_readfirstlane_b32 s79, v29
    s_cmp_ge_u32 s79, 80
    s_cbranch_scc1 LWD_108
    s_sleep 4
    s_sub_u32 s80, s80, 1
    s_cmp_lg_u32 s80, 0
    s_cbranch_scc1 LW_107
LWD_108:
    v_xor_b32 v28, 0, v4
    ds_read_b64_tr_b16 v[32:33], v28 offset:0
    ds_read_b64_tr_b16 v[34:35], v28 offset:16384
    ds_read_b64_tr_b16 v[36:37], v28 offset:1024
    ds_read_b64_tr_b16 v[38:39], v28 offset:17408
    ds_read_b64_tr_b16 v[40:41], v28 offset:2048
    ds_read_b64_tr_b16 v[42:43], v28 offset:18432
    ds_read_b64_tr_b16 v[44:45], v28 offset:3072
    ds_read_b64_tr_b16 v[46:47], v28 offset:19456
    v_xor_b32 v28, 32, v4
    ds_read_b64_tr_b16 v[48:49], v28 offset:0
    ds_read_b64_tr_b16 v[50:51], v28 offset:16384
    ds_read_b64_tr_b16 v[52:53], v28 offset:1024
    ds_read_b64_tr_b16 v[54:55], v28 offset:17408
    ds_read_b64_tr_b16 v[56:57], v28 offset:2048
    ds_read_b64_tr_b16 v[58:59], v28 offset:18432
    ds_read_b64_tr_b16 v[60:61], v28 offset:3072
    ds_read_b64_tr_b16 v[62:63], v28 offset:19456
    v_lshlrev_b32 v28, 2, v1
    v_add_u32 v28, 0x24100, v28
    v_mov_b32 v29, 1
    s_mov_b64 exec, 15
    ds_add_u32 v28, v29
    s_mov_b64 exec, -1
    v_lshlrev_b32 v26, 7, v24
    v_and_b32 v25, 12, v1
    v_lshl_add_u32 v27, v25, 2, v26
    v_and_b32 v25, 4, v1
    v_lshl_add_u32 v26, v25, 2, v26
    v_lshlrev_b32 v8, 16, v24
    v_lshl_add_u32 v8, v25, 4, v8
    v_lshl_add_u32 v8, v2, 4, v8
    s_lshl_b32 s7, s5, 2
    s_add_u32 s7, s7, s61
    s_lshl_b32 s7, s7, 5
    s_add_u32 s7, s7, s4
    s_lshl_b32 s7, s7, 7
    s_add_u32 s7, s7, 0x400000
    v_add_u32 v8, s7, v8
    v_cmp_gt_u32 s[84:85], 8, v3
    s_lshl_b32 s7, s4, 14
    s_lshl_b32 s62, s61, 10
    s_add_u32 s7, s7, s62
    s_add_u32 s7, s7, 0x40000
    v_lshl_add_u32 v5, v1, 4, s7
    v_lshrrev_b32 v24, 5, v1
    s_lshl_b32 s7, s61, 1
    v_add_u32 v24, s7, v24
    v_xor_b32 v6, v24, v3
    v_lshlrev_b32 v6, 4, v6
    v_lshl_add_u32 v6, v24, 8, v6
    v_and_b32 v24, 1, v2
    v_lshl_add_u32 v6, v24, 3, v6
    v_add_u32 v6, 0x26600, v6
    v_xor_b32 v7, 0x80, v6
    v_xor_b32 v12, v3, v2
    v_lshlrev_b32 v12, 4, v12
    v_lshl_add_u32 v12, v3, 8, v12
    v_add_u32 v12, 0x26600, v12
    v_and_b32 v24, 7, v1
    v_xor_b32 v124, v24, v2
    v_lshlrev_b32 v124, 4, v124
    v_lshl_add_u32 v124, v24, 8, v124
    v_add_u32 v124, 0x27600, v124
    v_xor_b32 v13, 64, v12
    v_xor_b32 v125, 64, v124
    v_xor_b32 v14, 128, v12
    v_xor_b32 v126, 128, v124
    v_xor_b32 v15, 192, v12
    v_xor_b32 v127, 192, v124
    s_lshl_b32 s63, s4, 9
    s_add_u32 s63, s63, 0x24000
    v_mov_b32 v28, 0x24204
    s_mov_b32 s80, 1600000
LW_109:
    ds_read_b32 v29, v28
    s_waitcnt lgkmcnt(0)
    v_readfirstlane_b32 s79, v29
    s_cmp_ge_u32 s79, 1
    s_cbranch_scc1 LWD_110
    s_sleep 1
    s_sub_u32 s80, s80, 1
    s_cmp_lg_u32 s80, 0
    s_cbranch_scc1 LW_109
LWD_110:
    v_mov_b32 v28, 0x24248
    ds_read_b64 v[30:31], v28
    s_waitcnt lgkmcnt(0)
    v_readfirstlane_b32 s92, v30
    v_readfirstlane_b32 s93, v31
    v_mov_b32 v28, 0x24210
    s_mov_b32 s80, 1600000
LW_111:
    ds_read_b32 v29, v28
    s_waitcnt lgkmcnt(0)
    v_readfirstlane_b32 s79, v29
    s_cmp_ge_u32 s79, 4
    s_cbranch_scc1 LWD_112
    s_sleep 16
    s_sub_u32 s80, s80, 1
    s_cmp_lg_u32 s80, 0
    s_cbranch_scc1 LW_111
LWD_112:
    s_mov_b32 s80, 200000
P_113:
    buffer_load_dwordx4 v[16:19], v27, s[36:39], s63 offen sc1 nt
    buffer_load_dwordx4 v[20:23], v26, s[36:39], s63 offen offset:64 sc1 nt
PP_114:
    s_waitcnt vmcnt(0)
    v_cmp_ne_u64 s[90:91], s[92:93], v[18:19]
    v_cmp_ne_u64 vcc, s[92:93], v[22:23]
    s_or_b64 s[90:91], s[90:91], vcc
    s_cmp_lg_u64 s[90:91], 0
    s_cbranch_scc0 PD_115
    s_sleep 16
    s_sub_u32 s80, s80, 1
    s_cmp_lg_u32 s80, 0
    s_cbranch_scc1 P_113
PD_115:
    v_max_f32 v24, v16, v20
    s_nop 1
    v_max_f32_dpp v24, v24, v24 row_ror:4 row_mask:0xf bank_mask:0xf
    s_nop 1
    v_max_f32_dpp v24, v24, v24 row_ror:8 row_mask:0xf bank_mask:0xf
    v_sub_f32 v9, v16, v24
    v_sub_f32 v10, v20, v24
    v_exp_f32 v9, v9
    v_exp_f32 v10, v10
    s_nop 0
    v_cndmask_b32 v10, 0, v10, s[84:85]
    v_mul_f32 v24, v9, v17
    v_fmac_f32 v24, v10, v21
    s_nop 1
    v_add_f32_dpp v24, v24, v24 row_ror:4 row_mask:0xf bank_mask:0xf
    s_nop 1
    v_add_f32_dpp v24, v24, v24 row_ror:8 row_mask:0xf bank_mask:0xf
    v_rcp_f32 v24, v24
    s_nop 0
    v_mul_f32 v9, v9, v24
    v_mul_f32 v10, v10, v24
    v_mov_b32 v18, s92
    v_mov_b32 v19, s93
    s_mov_b32 s62, 4096
    s_mov_b32 s63, 8192
    v_mov_b32 v28, 0x24214
    s_mov_b32 s80, 1600000
LW_116:
    ds_read_b32 v29, v28
    s_waitcnt lgkmcnt(0)
    v_readfirstlane_b32 s79, v29
    s_cmp_ge_u32 s79, 4
    s_cbranch_scc1 LWD_117
    s_sleep 1
    s_sub_u32 s80, s80, 1
    s_cmp_lg_u32 s80, 0
    s_cbranch_scc1 LW_116
LWD_117:
    s_setprio 2
    s_mov_b64 exec, -1
    buffer_load_dwordx4 v[112:115], v5, s[36:39], 0 offen sc1 nt
    buffer_load_dwordx4 v[116:119], v5, s[36:39], s62 offen sc1 nt
    buffer_load_dwordx4 v[120:123], v5, s[36:39], s63 offen sc1 nt
    s_mov_b32 s80, 200000
MC_119:
    s_mov_b64 exec, -1
    s_waitcnt vmcnt(0)
    v_cmp_ne_u64 s[64:65], s[92:93], v[114:115]
    v_cmp_ne_u64 s[66:67], s[92:93], v[118:119]
    v_cmp_ne_u64 s[68:69], s[92:93], v[122:123]
    s_or_b64 s[90:91], s[64:65], s[66:67]
    s_or_b64 s[90:91], s[90:91], s[68:69]
    s_cbranch_scc1 M_118
MD_120:
    s_mov_b64 exec, -1
    ds_write_b64 v6, v[112:113]
    ds_write_b64 v7, v[116:117] offset:2048
    ds_write_b64 v6, v[120:121] offset:4096
    s_add_u32 s81, s81, 4
    v_mov_b32 v24, 0x2420c
    v_mov_b32 v25, 1
    s_mov_b64 exec, 1
    ds_add_u32 v24, v25
    s_mov_b64 exec, -1
    v_mov_b32 v24, 0x2420c
    s_mov_b32 s80, 1600000
LW_121:
    ds_read_b32 v25, v24
    s_waitcnt lgkmcnt(0)
    v_readfirstlane_b32 s79, v25
    s_cmp_ge_u32 s79, s81
    s_cbranch_scc1 LWD_122
    s_sub_u32 s80, s80, 1
    s_cmp_lg_u32 s80, 0
    s_cbranch_scc1 LW_121
LWD_122:
    ds_read_b128 v[64:67], v12
    ds_read_b128 v[68:71], v124
    ds_read_b128 v[72:75], v13
    ds_read_b128 v[76:79], v125
    ds_read_b128 v[80:83], v14
    ds_read_b128 v[84:87], v126
    ds_read_b128 v[88:91], v15
    ds_read_b128 v[92:95], v127
    s_waitcnt lgkmcnt(7)
    v_mfma_f32_16x16x32_bf16 v[96:99], v[32:35], v[64:67], 0
    v_mfma_f32_16x16x32_bf16 v[100:103], v[48:51], v[64:67], 0
    s_waitcnt lgkmcnt(6)
    v_mfma_f32_16x16x32_bf16 v[104:107], v[32:35], v[68:71], 0
    v_mfma_f32_16x16x32_bf16 v[108:111], v[48:51], v[68:71], 0
    s_waitcnt lgkmcnt(5)
    v_mfma_f32_16x16x32_bf16 v[96:99], v[36:39], v[72:75], v[96:99]
    v_mfma_f32_16x16x32_bf16 v[100:103], v[52:55], v[72:75], v[100:103]
    s_waitcnt lgkmcnt(4)
    v_mfma_f32_16x16x32_bf16 v[104:107], v[36:39], v[76:79], v[104:107]
    v_mfma_f32_16x16x32_bf16 v[108:111], v[52:55], v[76:79], v[108:111]
    s_waitcnt lgkmcnt(3)
    v_mfma_f32_16x16x32_bf16 v[96:99], v[40:43], v[80:83], v[96:99]
    v_mfma_f32_16x16x32_bf16 v[100:103], v[56:59], v[80:83], v[100:103]
    s_waitcnt lgkmcnt(2)
    v_mfma_f32_16x16x32_bf16 v[104:107], v[40:43], v[84:87], v[104:107]
    v_mfma_f32_16x16x32_bf16 v[108:111], v[56:59], v[84:87], v[108:111]
    s_waitcnt lgkmcnt(1)
    v_mfma_f32_16x16x32_bf16 v[96:99], v[44:47], v[88:91], v[96:99]
    v_mfma_f32_16x16x32_bf16 v[100:103], v[60:63], v[88:91], v[100:103]
    s_waitcnt lgkmcnt(0)
    v_mfma_f32_16x16x32_bf16 v[104:107], v[44:47], v[92:95], v[104:107]
    v_mfma_f32_16x16x32_bf16 v[108:111], v[60:63], v[92:95], v[108:111]
    s_nop 3
    v_mul_f32 v96, v96, v9
    v_mul_f32 v97, v97, v9
    v_mul_f32 v98, v98, v9
    v_mul_f32 v99, v99, v9
    v_mul_f32 v100, v100, v9
    v_mul_f32 v101, v101, v9
    v_mul_f32 v102, v102, v9
    v_mul_f32 v103, v103, v9
    v_fmac_f32 v96, v104, v10
    v_fmac_f32 v97, v105, v10
    v_fmac_f32 v98, v106, v10
    v_fmac_f32 v99, v107, v10
    v_fmac_f32 v100, v108, v10
    v_fmac_f32 v101, v109, v10
    v_fmac_f32 v102, v110, v10
    v_fmac_f32 v103, v111, v10
    v_add_f32_dpp v96, v96, v96 row_ror:8 row_mask:0xf bank_mask:0xf
    v_add_f32_dpp v97, v97, v97 row_ror:8 row_mask:0xf bank_mask:0xf
    v_add_f32_dpp v98, v98, v98 row_ror:8 row_mask:0xf bank_mask:0xf
    v_add_f32_dpp v99, v99, v99 row_ror:8 row_mask:0xf bank_mask:0xf
    v_add_f32_dpp v100, v100, v100 row_ror:8 row_mask:0xf bank_mask:0xf
    v_add_f32_dpp v101, v101, v101 row_ror:8 row_mask:0xf bank_mask:0xf
    v_add_f32_dpp v102, v102, v102 row_ror:8 row_mask:0xf bank_mask:0xf
    v_add_f32_dpp v103, v103, v103 row_ror:8 row_mask:0xf bank_mask:0xf
    v_add_f32_dpp v104, v96, v96 row_ror:4 row_mask:0xf bank_mask:0x1
    v_add_f32_dpp v105, v97, v97 row_ror:4 row_mask:0xf bank_mask:0x1
    v_add_f32_dpp v106, v98, v98 row_ror:4 row_mask:0xf bank_mask:0x1
    v_add_f32_dpp v107, v99, v99 row_ror:4 row_mask:0xf bank_mask:0x1
    v_add_f32_dpp v104, v100, v100 row_ror:4 row_mask:0xf bank_mask:0x2
    v_add_f32_dpp v105, v101, v101 row_ror:4 row_mask:0xf bank_mask:0x2
    v_add_f32_dpp v106, v102, v102 row_ror:4 row_mask:0xf bank_mask:0x2
    v_add_f32_dpp v107, v103, v103 row_ror:4 row_mask:0xf bank_mask:0x2
    v_cvt_pk_bf16_f32 v16, v104, v105
    v_cvt_pk_bf16_f32 v17, v106, v107
    s_mov_b64 exec, s[84:85]
    buffer_store_dwordx4 v[16:19], v8, s[36:39], 0 offen sc1
    s_mov_b64 exec, -1
    s_endpgm
L_ESVC:
    v_lshrrev_b32 v160, 2, v1
    v_bfe_u32 v161, v1, 3, 2
    v_xor_b32 v161, s61, v161
    v_lshlrev_b32 v161, 5, v161
    v_lshl_add_u32 v161, v160, 7, v161
    v_and_b32 v162, 3, v1
    v_lshl_add_u32 v161, v162, 3, v161
    s_lshl_b32 s7, s61, 10
    s_lshl_b32 s62, s4, 4
    s_add_u32 s7, s7, s62
    s_add_u32 s7, s7, 0x30000
    v_and_b32 v164, 1, v1
    v_lshl_add_u32 v4, v164, 9, s7
    s_lshl_b32 s7, s4, 14
    s_lshl_b32 s62, s61, 12
    s_add_u32 s7, s7, s62
    s_add_u32 s7, s7, 0x100000
    v_lshl_add_u32 v5, v1, 4, s7
    s_mul_i32 s7, s61, 1088
    s_add_u32 s7, s7, 0x26600
    v_lshrrev_b32 v164, 3, v1
    v_lshl_add_u32 v6, v164, 6, s7
    v_lshl_add_u32 v6, v162, 4, v6
    v_and_b32 v164, 4, v1
    v_lshl_add_u32 v6, v164, 1, v6
    v_mul_u32_u24 v7, 1088, v162
    v_lshl_add_u32 v7, v2, 4, v7
    v_add_u32 v7, 0x26600, v7
    v_cmp_gt_u32 s[84:85], 4, v3
    s_and_b32 s62, s4, 7
    s_lshl_b32 s62, s62, 3
    s_lshr_b32 s7, s4, 3
    s_lshl_b32 s7, s7, 1
    s_add_u32 s62, s62, s7
    s_add_u32 s62, s62, s5
    s_sub_u32 s62, s62, 6
    s_add_u32 s62, s62, 2
    s_lshl_b32 s7, s62, 10
    s_lshl_b32 s64, s61, 8
    s_add_u32 s7, s7, s64
    s_add_u32 s7, s7, 0x4a0000
    v_lshl_add_u32 v10, v162, 6, s7
    v_lshl_add_u32 v10, v2, 4, v10
    v_mov_b32 v8, 0
    s_mov_b64 exec, 5
    buffer_store_dword v8, v10, s[36:39], 0 offen
    buffer_load_dword v8, v10, s[36:39], 0 offen sc1 nt
    s_mov_b64 exec, -1
    s_lshr_b32 s7, s62, 3
    s_lshl_b32 s7, s7, 7
    s_add_u32 s7, s7, 0x22000
    v_and_b32 v164, 7, v1
    v_lshl_add_u32 v9, v164, 3, s7
    v_mov_b32 v16, 0x24204
    s_mov_b32 s80, 1600000
LW_123:
    ds_read_b32 v17, v16
    s_waitcnt lgkmcnt(0)
    v_readfirstlane_b32 s79, v17
    s_cmp_ge_u32 s79, 1
    s_cbranch_scc1 LWD_124
    s_sleep 1
    s_sub_u32 s80, s80, 1
    s_cmp_lg_u32 s80, 0
    s_cbranch_scc1 LW_123
LWD_124:
    v_mov_b32 v16, 0x24248
    ds_read_b64 v[18:19], v16
    s_waitcnt lgkmcnt(0)
    v_readfirstlane_b32 s92, v18
    v_readfirstlane_b32 s93, v19
    s_mov_b32 s80, 200000
P_125:
    buffer_load_dwordx2 v[16:17], v9, s[36:39], 0 offen sc1
PP_126:
    s_waitcnt vmcnt(0)
    v_and_b32 v18, 15, v16
    v_and_b32 v16, -32, v16
    v_cmp_ne_u64 s[90:91], s[92:93], v[16:17]
    s_cmp_lg_u64 s[90:91], 0
    s_cbranch_scc0 PD_127
    s_sleep 8
    s_sub_u32 s80, s80, 1
    s_cmp_lg_u32 s80, 0
    s_cbranch_scc1 P_125
PD_127:
    v_cmp_ne_u32 vcc, s78, v18
    s_cmp_eq_u64 vcc, 0
    s_cselect_b32 s101, 1, 0
    v_mov_b32 v16, 0x24000
    s_mov_b32 s80, 1600000
LW_128:
    ds_read_b32 v17, v16
    s_waitcnt lgkmcnt(0)
    v_readfirstlane_b32 s79, v17
    s_cmp_ge_u32 s79, 96
    s_cbranch_scc1 LWD_129
    s_sleep 4
    s_sub_u32 s80, s80, 1
    s_cmp_lg_u32 s80, 0
    s_cbranch_scc1 LW_128
LWD_129:
    ds_read_b64_tr_b16 v[32:33], v161 offset:0
    ds_read_b64_tr_b16 v[34:35], v161 offset:2048
    ds_read_b64_tr_b16 v[36:37], v161 offset:4096
    ds_read_b64_tr_b16 v[38:39], v161 offset:6144
    ds_read_b64_tr_b16 v[40:41], v161 offset:8192
    ds_read_b64_tr_b16 v[42:43], v161 offset:10240
    ds_read_b64_tr_b16 v[44:45], v161 offset:12288
    ds_read_b64_tr_b16 v[46:47], v161 offset:14336
    s_waitcnt lgkmcnt(4)
    ds_read_b64_tr_b16 v[48:49], v161 offset:16384
    ds_read_b64_tr_b16 v[50:51], v161 offset:18432
    ds_read_b64_tr_b16 v[52:53], v161 offset:20480
    ds_read_b64_tr_b16 v[54:55], v161 offset:22528
    ds_read_b64_tr_b16 v[56:57], v161 offset:24576
    ds_read_b64_tr_b16 v[58:59], v161 offset:26624
    ds_read_b64_tr_b16 v[60:61], v161 offset:28672
    ds_read_b64_tr_b16 v[62:63], v161 offset:30720
    s_waitcnt lgkmcnt(4)
    ds_read_b64_tr_b16 v[64:65], v161 offset:32768
    ds_read_b64_tr_b16 v[66:67], v161 offset:34816
    ds_read_b64_tr_b16 v[68:69], v161 offset:36864
    ds_read_b64_tr_b16 v[70:71], v161 offset:38912
    ds_read_b64_tr_b16 v[72:73], v161 offset:40960
    ds_read_b64_tr_b16 v[74:75], v161 offset:43008
    ds_read_b64_tr_b16 v[76:77], v161 offset:45056
    ds_read_b64_tr_b16 v[78:79], v161 offset:47104
    s_waitcnt lgkmcnt(4)
    ds_read_b64_tr_b16 v[80:81], v161 offset:49152
    ds_read_b64_tr_b16 v[82:83], v161 offset:51200
    ds_read_b64_tr_b16 v[84:85], v161 offset:53248
    ds_read_b64_tr_b16 v[86:87], v161 offset:55296
    ds_read_b64_tr_b16 v[88:89], v161 offset:57344
    ds_read_b64_tr_b16 v[90:91], v161 offset:59392
    ds_read_b64_tr_b16 v[92:93], v161 offset:61440
    ds_read_b64_tr_b16 v[94:95], v161 offset:63488
    s_waitcnt lgkmcnt(4)
    v_lshlrev_b32 v16, 2, v1
    v_add_u32 v16, 0x24100, v16
    v_mov_b32 v17, 1
    s_mov_b64 exec, 255
    ds_add_u32 v16, v17
    s_mov_b64 exec, -1
    s_cmp_eq_u32 s101, 0
    s_cbranch_scc1 EH_130
    s_and_b32 s7, s4, 7
    s_lshl_b32 s7, s7, 12
    s_add_u32 s7, s7, 0x28008
    v_lshl_add_u32 v9, v1, 9, s7
    s_mov_b64 exec, 0xff
    buffer_load_dwordx2 v[12:13], v9, s[36:39], 0 offen sc1 nt
    s_mov_b32 s80, 200000
MC_132:
    s_mov_b64 exec, 0xff
    s_waitcnt vmcnt(0)
    v_cmp_ne_u64 s[64:65], s[92:93], v[12:13]
    s_cmp_lg_u64 s[64:65], 0
    s_cbranch_scc1 M_131
MD_133:
    s_mov_b64 exec, -1
    s_sleep 20
EH_130:
    s_setprio 2
    s_mov_b64 exec, -1
    buffer_load_dwordx4 v[16:19], v5, s[36:39], 0 offen offset:0 sc1
    buffer_load_dwordx4 v[20:23], v5, s[36:39], 0 offen offset:1024 sc1
    buffer_load_dwordx4 v[24:27], v5, s[36:39], 0 offen offset:2048 sc1
    buffer_load_dwordx4 v[28:31], v5, s[36:39], 0 offen offset:3072 sc1
    buffer_load_dwordx4 v[12:15], v4, s[36:39], 0 offen sc1
    s_mov_b32 s80, 200000
MC_135:
    s_mov_b64 exec, -1
    s_waitcnt vmcnt(0)
    v_cmp_ne_u64 s[64:65], s[92:93], v[18:19]
    v_cmp_ne_u64 s[66:67], s[92:93], v[22:23]
    v_cmp_ne_u64 s[68:69], s[92:93], v[26:27]
    v_cmp_ne_u64 s[70:71], s[92:93], v[30:31]
    v_cmp_ne_u64 s[72:73], s[92:93], v[14:15]
    s_or_b64 s[90:91], s[64:65], s[66:67]
    s_or_b64 s[90:91], s[90:91], s[68:69]
    s_or_b64 s[90:91], s[90:91], s[70:71]
    s_or_b64 s[90:91], s[90:91], s[72:73]
    s_cbranch_scc1 M_134
MD_136:
    s_mov_b64 exec, -1
    v_readlane_b32 s74, v12, 0
    v_readlane_b32 s76, v13, 0
    v_readlane_b32 s75, v12, 1
    v_readlane_b32 s77, v13, 1
    v_mov_b32 v160, s74
    v_max_f32 v160, s75, v160
    v_sub_f32 v11, s74, v160
    v_sub_f32 v12, s75, v160
    v_exp_f32 v11, v11
    v_exp_f32 v12, v12
    v_mul_f32 v160, s76, v11
    v_fmac_f32 v160, s77, v12
    v_rcp_f32 v160, v160
    s_nop 0
    v_mul_f32 v11, v11, v160
    v_mul_f32 v12, v12, v160
    v_lshlrev_b32 v18, 16, v17
    v_and_b32 v19, 0xffff0000, v17
    v_and_b32 v17, 0xffff0000, v16
    v_lshlrev_b32 v16, 16, v16
    v_lshlrev_b32 v22, 16, v21
    v_and_b32 v23, 0xffff0000, v21
    v_and_b32 v21, 0xffff0000, v20
    v_lshlrev_b32 v20, 16, v20
    v_lshlrev_b32 v26, 16, v25
    v_and_b32 v27, 0xffff0000, v25
    v_and_b32 v25, 0xffff0000, v24
    v_lshlrev_b32 v24, 16, v24
    v_lshlrev_b32 v30, 16, v29
    v_and_b32 v31, 0xffff0000, v29
    v_and_b32 v29, 0xffff0000, v28
    v_lshlrev_b32 v28, 16, v28
    v_mul_f32 v16, v16, v11
    v_mul_f32 v17, v17, v11
    v_mul_f32 v18, v18, v11
    v_mul_f32 v19, v19, v11
    v_mul_f32 v20, v20, v11
    v_mul_f32 v21, v21, v11
    v_mul_f32 v22, v22, v11
    v_mul_f32 v23, v23, v11
    v_fmac_f32 v16, v24, v12
    v_fmac_f32 v17, v25, v12
    v_fmac_f32 v18, v26, v12
    v_fmac_f32 v19, v27, v12
    v_fmac_f32 v20, v28, v12
    v_fmac_f32 v21, v29, v12
    v_fmac_f32 v22, v30, v12
    v_fmac_f32 v23, v31, v12
    v_cvt_pk_bf16_f32 v24, v16, v17
    v_cvt_pk_bf16_f32 v25, v18, v19
    v_cvt_pk_bf16_f32 v26, v20, v21
    v_cvt_pk_bf16_f32 v27, v22, v23
    ds_write_b64 v6, v[24:25]
    ds_write_b64 v6, v[26:27] offset:512
    s_add_u32 s81, s81, 4
    v_mov_b32 v160, 0x2420c
    v_mov_b32 v161, 1
    s_mov_b64 exec, 1
    ds_add_u32 v160, v161
    s_mov_b64 exec, -1
    v_mov_b32 v160, 0x2420c
    s_mov_b32 s80, 1600000
LW_137:
    ds_read_b32 v161, v160
    s_waitcnt lgkmcnt(0)
    v_readfirstlane_b32 s79, v161
    s_cmp_ge_u32 s79, s81
    s_cbranch_scc1 LWD_138
    s_sub_u32 s80, s80, 1
    s_cmp_lg_u32 s80, 0
    s_cbranch_scc1 LW_137
LWD_138:
    ds_read_b128 v[96:99], v7 offset:0
    ds_read_b128 v[100:103], v7 offset:64
    ds_read_b128 v[104:107], v7 offset:128
    ds_read_b128 v[108:111], v7 offset:192
    ds_read_b128 v[112:115], v7 offset:256
    ds_read_b128 v[116:119], v7 offset:320
    ds_read_b128 v[120:123], v7 offset:384
    ds_read_b128 v[124:127], v7 offset:448
    ds_read_b128 v[128:131], v7 offset:512
    ds_read_b128 v[132:135], v7 offset:576
    ds_read_b128 v[136:139], v7 offset:640
    ds_read_b128 v[140:143], v7 offset:704
    v_mov_b32 v18, s92
    v_mov_b32 v19, s93
    s_waitcnt lgkmcnt(8)
    ds_read_b128 v[144:147], v7 offset:768
    ds_read_b128 v[148:151], v7 offset:832
    ds_read_b128 v[152:155], v7 offset:896
    ds_read_b128 v[156:159], v7 offset:960
    v_mfma_f32_16x16x32_bf16 v[12:15], v[32:35], v[96:99], 0
    v_mfma_f32_16x16x32_bf16 v[12:15], v[36:39], v[100:103], v[12:15]
    v_mfma_f32_16x16x32_bf16 v[12:15], v[40:43], v[104:107], v[12:15]
    v_mfma_f32_16x16x32_bf16 v[12:15], v[44:47], v[108:111], v[12:15]
    s_waitcnt lgkmcnt(11)
    v_mfma_f32_16x16x32_bf16 v[12:15], v[48:51], v[112:115], v[12:15]
    s_waitcnt lgkmcnt(10)
    v_mfma_f32_16x16x32_bf16 v[12:15], v[52:55], v[116:119], v[12:15]
    s_waitcnt lgkmcnt(9)
    v_mfma_f32_16x16x32_bf16 v[12:15], v[56:59], v[120:123], v[12:15]
    s_waitcnt lgkmcnt(8)
    v_mfma_f32_16x16x32_bf16 v[12:15], v[60:63], v[124:127], v[12:15]
    s_waitcnt lgkmcnt(7)
    v_mfma_f32_16x16x32_bf16 v[12:15], v[64:67], v[128:131], v[12:15]
    s_waitcnt lgkmcnt(6)
    v_mfma_f32_16x16x32_bf16 v[12:15], v[68:71], v[132:135], v[12:15]
    s_waitcnt lgkmcnt(5)
    v_mfma_f32_16x16x32_bf16 v[12:15], v[72:75], v[136:139], v[12:15]
    s_waitcnt lgkmcnt(4)
    v_mfma_f32_16x16x32_bf16 v[12:15], v[76:79], v[140:143], v[12:15]
    s_waitcnt lgkmcnt(3)
    v_mfma_f32_16x16x32_bf16 v[12:15], v[80:83], v[144:147], v[12:15]
    s_waitcnt lgkmcnt(2)
    v_mfma_f32_16x16x32_bf16 v[12:15], v[84:87], v[148:151], v[12:15]
    s_waitcnt lgkmcnt(1)
    v_mfma_f32_16x16x32_bf16 v[12:15], v[88:91], v[152:155], v[12:15]
    s_waitcnt lgkmcnt(0)
    v_mfma_f32_16x16x32_bf16 v[12:15], v[92:95], v[156:159], v[12:15]
    s_nop 7
    v_cvt_pk_bf16_f32 v16, v12, v13
    v_cvt_pk_bf16_f32 v17, v14, v15
    s_mov_b64 exec, s[84:85]
    s_cmp_eq_u32 s101, 0
    s_cbranch_scc1 SU_139
    buffer_store_dwordx4 v[16:19], v10, s[36:39], 0 offen
SV_140:
    s_mov_b64 exec, -1
    s_endpgm
L_BATT:
    s_and_b32 s60, s4, 7
    s_lshl_b32 s60, s60, 3
    s_lshr_b32 s7, s4, 3
    s_lshl_b32 s7, s7, 1
    s_add_u32 s60, s60, s7
    s_add_u32 s60, s60, s5
    s_sub_u32 s60, s60, 6
    s_lshl_b32 s7, s60, 15
    s_lshl_b32 s63, s6, 12
    s_add_u32 s7, s7, s63
    s_add_u32 s7, s7, 0x600000
    v_lshl_add_u32 v162, v1, 7, s7
    v_mov_b32 v160, 0x24000
    s_mov_b32 s80, 1600000
LW_141:
    ds_read_b32 v161, v160
    s_waitcnt lgkmcnt(0)
    v_readfirstlane_b32 s79, v161
    s_cmp_ge_u32 s79, 32
    s_cbranch_scc1 LWD_142
    s_sleep 4
    s_sub_u32 s80, s80, 1
    s_cmp_lg_u32 s80, 0
    s_cbranch_scc1 LW_141
LWD_142:
    v_mov_b32 v15, 0
    s_mov_b64 exec, 0xffffffff
    buffer_store_dword v15, v162, s[36:39], 0 offen
    buffer_load_dword v15, v162, s[36:39], 0 offen sc1 nt
    s_mov_b64 exec, -1
    s_lshr_b32 s61, s6, 1
    s_and_b32 s62, s6, 1
    s_mov_b32 s64, 0x3e0293ee
    v_lshlrev_b32 v4, 10, v3
    v_lshl_add_u32 v4, v2, 8, v4
    v_lshl_add_u32 v96, v3, 4, v4
    s_lshl_b32 s7, s62, 14
    s_add_u32 s7, s7, 0x1c000
    v_add_u32 v96, s7, v96
    v_and_b32 v162, 3, v1
    v_lshl_add_u32 v4, v162, 6, v4
    v_bfe_u32 v162, v1, 2, 2
    v_lshl_add_u32 v4, v162, 4, v4
    s_lshl_b32 s7, s6, 7
    s_add_u32 s7, s7, 0x24400
    v_lshl_add_u32 v5, v3, 3, s7
    s_lshl_b32 s7, s61, 10
    s_lshl_b32 s63, s62, 8
    s_add_u32 s7, s7, s63
    s_add_u32 s7, s7, 0x26000
    v_lshl_add_u32 v6, v3, 4, s7
    v_lshrrev_b32 v163, 5, v1
    v_lshl_add_u32 v6, v163, 9, v6
    v_and_b32 v162, 1, v2
    v_lshl_add_u32 v6, v162, 3, v6
    v_lshlrev_b32 v7, 4, v1
    v_add_u32 v7, 0x26000, v7
    v_and_b32 v162, 31, v1
    v_lshlrev_b32 v8, 3, v162
    v_add_u32 v8, 0x24400, v8
    v_bfe_u32 v162, v1, 2, 2
    v_lshl_add_u32 v164, v163, 3, v162
    v_lshlrev_b32 v164, 10, v164
    v_and_b32 v165, 1, v1
    v_lshl_add_u32 v164, v165, 3, v164
    s_lshl_b32 s7, s61, 8
    v_add_u32 v164, s7, v164
    v_bfe_u32 v165, v1, 4, 1
    v_lshlrev_b32 v165, 1, v165
    v_bfe_u32 v160, v1, 1, 1
    v_or_b32 v165, v165, v160
    s_lshl_b32 s7, s62, 3
    v_or_b32 v165, s7, v165
    v_lshlrev_b32 v162, 2, v162
    v_xor_b32 v165, v165, v162
    v_lshlrev_b32 v163, 1, v163
    v_xor_b32 v165, v165, v163
    v_xor_b32 v160, 0, v165
    v_lshl_add_u32 v9, v160, 4, v164
    v_xor_b32 v160, 4, v165
    v_lshl_add_u32 v10, v160, 4, v164
    v_xor_b32 v160, 1, v165
    v_lshl_add_u32 v11, v160, 4, v164
    v_add_u32 v11, 0x1000, v11
    v_xor_b32 v160, 5, v165
    v_lshl_add_u32 v12, v160, 4, v164
    v_add_u32 v12, 0x1000, v12
    v_mov_b32 v13, 0xff800000
    v_mov_b32 v128, 0
    v_mov_b32 v129, 0
    v_mov_b32 v130, 0
    v_mov_b32 v131, 0
    v_mov_b32 v132, 0
    v_mov_b32 v133, 0
    v_mov_b32 v134, 0
    v_mov_b32 v135, 0
    v_mov_b32 v136, 0
    v_mov_b32 v137, 0
    v_mov_b32 v138, 0
    v_mov_b32 v139, 0
    v_mov_b32 v140, 0
    v_mov_b32 v141, 0
    v_mov_b32 v142, 0
    v_mov_b32 v143, 0
    v_mov_b32 v144, 0
    v_mov_b32 v145, 0
    v_mov_b32 v146, 0
    v_mov_b32 v147, 0
    v_mov_b32 v148, 0
    v_mov_b32 v149, 0
    v_mov_b32 v150, 0
    v_mov_b32 v151, 0
    v_mov_b32 v152, 0
    v_mov_b32 v153, 0
    v_mov_b32 v154, 0
    v_mov_b32 v155, 0
    v_mov_b32 v156, 0
    v_mov_b32 v157, 0
    v_mov_b32 v158, 0
    v_mov_b32 v159, 0
    s_mov_b64 s[84:85], 0xffff
    s_lshl_b32 s7, s6, 7
    s_add_u32 s7, s7, 0x20000
    v_lshl_add_u32 v100, v3, 3, s7
    s_lshr_b32 s7, s60, 4
    s_lshl_b32 s7, s7, 15
    s_lshl_b32 s63, s6, 12
    s_add_u32 s7, s7, s63
    v_lshl_add_u32 v101, v1, 4, s7
    s_and_b32 s7, s6, 3
    s_lshl_b32 s7, s7, 6
    v_lshlrev_b32 v102, 4, v1
    v_xor_b32 v102, s7, v102
    s_add_u32 s7, s63, 0x1c000
    v_add_u32 v102, s7, v102
    s_lshr_b32 s7, s60, 3
    s_lshl_b32 s7, s7, 7
    s_add_u32 s7, s7, 0x22000
    v_and_b32 v160, 7, v1
    v_lshl_add_u32 v160, v160, 3, s7
    v_cmp_lt_u32 vcc, 31, v1
    s_nop 1
    v_cndmask_b32 v100, v100, v160, vcc
    v_mov_b32 v160, 0x24204
    s_mov_b32 s80, 1600000
LW_143:
    ds_read_b32 v161, v160
    s_waitcnt lgkmcnt(0)
    v_readfirstlane_b32 s79, v161
    s_cmp_ge_u32 s79, 1
    s_cbranch_scc1 LWD_144
    s_sleep 1
    s_sub_u32 s80, s80, 1
    s_cmp_lg_u32 s80, 0
    s_cbranch_scc1 LW_143
LWD_144:
    v_mov_b32 v160, 0x24248
    ds_read_b64 v[162:163], v160
    s_waitcnt lgkmcnt(0)
    v_readfirstlane_b32 s92, v162
    v_readfirstlane_b32 s93, v163
    s_add_u32 s81, s81, 8
    v_mov_b32 v160, 0x2420c
    v_mov_b32 v161, 1
    s_mov_b64 exec, 1
    ds_add_u32 v160, v161
    s_mov_b64 exec, -1
    v_mov_b32 v160, 0x2420c
    s_mov_b32 s80, 1600000
LW_145:
    ds_read_b32 v161, v160
    s_waitcnt lgkmcnt(0)
    v_readfirstlane_b32 s79, v161
    s_cmp_ge_u32 s79, s81
    s_cbranch_scc1 LWD_146
    s_sub_u32 s80, s80, 1
    s_cmp_lg_u32 s80, 0
    s_cbranch_scc1 LW_145
LWD_146:
    s_mov_b32 s80, 200000
P_147:
    buffer_load_dwordx2 v[16:17], v100, s[36:39], 0 offen sc1
PP_148:
    s_waitcnt vmcnt(0)
    v_and_b32 v18, 15, v16
    v_and_b32 v16, -32, v16
    v_cmp_ne_u64 s[90:91], s[92:93], v[16:17]
    s_cmp_lg_u64 s[90:91], 0
    s_cbranch_scc0 PD_149
    s_sleep 1
    s_sub_u32 s80, s80, 1
    s_cmp_lg_u32 s80, 0
    s_cbranch_scc1 P_147
PD_149:
    v_cmp_ne_u32 vcc, s78, v18
    s_cmp_eq_u32 vcc_hi, 0
    s_cselect_b32 s101, 1, 0
    s_mov_b64 exec, -1
    buffer_load_dwordx4 v[16:19], v101, s[36:39], 0 offen offset:0 sc1
    buffer_load_dwordx4 v[20:23], v101, s[36:39], 0 offen offset:1024 sc1
    buffer_load_dwordx4 v[24:27], v101, s[36:39], 0 offen offset:2048 sc1
    buffer_load_dwordx4 v[28:31], v101, s[36:39], 0 offen offset:3072 sc1
    s_mov_b32 s80, 200000
MC_151:
    s_mov_b64 exec, -1
    s_waitcnt vmcnt(0)
    v_max3_u32 v160, v16, v17, v18
    v_max_u32 v160, v160, v19
    v_cmp_eq_u32 s[44:45], -1, v160
    v_max3_u32 v161, v20, v21, v22
    v_max_u32 v161, v161, v23
    v_cmp_eq_u32 s[46:47], -1, v161
    v_max3_u32 v162, v24, v25, v26
    v_max_u32 v162, v162, v27
    v_cmp_eq_u32 s[48:49], -1, v162
    v_max3_u32 v163, v28, v29, v30
    v_max_u32 v163, v163, v31
    v_cmp_eq_u32 s[50:51], -1, v163
    s_or_b64 s[90:91], s[44:45], s[46:47]
    s_or_b64 s[90:91], s[90:91], s[48:49]
    s_or_b64 s[90:91], s[90:91], s[50:51]
    s_cbranch_scc1 M_150
MD_152:
    s_mov_b64 exec, -1
    v_xor_b32 v160, 0x0, v102
    ds_write_b128 v160, v[16:19] offset:0
    v_xor_b32 v161, 0x10, v102
    ds_write_b128 v161, v[20:23] offset:1024
    v_xor_b32 v160, 0x20, v102
    ds_write_b128 v160, v[24:27] offset:2048
    v_xor_b32 v161, 0x30, v102
    ds_write_b128 v161, v[28:31] offset:3072
    s_add_u32 s81, s81, 8
    v_mov_b32 v162, 0x2420c
    v_mov_b32 v163, 1
    s_mov_b64 exec, 1
    ds_add_u32 v162, v163
    s_mov_b64 exec, -1
    v_mov_b32 v162, 0x2420c
    s_mov_b32 s80, 1600000
LW_153:
    ds_read_b32 v163, v162
    s_waitcnt lgkmcnt(0)
    v_readfirstlane_b32 s79, v163
    s_cmp_ge_u32 s79, s81
    s_cbranch_scc1 LWD_154
    s_sub_u32 s80, s80, 1
    s_cmp_lg_u32 s80, 0
    s_cbranch_scc1 LW_153
LWD_154:
    v_xor_b32 v160, 0x0, v96
    ds_read_b128 v[32:35], v160
    v_xor_b32 v161, 0x10, v96
    ds_read_b128 v[36:39], v161
    v_xor_b32 v160, 0x20, v96
    ds_read_b128 v[40:43], v160
    v_xor_b32 v161, 0x30, v96
    ds_read_b128 v[44:47], v161
    v_xor_b32 v160, 0x40, v96
    ds_read_b128 v[48:51], v160
    v_xor_b32 v161, 0x50, v96
    ds_read_b128 v[52:55], v161
    v_xor_b32 v160, 0x60, v96
    ds_read_b128 v[56:59], v160
    v_xor_b32 v161, 0x70, v96
    ds_read_b128 v[60:63], v161
    v_xor_b32 v160, 0x80, v96
    ds_read_b128 v[64:67], v160
    v_xor_b32 v161, 0x90, v96
    ds_read_b128 v[68:71], v161
    s_waitcnt lgkmcnt(4)
    v_xor_b32 v160, 0xa0, v96
    ds_read_b128 v[72:75], v160
    v_xor_b32 v161, 0xb0, v96
    ds_read_b128 v[76:79], v161
    v_xor_b32 v160, 0xc0, v96
    ds_read_b128 v[80:83], v160
    v_xor_b32 v161, 0xd0, v96
    ds_read_b128 v[84:87], v161
    v_xor_b32 v160, 0xe0, v96
    ds_read_b128 v[88:91], v160
    v_xor_b32 v161, 0xf0, v96
    ds_read_b128 v[92:95], v161
    v_mov_b32 v162, 0x24104
    v_mov_b32 v163, 1
    s_mov_b64 exec, 1
    ds_add_u32 v162, v163
    s_mov_b64 exec, -1
    s_lshr_b32 s7, s60, 3
    s_lshl_b32 s7, s7, 9
    s_lshl_b32 s63, s6, 6
    s_add_u32 s7, s7, s63
    s_and_b32 s63, s60, 7
    s_lshl_b32 s63, s63, 3
    s_add_u32 s7, s7, s63
    s_add_u32 s7, s7, 0x23004
    v_mov_b32 v162, s7
    s_cmp_eq_u32 s101, 0
    s_cbranch_scc1 BF_155
    v_mov_b32 v15, 0
    s_mov_b64 exec, 1
    buffer_store_dword v15, v162, s[36:39], 0 offen
    buffer_load_dword v15, v162, s[36:39], 0 offen sc1 nt
    s_mov_b64 exec, -1
BF_155:
    s_lshl_b32 s66, s61, 4
    s_add_u32 s66, s66, 16
    s_mov_b32 s70, 64
    s_mov_b32 s71, 0x800080
    s_mov_b32 s67, s61
    s_mov_b32 s68, 0
    s_mov_b32 s69, 4
BS_156:
    s_lshl_b32 s7, s67, 14
    v_add_u32 v20, s7, v4
    v_xor_b32 v21, 0x10, v20
    v_xor_b32 v22, 0x20, v20
    v_xor_b32 v23, 0x30, v20
    v_xor_b32 v24, 0x40, v20
    v_xor_b32 v25, 0x50, v20
    v_xor_b32 v26, 0x60, v20
    v_xor_b32 v27, 0x70, v20
    v_mov_b32 v162, 0x24000
    s_mov_b32 s80, 1600000
LW_157:
    ds_read_b32 v163, v162
    s_waitcnt lgkmcnt(0)
    v_readfirstlane_b32 s79, v163
    s_cmp_ge_u32 s79, s66
    s_cbranch_scc1 LWD_158
    s_sleep 1
    s_sub_u32 s80, s80, 1
    s_cmp_lg_u32 s80, 0
    s_cbranch_scc1 LW_157
LWD_158:
    ds_read_b128 v[96:99], v20
    ds_read_b128 v[100:103], v21
    ds_read_b128 v[104:107], v22
    ds_read_b128 v[108:111], v23
    ds_read_b128 v[112:115], v24
    ds_read_b128 v[116:119], v25
    ds_read_b128 v[120:123], v26
    ds_read_b128 v[124:127], v27
    v_xor_b32 v20, 0x80, v20
    v_xor_b32 v21, 0x80, v21
    v_xor_b32 v22, 0x80, v22
    v_xor_b32 v23, 0x80, v23
    v_xor_b32 v24, 0x80, v24
    v_xor_b32 v25, 0x80, v25
    v_xor_b32 v26, 0x80, v26
    v_xor_b32 v27, 0x80, v27
    s_waitcnt lgkmcnt(7)
    v_mfma_f32_16x16x32_bf16 v[16:19], v[96:99], v[32:35], 0
    ds_read_b128 v[96:99], v20
    s_waitcnt lgkmcnt(7)
    v_mfma_f32_16x16x32_bf16 v[16:19], v[100:103], v[36:39], v[16:19]
    ds_read_b128 v[100:103], v21
    s_waitcnt lgkmcnt(7)
    v_mfma_f32_16x16x32_bf16 v[16:19], v[104:107], v[40:43], v[16:19]
    ds_read_b128 v[104:107], v22
    s_waitcnt lgkmcnt(7)
    v_mfma_f32_16x16x32_bf16 v[16:19], v[108:111], v[44:47], v[16:19]
    ds_read_b128 v[108:111], v23
    s_waitcnt lgkmcnt(7)
    v_mfma_f32_16x16x32_bf16 v[16:19], v[112:115], v[48:51], v[16:19]
    ds_read_b128 v[112:115], v24
    s_waitcnt lgkmcnt(7)
    v_mfma_f32_16x16x32_bf16 v[16:19], v[116:119], v[52:55], v[16:19]
    ds_read_b128 v[116:119], v25
    s_waitcnt lgkmcnt(7)
    v_mfma_f32_16x16x32_bf16 v[16:19], v[120:123], v[56:59], v[16:19]
    ds_read_b128 v[120:123], v26
    s_waitcnt lgkmcnt(7)
    v_mfma_f32_16x16x32_bf16 v[16:19], v[124:127], v[60:63], v[16:19]
    ds_read_b128 v[124:127], v27
    s_waitcnt lgkmcnt(7)
    v_mfma_f32_16x16x32_bf16 v[16:19], v[96:99], v[64:67], v[16:19]
    s_waitcnt lgkmcnt(6)
    v_mfma_f32_16x16x32_bf16 v[16:19], v[100:103], v[68:71], v[16:19]
    v_add_u32 v20, s68, v9
    v_add_u32 v21, s68, v10
    v_add_u32 v22, s68, v11
    v_add_u32 v23, s68, v12
    s_add_u32 s68, s68, 16384
    s_cmp_eq_u32 s68, 147456
    s_cselect_b32 s68, 0, s68
    s_waitcnt lgkmcnt(5)
    v_mfma_f32_16x16x32_bf16 v[16:19], v[104:107], v[72:75], v[16:19]
    s_waitcnt lgkmcnt(4)
    v_mfma_f32_16x16x32_bf16 v[16:19], v[108:111], v[76:79], v[16:19]
    v_add_u32 v24, s68, v9
    v_add_u32 v25, s68, v10
    v_add_u32 v26, s68, v11
    v_add_u32 v27, s68, v12
    s_add_u32 s68, s68, 16384
    s_cmp_eq_u32 s68, 147456
    s_cselect_b32 s68, 0, s68
    s_waitcnt lgkmcnt(3)
    v_mfma_f32_16x16x32_bf16 v[16:19], v[112:115], v[80:83], v[16:19]
    s_waitcnt lgkmcnt(2)
    v_mfma_f32_16x16x32_bf16 v[16:19], v[116:119], v[84:87], v[16:19]
    v_add_u32 v28, s68, v9
    v_add_u32 v29, s68, v10
    v_add_u32 v30, s68, v11
    v_add_u32 v31, s68, v12
    s_add_u32 s68, s68, 16384
    s_cmp_eq_u32 s68, 147456
    s_cselect_b32 s68, 0, s68
    s_waitcnt lgkmcnt(1)
    v_mfma_f32_16x16x32_bf16 v[16:19], v[120:123], v[88:91], v[16:19]
    s_waitcnt lgkmcnt(0)
    v_mfma_f32_16x16x32_bf16 v[16:19], v[124:127], v[92:95], v[16:19]
    s_cmp_ge_u32 s79, s70
    s_cbranch_scc1 BA_159
    v_mov_b32 v162, 0x24000
    s_mov_b32 s80, 1600000
LW_160:
    ds_read_b32 v163, v162
    s_waitcnt lgkmcnt(0)
    v_readfirstlane_b32 s79, v163
    s_cmp_ge_u32 s79, s70
    s_cbranch_scc1 LWD_161
    s_sleep 1
    s_sub_u32 s80, s80, 1
    s_cmp_lg_u32 s80, 0
    s_cbranch_scc1 LW_160
LWD_161:
BA_159:
    ds_read_b64_tr_b16 v[96:97], v20
    ds_read_b64_tr_b16 v[98:99], v22
    ds_read_b64_tr_b16 v[100:101], v21
    ds_read_b64_tr_b16 v[102:103], v23
    ds_read_b64_tr_b16 v[104:105], v24
    ds_read_b64_tr_b16 v[106:107], v26
    ds_read_b64_tr_b16 v[108:109], v25
    ds_read_b64_tr_b16 v[110:111], v27
    ds_read_b64_tr_b16 v[112:113], v28
    ds_read_b64_tr_b16 v[114:115], v30
    ds_read_b64_tr_b16 v[116:117], v29
    ds_read_b64_tr_b16 v[118:119], v31
    v_add_u32 v20, s68, v9
    v_add_u32 v21, s68, v10
    v_add_u32 v22, s68, v11
    v_add_u32 v23, s68, v12
    s_add_u32 s68, s68, 16384
    s_cmp_eq_u32 s68, 147456
    s_cselect_b32 s68, 0, s68
    ds_read_b64_tr_b16 v[120:121], v20
    ds_read_b64_tr_b16 v[122:123], v22
    ds_read_b64_tr_b16 v[124:125], v21
    ds_read_b64_tr_b16 v[126:127], v23
    v_mov_b32 v162, 0x24100
    v_mov_b32 v163, 1
    s_mov_b64 exec, 1
    ds_add_u32 v162, v163
    s_mov_b64 exec, -1
    v_max3_f32 v160, v16, v17, v18
    v_max_f32 v160, v160, v19
    v_mov_b32 v161, v160
    s_nop 1
    v_permlane32_swap_b32 v160, v161
    v_max_f32 v160, v160, v161
    v_mov_b32 v161, v160
    s_nop 1
    v_permlane16_swap_b32 v160, v161
    v_max_f32 v160, v160, v161
    v_mul_f32 v160, s64, v160
    v_ceil_f32 v160, v160
    v_fma_f32 v16, v16, s64, -v160
    v_fma_f32 v17, v17, s64, -v160
    v_fma_f32 v18, v18, s64, -v160
    v_fma_f32 v19, v19, s64, -v160
    v_exp_f32 v16, v16
    v_exp_f32 v17, v17
    v_exp_f32 v18, v18
    v_exp_f32 v19, v19
    v_cvt_pk_bf16_f32 v162, v16, v17
    v_cvt_pk_bf16_f32 v163, v18, v19
    v_add_f32 v16, v16, v17
    v_add_f32 v18, v18, v19
    ds_write_b64 v6, v[162:163]
    v_add_f32 v161, v16, v18
    v_mov_b32 v16, v161
    s_nop 1
    v_permlane32_swap_b32 v161, v16
    v_add_f32 v161, v161, v16
    v_mov_b32 v16, v161
    s_nop 1
    v_permlane16_swap_b32 v161, v16
    v_add_f32 v161, v161, v16
    s_mov_b64 exec, s[84:85]
    ds_write_b64 v5, v[160:161]
    s_add_u32 s81, s81, 8
    v_mov_b32 v164, 0x2420c
    v_mov_b32 v165, 1
    s_mov_b64 exec, 1
    ds_add_u32 v164, v165
    s_mov_b64 exec, -1
    v_mov_b32 v164, 0x2420c
    s_mov_b32 s80, 1600000
LW_162:
    ds_read_b32 v165, v164
    s_waitcnt lgkmcnt(0)
    v_readfirstlane_b32 s79, v165
    s_cmp_ge_u32 s79, s81
    s_cbranch_scc1 LWD_163
    s_sub_u32 s80, s80, 1
    s_cmp_lg_u32 s80, 0
    s_cbranch_scc1 LW_162
LWD_163:
    ds_read_b32 v160, v8 offset:0
    ds_read_b32 v161, v8 offset:256
    ds_read_b32 v162, v8 offset:512
    ds_read_b32 v163, v8 offset:768
    ds_read_b128 v[16:19], v7 offset:0
    ds_read_b128 v[20:23], v7 offset:1024
    ds_read_b128 v[24:27], v7 offset:2048
    ds_read_b128 v[28:31], v7 offset:3072
    v_xor_b32 v6, 0x1000, v6
    v_xor_b32 v7, 0x1000, v7
    v_add_u32 v5, 1024, v5
    v_add_u32 v8, 1024, v8
    s_waitcnt lgkmcnt(4)
    v_max3_f32 v14, v13, v160, v161
    v_max3_f32 v14, v14, v162, v163
    v_cmp_neq_f32 vcc, v14, v13
    v_sub_f32 v160, v14, v160
    v_sub_f32 v161, v14, v161
    v_sub_f32 v162, v14, v162
    v_sub_f32 v163, v14, v163
    v_cvt_u32_f32 v160, v160
    v_cvt_u32_f32 v161, v161
    v_cvt_u32_f32 v162, v162
    v_cvt_u32_f32 v163, v163
    v_min_u32 v160, 0xff, v160
    v_min_u32 v161, 0xff, v161
    v_min_u32 v162, 0xff, v162
    v_min_u32 v163, 0xff, v163
    v_mul_u32_u24 v160, s71, v160
    v_mul_u32_u24 v161, s71, v161
    v_mul_u32_u24 v162, s71, v162
    v_mul_u32_u24 v163, s71, v163
    s_cbranch_vccz BR_164
    v_sub_f32 v164, v13, v14
    v_exp_f32 v164, v164
    v_mov_b32 v13, v14
    v_pk_mul_f32 v[128:129], v[128:129], v[164:165] op_sel_hi:[1,0]
    v_pk_mul_f32 v[130:131], v[130:131], v[164:165] op_sel_hi:[1,0]
    v_pk_mul_f32 v[132:133], v[132:133], v[164:165] op_sel_hi:[1,0]
    v_pk_mul_f32 v[134:135], v[134:135], v[164:165] op_sel_hi:[1,0]
    v_pk_mul_f32 v[136:137], v[136:137], v[164:165] op_sel_hi:[1,0]
    v_pk_mul_f32 v[138:139], v[138:139], v[164:165] op_sel_hi:[1,0]
    v_pk_mul_f32 v[140:141], v[140:141], v[164:165] op_sel_hi:[1,0]
    v_pk_mul_f32 v[142:143], v[142:143], v[164:165] op_sel_hi:[1,0]
    v_pk_mul_f32 v[144:145], v[144:145], v[164:165] op_sel_hi:[1,0]
    v_pk_mul_f32 v[146:147], v[146:147], v[164:165] op_sel_hi:[1,0]
    v_pk_mul_f32 v[148:149], v[148:149], v[164:165] op_sel_hi:[1,0]
    v_pk_mul_f32 v[150:151], v[150:151], v[164:165] op_sel_hi:[1,0]
    v_pk_mul_f32 v[152:153], v[152:153], v[164:165] op_sel_hi:[1,0]
    v_pk_mul_f32 v[154:155], v[154:155], v[164:165] op_sel_hi:[1,0]
    v_pk_mul_f32 v[156:157], v[156:157], v[164:165] op_sel_hi:[1,0]
    v_pk_mul_f32 v[158:159], v[158:159], v[164:165] op_sel_hi:[1,0]
BR_164:
    s_waitcnt lgkmcnt(3)
    v_pk_sub_u16 v16, v16, v160 clamp
    v_pk_sub_u16 v17, v17, v160 clamp
    v_pk_sub_u16 v18, v18, v160 clamp
    v_pk_sub_u16 v19, v19, v160 clamp
    s_nop 1
    v_mfma_f32_32x32x16_bf16 v[128:143], v[96:99], v[16:19], v[128:143]
    v_mfma_f32_32x32x16_bf16 v[144:159], v[100:103], v[16:19], v[144:159]
    s_waitcnt lgkmcnt(2)
    v_pk_sub_u16 v20, v20, v161 clamp
    v_pk_sub_u16 v21, v21, v161 clamp
    v_pk_sub_u16 v22, v22, v161 clamp
    v_pk_sub_u16 v23, v23, v161 clamp
    s_nop 1
    v_mfma_f32_32x32x16_bf16 v[128:143], v[104:107], v[20:23], v[128:143]
    v_mfma_f32_32x32x16_bf16 v[144:159], v[108:111], v[20:23], v[144:159]
    s_waitcnt lgkmcnt(1)
    v_pk_sub_u16 v24, v24, v162 clamp
    v_pk_sub_u16 v25, v25, v162 clamp
    v_pk_sub_u16 v26, v26, v162 clamp
    v_pk_sub_u16 v27, v27, v162 clamp
    s_nop 1
    v_mfma_f32_32x32x16_bf16 v[128:143], v[112:115], v[24:27], v[128:143]
    v_mfma_f32_32x32x16_bf16 v[144:159], v[116:119], v[24:27], v[144:159]
    s_waitcnt lgkmcnt(0)
    v_pk_sub_u16 v28, v28, v163 clamp
    v_pk_sub_u16 v29, v29, v163 clamp
    v_pk_sub_u16 v30, v30, v163 clamp
    v_pk_sub_u16 v31, v31, v163 clamp
    s_nop 1
    v_mfma_f32_32x32x16_bf16 v[128:143], v[120:123], v[28:31], v[128:143]
    v_mfma_f32_32x32x16_bf16 v[144:159], v[124:127], v[28:31], v[144:159]
    s_add_u32 s67, s67, 4
    s_cmp_ge_u32 s67, 9
    s_cselect_b32 s7, 9, 0
    s_sub_u32 s67, s67, s7
    s_add_u32 s66, s66, 64
    s_add_u32 s70, s70, 64
    s_sub_u32 s69, s69, 1
    s_cmp_lg_u32 s69, 0
    s_cbranch_scc1 BS_156
    s_lshr_b32 s67, s60, 3
    s_and_b32 s68, s60, 7
    s_lshl_b32 s7, s60, 15
    s_lshl_b32 s63, s6, 12
    s_add_u32 s7, s7, s63
    s_add_u32 s7, s7, 0x600000
    v_lshl_add_u32 v5, v1, 4, s7
    v_mov_b32 v38, s92
    v_mov_b32 v39, s93
    v_permlane32_swap_b32 v128, v132
    v_permlane32_swap_b32 v129, v133
    v_permlane32_swap_b32 v130, v134
    v_permlane32_swap_b32 v131, v135
    v_cvt_pk_bf16_f32 v16, v128, v129
    v_cvt_pk_bf16_f32 v17, v130, v131
    v_cvt_pk_bf16_f32 v18, v132, v133
    v_cvt_pk_bf16_f32 v19, v134, v135
    v_permlane32_swap_b32 v136, v140
    v_permlane32_swap_b32 v137, v141
    v_permlane32_swap_b32 v138, v142
    v_permlane32_swap_b32 v139, v143
    v_cvt_pk_bf16_f32 v20, v136, v137
    v_cvt_pk_bf16_f32 v21, v138, v139
    v_cvt_pk_bf16_f32 v22, v140, v141
    v_cvt_pk_bf16_f32 v23, v142, v143
    v_permlane32_swap_b32 v144, v148
    v_permlane32_swap_b32 v145, v149
    v_permlane32_swap_b32 v146, v150
    v_permlane32_swap_b32 v147, v151
    v_cvt_pk_bf16_f32 v24, v144, v145
    v_cvt_pk_bf16_f32 v25, v146, v147
    v_cvt_pk_bf16_f32 v26, v148, v149
    v_cvt_pk_bf16_f32 v27, v150, v151
    v_permlane32_swap_b32 v152, v156
    v_permlane32_swap_b32 v153, v157
    v_permlane32_swap_b32 v154, v158
    v_permlane32_swap_b32 v155, v159
    v_cvt_pk_bf16_f32 v28, v152, v153
    v_cvt_pk_bf16_f32 v29, v154, v155
    v_cvt_pk_bf16_f32 v30, v156, v157
    v_cvt_pk_bf16_f32 v31, v158, v159
    s_lshl_b32 s7, s67, 9
    s_lshl_b32 s65, s6, 6
    s_add_u32 s7, s7, s65
    s_add_u32 s7, s7, 0x23000
    v_and_b32 v160, 7, v1
    v_lshl_add_u32 v7, v160, 3, s7
    s_lshl_b64 s[88:89], 1, s68
    s_cmp_eq_u32 s101, 0
    s_cbranch_scc1 SU_165
    buffer_store_dwordx4 v[16:19], v5, s[36:39], 0 offen offset:0
    buffer_store_dwordx4 v[20:23], v5, s[36:39], 0 offen offset:1024
    buffer_store_dwordx4 v[24:27], v5, s[36:39], 0 offen offset:2048
    buffer_store_dwordx4 v[28:31], v5, s[36:39], 0 offen offset:3072
    s_waitcnt vmcnt(0)
    s_mov_b64 exec, s[88:89]
    buffer_store_dwordx2 v[38:39], v7, s[36:39], 0 offen
    s_mov_b64 exec, -1
SV_166:
    s_lshl_b32 s7, s67, 18
    s_add_u32 s7, s7, s63
    s_lshl_b32 s65, s68, 6
    s_add_u32 s7, s7, s65
    s_add_u32 s7, s7, 0x600000
    v_and_b32 v160, 3, v1
    v_lshl_add_u32 v5, v160, 4, s7
    v_bfe_u32 v161, v1, 2, 3
    v_lshl_add_u32 v5, v161, 9, v5
    v_lshrrev_b32 v162, 5, v1
    v_lshl_add_u32 v5, v162, 15, v5
    s_lshl_b32 s7, s67, 12
    s_add_u32 s7, s7, s65
    s_add_u32 s7, s7, 0x28000
    v_lshl_add_u32 v6, v160, 4, s7
    v_lshl_add_u32 v6, v162, 9, v6
    s_lshl_b32 s7, s68, 16
    s_lshl_b32 s63, s67, 11
    s_add_u32 s7, s7, s63
    s_lshl_b32 s63, s6, 8
    s_add_u32 s7, s7, s63
    s_add_u32 s7, s7, 0x100000
    v_lshl_add_u32 v8, v160, 14, s7
    v_lshl_add_u32 v8, v161, 5, v8
    v_lshl_add_u32 v8, v162, 4, v8
    s_lshl_b32 s7, s67, 9
    s_add_u32 s7, s7, s65
    s_add_u32 s7, s7, 0x30000
    v_lshl_add_u32 v9, v160, 4, s7
    s_mov_b64 exec, 0xff
    buffer_load_dwordx2 v[40:41], v7, s[36:39], 0 offen sc1 nt
    s_mov_b32 s80, 200000
MC_168:
    s_mov_b64 exec, 0xff
    s_waitcnt vmcnt(0)
    v_cmp_ne_u64 s[86:87], s[92:93], v[40:41]
    s_cmp_lg_u64 s[86:87], 0
    s_cbranch_scc1 M_167
MD_169:
    s_mov_b64 exec, -1
    buffer_load_dwordx4 v[64:67], v6, s[36:39], 0 offen offset:0 sc1 nt
    buffer_load_dwordx4 v[68:71], v6, s[36:39], 0 offen offset:1024 sc1 nt
    buffer_load_dwordx4 v[72:75], v6, s[36:39], 0 offen offset:2048 sc1 nt
    buffer_load_dwordx4 v[76:79], v6, s[36:39], 0 offen offset:3072 sc1 nt
    s_mov_b32 s63, 0
    buffer_load_dwordx4 v[48:51], v5, s[36:39], s63 offen sc1 nt
    s_add_u32 s63, s63, 65536
    buffer_load_dwordx4 v[52:55], v5, s[36:39], s63 offen sc1 nt
    s_add_u32 s63, s63, 65536
    buffer_load_dwordx4 v[56:59], v5, s[36:39], s63 offen sc1 nt
    s_add_u32 s63, s63, 65536
    buffer_load_dwordx4 v[60:63], v5, s[36:39], s63 offen sc1 nt
    s_add_u32 s63, s63, 65536
    s_waitcnt vmcnt(4)
    v_cmp_ne_u64 s[90:91], s[92:93], v[66:67]
    v_cmp_ne_u64 vcc, s[92:93], v[70:71]
    s_or_b64 s[90:91], s[90:91], vcc
    v_cmp_ne_u64 vcc, s[92:93], v[74:75]
    s_or_b64 s[90:91], s[90:91], vcc
    v_cmp_ne_u64 vcc, s[92:93], v[78:79]
    s_or_b64 s[90:91], s[90:91], vcc
    s_cmp_lg_u64 s[90:91], 0
    s_cbranch_scc1 BL_170
BLD_171:
    v_max3_f32 v36, v64, v68, v72
    v_max_f32 v36, v36, v76
    v_mov_b32 v37, v36
    s_nop 1
    v_permlane32_swap_b32 v36, v37
    v_max_f32 v36, v36, v37
    v_sub_f32 v80, v64, v36
    v_sub_f32 v81, v68, v36
    v_sub_f32 v82, v72, v36
    v_sub_f32 v83, v76, v36
    v_exp_f32 v80, v80
    v_exp_f32 v81, v81
    v_exp_f32 v82, v82
    v_exp_f32 v83, v83
    v_mul_f32 v37, v80, v65
    v_fmac_f32 v37, v81, v69
    v_fmac_f32 v37, v82, v73
    v_fmac_f32 v37, v83, v77
    v_mov_b32 v40, v37
    s_nop 1
    v_permlane32_swap_b32 v37, v40
    v_add_f32 v37, v37, v40
    s_waitcnt vmcnt(3)
    v_lshlrev_b32 v88, 16, v48
    v_and_b32 v89, 0xffff0000, v48
    v_lshlrev_b32 v90, 16, v49
    v_and_b32 v91, 0xffff0000, v49
    v_lshlrev_b32 v92, 16, v50
    v_and_b32 v93, 0xffff0000, v50
    v_lshlrev_b32 v94, 16, v51
    v_and_b32 v95, 0xffff0000, v51
    v_mul_f32 v16, v88, v80
    v_mul_f32 v17, v89, v80
    v_mul_f32 v18, v90, v80
    v_mul_f32 v19, v91, v80
    v_mul_f32 v20, v92, v80
    v_mul_f32 v21, v93, v80
    v_mul_f32 v22, v94, v80
    v_mul_f32 v23, v95, v80
    s_waitcnt vmcnt(2)
    v_lshlrev_b32 v88, 16, v52
    v_and_b32 v89, 0xffff0000, v52
    v_lshlrev_b32 v90, 16, v53
    v_and_b32 v91, 0xffff0000, v53
    v_lshlrev_b32 v92, 16, v54
    v_and_b32 v93, 0xffff0000, v54
    v_lshlrev_b32 v94, 16, v55
    v_and_b32 v95, 0xffff0000, v55
    v_fmac_f32 v16, v88, v81
    v_fmac_f32 v17, v89, v81
    v_fmac_f32 v18, v90, v81
    v_fmac_f32 v19, v91, v81
    v_fmac_f32 v20, v92, v81
    v_fmac_f32 v21, v93, v81
    v_fmac_f32 v22, v94, v81
    v_fmac_f32 v23, v95, v81
    s_waitcnt vmcnt(1)
    v_lshlrev_b32 v88, 16, v56
    v_and_b32 v89, 0xffff0000, v56
    v_lshlrev_b32 v90, 16, v57
    v_and_b32 v91, 0xffff0000, v57
    v_lshlrev_b32 v92, 16, v58
    v_and_b32 v93, 0xffff0000, v58
    v_lshlrev_b32 v94, 16, v59
    v_and_b32 v95, 0xffff0000, v59
    v_fmac_f32 v16, v88, v82
    v_fmac_f32 v17, v89, v82
    v_fmac_f32 v18, v90, v82
    v_fmac_f32 v19, v91, v82
    v_fmac_f32 v20, v92, v82
    v_fmac_f32 v21, v93, v82
    v_fmac_f32 v22, v94, v82
    v_fmac_f32 v23, v95, v82
    s_waitcnt vmcnt(0)
    v_mov_b32 v160, 0x24218
    v_mov_b32 v161, 1
    s_mov_b64 exec, 1
    ds_add_u32 v160, v161
    s_mov_b64 exec, -1
    v_lshlrev_b32 v88, 16, v60
    v_and_b32 v89, 0xffff0000, v60
    v_lshlrev_b32 v90, 16, v61
    v_and_b32 v91, 0xffff0000, v61
    v_lshlrev_b32 v92, 16, v62
    v_and_b32 v93, 0xffff0000, v62
    v_lshlrev_b32 v94, 16, v63
    v_and_b32 v95, 0xffff0000, v63
    v_fmac_f32 v16, v88, v83
    v_fmac_f32 v17, v89, v83
    v_fmac_f32 v18, v90, v83
    v_fmac_f32 v19, v91, v83
    v_fmac_f32 v20, v92, v83
    v_fmac_f32 v21, v93, v83
    v_fmac_f32 v22, v94, v83
    v_fmac_f32 v23, v95, v83
    v_permlane32_swap_b32 v16, v20
    v_permlane32_swap_b32 v17, v21
    v_permlane32_swap_b32 v18, v22
    v_permlane32_swap_b32 v19, v23
    v_add_f32 v16, v16, v20
    v_add_f32 v17, v17, v21
    v_add_f32 v18, v18, v22
    v_add_f32 v19, v19, v23
    v_cvt_pk_bf16_f32 v44, v16, v17
    v_cvt_pk_bf16_f32 v45, v18, v19
    v_mov_b32 v46, s92
    v_mov_b32 v47, s93
    v_mov_b32 v160, 0x24218
    s_mov_b32 s80, 1600000
LW_172:
    ds_read_b32 v161, v160
    s_waitcnt lgkmcnt(0)
    v_readfirstlane_b32 s79, v161
    s_cmp_ge_u32 s79, 8
    s_cbranch_scc1 LWD_173
    s_sub_u32 s80, s80, 1
    s_cmp_lg_u32 s80, 0
    s_cbranch_scc1 LW_172
LWD_173:
    buffer_store_dwordx4 v[44:47], v8, s[36:39], 0 offen sc1
    s_cmp_lg_u32 s6, 0
    s_cbranch_scc1 BM2_174
    s_mov_b64 exec, 15
    buffer_store_dwordx4 v[36:39], v9, s[36:39], 0 offen sc1
    s_mov_b64 exec, -1
BM2_174:
    v_mov_b32 v160, 0x24218
    v_mov_b32 v161, 1
    s_mov_b64 exec, 1
    ds_add_u32 v160, v161
    s_mov_b64 exec, -1
    s_lshl_b32 s7, s67, 13
    s_lshl_b32 s63, s6, 10
    s_add_u32 s7, s7, s63
    s_add_u32 s7, s7, 0x4a0000
    v_lshl_add_u32 v4, v1, 4, s7
    v_lshrrev_b32 v160, 2, v3
    v_mul_u32_u24 v5, 1088, v160
    v_and_b32 v160, 3, v1
    v_lshl_add_u32 v5, v160, 4, v5
    v_lshrrev_b32 v161, 5, v1
    v_lshl_add_u32 v5, v161, 6, v5
    v_and_b32 v161, 1, v2
    v_lshl_add_u32 v5, v161, 3, v5
    s_lshl_b32 s7, s6, 7
    s_add_u32 s7, s7, 0x26000
    v_add_u32 v5, s7, v5
    v_mul_u32_u24 v6, 1088, v160
    v_lshl_add_u32 v6, v2, 4, v6
    v_add_u32 v6, 0x26000, v6
    s_lshl_b32 s7, s68, 2
    s_add_u32 s7, s7, s6
    s_lshl_b32 s7, s7, 3
    s_add_u32 s7, s7, s67
    s_lshl_b32 s7, s7, 8
    s_add_u32 s7, s7, 0x480000
    v_lshl_add_u32 v7, v160, 6, s7
    v_lshl_add_u32 v7, v2, 4, v7
    v_cmp_gt_u32 s[84:85], 4, v3
    v_bfe_u32 v8, v1, 3, 2
    v_xor_b32 v8, s6, v8
    v_lshlrev_b32 v8, 5, v8
    v_lshrrev_b32 v161, 2, v1
    v_lshl_add_u32 v8, v161, 7, v8
    v_lshl_add_u32 v8, v160, 3, v8
    s_cmp_ge_u32 s6, 4
    s_cbranch_scc1 W4_175
    v_add_u32 v9, 114688, v8
    v_mov_b32 v162, 0x24000
    s_mov_b32 s80, 1600000
LW_176:
    ds_read_b32 v163, v162
    s_waitcnt lgkmcnt(0)
    v_readfirstlane_b32 s79, v163
    s_cmp_ge_u32 s79, 288
    s_cbranch_scc1 LWD_177
    s_sleep 1
    s_sub_u32 s80, s80, 1
    s_cmp_lg_u32 s80, 0
    s_cbranch_scc1 LW_176
LWD_177:
    ds_read_b64_tr_b16 v[48:49], v9 offset:0
    ds_read_b64_tr_b16 v[50:51], v9 offset:2048
    ds_read_b64_tr_b16 v[52:53], v9 offset:4096
    ds_read_b64_tr_b16 v[54:55], v9 offset:6144
    ds_read_b64_tr_b16 v[56:57], v9 offset:8192
    ds_read_b64_tr_b16 v[58:59], v9 offset:10240
    ds_read_b64_tr_b16 v[60:61], v9 offset:12288
    ds_read_b64_tr_b16 v[62:63], v9 offset:14336
    s_waitcnt lgkmcnt(4)
    ds_read_b64_tr_b16 v[64:65], v9 offset:16384
    ds_read_b64_tr_b16 v[66:67], v9 offset:18432
    ds_read_b64_tr_b16 v[68:69], v9 offset:20480
    ds_read_b64_tr_b16 v[70:71], v9 offset:22528
    ds_read_b64_tr_b16 v[72:73], v9 offset:24576
    ds_read_b64_tr_b16 v[74:75], v9 offset:26624
    ds_read_b64_tr_b16 v[76:77], v9 offset:28672
    ds_read_b64_tr_b16 v[78:79], v9 offset:30720
    s_waitcnt lgkmcnt(4)
    v_mov_b32 v162, 0x24000
    s_mov_b32 s80, 1600000
LW_178:
    ds_read_b32 v163, v162
    s_waitcnt lgkmcnt(0)
    v_readfirstlane_b32 s79, v163
    s_cmp_ge_u32 s79, 320
    s_cbranch_scc1 LWD_179
    s_sleep 1
    s_sub_u32 s80, s80, 1
    s_cmp_lg_u32 s80, 0
    s_cbranch_scc1 LW_178
LWD_179:
    ds_read_b64_tr_b16 v[80:81], v8 offset:0
    ds_read_b64_tr_b16 v[82:83], v8 offset:2048
    ds_read_b64_tr_b16 v[84:85], v8 offset:4096
    ds_read_b64_tr_b16 v[86:87], v8 offset:6144
    ds_read_b64_tr_b16 v[88:89], v8 offset:8192
    ds_read_b64_tr_b16 v[90:91], v8 offset:10240
    ds_read_b64_tr_b16 v[92:93], v8 offset:12288
    ds_read_b64_tr_b16 v[94:95], v8 offset:14336
    s_waitcnt lgkmcnt(4)
    ds_read_b64_tr_b16 v[96:97], v8 offset:16384
    ds_read_b64_tr_b16 v[98:99], v8 offset:18432
    ds_read_b64_tr_b16 v[100:101], v8 offset:20480
    ds_read_b64_tr_b16 v[102:103], v8 offset:22528
    ds_read_b64_tr_b16 v[104:105], v8 offset:24576
    ds_read_b64_tr_b16 v[106:107], v8 offset:26624
    ds_read_b64_tr_b16 v[108:109], v8 offset:28672
    ds_read_b64_tr_b16 v[110:111], v8 offset:30720
    s_waitcnt lgkmcnt(4)
W4_175:
    s_mov_b64 exec, -1
    buffer_load_dwordx4 v[16:19], v4, s[36:39], 0 offen sc1 nt
    s_mov_b32 s80, 200000
MC_181:
    s_mov_b64 exec, -1
    s_waitcnt vmcnt(0)
    v_cmp_ne_u64 s[86:87], s[92:93], v[18:19]
    s_cmp_lg_u64 s[86:87], 0
    s_cbranch_scc1 M_180
MD_182:
    s_mov_b64 exec, -1
    ds_write_b64 v5, v[16:17]
    s_add_u32 s81, s81, 8
    v_mov_b32 v160, 0x2420c
    v_mov_b32 v161, 1
    s_mov_b64 exec, 1
    ds_add_u32 v160, v161
    s_mov_b64 exec, -1
    s_cmp_ge_u32 s6, 4
    s_cbranch_scc1 L_END
    v_mov_b32 v160, 0x2420c
    s_mov_b32 s80, 1600000
LW_183:
    ds_read_b32 v161, v160
    s_waitcnt lgkmcnt(0)
    v_readfirstlane_b32 s79, v161
    s_cmp_ge_u32 s79, s81
    s_cbranch_scc1 LWD_184
    s_sub_u32 s80, s80, 1
    s_cmp_lg_u32 s80, 0
    s_cbranch_scc1 LW_183
LWD_184:
    ds_read_b128 v[112:115], v6 offset:0
    ds_read_b128 v[116:119], v6 offset:64
    ds_read_b128 v[120:123], v6 offset:128
    ds_read_b128 v[124:127], v6 offset:192
    ds_read_b128 v[128:131], v6 offset:256
    ds_read_b128 v[132:135], v6 offset:320
    ds_read_b128 v[136:139], v6 offset:384
    ds_read_b128 v[140:143], v6 offset:448
    ds_read_b128 v[144:147], v6 offset:512
    ds_read_b128 v[148:151], v6 offset:576
    ds_read_b128 v[152:155], v6 offset:640
    ds_read_b128 v[156:159], v6 offset:704
    s_waitcnt lgkmcnt(8)
    ds_read_b128 v[20:23], v6 offset:768
    ds_read_b128 v[24:27], v6 offset:832
    ds_read_b128 v[28:31], v6 offset:896
    ds_read_b128 v[32:35], v6 offset:960
    v_mfma_f32_16x16x32_bf16 v[12:15], v[48:51], v[112:115], 0
    v_mfma_f32_16x16x32_bf16 v[12:15], v[52:55], v[116:119], v[12:15]
    v_mfma_f32_16x16x32_bf16 v[12:15], v[56:59], v[120:123], v[12:15]
    v_mfma_f32_16x16x32_bf16 v[12:15], v[60:63], v[124:127], v[12:15]
    s_waitcnt lgkmcnt(11)
    v_mfma_f32_16x16x32_bf16 v[12:15], v[64:67], v[128:131], v[12:15]
    s_waitcnt lgkmcnt(10)
    v_mfma_f32_16x16x32_bf16 v[12:15], v[68:71], v[132:135], v[12:15]
    s_waitcnt lgkmcnt(9)
    v_mfma_f32_16x16x32_bf16 v[12:15], v[72:75], v[136:139], v[12:15]
    s_waitcnt lgkmcnt(8)
    v_mfma_f32_16x16x32_bf16 v[12:15], v[76:79], v[140:143], v[12:15]
    s_waitcnt lgkmcnt(7)
    v_mfma_f32_16x16x32_bf16 v[12:15], v[80:83], v[144:147], v[12:15]
    s_waitcnt lgkmcnt(6)
    v_mfma_f32_16x16x32_bf16 v[12:15], v[84:87], v[148:151], v[12:15]
    s_waitcnt lgkmcnt(5)
    v_mfma_f32_16x16x32_bf16 v[12:15], v[88:91], v[152:155], v[12:15]
    s_waitcnt lgkmcnt(4)
    v_mfma_f32_16x16x32_bf16 v[12:15], v[92:95], v[156:159], v[12:15]
    s_waitcnt lgkmcnt(3)
    v_mfma_f32_16x16x32_bf16 v[12:15], v[96:99], v[20:23], v[12:15]
    s_waitcnt lgkmcnt(2)
    v_mfma_f32_16x16x32_bf16 v[12:15], v[100:103], v[24:27], v[12:15]
    s_waitcnt lgkmcnt(1)
    v_mfma_f32_16x16x32_bf16 v[12:15], v[104:107], v[28:31], v[12:15]
    s_waitcnt lgkmcnt(0)
    v_mfma_f32_16x16x32_bf16 v[12:15], v[108:111], v[32:35], v[12:15]
    s_nop 7
    v_cvt_pk_bf16_f32 v16, v12, v13
    v_cvt_pk_bf16_f32 v17, v14, v15
    s_mov_b64 exec, s[84:85]
    buffer_store_dwordx4 v[16:19], v7, s[36:39], 0 offen sc1
    s_mov_b64 exec, -1
    v_mov_b32 v160, 0x24214
    v_mov_b32 v161, 1
    s_mov_b64 exec, 1
    ds_add_u32 v160, v161
    s_mov_b64 exec, -1
    s_endpgm
RA_12:
    v_mov_b32 v12, 0x24000
    s_mov_b32 s80, 1600000
LW_185:
    ds_read_b32 v13, v12
    s_waitcnt lgkmcnt(0)
    v_readfirstlane_b32 s79, v13
    s_cmp_ge_u32 s79, s65
    s_cbranch_scc1 LWD_186
    s_sleep 1
    s_sub_u32 s80, s80, 1
    s_cmp_lg_u32 s80, 0
    s_cbranch_scc1 LW_185
LWD_186:
    ds_read_b64_tr_b16 v[32:33], v10 offset:0
    ds_read_b64_tr_b16 v[34:35], v10 offset:4096
    ds_read_b64_tr_b16 v[36:37], v11 offset:0
    ds_read_b64_tr_b16 v[38:39], v11 offset:4096
    ds_read_b64_tr_b16 v[40:41], v10 offset:8192
    ds_read_b64_tr_b16 v[42:43], v10 offset:12288
    ds_read_b64_tr_b16 v[44:45], v11 offset:8192
    ds_read_b64_tr_b16 v[46:47], v11 offset:12288
    s_waitcnt vmcnt(0)
    s_branch RB_13
E2_14:
    v_add_u32 v10, 0xffff8000, v10
    v_add_u32 v11, 0xffff8000, v11
    ds_read_b64_tr_b16 v[48:49], v10 offset:0
    ds_read_b64_tr_b16 v[50:51], v10 offset:4096
    ds_read_b64_tr_b16 v[52:53], v11 offset:0
    ds_read_b64_tr_b16 v[54:55], v11 offset:4096
    ds_read_b64_tr_b16 v[56:57], v10 offset:8192
    ds_read_b64_tr_b16 v[58:59], v10 offset:12288
    ds_read_b64_tr_b16 v[60:61], v11 offset:8192
    ds_read_b64_tr_b16 v[62:63], v11 offset:12288
    v_lshlrev_b32 v12, 2, v1
    v_add_u32 v12, 0x24130, v12
    v_mov_b32 v13, 1
    s_mov_b64 exec, 3
    ds_add_u32 v12, v13
    s_mov_b64 exec, -1
    s_waitcnt lgkmcnt(0)
    v_mfma_f32_16x16x32_bf16 v[24:27], v[48:51], v[136:139], v[24:27]
    v_mfma_f32_16x16x32_bf16 v[28:31], v[52:55], v[136:139], v[28:31]
    v_mfma_f32_16x16x32_bf16 v[24:27], v[56:59], v[140:143], v[24:27]
    v_mfma_f32_16x16x32_bf16 v[28:31], v[60:63], v[140:143], v[28:31]
    s_branch E3_15
SU_21:
    s_nop 3
    buffer_store_dwordx4 v[40:43], v4, s[36:39], 0 offen sc1
    s_branch SV_22
M_25:
    s_sub_u32 s80, s80, 1
    s_cmp_le_u32 s80, 199994
    s_cbranch_scc1 G2_24
    s_mov_b64 exec, s[44:45]
    s_cbranch_execz RS_187
    buffer_load_dwordx4 v[48:51], v7, s[36:39], 0 offen sc1 nt
RS_187:
    s_mov_b64 exec, s[46:47]
    s_cbranch_execz RS_188
    buffer_load_dwordx4 v[52:55], v7, s[36:39], s62 offen sc1 nt
RS_188:
    s_mov_b64 exec, s[48:49]
    s_cbranch_execz RS_189
    buffer_load_dwordx4 v[56:59], v9, s[36:39], 0 offen sc1 nt
RS_189:
    s_mov_b64 exec, s[50:51]
    s_cbranch_execz RS_190
    buffer_load_dwordx4 v[60:63], v9, s[36:39], s76 offen sc1 nt
RS_190:
    s_branch MC_26
G2_24:
    s_mov_b32 s64, 16
    s_mov_b64 exec, -1
    v_mov_b32 v12, 0x24204
    s_mov_b32 s80, 1600000
LW_191:
    ds_read_b32 v13, v12
    s_waitcnt lgkmcnt(0)
    v_readfirstlane_b32 s79, v13
    s_cmp_ge_u32 s79, 1
    s_cbranch_scc1 LWD_192
    s_sleep 1
    s_sub_u32 s80, s80, 1
    s_cmp_lg_u32 s80, 0
    s_cbranch_scc1 LW_191
LWD_192:
    v_mov_b32 v12, 0x24248
    ds_read_b64 v[14:15], v12
    s_waitcnt lgkmcnt(0)
    v_readfirstlane_b32 s92, v14
    v_readfirstlane_b32 s93, v15
    s_nop 0
    v_mov_b32 v42, s92
    v_mov_b32 v43, s93
    s_mov_b64 exec, s[84:85]
    buffer_store_dwordx4 v[40:43], v4, s[36:39], 0 offen sc1
    s_mov_b64 exec, s[86:87]
    s_mov_b32 s80, 200000
P_193:
    buffer_load_dwordx4 v[48:51], v7, s[36:39], 0 offen sc1 nt
    buffer_load_dwordx4 v[52:55], v7, s[36:39], s62 offen sc1 nt
    buffer_load_dwordx4 v[56:59], v9, s[36:39], 0 offen sc1 nt
    buffer_load_dwordx4 v[60:63], v9, s[36:39], s76 offen sc1 nt
PP_194:
    s_waitcnt vmcnt(0)
    s_mov_b64 s[90:91], 0
    v_cmp_gt_u64 s[88:89], s[94:95], v[50:51]
    v_cmp_le_u64 vcc, s[72:73], v[50:51]
    s_or_b64 s[88:89], s[88:89], vcc
    v_cmp_ne_u64 vcc, s[92:93], v[50:51]
    s_and_b64 vcc, vcc, s[88:89]
    s_or_b64 s[90:91], s[90:91], vcc
    v_cmp_gt_u64 s[88:89], s[94:95], v[54:55]
    v_cmp_le_u64 vcc, s[72:73], v[54:55]
    s_or_b64 s[88:89], s[88:89], vcc
    v_cmp_ne_u64 vcc, s[92:93], v[54:55]
    s_and_b64 vcc, vcc, s[88:89]
    s_or_b64 s[90:91], s[90:91], vcc
    v_cmp_gt_u64 s[88:89], s[94:95], v[58:59]
    v_cmp_le_u64 vcc, s[72:73], v[58:59]
    s_or_b64 s[88:89], s[88:89], vcc
    v_cmp_ne_u64 vcc, s[92:93], v[58:59]
    s_and_b64 vcc, vcc, s[88:89]
    s_or_b64 s[90:91], s[90:91], vcc
    v_cmp_gt_u64 s[88:89], s[94:95], v[62:63]
    v_cmp_le_u64 vcc, s[72:73], v[62:63]
    s_or_b64 s[88:89], s[88:89], vcc
    v_cmp_ne_u64 vcc, s[92:93], v[62:63]
    s_and_b64 vcc, vcc, s[88:89]
    s_or_b64 s[90:91], s[90:91], vcc
    s_cbranch_scc0 PD_195
    s_sleep 1
    s_sub_u32 s80, s80, 1
    s_cmp_lg_u32 s80, 0
    s_cbranch_scc1 P_193
PD_195:
    s_branch MD_27
ST_40:
    ds_read_b32 v18, v17
    s_waitcnt lgkmcnt(0)
    v_readlane_b32 s79, v18, s62
    s_cmp_ge_u32 s79, s63
    s_cbranch_scc1 GO_39
    s_waitcnt vmcnt(8)
    s_sub_u32 s7, s60, 8
    s_max_i32 s61, s61, s7
    v_mov_b32 v19, s61
    ds_write_b32 v16, v19
    ds_read_b32 v18, v17
    s_waitcnt lgkmcnt(0)
    v_readlane_b32 s79, v18, s62
    s_cmp_ge_u32 s79, s63
    s_cbranch_scc1 GO_39
    s_waitcnt vmcnt(0)
    s_mov_b32 s61, s60
    v_mov_b32 v19, s61
    ds_write_b32 v16, v19
    ds_read_b32 v18, v17
    s_waitcnt lgkmcnt(0)
    v_readlane_b32 s79, v18, s62
    s_cmp_ge_u32 s79, s63
    s_cbranch_scc1 GO_39
    s_mov_b32 s80, 1600000
SP_196:
    ds_read_b32 v18, v17
    s_waitcnt lgkmcnt(0)
    v_readlane_b32 s79, v18, s62
    s_cmp_ge_u32 s79, s63
    s_cbranch_scc1 GO_39
    s_sub_u32 s80, s80, 1
    s_cmp_lg_u32 s80, 0
    s_cbranch_scc1 SP_196
    s_branch GO_39
ST_43:
    ds_read_b32 v18, v17
    s_waitcnt lgkmcnt(0)
    v_readlane_b32 s79, v18, s62
    s_cmp_ge_u32 s79, s63
    s_cbranch_scc1 GO_42
    s_waitcnt vmcnt(16)
    s_sub_u32 s7, s60, 16
    s_max_i32 s61, s61, s7
    v_mov_b32 v19, s61
    ds_write_b32 v16, v19
    ds_read_b32 v18, v17
    s_waitcnt lgkmcnt(0)
    v_readlane_b32 s79, v18, s62
    s_cmp_ge_u32 s79, s63
    s_cbranch_scc1 GO_42
    s_waitcnt vmcnt(8)
    s_sub_u32 s7, s60, 8
    s_max_i32 s61, s61, s7
    v_mov_b32 v19, s61
    ds_write_b32 v16, v19
    ds_read_b32 v18, v17
    s_waitcnt lgkmcnt(0)
    v_readlane_b32 s79, v18, s62
    s_cmp_ge_u32 s79, s63
    s_cbranch_scc1 GO_42
    s_waitcnt vmcnt(0)
    s_mov_b32 s61, s60
    v_mov_b32 v19, s61
    ds_write_b32 v16, v19
    ds_read_b32 v18, v17
    s_waitcnt lgkmcnt(0)
    v_readlane_b32 s79, v18, s62
    s_cmp_ge_u32 s79, s63
    s_cbranch_scc1 GO_42
    s_mov_b32 s80, 1600000
SP_197:
    ds_read_b32 v18, v17
    s_waitcnt lgkmcnt(0)
    v_readlane_b32 s79, v18, s62
    s_cmp_ge_u32 s79, s63
    s_cbranch_scc1 GO_42
    s_sub_u32 s80, s80, 1
    s_cmp_lg_u32 s80, 0
    s_cbranch_scc1 SP_197
    s_branch GO_42
ST_46:
    ds_read_b32 v18, v17
    s_waitcnt lgkmcnt(0)
    v_readlane_b32 s79, v18, s62
    s_cmp_ge_u32 s79, s63
    s_cbranch_scc1 GO_45
    s_waitcnt vmcnt(16)
    s_sub_u32 s7, s60, 16
    s_max_i32 s61, s61, s7
    v_mov_b32 v19, s61
    ds_write_b32 v16, v19
    ds_read_b32 v18, v17
    s_waitcnt lgkmcnt(0)
    v_readlane_b32 s79, v18, s62
    s_cmp_ge_u32 s79, s63
    s_cbranch_scc1 GO_45
    s_waitcnt vmcnt(8)
    s_sub_u32 s7, s60, 8
    s_max_i32 s61, s61, s7
    v_mov_b32 v19, s61
    ds_write_b32 v16, v19
    ds_read_b32 v18, v17
    s_waitcnt lgkmcnt(0)
    v_readlane_b32 s79, v18, s62
    s_cmp_ge_u32 s79, s63
    s_cbranch_scc1 GO_45
    s_waitcnt vmcnt(0)
    s_mov_b32 s61, s60
    v_mov_b32 v19, s61
    ds_write_b32 v16, v19
    ds_read_b32 v18, v17
    s_waitcnt lgkmcnt(0)
    v_readlane_b32 s79, v18, s62
    s_cmp_ge_u32 s79, s63
    s_cbranch_scc1 GO_45
    s_mov_b32 s80, 1600000
SP_198:
    ds_read_b32 v18, v17
    s_waitcnt lgkmcnt(0)
    v_readlane_b32 s79, v18, s62
    s_cmp_ge_u32 s79, s63
    s_cbranch_scc1 GO_45
    s_sub_u32 s80, s80, 1
    s_cmp_lg_u32 s80, 0
    s_cbranch_scc1 SP_198
    s_branch GO_45
ST_49:
    ds_read_b32 v18, v17
    s_waitcnt lgkmcnt(0)
    v_readlane_b32 s79, v18, s62
    s_cmp_ge_u32 s79, s63
    s_cbranch_scc1 GO_48
    s_waitcnt vmcnt(24)
    s_sub_u32 s7, s60, 24
    s_max_i32 s61, s61, s7
    v_mov_b32 v19, s61
    ds_write_b32 v16, v19
    ds_read_b32 v18, v17
    s_waitcnt lgkmcnt(0)
    v_readlane_b32 s79, v18, s62
    s_cmp_ge_u32 s79, s63
    s_cbranch_scc1 GO_48
    s_waitcnt vmcnt(16)
    s_sub_u32 s7, s60, 16
    s_max_i32 s61, s61, s7
    v_mov_b32 v19, s61
    ds_write_b32 v16, v19
    ds_read_b32 v18, v17
    s_waitcnt lgkmcnt(0)
    v_readlane_b32 s79, v18, s62
    s_cmp_ge_u32 s79, s63
    s_cbranch_scc1 GO_48
    s_waitcnt vmcnt(8)
    s_sub_u32 s7, s60, 8
    s_max_i32 s61, s61, s7
    v_mov_b32 v19, s61
    ds_write_b32 v16, v19
    ds_read_b32 v18, v17
    s_waitcnt lgkmcnt(0)
    v_readlane_b32 s79, v18, s62
    s_cmp_ge_u32 s79, s63
    s_cbranch_scc1 GO_48
    s_waitcnt vmcnt(0)
    s_mov_b32 s61, s60
    v_mov_b32 v19, s61
    ds_write_b32 v16, v19
    ds_read_b32 v18, v17
    s_waitcnt lgkmcnt(0)
    v_readlane_b32 s79, v18, s62
    s_cmp_ge_u32 s79, s63
    s_cbranch_scc1 GO_48
    s_mov_b32 s80, 1600000
SP_199:
    ds_read_b32 v18, v17
    s_waitcnt lgkmcnt(0)
    v_readlane_b32 s79, v18, s62
    s_cmp_ge_u32 s79, s63
    s_cbranch_scc1 GO_48
    s_sub_u32 s80, s80, 1
    s_cmp_lg_u32 s80, 0
    s_cbranch_scc1 SP_199
    s_branch GO_48
M_54:
    s_sub_u32 s80, s80, 1
    s_cmp_le_u32 s80, 0
    s_cbranch_scc1 MD_56
    s_mov_b64 exec, s[62:63]
    s_cbranch_execz RS_200
    buffer_load_dwordx4 v[48:51], v36, s[36:39], 0 offen offset:0 sc1
RS_200:
    s_mov_b64 exec, s[64:65]
    s_cbranch_execz RS_201
    buffer_load_dwordx4 v[52:55], v36, s[36:39], 0 offen offset:1024 sc1
RS_201:
    s_mov_b64 exec, s[66:67]
    s_cbranch_execz RS_202
    buffer_load_dwordx4 v[56:59], v36, s[36:39], 0 offen offset:2048 sc1
RS_202:
    s_mov_b64 exec, s[68:69]
    s_cbranch_execz RS_203
    buffer_load_dwordx4 v[60:63], v36, s[36:39], 0 offen offset:3072 sc1
RS_203:
    s_branch MC_55
ST_63:
    ds_read_b32 v18, v17
    s_waitcnt lgkmcnt(0)
    v_readlane_b32 s79, v18, s62
    s_cmp_ge_u32 s79, s63
    s_cbranch_scc1 GO_62
    s_waitcnt vmcnt(16)
    s_sub_u32 s7, s60, 16
    s_max_i32 s61, s61, s7
    v_mov_b32 v19, s61
    ds_write_b32 v16, v19
    ds_read_b32 v18, v17
    s_waitcnt lgkmcnt(0)
    v_readlane_b32 s79, v18, s62
    s_cmp_ge_u32 s79, s63
    s_cbranch_scc1 GO_62
    s_waitcnt vmcnt(8)
    s_sub_u32 s7, s60, 8
    s_max_i32 s61, s61, s7
    v_mov_b32 v19, s61
    ds_write_b32 v16, v19
    ds_read_b32 v18, v17
    s_waitcnt lgkmcnt(0)
    v_readlane_b32 s79, v18, s62
    s_cmp_ge_u32 s79, s63
    s_cbranch_scc1 GO_62
    s_waitcnt vmcnt(0)
    s_mov_b32 s61, s60
    v_mov_b32 v19, s61
    ds_write_b32 v16, v19
    ds_read_b32 v18, v17
    s_waitcnt lgkmcnt(0)
    v_readlane_b32 s79, v18, s62
    s_cmp_ge_u32 s79, s63
    s_cbranch_scc1 GO_62
    s_mov_b32 s80, 1600000
SP_204:
    ds_read_b32 v18, v17
    s_waitcnt lgkmcnt(0)
    v_readlane_b32 s79, v18, s62
    s_cmp_ge_u32 s79, s63
    s_cbranch_scc1 GO_62
    s_sub_u32 s80, s80, 1
    s_cmp_lg_u32 s80, 0
    s_cbranch_scc1 SP_204
    s_branch GO_62
ST_66:
    ds_read_b32 v18, v17
    s_waitcnt lgkmcnt(0)
    v_readlane_b32 s79, v18, s62
    s_cmp_ge_u32 s79, s63
    s_cbranch_scc1 GO_65
    s_waitcnt vmcnt(16)
    s_sub_u32 s7, s60, 16
    s_max_i32 s61, s61, s7
    v_mov_b32 v19, s61
    ds_write_b32 v16, v19
    ds_read_b32 v18, v17
    s_waitcnt lgkmcnt(0)
    v_readlane_b32 s79, v18, s62
    s_cmp_ge_u32 s79, s63
    s_cbranch_scc1 GO_65
    s_waitcnt vmcnt(8)
    s_sub_u32 s7, s60, 8
    s_max_i32 s61, s61, s7
    v_mov_b32 v19, s61
    ds_write_b32 v16, v19
    ds_read_b32 v18, v17
    s_waitcnt lgkmcnt(0)
    v_readlane_b32 s79, v18, s62
    s_cmp_ge_u32 s79, s63
    s_cbranch_scc1 GO_65
    s_waitcnt vmcnt(0)
    s_mov_b32 s61, s60
    v_mov_b32 v19, s61
    ds_write_b32 v16, v19
    ds_read_b32 v18, v17
    s_waitcnt lgkmcnt(0)
    v_readlane_b32 s79, v18, s62
    s_cmp_ge_u32 s79, s63
    s_cbranch_scc1 GO_65
    s_mov_b32 s80, 1600000
SP_205:
    ds_read_b32 v18, v17
    s_waitcnt lgkmcnt(0)
    v_readlane_b32 s79, v18, s62
    s_cmp_ge_u32 s79, s63
    s_cbranch_scc1 GO_65
    s_sub_u32 s80, s80, 1
    s_cmp_lg_u32 s80, 0
    s_cbranch_scc1 SP_205
    s_branch GO_65
ST_69:
    ds_read_b32 v18, v17
    s_waitcnt lgkmcnt(0)
    v_readlane_b32 s79, v18, s62
    s_cmp_ge_u32 s79, s63
    s_cbranch_scc1 GO_68
    s_waitcnt vmcnt(24)
    s_sub_u32 s7, s60, 24
    s_max_i32 s61, s61, s7
    v_mov_b32 v19, s61
    ds_write_b32 v16, v19
    ds_read_b32 v18, v17
    s_waitcnt lgkmcnt(0)
    v_readlane_b32 s79, v18, s62
    s_cmp_ge_u32 s79, s63
    s_cbranch_scc1 GO_68
    s_waitcnt vmcnt(16)
    s_sub_u32 s7, s60, 16
    s_max_i32 s61, s61, s7
    v_mov_b32 v19, s61
    ds_write_b32 v16, v19
    ds_read_b32 v18, v17
    s_waitcnt lgkmcnt(0)
    v_readlane_b32 s79, v18, s62
    s_cmp_ge_u32 s79, s63
    s_cbranch_scc1 GO_68
    s_waitcnt vmcnt(8)
    s_sub_u32 s7, s60, 8
    s_max_i32 s61, s61, s7
    v_mov_b32 v19, s61
    ds_write_b32 v16, v19
    ds_read_b32 v18, v17
    s_waitcnt lgkmcnt(0)
    v_readlane_b32 s79, v18, s62
    s_cmp_ge_u32 s79, s63
    s_cbranch_scc1 GO_68
    s_waitcnt vmcnt(0)
    s_mov_b32 s61, s60
    v_mov_b32 v19, s61
    ds_write_b32 v16, v19
    ds_read_b32 v18, v17
    s_waitcnt lgkmcnt(0)
    v_readlane_b32 s79, v18, s62
    s_cmp_ge_u32 s79, s63
    s_cbranch_scc1 GO_68
    s_mov_b32 s80, 1600000
SP_206:
    ds_read_b32 v18, v17
    s_waitcnt lgkmcnt(0)
    v_readlane_b32 s79, v18, s62
    s_cmp_ge_u32 s79, s63
    s_cbranch_scc1 GO_68
    s_sub_u32 s80, s80, 1
    s_cmp_lg_u32 s80, 0
    s_cbranch_scc1 SP_206
    s_branch GO_68
ST_77:
    ds_read_b32 v18, v17
    s_waitcnt lgkmcnt(0)
    v_readlane_b32 s79, v18, s62
    s_cmp_ge_u32 s79, s63
    s_cbranch_scc1 GO_76
    s_waitcnt vmcnt(24)
    s_sub_u32 s7, s60, 24
    s_max_i32 s61, s61, s7
    v_mov_b32 v19, s61
    ds_write_b32 v16, v19
    ds_read_b32 v18, v17
    s_waitcnt lgkmcnt(0)
    v_readlane_b32 s79, v18, s62
    s_cmp_ge_u32 s79, s63
    s_cbranch_scc1 GO_76
    s_waitcnt vmcnt(16)
    s_sub_u32 s7, s60, 16
    s_max_i32 s61, s61, s7
    v_mov_b32 v19, s61
    ds_write_b32 v16, v19
    ds_read_b32 v18, v17
    s_waitcnt lgkmcnt(0)
    v_readlane_b32 s79, v18, s62
    s_cmp_ge_u32 s79, s63
    s_cbranch_scc1 GO_76
    s_waitcnt vmcnt(8)
    s_sub_u32 s7, s60, 8
    s_max_i32 s61, s61, s7
    v_mov_b32 v19, s61
    ds_write_b32 v16, v19
    ds_read_b32 v18, v17
    s_waitcnt lgkmcnt(0)
    v_readlane_b32 s79, v18, s62
    s_cmp_ge_u32 s79, s63
    s_cbranch_scc1 GO_76
    s_waitcnt vmcnt(0)
    s_mov_b32 s61, s60
    v_mov_b32 v19, s61
    ds_write_b32 v16, v19
    ds_read_b32 v18, v17
    s_waitcnt lgkmcnt(0)
    v_readlane_b32 s79, v18, s62
    s_cmp_ge_u32 s79, s63
    s_cbranch_scc1 GO_76
    s_mov_b32 s80, 1600000
SP_207:
    ds_read_b32 v18, v17
    s_waitcnt lgkmcnt(0)
    v_readlane_b32 s79, v18, s62
    s_cmp_ge_u32 s79, s63
    s_cbranch_scc1 GO_76
    s_sub_u32 s80, s80, 1
    s_cmp_lg_u32 s80, 0
    s_cbranch_scc1 SP_207
    s_branch GO_76
ST_79:
    ds_read_b32 v18, v17
    s_waitcnt lgkmcnt(0)
    v_readlane_b32 s79, v18, 0
    s_cmp_ge_u32 s79, s63
    s_cbranch_scc1 GO_78
    s_waitcnt vmcnt(24)
    s_sub_u32 s7, s60, 24
    s_max_i32 s61, s61, s7
    v_mov_b32 v19, s61
    ds_write_b32 v16, v19
    ds_read_b32 v18, v17
    s_waitcnt lgkmcnt(0)
    v_readlane_b32 s79, v18, 0
    s_cmp_ge_u32 s79, s63
    s_cbranch_scc1 GO_78
    s_waitcnt vmcnt(16)
    s_sub_u32 s7, s60, 16
    s_max_i32 s61, s61, s7
    v_mov_b32 v19, s61
    ds_write_b32 v16, v19
    ds_read_b32 v18, v17
    s_waitcnt lgkmcnt(0)
    v_readlane_b32 s79, v18, 0
    s_cmp_ge_u32 s79, s63
    s_cbranch_scc1 GO_78
    s_waitcnt vmcnt(8)
    s_sub_u32 s7, s60, 8
    s_max_i32 s61, s61, s7
    v_mov_b32 v19, s61
    ds_write_b32 v16, v19
    ds_read_b32 v18, v17
    s_waitcnt lgkmcnt(0)
    v_readlane_b32 s79, v18, 0
    s_cmp_ge_u32 s79, s63
    s_cbranch_scc1 GO_78
    s_waitcnt vmcnt(0)
    s_mov_b32 s61, s60
    v_mov_b32 v19, s61
    ds_write_b32 v16, v19
    ds_read_b32 v18, v17
    s_waitcnt lgkmcnt(0)
    v_readlane_b32 s79, v18, 0
    s_cmp_ge_u32 s79, s63
    s_cbranch_scc1 GO_78
    s_mov_b32 s80, 1600000
SP_208:
    ds_read_b32 v18, v17
    s_waitcnt lgkmcnt(0)
    v_readlane_b32 s79, v18, 0
    s_cmp_ge_u32 s79, s63
    s_cbranch_scc1 GO_78
    s_sub_u32 s80, s80, 1
    s_cmp_lg_u32 s80, 0
    s_cbranch_scc1 SP_208
    s_branch GO_78
SU_84:
    s_nop 3
    buffer_store_dwordx4 v[40:43], v44, s[36:39], 0 offen sc1
    s_branch SV_85
M_92:
    s_sub_u32 s80, s80, 1
    s_cmp_le_u32 s80, 0
    s_cbranch_scc1 MD_94
    s_mov_b64 exec, s[62:63]
    s_cbranch_execz RS_209
    buffer_load_dwordx4 v[48:51], v36, s[36:39], 0 offen offset:0 sc1
RS_209:
    s_mov_b64 exec, s[64:65]
    s_cbranch_execz RS_210
    buffer_load_dwordx4 v[52:55], v36, s[36:39], 0 offen offset:1024 sc1
RS_210:
    s_branch MC_93
SU_100:
    s_nop 3
    buffer_store_dwordx4 v[64:67], v8, s[36:39], 0 offen sc1
    s_branch SV_101
SU_105:
    s_nop 3
    buffer_store_dwordx4 v[64:67], v6, s[36:39], 0 offen sc1
    s_branch SV_106
M_118:
    s_sub_u32 s80, s80, 1
    s_cmp_le_u32 s80, 0
    s_cbranch_scc1 MD_120
    s_mov_b64 exec, s[64:65]
    s_cbranch_execz RS_211
    buffer_load_dwordx4 v[112:115], v5, s[36:39], 0 offen sc1 nt
RS_211:
    s_mov_b64 exec, s[66:67]
    s_cbranch_execz RS_212
    buffer_load_dwordx4 v[116:119], v5, s[36:39], s62 offen sc1 nt
RS_212:
    s_mov_b64 exec, s[68:69]
    s_cbranch_execz RS_213
    buffer_load_dwordx4 v[120:123], v5, s[36:39], s63 offen sc1 nt
RS_213:
    s_branch MC_119
M_131:
    s_sleep 6
    s_sub_u32 s80, s80, 1
    s_cmp_le_u32 s80, 0
    s_cbranch_scc1 MD_133
    s_mov_b64 exec, s[64:65]
    s_cbranch_execz RS_214
    buffer_load_dwordx2 v[12:13], v9, s[36:39], 0 offen sc1 nt
RS_214:
    s_branch MC_132
M_134:
    s_sub_u32 s80, s80, 1
    s_cmp_le_u32 s80, 0
    s_cbranch_scc1 MD_136
    s_mov_b64 exec, s[64:65]
    s_cbranch_execz RS_215
    buffer_load_dwordx4 v[16:19], v5, s[36:39], 0 offen offset:0 sc1
RS_215:
    s_mov_b64 exec, s[66:67]
    s_cbranch_execz RS_216
    buffer_load_dwordx4 v[20:23], v5, s[36:39], 0 offen offset:1024 sc1
RS_216:
    s_mov_b64 exec, s[68:69]
    s_cbranch_execz RS_217
    buffer_load_dwordx4 v[24:27], v5, s[36:39], 0 offen offset:2048 sc1
RS_217:
    s_mov_b64 exec, s[70:71]
    s_cbranch_execz RS_218
    buffer_load_dwordx4 v[28:31], v5, s[36:39], 0 offen offset:3072 sc1
RS_218:
    s_mov_b64 exec, s[72:73]
    s_cbranch_execz RS_219
    buffer_load_dwordx4 v[12:15], v4, s[36:39], 0 offen sc1
RS_219:
    s_branch MC_135
SU_139:
    s_nop 3
    buffer_store_dwordx4 v[16:19], v10, s[36:39], 0 offen sc1
    s_branch SV_140
M_150:
    s_sleep 2
    s_sub_u32 s80, s80, 1
    s_cmp_le_u32 s80, 0
    s_cbranch_scc1 MD_152
    s_mov_b64 exec, s[44:45]
    s_cbranch_execz RS_220
    buffer_load_dwordx4 v[16:19], v101, s[36:39], 0 offen offset:0 sc1
RS_220:
    s_mov_b64 exec, s[46:47]
    s_cbranch_execz RS_221
    buffer_load_dwordx4 v[20:23], v101, s[36:39], 0 offen offset:1024 sc1
RS_221:
    s_mov_b64 exec, s[48:49]
    s_cbranch_execz RS_222
    buffer_load_dwordx4 v[24:27], v101, s[36:39], 0 offen offset:2048 sc1
RS_222:
    s_mov_b64 exec, s[50:51]
    s_cbranch_execz RS_223
    buffer_load_dwordx4 v[28:31], v101, s[36:39], 0 offen offset:3072 sc1
RS_223:
    s_branch MC_151
SU_165:
    s_nop 3
    buffer_store_dwordx4 v[16:19], v5, s[36:39], 0 offen offset:0 sc1
    buffer_store_dwordx4 v[20:23], v5, s[36:39], 0 offen offset:1024 sc1
    buffer_store_dwordx4 v[24:27], v5, s[36:39], 0 offen offset:2048 sc1
    buffer_store_dwordx4 v[28:31], v5, s[36:39], 0 offen offset:3072 sc1
    s_waitcnt vmcnt(0)
    s_mov_b64 exec, s[88:89]
    buffer_store_dwordx2 v[38:39], v7, s[36:39], 0 offen sc1
    s_mov_b64 exec, -1
    s_branch SV_166
M_167:
    s_sub_u32 s80, s80, 1
    s_cmp_le_u32 s80, 0
    s_cbranch_scc1 MD_169
    s_mov_b64 exec, s[86:87]
    s_cbranch_execz RS_224
    buffer_load_dwordx2 v[40:41], v7, s[36:39], 0 offen sc1 nt
RS_224:
    s_branch MC_168
BL_170:
    s_mov_b32 s80, 200000
P_225:
    buffer_load_dwordx4 v[64:67], v6, s[36:39], 0 offen offset:0 sc1 nt
    buffer_load_dwordx4 v[68:71], v6, s[36:39], 0 offen offset:1024 sc1 nt
    buffer_load_dwordx4 v[72:75], v6, s[36:39], 0 offen offset:2048 sc1 nt
    buffer_load_dwordx4 v[76:79], v6, s[36:39], 0 offen offset:3072 sc1 nt
PP_226:
    s_waitcnt vmcnt(0)
    v_cmp_ne_u64 s[90:91], s[92:93], v[66:67]
    v_cmp_ne_u64 vcc, s[92:93], v[70:71]
    s_or_b64 s[90:91], s[90:91], vcc
    v_cmp_ne_u64 vcc, s[92:93], v[74:75]
    s_or_b64 s[90:91], s[90:91], vcc
    v_cmp_ne_u64 vcc, s[92:93], v[78:79]
    s_or_b64 s[90:91], s[90:91], vcc
    s_cmp_lg_u64 s[90:91], 0
    s_cbranch_scc0 PD_227
    s_sub_u32 s80, s80, 1
    s_cmp_lg_u32 s80, 0
    s_cbranch_scc1 P_225
PD_227:
    s_branch BLD_171
M_180:
    s_sleep 1
    s_sub_u32 s80, s80, 1
    s_cmp_le_u32 s80, 0
    s_cbranch_scc1 MD_182
    s_mov_b64 exec, s[86:87]
    s_cbranch_execz RS_228
    buffer_load_dwordx4 v[16:19], v4, s[36:39], 0 offen sc1 nt
RS_228:
    s_branch MC_181
L_END:
    s_endpgm
.section .rodata,"a"
.p2align 6
.amdhsa_kernel concat_heads__sliding_block_cached__compressed_kv_cla__decode_kernel
  .amdhsa_next_free_vgpr 168
  .amdhsa_next_free_sgpr 102
  .amdhsa_accum_offset 168
  .amdhsa_group_segment_fixed_size 0
  .amdhsa_kernarg_size 112
  .amdhsa_user_sgpr_count 2
  .amdhsa_user_sgpr_kernarg_segment_ptr 1
  .amdhsa_system_sgpr_workgroup_id_x 1
  .amdhsa_float_denorm_mode_32 3
.end_amdhsa_kernel
```

```asm
; @launch grid=(256,1,1) block=(576,1,1) lds=163840
.amdgcn_target "amdgcn-amd-amdhsa--gfx950"
.text
.globl concat_heads__sliding_block_cached__compressed_kv_cla__decode_kernel
.p2align 8
.type concat_heads__sliding_block_cached__compressed_kv_cla__decode_kernel,@function
concat_heads__sliding_block_cached__compressed_kv_cla__decode_kernel:
    s_cmp_ge_u32 s2, 256
    s_cbranch_scc1 L_END
    s_load_dwordx16 s[8:23], s[0:1], 0
    s_load_dwordx8 s[24:31], s[0:1], 64
    s_load_dwordx4 s[32:35], s[0:1], 96
    s_memrealtime s[94:95]
    v_lshrrev_b32 v1, 6, v0
    s_nop 0
    v_readfirstlane_b32 s3, v1
    v_and_b32 v1, 63, v0
    v_lshrrev_b32 v2, 4, v1
    v_and_b32 v3, 15, v1
    s_and_b32 s4, s2, 7
    s_lshr_b32 s7, s2, 6
    s_lshl_b32 s7, s7, 3
    s_or_b32 s4, s4, s7
    s_bfe_u32 s5, s2, 0x30003
    s_getreg_b32 s78, hwreg(HW_REG_XCC_ID, 0, 4)
    s_xor_b32 s6, s3, 4
    s_cmp_eq_u32 s3, 8
    s_cselect_b32 s7, 8, 0
    s_add_u32 s7, s7, s5
    s_cmp_ge_u32 s7, 14
    s_cbranch_scc1 L_LDB
    s_cmp_ge_u32 s7, 12
    s_cbranch_scc1 L_LDE
    s_cmp_ge_u32 s7, 8
    s_cbranch_scc1 L_LDA
    s_lshr_b32 s60, s6, 2
    s_and_b32 s61, s6, 3
    v_lshrrev_b32 v10, 1, v1
    v_xor_b32 v10, v10, v2
    v_and_b32 v10, 1, v10
    v_lshlrev_b32 v10, 5, v10
    v_lshrrev_b32 v11, 2, v1
    v_lshl_add_u32 v10, v11, 13, v10
    v_and_b32 v11, 1, v1
    v_lshl_add_u32 v10, v11, 4, v10
    s_lshl_b32 s63, s5, 19
    s_lshl_b32 s7, s4, 8
    s_add_u32 s63, s63, s7
    s_lshl_b32 s7, s61, 6
    s_add_u32 s63, s63, s7
    s_lshl_b32 s64, s61, 12
    s_add_u32 s64, s64, 0x1c000
    s_mov_b32 s81, 0
    s_lshr_b32 s7, s6, 1
    s_cmp_eq_u32 s7, 2
    s_cselect_b32 s74, 1, 0
    s_cmp_eq_u32 s6, 2
    s_cselect_b32 s77, 1, 0
    s_cmp_lt_u32 s5, 4
    s_cselect_b32 s74, s74, 0
    s_cselect_b32 s77, s77, 0
    v_and_b32 v8, 3, v1
    v_lshlrev_b32 v9, 10, v8
    v_lshl_add_u32 v9, v2, 3, v9
    s_lshl_b32 s62, s5, 7
    s_lshr_b32 s76, s5, 2
    s_andn2_b32 s76, s76, s60
    s_sub_u32 s7, s62, 512
    s_mul_i32 s7, s7, s76
    s_add_u32 s62, s62, s7
    s_waitcnt lgkmcnt(0)
    s_cmp_eq_u32 s60, 0
    s_cbranch_scc1 WQ_1
    s_mov_b32 s48, s22
    s_and_b32 s49, s23, 0xffff
    s_mov_b32 s50, 0x400000
    s_mov_b32 s51, 0x20000
    s_mov_b32 m0, s64
    s_add_u32 s64, s64, 1024
    buffer_load_dwordx4 v10, s[48:51], s63 offen nt lds
    s_add_u32 s63, s63, 131072
    s_mov_b32 m0, s64
    s_add_u32 s64, s64, 1024
    buffer_load_dwordx4 v10, s[48:51], s63 offen nt lds
    s_add_u32 s63, s63, 131072
    s_mov_b32 m0, s64
    s_add_u32 s64, s64, 1024
    buffer_load_dwordx4 v10, s[48:51], s63 offen nt lds
    s_add_u32 s63, s63, 131072
    s_mov_b32 m0, s64
    s_add_u32 s64, s64, 1024
    buffer_load_dwordx4 v10, s[48:51], s63 offen nt lds
    s_add_u32 s63, s63, 131072
    s_mov_b32 s44, s18
    s_and_b32 s45, s19, 0xffff
    s_mov_b32 s46, 0x1000
    s_mov_b32 s47, 0x20000
    buffer_load_dwordx2 v[128:129], v9, s[44:47], s62 offen offset:0
    buffer_load_dwordx2 v[130:131], v9, s[44:47], s62 offen offset:32
    buffer_load_dwordx2 v[132:133], v9, s[44:47], s62 offen offset:64
    buffer_load_dwordx2 v[134:135], v9, s[44:47], s62 offen offset:96
    s_barrier
    s_mov_b32 s36, s34
    s_and_b32 s37, s35, 0xffff
    s_mov_b32 s38, 0x1000000
    s_mov_b32 s39, 0x20000
    s_lshl_b32 s7, s4, 3
    s_add_u32 s7, s7, s5
    s_lshl_b32 s7, s7, 4
    s_add_u32 s7, s7, s61
    s_lshl_b32 s7, s7, 7
    s_add_u32 s7, s7, 0x180000
    v_lshl_add_u32 v10, v1, 9, s7
    v_mov_b32 v16, 0
    s_mov_b64 exec, 15
    buffer_store_dword v16, v10, s[36:39], 0 offen
    buffer_load_dword v16, v10, s[36:39], 0 offen sc1 nt
    s_mov_b64 exec, -1
    s_branch WR_2
WQ_1:
    v_lshlrev_b32 v10, 2, v0
    v_mov_b32 v24, 0
    v_add_u32 v10, 0x23c00, v10
    ds_write_b32 v10, v24
    s_mov_b32 s40, s32
    s_and_b32 s41, s33, 0xffff
    s_mov_b32 s42, 0x100
    s_mov_b32 s43, 0x20000
    s_or_b32 s7, s6, s2
    s_cbranch_scc1 NC_3
    s_lshl_b64 s[92:93], s[94:95], 5
    s_or_b32 s93, s93, 0x80000000
    v_mov_b32 v12, s92
    v_mov_b32 v13, s93
    s_mov_b64 exec, 1
    buffer_store_dwordx2 v[12:13], v24, s[40:43], 0 offen sc1
    s_mov_b64 exec, -1
NC_3:
    s_waitcnt lgkmcnt(0)
    s_mov_b32 s44, s8
    s_and_b32 s45, s9, 0xffff
    s_mov_b32 s46, 0x1000
    s_mov_b32 s47, 0x20000
    s_mov_b32 s36, s34
    s_and_b32 s37, s35, 0xffff
    s_mov_b32 s38, 0x1000000
    s_mov_b32 s39, 0x20000
    s_cmp_eq_u32 s77, 0
    s_cbranch_scc1 NQ_5
    s_lshl_b32 s7, s4, 2
    s_add_u32 s7, s7, s5
    s_lshl_b32 s7, s7, 8
    v_lshl_add_u32 v10, v3, 4, s7
    v_lshl_add_u32 v10, v2, 15, v10
    v_mov_b32 v28, -1
    v_mov_b32 v29, -1
    v_mov_b32 v30, -1
    v_mov_b32 v31, -1
    buffer_store_dwordx4 v[28:31], v10, s[36:39], 0 offen sc1
NQ_5:
    buffer_load_dwordx2 v[128:129], v9, s[44:47], s62 offen offset:0
    buffer_load_dwordx2 v[130:131], v9, s[44:47], s62 offen offset:32
    buffer_load_dwordx2 v[132:133], v9, s[44:47], s62 offen offset:64
    buffer_load_dwordx2 v[134:135], v9, s[44:47], s62 offen offset:96
    s_cmp_eq_u32 s76, 0
    s_cbranch_scc1 NX_6
    buffer_load_dwordx2 v[136:137], v9, s[44:47], s62 offen offset:128
    buffer_load_dwordx2 v[138:139], v9, s[44:47], s62 offen offset:160
    buffer_load_dwordx2 v[140:141], v9, s[44:47], s62 offen offset:192
    buffer_load_dwordx2 v[142:143], v9, s[44:47], s62 offen offset:224
NX_6:
    s_barrier
    s_cmp_lg_u32 s6, 0
    s_cbranch_scc1 NP_7
    s_mov_b32 s80, 800000
    s_sleep 4
NL_8:
    s_mov_b64 exec, 1
    buffer_load_dwordx2 v[12:13], v24, s[40:43], 0 offen sc1
    s_mov_b64 exec, -1
    s_waitcnt vmcnt(0)
    v_readfirstlane_b32 s92, v12
    v_readfirstlane_b32 s93, v13
    s_sub_u32 s80, s80, 1
    s_cbranch_scc1 NH_9
    s_cmp_eq_u32 s93, 0
    s_cbranch_scc1 NL_8
NH_9:
    v_mov_b32 v11, 0x24248
    v_mov_b32 v12, s92
    v_mov_b32 v13, s93
    ds_write_b64 v11, v[12:13]
    v_mov_b32 v11, 0x24204
    v_mov_b32 v14, 1
    s_mov_b64 exec, 1
    ds_add_u32 v11, v14
    s_mov_b64 exec, -1
    s_cmp_lt_u32 s5, 6
    s_cbranch_scc1 NP_7
    s_and_b32 s64, s4, 7
    s_lshl_b32 s64, s64, 3
    s_lshr_b32 s7, s4, 3
    s_lshl_b32 s7, s7, 1
    s_add_u32 s64, s64, s7
    s_add_u32 s64, s64, s5
    s_sub_u32 s64, s64, 6
    s_lshr_b32 s7, s64, 3
    s_lshl_b32 s7, s7, 7
    s_and_b32 s64, s64, 7
    s_lshl_b32 s64, s64, 3
    s_add_u32 s7, s7, s64
    s_add_u32 s7, s7, 0x22000
    v_mov_b32 v11, s7
    v_or_b32 v12, s78, v12
    s_mov_b64 exec, 1
    buffer_store_dwordx2 v[12:13], v11, s[36:39], 0 offen sc1
    s_mov_b64 exec, -1
NP_7:
    s_cmp_ge_u32 s5, 6
    s_cbranch_scc1 L_BATT
    s_cmp_eq_u32 s77, 0
    s_cbranch_scc1 WR_2
    s_lshl_b32 s7, s4, 2
    s_add_u32 s7, s7, s5
    s_lshl_b32 s7, s7, 3
    s_add_u32 s7, s7, 0x20000
    v_mov_b32 v11, s7
    s_waitcnt vmcnt(0)
    v_mov_b32 v12, 0x2421c
    v_mov_b32 v13, 1
    s_mov_b64 exec, 1
    ds_add_u32 v12, v13
    s_mov_b64 exec, -1
    v_mov_b32 v12, 0x24204
    s_mov_b32 s80, 1600000
LW_10:
    ds_read_b32 v13, v12
    s_waitcnt lgkmcnt(0)
    v_readfirstlane_b32 s79, v13
    s_cmp_ge_u32 s79, 1
    s_cbranch_scc1 LWD_11
    s_sleep 1
    s_sub_u32 s80, s80, 1
    s_cmp_lg_u32 s80, 0
    s_cbranch_scc1 LW_10
LWD_11:
    v_mov_b32 v12, 0x24248
    ds_read_b64 v[14:15], v12
    s_waitcnt lgkmcnt(0)
    v_readfirstlane_b32 s92, v14
    v_readfirstlane_b32 s93, v15
    s_mov_b64 exec, 1
    buffer_store_dwordx2 v[14:15], v11, s[36:39], 0 offen sc1
    s_mov_b64 exec, -1
WR_2:
    v_lshlrev_b32 v5, 15, v8
    v_lshl_add_u32 v5, v2, 3, v5
    v_lshrrev_b32 v10, 2, v3
    v_lshl_add_u32 v5, v10, 5, v5
    s_lshl_b32 s7, s4, 2
    s_add_u32 s7, s7, s5
    s_lshl_b32 s7, s7, 1
    s_add_u32 s7, s7, s61
    s_lshl_b32 s7, s7, 7
    v_add_u32 v5, s7, v5
    s_lshl_b32 s75, s78, 26
    s_or_b32 s95, s95, s75
    s_add_u32 s72, s94, 0x10000
    s_addc_u32 s73, s95, 0
    s_mov_b32 s96, 0x6010600
    s_mov_b32 s97, 0x5030502
    s_cmp_eq_u32 s5, 1
    s_cselect_b32 s96, 0x6170616, s96
    s_cselect_b32 s97, 0x5190518, s97
    s_cmp_eq_u32 s5, 2
    s_cselect_b32 s96, 0x62d062c, s96
    s_cselect_b32 s97, 0x52f052e, s97
    s_cmp_eq_u32 s5, 3
    s_cselect_b32 s96, 0x6430642, s96
    s_cselect_b32 s97, 0x5450544, s97
    s_cmp_eq_u32 s5, 4
    s_cselect_b32 s96, 0x5590558, s96
    s_cselect_b32 s97, 0x55b055a, s97
    s_cmp_eq_u32 s5, 5
    s_cselect_b32 s96, 0x56d056c, s96
    s_cselect_b32 s97, 0x56f056e, s97
    v_lshrrev_b32 v10, 2, v1
    v_and_b32 v11, 7, v10
    s_lshl_b32 s7, s61, 1
    v_xor_b32 v11, s7, v11
    v_lshlrev_b32 v10, 8, v10
    v_lshl_add_u32 v10, v11, 5, v10
    v_lshl_add_u32 v10, v8, 3, v10
    s_cmp_lt_u32 s5, 4
    s_cselect_b32 s65, 48, 32
    s_cmp_eq_u32 s60, 0
    s_cselect_b32 s64, 8, 0
    v_add_u32 v10, 0x20000, v10
    v_xor_b32 v11, 32, v10
    s_add_u32 s64, s64, 0x24138
    s_lshl_b32 s7, s60, 5
    s_add_u32 s7, s7, s4
    s_lshl_b32 s63, s7, 14
    s_add_u32 s63, s63, 0x100000
    s_lshl_b32 s7, s5, 11
    s_lshl_b32 s62, s61, 7
    s_add_u32 s7, s7, s62
    s_add_u32 s7, s7, s63
    v_lshlrev_b32 v4, 9, v8
    v_lshl_add_u32 v4, v2, 4, v4
    v_and_b32 v12, 4, v1
    v_lshl_add_u32 v4, v12, 4, v4
    v_add_u32 v4, s7, v4
    v_cmp_gt_u32 s[84:85], 8, v3
    s_lshl_b32 s7, s61, 4
    s_lshr_b64 s[90:91], s[96:97], s7
    s_and_b32 s66, s90, 3
    s_bfe_u32 s67, s90, 0x50002
    s_bfe_u32 s68, s90, 0x40008
    s_cmp_eq_u32 s60, 1
    s_cselect_b32 s66, s61, s66
    s_lshl_b32 s7, s66, 9
    s_add_u32 s7, s7, s63
    v_and_b32 v12, 31, v1
    v_lshl_add_u32 v7, v12, 4, s7
    v_lshrrev_b32 v13, 5, v1
    v_lshl_add_u32 v7, v13, 11, v7
    s_lshl_b32 s7, s60, 2
    s_add_u32 s7, s7, s66
    s_mul_i32 s7, s7, 320
    s_add_u32 s63, s7, 0x24400
    v_lshl_add_u32 v6, v12, 3, s63
    s_mov_b32 s70, 0x3f80
    s_mov_b32 s71, 0x3f800000
    s_mov_b64 s[86:87], -1
    s_lshr_b32 s7, s5, 2
    s_and_b32 s7, s7, s60
    s_cselect_b32 s86, 1, s86
    s_cselect_b32 s87, 1, s87
    s_cmp_eq_u32 s60, 0
    s_cbranch_scc1 RA_12
    v_lshrrev_b32 v10, 2, v1
    v_lshlrev_b32 v10, 6, v10
    v_and_b32 v11, 1, v2
    v_lshl_add_u32 v10, v11, 5, v10
    v_lshl_add_u32 v10, v8, 3, v10
    s_lshl_b32 s7, s61, 12
    s_add_u32 s7, s7, 0x1c000
    v_add_u32 v10, s7, v10
    v_xor_b32 v11, 32, v10
    s_waitcnt vmcnt(2)
    ds_read_b64_tr_b16 v[32:33], v10 offset:0
    ds_read_b64_tr_b16 v[34:35], v10 offset:1024
    ds_read_b64_tr_b16 v[36:37], v11 offset:0
    ds_read_b64_tr_b16 v[38:39], v11 offset:1024
    ds_read_b64_tr_b16 v[40:41], v10 offset:2048
    ds_read_b64_tr_b16 v[42:43], v10 offset:3072
    ds_read_b64_tr_b16 v[44:45], v11 offset:2048
    ds_read_b64_tr_b16 v[46:47], v11 offset:3072
RB_13:
    v_lshl_add_u32 v12, v1, 2, s64
    v_mov_b32 v13, 1
    s_mov_b64 exec, 3
    ds_add_u32 v12, v13
    s_mov_b64 exec, -1
    s_memrealtime s[88:89]
    s_waitcnt lgkmcnt(0)
    v_mfma_f32_16x16x32_bf16 v[24:27], v[32:35], v[128:131], 0
    v_mfma_f32_16x16x32_bf16 v[28:31], v[36:39], v[128:131], 0
    v_mfma_f32_16x16x32_bf16 v[24:27], v[40:43], v[132:135], v[24:27]
    v_mfma_f32_16x16x32_bf16 v[28:31], v[44:47], v[132:135], v[28:31]
    s_cmp_lg_u32 s76, 0
    s_cbranch_scc1 E2_14
E3_15:
    s_or_b32 s89, s89, s75
    s_mov_b32 s101, 1
    s_cmp_eq_u32 s60, 1
    s_cbranch_scc1 VD_16
    v_mov_b32 v10, 0x24208
    s_mov_b32 s80, 1600000
LW_17:
    ds_read_b32 v11, v10
    s_waitcnt lgkmcnt(0)
    v_readfirstlane_b32 s79, v11
    s_cmp_ge_u32 s79, 64
    s_cbranch_scc1 LWD_18
    s_sleep 1
    s_sub_u32 s80, s80, 1
    s_cmp_lg_u32 s80, 0
    s_cbranch_scc1 LW_17
LWD_18:
    s_and_b32 s101, s79, 15
    v_mov_b32 v12, 0x24204
    s_mov_b32 s80, 1600000
LW_19:
    ds_read_b32 v13, v12
    s_waitcnt lgkmcnt(0)
    v_readfirstlane_b32 s79, v13
    s_cmp_ge_u32 s79, 1
    s_cbranch_scc1 LWD_20
    s_sleep 1
    s_sub_u32 s80, s80, 1
    s_cmp_lg_u32 s80, 0
    s_cbranch_scc1 LW_19
LWD_20:
    v_mov_b32 v12, 0x24248
    ds_read_b64 v[14:15], v12
    s_waitcnt lgkmcnt(0)
    v_readfirstlane_b32 s92, v14
    v_readfirstlane_b32 s93, v15
    s_mov_b64 s[88:89], s[92:93]
    s_mov_b64 s[94:95], s[92:93]
    s_or_b64 s[72:73], s[92:93], 1
VD_16:
    s_nop 2
    v_cvt_pk_bf16_f32 v40, v24, v25
    v_cvt_pk_bf16_f32 v41, v26, v27
    v_cvt_pk_bf16_f32 v44, v28, v29
    v_cvt_pk_bf16_f32 v45, v30, v31
    v_mov_b32 v42, s88
    v_mov_b32 v43, s89
    v_mov_b32_dpp v40, v44 quad_perm:[0,1,2,3] row_mask:0xf bank_mask:0x2
    v_mov_b32_dpp v41, v45 quad_perm:[0,1,2,3] row_mask:0xf bank_mask:0x2
    s_mov_b64 exec, s[84:85]
    s_cmp_eq_u32 s101, 0
    s_cbranch_scc1 SU_21
    buffer_store_dwordx4 v[40:43], v4, s[36:39], 0 offen
SV_22:
    s_mov_b64 exec, -1
    v_mov_b32 v12, 0x24200
    v_mov_b32 v13, 1
    s_mov_b64 exec, 1
    ds_add_u32 v12, v13
    s_mov_b64 exec, -1
    s_sleep 4
    s_cmp_eq_u32 s60, 1
    s_cbranch_scc1 GDL_23
    s_sleep 16
GDL_23:
    v_add_u32 v9, 8192, v7
    s_mov_b32 s62, 4096
    s_lshl_b32 s76, s60, 12
    s_mov_b32 s64, 17
    s_mov_b64 exec, s[86:87]
    buffer_load_dwordx4 v[48:51], v7, s[36:39], 0 offen sc1 nt
    buffer_load_dwordx4 v[52:55], v7, s[36:39], s62 offen sc1 nt
    buffer_load_dwordx4 v[56:59], v9, s[36:39], 0 offen sc1 nt
    buffer_load_dwordx4 v[60:63], v9, s[36:39], s76 offen sc1 nt
    s_mov_b32 s80, 200000
MC_26:
    s_mov_b64 exec, s[86:87]
    s_waitcnt vmcnt(0)
    v_cmp_gt_u64 s[44:45], s[94:95], v[50:51]
    v_cmp_le_u64 vcc, s[72:73], v[50:51]
    s_or_b64 s[44:45], s[44:45], vcc
    v_cmp_gt_u64 s[46:47], s[94:95], v[54:55]
    v_cmp_le_u64 vcc, s[72:73], v[54:55]
    s_or_b64 s[46:47], s[46:47], vcc
    v_cmp_gt_u64 s[48:49], s[94:95], v[58:59]
    v_cmp_le_u64 vcc, s[72:73], v[58:59]
    s_or_b64 s[48:49], s[48:49], vcc
    v_cmp_gt_u64 s[50:51], s[94:95], v[62:63]
    v_cmp_le_u64 vcc, s[72:73], v[62:63]
    s_or_b64 s[50:51], s[50:51], vcc
    s_or_b64 s[90:91], s[44:45], s[46:47]
    s_or_b64 s[90:91], s[90:91], s[48:49]
    s_or_b64 s[90:91], s[90:91], s[50:51]
    s_cbranch_scc1 M_25
MD_27:
    s_mov_b64 exec, -1
    s_cmp_eq_u32 s86, 1
    s_cbranch_scc1 QS_28
    v_dot2_f32_bf16 v24, v48, s70, 0
    v_dot2_f32_bf16 v25, v48, s71, 0
    v_dot2_f32_bf16 v26, v49, s70, 0
    v_dot2_f32_bf16 v27, v49, s71, 0
    v_dot2_f32_bf16 v24, v52, s70, v24
    v_dot2_f32_bf16 v25, v52, s71, v25
    v_dot2_f32_bf16 v26, v53, s70, v26
    v_dot2_f32_bf16 v27, v53, s71, v27
    v_dot2_f32_bf16 v24, v56, s70, v24
    v_dot2_f32_bf16 v25, v56, s71, v25
    v_dot2_f32_bf16 v26, v57, s70, v26
    v_dot2_f32_bf16 v27, v57, s71, v27
    s_mul_i32 s70, s70, s60
    s_mul_i32 s71, s71, s60
    v_dot2_f32_bf16 v24, v60, s70, v24
    v_dot2_f32_bf16 v25, v60, s71, v25
    v_dot2_f32_bf16 v26, v61, s70, v26
    v_dot2_f32_bf16 v27, v61, s71, v27
    s_nop 1
    v_permlane32_swap_b32 v24, v26
    v_permlane32_swap_b32 v25, v27
    v_lshrrev_b32 v28, 5, v1
    v_add_f32 v24, v24, v26
    v_add_f32 v25, v25, v27
    v_lshl_add_u32 v6, v28, 2, v6
    v_cvt_pk_bf16_f32 v24, v24, v25
    ds_write_b32 v6, v24
    s_cmp_eq_u32 s60, 0
    s_cbranch_scc1 L_AATT
QS_28:
    v_mov_b32 v48, 0x24208
    v_mov_b32 v49, s64
    s_mov_b64 exec, 1
    ds_add_u32 v48, v49
    s_mov_b64 exec, -1
    s_cmp_lg_u32 s64, 17
    s_cbranch_scc1 RT_29
    s_memrealtime s[88:89]
    s_waitcnt lgkmcnt(0)
    s_or_b32 s89, s89, s75
    v_mov_b32 v42, s88
    v_mov_b32 v43, s89
    s_mov_b64 exec, s[84:85]
    buffer_store_dwordx4 v[40:43], v4, s[36:39], 0 offen
    s_mov_b64 exec, -1
RT_29:
    s_cmp_ge_u32 s5, 6
    s_cbranch_scc1 L_BATT
    s_cmp_ge_u32 s5, 4
    s_cbranch_scc1 L_ESVC
    s_cmp_eq_u32 s74, 0
    s_cbranch_scc1 L_ASVC
    v_xor_b32 v10, v3, v2
    v_lshlrev_b32 v10, 4, v10
    v_lshl_add_u32 v10, v3, 8, v10
    s_lshl_b32 s7, s61, 14
    s_add_u32 s7, s7, 0x14000
    v_add_u32 v10, s7, v10
    s_lshl_b32 s65, s61, 4
    s_add_u32 s65, s65, 16
    s_lshl_b32 s64, s61, 3
    s_add_u32 s64, s64, 0x24128
    v_mov_b32 v12, 0x24000
    s_mov_b32 s80, 1600000
LW_30:
    ds_read_b32 v13, v12
    s_waitcnt lgkmcnt(0)
    v_readfirstlane_b32 s79, v13
    s_cmp_ge_u32 s79, s65
    s_cbranch_scc1 LWD_31
    s_sub_u32 s80, s80, 1
    s_cmp_lg_u32 s80, 0
    s_cbranch_scc1 LW_30
LWD_31:
    v_xor_b32 v11, 0x0, v10
    ds_read_b128 v[64:67], v11 offset:0
    ds_read_b128 v[80:83], v11 offset:4096
    ds_read_b128 v[96:99], v11 offset:8192
    ds_read_b128 v[112:115], v11 offset:12288
    v_xor_b32 v11, 0x40, v10
    ds_read_b128 v[68:71], v11 offset:0
    ds_read_b128 v[84:87], v11 offset:4096
    ds_read_b128 v[100:103], v11 offset:8192
    ds_read_b128 v[116:119], v11 offset:12288
    v_xor_b32 v11, 0x80, v10
    ds_read_b128 v[72:75], v11 offset:0
    ds_read_b128 v[88:91], v11 offset:4096
    ds_read_b128 v[104:107], v11 offset:8192
    ds_read_b128 v[120:123], v11 offset:12288
    v_xor_b32 v11, 0xc0, v10
    ds_read_b128 v[76:79], v11 offset:0
    ds_read_b128 v[92:95], v11 offset:4096
    ds_read_b128 v[108:111], v11 offset:8192
    ds_read_b128 v[124:127], v11 offset:12288
    v_lshl_add_u32 v12, v1, 2, s64
    v_mov_b32 v13, 4
    s_mov_b64 exec, 3
    ds_add_u32 v12, v13
    s_mov_b64 exec, -1
    v_mov_b32 v12, 0x2421c
    s_mov_b32 s80, 1600000
LW_32:
    ds_read_b32 v13, v12
    s_waitcnt lgkmcnt(0)
    v_readfirstlane_b32 s79, v13
    s_cmp_ge_u32 s79, 1
    s_cbranch_scc1 LWD_33
    s_sub_u32 s80, s80, 1
    s_cmp_lg_u32 s80, 0
    s_cbranch_scc1 LW_32
LWD_33:
    v_mul_u32_u24 v10, 320, v8
    v_lshl_add_u32 v10, v2, 4, v10
    v_add_u32 v10, 0x24900, v10
    v_mov_b32 v12, 0x24208
    s_mov_b32 s80, 1600000
LW_34:
    ds_read_b32 v13, v12
    s_waitcnt lgkmcnt(0)
    v_readfirstlane_b32 s79, v13
    s_cmp_ge_u32 s79, 64
    s_cbranch_scc1 LWD_35
    s_sub_u32 s80, s80, 1
    s_cmp_lg_u32 s80, 0
    s_cbranch_scc1 LW_34
LWD_35:
    ds_read_b128 v[48:51], v10 offset:0
    ds_read_b128 v[52:55], v10 offset:64
    ds_read_b128 v[56:59], v10 offset:128
    ds_read_b128 v[60:63], v10 offset:192
    s_waitcnt lgkmcnt(3)
    v_mfma_f32_16x16x32_bf16 v[128:131], v[64:67], v[48:51], 0
    v_mfma_f32_16x16x32_bf16 v[132:135], v[80:83], v[48:51], 0
    v_mfma_f32_16x16x32_bf16 v[136:139], v[96:99], v[48:51], 0
    v_mfma_f32_16x16x32_bf16 v[140:143], v[112:115], v[48:51], 0
    s_waitcnt lgkmcnt(2)
    v_mfma_f32_16x16x32_bf16 v[128:131], v[68:71], v[52:55], v[128:131]
    v_mfma_f32_16x16x32_bf16 v[132:135], v[84:87], v[52:55], v[132:135]
    v_mfma_f32_16x16x32_bf16 v[136:139], v[100:103], v[52:55], v[136:139]
    v_mfma_f32_16x16x32_bf16 v[140:143], v[116:119], v[52:55], v[140:143]
    s_waitcnt lgkmcnt(1)
    v_mfma_f32_16x16x32_bf16 v[128:131], v[72:75], v[56:59], v[128:131]
    v_mfma_f32_16x16x32_bf16 v[132:135], v[88:91], v[56:59], v[132:135]
    v_mfma_f32_16x16x32_bf16 v[136:139], v[104:107], v[56:59], v[136:139]
    v_mfma_f32_16x16x32_bf16 v[140:143], v[120:123], v[56:59], v[140:143]
    s_waitcnt lgkmcnt(0)
    v_mfma_f32_16x16x32_bf16 v[128:131], v[76:79], v[60:63], v[128:131]
    v_mfma_f32_16x16x32_bf16 v[132:135], v[92:95], v[60:63], v[132:135]
    v_mfma_f32_16x16x32_bf16 v[136:139], v[108:111], v[60:63], v[136:139]
    v_mfma_f32_16x16x32_bf16 v[140:143], v[124:127], v[60:63], v[140:143]
    s_nop 4
    v_cvt_pk_bf16_f32 v24, v128, v129
    v_cvt_pk_bf16_f32 v25, v130, v131
    v_cvt_pk_bf16_f32 v26, v132, v133
    v_cvt_pk_bf16_f32 v27, v134, v135
    v_cvt_pk_bf16_f32 v28, v136, v137
    v_cvt_pk_bf16_f32 v29, v138, v139
    v_cvt_pk_bf16_f32 v30, v140, v141
    v_cvt_pk_bf16_f32 v31, v142, v143
    v_mov_b32_dpp v24, v26 quad_perm:[0,1,2,3] row_mask:0xf bank_mask:0x2
    v_mov_b32_dpp v25, v27 quad_perm:[0,1,2,3] row_mask:0xf bank_mask:0x2
    v_mov_b32_dpp v24, v28 quad_perm:[0,1,2,3] row_mask:0xf bank_mask:0x4
    v_mov_b32_dpp v25, v29 quad_perm:[0,1,2,3] row_mask:0xf bank_mask:0x4
    v_mov_b32_dpp v24, v30 quad_perm:[0,1,2,3] row_mask:0xf bank_mask:0x8
    v_mov_b32_dpp v25, v31 quad_perm:[0,1,2,3] row_mask:0xf bank_mask:0x8
    buffer_store_dwordx2 v[24:25], v5, s[36:39], 0 offen sc1
    s_branch L_ASVC
L_LDA:
    s_setprio 3
    s_lshl_b32 s65, s5, 19
    s_lshl_b32 s7, s4, 8
    s_add_u32 s67, s65, s7
    s_add_u32 s65, s65, s67
    v_xor_b32 v6, v3, v2
    v_lshlrev_b32 v6, 4, v6
    v_lshl_add_u32 v6, v2, 13, v6
    v_xor_b32 v7, 0x40, v6
    v_xor_b32 v8, 0x80, v6
    v_xor_b32 v9, 0xc0, v6
    s_mov_b32 s64, 0x14000
    s_waitcnt lgkmcnt(0)
    s_mov_b32 s48, s24
    s_and_b32 s49, s25, 0xffff
    s_mov_b32 s50, 0x400000
    s_mov_b32 s51, 0x20000
    s_barrier
    v_mov_b32 v40, 0x24200
    s_mov_b32 s80, 1600000
LW_36:
    ds_read_b32 v41, v40
    s_waitcnt lgkmcnt(0)
    v_readfirstlane_b32 s79, v41
    s_cmp_ge_u32 s79, 4
    s_cbranch_scc1 LWD_37
    s_sub_u32 s80, s80, 1
    s_cmp_lg_u32 s80, 0
    s_cbranch_scc1 LW_36
LWD_37:
    s_mov_b32 m0, s64
    s_add_u32 s64, s64, 1024
    buffer_load_dwordx4 v6, s[48:51], s65 offen nt lds
    s_add_u32 s65, s65, 32768
    s_mov_b32 m0, s64
    s_add_u32 s64, s64, 1024
    buffer_load_dwordx4 v7, s[48:51], s65 offen nt lds
    s_add_u32 s65, s65, 32768
    s_mov_b32 m0, s64
    s_add_u32 s64, s64, 1024
    buffer_load_dwordx4 v8, s[48:51], s65 offen nt lds
    s_add_u32 s65, s65, 32768
    s_mov_b32 m0, s64
    s_add_u32 s64, s64, 1024
    buffer_load_dwordx4 v9, s[48:51], s65 offen nt lds
    s_add_u32 s65, s65, 32768
    s_mov_b32 m0, s64
    s_add_u32 s64, s64, 1024
    buffer_load_dwordx4 v6, s[48:51], s65 offen nt lds
    s_add_u32 s65, s65, 32768
    s_mov_b32 m0, s64
    s_add_u32 s64, s64, 1024
    buffer_load_dwordx4 v7, s[48:51], s65 offen nt lds
    s_add_u32 s65, s65, 32768
    s_mov_b32 m0, s64
    s_add_u32 s64, s64, 1024
    buffer_load_dwordx4 v8, s[48:51], s65 offen nt lds
    s_add_u32 s65, s65, 32768
    s_mov_b32 m0, s64
    s_add_u32 s64, s64, 1024
    buffer_load_dwordx4 v9, s[48:51], s65 offen nt lds
    s_add_u32 s65, s65, 32768
    s_mov_b32 m0, s64
    s_add_u32 s64, s64, 1024
    buffer_load_dwordx4 v6, s[48:51], s65 offen nt lds
    s_add_u32 s65, s65, 32768
    s_mov_b32 m0, s64
    s_add_u32 s64, s64, 1024
    buffer_load_dwordx4 v7, s[48:51], s65 offen nt lds
    s_add_u32 s65, s65, 32768
    s_mov_b32 m0, s64
    s_add_u32 s64, s64, 1024
    buffer_load_dwordx4 v8, s[48:51], s65 offen nt lds
    s_add_u32 s65, s65, 32768
    s_mov_b32 m0, s64
    s_add_u32 s64, s64, 1024
    buffer_load_dwordx4 v9, s[48:51], s65 offen nt lds
    s_add_u32 s65, s65, 32768
    s_mov_b32 m0, s64
    s_add_u32 s64, s64, 1024
    buffer_load_dwordx4 v6, s[48:51], s65 offen nt lds
    s_add_u32 s65, s65, 32768
    s_mov_b32 m0, s64
    s_add_u32 s64, s64, 1024
    buffer_load_dwordx4 v7, s[48:51], s65 offen nt lds
    s_add_u32 s65, s65, 32768
    s_mov_b32 m0, s64
    s_add_u32 s64, s64, 1024
    buffer_load_dwordx4 v8, s[48:51], s65 offen nt lds
    s_add_u32 s65, s65, 32768
    s_mov_b32 m0, s64
    s_add_u32 s64, s64, 1024
    buffer_load_dwordx4 v9, s[48:51], s65 offen nt lds
    s_add_u32 s65, s65, 32768
    s_mov_b32 m0, s64
    s_add_u32 s64, s64, 1024
    buffer_load_dwordx4 v6, s[48:51], s65 offen nt lds
    s_add_u32 s65, s65, 32768
    s_mov_b32 m0, s64
    s_add_u32 s64, s64, 1024
    buffer_load_dwordx4 v7, s[48:51], s65 offen nt lds
    s_add_u32 s65, s65, 32768
    s_mov_b32 m0, s64
    s_add_u32 s64, s64, 1024
    buffer_load_dwordx4 v8, s[48:51], s65 offen nt lds
    s_add_u32 s65, s65, 32768
    s_mov_b32 m0, s64
    s_add_u32 s64, s64, 1024
    buffer_load_dwordx4 v9, s[48:51], s65 offen nt lds
    s_add_u32 s65, s65, 32768
    s_mov_b32 m0, s64
    s_add_u32 s64, s64, 1024
    buffer_load_dwordx4 v6, s[48:51], s65 offen nt lds
    s_add_u32 s65, s65, 32768
    s_mov_b32 m0, s64
    s_add_u32 s64, s64, 1024
    buffer_load_dwordx4 v7, s[48:51], s65 offen nt lds
    s_add_u32 s65, s65, 32768
    s_mov_b32 m0, s64
    s_add_u32 s64, s64, 1024
    buffer_load_dwordx4 v8, s[48:51], s65 offen nt lds
    s_add_u32 s65, s65, 32768
    s_mov_b32 m0, s64
    s_add_u32 s64, s64, 1024
    buffer_load_dwordx4 v9, s[48:51], s65 offen nt lds
    s_add_u32 s65, s65, 32768
    s_mov_b32 m0, s64
    s_add_u32 s64, s64, 1024
    buffer_load_dwordx4 v6, s[48:51], s65 offen nt lds
    s_add_u32 s65, s65, 32768
    s_mov_b32 m0, s64
    s_add_u32 s64, s64, 1024
    buffer_load_dwordx4 v7, s[48:51], s65 offen nt lds
    s_add_u32 s65, s65, 32768
    s_mov_b32 m0, s64
    s_add_u32 s64, s64, 1024
    buffer_load_dwordx4 v8, s[48:51], s65 offen nt lds
    s_add_u32 s65, s65, 32768
    s_mov_b32 m0, s64
    s_add_u32 s64, s64, 1024
    buffer_load_dwordx4 v9, s[48:51], s65 offen nt lds
    s_add_u32 s65, s65, 32768
    s_mov_b32 m0, s64
    s_add_u32 s64, s64, 1024
    buffer_load_dwordx4 v6, s[48:51], s65 offen nt lds
    s_add_u32 s65, s65, 32768
    s_mov_b32 m0, s64
    s_add_u32 s64, s64, 1024
    buffer_load_dwordx4 v7, s[48:51], s65 offen nt lds
    s_add_u32 s65, s65, 32768
    s_mov_b32 m0, s64
    s_add_u32 s64, s64, 1024
    buffer_load_dwordx4 v8, s[48:51], s65 offen nt lds
    s_add_u32 s65, s65, 32768
    s_mov_b32 m0, s64
    s_add_u32 s64, s64, 1024
    buffer_load_dwordx4 v9, s[48:51], s65 offen nt lds
    s_add_u32 s65, s65, 32768
    s_mov_b32 s61, 0
    s_mov_b32 s63, 0
    v_lshlrev_b32 v16, 2, v1
    v_add_u32 v17, 0x24100, v16
    v_add_u32 v16, 0x24000, v16
    v_mov_b32 v18, 0
    s_mov_b32 s60, 32
    s_mov_b32 s36, s34
    s_and_b32 s37, s35, 0xffff
    s_mov_b32 s38, 0x1000000
    s_mov_b32 s39, 0x20000
    v_lshrrev_b32 v4, 1, v3
    v_xor_b32 v4, v4, v2
    v_lshlrev_b32 v4, 5, v4
    v_lshl_add_u32 v4, v2, 13, v4
    v_and_b32 v40, 1, v1
    v_lshl_add_u32 v4, v40, 4, v4
    v_xor_b32 v5, 0x80, v4
    s_mov_b32 s52, s14
    s_and_b32 s53, s15, 0xffff
    s_mov_b32 s54, 0x400000
    s_mov_b32 s55, 0x20000
    s_mov_b32 s96, 0x6010600
    s_mov_b32 s97, 0x5030502
    s_cmp_eq_u32 s5, 1
    s_cselect_b32 s96, 0x6170616, s96
    s_cselect_b32 s97, 0x5190518, s97
    s_cmp_eq_u32 s5, 2
    s_cselect_b32 s96, 0x62d062c, s96
    s_cselect_b32 s97, 0x52f052e, s97
    s_cmp_eq_u32 s5, 3
    s_cselect_b32 s96, 0x6430642, s96
    s_cselect_b32 s97, 0x5450544, s97
    s_cmp_eq_u32 s5, 4
    s_cselect_b32 s96, 0x5590558, s96
    s_cselect_b32 s97, 0x55b055a, s97
    s_cmp_eq_u32 s5, 5
    s_cselect_b32 s96, 0x56d056c, s96
    s_cselect_b32 s97, 0x56f056e, s97
    v_xor_b32 v10, v3, v2
    v_lshlrev_b32 v10, 4, v10
    v_lshl_add_u32 v10, v2, 8, v10
    v_xor_b32 v11, 0x40, v10
    v_xor_b32 v12, 0x80, v10
    v_xor_b32 v13, 0xc0, v10
    v_lshrrev_b32 v14, 1, v3
    v_xor_b32 v14, v14, v2
    v_lshlrev_b32 v14, 5, v14
    v_lshl_add_u32 v14, v2, 8, v14
    v_and_b32 v40, 1, v1
    v_lshl_add_u32 v14, v40, 4, v14
    v_xor_b32 v15, 0x80, v14
    s_mov_b32 s76, 0
    s_lshl_b32 s7, s76, 4
    s_lshr_b64 s[90:91], s[96:97], s7
    s_and_b32 s68, s90, 3
    s_bfe_u32 s72, s90, 0x50002
    s_lshl_b32 s68, s68, 5
    s_add_u32 s68, s68, s4
    s_lshl_b32 s68, s68, 20
    s_lshl_b32 s72, s72, 13
    s_add_u32 s72, s72, s68
    s_add_u32 s72, s72, 0xC0000
    s_mov_b32 s76, 1
    s_lshl_b32 s7, s76, 4
    s_lshr_b64 s[90:91], s[96:97], s7
    s_and_b32 s69, s90, 3
    s_bfe_u32 s73, s90, 0x50002
    s_lshl_b32 s69, s69, 5
    s_add_u32 s69, s69, s4
    s_lshl_b32 s69, s69, 20
    s_lshl_b32 s73, s73, 13
    s_add_u32 s73, s73, s69
    s_add_u32 s73, s73, 0xC0000
    s_mov_b32 s76, 2
    s_lshl_b32 s7, s76, 4
    s_lshr_b64 s[90:91], s[96:97], s7
    s_and_b32 s70, s90, 3
    s_bfe_u32 s74, s90, 0x50002
    s_lshl_b32 s70, s70, 5
    s_add_u32 s70, s70, s4
    s_lshl_b32 s70, s70, 20
    s_lshl_b32 s74, s74, 13
    s_add_u32 s74, s74, s70
    s_add_u32 s74, s74, 0xC0000
    s_mov_b32 s76, 3
    s_lshl_b32 s7, s76, 4
    s_lshr_b64 s[90:91], s[96:97], s7
    s_and_b32 s71, s90, 3
    s_bfe_u32 s75, s90, 0x50002
    s_lshl_b32 s71, s71, 5
    s_add_u32 s71, s71, s4
    s_lshl_b32 s71, s71, 20
    s_lshl_b32 s75, s75, 13
    s_add_u32 s75, s75, s71
    s_add_u32 s75, s75, 0xC0000
    v_lshrrev_b32 v20, 1, v3
    v_and_b32 v40, 1, v2
    v_xor_b32 v20, v20, v40
    v_lshlrev_b32 v20, 5, v20
    v_lshl_add_u32 v20, v2, 10, v20
    v_and_b32 v40, 1, v1
    v_lshl_add_u32 v20, v40, 4, v20
    v_xor_b32 v21, 0x40, v20
    v_xor_b32 v22, 0x80, v20
    v_xor_b32 v23, 0xc0, v20
    s_mov_b32 s56, s16
    s_and_b32 s57, s17, 0xffff
    s_mov_b32 s58, 0x400000
    s_mov_b32 s59, 0x20000
    s_waitcnt vmcnt(16)
    s_sub_u32 s7, s60, 16
    s_max_i32 s61, s61, s7
    v_mov_b32 v19, s61
    ds_write_b32 v16, v19
    s_mov_b32 s65, s67
    s_mov_b32 s64, 0x20000
    s_mov_b32 s66, 2
LL_38:
    s_waitcnt vmcnt(15)
    s_mov_b32 m0, s64
    s_add_u32 s64, s64, 1024
    buffer_load_dwordx4 v4, s[52:55], s65 offen nt lds
    s_add_u32 s65, s65, 32768
    s_waitcnt vmcnt(15)
    s_mov_b32 m0, s64
    s_add_u32 s64, s64, 1024
    buffer_load_dwordx4 v5, s[52:55], s65 offen nt lds
    s_add_u32 s65, s65, 32768
    s_waitcnt vmcnt(15)
    s_mov_b32 m0, s64
    s_add_u32 s64, s64, 1024
    buffer_load_dwordx4 v4, s[52:55], s65 offen nt lds
    s_add_u32 s65, s65, 32768
    s_waitcnt vmcnt(15)
    s_mov_b32 m0, s64
    s_add_u32 s64, s64, 1024
    buffer_load_dwordx4 v5, s[52:55], s65 offen nt lds
    s_add_u32 s65, s65, 32768
    s_waitcnt vmcnt(15)
    s_mov_b32 m0, s64
    s_add_u32 s64, s64, 1024
    buffer_load_dwordx4 v4, s[52:55], s65 offen nt lds
    s_add_u32 s65, s65, 32768
    s_waitcnt vmcnt(15)
    s_mov_b32 m0, s64
    s_add_u32 s64, s64, 1024
    buffer_load_dwordx4 v5, s[52:55], s65 offen nt lds
    s_add_u32 s65, s65, 32768
    s_waitcnt vmcnt(15)
    s_mov_b32 m0, s64
    s_add_u32 s64, s64, 1024
    buffer_load_dwordx4 v4, s[52:55], s65 offen nt lds
    s_add_u32 s65, s65, 32768
    s_waitcnt vmcnt(15)
    s_sub_u32 s7, s60, 8
    s_max_i32 s61, s61, s7
    v_mov_b32 v19, s61
    ds_write_b32 v16, v19
    s_mov_b32 m0, s64
    s_add_u32 s64, s64, 1024
    buffer_load_dwordx4 v5, s[52:55], s65 offen nt lds
    s_add_u32 s65, s65, 32768
    s_add_u32 s60, s60, 8
    s_sub_u32 s66, s66, 1
    s_cmp_lg_u32 s66, 0
    s_cbranch_scc1 LL_38
    s_lshl_b32 s65, s4, 17
    s_lshl_b32 s7, s5, 8
    s_add_u32 s65, s65, s7
    s_mov_b32 s64, 0
    s_mov_b32 s66, 2
LL_39:
    s_waitcnt vmcnt(15)
    s_mov_b32 m0, s64
    s_add_u32 s64, s64, 1024
    buffer_load_dwordx4 v20, s[56:59], s65 offen nt lds
    s_add_u32 s65, s65, 4096
    s_waitcnt vmcnt(15)
    s_mov_b32 m0, s64
    s_add_u32 s64, s64, 1024
    buffer_load_dwordx4 v20, s[56:59], s65 offen nt lds
    s_add_u32 s65, s65, 4096
    s_waitcnt vmcnt(15)
    s_mov_b32 m0, s64
    s_add_u32 s64, s64, 1024
    buffer_load_dwordx4 v20, s[56:59], s65 offen nt lds
    s_add_u32 s65, s65, 4096
    s_waitcnt vmcnt(15)
    s_mov_b32 m0, s64
    s_add_u32 s64, s64, 1024
    buffer_load_dwordx4 v20, s[56:59], s65 offen nt lds
    s_add_u32 s65, s65, 4096
    s_waitcnt vmcnt(15)
    s_mov_b32 m0, s64
    s_add_u32 s64, s64, 1024
    buffer_load_dwordx4 v21, s[56:59], s65 offen nt lds
    s_add_u32 s65, s65, 4096
    s_waitcnt vmcnt(15)
    s_mov_b32 m0, s64
    s_add_u32 s64, s64, 1024
    buffer_load_dwordx4 v21, s[56:59], s65 offen nt lds
    s_add_u32 s65, s65, 4096
    s_waitcnt vmcnt(15)
    s_mov_b32 m0, s64
    s_add_u32 s64, s64, 1024
    buffer_load_dwordx4 v21, s[56:59], s65 offen nt lds
    s_add_u32 s65, s65, 4096
    s_waitcnt vmcnt(15)
    s_sub_u32 s7, s60, 8
    s_max_i32 s61, s61, s7
    v_mov_b32 v19, s61
    ds_write_b32 v16, v19
    s_mov_b32 m0, s64
    s_add_u32 s64, s64, 1024
    buffer_load_dwordx4 v21, s[56:59], s65 offen nt lds
    s_add_u32 s65, s65, 4096
    s_waitcnt vmcnt(15)
    s_mov_b32 m0, s64
    s_add_u32 s64, s64, 1024
    buffer_load_dwordx4 v22, s[56:59], s65 offen nt lds
    s_add_u32 s65, s65, 4096
    s_waitcnt vmcnt(15)
    s_mov_b32 m0, s64
    s_add_u32 s64, s64, 1024
    buffer_load_dwordx4 v22, s[56:59], s65 offen nt lds
    s_add_u32 s65, s65, 4096
    s_waitcnt vmcnt(15)
    s_mov_b32 m0, s64
    s_add_u32 s64, s64, 1024
    buffer_load_dwordx4 v22, s[56:59], s65 offen nt lds
    s_add_u32 s65, s65, 4096
    s_waitcnt vmcnt(15)
    s_mov_b32 m0, s64
    s_add_u32 s64, s64, 1024
    buffer_load_dwordx4 v22, s[56:59], s65 offen nt lds
    s_add_u32 s65, s65, 4096
    s_waitcnt vmcnt(15)
    s_mov_b32 m0, s64
    s_add_u32 s64, s64, 1024
    buffer_load_dwordx4 v23, s[56:59], s65 offen nt lds
    s_add_u32 s65, s65, 4096
    s_waitcnt vmcnt(15)
    s_mov_b32 m0, s64
    s_add_u32 s64, s64, 1024
    buffer_load_dwordx4 v23, s[56:59], s65 offen nt lds
    s_add_u32 s65, s65, 4096
    s_waitcnt vmcnt(15)
    s_mov_b32 m0, s64
    s_add_u32 s64, s64, 1024
    buffer_load_dwordx4 v23, s[56:59], s65 offen nt lds
    s_add_u32 s65, s65, 4096
    s_waitcnt vmcnt(15)
    s_mov_b32 s61, s60
    v_mov_b32 v19, s61
    ds_write_b32 v16, v19
    s_mov_b32 m0, s64
    s_add_u32 s64, s64, 1024
    buffer_load_dwordx4 v23, s[56:59], s65 offen nt lds
    s_add_u32 s65, s65, 4096
    s_add_u32 s60, s60, 16
    s_sub_u32 s66, s66, 1
    s_cmp_lg_u32 s66, 0
    s_cbranch_scc1 LL_39
    s_mov_b32 s62, 4
    s_mov_b32 s44, s10
    s_and_b32 s45, s11, 0xffff
    s_mov_b32 s46, 0x8000000
    s_mov_b32 s47, 0x20000
    s_mov_b32 s48, s12
    s_and_b32 s49, s13, 0xffff
    s_mov_b32 s50, 0x8000000
    s_mov_b32 s51, 0x20000
    s_mov_b32 s68, s72
    s_mov_b32 s69, s73
    s_mov_b32 s70, s74
    s_mov_b32 s71, s75
    s_mov_b32 s66, 2
LL_40:
    s_waitcnt lgkmcnt(0)
    v_readlane_b32 s79, v18, s62
    s_cmp_lt_u32 s79, s63
    s_cbranch_scc1 ST_42
GO_41:
    s_waitcnt vmcnt(15)
    s_add_u32 s7, s64, 0
    s_mov_b32 m0, s7
    s_add_u32 s65, s68, 0
    buffer_load_dwordx4 v10, s[44:47], s65 offen offset:0 nt lds
    s_waitcnt vmcnt(15)
    buffer_load_dwordx4 v11, s[44:47], s65 offen offset:1024 nt lds
    s_waitcnt vmcnt(15)
    buffer_load_dwordx4 v12, s[44:47], s65 offen offset:2048 nt lds
    s_waitcnt vmcnt(15)
    buffer_load_dwordx4 v13, s[44:47], s65 offen offset:3072 nt lds
    s_waitcnt vmcnt(15)
    s_add_u32 s7, s64, 4096
    s_mov_b32 m0, s7
    s_add_u32 s65, s68, 4096
    buffer_load_dwordx4 v10, s[44:47], s65 offen offset:0 nt lds
    s_waitcnt vmcnt(15)
    buffer_load_dwordx4 v11, s[44:47], s65 offen offset:1024 nt lds
    ds_read_b32 v18, v17
    s_waitcnt vmcnt(15)
    buffer_load_dwordx4 v12, s[44:47], s65 offen offset:2048 nt lds
    s_waitcnt vmcnt(15)
    s_sub_u32 s7, s60, 8
    s_max_i32 s61, s61, s7
    v_mov_b32 v19, s61
    ds_write_b32 v16, v19
    buffer_load_dwordx4 v13, s[44:47], s65 offen offset:3072 nt lds
    s_add_u32 s60, s60, 8
    s_add_u32 s65, s65, 4096
    s_mov_b32 s68, s69
    s_mov_b32 s69, s70
    s_mov_b32 s70, s71
    s_mov_b32 s71, s65
    s_add_u32 s62, s62, 1
    s_add_u32 s64, s64, 8192
    s_cmp_eq_u32 s62, 10
    s_cselect_b32 s7, 4, 0
    s_add_u32 s63, s63, s7
    s_cmp_eq_u32 s62, 18
    s_cselect_b32 s62, 0, s62
    s_cselect_b32 s64, 0, s64
    s_sub_u32 s66, s66, 1
    s_cmp_lg_u32 s66, 0
    s_cbranch_scc1 LL_40
    s_mov_b32 s66, 20
LL_43:
    s_waitcnt lgkmcnt(0)
    v_readlane_b32 s79, v18, s62
    s_cmp_lt_u32 s79, s63
    s_cbranch_scc1 ST_45
GO_44:
    s_waitcnt vmcnt(19)
    s_add_u32 s7, s64, 0
    s_mov_b32 m0, s7
    s_add_u32 s65, s68, 0
    buffer_load_dwordx4 v10, s[44:47], s65 offen offset:0 nt lds
    s_waitcnt vmcnt(19)
    buffer_load_dwordx4 v11, s[44:47], s65 offen offset:1024 nt lds
    s_waitcnt vmcnt(19)
    buffer_load_dwordx4 v12, s[44:47], s65 offen offset:2048 nt lds
    s_waitcnt vmcnt(19)
    s_sub_u32 s7, s60, 16
    s_max_i32 s61, s61, s7
    v_mov_b32 v19, s61
    ds_write_b32 v16, v19
    buffer_load_dwordx4 v13, s[44:47], s65 offen offset:3072 nt lds
    s_waitcnt vmcnt(19)
    s_add_u32 s7, s64, 4096
    s_mov_b32 m0, s7
    s_add_u32 s65, s68, 4096
    buffer_load_dwordx4 v10, s[44:47], s65 offen offset:0 nt lds
    s_waitcnt vmcnt(19)
    buffer_load_dwordx4 v11, s[44:47], s65 offen offset:1024 nt lds
    ds_read_b32 v18, v17
    s_waitcnt vmcnt(19)
    buffer_load_dwordx4 v12, s[44:47], s65 offen offset:2048 nt lds
    s_waitcnt vmcnt(19)
    buffer_load_dwordx4 v13, s[44:47], s65 offen offset:3072 nt lds
    s_add_u32 s60, s60, 8
    s_add_u32 s65, s65, 4096
    s_mov_b32 s68, s69
    s_mov_b32 s69, s70
    s_mov_b32 s70, s71
    s_mov_b32 s71, s65
    s_add_u32 s62, s62, 1
    s_add_u32 s64, s64, 8192
    s_cmp_eq_u32 s62, 10
    s_cselect_b32 s7, 4, 0
    s_add_u32 s63, s63, s7
    s_cmp_eq_u32 s62, 18
    s_cselect_b32 s62, 0, s62
    s_cselect_b32 s64, 0, s64
    s_sub_u32 s66, s66, 1
    s_cmp_lg_u32 s66, 0
    s_cbranch_scc1 LL_43
    s_mov_b32 s68, s72
    s_mov_b32 s69, s73
    s_mov_b32 s70, s74
    s_mov_b32 s71, s75
    s_mov_b32 s66, 4
LL_46:
    s_waitcnt lgkmcnt(0)
    v_readlane_b32 s79, v18, s62
    s_cmp_lt_u32 s79, s63
    s_cbranch_scc1 ST_48
GO_47:
    s_waitcnt vmcnt(19)
    s_add_u32 s7, s64, 0
    s_mov_b32 m0, s7
    s_add_u32 s65, s68, 0
    buffer_load_dwordx4 v14, s[48:51], s65 offen offset:0 nt lds
    s_waitcnt vmcnt(19)
    buffer_load_dwordx4 v15, s[48:51], s65 offen offset:1024 nt lds
    s_waitcnt vmcnt(19)
    buffer_load_dwordx4 v14, s[48:51], s65 offen offset:2048 nt lds
    s_waitcnt vmcnt(19)
    s_sub_u32 s7, s60, 16
    s_max_i32 s61, s61, s7
    v_mov_b32 v19, s61
    ds_write_b32 v16, v19
    buffer_load_dwordx4 v15, s[48:51], s65 offen offset:3072 nt lds
    s_waitcnt vmcnt(19)
    s_add_u32 s7, s64, 4096
    s_mov_b32 m0, s7
    s_add_u32 s65, s68, 4096
    buffer_load_dwordx4 v14, s[48:51], s65 offen offset:0 nt lds
    s_waitcnt vmcnt(19)
    buffer_load_dwordx4 v15, s[48:51], s65 offen offset:1024 nt lds
    ds_read_b32 v18, v17
    s_waitcnt vmcnt(19)
    buffer_load_dwordx4 v14, s[48:51], s65 offen offset:2048 nt lds
    s_waitcnt vmcnt(19)
    buffer_load_dwordx4 v15, s[48:51], s65 offen offset:3072 nt lds
    s_add_u32 s60, s60, 8
    s_add_u32 s65, s65, 4096
    s_mov_b32 s68, s69
    s_mov_b32 s69, s70
    s_mov_b32 s70, s71
    s_mov_b32 s71, s65
    s_add_u32 s62, s62, 1
    s_add_u32 s64, s64, 8192
    s_cmp_eq_u32 s62, 10
    s_cselect_b32 s7, 4, 0
    s_add_u32 s63, s63, s7
    s_cmp_eq_u32 s62, 18
    s_cselect_b32 s62, 0, s62
    s_cselect_b32 s64, 0, s64
    s_sub_u32 s66, s66, 1
    s_cmp_lg_u32 s66, 0
    s_cbranch_scc1 LL_46
    s_mov_b32 s66, 18
LL_49:
    s_waitcnt lgkmcnt(0)
    v_readlane_b32 s79, v18, s62
    s_cmp_lt_u32 s79, s63
    s_cbranch_scc1 ST_51
GO_50:
    s_waitcnt vmcnt(31)
    s_add_u32 s7, s64, 0
    s_mov_b32 m0, s7
    s_add_u32 s65, s68, 0
    buffer_load_dwordx4 v14, s[48:51], s65 offen offset:0 nt lds
    s_waitcnt vmcnt(31)
    buffer_load_dwordx4 v15, s[48:51], s65 offen offset:1024 nt lds
    s_waitcnt vmcnt(31)
    buffer_load_dwordx4 v14, s[48:51], s65 offen offset:2048 nt lds
    s_waitcnt vmcnt(31)
    buffer_load_dwordx4 v15, s[48:51], s65 offen offset:3072 nt lds
    s_waitcnt vmcnt(31)
    s_add_u32 s7, s64, 4096
    s_mov_b32 m0, s7
    s_add_u32 s65, s68, 4096
    buffer_load_dwordx4 v14, s[48:51], s65 offen offset:0 nt lds
    s_waitcnt vmcnt(31)
    buffer_load_dwordx4 v15, s[48:51], s65 offen offset:1024 nt lds
    ds_read_b32 v18, v17
    s_waitcnt vmcnt(31)
    buffer_load_dwordx4 v14, s[48:51], s65 offen offset:2048 nt lds
    s_waitcnt vmcnt(31)
    s_sub_u32 s7, s60, 24
    s_max_i32 s61, s61, s7
    v_mov_b32 v19, s61
    ds_write_b32 v16, v19
    buffer_load_dwordx4 v15, s[48:51], s65 offen offset:3072 nt lds
    s_add_u32 s60, s60, 8
    s_add_u32 s65, s65, 4096
    s_mov_b32 s68, s69
    s_mov_b32 s69, s70
    s_mov_b32 s70, s71
    s_mov_b32 s71, s65
    s_add_u32 s62, s62, 1
    s_add_u32 s64, s64, 8192
    s_cmp_eq_u32 s62, 10
    s_cselect_b32 s7, 4, 0
    s_add_u32 s63, s63, s7
    s_cmp_eq_u32 s62, 18
    s_cselect_b32 s62, 0, s62
    s_cselect_b32 s64, 0, s64
    s_sub_u32 s66, s66, 1
    s_cmp_lg_u32 s66, 0
    s_cbranch_scc1 LL_49
    s_waitcnt vmcnt(24)
    s_sub_u32 s7, s60, 24
    s_max_i32 s61, s61, s7
    v_mov_b32 v19, s61
    ds_write_b32 v16, v19
    s_waitcnt vmcnt(16)
    s_sub_u32 s7, s60, 16
    s_max_i32 s61, s61, s7
    v_mov_b32 v19, s61
    ds_write_b32 v16, v19
    s_waitcnt vmcnt(8)
    s_sub_u32 s7, s60, 8
    s_max_i32 s61, s61, s7
    v_mov_b32 v19, s61
    ds_write_b32 v16, v19
    s_waitcnt vmcnt(0)
    s_mov_b32 s61, s60
    v_mov_b32 v19, s61
    ds_write_b32 v16, v19
    s_cmp_ge_u32 s5, 2
    s_cbranch_scc1 L_END
    v_mov_b32 v40, 0x24204
    s_mov_b32 s80, 1600000
LW_52:
    ds_read_b32 v41, v40
    s_waitcnt lgkmcnt(0)
    v_readfirstlane_b32 s79, v41
    s_cmp_ge_u32 s79, 1
    s_cbranch_scc1 LWD_53
    s_sleep 1
    s_sub_u32 s80, s80, 1
    s_cmp_lg_u32 s80, 0
    s_cbranch_scc1 LW_52
LWD_53:
    v_mov_b32 v40, 0x24248
    ds_read_b64 v[42:43], v40
    s_waitcnt lgkmcnt(0)
    v_readfirstlane_b32 s92, v42
    v_readfirstlane_b32 s93, v43
    s_mov_b32 s52, s30
    s_and_b32 s53, s31, 0xffff
    s_mov_b32 s54, 0x2000
    s_mov_b32 s55, 0x20000
    s_mov_b32 s84, 0x3f80
    s_mov_b32 s85, 0x3f800000
    s_lshl_b32 s60, s4, 1
    s_add_u32 s60, s60, s5
    s_lshl_b32 s7, s60, 12
    s_add_u32 s7, s7, 0x280000
    v_lshl_add_u32 v36, v1, 4, s7
    s_lshr_b32 s7, s60, 4
    s_lshl_b32 s7, s7, 11
    s_and_b32 s61, s60, 15
    s_lshl_b32 s61, s61, 6
    s_add_u32 s7, s7, s61
    v_lshl_add_u32 v37, v1, 3, s7
    v_mov_b32 v38, 0x24214
    s_mov_b32 s80, 1600000
LW_54:
    ds_read_b32 v39, v38
    s_waitcnt lgkmcnt(0)
    v_readfirstlane_b32 s79, v39
    s_cmp_ge_u32 s79, 4
    s_cbranch_scc1 LWD_55
    s_sleep 1
    s_sub_u32 s80, s80, 1
    s_cmp_lg_u32 s80, 0
    s_cbranch_scc1 LW_54
LWD_55:
    s_mov_b64 exec, -1
    buffer_load_dwordx4 v[48:51], v36, s[36:39], 0 offen offset:0 sc1
    buffer_load_dwordx4 v[52:55], v36, s[36:39], 0 offen offset:1024 sc1
    buffer_load_dwordx4 v[56:59], v36, s[36:39], 0 offen offset:2048 sc1
    buffer_load_dwordx4 v[60:63], v36, s[36:39], 0 offen offset:3072 sc1
    s_mov_b32 s80, 200000
MC_57:
    s_mov_b64 exec, -1
    s_waitcnt vmcnt(0)
    v_cmp_ne_u64 s[62:63], s[92:93], v[50:51]
    v_cmp_ne_u64 s[64:65], s[92:93], v[54:55]
    v_cmp_ne_u64 s[66:67], s[92:93], v[58:59]
    v_cmp_ne_u64 s[68:69], s[92:93], v[62:63]
    s_or_b64 s[90:91], s[62:63], s[64:65]
    s_or_b64 s[90:91], s[90:91], s[66:67]
    s_or_b64 s[90:91], s[90:91], s[68:69]
    s_cbranch_scc1 M_56
MD_58:
    s_mov_b64 exec, -1
    v_dot2_f32_bf16 v44, v48, s84, 0
    v_dot2_f32_bf16 v45, v48, s85, 0
    v_dot2_f32_bf16 v46, v49, s84, 0
    v_dot2_f32_bf16 v47, v49, s85, 0
    v_dot2_f32_bf16 v44, v52, s84, v44
    v_dot2_f32_bf16 v45, v52, s85, v45
    v_dot2_f32_bf16 v46, v53, s84, v46
    v_dot2_f32_bf16 v47, v53, s85, v47
    v_dot2_f32_bf16 v44, v56, s84, v44
    v_dot2_f32_bf16 v45, v56, s85, v45
    v_dot2_f32_bf16 v46, v57, s84, v46
    v_dot2_f32_bf16 v47, v57, s85, v47
    v_dot2_f32_bf16 v44, v60, s84, v44
    v_dot2_f32_bf16 v45, v60, s85, v45
    v_dot2_f32_bf16 v46, v61, s84, v46
    v_dot2_f32_bf16 v47, v61, s85, v47
    v_add_f32_dpp v44, v44, v44 row_ror:8 row_mask:0xf bank_mask:0xf
    v_add_f32_dpp v45, v45, v45 row_ror:8 row_mask:0xf bank_mask:0xf
    v_add_f32_dpp v46, v46, v46 row_ror:8 row_mask:0xf bank_mask:0xf
    v_add_f32_dpp v47, v47, v47 row_ror:8 row_mask:0xf bank_mask:0xf
    s_nop 0
    v_permlane32_swap_b32 v44, v46
    v_permlane32_swap_b32 v45, v47
    v_add_f32 v44, v44, v46
    v_add_f32 v45, v45, v47
    v_mov_b32 v46, v44
    v_mov_b32 v47, v45
    s_nop 0
    v_permlane16_swap_b32 v44, v46
    v_permlane16_swap_b32 v45, v47
    v_add_f32 v44, v44, v46
    v_add_f32 v45, v45, v47
    v_cvt_pk_bf16_f32 v44, v44, v45
    v_mov_b32 v45, v44
    s_nop 1
    v_permlane32_swap_b32 v44, v45
    s_mov_b64 exec, 0xff
    buffer_store_dwordx2 v[44:45], v37, s[52:55], 0 offen
    s_mov_b64 exec, -1
    s_endpgm
L_LDE:
    s_setprio 3
    s_lshl_b32 s65, s5, 19
    s_lshl_b32 s7, s4, 8
    s_add_u32 s67, s65, s7
    s_add_u32 s65, s65, s67
    v_lshrrev_b32 v4, 1, v3
    v_xor_b32 v4, v4, v2
    v_lshlrev_b32 v4, 5, v4
    v_lshl_add_u32 v4, v2, 13, v4
    v_and_b32 v40, 1, v1
    v_lshl_add_u32 v4, v40, 4, v4
    v_xor_b32 v5, 0x80, v4
    s_sub_u32 s65, s65, 0x200000
    s_mov_b32 s64, 0x20000
    s_waitcnt lgkmcnt(0)
    s_mov_b32 s52, s14
    s_and_b32 s53, s15, 0xffff
    s_mov_b32 s54, 0x400000
    s_mov_b32 s55, 0x20000
    s_barrier
    v_mov_b32 v40, 0x24200
    s_mov_b32 s80, 1600000
LW_59:
    ds_read_b32 v41, v40
    s_waitcnt lgkmcnt(0)
    v_readfirstlane_b32 s79, v41
    s_cmp_ge_u32 s79, 4
    s_cbranch_scc1 LWD_60
    s_sub_u32 s80, s80, 1
    s_cmp_lg_u32 s80, 0
    s_cbranch_scc1 LW_59
LWD_60:
    s_mov_b32 m0, s64
    s_add_u32 s64, s64, 1024
    buffer_load_dwordx4 v4, s[52:55], s65 offen nt lds
    s_add_u32 s65, s65, 32768
    s_mov_b32 m0, s64
    s_add_u32 s64, s64, 1024
    buffer_load_dwordx4 v5, s[52:55], s65 offen nt lds
    s_add_u32 s65, s65, 32768
    s_mov_b32 m0, s64
    s_add_u32 s64, s64, 1024
    buffer_load_dwordx4 v4, s[52:55], s65 offen nt lds
    s_add_u32 s65, s65, 32768
    s_mov_b32 m0, s64
    s_add_u32 s64, s64, 1024
    buffer_load_dwordx4 v5, s[52:55], s65 offen nt lds
    s_add_u32 s65, s65, 32768
    s_mov_b32 m0, s64
    s_add_u32 s64, s64, 1024
    buffer_load_dwordx4 v4, s[52:55], s65 offen nt lds
    s_add_u32 s65, s65, 32768
    s_mov_b32 m0, s64
    s_add_u32 s64, s64, 1024
    buffer_load_dwordx4 v5, s[52:55], s65 offen nt lds
    s_add_u32 s65, s65, 32768
    s_mov_b32 m0, s64
    s_add_u32 s64, s64, 1024
    buffer_load_dwordx4 v4, s[52:55], s65 offen nt lds
    s_add_u32 s65, s65, 32768
    s_mov_b32 m0, s64
    s_add_u32 s64, s64, 1024
    buffer_load_dwordx4 v5, s[52:55], s65 offen nt lds
    s_add_u32 s65, s65, 32768
    s_mov_b32 m0, s64
    s_add_u32 s64, s64, 1024
    buffer_load_dwordx4 v4, s[52:55], s65 offen nt lds
    s_add_u32 s65, s65, 32768
    s_mov_b32 m0, s64
    s_add_u32 s64, s64, 1024
    buffer_load_dwordx4 v5, s[52:55], s65 offen nt lds
    s_add_u32 s65, s65, 32768
    s_mov_b32 m0, s64
    s_add_u32 s64, s64, 1024
    buffer_load_dwordx4 v4, s[52:55], s65 offen nt lds
    s_add_u32 s65, s65, 32768
    s_mov_b32 m0, s64
    s_add_u32 s64, s64, 1024
    buffer_load_dwordx4 v5, s[52:55], s65 offen nt lds
    s_add_u32 s65, s65, 32768
    s_mov_b32 m0, s64
    s_add_u32 s64, s64, 1024
    buffer_load_dwordx4 v4, s[52:55], s65 offen nt lds
    s_add_u32 s65, s65, 32768
    s_mov_b32 m0, s64
    s_add_u32 s64, s64, 1024
    buffer_load_dwordx4 v5, s[52:55], s65 offen nt lds
    s_add_u32 s65, s65, 32768
    s_mov_b32 m0, s64
    s_add_u32 s64, s64, 1024
    buffer_load_dwordx4 v4, s[52:55], s65 offen nt lds
    s_add_u32 s65, s65, 32768
    s_mov_b32 m0, s64
    s_add_u32 s64, s64, 1024
    buffer_load_dwordx4 v5, s[52:55], s65 offen nt lds
    s_add_u32 s65, s65, 32768
    s_mov_b32 s61, 0
    s_mov_b32 s63, 0
    v_lshlrev_b32 v16, 2, v1
    v_add_u32 v17, 0x24100, v16
    v_add_u32 v16, 0x24000, v16
    v_mov_b32 v18, 0
    s_mov_b32 s60, 16
    s_mov_b32 s36, s34
    s_and_b32 s37, s35, 0xffff
    s_mov_b32 s38, 0x1000000
    s_mov_b32 s39, 0x20000
    s_mov_b32 s44, s26
    s_and_b32 s45, s27, 0xffff
    s_mov_b32 s46, 0x400000
    s_mov_b32 s47, 0x20000
    v_bfe_u32 v20, v1, 1, 2
    v_xor_b32 v20, v20, v2
    v_lshlrev_b32 v20, 5, v20
    v_lshrrev_b32 v40, 3, v1
    v_lshl_add_u32 v20, v40, 13, v20
    v_and_b32 v40, 1, v1
    v_lshl_add_u32 v20, v40, 4, v20
    s_mov_b32 s96, 0x6010600
    s_mov_b32 s97, 0x5030502
    s_cmp_eq_u32 s5, 1
    s_cselect_b32 s96, 0x6170616, s96
    s_cselect_b32 s97, 0x5190518, s97
    s_cmp_eq_u32 s5, 2
    s_cselect_b32 s96, 0x62d062c, s96
    s_cselect_b32 s97, 0x52f052e, s97
    s_cmp_eq_u32 s5, 3
    s_cselect_b32 s96, 0x6430642, s96
    s_cselect_b32 s97, 0x5450544, s97
    s_cmp_eq_u32 s5, 4
    s_cselect_b32 s96, 0x5590558, s96
    s_cselect_b32 s97, 0x55b055a, s97
    s_cmp_eq_u32 s5, 5
    s_cselect_b32 s96, 0x56d056c, s96
    s_cselect_b32 s97, 0x56f056e, s97
    v_xor_b32 v10, v3, v2
    v_lshlrev_b32 v10, 4, v10
    v_lshl_add_u32 v10, v2, 8, v10
    v_xor_b32 v11, 0x40, v10
    v_xor_b32 v12, 0x80, v10
    v_xor_b32 v13, 0xc0, v10
    v_lshrrev_b32 v14, 1, v3
    v_xor_b32 v14, v14, v2
    v_lshlrev_b32 v14, 5, v14
    v_lshl_add_u32 v14, v2, 8, v14
    v_and_b32 v40, 1, v1
    v_lshl_add_u32 v14, v40, 4, v14
    v_xor_b32 v15, 0x80, v14
    s_mov_b32 s76, 0
    s_lshl_b32 s7, s76, 4
    s_lshr_b64 s[90:91], s[96:97], s7
    s_and_b32 s68, s90, 3
    s_bfe_u32 s72, s90, 0x50002
    s_lshl_b32 s68, s68, 5
    s_add_u32 s68, s68, s4
    s_lshl_b32 s68, s68, 20
    s_lshl_b32 s72, s72, 13
    s_add_u32 s72, s72, s68
    s_add_u32 s72, s72, 0xC0000
    s_mov_b32 s76, 1
    s_lshl_b32 s7, s76, 4
    s_lshr_b64 s[90:91], s[96:97], s7
    s_and_b32 s69, s90, 3
    s_bfe_u32 s73, s90, 0x50002
    s_lshl_b32 s69, s69, 5
    s_add_u32 s69, s69, s4
    s_lshl_b32 s69, s69, 20
    s_lshl_b32 s73, s73, 13
    s_add_u32 s73, s73, s69
    s_add_u32 s73, s73, 0xC0000
    s_mov_b32 s76, 2
    s_lshl_b32 s7, s76, 4
    s_lshr_b64 s[90:91], s[96:97], s7
    s_and_b32 s70, s90, 3
    s_bfe_u32 s74, s90, 0x50002
    s_lshl_b32 s70, s70, 5
    s_add_u32 s70, s70, s4
    s_lshl_b32 s70, s70, 20
    s_lshl_b32 s74, s74, 13
    s_add_u32 s74, s74, s70
    s_add_u32 s74, s74, 0xC0000
    s_mov_b32 s76, 3
    s_lshl_b32 s7, s76, 4
    s_lshr_b64 s[90:91], s[96:97], s7
    s_and_b32 s71, s90, 3
    s_bfe_u32 s75, s90, 0x50002
    s_lshl_b32 s71, s71, 5
    s_add_u32 s71, s71, s4
    s_lshl_b32 s71, s71, 20
    s_lshl_b32 s75, s75, 13
    s_add_u32 s75, s75, s71
    s_add_u32 s75, s75, 0xC0000
    s_mov_b32 s64, 0x18000
    s_mov_b32 s66, 2
LL_61:
    s_waitcnt vmcnt(15)
    s_mov_b32 m0, s64
    s_add_u32 s64, s64, 1024
    buffer_load_dwordx4 v4, s[52:55], s65 offen nt lds
    s_add_u32 s65, s65, 32768
    s_waitcnt vmcnt(15)
    s_mov_b32 m0, s64
    s_add_u32 s64, s64, 1024
    buffer_load_dwordx4 v5, s[52:55], s65 offen nt lds
    s_add_u32 s65, s65, 32768
    s_waitcnt vmcnt(15)
    s_mov_b32 m0, s64
    s_add_u32 s64, s64, 1024
    buffer_load_dwordx4 v4, s[52:55], s65 offen nt lds
    s_add_u32 s65, s65, 32768
    s_waitcnt vmcnt(15)
    s_mov_b32 m0, s64
    s_add_u32 s64, s64, 1024
    buffer_load_dwordx4 v5, s[52:55], s65 offen nt lds
    s_add_u32 s65, s65, 32768
    s_waitcnt vmcnt(15)
    s_mov_b32 m0, s64
    s_add_u32 s64, s64, 1024
    buffer_load_dwordx4 v4, s[52:55], s65 offen nt lds
    s_add_u32 s65, s65, 32768
    s_waitcnt vmcnt(15)
    s_mov_b32 m0, s64
    s_add_u32 s64, s64, 1024
    buffer_load_dwordx4 v5, s[52:55], s65 offen nt lds
    s_add_u32 s65, s65, 32768
    s_waitcnt vmcnt(15)
    s_mov_b32 m0, s64
    s_add_u32 s64, s64, 1024
    buffer_load_dwordx4 v4, s[52:55], s65 offen nt lds
    s_add_u32 s65, s65, 32768
    s_waitcnt vmcnt(15)
    s_sub_u32 s7, s60, 8
    s_max_i32 s61, s61, s7
    v_mov_b32 v19, s61
    ds_write_b32 v16, v19
    s_mov_b32 m0, s64
    s_add_u32 s64, s64, 1024
    buffer_load_dwordx4 v5, s[52:55], s65 offen nt lds
    s_add_u32 s65, s65, 32768
    s_add_u32 s60, s60, 8
    s_sub_u32 s66, s66, 1
    s_cmp_lg_u32 s66, 0
    s_cbranch_scc1 LL_61
    s_lshl_b32 s65, s4, 8
    s_lshl_b32 s7, s5, 7
    s_add_u32 s65, s65, s7
    s_sub_u32 s65, s65, 512
    s_mov_b32 s64, 0
    s_mov_b32 s66, 8
LL_62:
    s_waitcnt vmcnt(15)
    s_mov_b32 m0, s64
    s_add_u32 s64, s64, 1024
    buffer_load_dwordx4 v20, s[44:47], s65 offen nt lds
    s_add_u32 s65, s65, 65536
    s_waitcnt vmcnt(15)
    s_mov_b32 m0, s64
    s_add_u32 s64, s64, 1024
    buffer_load_dwordx4 v20, s[44:47], s65 offen nt lds
    s_add_u32 s65, s65, 65536
    s_waitcnt vmcnt(15)
    s_mov_b32 m0, s64
    s_add_u32 s64, s64, 1024
    buffer_load_dwordx4 v20, s[44:47], s65 offen nt lds
    s_add_u32 s65, s65, 65536
    s_waitcnt vmcnt(15)
    s_mov_b32 m0, s64
    s_add_u32 s64, s64, 1024
    buffer_load_dwordx4 v20, s[44:47], s65 offen nt lds
    s_add_u32 s65, s65, 65536
    s_waitcnt vmcnt(15)
    s_mov_b32 m0, s64
    s_add_u32 s64, s64, 1024
    buffer_load_dwordx4 v20, s[44:47], s65 offen nt lds
    s_add_u32 s65, s65, 65536
    s_waitcnt vmcnt(15)
    s_mov_b32 m0, s64
    s_add_u32 s64, s64, 1024
    buffer_load_dwordx4 v20, s[44:47], s65 offen nt lds
    s_add_u32 s65, s65, 65536
    s_waitcnt vmcnt(15)
    s_mov_b32 m0, s64
    s_add_u32 s64, s64, 1024
    buffer_load_dwordx4 v20, s[44:47], s65 offen nt lds
    s_add_u32 s65, s65, 65536
    s_waitcnt vmcnt(15)
    s_sub_u32 s7, s60, 8
    s_max_i32 s61, s61, s7
    v_mov_b32 v19, s61
    ds_write_b32 v16, v19
    s_mov_b32 m0, s64
    s_add_u32 s64, s64, 1024
    buffer_load_dwordx4 v20, s[44:47], s65 offen nt lds
    s_add_u32 s65, s65, 65536
    s_add_u32 s60, s60, 8
    s_sub_u32 s66, s66, 1
    s_cmp_lg_u32 s66, 0
    s_cbranch_scc1 LL_62
    s_mov_b32 s62, 8
    s_mov_b32 s44, s10
    s_and_b32 s45, s11, 0xffff
    s_mov_b32 s46, 0x8000000
    s_mov_b32 s47, 0x20000
    s_mov_b32 s48, s12
    s_and_b32 s49, s13, 0xffff
    s_mov_b32 s50, 0x8000000
    s_mov_b32 s51, 0x20000
    s_mov_b32 s68, s72
    s_mov_b32 s69, s73
    s_mov_b32 s70, s74
    s_mov_b32 s71, s75
    s_mov_b32 s66, 20
LL_63:
    s_waitcnt lgkmcnt(0)
    v_readlane_b32 s79, v18, s62
    s_cmp_lt_u32 s79, s63
    s_cbranch_scc1 ST_65
GO_64:
    s_waitcnt vmcnt(19)
    s_add_u32 s7, s64, 0
    s_mov_b32 m0, s7
    s_add_u32 s65, s68, 0
    buffer_load_dwordx4 v10, s[44:47], s65 offen offset:0 nt lds
    s_waitcnt vmcnt(19)
    buffer_load_dwordx4 v11, s[44:47], s65 offen offset:1024 nt lds
    s_waitcnt vmcnt(19)
    buffer_load_dwordx4 v12, s[44:47], s65 offen offset:2048 nt lds
    s_waitcnt vmcnt(19)
    s_sub_u32 s7, s60, 16
    s_max_i32 s61, s61, s7
    v_mov_b32 v19, s61
    ds_write_b32 v16, v19
    buffer_load_dwordx4 v13, s[44:47], s65 offen offset:3072 nt lds
    s_waitcnt vmcnt(19)
    s_add_u32 s7, s64, 4096
    s_mov_b32 m0, s7
    s_add_u32 s65, s68, 4096
    buffer_load_dwordx4 v10, s[44:47], s65 offen offset:0 nt lds
    s_waitcnt vmcnt(19)
    buffer_load_dwordx4 v11, s[44:47], s65 offen offset:1024 nt lds
    ds_read_b32 v18, v17
    s_waitcnt vmcnt(19)
    buffer_load_dwordx4 v12, s[44:47], s65 offen offset:2048 nt lds
    s_waitcnt vmcnt(19)
    buffer_load_dwordx4 v13, s[44:47], s65 offen offset:3072 nt lds
    s_add_u32 s60, s60, 8
    s_add_u32 s65, s65, 4096
    s_mov_b32 s68, s69
    s_mov_b32 s69, s70
    s_mov_b32 s70, s71
    s_mov_b32 s71, s65
    s_add_u32 s62, s62, 1
    s_add_u32 s64, s64, 8192
    s_cmp_eq_u32 s62, 12
    s_cselect_b32 s7, 4, 0
    s_add_u32 s63, s63, s7
    s_cmp_eq_u32 s62, 18
    s_cselect_b32 s62, 0, s62
    s_cselect_b32 s64, 0, s64
    s_sub_u32 s66, s66, 1
    s_cmp_lg_u32 s66, 0
    s_cbranch_scc1 LL_63
    s_mov_b32 s68, s72
    s_mov_b32 s69, s73
    s_mov_b32 s70, s74
    s_mov_b32 s71, s75
    s_mov_b32 s66, 4
LL_66:
    s_waitcnt lgkmcnt(0)
    v_readlane_b32 s79, v18, s62
    s_cmp_lt_u32 s79, s63
    s_cbranch_scc1 ST_68
GO_67:
    s_waitcnt vmcnt(19)
    s_add_u32 s7, s64, 0
    s_mov_b32 m0, s7
    s_add_u32 s65, s68, 0
    buffer_load_dwordx4 v14, s[48:51], s65 offen offset:0 nt lds
    s_waitcnt vmcnt(19)
    buffer_load_dwordx4 v15, s[48:51], s65 offen offset:1024 nt lds
    s_waitcnt vmcnt(19)
    buffer_load_dwordx4 v14, s[48:51], s65 offen offset:2048 nt lds
    s_waitcnt vmcnt(19)
    s_sub_u32 s7, s60, 16
    s_max_i32 s61, s61, s7
    v_mov_b32 v19, s61
    ds_write_b32 v16, v19
    buffer_load_dwordx4 v15, s[48:51], s65 offen offset:3072 nt lds
    s_waitcnt vmcnt(19)
    s_add_u32 s7, s64, 4096
    s_mov_b32 m0, s7
    s_add_u32 s65, s68, 4096
    buffer_load_dwordx4 v14, s[48:51], s65 offen offset:0 nt lds
    s_waitcnt vmcnt(19)
    buffer_load_dwordx4 v15, s[48:51], s65 offen offset:1024 nt lds
    ds_read_b32 v18, v17
    s_waitcnt vmcnt(19)
    buffer_load_dwordx4 v14, s[48:51], s65 offen offset:2048 nt lds
    s_waitcnt vmcnt(19)
    buffer_load_dwordx4 v15, s[48:51], s65 offen offset:3072 nt lds
    s_add_u32 s60, s60, 8
    s_add_u32 s65, s65, 4096
    s_mov_b32 s68, s69
    s_mov_b32 s69, s70
    s_mov_b32 s70, s71
    s_mov_b32 s71, s65
    s_add_u32 s62, s62, 1
    s_add_u32 s64, s64, 8192
    s_cmp_eq_u32 s62, 12
    s_cselect_b32 s7, 4, 0
    s_add_u32 s63, s63, s7
    s_cmp_eq_u32 s62, 18
    s_cselect_b32 s62, 0, s62
    s_cselect_b32 s64, 0, s64
    s_sub_u32 s66, s66, 1
    s_cmp_lg_u32 s66, 0
    s_cbranch_scc1 LL_66
    s_mov_b32 s66, 16
LL_69:
    s_waitcnt lgkmcnt(0)
    v_readlane_b32 s79, v18, s62
    s_cmp_lt_u32 s79, s63
    s_cbranch_scc1 ST_71
GO_70:
    s_waitcnt vmcnt(31)
    s_add_u32 s7, s64, 0
    s_mov_b32 m0, s7
    s_add_u32 s65, s68, 0
    buffer_load_dwordx4 v14, s[48:51], s65 offen offset:0 nt lds
    s_waitcnt vmcnt(31)
    buffer_load_dwordx4 v15, s[48:51], s65 offen offset:1024 nt lds
    s_waitcnt vmcnt(31)
    buffer_load_dwordx4 v14, s[48:51], s65 offen offset:2048 nt lds
    s_waitcnt vmcnt(31)
    buffer_load_dwordx4 v15, s[48:51], s65 offen offset:3072 nt lds
    s_waitcnt vmcnt(31)
    s_add_u32 s7, s64, 4096
    s_mov_b32 m0, s7
    s_add_u32 s65, s68, 4096
    buffer_load_dwordx4 v14, s[48:51], s65 offen offset:0 nt lds
    s_waitcnt vmcnt(31)
    buffer_load_dwordx4 v15, s[48:51], s65 offen offset:1024 nt lds
    ds_read_b32 v18, v17
    s_waitcnt vmcnt(31)
    buffer_load_dwordx4 v14, s[48:51], s65 offen offset:2048 nt lds
    s_waitcnt vmcnt(31)
    s_sub_u32 s7, s60, 24
    s_max_i32 s61, s61, s7
    v_mov_b32 v19, s61
    ds_write_b32 v16, v19
    buffer_load_dwordx4 v15, s[48:51], s65 offen offset:3072 nt lds
    s_add_u32 s60, s60, 8
    s_add_u32 s65, s65, 4096
    s_mov_b32 s68, s69
    s_mov_b32 s69, s70
    s_mov_b32 s70, s71
    s_mov_b32 s71, s65
    s_add_u32 s62, s62, 1
    s_add_u32 s64, s64, 8192
    s_cmp_eq_u32 s62, 12
    s_cselect_b32 s7, 4, 0
    s_add_u32 s63, s63, s7
    s_cmp_eq_u32 s62, 18
    s_cselect_b32 s62, 0, s62
    s_cselect_b32 s64, 0, s64
    s_sub_u32 s66, s66, 1
    s_cmp_lg_u32 s66, 0
    s_cbranch_scc1 LL_69
    s_waitcnt vmcnt(24)
    s_sub_u32 s7, s60, 24
    s_max_i32 s61, s61, s7
    v_mov_b32 v19, s61
    ds_write_b32 v16, v19
    s_waitcnt vmcnt(16)
    s_sub_u32 s7, s60, 16
    s_max_i32 s61, s61, s7
    v_mov_b32 v19, s61
    ds_write_b32 v16, v19
    s_waitcnt vmcnt(8)
    s_sub_u32 s7, s60, 8
    s_max_i32 s61, s61, s7
    v_mov_b32 v19, s61
    ds_write_b32 v16, v19
    s_waitcnt vmcnt(0)
    s_mov_b32 s61, s60
    v_mov_b32 v19, s61
    ds_write_b32 v16, v19
    s_endpgm
L_LDB:
    s_setprio 3
    v_lshlrev_b32 v20, 4, v1
    v_xor_b32 v21, 0x40, v20
    v_xor_b32 v22, 0x80, v20
    v_xor_b32 v23, 0xc0, v20
    v_xor_b32 v24, 0x10, v20
    v_xor_b32 v25, 0x50, v20
    v_xor_b32 v26, 0x90, v20
    v_xor_b32 v27, 0xd0, v20
    v_xor_b32 v28, 0x20, v20
    v_xor_b32 v29, 0x60, v20
    v_xor_b32 v30, 0xa0, v20
    v_xor_b32 v31, 0xe0, v20
    v_xor_b32 v32, 0x30, v20
    v_xor_b32 v33, 0x70, v20
    v_xor_b32 v34, 0xb0, v20
    v_xor_b32 v35, 0xf0, v20
    s_and_b32 s69, s4, 7
    s_lshl_b32 s69, s69, 3
    s_lshr_b32 s7, s4, 3
    s_lshl_b32 s7, s7, 1
    s_add_u32 s69, s69, s7
    s_add_u32 s69, s69, s5
    s_sub_u32 s69, s69, 6
    s_lshl_b32 s68, s69, 18
    s_mov_b32 s70, s68
    s_mov_b32 s64, 0
    s_waitcnt lgkmcnt(0)
    s_mov_b32 s44, s20
    s_and_b32 s45, s21, 0xffff
    s_mov_b32 s46, 0x1000000
    s_mov_b32 s47, 0x20000
    s_barrier
    v_mov_b32 v40, 0x24200
    s_mov_b32 s80, 1600000
LW_72:
    ds_read_b32 v41, v40
    s_waitcnt lgkmcnt(0)
    v_readfirstlane_b32 s79, v41
    s_cmp_ge_u32 s79, 4
    s_cbranch_scc1 LWD_73
    s_sub_u32 s80, s80, 1
    s_cmp_lg_u32 s80, 0
    s_cbranch_scc1 LW_72
LWD_73:
    s_add_u32 s7, s64, 0
    s_mov_b32 m0, s7
    s_add_u32 s65, s68, 0
    buffer_load_dwordx4 v20, s[44:47], s65 offen offset:0 nt lds
    buffer_load_dwordx4 v21, s[44:47], s65 offen offset:1024 nt lds
    buffer_load_dwordx4 v22, s[44:47], s65 offen offset:2048 nt lds
    buffer_load_dwordx4 v23, s[44:47], s65 offen offset:3072 nt lds
    s_add_u32 s7, s64, 4096
    s_mov_b32 m0, s7
    s_add_u32 s65, s68, 4096
    buffer_load_dwordx4 v24, s[44:47], s65 offen offset:0 nt lds
    buffer_load_dwordx4 v25, s[44:47], s65 offen offset:1024 nt lds
    buffer_load_dwordx4 v26, s[44:47], s65 offen offset:2048 nt lds
    buffer_load_dwordx4 v27, s[44:47], s65 offen offset:3072 nt lds
    s_add_u32 s7, s64, 8192
    s_mov_b32 m0, s7
    s_add_u32 s65, s68, 8192
    buffer_load_dwordx4 v28, s[44:47], s65 offen offset:0 nt lds
    buffer_load_dwordx4 v29, s[44:47], s65 offen offset:1024 nt lds
    buffer_load_dwordx4 v30, s[44:47], s65 offen offset:2048 nt lds
    buffer_load_dwordx4 v31, s[44:47], s65 offen offset:3072 nt lds
    s_add_u32 s7, s64, 12288
    s_mov_b32 m0, s7
    s_add_u32 s65, s68, 12288
    buffer_load_dwordx4 v32, s[44:47], s65 offen offset:0 nt lds
    buffer_load_dwordx4 v33, s[44:47], s65 offen offset:1024 nt lds
    buffer_load_dwordx4 v34, s[44:47], s65 offen offset:2048 nt lds
    buffer_load_dwordx4 v35, s[44:47], s65 offen offset:3072 nt lds
    s_mov_b32 s61, 0
    s_mov_b32 s63, 0
    v_lshlrev_b32 v16, 2, v1
    v_add_u32 v17, 0x24100, v16
    v_add_u32 v16, 0x24000, v16
    v_mov_b32 v18, 0
    s_mov_b32 s60, 16
    s_mov_b32 s36, s34
    s_and_b32 s37, s35, 0xffff
    s_mov_b32 s38, 0x1000000
    s_mov_b32 s39, 0x20000
    s_add_u32 s68, s68, 16384
    s_xor_b32 s7, s68, s70
    s_and_b32 s7, s7, 0xfffc0000
    s_xor_b32 s68, s68, s7
    s_mov_b32 s64, 16384
    s_mov_b32 s48, s28
    s_and_b32 s49, s29, 0xffff
    s_mov_b32 s50, 0x400000
    s_mov_b32 s51, 0x20000
    v_bfe_u32 v10, v1, 1, 2
    v_xor_b32 v10, v10, v2
    v_lshlrev_b32 v10, 5, v10
    v_lshrrev_b32 v40, 3, v1
    v_lshl_add_u32 v10, v40, 10, v10
    v_and_b32 v40, 1, v1
    v_lshl_add_u32 v10, v40, 4, v10
    s_mov_b32 s72, 0x21111559
    s_mov_b32 s73, 0x22
    s_lshl_b32 s7, s69, 9
    s_add_u32 s7, s7, 0x28000
    v_lshl_add_u32 v44, v1, 4, s7
    s_mov_b32 s66, 5
LL_74:
    s_waitcnt vmcnt(27)
    s_add_u32 s7, s64, 0
    s_mov_b32 m0, s7
    s_add_u32 s65, s68, 0
    buffer_load_dwordx4 v20, s[44:47], s65 offen offset:0 nt lds
    s_waitcnt vmcnt(27)
    buffer_load_dwordx4 v21, s[44:47], s65 offen offset:1024 nt lds
    s_waitcnt vmcnt(27)
    buffer_load_dwordx4 v22, s[44:47], s65 offen offset:2048 nt lds
    s_waitcnt vmcnt(27)
    s_sub_u32 s7, s60, 24
    s_max_i32 s61, s61, s7
    v_mov_b32 v19, s61
    ds_write_b32 v16, v19
    buffer_load_dwordx4 v23, s[44:47], s65 offen offset:3072 nt lds
    s_waitcnt vmcnt(27)
    s_add_u32 s7, s64, 4096
    s_mov_b32 m0, s7
    s_add_u32 s65, s68, 4096
    buffer_load_dwordx4 v24, s[44:47], s65 offen offset:0 nt lds
    s_waitcnt vmcnt(27)
    buffer_load_dwordx4 v25, s[44:47], s65 offen offset:1024 nt lds
    s_waitcnt vmcnt(27)
    buffer_load_dwordx4 v26, s[44:47], s65 offen offset:2048 nt lds
    s_waitcnt vmcnt(27)
    buffer_load_dwordx4 v27, s[44:47], s65 offen offset:3072 nt lds
    s_waitcnt vmcnt(27)
    s_add_u32 s7, s64, 8192
    s_mov_b32 m0, s7
    s_add_u32 s65, s68, 8192
    buffer_load_dwordx4 v28, s[44:47], s65 offen offset:0 nt lds
    s_waitcnt vmcnt(27)
    buffer_load_dwordx4 v29, s[44:47], s65 offen offset:1024 nt lds
    s_waitcnt vmcnt(27)
    buffer_load_dwordx4 v30, s[44:47], s65 offen offset:2048 nt lds
    s_waitcnt vmcnt(27)
    s_sub_u32 s7, s60, 16
    s_max_i32 s61, s61, s7
    v_mov_b32 v19, s61
    ds_write_b32 v16, v19
    buffer_load_dwordx4 v31, s[44:47], s65 offen offset:3072 nt lds
    s_waitcnt vmcnt(27)
    s_add_u32 s7, s64, 12288
    s_mov_b32 m0, s7
    s_add_u32 s65, s68, 12288
    buffer_load_dwordx4 v32, s[44:47], s65 offen offset:0 nt lds
    s_waitcnt vmcnt(27)
    buffer_load_dwordx4 v33, s[44:47], s65 offen offset:1024 nt lds
    s_waitcnt vmcnt(27)
    buffer_load_dwordx4 v34, s[44:47], s65 offen offset:2048 nt lds
    s_waitcnt vmcnt(27)
    buffer_load_dwordx4 v35, s[44:47], s65 offen offset:3072 nt lds
    s_add_u32 s60, s60, 16
    s_add_u32 s68, s68, 16384
    s_xor_b32 s7, s68, s70
    s_and_b32 s7, s7, 0xfffc0000
    s_xor_b32 s68, s68, s7
    s_add_u32 s64, s64, 16384
    s_sub_u32 s66, s66, 1
    s_cmp_lg_u32 s66, 0
    s_cbranch_scc1 LL_74
    v_mov_b32 v45, 0
    s_mov_b64 exec, 0x01010101
    buffer_store_dword v45, v44, s[36:39], 0 offen
    buffer_load_dword v45, v44, s[36:39], 0 offen sc1 nt
    s_mov_b64 exec, -1
    v_mov_b32 v40, 0x24204
    s_mov_b32 s80, 1600000
LW_75:
    ds_read_b32 v41, v40
    s_waitcnt lgkmcnt(0)
    v_readfirstlane_b32 s79, v41
    s_cmp_ge_u32 s79, 1
    s_cbranch_scc1 LWD_76
    s_sleep 1
    s_sub_u32 s80, s80, 1
    s_cmp_lg_u32 s80, 0
    s_cbranch_scc1 LW_75
LWD_76:
    v_mov_b32 v40, 0x24248
    ds_read_b64 v[42:43], v40
    s_waitcnt lgkmcnt(0)
    v_readfirstlane_b32 s92, v42
    v_readfirstlane_b32 s93, v43
    s_lshr_b32 s7, s69, 3
    s_lshl_b32 s7, s7, 7
    s_add_u32 s7, s7, 0x22000
    v_and_b32 v38, 7, v1
    v_lshl_add_u32 v38, v38, 3, s7
    s_and_b32 s7, s69, 7
    s_lshl_b32 s67, s7, 15
    s_lshr_b32 s7, s69, 3
    s_lshl_b32 s7, s7, 10
    s_add_u32 s67, s67, s7
    s_add_u32 s67, s67, 0x200000
    v_mov_b32 v48, -1
    v_mov_b32 v49, -1
    v_mov_b32 v50, -1
    v_mov_b32 v51, -1
    s_mov_b32 s66, 3
LL_77:
    s_and_b32 s63, s72, 3
    s_lshl_b32 s63, s63, 3
    s_bfe_u32 s62, s72, 0x20002
    s_lshr_b64 s[72:73], s[72:73], 4
    s_waitcnt lgkmcnt(0)
    v_readlane_b32 s79, v18, s62
    s_cmp_lt_u32 s79, s63
    s_cbranch_scc1 ST_79
GO_78:
    s_waitcnt vmcnt(31)
    s_add_u32 s7, s64, 0
    s_mov_b32 m0, s7
    s_add_u32 s65, s68, 0
    buffer_load_dwordx4 v20, s[44:47], s65 offen offset:0 nt lds
    s_waitcnt vmcnt(31)
    buffer_load_dwordx4 v21, s[44:47], s65 offen offset:1024 nt lds
    s_waitcnt vmcnt(31)
    buffer_load_dwordx4 v22, s[44:47], s65 offen offset:2048 nt lds
    s_waitcnt vmcnt(31)
    buffer_load_dwordx4 v23, s[44:47], s65 offen offset:3072 nt lds
    s_waitcnt vmcnt(31)
    s_add_u32 s7, s64, 4096
    s_mov_b32 m0, s7
    s_add_u32 s65, s68, 4096
    buffer_load_dwordx4 v24, s[44:47], s65 offen offset:0 nt lds
    s_waitcnt vmcnt(31)
    buffer_load_dwordx4 v25, s[44:47], s65 offen offset:1024 nt lds
    s_waitcnt vmcnt(31)
    buffer_load_dwordx4 v26, s[44:47], s65 offen offset:2048 nt lds
    s_waitcnt vmcnt(31)
    s_sub_u32 s7, s60, 24
    s_max_i32 s61, s61, s7
    v_mov_b32 v19, s61
    ds_write_b32 v16, v19
    buffer_load_dwordx4 v27, s[44:47], s65 offen offset:3072 nt lds
    s_waitcnt vmcnt(31)
    s_add_u32 s7, s64, 8192
    s_mov_b32 m0, s7
    s_add_u32 s65, s68, 8192
    buffer_load_dwordx4 v28, s[44:47], s65 offen offset:0 nt lds
    s_waitcnt vmcnt(31)
    buffer_load_dwordx4 v29, s[44:47], s65 offen offset:1024 nt lds
    s_waitcnt vmcnt(31)
    buffer_load_dwordx4 v30, s[44:47], s65 offen offset:2048 nt lds
    s_waitcnt vmcnt(31)
    buffer_load_dwordx4 v31, s[44:47], s65 offen offset:3072 nt lds
    s_waitcnt vmcnt(31)
    s_add_u32 s7, s64, 12288
    s_mov_b32 m0, s7
    s_add_u32 s65, s68, 12288
    buffer_load_dwordx4 v32, s[44:47], s65 offen offset:0 nt lds
    s_waitcnt vmcnt(31)
    buffer_load_dwordx4 v33, s[44:47], s65 offen offset:1024 nt lds
    ds_read_b32 v18, v17
    s_waitcnt vmcnt(31)
    buffer_load_dwordx4 v34, s[44:47], s65 offen offset:2048 nt lds
    s_waitcnt vmcnt(31)
    s_sub_u32 s7, s60, 16
    s_max_i32 s61, s61, s7
    v_mov_b32 v19, s61
    ds_write_b32 v16, v19
    buffer_load_dwordx4 v35, s[44:47], s65 offen offset:3072 nt lds
    s_add_u32 s60, s60, 16
    s_add_u32 s68, s68, 16384
    s_xor_b32 s7, s68, s70
    s_and_b32 s7, s7, 0xfffc0000
    s_xor_b32 s68, s68, s7
    s_add_u32 s64, s64, 16384
    s_cmp_eq_u32 s64, 147456
    s_cselect_b32 s64, 0, s64
    s_sub_u32 s66, s66, 1
    s_cmp_lg_u32 s66, 0
    s_cbranch_scc1 LL_77
    buffer_store_dwordx4 v[48:51], v20, s[36:39], s67 offen sc1
    s_add_u32 s67, s67, 8192
    buffer_store_dwordx4 v[48:51], v20, s[36:39], s67 offen sc1
    s_add_u32 s67, s67, 8192
    buffer_store_dwordx4 v[48:51], v20, s[36:39], s67 offen sc1
    s_add_u32 s67, s67, 8192
    buffer_store_dwordx4 v[48:51], v20, s[36:39], s67 offen sc1
    s_add_u32 s67, s67, 8192
    s_mov_b32 s66, 7
LL_80:
    s_and_b32 s63, s72, 3
    s_lshl_b32 s63, s63, 3
    s_bfe_u32 s62, s72, 0x20002
    s_lshr_b64 s[72:73], s[72:73], 4
    s_waitcnt lgkmcnt(0)
    v_readlane_b32 s79, v18, s62
    s_cmp_lt_u32 s79, s63
    s_cbranch_scc1 ST_82
GO_81:
    s_waitcnt vmcnt(31)
    s_add_u32 s7, s64, 0
    s_mov_b32 m0, s7
    s_add_u32 s65, s68, 0
    buffer_load_dwordx4 v20, s[44:47], s65 offen offset:0 nt lds
    s_waitcnt vmcnt(31)
    buffer_load_dwordx4 v21, s[44:47], s65 offen offset:1024 nt lds
    s_waitcnt vmcnt(31)
    buffer_load_dwordx4 v22, s[44:47], s65 offen offset:2048 nt lds
    s_waitcnt vmcnt(31)
    buffer_load_dwordx4 v23, s[44:47], s65 offen offset:3072 nt lds
    s_waitcnt vmcnt(31)
    s_add_u32 s7, s64, 4096
    s_mov_b32 m0, s7
    s_add_u32 s65, s68, 4096
    buffer_load_dwordx4 v24, s[44:47], s65 offen offset:0 nt lds
    s_waitcnt vmcnt(31)
    buffer_load_dwordx4 v25, s[44:47], s65 offen offset:1024 nt lds
    s_waitcnt vmcnt(31)
    buffer_load_dwordx4 v26, s[44:47], s65 offen offset:2048 nt lds
    s_waitcnt vmcnt(31)
    s_sub_u32 s7, s60, 24
    s_max_i32 s61, s61, s7
    v_mov_b32 v19, s61
    ds_write_b32 v16, v19
    buffer_load_dwordx4 v27, s[44:47], s65 offen offset:3072 nt lds
    s_waitcnt vmcnt(31)
    s_add_u32 s7, s64, 8192
    s_mov_b32 m0, s7
    s_add_u32 s65, s68, 8192
    buffer_load_dwordx4 v28, s[44:47], s65 offen offset:0 nt lds
    s_waitcnt vmcnt(31)
    buffer_load_dwordx4 v29, s[44:47], s65 offen offset:1024 nt lds
    s_waitcnt vmcnt(31)
    buffer_load_dwordx4 v30, s[44:47], s65 offen offset:2048 nt lds
    s_waitcnt vmcnt(31)
    buffer_load_dwordx4 v31, s[44:47], s65 offen offset:3072 nt lds
    s_waitcnt vmcnt(31)
    s_add_u32 s7, s64, 12288
    s_mov_b32 m0, s7
    s_add_u32 s65, s68, 12288
    buffer_load_dwordx4 v32, s[44:47], s65 offen offset:0 nt lds
    s_waitcnt vmcnt(31)
    buffer_load_dwordx4 v33, s[44:47], s65 offen offset:1024 nt lds
    ds_read_b32 v18, v17
    s_waitcnt vmcnt(31)
    buffer_load_dwordx4 v34, s[44:47], s65 offen offset:2048 nt lds
    s_waitcnt vmcnt(31)
    s_sub_u32 s7, s60, 16
    s_max_i32 s61, s61, s7
    v_mov_b32 v19, s61
    ds_write_b32 v16, v19
    buffer_load_dwordx4 v35, s[44:47], s65 offen offset:3072 nt lds
    s_add_u32 s60, s60, 16
    s_add_u32 s68, s68, 16384
    s_xor_b32 s7, s68, s70
    s_and_b32 s7, s7, 0xfffc0000
    s_xor_b32 s68, s68, s7
    s_add_u32 s64, s64, 16384
    s_cmp_eq_u32 s64, 147456
    s_cselect_b32 s64, 0, s64
    s_sub_u32 s66, s66, 1
    s_cmp_lg_u32 s66, 0
    s_cbranch_scc1 LL_80
    s_and_b32 s7, s69, 7
    s_lshl_b64 exec, 1, s7
    buffer_store_dwordx2 v[42:43], v38, s[36:39], 0 offen offset:2048 sc1
    s_mov_b64 exec, -1
    buffer_load_dwordx2 v[46:47], v38, s[36:39], 0 offen sc1
    s_lshr_b32 s65, s69, 3
    s_lshl_b32 s65, s65, 17
    s_and_b32 s7, s69, 7
    s_lshl_b32 s7, s7, 7
    s_add_u32 s65, s65, s7
    s_mov_b32 s64, 114688
    s_mov_b32 s63, 24
    s_waitcnt lgkmcnt(0)
    v_readlane_b32 s79, v18, 0
    s_cmp_lt_u32 s79, s63
    s_cbranch_scc1 ST_84
GO_83:
    s_mov_b32 s66, 1
LL_85:
    s_waitcnt vmcnt(31)
    s_mov_b32 m0, s64
    s_add_u32 s64, s64, 1024
    buffer_load_dwordx4 v10, s[48:51], s65 offen nt lds
    s_add_u32 s65, s65, 8192
    s_waitcnt vmcnt(31)
    s_mov_b32 m0, s64
    s_add_u32 s64, s64, 1024
    buffer_load_dwordx4 v10, s[48:51], s65 offen nt lds
    s_add_u32 s65, s65, 8192
    s_waitcnt vmcnt(31)
    s_mov_b32 m0, s64
    s_add_u32 s64, s64, 1024
    buffer_load_dwordx4 v10, s[48:51], s65 offen nt lds
    s_add_u32 s65, s65, 8192
    s_waitcnt vmcnt(31)
    s_mov_b32 m0, s64
    s_add_u32 s64, s64, 1024
    buffer_load_dwordx4 v10, s[48:51], s65 offen nt lds
    s_add_u32 s65, s65, 8192
    s_waitcnt vmcnt(31)
    s_mov_b32 m0, s64
    s_add_u32 s64, s64, 1024
    buffer_load_dwordx4 v10, s[48:51], s65 offen nt lds
    s_add_u32 s65, s65, 8192
    s_waitcnt vmcnt(31)
    s_mov_b32 m0, s64
    s_add_u32 s64, s64, 1024
    buffer_load_dwordx4 v10, s[48:51], s65 offen nt lds
    s_add_u32 s65, s65, 8192
    s_waitcnt vmcnt(31)
    s_mov_b32 m0, s64
    s_add_u32 s64, s64, 1024
    buffer_load_dwordx4 v10, s[48:51], s65 offen nt lds
    s_add_u32 s65, s65, 8192
    s_waitcnt vmcnt(31)
    s_sub_u32 s7, s60, 24
    s_max_i32 s61, s61, s7
    v_mov_b32 v19, s61
    ds_write_b32 v16, v19
    s_mov_b32 m0, s64
    s_add_u32 s64, s64, 1024
    buffer_load_dwordx4 v10, s[48:51], s65 offen nt lds
    s_add_u32 s65, s65, 8192
    s_waitcnt vmcnt(31)
    s_mov_b32 m0, s64
    s_add_u32 s64, s64, 1024
    buffer_load_dwordx4 v10, s[48:51], s65 offen nt lds
    s_add_u32 s65, s65, 8192
    s_waitcnt vmcnt(31)
    s_mov_b32 m0, s64
    s_add_u32 s64, s64, 1024
    buffer_load_dwordx4 v10, s[48:51], s65 offen nt lds
    s_add_u32 s65, s65, 8192
    s_waitcnt vmcnt(31)
    s_mov_b32 m0, s64
    s_add_u32 s64, s64, 1024
    buffer_load_dwordx4 v10, s[48:51], s65 offen nt lds
    s_add_u32 s65, s65, 8192
    s_waitcnt vmcnt(31)
    s_mov_b32 m0, s64
    s_add_u32 s64, s64, 1024
    buffer_load_dwordx4 v10, s[48:51], s65 offen nt lds
    s_add_u32 s65, s65, 8192
    s_waitcnt vmcnt(31)
    s_mov_b32 m0, s64
    s_add_u32 s64, s64, 1024
    buffer_load_dwordx4 v10, s[48:51], s65 offen nt lds
    s_add_u32 s65, s65, 8192
    s_waitcnt vmcnt(31)
    s_mov_b32 m0, s64
    s_add_u32 s64, s64, 1024
    buffer_load_dwordx4 v10, s[48:51], s65 offen nt lds
    s_add_u32 s65, s65, 8192
    s_waitcnt vmcnt(31)
    s_mov_b32 m0, s64
    s_add_u32 s64, s64, 1024
    buffer_load_dwordx4 v10, s[48:51], s65 offen nt lds
    s_add_u32 s65, s65, 8192
    s_waitcnt vmcnt(31)
    s_sub_u32 s7, s60, 16
    s_max_i32 s61, s61, s7
    v_mov_b32 v19, s61
    ds_write_b32 v16, v19
    s_mov_b32 m0, s64
    s_add_u32 s64, s64, 1024
    buffer_load_dwordx4 v10, s[48:51], s65 offen nt lds
    s_add_u32 s65, s65, 8192
    s_add_u32 s60, s60, 16
    s_add_u32 s65, s65, 917504
    s_sub_u32 s66, s66, 1
    s_cmp_lg_u32 s66, 0
    s_cbranch_scc1 LL_85
    s_waitcnt vmcnt(24)
    s_sub_u32 s7, s60, 24
    s_max_i32 s61, s61, s7
    v_mov_b32 v19, s61
    ds_write_b32 v16, v19
    s_waitcnt vmcnt(16)
    s_sub_u32 s7, s60, 16
    s_max_i32 s61, s61, s7
    v_mov_b32 v19, s61
    ds_write_b32 v16, v19
    s_waitcnt vmcnt(8)
    s_sub_u32 s7, s60, 8
    s_max_i32 s61, s61, s7
    v_mov_b32 v19, s61
    ds_write_b32 v16, v19
    s_waitcnt vmcnt(0)
    s_mov_b32 s61, s60
    v_mov_b32 v19, s61
    ds_write_b32 v16, v19
    v_and_b32 v45, 31, v1
    v_lshlrev_b32 v45, 3, v45
    v_lshrrev_b32 v48, 5, v1
    v_lshl_add_u32 v45, v48, 11, v45
    v_add_u32 v45, 0x24400, v45
    s_or_b32 s7, s92, s78
    v_cmp_ne_u32 vcc, s7, v46
    s_cmp_eq_u64 vcc, 0
    s_cselect_b32 s101, 1, 0
    v_mov_b32 v48, 0x2420c
    s_mov_b32 s80, 1600000
LW_87:
    ds_read_b32 v49, v48
    s_waitcnt lgkmcnt(0)
    v_readfirstlane_b32 s79, v49
    s_cmp_ge_u32 s79, 40
    s_cbranch_scc1 LWD_88
    s_sub_u32 s80, s80, 1
    s_cmp_lg_u32 s80, 0
    s_cbranch_scc1 LW_87
LWD_88:
    ds_read_b64 v[48:49], v45 offset:0
    ds_read_b64 v[50:51], v45 offset:256
    ds_read_b64 v[52:53], v45 offset:512
    ds_read_b64 v[54:55], v45 offset:768
    ds_read_b64 v[56:57], v45 offset:1024
    ds_read_b64 v[58:59], v45 offset:1280
    ds_read_b64 v[60:61], v45 offset:1536
    ds_read_b64 v[62:63], v45 offset:1792
    s_waitcnt lgkmcnt(0)
    v_max3_f32 v40, v48, v50, v52
    v_max3_f32 v40, v40, v54, v56
    v_max3_f32 v40, v40, v58, v60
    v_max_f32 v40, v40, v62
    v_mov_b32 v41, v40
    s_nop 1
    v_permlane32_swap_b32 v40, v41
    v_max_f32 v40, v40, v41
    v_sub_f32 v48, v48, v40
    v_sub_f32 v50, v50, v40
    v_sub_f32 v52, v52, v40
    v_sub_f32 v54, v54, v40
    v_sub_f32 v56, v56, v40
    v_sub_f32 v58, v58, v40
    v_sub_f32 v60, v60, v40
    v_sub_f32 v62, v62, v40
    v_exp_f32 v48, v48
    v_exp_f32 v50, v50
    v_exp_f32 v52, v52
    v_exp_f32 v54, v54
    v_exp_f32 v56, v56
    v_exp_f32 v58, v58
    v_exp_f32 v60, v60
    v_exp_f32 v62, v62
    v_mul_f32 v41, v48, v49
    v_fmac_f32 v41, v50, v51
    v_fmac_f32 v41, v52, v53
    v_fmac_f32 v41, v54, v55
    v_fmac_f32 v41, v56, v57
    v_fmac_f32 v41, v58, v59
    v_fmac_f32 v41, v60, v61
    v_fmac_f32 v41, v62, v63
    v_mov_b32 v48, v41
    s_nop 1
    v_permlane32_swap_b32 v41, v48
    v_add_f32 v41, v41, v48
    s_mov_b64 exec, 0xffffffff
    s_cmp_eq_u32 s101, 0
    s_cbranch_scc1 SU_89
    buffer_store_dwordx4 v[40:43], v44, s[36:39], 0 offen
SV_90:
    s_mov_b64 exec, -1
    v_mov_b32 v48, 0x24218
    s_mov_b32 s80, 1600000
LW_91:
    ds_read_b32 v49, v48
    s_waitcnt lgkmcnt(0)
    v_readfirstlane_b32 s79, v49
    s_cmp_ge_u32 s79, 16
    s_cbranch_scc1 LWD_92
    s_sleep 1
    s_sub_u32 s80, s80, 1
    s_cmp_lg_u32 s80, 0
    s_cbranch_scc1 LW_91
LWD_92:
LWO_86:
    s_mov_b32 s66, 1
LL_93:
    s_waitcnt vmcnt(31)
    s_mov_b32 m0, s64
    s_add_u32 s64, s64, 1024
    buffer_load_dwordx4 v10, s[48:51], s65 offen nt lds
    s_add_u32 s65, s65, 8192
    s_waitcnt vmcnt(31)
    s_mov_b32 m0, s64
    s_add_u32 s64, s64, 1024
    buffer_load_dwordx4 v10, s[48:51], s65 offen nt lds
    s_add_u32 s65, s65, 8192
    s_waitcnt vmcnt(31)
    s_mov_b32 m0, s64
    s_add_u32 s64, s64, 1024
    buffer_load_dwordx4 v10, s[48:51], s65 offen nt lds
    s_add_u32 s65, s65, 8192
    s_waitcnt vmcnt(31)
    s_mov_b32 m0, s64
    s_add_u32 s64, s64, 1024
    buffer_load_dwordx4 v10, s[48:51], s65 offen nt lds
    s_add_u32 s65, s65, 8192
    s_waitcnt vmcnt(31)
    s_mov_b32 m0, s64
    s_add_u32 s64, s64, 1024
    buffer_load_dwordx4 v10, s[48:51], s65 offen nt lds
    s_add_u32 s65, s65, 8192
    s_waitcnt vmcnt(31)
    s_mov_b32 m0, s64
    s_add_u32 s64, s64, 1024
    buffer_load_dwordx4 v10, s[48:51], s65 offen nt lds
    s_add_u32 s65, s65, 8192
    s_waitcnt vmcnt(31)
    s_mov_b32 m0, s64
    s_add_u32 s64, s64, 1024
    buffer_load_dwordx4 v10, s[48:51], s65 offen nt lds
    s_add_u32 s65, s65, 8192
    s_waitcnt vmcnt(31)
    s_sub_u32 s7, s60, 24
    s_max_i32 s61, s61, s7
    v_mov_b32 v19, s61
    ds_write_b32 v16, v19
    s_mov_b32 m0, s64
    s_add_u32 s64, s64, 1024
    buffer_load_dwordx4 v10, s[48:51], s65 offen nt lds
    s_add_u32 s65, s65, 8192
    s_waitcnt vmcnt(31)
    s_mov_b32 m0, s64
    s_add_u32 s64, s64, 1024
    buffer_load_dwordx4 v10, s[48:51], s65 offen nt lds
    s_add_u32 s65, s65, 8192
    s_waitcnt vmcnt(31)
    s_mov_b32 m0, s64
    s_add_u32 s64, s64, 1024
    buffer_load_dwordx4 v10, s[48:51], s65 offen nt lds
    s_add_u32 s65, s65, 8192
    s_waitcnt vmcnt(31)
    s_mov_b32 m0, s64
    s_add_u32 s64, s64, 1024
    buffer_load_dwordx4 v10, s[48:51], s65 offen nt lds
    s_add_u32 s65, s65, 8192
    s_waitcnt vmcnt(31)
    s_mov_b32 m0, s64
    s_add_u32 s64, s64, 1024
    buffer_load_dwordx4 v10, s[48:51], s65 offen nt lds
    s_add_u32 s65, s65, 8192
    s_waitcnt vmcnt(31)
    s_mov_b32 m0, s64
    s_add_u32 s64, s64, 1024
    buffer_load_dwordx4 v10, s[48:51], s65 offen nt lds
    s_add_u32 s65, s65, 8192
    s_waitcnt vmcnt(31)
    s_mov_b32 m0, s64
    s_add_u32 s64, s64, 1024
    buffer_load_dwordx4 v10, s[48:51], s65 offen nt lds
    s_add_u32 s65, s65, 8192
    s_waitcnt vmcnt(31)
    s_mov_b32 m0, s64
    s_add_u32 s64, s64, 1024
    buffer_load_dwordx4 v10, s[48:51], s65 offen nt lds
    s_add_u32 s65, s65, 8192
    s_waitcnt vmcnt(31)
    s_sub_u32 s7, s60, 16
    s_max_i32 s61, s61, s7
    v_mov_b32 v19, s61
    ds_write_b32 v16, v19
    s_mov_b32 m0, s64
    s_add_u32 s64, s64, 1024
    buffer_load_dwordx4 v10, s[48:51], s65 offen nt lds
    s_add_u32 s65, s65, 8192
    s_add_u32 s60, s60, 16
    s_add_u32 s65, s65, 917504
    s_sub_u32 s66, s66, 1
    s_cmp_lg_u32 s66, 0
    s_cbranch_scc1 LL_93
    s_mov_b32 s64, 0
    s_mov_b32 s66, 2
LL_94:
    s_waitcnt vmcnt(31)
    s_mov_b32 m0, s64
    s_add_u32 s64, s64, 1024
    buffer_load_dwordx4 v10, s[48:51], s65 offen nt lds
    s_add_u32 s65, s65, 8192
    s_waitcnt vmcnt(31)
    s_mov_b32 m0, s64
    s_add_u32 s64, s64, 1024
    buffer_load_dwordx4 v10, s[48:51], s65 offen nt lds
    s_add_u32 s65, s65, 8192
    s_waitcnt vmcnt(31)
    s_mov_b32 m0, s64
    s_add_u32 s64, s64, 1024
    buffer_load_dwordx4 v10, s[48:51], s65 offen nt lds
    s_add_u32 s65, s65, 8192
    s_waitcnt vmcnt(31)
    s_mov_b32 m0, s64
    s_add_u32 s64, s64, 1024
    buffer_load_dwordx4 v10, s[48:51], s65 offen nt lds
    s_add_u32 s65, s65, 8192
    s_waitcnt vmcnt(31)
    s_mov_b32 m0, s64
    s_add_u32 s64, s64, 1024
    buffer_load_dwordx4 v10, s[48:51], s65 offen nt lds
    s_add_u32 s65, s65, 8192
    s_waitcnt vmcnt(31)
    s_mov_b32 m0, s64
    s_add_u32 s64, s64, 1024
    buffer_load_dwordx4 v10, s[48:51], s65 offen nt lds
    s_add_u32 s65, s65, 8192
    s_waitcnt vmcnt(31)
    s_mov_b32 m0, s64
    s_add_u32 s64, s64, 1024
    buffer_load_dwordx4 v10, s[48:51], s65 offen nt lds
    s_add_u32 s65, s65, 8192
    s_waitcnt vmcnt(31)
    s_sub_u32 s7, s60, 24
    s_max_i32 s61, s61, s7
    v_mov_b32 v19, s61
    ds_write_b32 v16, v19
    s_mov_b32 m0, s64
    s_add_u32 s64, s64, 1024
    buffer_load_dwordx4 v10, s[48:51], s65 offen nt lds
    s_add_u32 s65, s65, 8192
    s_waitcnt vmcnt(31)
    s_mov_b32 m0, s64
    s_add_u32 s64, s64, 1024
    buffer_load_dwordx4 v10, s[48:51], s65 offen nt lds
    s_add_u32 s65, s65, 8192
    s_waitcnt vmcnt(31)
    s_mov_b32 m0, s64
    s_add_u32 s64, s64, 1024
    buffer_load_dwordx4 v10, s[48:51], s65 offen nt lds
    s_add_u32 s65, s65, 8192
    s_waitcnt vmcnt(31)
    s_mov_b32 m0, s64
    s_add_u32 s64, s64, 1024
    buffer_load_dwordx4 v10, s[48:51], s65 offen nt lds
    s_add_u32 s65, s65, 8192
    s_waitcnt vmcnt(31)
    s_mov_b32 m0, s64
    s_add_u32 s64, s64, 1024
    buffer_load_dwordx4 v10, s[48:51], s65 offen nt lds
    s_add_u32 s65, s65, 8192
    s_waitcnt vmcnt(31)
    s_mov_b32 m0, s64
    s_add_u32 s64, s64, 1024
    buffer_load_dwordx4 v10, s[48:51], s65 offen nt lds
    s_add_u32 s65, s65, 8192
    s_waitcnt vmcnt(31)
    s_mov_b32 m0, s64
    s_add_u32 s64, s64, 1024
    buffer_load_dwordx4 v10, s[48:51], s65 offen nt lds
    s_add_u32 s65, s65, 8192
    s_waitcnt vmcnt(31)
    s_mov_b32 m0, s64
    s_add_u32 s64, s64, 1024
    buffer_load_dwordx4 v10, s[48:51], s65 offen nt lds
    s_add_u32 s65, s65, 8192
    s_waitcnt vmcnt(31)
    s_sub_u32 s7, s60, 16
    s_max_i32 s61, s61, s7
    v_mov_b32 v19, s61
    ds_write_b32 v16, v19
    s_mov_b32 m0, s64
    s_add_u32 s64, s64, 1024
    buffer_load_dwordx4 v10, s[48:51], s65 offen nt lds
    s_add_u32 s65, s65, 8192
    s_add_u32 s60, s60, 16
    s_add_u32 s65, s65, 917504
    s_sub_u32 s66, s66, 1
    s_cmp_lg_u32 s66, 0
    s_cbranch_scc1 LL_94
    s_waitcnt vmcnt(24)
    s_sub_u32 s7, s60, 24
    s_max_i32 s61, s61, s7
    v_mov_b32 v19, s61
    ds_write_b32 v16, v19
    s_waitcnt vmcnt(16)
    s_sub_u32 s7, s60, 16
    s_max_i32 s61, s61, s7
    v_mov_b32 v19, s61
    ds_write_b32 v16, v19
    s_waitcnt vmcnt(8)
    s_sub_u32 s7, s60, 8
    s_max_i32 s61, s61, s7
    v_mov_b32 v19, s61
    ds_write_b32 v16, v19
    s_waitcnt vmcnt(0)
    s_mov_b32 s61, s60
    v_mov_b32 v19, s61
    ds_write_b32 v16, v19
    s_cmp_eq_u32 s5, 7
    s_cbranch_scc1 L_END
    s_mov_b32 s52, s30
    s_and_b32 s53, s31, 0xffff
    s_mov_b32 s54, 0x2000
    s_mov_b32 s55, 0x20000
    s_mov_b32 s84, 0x3f80
    s_mov_b32 s85, 0x3f800000
    s_lshl_b32 s7, s4, 11
    s_add_u32 s7, s7, 0x2c0000
    v_lshl_add_u32 v36, v1, 4, s7
    s_lshl_b32 s7, s4, 5
    s_add_u32 s7, s7, 1024
    v_and_b32 v38, 3, v1
    v_lshl_add_u32 v37, v38, 3, s7
    v_lshrrev_b32 v38, 2, v3
    v_lshl_add_u32 v37, v38, 11, v37
    v_mov_b32 v38, 0x24214
    s_mov_b32 s80, 1600000
LW_95:
    ds_read_b32 v39, v38
    s_waitcnt lgkmcnt(0)
    v_readfirstlane_b32 s79, v39
    s_cmp_ge_u32 s79, 4
    s_cbranch_scc1 LWD_96
    s_sleep 1
    s_sub_u32 s80, s80, 1
    s_cmp_lg_u32 s80, 0
    s_cbranch_scc1 LW_95
LWD_96:
    s_mov_b64 exec, -1
    buffer_load_dwordx4 v[48:51], v36, s[36:39], 0 offen offset:0 sc1
    buffer_load_dwordx4 v[52:55], v36, s[36:39], 0 offen offset:1024 sc1
    s_mov_b32 s80, 200000
MC_98:
    s_mov_b64 exec, -1
    s_waitcnt vmcnt(0)
    v_cmp_ne_u64 s[62:63], s[92:93], v[50:51]
    v_cmp_ne_u64 s[64:65], s[92:93], v[54:55]
    s_or_b64 s[90:91], s[62:63], s[64:65]
    s_cbranch_scc1 M_97
MD_99:
    s_mov_b64 exec, -1
    v_dot2_f32_bf16 v44, v48, s84, 0
    v_dot2_f32_bf16 v45, v48, s85, 0
    v_dot2_f32_bf16 v46, v49, s84, 0
    v_dot2_f32_bf16 v47, v49, s85, 0
    v_dot2_f32_bf16 v44, v52, s84, v44
    v_dot2_f32_bf16 v45, v52, s85, v45
    v_dot2_f32_bf16 v46, v53, s84, v46
    v_dot2_f32_bf16 v47, v53, s85, v47
    s_nop 1
    v_permlane32_swap_b32 v44, v46
    v_permlane32_swap_b32 v45, v47
    v_add_f32 v44, v44, v46
    v_add_f32 v45, v45, v47
    v_mov_b32 v46, v44
    v_mov_b32 v47, v45
    s_nop 0
    v_permlane16_swap_b32 v44, v46
    v_permlane16_swap_b32 v45, v47
    v_add_f32 v44, v44, v46
    v_add_f32 v45, v45, v47
    v_cvt_pk_bf16_f32 v44, v44, v45
    v_mov_b32 v45, v44
    s_nop 1
    v_permlane32_swap_b32 v44, v45
    s_mov_b64 exec, 0xffff
    buffer_store_dwordx2 v[44:45], v37, s[52:55], 0 offen
    s_mov_b64 exec, -1
    s_endpgm
L_AATT:
    v_lshl_add_u32 v8, v2, 4, s63
    s_waitcnt lgkmcnt(0)
    ds_read_b128 v[16:19], v8 offset:0
    ds_read_b128 v[20:23], v8 offset:64
    ds_read_b128 v[24:27], v8 offset:128
    ds_read_b128 v[28:31], v8 offset:192
    v_xor_b32 v4, v3, v2
    v_lshlrev_b32 v4, 4, v4
    v_lshl_add_u32 v4, v3, 8, v4
    v_lshrrev_b32 v9, 2, v1
    v_and_b32 v5, 7, v9
    v_lshlrev_b32 v5, 5, v5
    v_lshl_add_u32 v5, v9, 8, v5
    v_and_b32 v10, 3, v1
    v_lshl_add_u32 v5, v10, 3, v5
    s_lshl_b32 s7, s61, 10
    s_add_u32 s7, s7, 0x24e00
    v_lshl_add_u32 v6, v2, 4, s7
    v_cmp_eq_u32 s[84:85], 0, v3
    s_mov_b32 s72, 0x3e0293ee
    s_cmp_ge_u32 s5, 4
    s_cselect_b32 s73, 10, 8
    s_cselect_b32 s69, 8, 4
    s_cselect_b32 s70, 13, 11
    s_cselect_b32 s74, 20, 22
    s_add_u32 s70, s70, s61
    s_add_u32 s74, s74, s70
    s_lshl_b32 s70, s70, 3
    s_add_u32 s69, s69, s61
    s_cmp_ge_u32 s69, 18
    s_cselect_b32 s7, 18, 0
    s_sub_u32 s69, s69, s7
    s_mov_b32 s71, s68
AK_100:
    s_lshl_b32 s7, s69, 13
    v_add_u32 v104, s7, v4
    v_xor_b32 v105, 0x40, v104
    v_xor_b32 v106, 0x80, v104
    v_xor_b32 v107, 0xc0, v104
    s_lshl_b32 s62, s69, 2
    s_add_u32 s62, s62, 0x24100
    v_mov_b32 v8, 0x24000
    s_mov_b32 s80, 1600000
LW_101:
    ds_read_b32 v9, v8
    s_waitcnt lgkmcnt(0)
    v_readfirstlane_b32 s79, v9
    s_cmp_ge_u32 s79, s70
    s_cbranch_scc1 LWD_102
    s_sleep 2
    s_sub_u32 s80, s80, 1
    s_cmp_lg_u32 s80, 0
    s_cbranch_scc1 LW_101
LWD_102:
    ds_read_b128 v[32:35], v104 offset:0
    ds_read_b128 v[36:39], v104 offset:4096
    ds_read_b128 v[40:43], v105 offset:0
    ds_read_b128 v[44:47], v105 offset:4096
    ds_read_b128 v[48:51], v106 offset:0
    ds_read_b128 v[52:55], v106 offset:4096
    ds_read_b128 v[56:59], v107 offset:0
    ds_read_b128 v[60:63], v107 offset:4096
    s_waitcnt lgkmcnt(6)
    v_mfma_f32_16x16x32_bf16 v[64:67], v[32:35], v[16:19], 0
    v_mfma_f32_16x16x32_bf16 v[68:71], v[36:39], v[16:19], 0
    s_waitcnt lgkmcnt(4)
    v_mfma_f32_16x16x32_bf16 v[64:67], v[40:43], v[20:23], v[64:67]
    v_mfma_f32_16x16x32_bf16 v[68:71], v[44:47], v[20:23], v[68:71]
    s_waitcnt lgkmcnt(2)
    v_mfma_f32_16x16x32_bf16 v[64:67], v[48:51], v[24:27], v[64:67]
    v_mfma_f32_16x16x32_bf16 v[68:71], v[52:55], v[24:27], v[68:71]
    s_waitcnt lgkmcnt(0)
    v_mfma_f32_16x16x32_bf16 v[64:67], v[56:59], v[28:31], v[64:67]
    v_mfma_f32_16x16x32_bf16 v[68:71], v[60:63], v[28:31], v[68:71]
    v_mov_b32 v8, s62
    v_mov_b32 v9, 4
    s_mov_b64 exec, 1
    ds_add_u32 v8, v9
    s_mov_b64 exec, -1
    s_mov_b64 exec, s[84:85]
    s_nop 0
    ds_write_b128 v6, v[64:67] offset:0
    ds_write_b128 v6, v[68:71] offset:64
    s_mov_b64 exec, -1
    v_add_u32 v6, 128, v6
    s_add_u32 s69, s69, 4
    s_cmp_ge_u32 s69, 18
    s_cselect_b32 s7, 18, 0
    s_sub_u32 s69, s69, s7
    s_add_u32 s70, s70, 32
    s_sub_u32 s71, s71, 1
    s_cmp_lg_u32 s71, 0
    s_cbranch_scc1 AK_100
    v_lshrrev_b32 v8, 2, v1
    v_cmp_gt_u32 s[86:87], s68, v8
    v_and_b32 v8, 7, v8
    v_and_b32 v9, 3, v1
    v_lshlrev_b32 v9, 4, v9
    v_lshl_add_u32 v10, v8, 7, v9
    s_lshl_b32 s7, s61, 10
    s_add_u32 s7, s7, 0x24e00
    v_add_u32 v10, s7, v10
    s_waitcnt lgkmcnt(0)
    ds_read_b128 v[32:35], v10
    ds_read_b128 v[36:39], v10 offset:64
    s_lshl_b32 s7, s61, 9
    s_add_u32 s7, s7, 0x25e00
    v_lshl_add_u32 v10, v8, 6, v9
    v_add_u32 v10, s7, v10
    v_lshl_add_u32 v7, v2, 4, s7
    v_mov_b32 v11, 0xff800000
    s_waitcnt lgkmcnt(0)
    v_cndmask_b32 v32, v11, v32, s[86:87]
    v_cndmask_b32 v33, v11, v33, s[86:87]
    v_cndmask_b32 v34, v11, v34, s[86:87]
    v_cndmask_b32 v35, v11, v35, s[86:87]
    v_cndmask_b32 v36, v11, v36, s[86:87]
    v_cndmask_b32 v37, v11, v37, s[86:87]
    v_cndmask_b32 v38, v11, v38, s[86:87]
    v_cndmask_b32 v39, v11, v39, s[86:87]
    v_max3_f32 v64, v32, v33, v34
    v_max3_f32 v64, v64, v35, v36
    v_max3_f32 v64, v64, v37, v38
    v_max_f32 v64, v64, v39
    s_nop 1
    v_max_f32_dpp v64, v64, v64 row_ror:1 row_mask:0xf bank_mask:0xf
    s_nop 1
    v_max_f32_dpp v64, v64, v64 row_ror:2 row_mask:0xf bank_mask:0xf
    s_nop 1
    v_max_f32_dpp v64, v64, v64 row_ror:4 row_mask:0xf bank_mask:0xf
    s_nop 1
    v_max_f32_dpp v64, v64, v64 row_ror:8 row_mask:0xf bank_mask:0xf
    v_mov_b32 v11, v64
    s_nop 1
    v_permlane32_swap_b32 v64, v11
    v_max_f32 v64, v64, v11
    v_mov_b32 v11, v64
    s_nop 1
    v_permlane16_swap_b32 v64, v11
    v_max_f32 v64, v64, v11
    v_mul_f32 v64, s72, v64
    v_fma_f32 v32, v32, s72, -v64
    v_fma_f32 v33, v33, s72, -v64
    v_fma_f32 v34, v34, s72, -v64
    v_fma_f32 v35, v35, s72, -v64
    v_fma_f32 v36, v36, s72, -v64
    v_fma_f32 v37, v37, s72, -v64
    v_fma_f32 v38, v38, s72, -v64
    v_fma_f32 v39, v39, s72, -v64
    v_exp_f32 v32, v32
    v_exp_f32 v33, v33
    v_exp_f32 v34, v34
    v_exp_f32 v35, v35
    v_exp_f32 v36, v36
    v_exp_f32 v37, v37
    v_exp_f32 v38, v38
    v_exp_f32 v39, v39
    v_cvt_pk_bf16_f32 v112, v32, v33
    v_cvt_pk_bf16_f32 v113, v34, v35
    v_cvt_pk_bf16_f32 v114, v36, v37
    v_cvt_pk_bf16_f32 v115, v38, v39
    s_mov_b64 exec, s[86:87]
    ds_write_b128 v10, v[112:115]
    s_mov_b64 exec, -1
    v_add_f32 v32, v32, v36
    v_add_f32 v33, v33, v37
    v_add_f32 v34, v34, v38
    v_add_f32 v35, v35, v39
    v_add_f32 v32, v32, v34
    v_add_f32 v33, v33, v35
    v_add_f32 v32, v32, v33
    v_mov_b32 v65, v32
    s_nop 1
    v_add_f32_dpp v65, v65, v65 row_ror:1 row_mask:0xf bank_mask:0xf
    s_nop 1
    v_add_f32_dpp v65, v65, v65 row_ror:2 row_mask:0xf bank_mask:0xf
    s_nop 1
    v_add_f32_dpp v65, v65, v65 row_ror:4 row_mask:0xf bank_mask:0xf
    s_nop 1
    v_add_f32_dpp v65, v65, v65 row_ror:8 row_mask:0xf bank_mask:0xf
    v_mov_b32 v11, v65
    s_nop 1
    v_permlane32_swap_b32 v65, v11
    v_add_f32 v65, v65, v11
    v_mov_b32 v11, v65
    s_nop 1
    v_permlane16_swap_b32 v65, v11
    v_add_f32 v65, v65, v11
    v_mov_b32 v8, 0x24204
    s_mov_b32 s80, 1600000
LW_103:
    ds_read_b32 v9, v8
    s_waitcnt lgkmcnt(0)
    v_readfirstlane_b32 s79, v9
    s_cmp_ge_u32 s79, 1
    s_cbranch_scc1 LWD_104
    s_sleep 1
    s_sub_u32 s80, s80, 1
    s_cmp_lg_u32 s80, 0
    s_cbranch_scc1 LW_103
LWD_104:
    v_mov_b32 v8, 0x24248
    ds_read_b64 v[10:11], v8
    s_waitcnt lgkmcnt(0)
    v_readfirstlane_b32 s92, v10
    v_readfirstlane_b32 s93, v11
    s_nop 0
    v_mov_b32 v66, s92
    v_mov_b32 v67, s93
    s_lshl_b32 s7, s4, 2
    s_add_u32 s7, s7, s66
    s_lshl_b32 s7, s7, 3
    s_add_u32 s7, s7, s5
    s_lshl_b32 s7, s7, 4
    s_add_u32 s7, s7, 0x24000
    v_mov_b32 v8, s7
    s_mov_b64 exec, 1
    s_cmp_eq_u32 s101, 0
    s_cbranch_scc1 SU_105
    buffer_store_dwordx4 v[64:67], v8, s[36:39], 0 offen
SV_106:
    s_mov_b64 exec, -1
    s_and_b32 s7, s7, -128
    v_lshl_add_u32 v12, v1, 4, s7
    v_or_b32 v70, 1, v66
    v_mov_b32 v71, v67
    v_mov_b32 v116, 0xff800000
    v_mov_b32 v117, 0
    v_mov_b32 v72, 0
    v_mov_b32 v73, 0
    v_mov_b32 v74, 0
    v_mov_b32 v75, 0
    v_mov_b32 v76, 0
    v_mov_b32 v77, 0
    v_mov_b32 v78, 0
    v_mov_b32 v79, 0
    v_mov_b32 v80, 0
    v_mov_b32 v81, 0
    v_mov_b32 v82, 0
    v_mov_b32 v83, 0
    v_mov_b32 v84, 0
    v_mov_b32 v85, 0
    v_mov_b32 v86, 0
    v_mov_b32 v87, 0
    v_mov_b32 v88, 0
    v_mov_b32 v89, 0
    v_mov_b32 v90, 0
    v_mov_b32 v91, 0
    v_mov_b32 v92, 0
    v_mov_b32 v93, 0
    v_mov_b32 v94, 0
    v_mov_b32 v95, 0
    v_mov_b32 v96, 0
    v_mov_b32 v97, 0
    v_mov_b32 v98, 0
    v_mov_b32 v99, 0
    v_mov_b32 v100, 0
    v_mov_b32 v101, 0
    v_mov_b32 v102, 0
    v_mov_b32 v103, 0
    s_lshl_b32 s7, s4, 3
    s_add_u32 s7, s7, s5
    s_lshl_b32 s7, s7, 2
    s_add_u32 s7, s7, s66
    s_lshl_b32 s7, s7, 9
    s_add_u32 s7, s7, 0x100000
    v_lshl_add_u32 v6, v1, 4, s7
    s_add_u32 s69, s73, s61
    s_lshl_b32 s70, s74, 3
    s_cmp_ge_u32 s69, 18
    s_cselect_b32 s7, 18, 0
    s_sub_u32 s69, s69, s7
    s_mov_b32 s71, s68
AV_107:
    s_lshl_b32 s7, s69, 13
    v_add_u32 v104, s7, v5
    v_xor_b32 v105, 0x20, v104
    v_xor_b32 v106, 0x40, v104
    v_xor_b32 v107, 0x60, v104
    v_xor_b32 v108, 0x80, v104
    v_xor_b32 v109, 0xa0, v104
    v_xor_b32 v110, 0xc0, v104
    v_xor_b32 v111, 0xe0, v104
    s_lshl_b32 s62, s69, 2
    s_add_u32 s62, s62, 0x24100
    ds_read_b128 v[112:115], v7
    v_add_u32 v7, 64, v7
    s_cmp_le_u32 s71, 2
    s_cbranch_scc1 AW_108
AWB_109:
    v_mov_b32 v8, 0x24000
    s_mov_b32 s80, 1600000
LW_110:
    ds_read_b32 v9, v8
    s_waitcnt lgkmcnt(0)
    v_readfirstlane_b32 s79, v9
    s_cmp_ge_u32 s79, s70
    s_cbranch_scc1 LWD_111
    s_sleep 1
    s_sub_u32 s80, s80, 1
    s_cmp_lg_u32 s80, 0
    s_cbranch_scc1 LW_110
LWD_111:
    ds_read_b64_tr_b16 v[32:33], v104
    ds_read_b64_tr_b16 v[34:35], v104 offset:4096
    ds_read_b64_tr_b16 v[36:37], v105
    ds_read_b64_tr_b16 v[38:39], v105 offset:4096
    ds_read_b64_tr_b16 v[40:41], v106
    ds_read_b64_tr_b16 v[42:43], v106 offset:4096
    ds_read_b64_tr_b16 v[44:45], v107
    ds_read_b64_tr_b16 v[46:47], v107 offset:4096
    ds_read_b64_tr_b16 v[48:49], v108
    ds_read_b64_tr_b16 v[50:51], v108 offset:4096
    ds_read_b64_tr_b16 v[52:53], v109
    ds_read_b64_tr_b16 v[54:55], v109 offset:4096
    ds_read_b64_tr_b16 v[56:57], v110
    ds_read_b64_tr_b16 v[58:59], v110 offset:4096
    s_waitcnt lgkmcnt(12)
    v_mfma_f32_16x16x32_bf16 v[72:75], v[112:115], v[32:35], v[72:75]
    ds_read_b64_tr_b16 v[60:61], v111
    ds_read_b64_tr_b16 v[62:63], v111 offset:4096
    s_waitcnt lgkmcnt(12)
    v_mfma_f32_16x16x32_bf16 v[76:79], v[112:115], v[36:39], v[76:79]
    s_waitcnt lgkmcnt(10)
    v_mfma_f32_16x16x32_bf16 v[80:83], v[112:115], v[40:43], v[80:83]
    s_waitcnt lgkmcnt(8)
    v_mfma_f32_16x16x32_bf16 v[84:87], v[112:115], v[44:47], v[84:87]
    s_waitcnt lgkmcnt(6)
    v_mfma_f32_16x16x32_bf16 v[88:91], v[112:115], v[48:51], v[88:91]
    s_waitcnt lgkmcnt(4)
    v_mfma_f32_16x16x32_bf16 v[92:95], v[112:115], v[52:55], v[92:95]
    s_waitcnt lgkmcnt(2)
    v_mfma_f32_16x16x32_bf16 v[96:99], v[112:115], v[56:59], v[96:99]
    s_waitcnt lgkmcnt(0)
    v_mfma_f32_16x16x32_bf16 v[100:103], v[112:115], v[60:63], v[100:103]
    v_mov_b32 v8, s62
    v_mov_b32 v9, 4
    s_mov_b64 exec, 1
    ds_add_u32 v8, v9
    s_mov_b64 exec, -1
    s_add_u32 s69, s69, 4
    s_cmp_ge_u32 s69, 18
    s_cselect_b32 s7, 18, 0
    s_sub_u32 s69, s69, s7
    s_add_u32 s70, s70, 32
    s_sub_u32 s71, s71, 1
    s_cmp_lg_u32 s71, 0
    s_cbranch_scc1 AV_107
    v_mov_b32_dpp v72, v88 quad_perm:[0,1,2,3] row_mask:0x2 bank_mask:0xf
    v_mov_b32_dpp v76, v92 quad_perm:[0,1,2,3] row_mask:0x2 bank_mask:0xf
    v_mov_b32_dpp v80, v96 quad_perm:[0,1,2,3] row_mask:0x2 bank_mask:0xf
    v_mov_b32_dpp v84, v100 quad_perm:[0,1,2,3] row_mask:0x2 bank_mask:0xf
    v_mul_f32 v72, s72, v72
    v_mul_f32 v76, s72, v76
    v_mul_f32 v80, s72, v80
    v_mul_f32 v84, s72, v84
    v_cvt_pk_bf16_f32 v68, v72, v76
    v_cvt_pk_bf16_f32 v69, v80, v84
    s_mov_b64 exec, 0xffffffff
    s_cmp_eq_u32 s101, 0
    s_cbranch_scc1 SU_112
    buffer_store_dwordx4 v[68:71], v6, s[36:39], 0 offen
SV_113:
    s_mov_b64 exec, -1
    v_mov_b32 v8, 0x24214
    v_mov_b32 v9, 1
    s_mov_b64 exec, 1
    ds_add_u32 v8, v9
    s_mov_b64 exec, -1
    s_endpgm
L_ASVC:
    v_bfe_u32 v24, v1, 2, 2
    v_lshl_add_u32 v4, v24, 4, v2
    v_lshlrev_b32 v4, 8, v4
    v_and_b32 v25, 1, v2
    v_lshl_or_b32 v24, v24, 1, v25
    s_lshl_b32 s7, s61, 1
    v_xor_b32 v24, s7, v24
    v_lshl_add_u32 v4, v24, 5, v4
    v_and_b32 v24, 3, v1
    v_lshl_add_u32 v4, v24, 3, v4
    v_mov_b32 v28, 0x24000
    s_mov_b32 s80, 1600000
LW_114:
    ds_read_b32 v29, v28
    s_waitcnt lgkmcnt(0)
    v_readfirstlane_b32 s79, v29
    s_cmp_ge_u32 s79, 80
    s_cbranch_scc1 LWD_115
    s_sleep 4
    s_sub_u32 s80, s80, 1
    s_cmp_lg_u32 s80, 0
    s_cbranch_scc1 LW_114
LWD_115:
    v_xor_b32 v28, 0, v4
    ds_read_b64_tr_b16 v[32:33], v28 offset:0
    ds_read_b64_tr_b16 v[34:35], v28 offset:16384
    ds_read_b64_tr_b16 v[36:37], v28 offset:1024
    ds_read_b64_tr_b16 v[38:39], v28 offset:17408
    ds_read_b64_tr_b16 v[40:41], v28 offset:2048
    ds_read_b64_tr_b16 v[42:43], v28 offset:18432
    ds_read_b64_tr_b16 v[44:45], v28 offset:3072
    ds_read_b64_tr_b16 v[46:47], v28 offset:19456
    v_xor_b32 v28, 32, v4
    ds_read_b64_tr_b16 v[48:49], v28 offset:0
    ds_read_b64_tr_b16 v[50:51], v28 offset:16384
    ds_read_b64_tr_b16 v[52:53], v28 offset:1024
    ds_read_b64_tr_b16 v[54:55], v28 offset:17408
    ds_read_b64_tr_b16 v[56:57], v28 offset:2048
    ds_read_b64_tr_b16 v[58:59], v28 offset:18432
    ds_read_b64_tr_b16 v[60:61], v28 offset:3072
    ds_read_b64_tr_b16 v[62:63], v28 offset:19456
    v_lshlrev_b32 v28, 2, v1
    v_add_u32 v28, 0x24100, v28
    v_mov_b32 v29, 1
    s_mov_b64 exec, 15
    ds_add_u32 v28, v29
    s_mov_b64 exec, -1
    v_and_b32 v25, 4, v1
    v_lshlrev_b32 v26, 2, v1
    v_mov_b32 v27, 0
    v_add_u32 v26, 0x27e00, v26
    ds_write_b32 v26, v27
    v_lshlrev_b32 v8, 16, v24
    v_lshl_add_u32 v8, v25, 4, v8
    v_lshl_add_u32 v8, v2, 4, v8
    s_lshl_b32 s7, s5, 2
    s_add_u32 s7, s7, s61
    s_lshl_b32 s7, s7, 5
    s_add_u32 s7, s7, s4
    s_lshl_b32 s7, s7, 7
    s_add_u32 s7, s7, 0x280000
    v_add_u32 v8, s7, v8
    v_cmp_gt_u32 s[84:85], 8, v3
    s_lshl_b32 s7, s4, 14
    s_lshl_b32 s62, s61, 10
    s_add_u32 s7, s7, s62
    s_add_u32 s7, s7, 0x100000
    v_lshl_add_u32 v5, v1, 4, s7
    v_lshrrev_b32 v24, 5, v1
    s_lshl_b32 s7, s61, 1
    v_add_u32 v24, s7, v24
    v_xor_b32 v6, v24, v3
    v_lshlrev_b32 v6, 4, v6
    v_lshl_add_u32 v6, v24, 8, v6
    v_and_b32 v24, 1, v2
    v_lshl_add_u32 v6, v24, 3, v6
    v_add_u32 v6, 0x26600, v6
    v_xor_b32 v7, 0x80, v6
    v_xor_b32 v12, v3, v2
    v_lshlrev_b32 v12, 4, v12
    v_lshl_add_u32 v12, v3, 8, v12
    v_add_u32 v12, 0x26600, v12
    v_min_u32 v24, 8, v3
    v_xor_b32 v124, v24, v2
    v_lshlrev_b32 v124, 4, v124
    v_lshl_add_u32 v124, v24, 8, v124
    v_add_u32 v124, 0x27600, v124
    v_xor_b32 v13, 64, v12
    v_xor_b32 v125, 64, v124
    v_xor_b32 v14, 128, v12
    v_xor_b32 v126, 128, v124
    v_xor_b32 v15, 192, v12
    v_xor_b32 v127, 192, v124
    v_mov_b32 v28, 0x24204
    s_mov_b32 s80, 1600000
LW_116:
    ds_read_b32 v29, v28
    s_waitcnt lgkmcnt(0)
    v_readfirstlane_b32 s79, v29
    s_cmp_ge_u32 s79, 1
    s_cbranch_scc1 LWD_117
    s_sleep 1
    s_sub_u32 s80, s80, 1
    s_cmp_lg_u32 s80, 0
    s_cbranch_scc1 LW_116
LWD_117:
    v_mov_b32 v28, 0x24248
    ds_read_b64 v[30:31], v28
    s_waitcnt lgkmcnt(0)
    v_readfirstlane_b32 s92, v30
    v_readfirstlane_b32 s93, v31
    s_or_b64 s[94:95], s[92:93], 1
    v_mov_b32 v18, s92
    v_mov_b32 v19, s93
    s_mov_b32 s62, 4096
    s_mov_b32 s63, 8192
    v_mov_b32 v28, 0x24214
    s_mov_b32 s80, 1600000
LW_118:
    ds_read_b32 v29, v28
    s_waitcnt lgkmcnt(0)
    v_readfirstlane_b32 s79, v29
    s_cmp_ge_u32 s79, 4
    s_cbranch_scc1 LWD_119
    s_sleep 2
    s_sub_u32 s80, s80, 1
    s_cmp_lg_u32 s80, 0
    s_cbranch_scc1 LW_118
LWD_119:
    s_setprio 2
    s_mov_b64 exec, -1
    buffer_load_dwordx4 v[112:115], v5, s[36:39], 0 offen sc1 nt
    buffer_load_dwordx4 v[116:119], v5, s[36:39], s62 offen sc1 nt
    buffer_load_dwordx4 v[120:123], v5, s[36:39], s63 offen sc1 nt
    s_mov_b32 s80, 200000
MC_121:
    s_mov_b64 exec, -1
    s_waitcnt vmcnt(0)
    v_cmp_ne_u64 s[64:65], s[94:95], v[114:115]
    v_cmp_ne_u64 s[66:67], s[94:95], v[118:119]
    v_cmp_ne_u64 s[68:69], s[94:95], v[122:123]
    s_or_b64 s[90:91], s[64:65], s[66:67]
    s_or_b64 s[90:91], s[90:91], s[68:69]
    s_cbranch_scc1 M_120
MD_122:
    s_mov_b64 exec, -1
    ds_write_b64 v6, v[112:113]
    ds_write_b64 v7, v[116:117] offset:2048
    ds_write_b64 v6, v[120:121] offset:4096
    s_add_u32 s81, s81, 4
    v_mov_b32 v24, 0x2420c
    v_mov_b32 v25, 1
    s_mov_b64 exec, 1
    ds_add_u32 v24, v25
    s_mov_b64 exec, -1
    v_mov_b32 v24, 0x2420c
    s_mov_b32 s80, 1600000
LW_123:
    ds_read_b32 v25, v24
    s_waitcnt lgkmcnt(0)
    v_readfirstlane_b32 s79, v25
    s_cmp_ge_u32 s79, s81
    s_cbranch_scc1 LWD_124
    s_sub_u32 s80, s80, 1
    s_cmp_lg_u32 s80, 0
    s_cbranch_scc1 LW_123
LWD_124:
    ds_read_b128 v[64:67], v12
    ds_read_b128 v[68:71], v124
    ds_read_b128 v[72:75], v13
    ds_read_b128 v[76:79], v125
    ds_read_b128 v[80:83], v14
    ds_read_b128 v[84:87], v126
    ds_read_b128 v[88:91], v15
    ds_read_b128 v[92:95], v127
    s_waitcnt lgkmcnt(7)
    v_mfma_f32_16x16x32_bf16 v[96:99], v[32:35], v[64:67], 0
    v_mfma_f32_16x16x32_bf16 v[100:103], v[48:51], v[64:67], 0
    s_waitcnt lgkmcnt(6)
    v_mfma_f32_16x16x32_bf16 v[96:99], v[32:35], v[68:71], v[96:99]
    v_mfma_f32_16x16x32_bf16 v[100:103], v[48:51], v[68:71], v[100:103]
    s_waitcnt lgkmcnt(5)
    v_mfma_f32_16x16x32_bf16 v[96:99], v[36:39], v[72:75], v[96:99]
    v_mfma_f32_16x16x32_bf16 v[100:103], v[52:55], v[72:75], v[100:103]
    s_waitcnt lgkmcnt(4)
    v_mfma_f32_16x16x32_bf16 v[96:99], v[36:39], v[76:79], v[96:99]
    v_mfma_f32_16x16x32_bf16 v[100:103], v[52:55], v[76:79], v[100:103]
    s_waitcnt lgkmcnt(3)
    v_mfma_f32_16x16x32_bf16 v[96:99], v[40:43], v[80:83], v[96:99]
    v_mfma_f32_16x16x32_bf16 v[100:103], v[56:59], v[80:83], v[100:103]
    s_waitcnt lgkmcnt(2)
    v_mfma_f32_16x16x32_bf16 v[96:99], v[40:43], v[84:87], v[96:99]
    v_mfma_f32_16x16x32_bf16 v[100:103], v[56:59], v[84:87], v[100:103]
    s_waitcnt lgkmcnt(1)
    v_mfma_f32_16x16x32_bf16 v[96:99], v[44:47], v[88:91], v[96:99]
    v_mfma_f32_16x16x32_bf16 v[100:103], v[60:63], v[88:91], v[100:103]
    s_waitcnt lgkmcnt(0)
    v_mfma_f32_16x16x32_bf16 v[96:99], v[44:47], v[92:95], v[96:99]
    v_mfma_f32_16x16x32_bf16 v[100:103], v[60:63], v[92:95], v[100:103]
    s_nop 6
    v_add_f32_dpp v96, v96, v96 row_ror:8 row_mask:0xf bank_mask:0xf
    v_add_f32_dpp v97, v97, v97 row_ror:8 row_mask:0xf bank_mask:0xf
    v_add_f32_dpp v98, v98, v98 row_ror:8 row_mask:0xf bank_mask:0xf
    v_add_f32_dpp v99, v99, v99 row_ror:8 row_mask:0xf bank_mask:0xf
    v_add_f32_dpp v100, v100, v100 row_ror:8 row_mask:0xf bank_mask:0xf
    v_add_f32_dpp v101, v101, v101 row_ror:8 row_mask:0xf bank_mask:0xf
    v_add_f32_dpp v102, v102, v102 row_ror:8 row_mask:0xf bank_mask:0xf
    v_add_f32_dpp v103, v103, v103 row_ror:8 row_mask:0xf bank_mask:0xf
    v_add_f32_dpp v104, v96, v96 row_ror:4 row_mask:0xf bank_mask:0x1
    v_add_f32_dpp v105, v97, v97 row_ror:4 row_mask:0xf bank_mask:0x1
    v_add_f32_dpp v106, v98, v98 row_ror:4 row_mask:0xf bank_mask:0x1
    v_add_f32_dpp v107, v99, v99 row_ror:4 row_mask:0xf bank_mask:0x1
    v_add_f32_dpp v104, v100, v100 row_ror:4 row_mask:0xf bank_mask:0x2
    v_add_f32_dpp v105, v101, v101 row_ror:4 row_mask:0xf bank_mask:0x2
    v_add_f32_dpp v106, v102, v102 row_ror:4 row_mask:0xf bank_mask:0x2
    v_add_f32_dpp v107, v103, v103 row_ror:4 row_mask:0xf bank_mask:0x2
    v_cvt_pk_bf16_f32 v16, v104, v105
    v_cvt_pk_bf16_f32 v17, v106, v107
    s_mov_b64 exec, s[84:85]
    buffer_store_dwordx4 v[16:19], v8, s[36:39], 0 offen sc1
    s_mov_b64 exec, -1
    s_endpgm
L_ESVC:
    v_lshrrev_b32 v160, 2, v1
    v_bfe_u32 v161, v1, 3, 2
    v_xor_b32 v161, s61, v161
    v_lshlrev_b32 v161, 5, v161
    v_lshl_add_u32 v161, v160, 7, v161
    v_and_b32 v162, 3, v1
    v_lshl_add_u32 v161, v162, 3, v161
    s_lshl_b32 s7, s61, 10
    s_lshl_b32 s62, s4, 4
    s_add_u32 s7, s7, s62
    s_add_u32 s7, s7, 0x30000
    v_and_b32 v164, 1, v1
    v_lshl_add_u32 v4, v164, 9, s7
    s_lshl_b32 s7, s4, 13
    s_lshl_b32 s62, s61, 11
    s_add_u32 s7, s7, s62
    s_add_u32 s7, s7, 0x200000
    v_lshl_add_u32 v5, v1, 4, s7
    s_mul_i32 s7, s61, 1088
    s_add_u32 s7, s7, 0x26600
    v_lshl_add_u32 v6, v160, 6, s7
    v_lshl_add_u32 v6, v164, 5, v6
    v_and_b32 v164, 2, v1
    v_lshl_add_u32 v6, v164, 2, v6
    v_mul_u32_u24 v7, 1088, v162
    v_lshl_add_u32 v7, v2, 4, v7
    v_add_u32 v7, 0x26600, v7
    v_cmp_gt_u32 s[84:85], 4, v3
    s_and_b32 s62, s4, 7
    s_lshl_b32 s62, s62, 3
    s_lshr_b32 s7, s4, 3
    s_lshl_b32 s7, s7, 1
    s_add_u32 s62, s62, s7
    s_add_u32 s62, s62, s5
    s_sub_u32 s62, s62, 6
    s_add_u32 s62, s62, 2
    s_lshl_b32 s7, s62, 10
    s_lshl_b32 s64, s61, 8
    s_add_u32 s7, s7, s64
    s_add_u32 s7, s7, 0xc0000
    v_lshl_add_u32 v10, v162, 6, s7
    v_lshl_add_u32 v10, v2, 4, v10
    v_mov_b32 v8, 0
    s_mov_b64 exec, 5
    buffer_store_dword v8, v10, s[36:39], 0 offen
    buffer_load_dword v8, v10, s[36:39], 0 offen sc1 nt
    s_mov_b64 exec, -1
    s_lshr_b32 s7, s62, 3
    s_lshl_b32 s7, s7, 7
    s_add_u32 s7, s7, 0x22000
    v_and_b32 v164, 7, v1
    v_lshl_add_u32 v9, v164, 3, s7
    v_mov_b32 v16, 0x24204
    s_mov_b32 s80, 1600000
LW_125:
    ds_read_b32 v17, v16
    s_waitcnt lgkmcnt(0)
    v_readfirstlane_b32 s79, v17
    s_cmp_ge_u32 s79, 1
    s_cbranch_scc1 LWD_126
    s_sleep 1
    s_sub_u32 s80, s80, 1
    s_cmp_lg_u32 s80, 0
    s_cbranch_scc1 LW_125
LWD_126:
    v_mov_b32 v16, 0x24248
    ds_read_b64 v[18:19], v16
    s_waitcnt lgkmcnt(0)
    v_readfirstlane_b32 s92, v18
    v_readfirstlane_b32 s93, v19
    v_mov_b32 v16, 0x24000
    s_mov_b32 s80, 1600000
LW_127:
    ds_read_b32 v17, v16
    s_waitcnt lgkmcnt(0)
    v_readfirstlane_b32 s79, v17
    s_cmp_ge_u32 s79, 64
    s_cbranch_scc1 LWD_128
    s_sleep 4
    s_sub_u32 s80, s80, 1
    s_cmp_lg_u32 s80, 0
    s_cbranch_scc1 LW_127
LWD_128:
    s_mov_b32 s80, 200000
P_129:
    buffer_load_dwordx2 v[16:17], v9, s[36:39], 0 offen sc1
PP_130:
    s_waitcnt vmcnt(0)
    v_and_b32 v18, 15, v16
    v_and_b32 v16, -32, v16
    v_cmp_ne_u64 s[90:91], s[92:93], v[16:17]
    s_cmp_lg_u64 s[90:91], 0
    s_cbranch_scc0 PD_131
    s_sleep 8
    s_sub_u32 s80, s80, 1
    s_cmp_lg_u32 s80, 0
    s_cbranch_scc1 P_129
PD_131:
    v_cmp_ne_u32 vcc, s78, v18
    s_cmp_eq_u32 vcc_lo, 0
    s_cselect_b32 s101, 1, 0
    v_mov_b32 v16, 0x24000
    s_mov_b32 s80, 1600000
LW_132:
    ds_read_b32 v17, v16
    s_waitcnt lgkmcnt(0)
    v_readfirstlane_b32 s79, v17
    s_cmp_ge_u32 s79, 96
    s_cbranch_scc1 LWD_133
    s_sleep 4
    s_sub_u32 s80, s80, 1
    s_cmp_lg_u32 s80, 0
    s_cbranch_scc1 LW_132
LWD_133:
    ds_read_b64_tr_b16 v[32:33], v161 offset:0
    ds_read_b64_tr_b16 v[34:35], v161 offset:2048
    ds_read_b64_tr_b16 v[36:37], v161 offset:4096
    ds_read_b64_tr_b16 v[38:39], v161 offset:6144
    ds_read_b64_tr_b16 v[40:41], v161 offset:8192
    ds_read_b64_tr_b16 v[42:43], v161 offset:10240
    ds_read_b64_tr_b16 v[44:45], v161 offset:12288
    ds_read_b64_tr_b16 v[46:47], v161 offset:14336
    s_waitcnt lgkmcnt(4)
    ds_read_b64_tr_b16 v[48:49], v161 offset:16384
    ds_read_b64_tr_b16 v[50:51], v161 offset:18432
    ds_read_b64_tr_b16 v[52:53], v161 offset:20480
    ds_read_b64_tr_b16 v[54:55], v161 offset:22528
    ds_read_b64_tr_b16 v[56:57], v161 offset:24576
    ds_read_b64_tr_b16 v[58:59], v161 offset:26624
    ds_read_b64_tr_b16 v[60:61], v161 offset:28672
    ds_read_b64_tr_b16 v[62:63], v161 offset:30720
    s_waitcnt lgkmcnt(4)
    ds_read_b64_tr_b16 v[64:65], v161 offset:32768
    ds_read_b64_tr_b16 v[66:67], v161 offset:34816
    ds_read_b64_tr_b16 v[68:69], v161 offset:36864
    ds_read_b64_tr_b16 v[70:71], v161 offset:38912
    ds_read_b64_tr_b16 v[72:73], v161 offset:40960
    ds_read_b64_tr_b16 v[74:75], v161 offset:43008
    ds_read_b64_tr_b16 v[76:77], v161 offset:45056
    ds_read_b64_tr_b16 v[78:79], v161 offset:47104
    s_waitcnt lgkmcnt(4)
    ds_read_b64_tr_b16 v[80:81], v161 offset:49152
    ds_read_b64_tr_b16 v[82:83], v161 offset:51200
    ds_read_b64_tr_b16 v[84:85], v161 offset:53248
    ds_read_b64_tr_b16 v[86:87], v161 offset:55296
    ds_read_b64_tr_b16 v[88:89], v161 offset:57344
    ds_read_b64_tr_b16 v[90:91], v161 offset:59392
    ds_read_b64_tr_b16 v[92:93], v161 offset:61440
    ds_read_b64_tr_b16 v[94:95], v161 offset:63488
    s_waitcnt lgkmcnt(4)
    v_lshlrev_b32 v16, 2, v1
    v_add_u32 v16, 0x24100, v16
    v_mov_b32 v17, 1
    s_mov_b64 exec, 255
    ds_add_u32 v16, v17
    s_mov_b64 exec, -1
    s_and_b32 s7, s4, 7
    s_lshl_b32 s7, s7, 12
    s_add_u32 s7, s7, 0x28008
    v_lshl_add_u32 v9, v1, 9, s7
    s_lshl_b32 s7, s61, 8
    s_lshr_b32 s64, s4, 2
    s_lshl_b32 s64, s64, 3
    s_add_u32 s7, s7, s64
    s_add_u32 s7, s7, 0x22800
    v_writelane_b32 v9, s7, 8
    s_add_u32 s7, s7, 128
    v_writelane_b32 v9, s7, 9
    s_cmp_eq_u32 s101, 0
    s_cbranch_scc1 EH_134
    s_mov_b64 exec, 0xff
    buffer_load_dwordx2 v[12:13], v9, s[36:39], 0 offen sc1 nt
    s_mov_b32 s80, 200000
MC_136:
    s_mov_b64 exec, 0xff
    s_waitcnt vmcnt(0)
    v_cmp_ne_u64 s[64:65], s[92:93], v[12:13]
    s_cmp_lg_u64 s[64:65], 0
    s_cbranch_scc1 M_135
MD_137:
    s_mov_b64 exec, -1
EH_134:
    s_mov_b64 exec, 0x300
    buffer_load_dwordx2 v[12:13], v9, s[36:39], 0 offen sc1
    s_mov_b32 s80, 200000
MC_139:
    s_mov_b64 exec, 0x300
    s_waitcnt vmcnt(0)
    v_cmp_ne_u64 s[64:65], s[92:93], v[12:13]
    s_cmp_lg_u64 s[64:65], 0
    s_cbranch_scc1 M_138
MD_140:
    s_mov_b64 exec, -1
    s_setprio 2
    s_mov_b64 exec, -1
    buffer_load_dwordx4 v[16:19], v5, s[36:39], 0 offen offset:0 sc1
    buffer_load_dwordx4 v[20:23], v5, s[36:39], 0 offen offset:1024 sc1
    buffer_load_dwordx4 v[12:15], v4, s[36:39], 0 offen sc1
    s_mov_b32 s80, 200000
MC_142:
    s_mov_b64 exec, -1
    s_waitcnt vmcnt(0)
    v_max3_u32 v160, v16, v17, v18
    v_max_u32 v160, v160, v19
    v_cmp_eq_u32 s[64:65], -1, v160
    v_max3_u32 v161, v20, v21, v22
    v_max_u32 v161, v161, v23
    v_cmp_eq_u32 s[66:67], -1, v161
    v_cmp_ne_u64 s[68:69], s[92:93], v[14:15]
    s_or_b64 s[90:91], s[64:65], s[66:67]
    s_or_b64 s[90:91], s[90:91], s[68:69]
    s_cbranch_scc1 M_141
MD_143:
    s_mov_b64 exec, -1
    v_readlane_b32 s74, v12, 0
    v_readlane_b32 s76, v13, 0
    v_readlane_b32 s75, v12, 1
    v_readlane_b32 s77, v13, 1
    v_mov_b32 v160, s74
    v_max_f32 v160, s75, v160
    v_sub_f32 v11, s74, v160
    v_sub_f32 v12, s75, v160
    v_exp_f32 v11, v11
    v_exp_f32 v12, v12
    v_mul_f32 v160, s76, v11
    v_fmac_f32 v160, s77, v12
    v_rcp_f32 v160, v160
    s_nop 0
    v_mul_f32 v11, v11, v160
    v_mul_f32 v12, v12, v160
    v_lshlrev_b32 v96, 16, v16
    v_and_b32 v97, 0xffff0000, v16
    v_lshlrev_b32 v98, 16, v17
    v_and_b32 v99, 0xffff0000, v17
    v_lshlrev_b32 v100, 16, v18
    v_and_b32 v101, 0xffff0000, v18
    v_lshlrev_b32 v102, 16, v19
    v_and_b32 v103, 0xffff0000, v19
    v_lshlrev_b32 v104, 16, v20
    v_and_b32 v105, 0xffff0000, v20
    v_lshlrev_b32 v106, 16, v21
    v_and_b32 v107, 0xffff0000, v21
    v_lshlrev_b32 v108, 16, v22
    v_and_b32 v109, 0xffff0000, v22
    v_lshlrev_b32 v110, 16, v23
    v_and_b32 v111, 0xffff0000, v23
    v_mul_f32 v96, v96, v11
    v_mul_f32 v97, v97, v11
    v_mul_f32 v98, v98, v11
    v_mul_f32 v99, v99, v11
    v_mul_f32 v100, v100, v11
    v_mul_f32 v101, v101, v11
    v_mul_f32 v102, v102, v11
    v_mul_f32 v103, v103, v11
    v_fmac_f32 v96, v104, v12
    v_fmac_f32 v97, v105, v12
    v_fmac_f32 v98, v106, v12
    v_fmac_f32 v99, v107, v12
    v_fmac_f32 v100, v108, v12
    v_fmac_f32 v101, v109, v12
    v_fmac_f32 v102, v110, v12
    v_fmac_f32 v103, v111, v12
    v_cvt_pk_bf16_f32 v24, v96, v97
    v_cvt_pk_bf16_f32 v25, v98, v99
    v_cvt_pk_bf16_f32 v26, v100, v101
    v_cvt_pk_bf16_f32 v27, v102, v103
    ds_write_b64 v6, v[24:25]
    ds_write_b64 v6, v[26:27] offset:16
    s_add_u32 s81, s81, 4
    v_mov_b32 v160, 0x2420c
    v_mov_b32 v161, 1
    s_mov_b64 exec, 1
    ds_add_u32 v160, v161
    s_mov_b64 exec, -1
    v_mov_b32 v160, 0x2420c
    s_mov_b32 s80, 1600000
LW_144:
    ds_read_b32 v161, v160
    s_waitcnt lgkmcnt(0)
    v_readfirstlane_b32 s79, v161
    s_cmp_ge_u32 s79, s81
    s_cbranch_scc1 LWD_145
    s_sub_u32 s80, s80, 1
    s_cmp_lg_u32 s80, 0
    s_cbranch_scc1 LW_144
LWD_145:
    ds_read_b128 v[96:99], v7 offset:0
    ds_read_b128 v[100:103], v7 offset:64
    ds_read_b128 v[104:107], v7 offset:128
    ds_read_b128 v[108:111], v7 offset:192
    ds_read_b128 v[112:115], v7 offset:256
    ds_read_b128 v[116:119], v7 offset:320
    ds_read_b128 v[120:123], v7 offset:384
    ds_read_b128 v[124:127], v7 offset:448
    ds_read_b128 v[128:131], v7 offset:512
    ds_read_b128 v[132:135], v7 offset:576
    ds_read_b128 v[136:139], v7 offset:640
    ds_read_b128 v[140:143], v7 offset:704
    v_mov_b32 v18, s92
    v_mov_b32 v19, s93
    s_waitcnt lgkmcnt(8)
    ds_read_b128 v[144:147], v7 offset:768
    ds_read_b128 v[148:151], v7 offset:832
    ds_read_b128 v[152:155], v7 offset:896
    ds_read_b128 v[156:159], v7 offset:960
    v_mfma_f32_16x16x32_bf16 v[12:15], v[32:35], v[96:99], 0
    v_mfma_f32_16x16x32_bf16 v[12:15], v[36:39], v[100:103], v[12:15]
    v_mfma_f32_16x16x32_bf16 v[12:15], v[40:43], v[104:107], v[12:15]
    v_mfma_f32_16x16x32_bf16 v[12:15], v[44:47], v[108:111], v[12:15]
    s_waitcnt lgkmcnt(11)
    v_mfma_f32_16x16x32_bf16 v[12:15], v[48:51], v[112:115], v[12:15]
    s_waitcnt lgkmcnt(10)
    v_mfma_f32_16x16x32_bf16 v[12:15], v[52:55], v[116:119], v[12:15]
    s_waitcnt lgkmcnt(9)
    v_mfma_f32_16x16x32_bf16 v[12:15], v[56:59], v[120:123], v[12:15]
    s_waitcnt lgkmcnt(8)
    v_mfma_f32_16x16x32_bf16 v[12:15], v[60:63], v[124:127], v[12:15]
    s_waitcnt lgkmcnt(7)
    v_mfma_f32_16x16x32_bf16 v[12:15], v[64:67], v[128:131], v[12:15]
    s_waitcnt lgkmcnt(6)
    v_mfma_f32_16x16x32_bf16 v[12:15], v[68:71], v[132:135], v[12:15]
    s_waitcnt lgkmcnt(5)
    v_mfma_f32_16x16x32_bf16 v[12:15], v[72:75], v[136:139], v[12:15]
    s_waitcnt lgkmcnt(4)
    v_mfma_f32_16x16x32_bf16 v[12:15], v[76:79], v[140:143], v[12:15]
    s_waitcnt lgkmcnt(3)
    v_mfma_f32_16x16x32_bf16 v[12:15], v[80:83], v[144:147], v[12:15]
    s_waitcnt lgkmcnt(2)
    v_mfma_f32_16x16x32_bf16 v[12:15], v[84:87], v[148:151], v[12:15]
    s_waitcnt lgkmcnt(1)
    v_mfma_f32_16x16x32_bf16 v[12:15], v[88:91], v[152:155], v[12:15]
    s_waitcnt lgkmcnt(0)
    v_mfma_f32_16x16x32_bf16 v[12:15], v[92:95], v[156:159], v[12:15]
    s_nop 7
    v_cvt_pk_bf16_f32 v16, v12, v13
    v_cvt_pk_bf16_f32 v17, v14, v15
    s_mov_b64 exec, s[84:85]
    s_cmp_eq_u32 s101, 0
    s_cbranch_scc1 SU_146
    buffer_store_dwordx4 v[16:19], v10, s[36:39], 0 offen
SV_147:
    s_mov_b64 exec, -1
    s_endpgm
L_BATT:
    s_and_b32 s60, s4, 7
    s_lshl_b32 s60, s60, 3
    s_lshr_b32 s7, s4, 3
    s_lshl_b32 s7, s7, 1
    s_add_u32 s60, s60, s7
    s_add_u32 s60, s60, s5
    s_sub_u32 s60, s60, 6
    s_lshl_b32 s7, s60, 15
    s_lshl_b32 s63, s6, 12
    s_add_u32 s7, s7, s63
    s_add_u32 s7, s7, 0x600000
    v_lshl_add_u32 v162, v1, 7, s7
    v_mov_b32 v160, 0x24000
    s_mov_b32 s80, 1600000
LW_148:
    ds_read_b32 v161, v160
    s_waitcnt lgkmcnt(0)
    v_readfirstlane_b32 s79, v161
    s_cmp_ge_u32 s79, 32
    s_cbranch_scc1 LWD_149
    s_sleep 4
    s_sub_u32 s80, s80, 1
    s_cmp_lg_u32 s80, 0
    s_cbranch_scc1 LW_148
LWD_149:
    v_mov_b32 v15, 0
    s_mov_b64 exec, 0xffffffff
    buffer_store_dword v15, v162, s[36:39], 0 offen
    buffer_load_dword v15, v162, s[36:39], 0 offen sc1 nt
    s_mov_b64 exec, -1
    s_lshr_b32 s61, s6, 1
    s_and_b32 s62, s6, 1
    s_mov_b32 s64, 0x3e0293ee
    v_lshlrev_b32 v4, 10, v3
    v_lshl_add_u32 v4, v2, 8, v4
    v_lshl_add_u32 v96, v3, 4, v4
    s_lshl_b32 s7, s62, 14
    s_add_u32 s7, s7, 0x1c000
    v_add_u32 v96, s7, v96
    v_and_b32 v162, 3, v1
    v_lshl_add_u32 v4, v162, 6, v4
    v_bfe_u32 v162, v1, 2, 2
    v_lshl_add_u32 v4, v162, 4, v4
    s_lshl_b32 s7, s6, 7
    s_add_u32 s7, s7, 0x24400
    v_lshl_add_u32 v5, v3, 3, s7
    s_lshl_b32 s7, s61, 10
    s_lshl_b32 s63, s62, 8
    s_add_u32 s7, s7, s63
    s_add_u32 s7, s7, 0x26000
    v_lshl_add_u32 v6, v3, 4, s7
    v_lshrrev_b32 v163, 5, v1
    v_lshl_add_u32 v6, v163, 9, v6
    v_and_b32 v162, 1, v2
    v_lshl_add_u32 v6, v162, 3, v6
    v_lshlrev_b32 v7, 4, v1
    v_add_u32 v7, 0x26000, v7
    v_and_b32 v162, 31, v1
    v_lshlrev_b32 v8, 3, v162
    v_add_u32 v8, 0x24400, v8
    v_bfe_u32 v162, v1, 2, 2
    v_lshl_add_u32 v164, v163, 3, v162
    v_lshlrev_b32 v164, 10, v164
    v_and_b32 v165, 1, v1
    v_lshl_add_u32 v164, v165, 3, v164
    s_lshl_b32 s7, s61, 8
    v_add_u32 v164, s7, v164
    v_bfe_u32 v165, v1, 4, 1
    v_lshlrev_b32 v165, 1, v165
    v_bfe_u32 v160, v1, 1, 1
    v_or_b32 v165, v165, v160
    s_lshl_b32 s7, s62, 3
    v_or_b32 v165, s7, v165
    v_lshlrev_b32 v162, 2, v162
    v_xor_b32 v165, v165, v162
    v_lshlrev_b32 v163, 1, v163
    v_xor_b32 v165, v165, v163
    v_xor_b32 v160, 0, v165
    v_lshl_add_u32 v9, v160, 4, v164
    v_xor_b32 v160, 4, v165
    v_lshl_add_u32 v10, v160, 4, v164
    v_xor_b32 v160, 1, v165
    v_lshl_add_u32 v11, v160, 4, v164
    v_add_u32 v11, 0x1000, v11
    v_xor_b32 v160, 5, v165
    v_lshl_add_u32 v12, v160, 4, v164
    v_add_u32 v12, 0x1000, v12
    v_mov_b32 v13, 0xff800000
    v_mov_b32 v128, 0
    v_mov_b32 v129, 0
    v_mov_b32 v130, 0
    v_mov_b32 v131, 0
    v_mov_b32 v132, 0
    v_mov_b32 v133, 0
    v_mov_b32 v134, 0
    v_mov_b32 v135, 0
    v_mov_b32 v136, 0
    v_mov_b32 v137, 0
    v_mov_b32 v138, 0
    v_mov_b32 v139, 0
    v_mov_b32 v140, 0
    v_mov_b32 v141, 0
    v_mov_b32 v142, 0
    v_mov_b32 v143, 0
    v_mov_b32 v144, 0
    v_mov_b32 v145, 0
    v_mov_b32 v146, 0
    v_mov_b32 v147, 0
    v_mov_b32 v148, 0
    v_mov_b32 v149, 0
    v_mov_b32 v150, 0
    v_mov_b32 v151, 0
    v_mov_b32 v152, 0
    v_mov_b32 v153, 0
    v_mov_b32 v154, 0
    v_mov_b32 v155, 0
    v_mov_b32 v156, 0
    v_mov_b32 v157, 0
    v_mov_b32 v158, 0
    v_mov_b32 v159, 0
    s_mov_b64 s[84:85], 0xffff
    v_mov_b32 v160, 0x24204
    s_mov_b32 s80, 1600000
LW_151:
    ds_read_b32 v161, v160
    s_waitcnt lgkmcnt(0)
    v_readfirstlane_b32 s79, v161
    s_cmp_ge_u32 s79, 1
    s_cbranch_scc1 LWD_152
    s_sleep 1
    s_sub_u32 s80, s80, 1
    s_cmp_lg_u32 s80, 0
    s_cbranch_scc1 LW_151
LWD_152:
    v_mov_b32 v160, 0x24248
    ds_read_b64 v[162:163], v160
    s_waitcnt lgkmcnt(0)
    v_readfirstlane_b32 s92, v162
    v_readfirstlane_b32 s93, v163
    s_cmp_ge_u32 s6, 4
    s_cbranch_scc1 BQ_150
    s_lshl_b32 s7, s6, 8
    s_add_u32 s7, s7, 0x20000
    v_lshl_add_u32 v100, v1, 3, s7
    s_lshr_b32 s7, s60, 4
    s_lshl_b32 s7, s7, 15
    s_lshl_b32 s63, s6, 13
    s_add_u32 s7, s7, s63
    v_lshl_add_u32 v101, v1, 4, s7
    v_add_u32 v103, 4096, v101
    s_lshl_b32 s7, s62, 7
    v_lshlrev_b32 v102, 4, v1
    v_xor_b32 v102, s7, v102
    s_add_u32 s7, s63, 0x1c000
    v_add_u32 v102, s7, v102
    v_xor_b32 v104, 0x10, v102
    v_xor_b32 v105, 0x20, v102
    v_xor_b32 v106, 0x30, v102
    v_xor_b32 v107, 0x40, v102
    v_xor_b32 v108, 0x50, v102
    v_xor_b32 v109, 0x60, v102
    v_xor_b32 v110, 0x70, v102
    v_mov_b32 v160, 0x24138
    s_mov_b32 s80, 1600000
LW_153:
    ds_read_b32 v161, v160
    s_waitcnt lgkmcnt(0)
    v_readfirstlane_b32 s79, v161
    s_cmp_ge_u32 s79, 4
    s_cbranch_scc1 LWD_154
    s_sleep 1
    s_sub_u32 s80, s80, 1
    s_cmp_lg_u32 s80, 0
    s_cbranch_scc1 LW_153
LWD_154:
    v_mov_b32 v160, 0x24000
    s_mov_b32 s80, 1600000
LW_155:
    ds_read_b32 v161, v160
    s_waitcnt lgkmcnt(0)
    v_readfirstlane_b32 s79, v161
    s_cmp_ge_u32 s79, 48
    s_cbranch_scc1 LWD_156
    s_sleep 2
    s_sub_u32 s80, s80, 1
    s_cmp_lg_u32 s80, 0
    s_cbranch_scc1 LW_155
LWD_156:
    s_mov_b64 exec, 0xffffffff
    buffer_load_dwordx2 v[16:17], v100, s[36:39], 0 offen sc1
    s_mov_b32 s80, 200000
MC_158:
    s_mov_b64 exec, 0xffffffff
    s_waitcnt vmcnt(0)
    v_cmp_ne_u64 s[44:45], s[92:93], v[16:17]
    s_cmp_lg_u64 s[44:45], 0
    s_cbranch_scc1 M_157
MD_159:
    s_mov_b64 exec, -1
    v_mov_b32 v160, 0x24000
    s_mov_b32 s80, 1600000
LW_160:
    ds_read_b32 v161, v160
    s_waitcnt lgkmcnt(0)
    v_readfirstlane_b32 s79, v161
    s_cmp_ge_u32 s79, 72
    s_cbranch_scc1 LWD_161
    s_sleep 1
    s_sub_u32 s80, s80, 1
    s_cmp_lg_u32 s80, 0
    s_cbranch_scc1 LW_160
LWD_161:
    s_mov_b64 exec, -1
    buffer_load_dwordx4 v[32:35], v101, s[36:39], 0 offen offset:0 sc1
    buffer_load_dwordx4 v[36:39], v101, s[36:39], 0 offen offset:1024 sc1
    buffer_load_dwordx4 v[40:43], v101, s[36:39], 0 offen offset:2048 sc1
    buffer_load_dwordx4 v[44:47], v101, s[36:39], 0 offen offset:3072 sc1
    buffer_load_dwordx4 v[48:51], v103, s[36:39], 0 offen offset:0 sc1
    buffer_load_dwordx4 v[52:55], v103, s[36:39], 0 offen offset:1024 sc1
    buffer_load_dwordx4 v[56:59], v103, s[36:39], 0 offen offset:2048 sc1
    buffer_load_dwordx4 v[60:63], v103, s[36:39], 0 offen offset:3072 sc1
    s_mov_b32 s80, 200000
MC_163:
    s_mov_b64 exec, -1
    s_waitcnt vmcnt(0)
    v_max3_u32 v160, v32, v33, v34
    v_max_u32 v160, v160, v35
    v_cmp_eq_u32 s[44:45], -1, v160
    v_max3_u32 v161, v36, v37, v38
    v_max_u32 v161, v161, v39
    v_cmp_eq_u32 s[46:47], -1, v161
    v_max3_u32 v162, v40, v41, v42
    v_max_u32 v162, v162, v43
    v_cmp_eq_u32 s[48:49], -1, v162
    v_max3_u32 v163, v44, v45, v46
    v_max_u32 v163, v163, v47
    v_cmp_eq_u32 s[50:51], -1, v163
    v_max3_u32 v160, v48, v49, v50
    v_max_u32 v160, v160, v51
    v_cmp_eq_u32 s[52:53], -1, v160
    v_max3_u32 v161, v52, v53, v54
    v_max_u32 v161, v161, v55
    v_cmp_eq_u32 s[54:55], -1, v161
    v_max3_u32 v162, v56, v57, v58
    v_max_u32 v162, v162, v59
    v_cmp_eq_u32 s[56:57], -1, v162
    v_max3_u32 v163, v60, v61, v62
    v_max_u32 v163, v163, v63
    v_cmp_eq_u32 s[58:59], -1, v163
    s_or_b64 s[90:91], s[44:45], s[46:47]
    s_or_b64 s[90:91], s[90:91], s[48:49]
    s_or_b64 s[90:91], s[90:91], s[50:51]
    s_or_b64 s[90:91], s[90:91], s[52:53]
    s_or_b64 s[90:91], s[90:91], s[54:55]
    s_or_b64 s[90:91], s[90:91], s[56:57]
    s_or_b64 s[90:91], s[90:91], s[58:59]
    s_cbranch_scc1 M_162
MD_164:
    s_mov_b64 exec, -1
    v_mov_b32 v160, 0x24108
    v_mov_b32 v161, 2
    s_mov_b64 exec, 1
    ds_add_u32 v160, v161
    s_mov_b64 exec, -1
    ds_write_b128 v102, v[32:35] offset:0
    ds_write_b128 v104, v[36:39] offset:1024
    ds_write_b128 v105, v[40:43] offset:2048
    ds_write_b128 v106, v[44:47] offset:3072
    ds_write_b128 v107, v[48:51] offset:4096
    ds_write_b128 v108, v[52:55] offset:5120
    ds_write_b128 v109, v[56:59] offset:6144
    ds_write_b128 v110, v[60:63] offset:7168
BQ_150:
    s_lshr_b32 s7, s60, 3
    s_lshl_b32 s7, s7, 7
    s_add_u32 s7, s7, 0x22000
    v_and_b32 v160, 7, v1
    v_lshl_add_u32 v0, v160, 3, s7
    s_mov_b64 exec, 0xff
    buffer_load_dwordx2 v[14:15], v0, s[36:39], 0 offen sc1
    s_mov_b64 exec, -1
    s_add_u32 s81, s81, 8
    v_mov_b32 v162, 0x2420c
    v_mov_b32 v163, 1
    s_mov_b64 exec, 1
    ds_add_u32 v162, v163
    s_mov_b64 exec, -1
    v_mov_b32 v162, 0x2420c
    s_mov_b32 s80, 1600000
LW_165:
    ds_read_b32 v163, v162
    s_waitcnt lgkmcnt(0)
    v_readfirstlane_b32 s79, v163
    s_cmp_ge_u32 s79, s81
    s_cbranch_scc1 LWD_166
    s_sub_u32 s80, s80, 1
    s_cmp_lg_u32 s80, 0
    s_cbranch_scc1 LW_165
LWD_166:
    v_xor_b32 v160, 0x0, v96
    ds_read_b128 v[32:35], v160
    v_xor_b32 v161, 0x10, v96
    ds_read_b128 v[36:39], v161
    v_xor_b32 v160, 0x20, v96
    ds_read_b128 v[40:43], v160
    v_xor_b32 v161, 0x30, v96
    ds_read_b128 v[44:47], v161
    v_xor_b32 v160, 0x40, v96
    ds_read_b128 v[48:51], v160
    v_xor_b32 v161, 0x50, v96
    ds_read_b128 v[52:55], v161
    v_xor_b32 v160, 0x60, v96
    ds_read_b128 v[56:59], v160
    v_xor_b32 v161, 0x70, v96
    ds_read_b128 v[60:63], v161
    v_xor_b32 v160, 0x80, v96
    ds_read_b128 v[64:67], v160
    v_xor_b32 v161, 0x90, v96
    ds_read_b128 v[68:71], v161
    s_waitcnt lgkmcnt(4)
    v_xor_b32 v160, 0xa0, v96
    ds_read_b128 v[72:75], v160
    v_xor_b32 v161, 0xb0, v96
    ds_read_b128 v[76:79], v161
    v_xor_b32 v160, 0xc0, v96
    ds_read_b128 v[80:83], v160
    v_xor_b32 v161, 0xd0, v96
    ds_read_b128 v[84:87], v161
    v_xor_b32 v160, 0xe0, v96
    ds_read_b128 v[88:91], v160
    v_xor_b32 v161, 0xf0, v96
    ds_read_b128 v[92:95], v161
    v_mov_b32 v162, 0x24104
    v_mov_b32 v163, 1
    s_mov_b64 exec, 1
    ds_add_u32 v162, v163
    s_mov_b64 exec, -1
    s_lshl_b32 s66, s61, 4
    s_add_u32 s66, s66, 16
    s_mov_b32 s70, 64
    s_mov_b32 s71, 0x800080
    s_mov_b32 s67, s61
    s_mov_b32 s68, 0
    s_mov_b32 s69, 4
BS_167:
    s_lshl_b32 s7, s67, 14
    v_add_u32 v20, s7, v4
    v_xor_b32 v21, 0x10, v20
    v_xor_b32 v22, 0x20, v20
    v_xor_b32 v23, 0x30, v20
    v_xor_b32 v24, 0x40, v20
    v_xor_b32 v25, 0x50, v20
    v_xor_b32 v26, 0x60, v20
    v_xor_b32 v27, 0x70, v20
    v_mov_b32 v162, 0x24000
    s_mov_b32 s80, 1600000
LW_168:
    ds_read_b32 v163, v162
    s_waitcnt lgkmcnt(0)
    v_readfirstlane_b32 s79, v163
    s_cmp_ge_u32 s79, s66
    s_cbranch_scc1 LWD_169
    s_sleep 1
    s_sub_u32 s80, s80, 1
    s_cmp_lg_u32 s80, 0
    s_cbranch_scc1 LW_168
LWD_169:
    ds_read_b128 v[96:99], v20
    ds_read_b128 v[100:103], v21
    ds_read_b128 v[104:107], v22
    ds_read_b128 v[108:111], v23
    ds_read_b128 v[112:115], v24
    ds_read_b128 v[116:119], v25
    ds_read_b128 v[120:123], v26
    ds_read_b128 v[124:127], v27
    v_xor_b32 v20, 0x80, v20
    v_xor_b32 v21, 0x80, v21
    v_xor_b32 v22, 0x80, v22
    v_xor_b32 v23, 0x80, v23
    v_xor_b32 v24, 0x80, v24
    v_xor_b32 v25, 0x80, v25
    v_xor_b32 v26, 0x80, v26
    v_xor_b32 v27, 0x80, v27
    s_waitcnt lgkmcnt(7)
    v_mfma_f32_16x16x32_bf16 v[16:19], v[96:99], v[32:35], 0
    ds_read_b128 v[96:99], v20
    s_waitcnt lgkmcnt(7)
    v_mfma_f32_16x16x32_bf16 v[16:19], v[100:103], v[36:39], v[16:19]
    ds_read_b128 v[100:103], v21
    s_waitcnt lgkmcnt(7)
    v_mfma_f32_16x16x32_bf16 v[16:19], v[104:107], v[40:43], v[16:19]
    ds_read_b128 v[104:107], v22
    s_waitcnt lgkmcnt(7)
    v_mfma_f32_16x16x32_bf16 v[16:19], v[108:111], v[44:47], v[16:19]
    ds_read_b128 v[108:111], v23
    s_waitcnt lgkmcnt(7)
    v_mfma_f32_16x16x32_bf16 v[16:19], v[112:115], v[48:51], v[16:19]
    ds_read_b128 v[112:115], v24
    s_waitcnt lgkmcnt(7)
    v_mfma_f32_16x16x32_bf16 v[16:19], v[116:119], v[52:55], v[16:19]
    ds_read_b128 v[116:119], v25
    s_waitcnt lgkmcnt(7)
    v_mfma_f32_16x16x32_bf16 v[16:19], v[120:123], v[56:59], v[16:19]
    ds_read_b128 v[120:123], v26
    s_waitcnt lgkmcnt(7)
    v_mfma_f32_16x16x32_bf16 v[16:19], v[124:127], v[60:63], v[16:19]
    ds_read_b128 v[124:127], v27
    s_waitcnt lgkmcnt(7)
    v_mfma_f32_16x16x32_bf16 v[16:19], v[96:99], v[64:67], v[16:19]
    s_waitcnt lgkmcnt(6)
    v_mfma_f32_16x16x32_bf16 v[16:19], v[100:103], v[68:71], v[16:19]
    v_add_u32 v20, s68, v9
    v_add_u32 v21, s68, v10
    v_add_u32 v22, s68, v11
    v_add_u32 v23, s68, v12
    s_add_u32 s68, s68, 16384
    s_cmp_eq_u32 s68, 147456
    s_cselect_b32 s68, 0, s68
    s_waitcnt lgkmcnt(5)
    v_mfma_f32_16x16x32_bf16 v[16:19], v[104:107], v[72:75], v[16:19]
    s_waitcnt lgkmcnt(4)
    v_mfma_f32_16x16x32_bf16 v[16:19], v[108:111], v[76:79], v[16:19]
    v_add_u32 v24, s68, v9
    v_add_u32 v25, s68, v10
    v_add_u32 v26, s68, v11
    v_add_u32 v27, s68, v12
    s_add_u32 s68, s68, 16384
    s_cmp_eq_u32 s68, 147456
    s_cselect_b32 s68, 0, s68
    s_waitcnt lgkmcnt(3)
    v_mfma_f32_16x16x32_bf16 v[16:19], v[112:115], v[80:83], v[16:19]
    s_waitcnt lgkmcnt(2)
    v_mfma_f32_16x16x32_bf16 v[16:19], v[116:119], v[84:87], v[16:19]
    v_add_u32 v28, s68, v9
    v_add_u32 v29, s68, v10
    v_add_u32 v30, s68, v11
    v_add_u32 v31, s68, v12
    s_add_u32 s68, s68, 16384
    s_cmp_eq_u32 s68, 147456
    s_cselect_b32 s68, 0, s68
    s_waitcnt lgkmcnt(1)
    v_mfma_f32_16x16x32_bf16 v[16:19], v[120:123], v[88:91], v[16:19]
    s_waitcnt lgkmcnt(0)
    v_mfma_f32_16x16x32_bf16 v[16:19], v[124:127], v[92:95], v[16:19]
    s_cmp_ge_u32 s79, s70
    s_cbranch_scc1 BA_170
    v_mov_b32 v162, 0x24000
    s_mov_b32 s80, 1600000
LW_171:
    ds_read_b32 v163, v162
    s_waitcnt lgkmcnt(0)
    v_readfirstlane_b32 s79, v163
    s_cmp_ge_u32 s79, s70
    s_cbranch_scc1 LWD_172
    s_sleep 1
    s_sub_u32 s80, s80, 1
    s_cmp_lg_u32 s80, 0
    s_cbranch_scc1 LW_171
LWD_172:
BA_170:
    ds_read_b64_tr_b16 v[96:97], v20
    ds_read_b64_tr_b16 v[98:99], v22
    ds_read_b64_tr_b16 v[100:101], v21
    ds_read_b64_tr_b16 v[102:103], v23
    ds_read_b64_tr_b16 v[104:105], v24
    ds_read_b64_tr_b16 v[106:107], v26
    ds_read_b64_tr_b16 v[108:109], v25
    ds_read_b64_tr_b16 v[110:111], v27
    ds_read_b64_tr_b16 v[112:113], v28
    ds_read_b64_tr_b16 v[114:115], v30
    ds_read_b64_tr_b16 v[116:117], v29
    ds_read_b64_tr_b16 v[118:119], v31
    v_add_u32 v20, s68, v9
    v_add_u32 v21, s68, v10
    v_add_u32 v22, s68, v11
    v_add_u32 v23, s68, v12
    s_add_u32 s68, s68, 16384
    s_cmp_eq_u32 s68, 147456
    s_cselect_b32 s68, 0, s68
    ds_read_b64_tr_b16 v[120:121], v20
    ds_read_b64_tr_b16 v[122:123], v22
    ds_read_b64_tr_b16 v[124:125], v21
    ds_read_b64_tr_b16 v[126:127], v23
    v_mov_b32 v162, 0x24100
    v_mov_b32 v163, 1
    s_mov_b64 exec, 1
    ds_add_u32 v162, v163
    s_mov_b64 exec, -1
    v_max3_f32 v160, v16, v17, v18
    v_max_f32 v160, v160, v19
    v_mov_b32 v161, v160
    s_nop 1
    v_permlane32_swap_b32 v160, v161
    v_max_f32 v160, v160, v161
    v_mov_b32 v161, v160
    s_nop 1
    v_permlane16_swap_b32 v160, v161
    v_max_f32 v160, v160, v161
    v_mul_f32 v160, s64, v160
    v_ceil_f32 v160, v160
    v_fma_f32 v16, v16, s64, -v160
    v_fma_f32 v17, v17, s64, -v160
    v_fma_f32 v18, v18, s64, -v160
    v_fma_f32 v19, v19, s64, -v160
    v_exp_f32 v16, v16
    v_exp_f32 v17, v17
    v_exp_f32 v18, v18
    v_exp_f32 v19, v19
    v_cvt_pk_bf16_f32 v162, v16, v17
    v_cvt_pk_bf16_f32 v163, v18, v19
    v_add_f32 v16, v16, v17
    v_add_f32 v18, v18, v19
    ds_write_b64 v6, v[162:163]
    v_add_f32 v161, v16, v18
    v_mov_b32 v16, v161
    s_nop 1
    v_permlane32_swap_b32 v161, v16
    v_add_f32 v161, v161, v16
    v_mov_b32 v16, v161
    s_nop 1
    v_permlane16_swap_b32 v161, v16
    v_add_f32 v161, v161, v16
    s_mov_b64 exec, s[84:85]
    ds_write_b64 v5, v[160:161]
    s_add_u32 s81, s81, 8
    v_mov_b32 v164, 0x2420c
    v_mov_b32 v165, 1
    s_mov_b64 exec, 1
    ds_add_u32 v164, v165
    s_mov_b64 exec, -1
    s_cmp_eq_u32 s69, 4
    s_cbranch_scc1 BU_173
BUB_174:
    v_mov_b32 v164, 0x2420c
    s_mov_b32 s80, 1600000
LW_175:
    ds_read_b32 v165, v164
    s_waitcnt lgkmcnt(0)
    v_readfirstlane_b32 s79, v165
    s_cmp_ge_u32 s79, s81
    s_cbranch_scc1 LWD_176
    s_sub_u32 s80, s80, 1
    s_cmp_lg_u32 s80, 0
    s_cbranch_scc1 LW_175
LWD_176:
    ds_read_b32 v160, v8 offset:0
    ds_read_b32 v161, v8 offset:256
    ds_read_b32 v162, v8 offset:512
    ds_read_b32 v163, v8 offset:768
    ds_read_b128 v[16:19], v7 offset:0
    ds_read_b128 v[20:23], v7 offset:1024
    ds_read_b128 v[24:27], v7 offset:2048
    ds_read_b128 v[28:31], v7 offset:3072
    v_xor_b32 v6, 0x1000, v6
    v_xor_b32 v7, 0x1000, v7
    v_add_u32 v5, 1024, v5
    v_add_u32 v8, 1024, v8
    s_waitcnt lgkmcnt(4)
    v_max3_f32 v14, v13, v160, v161
    v_max3_f32 v14, v14, v162, v163
    v_cmp_neq_f32 vcc, v14, v13
    v_sub_f32 v160, v14, v160
    v_sub_f32 v161, v14, v161
    v_sub_f32 v162, v14, v162
    v_sub_f32 v163, v14, v163
    v_cvt_u32_f32 v160, v160
    v_cvt_u32_f32 v161, v161
    v_cvt_u32_f32 v162, v162
    v_cvt_u32_f32 v163, v163
    v_min_u32 v160, 0xff, v160
    v_min_u32 v161, 0xff, v161
    v_min_u32 v162, 0xff, v162
    v_min_u32 v163, 0xff, v163
    v_mul_u32_u24 v160, s71, v160
    v_mul_u32_u24 v161, s71, v161
    v_mul_u32_u24 v162, s71, v162
    v_mul_u32_u24 v163, s71, v163
    s_cbranch_vccz BR_177
    v_sub_f32 v164, v13, v14
    v_exp_f32 v164, v164
    v_mov_b32 v13, v14
    v_pk_mul_f32 v[128:129], v[128:129], v[164:165] op_sel_hi:[1,0]
    v_pk_mul_f32 v[130:131], v[130:131], v[164:165] op_sel_hi:[1,0]
    v_pk_mul_f32 v[132:133], v[132:133], v[164:165] op_sel_hi:[1,0]
    v_pk_mul_f32 v[134:135], v[134:135], v[164:165] op_sel_hi:[1,0]
    v_pk_mul_f32 v[136:137], v[136:137], v[164:165] op_sel_hi:[1,0]
    v_pk_mul_f32 v[138:139], v[138:139], v[164:165] op_sel_hi:[1,0]
    v_pk_mul_f32 v[140:141], v[140:141], v[164:165] op_sel_hi:[1,0]
    v_pk_mul_f32 v[142:143], v[142:143], v[164:165] op_sel_hi:[1,0]
    v_pk_mul_f32 v[144:145], v[144:145], v[164:165] op_sel_hi:[1,0]
    v_pk_mul_f32 v[146:147], v[146:147], v[164:165] op_sel_hi:[1,0]
    v_pk_mul_f32 v[148:149], v[148:149], v[164:165] op_sel_hi:[1,0]
    v_pk_mul_f32 v[150:151], v[150:151], v[164:165] op_sel_hi:[1,0]
    v_pk_mul_f32 v[152:153], v[152:153], v[164:165] op_sel_hi:[1,0]
    v_pk_mul_f32 v[154:155], v[154:155], v[164:165] op_sel_hi:[1,0]
    v_pk_mul_f32 v[156:157], v[156:157], v[164:165] op_sel_hi:[1,0]
    v_pk_mul_f32 v[158:159], v[158:159], v[164:165] op_sel_hi:[1,0]
BR_177:
    s_waitcnt lgkmcnt(3)
    v_pk_sub_u16 v16, v16, v160 clamp
    v_pk_sub_u16 v17, v17, v160 clamp
    v_pk_sub_u16 v18, v18, v160 clamp
    v_pk_sub_u16 v19, v19, v160 clamp
    s_nop 1
    v_mfma_f32_32x32x16_bf16 v[128:143], v[96:99], v[16:19], v[128:143]
    v_mfma_f32_32x32x16_bf16 v[144:159], v[100:103], v[16:19], v[144:159]
    s_waitcnt lgkmcnt(2)
    v_pk_sub_u16 v20, v20, v161 clamp
    v_pk_sub_u16 v21, v21, v161 clamp
    v_pk_sub_u16 v22, v22, v161 clamp
    v_pk_sub_u16 v23, v23, v161 clamp
    s_nop 1
    v_mfma_f32_32x32x16_bf16 v[128:143], v[104:107], v[20:23], v[128:143]
    v_mfma_f32_32x32x16_bf16 v[144:159], v[108:111], v[20:23], v[144:159]
    s_waitcnt lgkmcnt(1)
    v_pk_sub_u16 v24, v24, v162 clamp
    v_pk_sub_u16 v25, v25, v162 clamp
    v_pk_sub_u16 v26, v26, v162 clamp
    v_pk_sub_u16 v27, v27, v162 clamp
    s_nop 1
    v_mfma_f32_32x32x16_bf16 v[128:143], v[112:115], v[24:27], v[128:143]
    v_mfma_f32_32x32x16_bf16 v[144:159], v[116:119], v[24:27], v[144:159]
    s_waitcnt lgkmcnt(0)
    v_pk_sub_u16 v28, v28, v163 clamp
    v_pk_sub_u16 v29, v29, v163 clamp
    v_pk_sub_u16 v30, v30, v163 clamp
    v_pk_sub_u16 v31, v31, v163 clamp
    s_nop 1
    v_mfma_f32_32x32x16_bf16 v[128:143], v[120:123], v[28:31], v[128:143]
    v_mfma_f32_32x32x16_bf16 v[144:159], v[124:127], v[28:31], v[144:159]
    s_add_u32 s67, s67, 4
    s_cmp_ge_u32 s67, 9
    s_cselect_b32 s7, 9, 0
    s_sub_u32 s67, s67, s7
    s_add_u32 s66, s66, 64
    s_add_u32 s70, s70, 64
    s_sub_u32 s69, s69, 1
    s_cmp_lg_u32 s69, 0
    s_cbranch_scc1 BS_167
    s_lshr_b32 s67, s60, 3
    s_and_b32 s68, s60, 7
    s_lshl_b32 s7, s60, 15
    s_lshl_b32 s63, s6, 12
    s_add_u32 s7, s7, s63
    s_add_u32 s7, s7, 0x600000
    v_lshl_add_u32 v5, v1, 4, s7
    v_mov_b32 v38, s92
    v_mov_b32 v39, s93
    v_permlane32_swap_b32 v128, v132
    v_permlane32_swap_b32 v129, v133
    v_permlane32_swap_b32 v130, v134
    v_permlane32_swap_b32 v131, v135
    v_cvt_pk_bf16_f32 v16, v128, v129
    v_cvt_pk_bf16_f32 v17, v130, v131
    v_cvt_pk_bf16_f32 v18, v132, v133
    v_cvt_pk_bf16_f32 v19, v134, v135
    v_permlane32_swap_b32 v136, v140
    v_permlane32_swap_b32 v137, v141
    v_permlane32_swap_b32 v138, v142
    v_permlane32_swap_b32 v139, v143
    v_cvt_pk_bf16_f32 v20, v136, v137
    v_cvt_pk_bf16_f32 v21, v138, v139
    v_cvt_pk_bf16_f32 v22, v140, v141
    v_cvt_pk_bf16_f32 v23, v142, v143
    v_permlane32_swap_b32 v144, v148
    v_permlane32_swap_b32 v145, v149
    v_permlane32_swap_b32 v146, v150
    v_permlane32_swap_b32 v147, v151
    v_cvt_pk_bf16_f32 v24, v144, v145
    v_cvt_pk_bf16_f32 v25, v146, v147
    v_cvt_pk_bf16_f32 v26, v148, v149
    v_cvt_pk_bf16_f32 v27, v150, v151
    v_permlane32_swap_b32 v152, v156
    v_permlane32_swap_b32 v153, v157
    v_permlane32_swap_b32 v154, v158
    v_permlane32_swap_b32 v155, v159
    v_cvt_pk_bf16_f32 v28, v152, v153
    v_cvt_pk_bf16_f32 v29, v154, v155
    v_cvt_pk_bf16_f32 v30, v156, v157
    v_cvt_pk_bf16_f32 v31, v158, v159
    s_lshl_b32 s7, s67, 9
    s_lshl_b32 s65, s6, 6
    s_add_u32 s7, s7, s65
    s_add_u32 s7, s7, 0x23000
    v_and_b32 v160, 7, v1
    v_lshl_add_u32 v7, v160, 3, s7
    s_lshl_b64 s[88:89], 1, s68
    s_cmp_eq_u32 s101, 0
    s_cbranch_scc1 SU_178
    buffer_store_dwordx4 v[16:19], v5, s[36:39], 0 offen offset:0
    buffer_store_dwordx4 v[20:23], v5, s[36:39], 0 offen offset:1024
    buffer_store_dwordx4 v[24:27], v5, s[36:39], 0 offen offset:2048
    buffer_store_dwordx4 v[28:31], v5, s[36:39], 0 offen offset:3072
    s_waitcnt vmcnt(0)
    s_mov_b64 exec, s[88:89]
    buffer_store_dwordx2 v[38:39], v7, s[36:39], 0 offen
    s_mov_b64 exec, -1
SV_179:
    s_lshl_b32 s7, s67, 18
    s_add_u32 s7, s7, s63
    s_lshl_b32 s65, s68, 6
    s_add_u32 s7, s7, s65
    s_add_u32 s7, s7, 0x600000
    v_and_b32 v160, 3, v1
    v_lshl_add_u32 v5, v160, 4, s7
    v_bfe_u32 v161, v1, 2, 3
    v_lshl_add_u32 v5, v161, 9, v5
    v_lshrrev_b32 v162, 5, v1
    v_lshl_add_u32 v5, v162, 15, v5
    s_lshl_b32 s7, s67, 12
    s_add_u32 s7, s7, s65
    s_add_u32 s7, s7, 0x28000
    v_lshl_add_u32 v6, v160, 4, s7
    v_lshl_add_u32 v6, v162, 9, v6
    s_lshl_b32 s7, s68, 15
    s_lshl_b32 s63, s67, 10
    s_add_u32 s7, s7, s63
    s_lshl_b32 s63, s6, 7
    s_add_u32 s7, s7, s63
    s_add_u32 s7, s7, 0x200000
    v_lshl_add_u32 v8, v160, 13, s7
    v_lshl_add_u32 v8, v161, 4, v8
    v_lshl_add_u32 v8, v162, 3, v8
    s_lshl_b32 s7, s67, 9
    s_add_u32 s7, s7, s65
    s_add_u32 s7, s7, 0x30000
    v_lshl_add_u32 v9, v160, 4, s7
    s_mov_b64 exec, 0xff
    buffer_load_dwordx2 v[40:41], v7, s[36:39], 0 offen sc1 nt
    s_mov_b32 s80, 200000
MC_181:
    s_mov_b64 exec, 0xff
    s_waitcnt vmcnt(0)
    v_cmp_ne_u64 s[86:87], s[92:93], v[40:41]
    s_cmp_lg_u64 s[86:87], 0
    s_cbranch_scc1 M_180
MD_182:
    s_mov_b64 exec, -1
    buffer_load_dwordx4 v[64:67], v6, s[36:39], 0 offen offset:0 sc1 nt
    buffer_load_dwordx4 v[68:71], v6, s[36:39], 0 offen offset:1024 sc1 nt
    buffer_load_dwordx4 v[72:75], v6, s[36:39], 0 offen offset:2048 sc1 nt
    buffer_load_dwordx4 v[76:79], v6, s[36:39], 0 offen offset:3072 sc1 nt
    s_mov_b32 s63, 0
    buffer_load_dwordx4 v[48:51], v5, s[36:39], s63 offen sc1 nt
    s_add_u32 s63, s63, 65536
    buffer_load_dwordx4 v[52:55], v5, s[36:39], s63 offen sc1 nt
    s_add_u32 s63, s63, 65536
    buffer_load_dwordx4 v[56:59], v5, s[36:39], s63 offen sc1 nt
    s_add_u32 s63, s63, 65536
    buffer_load_dwordx4 v[60:63], v5, s[36:39], s63 offen sc1 nt
    s_add_u32 s63, s63, 65536
    s_waitcnt vmcnt(4)
    v_cmp_ne_u64 s[90:91], s[92:93], v[66:67]
    v_cmp_ne_u64 vcc, s[92:93], v[70:71]
    s_or_b64 s[90:91], s[90:91], vcc
    v_cmp_ne_u64 vcc, s[92:93], v[74:75]
    s_or_b64 s[90:91], s[90:91], vcc
    v_cmp_ne_u64 vcc, s[92:93], v[78:79]
    s_or_b64 s[90:91], s[90:91], vcc
    s_cmp_lg_u64 s[90:91], 0
    s_cbranch_scc1 BL_183
BLD_184:
    v_max3_f32 v36, v64, v68, v72
    v_max_f32 v36, v36, v76
    v_mov_b32 v37, v36
    s_nop 1
    v_permlane32_swap_b32 v36, v37
    v_max_f32 v36, v36, v37
    v_sub_f32 v80, v64, v36
    v_sub_f32 v81, v68, v36
    v_sub_f32 v82, v72, v36
    v_sub_f32 v83, v76, v36
    v_exp_f32 v80, v80
    v_exp_f32 v81, v81
    v_exp_f32 v82, v82
    v_exp_f32 v83, v83
    v_mul_f32 v37, v80, v65
    v_fmac_f32 v37, v81, v69
    v_fmac_f32 v37, v82, v73
    v_fmac_f32 v37, v83, v77
    v_mov_b32 v40, v37
    s_nop 1
    v_permlane32_swap_b32 v37, v40
    v_add_f32 v37, v37, v40
    s_waitcnt vmcnt(3)
    v_lshlrev_b32 v88, 16, v48
    v_and_b32 v89, 0xffff0000, v48
    v_lshlrev_b32 v90, 16, v49
    v_and_b32 v91, 0xffff0000, v49
    v_lshlrev_b32 v92, 16, v50
    v_and_b32 v93, 0xffff0000, v50
    v_lshlrev_b32 v94, 16, v51
    v_and_b32 v95, 0xffff0000, v51
    v_mul_f32 v16, v88, v80
    v_mul_f32 v17, v89, v80
    v_mul_f32 v18, v90, v80
    v_mul_f32 v19, v91, v80
    v_mul_f32 v20, v92, v80
    v_mul_f32 v21, v93, v80
    v_mul_f32 v22, v94, v80
    v_mul_f32 v23, v95, v80
    s_waitcnt vmcnt(2)
    v_lshlrev_b32 v88, 16, v52
    v_and_b32 v89, 0xffff0000, v52
    v_lshlrev_b32 v90, 16, v53
    v_and_b32 v91, 0xffff0000, v53
    v_lshlrev_b32 v92, 16, v54
    v_and_b32 v93, 0xffff0000, v54
    v_lshlrev_b32 v94, 16, v55
    v_and_b32 v95, 0xffff0000, v55
    v_fmac_f32 v16, v88, v81
    v_fmac_f32 v17, v89, v81
    v_fmac_f32 v18, v90, v81
    v_fmac_f32 v19, v91, v81
    v_fmac_f32 v20, v92, v81
    v_fmac_f32 v21, v93, v81
    v_fmac_f32 v22, v94, v81
    v_fmac_f32 v23, v95, v81
    s_waitcnt vmcnt(1)
    v_lshlrev_b32 v88, 16, v56
    v_and_b32 v89, 0xffff0000, v56
    v_lshlrev_b32 v90, 16, v57
    v_and_b32 v91, 0xffff0000, v57
    v_lshlrev_b32 v92, 16, v58
    v_and_b32 v93, 0xffff0000, v58
    v_lshlrev_b32 v94, 16, v59
    v_and_b32 v95, 0xffff0000, v59
    v_fmac_f32 v16, v88, v82
    v_fmac_f32 v17, v89, v82
    v_fmac_f32 v18, v90, v82
    v_fmac_f32 v19, v91, v82
    v_fmac_f32 v20, v92, v82
    v_fmac_f32 v21, v93, v82
    v_fmac_f32 v22, v94, v82
    v_fmac_f32 v23, v95, v82
    s_waitcnt vmcnt(0)
    v_mov_b32 v160, 0x24218
    v_mov_b32 v161, 1
    s_mov_b64 exec, 1
    ds_add_u32 v160, v161
    s_mov_b64 exec, -1
    v_lshlrev_b32 v88, 16, v60
    v_and_b32 v89, 0xffff0000, v60
    v_lshlrev_b32 v90, 16, v61
    v_and_b32 v91, 0xffff0000, v61
    v_lshlrev_b32 v92, 16, v62
    v_and_b32 v93, 0xffff0000, v62
    v_lshlrev_b32 v94, 16, v63
    v_and_b32 v95, 0xffff0000, v63
    v_fmac_f32 v16, v88, v83
    v_fmac_f32 v17, v89, v83
    v_fmac_f32 v18, v90, v83
    v_fmac_f32 v19, v91, v83
    v_fmac_f32 v20, v92, v83
    v_fmac_f32 v21, v93, v83
    v_fmac_f32 v22, v94, v83
    v_fmac_f32 v23, v95, v83
    v_permlane32_swap_b32 v16, v20
    v_permlane32_swap_b32 v17, v21
    v_permlane32_swap_b32 v18, v22
    v_permlane32_swap_b32 v19, v23
    v_add_f32 v16, v16, v20
    v_add_f32 v17, v17, v21
    v_add_f32 v18, v18, v22
    v_add_f32 v19, v19, v23
    v_cvt_pk_bf16_f32 v44, v16, v17
    v_cvt_pk_bf16_f32 v45, v18, v19
    v_mov_b32 v160, 0x24218
    s_mov_b32 s80, 1600000
LW_185:
    ds_read_b32 v161, v160
    s_waitcnt lgkmcnt(0)
    v_readfirstlane_b32 s79, v161
    s_cmp_ge_u32 s79, 8
    s_cbranch_scc1 LWD_186
    s_sub_u32 s80, s80, 1
    s_cmp_lg_u32 s80, 0
    s_cbranch_scc1 LW_185
LWD_186:
    buffer_store_dwordx2 v[44:45], v8, s[36:39], 0 offen sc1
    s_cmp_lg_u32 s6, 0
    s_cbranch_scc1 BM2_187
    s_mov_b64 exec, 15
    buffer_store_dwordx4 v[36:39], v9, s[36:39], 0 offen sc1
    s_mov_b64 exec, -1
BM2_187:
    v_mov_b32 v160, 0x24218
    v_mov_b32 v161, 1
    s_mov_b64 exec, 1
    ds_add_u32 v160, v161
    s_mov_b64 exec, -1
    s_lshl_b32 s7, s67, 13
    s_lshl_b32 s63, s6, 10
    s_add_u32 s7, s7, s63
    s_add_u32 s7, s7, 0xc0000
    v_lshl_add_u32 v4, v1, 4, s7
    v_lshrrev_b32 v160, 2, v3
    v_mul_u32_u24 v5, 1088, v160
    v_and_b32 v160, 3, v1
    v_lshl_add_u32 v5, v160, 4, v5
    v_lshrrev_b32 v161, 5, v1
    v_lshl_add_u32 v5, v161, 6, v5
    v_and_b32 v161, 1, v2
    v_lshl_add_u32 v5, v161, 3, v5
    s_lshl_b32 s7, s6, 7
    s_add_u32 s7, s7, 0x26000
    v_add_u32 v5, s7, v5
    v_mul_u32_u24 v6, 1088, v160
    v_lshl_add_u32 v6, v2, 4, v6
    v_add_u32 v6, 0x26000, v6
    s_lshl_b32 s7, s68, 2
    s_add_u32 s7, s7, s6
    s_lshl_b32 s7, s7, 3
    s_add_u32 s7, s7, s67
    s_lshl_b32 s7, s7, 8
    s_add_u32 s7, s7, 0x2c0000
    v_lshl_add_u32 v7, v160, 6, s7
    v_lshl_add_u32 v7, v2, 4, v7
    v_cmp_gt_u32 s[84:85], 4, v3
    v_bfe_u32 v8, v1, 3, 2
    v_xor_b32 v8, s6, v8
    v_lshlrev_b32 v8, 5, v8
    v_lshrrev_b32 v161, 2, v1
    v_lshl_add_u32 v8, v161, 7, v8
    v_lshl_add_u32 v8, v160, 3, v8
    s_cmp_ge_u32 s6, 4
    s_cbranch_scc1 W4_188
    v_add_u32 v9, 114688, v8
    v_mov_b32 v162, 0x24000
    s_mov_b32 s80, 1600000
LW_189:
    ds_read_b32 v163, v162
    s_waitcnt lgkmcnt(0)
    v_readfirstlane_b32 s79, v163
    s_cmp_ge_u32 s79, 288
    s_cbranch_scc1 LWD_190
    s_sleep 1
    s_sub_u32 s80, s80, 1
    s_cmp_lg_u32 s80, 0
    s_cbranch_scc1 LW_189
LWD_190:
    ds_read_b64_tr_b16 v[48:49], v9 offset:0
    ds_read_b64_tr_b16 v[50:51], v9 offset:2048
    ds_read_b64_tr_b16 v[52:53], v9 offset:4096
    ds_read_b64_tr_b16 v[54:55], v9 offset:6144
    ds_read_b64_tr_b16 v[56:57], v9 offset:8192
    ds_read_b64_tr_b16 v[58:59], v9 offset:10240
    ds_read_b64_tr_b16 v[60:61], v9 offset:12288
    ds_read_b64_tr_b16 v[62:63], v9 offset:14336
    s_waitcnt lgkmcnt(4)
    ds_read_b64_tr_b16 v[64:65], v9 offset:16384
    ds_read_b64_tr_b16 v[66:67], v9 offset:18432
    ds_read_b64_tr_b16 v[68:69], v9 offset:20480
    ds_read_b64_tr_b16 v[70:71], v9 offset:22528
    ds_read_b64_tr_b16 v[72:73], v9 offset:24576
    ds_read_b64_tr_b16 v[74:75], v9 offset:26624
    ds_read_b64_tr_b16 v[76:77], v9 offset:28672
    ds_read_b64_tr_b16 v[78:79], v9 offset:30720
    s_waitcnt lgkmcnt(4)
    v_mov_b32 v162, 0x24000
    s_mov_b32 s80, 1600000
LW_191:
    ds_read_b32 v163, v162
    s_waitcnt lgkmcnt(0)
    v_readfirstlane_b32 s79, v163
    s_cmp_ge_u32 s79, 320
    s_cbranch_scc1 LWD_192
    s_sleep 1
    s_sub_u32 s80, s80, 1
    s_cmp_lg_u32 s80, 0
    s_cbranch_scc1 LW_191
LWD_192:
    ds_read_b64_tr_b16 v[80:81], v8 offset:0
    ds_read_b64_tr_b16 v[82:83], v8 offset:2048
    ds_read_b64_tr_b16 v[84:85], v8 offset:4096
    ds_read_b64_tr_b16 v[86:87], v8 offset:6144
    ds_read_b64_tr_b16 v[88:89], v8 offset:8192
    ds_read_b64_tr_b16 v[90:91], v8 offset:10240
    ds_read_b64_tr_b16 v[92:93], v8 offset:12288
    ds_read_b64_tr_b16 v[94:95], v8 offset:14336
    s_waitcnt lgkmcnt(4)
    ds_read_b64_tr_b16 v[96:97], v8 offset:16384
    ds_read_b64_tr_b16 v[98:99], v8 offset:18432
    ds_read_b64_tr_b16 v[100:101], v8 offset:20480
    ds_read_b64_tr_b16 v[102:103], v8 offset:22528
    ds_read_b64_tr_b16 v[104:105], v8 offset:24576
    ds_read_b64_tr_b16 v[106:107], v8 offset:26624
    ds_read_b64_tr_b16 v[108:109], v8 offset:28672
    ds_read_b64_tr_b16 v[110:111], v8 offset:30720
    s_waitcnt lgkmcnt(4)
W4_188:
    s_mov_b64 exec, -1
    buffer_load_dwordx4 v[16:19], v4, s[36:39], 0 offen sc1 nt
    s_mov_b32 s80, 200000
MC_194:
    s_mov_b64 exec, -1
    s_waitcnt vmcnt(0)
    v_cmp_ne_u64 s[86:87], s[92:93], v[18:19]
    s_cmp_lg_u64 s[86:87], 0
    s_cbranch_scc1 M_193
MD_195:
    s_mov_b64 exec, -1
    ds_write_b64 v5, v[16:17]
    s_add_u32 s81, s81, 8
    v_mov_b32 v160, 0x2420c
    v_mov_b32 v161, 1
    s_mov_b64 exec, 1
    ds_add_u32 v160, v161
    s_mov_b64 exec, -1
    s_cmp_ge_u32 s6, 4
    s_cbranch_scc1 L_END
    v_mov_b32 v160, 0x2420c
    s_mov_b32 s80, 1600000
LW_196:
    ds_read_b32 v161, v160
    s_waitcnt lgkmcnt(0)
    v_readfirstlane_b32 s79, v161
    s_cmp_ge_u32 s79, s81
    s_cbranch_scc1 LWD_197
    s_sub_u32 s80, s80, 1
    s_cmp_lg_u32 s80, 0
    s_cbranch_scc1 LW_196
LWD_197:
    ds_read_b128 v[112:115], v6 offset:0
    ds_read_b128 v[116:119], v6 offset:64
    ds_read_b128 v[120:123], v6 offset:128
    ds_read_b128 v[124:127], v6 offset:192
    ds_read_b128 v[128:131], v6 offset:256
    ds_read_b128 v[132:135], v6 offset:320
    ds_read_b128 v[136:139], v6 offset:384
    ds_read_b128 v[140:143], v6 offset:448
    ds_read_b128 v[144:147], v6 offset:512
    ds_read_b128 v[148:151], v6 offset:576
    ds_read_b128 v[152:155], v6 offset:640
    ds_read_b128 v[156:159], v6 offset:704
    s_waitcnt lgkmcnt(8)
    ds_read_b128 v[20:23], v6 offset:768
    ds_read_b128 v[24:27], v6 offset:832
    ds_read_b128 v[28:31], v6 offset:896
    ds_read_b128 v[32:35], v6 offset:960
    v_mfma_f32_16x16x32_bf16 v[12:15], v[48:51], v[112:115], 0
    v_mfma_f32_16x16x32_bf16 v[12:15], v[52:55], v[116:119], v[12:15]
    v_mfma_f32_16x16x32_bf16 v[12:15], v[56:59], v[120:123], v[12:15]
    v_mfma_f32_16x16x32_bf16 v[12:15], v[60:63], v[124:127], v[12:15]
    s_waitcnt lgkmcnt(11)
    v_mfma_f32_16x16x32_bf16 v[12:15], v[64:67], v[128:131], v[12:15]
    s_waitcnt lgkmcnt(10)
    v_mfma_f32_16x16x32_bf16 v[12:15], v[68:71], v[132:135], v[12:15]
    s_waitcnt lgkmcnt(9)
    v_mfma_f32_16x16x32_bf16 v[12:15], v[72:75], v[136:139], v[12:15]
    s_waitcnt lgkmcnt(8)
    v_mfma_f32_16x16x32_bf16 v[12:15], v[76:79], v[140:143], v[12:15]
    s_waitcnt lgkmcnt(7)
    v_mfma_f32_16x16x32_bf16 v[12:15], v[80:83], v[144:147], v[12:15]
    s_waitcnt lgkmcnt(6)
    v_mfma_f32_16x16x32_bf16 v[12:15], v[84:87], v[148:151], v[12:15]
    s_waitcnt lgkmcnt(5)
    v_mfma_f32_16x16x32_bf16 v[12:15], v[88:91], v[152:155], v[12:15]
    s_waitcnt lgkmcnt(4)
    v_mfma_f32_16x16x32_bf16 v[12:15], v[92:95], v[156:159], v[12:15]
    s_waitcnt lgkmcnt(3)
    v_mfma_f32_16x16x32_bf16 v[12:15], v[96:99], v[20:23], v[12:15]
    s_waitcnt lgkmcnt(2)
    v_mfma_f32_16x16x32_bf16 v[12:15], v[100:103], v[24:27], v[12:15]
    s_waitcnt lgkmcnt(1)
    v_mfma_f32_16x16x32_bf16 v[12:15], v[104:107], v[28:31], v[12:15]
    s_waitcnt lgkmcnt(0)
    v_mfma_f32_16x16x32_bf16 v[12:15], v[108:111], v[32:35], v[12:15]
    s_nop 7
    v_cvt_pk_bf16_f32 v16, v12, v13
    v_cvt_pk_bf16_f32 v17, v14, v15
    s_mov_b64 exec, s[84:85]
    buffer_store_dwordx4 v[16:19], v7, s[36:39], 0 offen sc1
    s_mov_b64 exec, -1
    v_mov_b32 v160, 0x24214
    v_mov_b32 v161, 1
    s_mov_b64 exec, 1
    ds_add_u32 v160, v161
    s_mov_b64 exec, -1
    s_endpgm
RA_12:
    v_mov_b32 v12, 0x24000
    s_mov_b32 s80, 1600000
LW_198:
    ds_read_b32 v13, v12
    s_waitcnt lgkmcnt(0)
    v_readfirstlane_b32 s79, v13
    s_cmp_ge_u32 s79, s65
    s_cbranch_scc1 LWD_199
    s_sleep 1
    s_sub_u32 s80, s80, 1
    s_cmp_lg_u32 s80, 0
    s_cbranch_scc1 LW_198
LWD_199:
    ds_read_b64_tr_b16 v[32:33], v10 offset:0
    ds_read_b64_tr_b16 v[34:35], v10 offset:4096
    ds_read_b64_tr_b16 v[36:37], v11 offset:0
    ds_read_b64_tr_b16 v[38:39], v11 offset:4096
    ds_read_b64_tr_b16 v[40:41], v10 offset:8192
    ds_read_b64_tr_b16 v[42:43], v10 offset:12288
    ds_read_b64_tr_b16 v[44:45], v11 offset:8192
    ds_read_b64_tr_b16 v[46:47], v11 offset:12288
    s_waitcnt vmcnt(0)
    s_branch RB_13
E2_14:
    v_add_u32 v10, 0xffff8000, v10
    v_add_u32 v11, 0xffff8000, v11
    ds_read_b64_tr_b16 v[48:49], v10 offset:0
    ds_read_b64_tr_b16 v[50:51], v10 offset:4096
    ds_read_b64_tr_b16 v[52:53], v11 offset:0
    ds_read_b64_tr_b16 v[54:55], v11 offset:4096
    ds_read_b64_tr_b16 v[56:57], v10 offset:8192
    ds_read_b64_tr_b16 v[58:59], v10 offset:12288
    ds_read_b64_tr_b16 v[60:61], v11 offset:8192
    ds_read_b64_tr_b16 v[62:63], v11 offset:12288
    v_lshlrev_b32 v12, 2, v1
    v_add_u32 v12, 0x24130, v12
    v_mov_b32 v13, 1
    s_mov_b64 exec, 3
    ds_add_u32 v12, v13
    s_mov_b64 exec, -1
    s_waitcnt lgkmcnt(0)
    v_mfma_f32_16x16x32_bf16 v[24:27], v[48:51], v[136:139], v[24:27]
    v_mfma_f32_16x16x32_bf16 v[28:31], v[52:55], v[136:139], v[28:31]
    v_mfma_f32_16x16x32_bf16 v[24:27], v[56:59], v[140:143], v[24:27]
    v_mfma_f32_16x16x32_bf16 v[28:31], v[60:63], v[140:143], v[28:31]
    s_branch E3_15
SU_21:
    s_nop 3
    buffer_store_dwordx4 v[40:43], v4, s[36:39], 0 offen sc1
    s_branch SV_22
M_25:
    s_sub_u32 s80, s80, 1
    s_cmp_le_u32 s80, 199994
    s_cbranch_scc1 G2_24
    s_mov_b64 exec, s[44:45]
    s_cbranch_execz RS_200
    buffer_load_dwordx4 v[48:51], v7, s[36:39], 0 offen sc1 nt
RS_200:
    s_mov_b64 exec, s[46:47]
    s_cbranch_execz RS_201
    buffer_load_dwordx4 v[52:55], v7, s[36:39], s62 offen sc1 nt
RS_201:
    s_mov_b64 exec, s[48:49]
    s_cbranch_execz RS_202
    buffer_load_dwordx4 v[56:59], v9, s[36:39], 0 offen sc1 nt
RS_202:
    s_mov_b64 exec, s[50:51]
    s_cbranch_execz RS_203
    buffer_load_dwordx4 v[60:63], v9, s[36:39], s76 offen sc1 nt
RS_203:
    s_branch MC_26
G2_24:
    s_mov_b32 s64, 16
    s_mov_b64 exec, -1
    v_mov_b32 v12, 0x24204
    s_mov_b32 s80, 1600000
LW_204:
    ds_read_b32 v13, v12
    s_waitcnt lgkmcnt(0)
    v_readfirstlane_b32 s79, v13
    s_cmp_ge_u32 s79, 1
    s_cbranch_scc1 LWD_205
    s_sleep 1
    s_sub_u32 s80, s80, 1
    s_cmp_lg_u32 s80, 0
    s_cbranch_scc1 LW_204
LWD_205:
    v_mov_b32 v12, 0x24248
    ds_read_b64 v[14:15], v12
    s_waitcnt lgkmcnt(0)
    v_readfirstlane_b32 s92, v14
    v_readfirstlane_b32 s93, v15
    s_nop 0
    v_mov_b32 v42, s92
    v_mov_b32 v43, s93
    s_mov_b64 exec, s[84:85]
    buffer_store_dwordx4 v[40:43], v4, s[36:39], 0 offen sc1
    s_mov_b64 exec, s[86:87]
    s_mov_b32 s80, 200000
P_206:
    buffer_load_dwordx4 v[48:51], v7, s[36:39], 0 offen sc1 nt
    buffer_load_dwordx4 v[52:55], v7, s[36:39], s62 offen sc1 nt
    buffer_load_dwordx4 v[56:59], v9, s[36:39], 0 offen sc1 nt
    buffer_load_dwordx4 v[60:63], v9, s[36:39], s76 offen sc1 nt
PP_207:
    s_waitcnt vmcnt(0)
    s_mov_b64 s[90:91], 0
    v_cmp_gt_u64 s[88:89], s[94:95], v[50:51]
    v_cmp_le_u64 vcc, s[72:73], v[50:51]
    s_or_b64 s[88:89], s[88:89], vcc
    v_cmp_ne_u64 vcc, s[92:93], v[50:51]
    s_and_b64 vcc, vcc, s[88:89]
    s_or_b64 s[90:91], s[90:91], vcc
    v_cmp_gt_u64 s[88:89], s[94:95], v[54:55]
    v_cmp_le_u64 vcc, s[72:73], v[54:55]
    s_or_b64 s[88:89], s[88:89], vcc
    v_cmp_ne_u64 vcc, s[92:93], v[54:55]
    s_and_b64 vcc, vcc, s[88:89]
    s_or_b64 s[90:91], s[90:91], vcc
    v_cmp_gt_u64 s[88:89], s[94:95], v[58:59]
    v_cmp_le_u64 vcc, s[72:73], v[58:59]
    s_or_b64 s[88:89], s[88:89], vcc
    v_cmp_ne_u64 vcc, s[92:93], v[58:59]
    s_and_b64 vcc, vcc, s[88:89]
    s_or_b64 s[90:91], s[90:91], vcc
    v_cmp_gt_u64 s[88:89], s[94:95], v[62:63]
    v_cmp_le_u64 vcc, s[72:73], v[62:63]
    s_or_b64 s[88:89], s[88:89], vcc
    v_cmp_ne_u64 vcc, s[92:93], v[62:63]
    s_and_b64 vcc, vcc, s[88:89]
    s_or_b64 s[90:91], s[90:91], vcc
    s_cbranch_scc0 PD_208
    s_sleep 1
    s_sub_u32 s80, s80, 1
    s_cmp_lg_u32 s80, 0
    s_cbranch_scc1 P_206
PD_208:
    s_branch MD_27
ST_42:
    ds_read_b32 v18, v17
    s_waitcnt lgkmcnt(0)
    v_readlane_b32 s79, v18, s62
    s_cmp_ge_u32 s79, s63
    s_cbranch_scc1 GO_41
    s_waitcnt vmcnt(8)
    s_sub_u32 s7, s60, 8
    s_max_i32 s61, s61, s7
    v_mov_b32 v19, s61
    ds_write_b32 v16, v19
    ds_read_b32 v18, v17
    s_waitcnt lgkmcnt(0)
    v_readlane_b32 s79, v18, s62
    s_cmp_ge_u32 s79, s63
    s_cbranch_scc1 GO_41
    s_waitcnt vmcnt(0)
    s_mov_b32 s61, s60
    v_mov_b32 v19, s61
    ds_write_b32 v16, v19
    ds_read_b32 v18, v17
    s_waitcnt lgkmcnt(0)
    v_readlane_b32 s79, v18, s62
    s_cmp_ge_u32 s79, s63
    s_cbranch_scc1 GO_41
    s_mov_b32 s80, 1600000
SP_209:
    ds_read_b32 v18, v17
    s_waitcnt lgkmcnt(0)
    v_readlane_b32 s79, v18, s62
    s_cmp_ge_u32 s79, s63
    s_cbranch_scc1 GO_41
    s_sub_u32 s80, s80, 1
    s_cmp_lg_u32 s80, 0
    s_cbranch_scc1 SP_209
    s_branch GO_41
ST_45:
    ds_read_b32 v18, v17
    s_waitcnt lgkmcnt(0)
    v_readlane_b32 s79, v18, s62
    s_cmp_ge_u32 s79, s63
    s_cbranch_scc1 GO_44
    s_waitcnt vmcnt(16)
    s_sub_u32 s7, s60, 16
    s_max_i32 s61, s61, s7
    v_mov_b32 v19, s61
    ds_write_b32 v16, v19
    ds_read_b32 v18, v17
    s_waitcnt lgkmcnt(0)
    v_readlane_b32 s79, v18, s62
    s_cmp_ge_u32 s79, s63
    s_cbranch_scc1 GO_44
    s_waitcnt vmcnt(8)
    s_sub_u32 s7, s60, 8
    s_max_i32 s61, s61, s7
    v_mov_b32 v19, s61
    ds_write_b32 v16, v19
    ds_read_b32 v18, v17
    s_waitcnt lgkmcnt(0)
    v_readlane_b32 s79, v18, s62
    s_cmp_ge_u32 s79, s63
    s_cbranch_scc1 GO_44
    s_waitcnt vmcnt(0)
    s_mov_b32 s61, s60
    v_mov_b32 v19, s61
    ds_write_b32 v16, v19
    ds_read_b32 v18, v17
    s_waitcnt lgkmcnt(0)
    v_readlane_b32 s79, v18, s62
    s_cmp_ge_u32 s79, s63
    s_cbranch_scc1 GO_44
    s_mov_b32 s80, 1600000
SP_210:
    ds_read_b32 v18, v17
    s_waitcnt lgkmcnt(0)
    v_readlane_b32 s79, v18, s62
    s_cmp_ge_u32 s79, s63
    s_cbranch_scc1 GO_44
    s_sub_u32 s80, s80, 1
    s_cmp_lg_u32 s80, 0
    s_cbranch_scc1 SP_210
    s_branch GO_44
ST_48:
    ds_read_b32 v18, v17
    s_waitcnt lgkmcnt(0)
    v_readlane_b32 s79, v18, s62
    s_cmp_ge_u32 s79, s63
    s_cbranch_scc1 GO_47
    s_waitcnt vmcnt(16)
    s_sub_u32 s7, s60, 16
    s_max_i32 s61, s61, s7
    v_mov_b32 v19, s61
    ds_write_b32 v16, v19
    ds_read_b32 v18, v17
    s_waitcnt lgkmcnt(0)
    v_readlane_b32 s79, v18, s62
    s_cmp_ge_u32 s79, s63
    s_cbranch_scc1 GO_47
    s_waitcnt vmcnt(8)
    s_sub_u32 s7, s60, 8
    s_max_i32 s61, s61, s7
    v_mov_b32 v19, s61
    ds_write_b32 v16, v19
    ds_read_b32 v18, v17
    s_waitcnt lgkmcnt(0)
    v_readlane_b32 s79, v18, s62
    s_cmp_ge_u32 s79, s63
    s_cbranch_scc1 GO_47
    s_waitcnt vmcnt(0)
    s_mov_b32 s61, s60
    v_mov_b32 v19, s61
    ds_write_b32 v16, v19
    ds_read_b32 v18, v17
    s_waitcnt lgkmcnt(0)
    v_readlane_b32 s79, v18, s62
    s_cmp_ge_u32 s79, s63
    s_cbranch_scc1 GO_47
    s_mov_b32 s80, 1600000
SP_211:
    ds_read_b32 v18, v17
    s_waitcnt lgkmcnt(0)
    v_readlane_b32 s79, v18, s62
    s_cmp_ge_u32 s79, s63
    s_cbranch_scc1 GO_47
    s_sub_u32 s80, s80, 1
    s_cmp_lg_u32 s80, 0
    s_cbranch_scc1 SP_211
    s_branch GO_47
ST_51:
    ds_read_b32 v18, v17
    s_waitcnt lgkmcnt(0)
    v_readlane_b32 s79, v18, s62
    s_cmp_ge_u32 s79, s63
    s_cbranch_scc1 GO_50
    s_waitcnt vmcnt(24)
    s_sub_u32 s7, s60, 24
    s_max_i32 s61, s61, s7
    v_mov_b32 v19, s61
    ds_write_b32 v16, v19
    ds_read_b32 v18, v17
    s_waitcnt lgkmcnt(0)
    v_readlane_b32 s79, v18, s62
    s_cmp_ge_u32 s79, s63
    s_cbranch_scc1 GO_50
    s_waitcnt vmcnt(16)
    s_sub_u32 s7, s60, 16
    s_max_i32 s61, s61, s7
    v_mov_b32 v19, s61
    ds_write_b32 v16, v19
    ds_read_b32 v18, v17
    s_waitcnt lgkmcnt(0)
    v_readlane_b32 s79, v18, s62
    s_cmp_ge_u32 s79, s63
    s_cbranch_scc1 GO_50
    s_waitcnt vmcnt(8)
    s_sub_u32 s7, s60, 8
    s_max_i32 s61, s61, s7
    v_mov_b32 v19, s61
    ds_write_b32 v16, v19
    ds_read_b32 v18, v17
    s_waitcnt lgkmcnt(0)
    v_readlane_b32 s79, v18, s62
    s_cmp_ge_u32 s79, s63
    s_cbranch_scc1 GO_50
    s_waitcnt vmcnt(0)
    s_mov_b32 s61, s60
    v_mov_b32 v19, s61
    ds_write_b32 v16, v19
    ds_read_b32 v18, v17
    s_waitcnt lgkmcnt(0)
    v_readlane_b32 s79, v18, s62
    s_cmp_ge_u32 s79, s63
    s_cbranch_scc1 GO_50
    s_mov_b32 s80, 1600000
SP_212:
    ds_read_b32 v18, v17
    s_waitcnt lgkmcnt(0)
    v_readlane_b32 s79, v18, s62
    s_cmp_ge_u32 s79, s63
    s_cbranch_scc1 GO_50
    s_sub_u32 s80, s80, 1
    s_cmp_lg_u32 s80, 0
    s_cbranch_scc1 SP_212
    s_branch GO_50
M_56:
    s_sub_u32 s80, s80, 1
    s_cmp_le_u32 s80, 0
    s_cbranch_scc1 MD_58
    s_mov_b64 exec, s[62:63]
    s_cbranch_execz RS_213
    buffer_load_dwordx4 v[48:51], v36, s[36:39], 0 offen offset:0 sc1
RS_213:
    s_mov_b64 exec, s[64:65]
    s_cbranch_execz RS_214
    buffer_load_dwordx4 v[52:55], v36, s[36:39], 0 offen offset:1024 sc1
RS_214:
    s_mov_b64 exec, s[66:67]
    s_cbranch_execz RS_215
    buffer_load_dwordx4 v[56:59], v36, s[36:39], 0 offen offset:2048 sc1
RS_215:
    s_mov_b64 exec, s[68:69]
    s_cbranch_execz RS_216
    buffer_load_dwordx4 v[60:63], v36, s[36:39], 0 offen offset:3072 sc1
RS_216:
    s_branch MC_57
ST_65:
    ds_read_b32 v18, v17
    s_waitcnt lgkmcnt(0)
    v_readlane_b32 s79, v18, s62
    s_cmp_ge_u32 s79, s63
    s_cbranch_scc1 GO_64
    s_waitcnt vmcnt(16)
    s_sub_u32 s7, s60, 16
    s_max_i32 s61, s61, s7
    v_mov_b32 v19, s61
    ds_write_b32 v16, v19
    ds_read_b32 v18, v17
    s_waitcnt lgkmcnt(0)
    v_readlane_b32 s79, v18, s62
    s_cmp_ge_u32 s79, s63
    s_cbranch_scc1 GO_64
    s_waitcnt vmcnt(8)
    s_sub_u32 s7, s60, 8
    s_max_i32 s61, s61, s7
    v_mov_b32 v19, s61
    ds_write_b32 v16, v19
    ds_read_b32 v18, v17
    s_waitcnt lgkmcnt(0)
    v_readlane_b32 s79, v18, s62
    s_cmp_ge_u32 s79, s63
    s_cbranch_scc1 GO_64
    s_waitcnt vmcnt(0)
    s_mov_b32 s61, s60
    v_mov_b32 v19, s61
    ds_write_b32 v16, v19
    ds_read_b32 v18, v17
    s_waitcnt lgkmcnt(0)
    v_readlane_b32 s79, v18, s62
    s_cmp_ge_u32 s79, s63
    s_cbranch_scc1 GO_64
    s_mov_b32 s80, 1600000
SP_217:
    ds_read_b32 v18, v17
    s_waitcnt lgkmcnt(0)
    v_readlane_b32 s79, v18, s62
    s_cmp_ge_u32 s79, s63
    s_cbranch_scc1 GO_64
    s_sub_u32 s80, s80, 1
    s_cmp_lg_u32 s80, 0
    s_cbranch_scc1 SP_217
    s_branch GO_64
ST_68:
    ds_read_b32 v18, v17
    s_waitcnt lgkmcnt(0)
    v_readlane_b32 s79, v18, s62
    s_cmp_ge_u32 s79, s63
    s_cbranch_scc1 GO_67
    s_waitcnt vmcnt(16)
    s_sub_u32 s7, s60, 16
    s_max_i32 s61, s61, s7
    v_mov_b32 v19, s61
    ds_write_b32 v16, v19
    ds_read_b32 v18, v17
    s_waitcnt lgkmcnt(0)
    v_readlane_b32 s79, v18, s62
    s_cmp_ge_u32 s79, s63
    s_cbranch_scc1 GO_67
    s_waitcnt vmcnt(8)
    s_sub_u32 s7, s60, 8
    s_max_i32 s61, s61, s7
    v_mov_b32 v19, s61
    ds_write_b32 v16, v19
    ds_read_b32 v18, v17
    s_waitcnt lgkmcnt(0)
    v_readlane_b32 s79, v18, s62
    s_cmp_ge_u32 s79, s63
    s_cbranch_scc1 GO_67
    s_waitcnt vmcnt(0)
    s_mov_b32 s61, s60
    v_mov_b32 v19, s61
    ds_write_b32 v16, v19
    ds_read_b32 v18, v17
    s_waitcnt lgkmcnt(0)
    v_readlane_b32 s79, v18, s62
    s_cmp_ge_u32 s79, s63
    s_cbranch_scc1 GO_67
    s_mov_b32 s80, 1600000
SP_218:
    ds_read_b32 v18, v17
    s_waitcnt lgkmcnt(0)
    v_readlane_b32 s79, v18, s62
    s_cmp_ge_u32 s79, s63
    s_cbranch_scc1 GO_67
    s_sub_u32 s80, s80, 1
    s_cmp_lg_u32 s80, 0
    s_cbranch_scc1 SP_218
    s_branch GO_67
ST_71:
    ds_read_b32 v18, v17
    s_waitcnt lgkmcnt(0)
    v_readlane_b32 s79, v18, s62
    s_cmp_ge_u32 s79, s63
    s_cbranch_scc1 GO_70
    s_waitcnt vmcnt(24)
    s_sub_u32 s7, s60, 24
    s_max_i32 s61, s61, s7
    v_mov_b32 v19, s61
    ds_write_b32 v16, v19
    ds_read_b32 v18, v17
    s_waitcnt lgkmcnt(0)
    v_readlane_b32 s79, v18, s62
    s_cmp_ge_u32 s79, s63
    s_cbranch_scc1 GO_70
    s_waitcnt vmcnt(16)
    s_sub_u32 s7, s60, 16
    s_max_i32 s61, s61, s7
    v_mov_b32 v19, s61
    ds_write_b32 v16, v19
    ds_read_b32 v18, v17
    s_waitcnt lgkmcnt(0)
    v_readlane_b32 s79, v18, s62
    s_cmp_ge_u32 s79, s63
    s_cbranch_scc1 GO_70
    s_waitcnt vmcnt(8)
    s_sub_u32 s7, s60, 8
    s_max_i32 s61, s61, s7
    v_mov_b32 v19, s61
    ds_write_b32 v16, v19
    ds_read_b32 v18, v17
    s_waitcnt lgkmcnt(0)
    v_readlane_b32 s79, v18, s62
    s_cmp_ge_u32 s79, s63
    s_cbranch_scc1 GO_70
    s_waitcnt vmcnt(0)
    s_mov_b32 s61, s60
    v_mov_b32 v19, s61
    ds_write_b32 v16, v19
    ds_read_b32 v18, v17
    s_waitcnt lgkmcnt(0)
    v_readlane_b32 s79, v18, s62
    s_cmp_ge_u32 s79, s63
    s_cbranch_scc1 GO_70
    s_mov_b32 s80, 1600000
SP_219:
    ds_read_b32 v18, v17
    s_waitcnt lgkmcnt(0)
    v_readlane_b32 s79, v18, s62
    s_cmp_ge_u32 s79, s63
    s_cbranch_scc1 GO_70
    s_sub_u32 s80, s80, 1
    s_cmp_lg_u32 s80, 0
    s_cbranch_scc1 SP_219
    s_branch GO_70
ST_79:
    ds_read_b32 v18, v17
    s_waitcnt lgkmcnt(0)
    v_readlane_b32 s79, v18, s62
    s_cmp_ge_u32 s79, s63
    s_cbranch_scc1 GO_78
    s_waitcnt vmcnt(24)
    s_sub_u32 s7, s60, 24
    s_max_i32 s61, s61, s7
    v_mov_b32 v19, s61
    ds_write_b32 v16, v19
    ds_read_b32 v18, v17
    s_waitcnt lgkmcnt(0)
    v_readlane_b32 s79, v18, s62
    s_cmp_ge_u32 s79, s63
    s_cbranch_scc1 GO_78
    s_waitcnt vmcnt(16)
    s_sub_u32 s7, s60, 16
    s_max_i32 s61, s61, s7
    v_mov_b32 v19, s61
    ds_write_b32 v16, v19
    ds_read_b32 v18, v17
    s_waitcnt lgkmcnt(0)
    v_readlane_b32 s79, v18, s62
    s_cmp_ge_u32 s79, s63
    s_cbranch_scc1 GO_78
    s_waitcnt vmcnt(8)
    s_sub_u32 s7, s60, 8
    s_max_i32 s61, s61, s7
    v_mov_b32 v19, s61
    ds_write_b32 v16, v19
    ds_read_b32 v18, v17
    s_waitcnt lgkmcnt(0)
    v_readlane_b32 s79, v18, s62
    s_cmp_ge_u32 s79, s63
    s_cbranch_scc1 GO_78
    s_waitcnt vmcnt(0)
    s_mov_b32 s61, s60
    v_mov_b32 v19, s61
    ds_write_b32 v16, v19
    ds_read_b32 v18, v17
    s_waitcnt lgkmcnt(0)
    v_readlane_b32 s79, v18, s62
    s_cmp_ge_u32 s79, s63
    s_cbranch_scc1 GO_78
    s_mov_b32 s80, 1600000
SP_220:
    ds_read_b32 v18, v17
    s_waitcnt lgkmcnt(0)
    v_readlane_b32 s79, v18, s62
    s_cmp_ge_u32 s79, s63
    s_cbranch_scc1 GO_78
    s_sub_u32 s80, s80, 1
    s_cmp_lg_u32 s80, 0
    s_cbranch_scc1 SP_220
    s_branch GO_78
ST_82:
    ds_read_b32 v18, v17
    s_waitcnt lgkmcnt(0)
    v_readlane_b32 s79, v18, s62
    s_cmp_ge_u32 s79, s63
    s_cbranch_scc1 GO_81
    s_waitcnt vmcnt(24)
    s_sub_u32 s7, s60, 24
    s_max_i32 s61, s61, s7
    v_mov_b32 v19, s61
    ds_write_b32 v16, v19
    ds_read_b32 v18, v17
    s_waitcnt lgkmcnt(0)
    v_readlane_b32 s79, v18, s62
    s_cmp_ge_u32 s79, s63
    s_cbranch_scc1 GO_81
    s_waitcnt vmcnt(16)
    s_sub_u32 s7, s60, 16
    s_max_i32 s61, s61, s7
    v_mov_b32 v19, s61
    ds_write_b32 v16, v19
    ds_read_b32 v18, v17
    s_waitcnt lgkmcnt(0)
    v_readlane_b32 s79, v18, s62
    s_cmp_ge_u32 s79, s63
    s_cbranch_scc1 GO_81
    s_waitcnt vmcnt(8)
    s_sub_u32 s7, s60, 8
    s_max_i32 s61, s61, s7
    v_mov_b32 v19, s61
    ds_write_b32 v16, v19
    ds_read_b32 v18, v17
    s_waitcnt lgkmcnt(0)
    v_readlane_b32 s79, v18, s62
    s_cmp_ge_u32 s79, s63
    s_cbranch_scc1 GO_81
    s_waitcnt vmcnt(0)
    s_mov_b32 s61, s60
    v_mov_b32 v19, s61
    ds_write_b32 v16, v19
    ds_read_b32 v18, v17
    s_waitcnt lgkmcnt(0)
    v_readlane_b32 s79, v18, s62
    s_cmp_ge_u32 s79, s63
    s_cbranch_scc1 GO_81
    s_mov_b32 s80, 1600000
SP_221:
    ds_read_b32 v18, v17
    s_waitcnt lgkmcnt(0)
    v_readlane_b32 s79, v18, s62
    s_cmp_ge_u32 s79, s63
    s_cbranch_scc1 GO_81
    s_sub_u32 s80, s80, 1
    s_cmp_lg_u32 s80, 0
    s_cbranch_scc1 SP_221
    s_branch GO_81
ST_84:
    ds_read_b32 v18, v17
    s_waitcnt lgkmcnt(0)
    v_readlane_b32 s79, v18, 0
    s_cmp_ge_u32 s79, s63
    s_cbranch_scc1 GO_83
    s_waitcnt vmcnt(24)
    s_sub_u32 s7, s60, 24
    s_max_i32 s61, s61, s7
    v_mov_b32 v19, s61
    ds_write_b32 v16, v19
    ds_read_b32 v18, v17
    s_waitcnt lgkmcnt(0)
    v_readlane_b32 s79, v18, 0
    s_cmp_ge_u32 s79, s63
    s_cbranch_scc1 GO_83
    s_waitcnt vmcnt(16)
    s_sub_u32 s7, s60, 16
    s_max_i32 s61, s61, s7
    v_mov_b32 v19, s61
    ds_write_b32 v16, v19
    ds_read_b32 v18, v17
    s_waitcnt lgkmcnt(0)
    v_readlane_b32 s79, v18, 0
    s_cmp_ge_u32 s79, s63
    s_cbranch_scc1 GO_83
    s_waitcnt vmcnt(8)
    s_sub_u32 s7, s60, 8
    s_max_i32 s61, s61, s7
    v_mov_b32 v19, s61
    ds_write_b32 v16, v19
    ds_read_b32 v18, v17
    s_waitcnt lgkmcnt(0)
    v_readlane_b32 s79, v18, 0
    s_cmp_ge_u32 s79, s63
    s_cbranch_scc1 GO_83
    s_waitcnt vmcnt(0)
    s_mov_b32 s61, s60
    v_mov_b32 v19, s61
    ds_write_b32 v16, v19
    ds_read_b32 v18, v17
    s_waitcnt lgkmcnt(0)
    v_readlane_b32 s79, v18, 0
    s_cmp_ge_u32 s79, s63
    s_cbranch_scc1 GO_83
    s_mov_b32 s80, 1600000
SP_222:
    ds_read_b32 v18, v17
    s_waitcnt lgkmcnt(0)
    v_readlane_b32 s79, v18, 0
    s_cmp_ge_u32 s79, s63
    s_cbranch_scc1 GO_83
    s_sub_u32 s80, s80, 1
    s_cmp_lg_u32 s80, 0
    s_cbranch_scc1 SP_222
    s_branch GO_83
SU_89:
    s_nop 3
    buffer_store_dwordx4 v[40:43], v44, s[36:39], 0 offen sc1
    s_branch SV_90
M_97:
    s_sub_u32 s80, s80, 1
    s_cmp_le_u32 s80, 0
    s_cbranch_scc1 MD_99
    s_mov_b64 exec, s[62:63]
    s_cbranch_execz RS_223
    buffer_load_dwordx4 v[48:51], v36, s[36:39], 0 offen offset:0 sc1
RS_223:
    s_mov_b64 exec, s[64:65]
    s_cbranch_execz RS_224
    buffer_load_dwordx4 v[52:55], v36, s[36:39], 0 offen offset:1024 sc1
RS_224:
    s_branch MC_98
SU_105:
    s_nop 3
    buffer_store_dwordx4 v[64:67], v8, s[36:39], 0 offen sc1
    s_branch SV_106
AW_108:
    s_mov_b64 exec, 0x3f
    s_cmp_eq_u32 s71, 1
    s_cbranch_scc1 AX_225
    buffer_load_dwordx4 v[116:119], v12, s[36:39], 0 offen sc1 nt
    s_mov_b64 exec, -1
    s_branch AWB_109
AX_225:
    s_mov_b32 s80, 200000
    s_branch PP_227
P_226:
    buffer_load_dwordx4 v[116:119], v12, s[36:39], 0 offen sc1 nt
PP_227:
    s_waitcnt vmcnt(0)
    v_cmp_ne_u64 s[90:91], s[92:93], v[118:119]
    s_cmp_lg_u64 s[90:91], 0
    s_cbranch_scc0 PD_228
    s_sleep 2
    s_sub_u32 s80, s80, 1
    s_cmp_lg_u32 s80, 0
    s_cbranch_scc1 P_226
PD_228:
    s_mov_b64 exec, -1
    v_mov_b32 v118, v116
    s_nop 1
    v_max_f32_dpp v118, v118, v118 row_ror:1 row_mask:0xf bank_mask:0xf
    s_nop 1
    v_max_f32_dpp v118, v118, v118 row_ror:2 row_mask:0xf bank_mask:0xf
    s_nop 1
    v_max_f32_dpp v118, v118, v118 row_ror:4 row_mask:0xf bank_mask:0xf
    s_nop 1
    v_max_f32_dpp v118, v118, v118 row_ror:8 row_mask:0xf bank_mask:0xf
    v_sub_f32 v116, v116, v118
    v_sub_f32 v119, v64, v118
    v_exp_f32 v116, v116
    v_exp_f32 v119, v119
    v_mul_f32 v116, v116, v117
    s_nop 1
    v_add_f32_dpp v116, v116, v116 row_ror:1 row_mask:0xf bank_mask:0xf
    s_nop 1
    v_add_f32_dpp v116, v116, v116 row_ror:2 row_mask:0xf bank_mask:0xf
    s_nop 1
    v_add_f32_dpp v116, v116, v116 row_ror:4 row_mask:0xf bank_mask:0xf
    s_nop 1
    v_add_f32_dpp v116, v116, v116 row_ror:8 row_mask:0xf bank_mask:0xf
    v_rcp_f32 v116, v116
    s_nop 0
    v_mul_f32 v116, v116, v119
    s_nop 0
    v_readfirstlane_b32 s72, v116
    s_branch AWB_109
SU_112:
    s_nop 3
    buffer_store_dwordx4 v[68:71], v6, s[36:39], 0 offen sc1
    s_branch SV_113
M_120:
    s_sub_u32 s80, s80, 1
    s_cmp_le_u32 s80, 0
    s_cbranch_scc1 MD_122
    s_mov_b64 exec, s[64:65]
    s_cbranch_execz RS_229
    buffer_load_dwordx4 v[112:115], v5, s[36:39], 0 offen sc1 nt
RS_229:
    s_mov_b64 exec, s[66:67]
    s_cbranch_execz RS_230
    buffer_load_dwordx4 v[116:119], v5, s[36:39], s62 offen sc1 nt
RS_230:
    s_mov_b64 exec, s[68:69]
    s_cbranch_execz RS_231
    buffer_load_dwordx4 v[120:123], v5, s[36:39], s63 offen sc1 nt
RS_231:
    s_branch MC_121
M_135:
    s_sleep 6
    s_sub_u32 s80, s80, 1
    s_cmp_le_u32 s80, 0
    s_cbranch_scc1 MD_137
    s_mov_b64 exec, s[64:65]
    s_cbranch_execz RS_232
    buffer_load_dwordx2 v[12:13], v9, s[36:39], 0 offen sc1 nt
RS_232:
    s_branch MC_136
M_138:
    s_sleep 2
    s_sub_u32 s80, s80, 1
    s_cmp_le_u32 s80, 0
    s_cbranch_scc1 MD_140
    s_mov_b64 exec, s[64:65]
    s_cbranch_execz RS_233
    buffer_load_dwordx2 v[12:13], v9, s[36:39], 0 offen sc1
RS_233:
    s_branch MC_139
M_141:
    s_sub_u32 s80, s80, 1
    s_cmp_le_u32 s80, 0
    s_cbranch_scc1 MD_143
    s_mov_b64 exec, s[64:65]
    s_cbranch_execz RS_234
    buffer_load_dwordx4 v[16:19], v5, s[36:39], 0 offen offset:0 sc1
RS_234:
    s_mov_b64 exec, s[66:67]
    s_cbranch_execz RS_235
    buffer_load_dwordx4 v[20:23], v5, s[36:39], 0 offen offset:1024 sc1
RS_235:
    s_mov_b64 exec, s[68:69]
    s_cbranch_execz RS_236
    buffer_load_dwordx4 v[12:15], v4, s[36:39], 0 offen sc1
RS_236:
    s_branch MC_142
SU_146:
    s_nop 3
    buffer_store_dwordx4 v[16:19], v10, s[36:39], 0 offen sc1
    s_branch SV_147
M_157:
    s_sleep 2
    s_sub_u32 s80, s80, 1
    s_cmp_le_u32 s80, 0
    s_cbranch_scc1 MD_159
    s_mov_b64 exec, s[44:45]
    s_cbranch_execz RS_237
    buffer_load_dwordx2 v[16:17], v100, s[36:39], 0 offen sc1
RS_237:
    s_branch MC_158
M_162:
    s_sleep 1
    s_sub_u32 s80, s80, 1
    s_cmp_le_u32 s80, 0
    s_cbranch_scc1 MD_164
    s_mov_b64 exec, s[44:45]
    s_cbranch_execz RS_238
    buffer_load_dwordx4 v[32:35], v101, s[36:39], 0 offen offset:0 sc1
RS_238:
    s_mov_b64 exec, s[46:47]
    s_cbranch_execz RS_239
    buffer_load_dwordx4 v[36:39], v101, s[36:39], 0 offen offset:1024 sc1
RS_239:
    s_mov_b64 exec, s[48:49]
    s_cbranch_execz RS_240
    buffer_load_dwordx4 v[40:43], v101, s[36:39], 0 offen offset:2048 sc1
RS_240:
    s_mov_b64 exec, s[50:51]
    s_cbranch_execz RS_241
    buffer_load_dwordx4 v[44:47], v101, s[36:39], 0 offen offset:3072 sc1
RS_241:
    s_mov_b64 exec, s[52:53]
    s_cbranch_execz RS_242
    buffer_load_dwordx4 v[48:51], v103, s[36:39], 0 offen offset:0 sc1
RS_242:
    s_mov_b64 exec, s[54:55]
    s_cbranch_execz RS_243
    buffer_load_dwordx4 v[52:55], v103, s[36:39], 0 offen offset:1024 sc1
RS_243:
    s_mov_b64 exec, s[56:57]
    s_cbranch_execz RS_244
    buffer_load_dwordx4 v[56:59], v103, s[36:39], 0 offen offset:2048 sc1
RS_244:
    s_mov_b64 exec, s[58:59]
    s_cbranch_execz RS_245
    buffer_load_dwordx4 v[60:63], v103, s[36:39], 0 offen offset:3072 sc1
RS_245:
    s_branch MC_163
BU_173:
    s_mov_b64 exec, 0xff
    s_mov_b32 s80, 200000
    s_branch PP_247
P_246:
    buffer_load_dwordx2 v[14:15], v0, s[36:39], 0 offen sc1
PP_247:
    s_waitcnt vmcnt(0)
    v_and_b32 v160, 15, v14
    v_and_b32 v14, -32, v14
    v_cmp_ne_u64 s[90:91], s[92:93], v[14:15]
    s_cmp_lg_u64 s[90:91], 0
    s_cbranch_scc0 PD_248
    s_sleep 1
    s_sub_u32 s80, s80, 1
    s_cmp_lg_u32 s80, 0
    s_cbranch_scc1 P_246
PD_248:
    v_cmp_ne_u32 vcc, s78, v160
    s_mov_b64 exec, -1
    s_cmp_eq_u32 vcc_lo, 0
    s_cselect_b32 s101, 1, 0
    s_cbranch_scc0 BUB_174
    s_lshr_b32 s7, s60, 3
    s_lshl_b32 s7, s7, 9
    s_lshl_b32 s63, s6, 6
    s_add_u32 s7, s7, s63
    s_and_b32 s63, s60, 7
    s_lshl_b32 s63, s63, 3
    s_add_u32 s7, s7, s63
    s_add_u32 s7, s7, 0x23004
    v_mov_b32 v0, s7
    v_mov_b32 v15, 0
    s_mov_b64 exec, 1
    buffer_store_dword v15, v0, s[36:39], 0 offen
    buffer_load_dword v15, v0, s[36:39], 0 offen sc1 nt
    s_mov_b64 exec, -1
    s_branch BUB_174
SU_178:
    s_nop 3
    buffer_store_dwordx4 v[16:19], v5, s[36:39], 0 offen offset:0 sc1
    buffer_store_dwordx4 v[20:23], v5, s[36:39], 0 offen offset:1024 sc1
    buffer_store_dwordx4 v[24:27], v5, s[36:39], 0 offen offset:2048 sc1
    buffer_store_dwordx4 v[28:31], v5, s[36:39], 0 offen offset:3072 sc1
    s_waitcnt vmcnt(0)
    s_mov_b64 exec, s[88:89]
    buffer_store_dwordx2 v[38:39], v7, s[36:39], 0 offen sc1
    s_mov_b64 exec, -1
    s_branch SV_179
M_180:
    s_sub_u32 s80, s80, 1
    s_cmp_le_u32 s80, 0
    s_cbranch_scc1 MD_182
    s_mov_b64 exec, s[86:87]
    s_cbranch_execz RS_249
    buffer_load_dwordx2 v[40:41], v7, s[36:39], 0 offen sc1 nt
RS_249:
    s_branch MC_181
BL_183:
    s_mov_b32 s80, 200000
P_250:
    buffer_load_dwordx4 v[64:67], v6, s[36:39], 0 offen offset:0 sc1 nt
    buffer_load_dwordx4 v[68:71], v6, s[36:39], 0 offen offset:1024 sc1 nt
    buffer_load_dwordx4 v[72:75], v6, s[36:39], 0 offen offset:2048 sc1 nt
    buffer_load_dwordx4 v[76:79], v6, s[36:39], 0 offen offset:3072 sc1 nt
PP_251:
    s_waitcnt vmcnt(0)
    v_cmp_ne_u64 s[90:91], s[92:93], v[66:67]
    v_cmp_ne_u64 vcc, s[92:93], v[70:71]
    s_or_b64 s[90:91], s[90:91], vcc
    v_cmp_ne_u64 vcc, s[92:93], v[74:75]
    s_or_b64 s[90:91], s[90:91], vcc
    v_cmp_ne_u64 vcc, s[92:93], v[78:79]
    s_or_b64 s[90:91], s[90:91], vcc
    s_cmp_lg_u64 s[90:91], 0
    s_cbranch_scc0 PD_252
    s_sub_u32 s80, s80, 1
    s_cmp_lg_u32 s80, 0
    s_cbranch_scc1 P_250
PD_252:
    s_branch BLD_184
M_193:
    s_sleep 1
    s_sub_u32 s80, s80, 1
    s_cmp_le_u32 s80, 0
    s_cbranch_scc1 MD_195
    s_mov_b64 exec, s[86:87]
    s_cbranch_execz RS_253
    buffer_load_dwordx4 v[16:19], v4, s[36:39], 0 offen sc1 nt
RS_253:
    s_branch MC_194
L_END:
    s_endpgm
.section .rodata,"a"
.p2align 6
.amdhsa_kernel concat_heads__sliding_block_cached__compressed_kv_cla__decode_kernel
  .amdhsa_next_free_vgpr 168
  .amdhsa_next_free_sgpr 102
  .amdhsa_accum_offset 168
  .amdhsa_group_segment_fixed_size 0
  .amdhsa_kernarg_size 112
  .amdhsa_user_sgpr_count 2
  .amdhsa_user_sgpr_kernarg_segment_ptr 1
  .amdhsa_system_sgpr_workgroup_id_x 1
  .amdhsa_float_denorm_mode_32 3
.end_amdhsa_kernel
```

```asm
; @launch grid=(256,1,1) block=(576,1,1) lds=163840
.amdgcn_target "amdgcn-amd-amdhsa--gfx950"
.text
.globl concat_heads__sliding_block_cached__compressed_kv_cla__decode_kernel
.p2align 8
.type concat_heads__sliding_block_cached__compressed_kv_cla__decode_kernel,@function
concat_heads__sliding_block_cached__compressed_kv_cla__decode_kernel:
    s_cmp_ge_u32 s2, 256
    s_cbranch_scc1 L_END
    s_load_dwordx16 s[8:23], s[0:1], 0
    s_load_dwordx8 s[24:31], s[0:1], 64
    s_load_dwordx4 s[32:35], s[0:1], 96
    s_memrealtime s[94:95]
    v_lshrrev_b32 v1, 6, v0
    s_nop 0
    v_readfirstlane_b32 s3, v1
    v_and_b32 v1, 63, v0
    v_lshrrev_b32 v2, 4, v1
    v_and_b32 v3, 15, v1
    s_and_b32 s4, s2, 7
    s_lshr_b32 s7, s2, 6
    s_lshl_b32 s7, s7, 3
    s_or_b32 s4, s4, s7
    s_bfe_u32 s5, s2, 0x30003
    s_getreg_b32 s78, hwreg(HW_REG_XCC_ID, 0, 4)
    s_lshl_b32 s78, s78, 26
    s_xor_b32 s6, s3, 4
    s_cmp_eq_u32 s3, 8
    s_cselect_b32 s7, 8, 0
    s_add_u32 s7, s7, s5
    s_cmp_ge_u32 s7, 14
    s_cbranch_scc1 L_LDB
    s_cmp_ge_u32 s7, 12
    s_cbranch_scc1 L_LDE
    s_cmp_ge_u32 s7, 8
    s_cbranch_scc1 L_LDA
    s_mov_b32 s81, 0
    s_cmp_lt_u32 s6, 4
    s_cbranch_scc1 L_SIDE
    s_cmp_ge_u32 s7, 4
    s_cbranch_scc1 L_QABS
    s_and_b32 s61, s6, 3
    v_lshrrev_b32 v10, 1, v3
    v_xor_b32 v10, v10, v2
    v_lshlrev_b32 v10, 5, v10
    v_lshl_add_u32 v10, v2, 13, v10
    v_and_b32 v40, 1, v1
    v_lshl_add_u32 v10, v40, 4, v10
    v_xor_b32 v11, 0x80, v10
    s_lshl_b32 s65, s5, 20
    s_lshl_b32 s7, s4, 8
    s_add_u32 s65, s65, s7
    s_lshl_b32 s7, s61, 18
    s_add_u32 s65, s65, s7
    s_lshl_b32 s64, s61, 13
    s_add_u32 s64, s64, 0x1c000
    v_and_b32 v8, 3, v1
    v_lshlrev_b32 v9, 10, v8
    v_lshl_add_u32 v9, v2, 4, v9
    s_lshl_b32 s62, s5, 8
    s_waitcnt lgkmcnt(0)
    s_mov_b32 s48, s22
    s_and_b32 s49, s23, 0xffff
    s_mov_b32 s50, 0x400000
    s_mov_b32 s51, 0x20000
    s_mov_b32 s63, s65
    s_mov_b32 m0, s64
    s_add_u32 s64, s64, 1024
    buffer_load_dwordx4 v10, s[48:51], s63 offen nt lds
    s_add_u32 s63, s63, 32768
    s_mov_b32 m0, s64
    s_add_u32 s64, s64, 1024
    buffer_load_dwordx4 v11, s[48:51], s63 offen nt lds
    s_add_u32 s63, s63, 32768
    s_mov_b32 m0, s64
    s_add_u32 s64, s64, 1024
    buffer_load_dwordx4 v10, s[48:51], s63 offen nt lds
    s_add_u32 s63, s63, 32768
    s_mov_b32 m0, s64
    s_add_u32 s64, s64, 1024
    buffer_load_dwordx4 v11, s[48:51], s63 offen nt lds
    s_add_u32 s63, s63, 32768
    s_mov_b32 m0, s64
    s_add_u32 s64, s64, 1024
    buffer_load_dwordx4 v10, s[48:51], s63 offen nt lds
    s_add_u32 s63, s63, 32768
    s_mov_b32 m0, s64
    s_add_u32 s64, s64, 1024
    buffer_load_dwordx4 v11, s[48:51], s63 offen nt lds
    s_add_u32 s63, s63, 32768
    s_mov_b32 m0, s64
    s_add_u32 s64, s64, 1024
    buffer_load_dwordx4 v10, s[48:51], s63 offen nt lds
    s_add_u32 s63, s63, 32768
    s_mov_b32 m0, s64
    s_add_u32 s64, s64, 1024
    buffer_load_dwordx4 v11, s[48:51], s63 offen nt lds
    s_add_u32 s63, s63, 32768
    s_mov_b32 s44, s18
    s_and_b32 s45, s19, 0xffff
    s_mov_b32 s46, 0x1000
    s_mov_b32 s47, 0x20000
    buffer_load_dwordx4 v[128:131], v9, s[44:47], s62 offen offset:0
    buffer_load_dwordx4 v[132:135], v9, s[44:47], s62 offen offset:64
    buffer_load_dwordx4 v[136:139], v9, s[44:47], s62 offen offset:128
    buffer_load_dwordx4 v[140:143], v9, s[44:47], s62 offen offset:192
    s_barrier
    s_mov_b32 s36, s34
    s_and_b32 s37, s35, 0xffff
    s_mov_b32 s38, 0x1000000
    s_mov_b32 s39, 0x20000
    s_lshl_b32 s7, s4, 4
    s_add_u32 s7, s7, s5
    s_lshl_b32 s7, s7, 4
    s_add_u32 s7, s7, s61
    s_lshl_b32 s7, s7, 7
    s_add_u32 s7, s7, 0x100000
    v_lshl_add_u32 v4, v8, 9, s7
    v_lshl_add_u32 v4, v2, 4, v4
    v_and_b32 v12, 4, v1
    v_lshl_add_u32 v4, v12, 4, v4
    v_add_u32 v5, 16384, v4
    v_mov_b32 v16, 0
    s_mov_b64 exec, 15
    buffer_store_dword v16, v5, s[36:39], 0 offen
    buffer_load_dword v16, v5, s[36:39], 0 offen sc1 nt
    s_mov_b64 exec, -1
    s_sub_u32 s64, s64, 40960
    s_mov_b32 s48, s14
    s_and_b32 s49, s15, 0xffff
    s_mov_b32 s50, 0x400000
    s_mov_b32 s51, 0x20000
    s_mov_b32 s63, s65
    s_mov_b32 m0, s64
    s_add_u32 s64, s64, 1024
    buffer_load_dwordx4 v10, s[48:51], s63 offen nt lds
    s_add_u32 s63, s63, 32768
    s_mov_b32 m0, s64
    s_add_u32 s64, s64, 1024
    buffer_load_dwordx4 v11, s[48:51], s63 offen nt lds
    s_add_u32 s63, s63, 32768
    s_mov_b32 m0, s64
    s_add_u32 s64, s64, 1024
    buffer_load_dwordx4 v10, s[48:51], s63 offen nt lds
    s_add_u32 s63, s63, 32768
    s_mov_b32 m0, s64
    s_add_u32 s64, s64, 1024
    buffer_load_dwordx4 v11, s[48:51], s63 offen nt lds
    s_add_u32 s63, s63, 32768
    s_mov_b32 m0, s64
    s_add_u32 s64, s64, 1024
    buffer_load_dwordx4 v10, s[48:51], s63 offen nt lds
    s_add_u32 s63, s63, 32768
    s_mov_b32 m0, s64
    s_add_u32 s64, s64, 1024
    buffer_load_dwordx4 v11, s[48:51], s63 offen nt lds
    s_add_u32 s63, s63, 32768
    s_mov_b32 m0, s64
    s_add_u32 s64, s64, 1024
    buffer_load_dwordx4 v10, s[48:51], s63 offen nt lds
    s_add_u32 s63, s63, 32768
    s_mov_b32 m0, s64
    s_add_u32 s64, s64, 1024
    buffer_load_dwordx4 v11, s[48:51], s63 offen nt lds
    s_add_u32 s63, s63, 32768
    s_mov_b32 s44, s8
    s_and_b32 s45, s9, 0xffff
    s_mov_b32 s46, 0x1000
    s_mov_b32 s47, 0x20000
    buffer_load_dwordx4 v[144:147], v9, s[44:47], s62 offen offset:0
    buffer_load_dwordx4 v[148:151], v9, s[44:47], s62 offen offset:64
    buffer_load_dwordx4 v[152:155], v9, s[44:47], s62 offen offset:128
    buffer_load_dwordx4 v[156:159], v9, s[44:47], s62 offen offset:192
    v_cmp_gt_u32 s[84:85], 8, v3
    v_bfe_u32 v21, v1, 2, 2
    v_lshl_add_u32 v20, v2, 3, v21
    s_lshl_b32 s7, s61, 1
    v_xor_b32 v21, s7, v21
    v_lshlrev_b32 v20, 8, v20
    v_lshl_add_u32 v20, v21, 5, v20
    v_lshl_add_u32 v20, v8, 3, v20
    v_add_u32 v20, 0x14000, v20
    v_xor_b32 v21, 32, v20
    v_xor_b32 v22, 0x480, v20
    v_xor_b32 v23, 0x4a0, v20
    s_waitcnt vmcnt(14)
    v_mov_b32 v14, 0x24210
    v_mov_b32 v15, 1
    s_mov_b64 exec, 1
    ds_add_u32 v14, v15
    s_mov_b64 exec, -1
    v_mov_b32 v14, 0x24210
    s_mov_b32 s80, 1600000
LW_1:
    ds_read_b32 v15, v14
    s_waitcnt lgkmcnt(0)
    v_readfirstlane_b32 s79, v15
    s_cmp_ge_u32 s79, 4
    s_cbranch_scc1 LWD_2
    s_sub_u32 s80, s80, 1
    s_cmp_lg_u32 s80, 0
    s_cbranch_scc1 LW_1
LWD_2:
    ds_read_b64_tr_b16 v[32:33], v20 offset:32768
    ds_read_b64_tr_b16 v[34:35], v22 offset:32768
    ds_read_b64_tr_b16 v[36:37], v21 offset:32768
    ds_read_b64_tr_b16 v[38:39], v23 offset:32768
    ds_read_b64_tr_b16 v[40:41], v20 offset:40960
    ds_read_b64_tr_b16 v[42:43], v22 offset:40960
    ds_read_b64_tr_b16 v[44:45], v21 offset:40960
    ds_read_b64_tr_b16 v[46:47], v23 offset:40960
    ds_read_b64_tr_b16 v[48:49], v20 offset:49152
    ds_read_b64_tr_b16 v[50:51], v22 offset:49152
    ds_read_b64_tr_b16 v[52:53], v21 offset:49152
    ds_read_b64_tr_b16 v[54:55], v23 offset:49152
    s_waitcnt lgkmcnt(8)
    ds_read_b64_tr_b16 v[56:57], v20 offset:57344
    ds_read_b64_tr_b16 v[58:59], v22 offset:57344
    ds_read_b64_tr_b16 v[60:61], v21 offset:57344
    ds_read_b64_tr_b16 v[62:63], v23 offset:57344
    s_waitcnt lgkmcnt(12)
    v_mfma_f32_16x16x32_bf16 v[24:27], v[32:35], v[128:131], 0
    v_mfma_f32_16x16x32_bf16 v[28:31], v[36:39], v[128:131], 0
    s_waitcnt lgkmcnt(8)
    v_mfma_f32_16x16x32_bf16 v[24:27], v[40:43], v[132:135], v[24:27]
    v_mfma_f32_16x16x32_bf16 v[28:31], v[44:47], v[132:135], v[28:31]
    s_waitcnt lgkmcnt(4)
    v_mfma_f32_16x16x32_bf16 v[24:27], v[48:51], v[136:139], v[24:27]
    v_mfma_f32_16x16x32_bf16 v[28:31], v[52:55], v[136:139], v[28:31]
    s_waitcnt lgkmcnt(0)
    v_mfma_f32_16x16x32_bf16 v[24:27], v[56:59], v[140:143], v[24:27]
    v_mfma_f32_16x16x32_bf16 v[28:31], v[60:63], v[140:143], v[28:31]
    s_memrealtime s[88:89]
    v_lshlrev_b32 v14, 2, v1
    v_add_u32 v14, 0x24138, v14
    v_mov_b32 v15, 1
    s_mov_b64 exec, 15
    ds_add_u32 v14, v15
    s_mov_b64 exec, -1
    v_cvt_pk_bf16_f32 v64, v24, v25
    v_cvt_pk_bf16_f32 v65, v26, v27
    v_cvt_pk_bf16_f32 v68, v28, v29
    v_cvt_pk_bf16_f32 v69, v30, v31
    s_nop 0
    v_mov_b32_dpp v64, v68 quad_perm:[0,1,2,3] row_mask:0xf bank_mask:0x2
    v_mov_b32_dpp v65, v69 quad_perm:[0,1,2,3] row_mask:0xf bank_mask:0x2
    s_waitcnt lgkmcnt(0)
    s_or_b32 s89, s89, s78
    v_mov_b32 v66, s88
    v_mov_b32 v67, s89
    s_mov_b64 exec, s[84:85]
    buffer_store_dwordx4 v[64:67], v5, s[36:39], 0 offen
    s_mov_b64 exec, -1
    v_mov_b32 v14, 0x24210
    v_mov_b32 v15, 1
    s_mov_b64 exec, 1
    ds_add_u32 v14, v15
    s_mov_b64 exec, -1
    s_waitcnt vmcnt(0)
    v_mov_b32 v14, 0x24210
    v_mov_b32 v15, 1
    s_mov_b64 exec, 1
    ds_add_u32 v14, v15
    s_mov_b64 exec, -1
    v_mov_b32 v14, 0x24210
    s_mov_b32 s80, 1600000
LW_3:
    ds_read_b32 v15, v14
    s_waitcnt lgkmcnt(0)
    v_readfirstlane_b32 s79, v15
    s_cmp_ge_u32 s79, 12
    s_cbranch_scc1 LWD_4
    s_sub_u32 s80, s80, 1
    s_cmp_lg_u32 s80, 0
    s_cbranch_scc1 LW_3
LWD_4:
    ds_read_b64_tr_b16 v[32:33], v20 offset:0
    ds_read_b64_tr_b16 v[34:35], v22 offset:0
    ds_read_b64_tr_b16 v[36:37], v21 offset:0
    ds_read_b64_tr_b16 v[38:39], v23 offset:0
    ds_read_b64_tr_b16 v[40:41], v20 offset:8192
    ds_read_b64_tr_b16 v[42:43], v22 offset:8192
    ds_read_b64_tr_b16 v[44:45], v21 offset:8192
    ds_read_b64_tr_b16 v[46:47], v23 offset:8192
    ds_read_b64_tr_b16 v[48:49], v20 offset:16384
    ds_read_b64_tr_b16 v[50:51], v22 offset:16384
    ds_read_b64_tr_b16 v[52:53], v21 offset:16384
    ds_read_b64_tr_b16 v[54:55], v23 offset:16384
    s_waitcnt lgkmcnt(8)
    ds_read_b64_tr_b16 v[56:57], v20 offset:24576
    ds_read_b64_tr_b16 v[58:59], v22 offset:24576
    ds_read_b64_tr_b16 v[60:61], v21 offset:24576
    ds_read_b64_tr_b16 v[62:63], v23 offset:24576
    s_waitcnt lgkmcnt(12)
    v_mfma_f32_16x16x32_bf16 v[24:27], v[32:35], v[144:147], 0
    v_mfma_f32_16x16x32_bf16 v[28:31], v[36:39], v[144:147], 0
    s_waitcnt lgkmcnt(8)
    v_mfma_f32_16x16x32_bf16 v[24:27], v[40:43], v[148:151], v[24:27]
    v_mfma_f32_16x16x32_bf16 v[28:31], v[44:47], v[148:151], v[28:31]
    s_waitcnt lgkmcnt(4)
    v_mfma_f32_16x16x32_bf16 v[24:27], v[48:51], v[152:155], v[24:27]
    v_mfma_f32_16x16x32_bf16 v[28:31], v[52:55], v[152:155], v[28:31]
    s_waitcnt lgkmcnt(0)
    v_mfma_f32_16x16x32_bf16 v[24:27], v[56:59], v[156:159], v[24:27]
    v_mfma_f32_16x16x32_bf16 v[28:31], v[60:63], v[156:159], v[28:31]
    v_lshlrev_b32 v14, 2, v1
    v_add_u32 v14, 0x24128, v14
    v_mov_b32 v15, 1
    s_mov_b64 exec, 15
    ds_add_u32 v14, v15
    s_mov_b64 exec, -1
    s_nop 0
    v_cvt_pk_bf16_f32 v72, v24, v25
    v_cvt_pk_bf16_f32 v73, v26, v27
    v_cvt_pk_bf16_f32 v76, v28, v29
    v_cvt_pk_bf16_f32 v77, v30, v31
    s_nop 0
    v_mov_b32_dpp v72, v76 quad_perm:[0,1,2,3] row_mask:0xf bank_mask:0x2
    v_mov_b32_dpp v73, v77 quad_perm:[0,1,2,3] row_mask:0xf bank_mask:0x2
    v_mov_b32 v10, 0x24200
    s_mov_b32 s80, 1600000
LW_5:
    ds_read_b32 v11, v10
    s_waitcnt lgkmcnt(0)
    v_readfirstlane_b32 s79, v11
    s_cmp_ge_u32 s79, 16
    s_cbranch_scc1 LWD_6
    s_sleep 1
    s_sub_u32 s80, s80, 1
    s_cmp_lg_u32 s80, 0
    s_cbranch_scc1 LW_5
LWD_6:
    s_and_b32 s101, s79, 15
    v_mov_b32 v12, 0x24204
    s_mov_b32 s80, 1600000
LW_7:
    ds_read_b32 v13, v12
    s_waitcnt lgkmcnt(0)
    v_readfirstlane_b32 s79, v13
    s_cmp_ge_u32 s79, 1
    s_cbranch_scc1 LWD_8
    s_sleep 1
    s_sub_u32 s80, s80, 1
    s_cmp_lg_u32 s80, 0
    s_cbranch_scc1 LW_7
LWD_8:
    v_mov_b32 v12, 0x24248
    ds_read_b64 v[14:15], v12
    s_waitcnt lgkmcnt(0)
    v_readfirstlane_b32 s92, v14
    v_readfirstlane_b32 s93, v15
    s_nop 0
    v_mov_b32 v66, s92
    v_mov_b32 v67, s93
    v_mov_b32 v74, s92
    v_mov_b32 v75, s93
    s_mov_b64 exec, s[84:85]
    s_cmp_eq_u32 s101, 0
    s_cbranch_scc1 SU_9
    buffer_store_dwordx4 v[72:75], v4, s[36:39], 0 offen
    buffer_store_dwordx4 v[64:67], v5, s[36:39], 0 offen
SV_10:
    s_mov_b64 exec, -1
    s_branch L_ASVC
L_LDA:
    s_setprio 3
    v_lshrrev_b32 v20, 1, v3
    v_and_b32 v40, 1, v2
    v_xor_b32 v20, v20, v40
    v_lshlrev_b32 v20, 5, v20
    v_lshl_add_u32 v20, v2, 10, v20
    v_and_b32 v40, 1, v1
    v_lshl_add_u32 v20, v40, 4, v20
    v_xor_b32 v21, 0x40, v20
    v_xor_b32 v22, 0x80, v20
    v_xor_b32 v23, 0xc0, v20
    s_lshl_b32 s65, s4, 17
    s_lshl_b32 s7, s5, 8
    s_add_u32 s65, s65, s7
    s_mov_b32 s64, 0
    s_mov_b32 s96, 0x6010600
    s_mov_b32 s97, 0x5030602
    s_cmp_eq_u32 s5, 1
    s_cselect_b32 s96, 0x6190618, s96
    s_cselect_b32 s97, 0x51a0617, s97
    s_cmp_eq_u32 s5, 2
    s_cselect_b32 s96, 0x62e0630, s96
    s_cselect_b32 s97, 0x531062f, s97
    s_cmp_eq_u32 s5, 3
    s_cselect_b32 s96, 0x6460645, s96
    s_cselect_b32 s97, 0x5480647, s97
    s_cmp_eq_u32 s5, 4
    s_cselect_b32 s96, 0x55d055c, s96
    s_cselect_b32 s97, 0x45f045e, s97
    s_cmp_eq_u32 s5, 5
    s_cselect_b32 s96, 0x56f056e, s96
    s_cselect_b32 s97, 0x4710470, s97
    v_xor_b32 v10, v3, v2
    v_lshlrev_b32 v10, 4, v10
    v_lshl_add_u32 v10, v2, 8, v10
    v_xor_b32 v11, 0x40, v10
    v_xor_b32 v12, 0x80, v10
    v_xor_b32 v13, 0xc0, v10
    v_lshrrev_b32 v14, 1, v3
    v_xor_b32 v14, v14, v2
    v_lshlrev_b32 v14, 5, v14
    v_lshl_add_u32 v14, v2, 8, v14
    v_and_b32 v40, 1, v1
    v_lshl_add_u32 v14, v40, 4, v14
    v_xor_b32 v15, 0x80, v14
    s_mov_b32 s76, 0
    s_lshl_b32 s7, s76, 4
    s_lshr_b64 s[90:91], s[96:97], s7
    s_and_b32 s68, s90, 3
    s_bfe_u32 s72, s90, 0x50002
    s_lshl_b32 s68, s68, 5
    s_add_u32 s68, s68, s4
    s_lshl_b32 s68, s68, 20
    s_lshl_b32 s72, s72, 13
    s_add_u32 s72, s72, s68
    s_add_u32 s72, s72, 0xC0000
    s_mov_b32 s76, 1
    s_lshl_b32 s7, s76, 4
    s_lshr_b64 s[90:91], s[96:97], s7
    s_and_b32 s69, s90, 3
    s_bfe_u32 s73, s90, 0x50002
    s_lshl_b32 s69, s69, 5
    s_add_u32 s69, s69, s4
    s_lshl_b32 s69, s69, 20
    s_lshl_b32 s73, s73, 13
    s_add_u32 s73, s73, s69
    s_add_u32 s73, s73, 0xC0000
    s_mov_b32 s76, 2
    s_lshl_b32 s7, s76, 4
    s_lshr_b64 s[90:91], s[96:97], s7
    s_and_b32 s70, s90, 3
    s_bfe_u32 s74, s90, 0x50002
    s_lshl_b32 s70, s70, 5
    s_add_u32 s70, s70, s4
    s_lshl_b32 s70, s70, 20
    s_lshl_b32 s74, s74, 13
    s_add_u32 s74, s74, s70
    s_add_u32 s74, s74, 0xC0000
    s_mov_b32 s76, 3
    s_lshl_b32 s7, s76, 4
    s_lshr_b64 s[90:91], s[96:97], s7
    s_and_b32 s71, s90, 3
    s_bfe_u32 s75, s90, 0x50002
    s_lshl_b32 s71, s71, 5
    s_add_u32 s71, s71, s4
    s_lshl_b32 s71, s71, 20
    s_lshl_b32 s75, s75, 13
    s_add_u32 s75, s75, s71
    s_add_u32 s75, s75, 0xC0000
    s_waitcnt lgkmcnt(0)
    s_mov_b32 s56, s16
    s_and_b32 s57, s17, 0xffff
    s_mov_b32 s58, 0x400000
    s_mov_b32 s59, 0x20000
    s_barrier
    s_mov_b32 s61, 0
    s_mov_b32 s63, 0
    v_lshlrev_b32 v16, 2, v1
    v_add_u32 v17, 0x24100, v16
    v_add_u32 v16, 0x24000, v16
    v_mov_b32 v18, 0
    s_mov_b32 s60, 0
    s_mov_b32 s36, s34
    s_and_b32 s37, s35, 0xffff
    s_mov_b32 s38, 0x1000000
    s_mov_b32 s39, 0x20000
    v_mov_b32 v40, 0x24210
    s_mov_b32 s80, 1600000
LW_11:
    ds_read_b32 v41, v40
    s_waitcnt lgkmcnt(0)
    v_readfirstlane_b32 s79, v41
    s_cmp_ge_u32 s79, 4
    s_cbranch_scc1 LWD_12
    s_sub_u32 s80, s80, 1
    s_cmp_lg_u32 s80, 0
    s_cbranch_scc1 LW_11
LWD_12:
    s_mov_b32 s66, 2
LL_13:
    s_waitcnt vmcnt(23)
    s_mov_b32 m0, s64
    s_add_u32 s64, s64, 1024
    buffer_load_dwordx4 v20, s[56:59], s65 offen nt lds
    s_add_u32 s65, s65, 4096
    s_waitcnt vmcnt(23)
    s_mov_b32 m0, s64
    s_add_u32 s64, s64, 1024
    buffer_load_dwordx4 v20, s[56:59], s65 offen nt lds
    s_add_u32 s65, s65, 4096
    s_waitcnt vmcnt(23)
    s_mov_b32 m0, s64
    s_add_u32 s64, s64, 1024
    buffer_load_dwordx4 v20, s[56:59], s65 offen nt lds
    s_add_u32 s65, s65, 4096
    s_waitcnt vmcnt(23)
    s_mov_b32 m0, s64
    s_add_u32 s64, s64, 1024
    buffer_load_dwordx4 v20, s[56:59], s65 offen nt lds
    s_add_u32 s65, s65, 4096
    s_waitcnt vmcnt(23)
    s_mov_b32 m0, s64
    s_add_u32 s64, s64, 1024
    buffer_load_dwordx4 v21, s[56:59], s65 offen nt lds
    s_add_u32 s65, s65, 4096
    s_waitcnt vmcnt(23)
    s_mov_b32 m0, s64
    s_add_u32 s64, s64, 1024
    buffer_load_dwordx4 v21, s[56:59], s65 offen nt lds
    s_add_u32 s65, s65, 4096
    s_waitcnt vmcnt(23)
    s_mov_b32 m0, s64
    s_add_u32 s64, s64, 1024
    buffer_load_dwordx4 v21, s[56:59], s65 offen nt lds
    s_add_u32 s65, s65, 4096
    s_waitcnt vmcnt(23)
    s_sub_u32 s7, s60, 16
    s_max_i32 s61, s61, s7
    v_mov_b32 v19, s61
    ds_write_b32 v16, v19
    s_mov_b32 m0, s64
    s_add_u32 s64, s64, 1024
    buffer_load_dwordx4 v21, s[56:59], s65 offen nt lds
    s_add_u32 s65, s65, 4096
    s_waitcnt vmcnt(23)
    s_mov_b32 m0, s64
    s_add_u32 s64, s64, 1024
    buffer_load_dwordx4 v22, s[56:59], s65 offen nt lds
    s_add_u32 s65, s65, 4096
    s_waitcnt vmcnt(23)
    s_mov_b32 m0, s64
    s_add_u32 s64, s64, 1024
    buffer_load_dwordx4 v22, s[56:59], s65 offen nt lds
    s_add_u32 s65, s65, 4096
    s_waitcnt vmcnt(23)
    s_mov_b32 m0, s64
    s_add_u32 s64, s64, 1024
    buffer_load_dwordx4 v22, s[56:59], s65 offen nt lds
    s_add_u32 s65, s65, 4096
    s_waitcnt vmcnt(23)
    s_mov_b32 m0, s64
    s_add_u32 s64, s64, 1024
    buffer_load_dwordx4 v22, s[56:59], s65 offen nt lds
    s_add_u32 s65, s65, 4096
    s_waitcnt vmcnt(23)
    s_mov_b32 m0, s64
    s_add_u32 s64, s64, 1024
    buffer_load_dwordx4 v23, s[56:59], s65 offen nt lds
    s_add_u32 s65, s65, 4096
    s_waitcnt vmcnt(23)
    s_mov_b32 m0, s64
    s_add_u32 s64, s64, 1024
    buffer_load_dwordx4 v23, s[56:59], s65 offen nt lds
    s_add_u32 s65, s65, 4096
    s_waitcnt vmcnt(23)
    s_mov_b32 m0, s64
    s_add_u32 s64, s64, 1024
    buffer_load_dwordx4 v23, s[56:59], s65 offen nt lds
    s_add_u32 s65, s65, 4096
    s_waitcnt vmcnt(23)
    s_sub_u32 s7, s60, 8
    s_max_i32 s61, s61, s7
    v_mov_b32 v19, s61
    ds_write_b32 v16, v19
    s_mov_b32 m0, s64
    s_add_u32 s64, s64, 1024
    buffer_load_dwordx4 v23, s[56:59], s65 offen nt lds
    s_add_u32 s65, s65, 4096
    s_add_u32 s60, s60, 16
    s_sub_u32 s66, s66, 1
    s_cmp_lg_u32 s66, 0
    s_cbranch_scc1 LL_13
    s_mov_b32 s62, 4
    s_mov_b32 s44, s10
    s_and_b32 s45, s11, 0xffff
    s_mov_b32 s46, 0x8000000
    s_mov_b32 s47, 0x20000
    s_mov_b32 s48, s12
    s_and_b32 s49, s13, 0xffff
    s_mov_b32 s50, 0x8000000
    s_mov_b32 s51, 0x20000
    s_mov_b32 s68, s72
    s_mov_b32 s69, s73
    s_mov_b32 s70, s74
    s_mov_b32 s71, s75
    s_mov_b32 s66, 2
LL_14:
    s_waitcnt lgkmcnt(0)
    v_readlane_b32 s79, v18, s62
    s_cmp_lt_u32 s79, s63
    s_cbranch_scc1 ST_16
GO_15:
    s_waitcnt vmcnt(23)
    s_add_u32 s7, s64, 0
    s_mov_b32 m0, s7
    s_add_u32 s65, s68, 0
    buffer_load_dwordx4 v10, s[44:47], s65 offen offset:0 nt lds
    s_waitcnt vmcnt(23)
    buffer_load_dwordx4 v11, s[44:47], s65 offen offset:1024 nt lds
    s_waitcnt vmcnt(23)
    buffer_load_dwordx4 v12, s[44:47], s65 offen offset:2048 nt lds
    s_waitcnt vmcnt(23)
    buffer_load_dwordx4 v13, s[44:47], s65 offen offset:3072 nt lds
    s_waitcnt vmcnt(23)
    s_add_u32 s7, s64, 4096
    s_mov_b32 m0, s7
    s_add_u32 s65, s68, 4096
    buffer_load_dwordx4 v10, s[44:47], s65 offen offset:0 nt lds
    s_waitcnt vmcnt(23)
    buffer_load_dwordx4 v11, s[44:47], s65 offen offset:1024 nt lds
    ds_read_b32 v18, v17
    s_waitcnt vmcnt(23)
    buffer_load_dwordx4 v12, s[44:47], s65 offen offset:2048 nt lds
    s_waitcnt vmcnt(23)
    s_sub_u32 s7, s60, 16
    s_max_i32 s61, s61, s7
    v_mov_b32 v19, s61
    ds_write_b32 v16, v19
    buffer_load_dwordx4 v13, s[44:47], s65 offen offset:3072 nt lds
    s_add_u32 s60, s60, 8
    s_add_u32 s65, s65, 4096
    s_mov_b32 s68, s69
    s_mov_b32 s69, s70
    s_mov_b32 s70, s71
    s_mov_b32 s71, s65
    s_add_u32 s62, s62, 1
    s_add_u32 s64, s64, 8192
    s_cmp_eq_u32 s62, 10
    s_cselect_b32 s7, 4, 0
    s_add_u32 s63, s63, s7
    s_cmp_eq_u32 s62, 18
    s_cselect_b32 s62, 0, s62
    s_cselect_b32 s64, 0, s64
    s_sub_u32 s66, s66, 1
    s_cmp_lg_u32 s66, 0
    s_cbranch_scc1 LL_14
    s_mov_b32 s66, 21
LL_17:
    s_waitcnt lgkmcnt(0)
    v_readlane_b32 s79, v18, s62
    s_cmp_lt_u32 s79, s63
    s_cbranch_scc1 ST_19
GO_18:
    s_waitcnt vmcnt(23)
    s_add_u32 s7, s64, 0
    s_mov_b32 m0, s7
    s_add_u32 s65, s68, 0
    buffer_load_dwordx4 v10, s[44:47], s65 offen offset:0 nt lds
    s_waitcnt vmcnt(23)
    buffer_load_dwordx4 v11, s[44:47], s65 offen offset:1024 nt lds
    s_waitcnt vmcnt(23)
    buffer_load_dwordx4 v12, s[44:47], s65 offen offset:2048 nt lds
    s_waitcnt vmcnt(23)
    buffer_load_dwordx4 v13, s[44:47], s65 offen offset:3072 nt lds
    s_waitcnt vmcnt(23)
    s_add_u32 s7, s64, 4096
    s_mov_b32 m0, s7
    s_add_u32 s65, s68, 4096
    buffer_load_dwordx4 v10, s[44:47], s65 offen offset:0 nt lds
    s_waitcnt vmcnt(23)
    buffer_load_dwordx4 v11, s[44:47], s65 offen offset:1024 nt lds
    ds_read_b32 v18, v17
    s_waitcnt vmcnt(23)
    buffer_load_dwordx4 v12, s[44:47], s65 offen offset:2048 nt lds
    s_waitcnt vmcnt(23)
    s_sub_u32 s7, s60, 16
    s_max_i32 s61, s61, s7
    v_mov_b32 v19, s61
    ds_write_b32 v16, v19
    buffer_load_dwordx4 v13, s[44:47], s65 offen offset:3072 nt lds
    s_add_u32 s60, s60, 8
    s_add_u32 s65, s65, 4096
    s_mov_b32 s68, s69
    s_mov_b32 s69, s70
    s_mov_b32 s70, s71
    s_mov_b32 s71, s65
    s_add_u32 s62, s62, 1
    s_add_u32 s64, s64, 8192
    s_cmp_eq_u32 s62, 10
    s_cselect_b32 s7, 4, 0
    s_add_u32 s63, s63, s7
    s_cmp_eq_u32 s62, 18
    s_cselect_b32 s62, 0, s62
    s_cselect_b32 s64, 0, s64
    s_sub_u32 s66, s66, 1
    s_cmp_lg_u32 s66, 0
    s_cbranch_scc1 LL_17
    s_mov_b32 s68, s72
    s_mov_b32 s69, s73
    s_mov_b32 s70, s74
    s_mov_b32 s71, s75
    s_mov_b32 s66, 4
LL_20:
    s_waitcnt lgkmcnt(0)
    v_readlane_b32 s79, v18, s62
    s_cmp_lt_u32 s79, s63
    s_cbranch_scc1 ST_22
GO_21:
    s_waitcnt vmcnt(23)
    s_add_u32 s7, s64, 0
    s_mov_b32 m0, s7
    s_add_u32 s65, s68, 0
    buffer_load_dwordx4 v14, s[48:51], s65 offen offset:0 nt lds
    s_waitcnt vmcnt(23)
    buffer_load_dwordx4 v15, s[48:51], s65 offen offset:1024 nt lds
    s_waitcnt vmcnt(23)
    buffer_load_dwordx4 v14, s[48:51], s65 offen offset:2048 nt lds
    s_waitcnt vmcnt(23)
    buffer_load_dwordx4 v15, s[48:51], s65 offen offset:3072 nt lds
    s_waitcnt vmcnt(23)
    s_add_u32 s7, s64, 4096
    s_mov_b32 m0, s7
    s_add_u32 s65, s68, 4096
    buffer_load_dwordx4 v14, s[48:51], s65 offen offset:0 nt lds
    s_waitcnt vmcnt(23)
    buffer_load_dwordx4 v15, s[48:51], s65 offen offset:1024 nt lds
    ds_read_b32 v18, v17
    s_waitcnt vmcnt(23)
    buffer_load_dwordx4 v14, s[48:51], s65 offen offset:2048 nt lds
    s_waitcnt vmcnt(23)
    s_sub_u32 s7, s60, 16
    s_max_i32 s61, s61, s7
    v_mov_b32 v19, s61
    ds_write_b32 v16, v19
    buffer_load_dwordx4 v15, s[48:51], s65 offen offset:3072 nt lds
    s_add_u32 s60, s60, 8
    s_add_u32 s65, s65, 4096
    s_mov_b32 s68, s69
    s_mov_b32 s69, s70
    s_mov_b32 s70, s71
    s_mov_b32 s71, s65
    s_add_u32 s62, s62, 1
    s_add_u32 s64, s64, 8192
    s_cmp_eq_u32 s62, 10
    s_cselect_b32 s7, 4, 0
    s_add_u32 s63, s63, s7
    s_cmp_eq_u32 s62, 18
    s_cselect_b32 s62, 0, s62
    s_cselect_b32 s64, 0, s64
    s_sub_u32 s66, s66, 1
    s_cmp_lg_u32 s66, 0
    s_cbranch_scc1 LL_20
    s_mov_b32 s66, 14
LL_23:
    s_waitcnt lgkmcnt(0)
    v_readlane_b32 s79, v18, s62
    s_cmp_lt_u32 s79, s63
    s_cbranch_scc1 ST_25
GO_24:
    s_waitcnt vmcnt(25)
    s_add_u32 s7, s64, 0
    s_mov_b32 m0, s7
    s_add_u32 s65, s68, 0
    buffer_load_dwordx4 v14, s[48:51], s65 offen offset:0 nt lds
    s_waitcnt vmcnt(25)
    s_sub_u32 s7, s60, 24
    s_max_i32 s61, s61, s7
    v_mov_b32 v19, s61
    ds_write_b32 v16, v19
    buffer_load_dwordx4 v15, s[48:51], s65 offen offset:1024 nt lds
    s_waitcnt vmcnt(25)
    buffer_load_dwordx4 v14, s[48:51], s65 offen offset:2048 nt lds
    s_waitcnt vmcnt(25)
    buffer_load_dwordx4 v15, s[48:51], s65 offen offset:3072 nt lds
    s_waitcnt vmcnt(25)
    s_add_u32 s7, s64, 4096
    s_mov_b32 m0, s7
    s_add_u32 s65, s68, 4096
    buffer_load_dwordx4 v14, s[48:51], s65 offen offset:0 nt lds
    s_waitcnt vmcnt(25)
    buffer_load_dwordx4 v15, s[48:51], s65 offen offset:1024 nt lds
    ds_read_b32 v18, v17
    s_waitcnt vmcnt(25)
    buffer_load_dwordx4 v14, s[48:51], s65 offen offset:2048 nt lds
    s_waitcnt vmcnt(25)
    buffer_load_dwordx4 v15, s[48:51], s65 offen offset:3072 nt lds
    s_add_u32 s60, s60, 8
    s_add_u32 s65, s65, 4096
    s_mov_b32 s68, s69
    s_mov_b32 s69, s70
    s_mov_b32 s70, s71
    s_mov_b32 s71, s65
    s_add_u32 s62, s62, 1
    s_add_u32 s64, s64, 8192
    s_cmp_eq_u32 s62, 10
    s_cselect_b32 s7, 4, 0
    s_add_u32 s63, s63, s7
    s_cmp_eq_u32 s62, 18
    s_cselect_b32 s62, 0, s62
    s_cselect_b32 s64, 0, s64
    s_sub_u32 s66, s66, 1
    s_cmp_lg_u32 s66, 0
    s_cbranch_scc1 LL_23
    s_mov_b32 s66, 5
LL_26:
    s_waitcnt lgkmcnt(0)
    v_readlane_b32 s79, v18, s62
    s_cmp_lt_u32 s79, s63
    s_cbranch_scc1 ST_28
GO_27:
    s_waitcnt vmcnt(39)
    s_add_u32 s7, s64, 0
    s_mov_b32 m0, s7
    s_add_u32 s65, s68, 0
    buffer_load_dwordx4 v14, s[48:51], s65 offen offset:0 nt lds
    s_waitcnt vmcnt(39)
    buffer_load_dwordx4 v15, s[48:51], s65 offen offset:1024 nt lds
    s_waitcnt vmcnt(39)
    buffer_load_dwordx4 v14, s[48:51], s65 offen offset:2048 nt lds
    s_waitcnt vmcnt(39)
    buffer_load_dwordx4 v15, s[48:51], s65 offen offset:3072 nt lds
    s_waitcnt vmcnt(39)
    s_add_u32 s7, s64, 4096
    s_mov_b32 m0, s7
    s_add_u32 s65, s68, 4096
    buffer_load_dwordx4 v14, s[48:51], s65 offen offset:0 nt lds
    s_waitcnt vmcnt(39)
    buffer_load_dwordx4 v15, s[48:51], s65 offen offset:1024 nt lds
    ds_read_b32 v18, v17
    s_waitcnt vmcnt(39)
    buffer_load_dwordx4 v14, s[48:51], s65 offen offset:2048 nt lds
    s_waitcnt vmcnt(39)
    s_sub_u32 s7, s60, 32
    s_max_i32 s61, s61, s7
    v_mov_b32 v19, s61
    ds_write_b32 v16, v19
    buffer_load_dwordx4 v15, s[48:51], s65 offen offset:3072 nt lds
    s_add_u32 s60, s60, 8
    s_add_u32 s65, s65, 4096
    s_mov_b32 s68, s69
    s_mov_b32 s69, s70
    s_mov_b32 s70, s71
    s_mov_b32 s71, s65
    s_add_u32 s62, s62, 1
    s_add_u32 s64, s64, 8192
    s_cmp_eq_u32 s62, 10
    s_cselect_b32 s7, 4, 0
    s_add_u32 s63, s63, s7
    s_cmp_eq_u32 s62, 18
    s_cselect_b32 s62, 0, s62
    s_cselect_b32 s64, 0, s64
    s_sub_u32 s66, s66, 1
    s_cmp_lg_u32 s66, 0
    s_cbranch_scc1 LL_26
    s_waitcnt vmcnt(32)
    s_sub_u32 s7, s60, 32
    s_max_i32 s61, s61, s7
    v_mov_b32 v19, s61
    ds_write_b32 v16, v19
    s_waitcnt vmcnt(24)
    s_sub_u32 s7, s60, 24
    s_max_i32 s61, s61, s7
    v_mov_b32 v19, s61
    ds_write_b32 v16, v19
    s_waitcnt vmcnt(16)
    s_sub_u32 s7, s60, 16
    s_max_i32 s61, s61, s7
    v_mov_b32 v19, s61
    ds_write_b32 v16, v19
    s_waitcnt vmcnt(8)
    s_sub_u32 s7, s60, 8
    s_max_i32 s61, s61, s7
    v_mov_b32 v19, s61
    ds_write_b32 v16, v19
    s_waitcnt vmcnt(0)
    s_mov_b32 s61, s60
    v_mov_b32 v19, s61
    ds_write_b32 v16, v19
    s_cmp_ge_u32 s5, 2
    s_cbranch_scc1 L_END
    v_mov_b32 v40, 0x24204
    s_mov_b32 s80, 1600000
LW_29:
    ds_read_b32 v41, v40
    s_waitcnt lgkmcnt(0)
    v_readfirstlane_b32 s79, v41
    s_cmp_ge_u32 s79, 1
    s_cbranch_scc1 LWD_30
    s_sleep 1
    s_sub_u32 s80, s80, 1
    s_cmp_lg_u32 s80, 0
    s_cbranch_scc1 LW_29
LWD_30:
    v_mov_b32 v40, 0x24248
    ds_read_b64 v[42:43], v40
    s_waitcnt lgkmcnt(0)
    v_readfirstlane_b32 s92, v42
    v_readfirstlane_b32 s93, v43
    s_mov_b32 s52, s30
    s_and_b32 s53, s31, 0xffff
    s_mov_b32 s54, 0x2000
    s_mov_b32 s55, 0x20000
    s_mov_b32 s84, 0x3f80
    s_mov_b32 s85, 0x3f800000
    s_lshl_b32 s60, s4, 1
    s_add_u32 s60, s60, s5
    s_lshl_b32 s7, s60, 12
    s_add_u32 s7, s7, 0x280000
    v_lshl_add_u32 v36, v1, 4, s7
    s_lshr_b32 s7, s60, 4
    s_lshl_b32 s7, s7, 11
    s_and_b32 s61, s60, 15
    s_lshl_b32 s61, s61, 6
    s_add_u32 s7, s7, s61
    v_lshl_add_u32 v37, v1, 3, s7
    v_mov_b32 v38, 0x24214
    s_mov_b32 s80, 1600000
LW_31:
    ds_read_b32 v39, v38
    s_waitcnt lgkmcnt(0)
    v_readfirstlane_b32 s79, v39
    s_cmp_ge_u32 s79, 4
    s_cbranch_scc1 LWD_32
    s_sleep 1
    s_sub_u32 s80, s80, 1
    s_cmp_lg_u32 s80, 0
    s_cbranch_scc1 LW_31
LWD_32:
    s_mov_b64 exec, -1
    buffer_load_dwordx4 v[48:51], v36, s[36:39], 0 offen offset:0 sc1
    buffer_load_dwordx4 v[52:55], v36, s[36:39], 0 offen offset:1024 sc1
    buffer_load_dwordx4 v[56:59], v36, s[36:39], 0 offen offset:2048 sc1
    buffer_load_dwordx4 v[60:63], v36, s[36:39], 0 offen offset:3072 sc1
    s_mov_b32 s80, 200000
MC_34:
    s_mov_b64 exec, -1
    s_waitcnt vmcnt(0)
    v_cmp_ne_u64 s[62:63], s[92:93], v[50:51]
    v_cmp_ne_u64 s[64:65], s[92:93], v[54:55]
    v_cmp_ne_u64 s[66:67], s[92:93], v[58:59]
    v_cmp_ne_u64 s[68:69], s[92:93], v[62:63]
    s_or_b64 s[90:91], s[62:63], s[64:65]
    s_or_b64 s[90:91], s[90:91], s[66:67]
    s_or_b64 s[90:91], s[90:91], s[68:69]
    s_cbranch_scc1 M_33
MD_35:
    s_mov_b64 exec, -1
    v_dot2_f32_bf16 v44, v48, s84, 0
    v_dot2_f32_bf16 v45, v48, s85, 0
    v_dot2_f32_bf16 v46, v49, s84, 0
    v_dot2_f32_bf16 v47, v49, s85, 0
    v_dot2_f32_bf16 v44, v52, s84, v44
    v_dot2_f32_bf16 v45, v52, s85, v45
    v_dot2_f32_bf16 v46, v53, s84, v46
    v_dot2_f32_bf16 v47, v53, s85, v47
    v_dot2_f32_bf16 v44, v56, s84, v44
    v_dot2_f32_bf16 v45, v56, s85, v45
    v_dot2_f32_bf16 v46, v57, s84, v46
    v_dot2_f32_bf16 v47, v57, s85, v47
    v_dot2_f32_bf16 v44, v60, s84, v44
    v_dot2_f32_bf16 v45, v60, s85, v45
    v_dot2_f32_bf16 v46, v61, s84, v46
    v_dot2_f32_bf16 v47, v61, s85, v47
    v_add_f32_dpp v44, v44, v44 row_ror:8 row_mask:0xf bank_mask:0xf
    v_add_f32_dpp v45, v45, v45 row_ror:8 row_mask:0xf bank_mask:0xf
    v_add_f32_dpp v46, v46, v46 row_ror:8 row_mask:0xf bank_mask:0xf
    v_add_f32_dpp v47, v47, v47 row_ror:8 row_mask:0xf bank_mask:0xf
    s_nop 0
    v_permlane32_swap_b32 v44, v46
    v_permlane32_swap_b32 v45, v47
    v_add_f32 v44, v44, v46
    v_add_f32 v45, v45, v47
    v_mov_b32 v46, v44
    v_mov_b32 v47, v45
    s_nop 0
    v_permlane16_swap_b32 v44, v46
    v_permlane16_swap_b32 v45, v47
    v_add_f32 v44, v44, v46
    v_add_f32 v45, v45, v47
    v_cvt_pk_bf16_f32 v44, v44, v45
    v_mov_b32 v45, v44
    s_nop 1
    v_permlane32_swap_b32 v44, v45
    s_mov_b64 exec, 0xff
    buffer_store_dwordx2 v[44:45], v37, s[52:55], 0 offen
    s_mov_b64 exec, -1
    s_endpgm
L_LDE:
    s_setprio 3
    v_xor_b32 v6, v3, v2
    v_lshlrev_b32 v6, 4, v6
    v_lshl_add_u32 v6, v2, 13, v6
    v_xor_b32 v7, 0x40, v6
    v_xor_b32 v8, 0x80, v6
    v_xor_b32 v9, 0xc0, v6
    s_lshl_b32 s65, s5, 21
    s_lshl_b32 s7, s4, 8
    s_add_u32 s65, s65, s7
    s_sub_u32 s65, s65, 0x800000
    s_mov_b32 s64, 0x14000
    s_waitcnt lgkmcnt(0)
    s_mov_b32 s52, s24
    s_and_b32 s53, s25, 0xffff
    s_mov_b32 s54, 0x400000
    s_mov_b32 s55, 0x20000
    s_mov_b32 m0, s64
    s_add_u32 s64, s64, 1024
    buffer_load_dwordx4 v6, s[52:55], s65 offen nt lds
    s_add_u32 s65, s65, 32768
    s_mov_b32 m0, s64
    s_add_u32 s64, s64, 1024
    buffer_load_dwordx4 v7, s[52:55], s65 offen nt lds
    s_add_u32 s65, s65, 32768
    s_mov_b32 m0, s64
    s_add_u32 s64, s64, 1024
    buffer_load_dwordx4 v8, s[52:55], s65 offen nt lds
    s_add_u32 s65, s65, 32768
    s_mov_b32 m0, s64
    s_add_u32 s64, s64, 1024
    buffer_load_dwordx4 v9, s[52:55], s65 offen nt lds
    s_add_u32 s65, s65, 32768
    s_mov_b32 m0, s64
    s_add_u32 s64, s64, 1024
    buffer_load_dwordx4 v6, s[52:55], s65 offen nt lds
    s_add_u32 s65, s65, 32768
    s_mov_b32 m0, s64
    s_add_u32 s64, s64, 1024
    buffer_load_dwordx4 v7, s[52:55], s65 offen nt lds
    s_add_u32 s65, s65, 32768
    s_mov_b32 m0, s64
    s_add_u32 s64, s64, 1024
    buffer_load_dwordx4 v8, s[52:55], s65 offen nt lds
    s_add_u32 s65, s65, 32768
    s_mov_b32 m0, s64
    s_add_u32 s64, s64, 1024
    buffer_load_dwordx4 v9, s[52:55], s65 offen nt lds
    s_add_u32 s65, s65, 32768
    s_mov_b32 m0, s64
    s_add_u32 s64, s64, 1024
    buffer_load_dwordx4 v6, s[52:55], s65 offen nt lds
    s_add_u32 s65, s65, 32768
    s_mov_b32 m0, s64
    s_add_u32 s64, s64, 1024
    buffer_load_dwordx4 v7, s[52:55], s65 offen nt lds
    s_add_u32 s65, s65, 32768
    s_mov_b32 m0, s64
    s_add_u32 s64, s64, 1024
    buffer_load_dwordx4 v8, s[52:55], s65 offen nt lds
    s_add_u32 s65, s65, 32768
    s_mov_b32 m0, s64
    s_add_u32 s64, s64, 1024
    buffer_load_dwordx4 v9, s[52:55], s65 offen nt lds
    s_add_u32 s65, s65, 32768
    s_mov_b32 m0, s64
    s_add_u32 s64, s64, 1024
    buffer_load_dwordx4 v6, s[52:55], s65 offen nt lds
    s_add_u32 s65, s65, 32768
    s_mov_b32 m0, s64
    s_add_u32 s64, s64, 1024
    buffer_load_dwordx4 v7, s[52:55], s65 offen nt lds
    s_add_u32 s65, s65, 32768
    s_mov_b32 m0, s64
    s_add_u32 s64, s64, 1024
    buffer_load_dwordx4 v8, s[52:55], s65 offen nt lds
    s_add_u32 s65, s65, 32768
    s_mov_b32 m0, s64
    s_add_u32 s64, s64, 1024
    buffer_load_dwordx4 v9, s[52:55], s65 offen nt lds
    s_add_u32 s65, s65, 32768
    s_mov_b32 m0, s64
    s_add_u32 s64, s64, 1024
    buffer_load_dwordx4 v6, s[52:55], s65 offen nt lds
    s_add_u32 s65, s65, 32768
    s_mov_b32 m0, s64
    s_add_u32 s64, s64, 1024
    buffer_load_dwordx4 v7, s[52:55], s65 offen nt lds
    s_add_u32 s65, s65, 32768
    s_mov_b32 m0, s64
    s_add_u32 s64, s64, 1024
    buffer_load_dwordx4 v8, s[52:55], s65 offen nt lds
    s_add_u32 s65, s65, 32768
    s_mov_b32 m0, s64
    s_add_u32 s64, s64, 1024
    buffer_load_dwordx4 v9, s[52:55], s65 offen nt lds
    s_add_u32 s65, s65, 32768
    s_mov_b32 m0, s64
    s_add_u32 s64, s64, 1024
    buffer_load_dwordx4 v6, s[52:55], s65 offen nt lds
    s_add_u32 s65, s65, 32768
    s_mov_b32 m0, s64
    s_add_u32 s64, s64, 1024
    buffer_load_dwordx4 v7, s[52:55], s65 offen nt lds
    s_add_u32 s65, s65, 32768
    s_mov_b32 m0, s64
    s_add_u32 s64, s64, 1024
    buffer_load_dwordx4 v8, s[52:55], s65 offen nt lds
    s_add_u32 s65, s65, 32768
    s_mov_b32 m0, s64
    s_add_u32 s64, s64, 1024
    buffer_load_dwordx4 v9, s[52:55], s65 offen nt lds
    s_add_u32 s65, s65, 32768
    s_mov_b32 m0, s64
    s_add_u32 s64, s64, 1024
    buffer_load_dwordx4 v6, s[52:55], s65 offen nt lds
    s_add_u32 s65, s65, 32768
    s_mov_b32 m0, s64
    s_add_u32 s64, s64, 1024
    buffer_load_dwordx4 v7, s[52:55], s65 offen nt lds
    s_add_u32 s65, s65, 32768
    s_mov_b32 m0, s64
    s_add_u32 s64, s64, 1024
    buffer_load_dwordx4 v8, s[52:55], s65 offen nt lds
    s_add_u32 s65, s65, 32768
    s_mov_b32 m0, s64
    s_add_u32 s64, s64, 1024
    buffer_load_dwordx4 v9, s[52:55], s65 offen nt lds
    s_add_u32 s65, s65, 32768
    s_mov_b32 m0, s64
    s_add_u32 s64, s64, 1024
    buffer_load_dwordx4 v6, s[52:55], s65 offen nt lds
    s_add_u32 s65, s65, 32768
    s_mov_b32 m0, s64
    s_add_u32 s64, s64, 1024
    buffer_load_dwordx4 v7, s[52:55], s65 offen nt lds
    s_add_u32 s65, s65, 32768
    s_mov_b32 m0, s64
    s_add_u32 s64, s64, 1024
    buffer_load_dwordx4 v8, s[52:55], s65 offen nt lds
    s_add_u32 s65, s65, 32768
    s_mov_b32 m0, s64
    s_add_u32 s64, s64, 1024
    buffer_load_dwordx4 v9, s[52:55], s65 offen nt lds
    s_add_u32 s65, s65, 32768
    s_barrier
    s_mov_b32 s61, 0
    s_mov_b32 s63, 0
    v_lshlrev_b32 v16, 2, v1
    v_add_u32 v17, 0x24100, v16
    v_add_u32 v16, 0x24000, v16
    v_mov_b32 v18, 0
    s_mov_b32 s60, 32
    s_mov_b32 s36, s34
    s_and_b32 s37, s35, 0xffff
    s_mov_b32 s38, 0x1000000
    s_mov_b32 s39, 0x20000
    s_mov_b32 s44, s26
    s_and_b32 s45, s27, 0xffff
    s_mov_b32 s46, 0x400000
    s_mov_b32 s47, 0x20000
    v_bfe_u32 v20, v1, 1, 2
    v_xor_b32 v20, v20, v2
    v_lshlrev_b32 v20, 5, v20
    v_lshrrev_b32 v40, 3, v1
    v_lshl_add_u32 v20, v40, 13, v20
    v_and_b32 v40, 1, v1
    v_lshl_add_u32 v20, v40, 4, v20
    s_mov_b32 s96, 0x6010600
    s_mov_b32 s97, 0x5030602
    s_cmp_eq_u32 s5, 1
    s_cselect_b32 s96, 0x6190618, s96
    s_cselect_b32 s97, 0x51a0617, s97
    s_cmp_eq_u32 s5, 2
    s_cselect_b32 s96, 0x62e0630, s96
    s_cselect_b32 s97, 0x531062f, s97
    s_cmp_eq_u32 s5, 3
    s_cselect_b32 s96, 0x6460645, s96
    s_cselect_b32 s97, 0x5480647, s97
    s_cmp_eq_u32 s5, 4
    s_cselect_b32 s96, 0x55d055c, s96
    s_cselect_b32 s97, 0x45f045e, s97
    s_cmp_eq_u32 s5, 5
    s_cselect_b32 s96, 0x56f056e, s96
    s_cselect_b32 s97, 0x4710470, s97
    v_xor_b32 v10, v3, v2
    v_lshlrev_b32 v10, 4, v10
    v_lshl_add_u32 v10, v2, 8, v10
    v_xor_b32 v11, 0x40, v10
    v_xor_b32 v12, 0x80, v10
    v_xor_b32 v13, 0xc0, v10
    v_lshrrev_b32 v14, 1, v3
    v_xor_b32 v14, v14, v2
    v_lshlrev_b32 v14, 5, v14
    v_lshl_add_u32 v14, v2, 8, v14
    v_and_b32 v40, 1, v1
    v_lshl_add_u32 v14, v40, 4, v14
    v_xor_b32 v15, 0x80, v14
    s_mov_b32 s76, 0
    s_lshl_b32 s7, s76, 4
    s_lshr_b64 s[90:91], s[96:97], s7
    s_and_b32 s68, s90, 3
    s_bfe_u32 s72, s90, 0x50002
    s_lshl_b32 s68, s68, 5
    s_add_u32 s68, s68, s4
    s_lshl_b32 s68, s68, 20
    s_lshl_b32 s72, s72, 13
    s_add_u32 s72, s72, s68
    s_add_u32 s72, s72, 0xC0000
    s_mov_b32 s76, 1
    s_lshl_b32 s7, s76, 4
    s_lshr_b64 s[90:91], s[96:97], s7
    s_and_b32 s69, s90, 3
    s_bfe_u32 s73, s90, 0x50002
    s_lshl_b32 s69, s69, 5
    s_add_u32 s69, s69, s4
    s_lshl_b32 s69, s69, 20
    s_lshl_b32 s73, s73, 13
    s_add_u32 s73, s73, s69
    s_add_u32 s73, s73, 0xC0000
    s_mov_b32 s76, 2
    s_lshl_b32 s7, s76, 4
    s_lshr_b64 s[90:91], s[96:97], s7
    s_and_b32 s70, s90, 3
    s_bfe_u32 s74, s90, 0x50002
    s_lshl_b32 s70, s70, 5
    s_add_u32 s70, s70, s4
    s_lshl_b32 s70, s70, 20
    s_lshl_b32 s74, s74, 13
    s_add_u32 s74, s74, s70
    s_add_u32 s74, s74, 0xC0000
    s_mov_b32 s76, 3
    s_lshl_b32 s7, s76, 4
    s_lshr_b64 s[90:91], s[96:97], s7
    s_and_b32 s71, s90, 3
    s_bfe_u32 s75, s90, 0x50002
    s_lshl_b32 s71, s71, 5
    s_add_u32 s71, s71, s4
    s_lshl_b32 s71, s71, 20
    s_lshl_b32 s75, s75, 13
    s_add_u32 s75, s75, s71
    s_add_u32 s75, s75, 0xC0000
    s_mov_b32 s66, 4
LL_36:
    s_waitcnt vmcnt(39)
    s_mov_b32 m0, s64
    s_add_u32 s64, s64, 1024
    buffer_load_dwordx4 v6, s[52:55], s65 offen nt lds
    s_add_u32 s65, s65, 32768
    s_waitcnt vmcnt(39)
    s_mov_b32 m0, s64
    s_add_u32 s64, s64, 1024
    buffer_load_dwordx4 v7, s[52:55], s65 offen nt lds
    s_add_u32 s65, s65, 32768
    s_waitcnt vmcnt(39)
    s_mov_b32 m0, s64
    s_add_u32 s64, s64, 1024
    buffer_load_dwordx4 v8, s[52:55], s65 offen nt lds
    s_add_u32 s65, s65, 32768
    s_waitcnt vmcnt(39)
    s_mov_b32 m0, s64
    s_add_u32 s64, s64, 1024
    buffer_load_dwordx4 v9, s[52:55], s65 offen nt lds
    s_add_u32 s65, s65, 32768
    s_waitcnt vmcnt(39)
    s_mov_b32 m0, s64
    s_add_u32 s64, s64, 1024
    buffer_load_dwordx4 v6, s[52:55], s65 offen nt lds
    s_add_u32 s65, s65, 32768
    s_waitcnt vmcnt(39)
    s_mov_b32 m0, s64
    s_add_u32 s64, s64, 1024
    buffer_load_dwordx4 v7, s[52:55], s65 offen nt lds
    s_add_u32 s65, s65, 32768
    s_waitcnt vmcnt(39)
    s_mov_b32 m0, s64
    s_add_u32 s64, s64, 1024
    buffer_load_dwordx4 v8, s[52:55], s65 offen nt lds
    s_add_u32 s65, s65, 32768
    s_waitcnt vmcnt(39)
    s_sub_u32 s7, s60, 32
    s_max_i32 s61, s61, s7
    v_mov_b32 v19, s61
    ds_write_b32 v16, v19
    s_mov_b32 m0, s64
    s_add_u32 s64, s64, 1024
    buffer_load_dwordx4 v9, s[52:55], s65 offen nt lds
    s_add_u32 s65, s65, 32768
    s_add_u32 s60, s60, 8
    s_sub_u32 s66, s66, 1
    s_cmp_lg_u32 s66, 0
    s_cbranch_scc1 LL_36
    s_waitcnt vmcnt(32)
    s_sub_u32 s7, s60, 32
    s_max_i32 s61, s61, s7
    v_mov_b32 v19, s61
    ds_write_b32 v16, v19
    s_waitcnt vmcnt(24)
    s_sub_u32 s7, s60, 24
    s_max_i32 s61, s61, s7
    v_mov_b32 v19, s61
    ds_write_b32 v16, v19
    s_waitcnt vmcnt(16)
    s_sub_u32 s7, s60, 16
    s_max_i32 s61, s61, s7
    v_mov_b32 v19, s61
    ds_write_b32 v16, v19
    s_waitcnt vmcnt(8)
    s_sub_u32 s7, s60, 8
    s_max_i32 s61, s61, s7
    v_mov_b32 v19, s61
    ds_write_b32 v16, v19
    s_waitcnt vmcnt(0)
    s_mov_b32 s61, s60
    v_mov_b32 v19, s61
    ds_write_b32 v16, v19
    v_mov_b32 v40, 0x24208
    s_mov_b32 s80, 1600000
LW_37:
    ds_read_b32 v41, v40
    s_waitcnt lgkmcnt(0)
    v_readfirstlane_b32 s79, v41
    s_cmp_ge_u32 s79, 20
    s_cbranch_scc1 LWD_38
    s_sub_u32 s80, s80, 1
    s_cmp_lg_u32 s80, 0
    s_cbranch_scc1 LW_37
LWD_38:
    s_lshl_b32 s65, s4, 8
    s_lshl_b32 s7, s5, 7
    s_add_u32 s65, s65, s7
    s_sub_u32 s65, s65, 512
    s_mov_b32 s64, 0
    s_mov_b32 s66, 8
LL_39:
    s_waitcnt vmcnt(23)
    s_mov_b32 m0, s64
    s_add_u32 s64, s64, 1024
    buffer_load_dwordx4 v20, s[44:47], s65 offen nt lds
    s_add_u32 s65, s65, 65536
    s_waitcnt vmcnt(23)
    s_mov_b32 m0, s64
    s_add_u32 s64, s64, 1024
    buffer_load_dwordx4 v20, s[44:47], s65 offen nt lds
    s_add_u32 s65, s65, 65536
    s_waitcnt vmcnt(23)
    s_mov_b32 m0, s64
    s_add_u32 s64, s64, 1024
    buffer_load_dwordx4 v20, s[44:47], s65 offen nt lds
    s_add_u32 s65, s65, 65536
    s_waitcnt vmcnt(23)
    s_mov_b32 m0, s64
    s_add_u32 s64, s64, 1024
    buffer_load_dwordx4 v20, s[44:47], s65 offen nt lds
    s_add_u32 s65, s65, 65536
    s_waitcnt vmcnt(23)
    s_mov_b32 m0, s64
    s_add_u32 s64, s64, 1024
    buffer_load_dwordx4 v20, s[44:47], s65 offen nt lds
    s_add_u32 s65, s65, 65536
    s_waitcnt vmcnt(23)
    s_mov_b32 m0, s64
    s_add_u32 s64, s64, 1024
    buffer_load_dwordx4 v20, s[44:47], s65 offen nt lds
    s_add_u32 s65, s65, 65536
    s_waitcnt vmcnt(23)
    s_mov_b32 m0, s64
    s_add_u32 s64, s64, 1024
    buffer_load_dwordx4 v20, s[44:47], s65 offen nt lds
    s_add_u32 s65, s65, 65536
    s_waitcnt vmcnt(23)
    s_sub_u32 s7, s60, 16
    s_max_i32 s61, s61, s7
    v_mov_b32 v19, s61
    ds_write_b32 v16, v19
    s_mov_b32 m0, s64
    s_add_u32 s64, s64, 1024
    buffer_load_dwordx4 v20, s[44:47], s65 offen nt lds
    s_add_u32 s65, s65, 65536
    s_add_u32 s60, s60, 8
    s_sub_u32 s66, s66, 1
    s_cmp_lg_u32 s66, 0
    s_cbranch_scc1 LL_39
    s_mov_b32 s62, 8
    s_mov_b32 s44, s10
    s_and_b32 s45, s11, 0xffff
    s_mov_b32 s46, 0x8000000
    s_mov_b32 s47, 0x20000
    s_mov_b32 s48, s12
    s_and_b32 s49, s13, 0xffff
    s_mov_b32 s50, 0x8000000
    s_mov_b32 s51, 0x20000
    s_mov_b32 s68, s72
    s_mov_b32 s69, s73
    s_mov_b32 s70, s74
    s_mov_b32 s71, s75
    s_mov_b32 s66, 18
LL_40:
    s_waitcnt lgkmcnt(0)
    v_readlane_b32 s79, v18, s62
    s_cmp_lt_u32 s79, s63
    s_cbranch_scc1 ST_42
GO_41:
    s_waitcnt vmcnt(23)
    s_add_u32 s7, s64, 0
    s_mov_b32 m0, s7
    s_add_u32 s65, s68, 0
    buffer_load_dwordx4 v10, s[44:47], s65 offen offset:0 nt lds
    s_waitcnt vmcnt(23)
    buffer_load_dwordx4 v11, s[44:47], s65 offen offset:1024 nt lds
    s_waitcnt vmcnt(23)
    buffer_load_dwordx4 v12, s[44:47], s65 offen offset:2048 nt lds
    s_waitcnt vmcnt(23)
    buffer_load_dwordx4 v13, s[44:47], s65 offen offset:3072 nt lds
    s_waitcnt vmcnt(23)
    s_add_u32 s7, s64, 4096
    s_mov_b32 m0, s7
    s_add_u32 s65, s68, 4096
    buffer_load_dwordx4 v10, s[44:47], s65 offen offset:0 nt lds
    s_waitcnt vmcnt(23)
    buffer_load_dwordx4 v11, s[44:47], s65 offen offset:1024 nt lds
    ds_read_b32 v18, v17
    s_waitcnt vmcnt(23)
    buffer_load_dwordx4 v12, s[44:47], s65 offen offset:2048 nt lds
    s_waitcnt vmcnt(23)
    s_sub_u32 s7, s60, 16
    s_max_i32 s61, s61, s7
    v_mov_b32 v19, s61
    ds_write_b32 v16, v19
    buffer_load_dwordx4 v13, s[44:47], s65 offen offset:3072 nt lds
    s_add_u32 s60, s60, 8
    s_add_u32 s65, s65, 4096
    s_mov_b32 s68, s69
    s_mov_b32 s69, s70
    s_mov_b32 s70, s71
    s_mov_b32 s71, s65
    s_add_u32 s62, s62, 1
    s_add_u32 s64, s64, 8192
    s_cmp_eq_u32 s62, 10
    s_cselect_b32 s7, 4, 0
    s_add_u32 s63, s63, s7
    s_cmp_eq_u32 s62, 18
    s_cselect_b32 s62, 0, s62
    s_cselect_b32 s64, 0, s64
    s_sub_u32 s66, s66, 1
    s_cmp_lg_u32 s66, 0
    s_cbranch_scc1 LL_40
    s_mov_b32 s68, s72
    s_mov_b32 s69, s73
    s_mov_b32 s70, s74
    s_mov_b32 s71, s75
    s_mov_b32 s66, 4
LL_43:
    s_waitcnt lgkmcnt(0)
    v_readlane_b32 s79, v18, s62
    s_cmp_lt_u32 s79, s63
    s_cbranch_scc1 ST_45
GO_44:
    s_waitcnt vmcnt(23)
    s_add_u32 s7, s64, 0
    s_mov_b32 m0, s7
    s_add_u32 s65, s68, 0
    buffer_load_dwordx4 v14, s[48:51], s65 offen offset:0 nt lds
    s_waitcnt vmcnt(23)
    buffer_load_dwordx4 v15, s[48:51], s65 offen offset:1024 nt lds
    s_waitcnt vmcnt(23)
    buffer_load_dwordx4 v14, s[48:51], s65 offen offset:2048 nt lds
    s_waitcnt vmcnt(23)
    buffer_load_dwordx4 v15, s[48:51], s65 offen offset:3072 nt lds
    s_waitcnt vmcnt(23)
    s_add_u32 s7, s64, 4096
    s_mov_b32 m0, s7
    s_add_u32 s65, s68, 4096
    buffer_load_dwordx4 v14, s[48:51], s65 offen offset:0 nt lds
    s_waitcnt vmcnt(23)
    buffer_load_dwordx4 v15, s[48:51], s65 offen offset:1024 nt lds
    ds_read_b32 v18, v17
    s_waitcnt vmcnt(23)
    buffer_load_dwordx4 v14, s[48:51], s65 offen offset:2048 nt lds
    s_waitcnt vmcnt(23)
    s_sub_u32 s7, s60, 16
    s_max_i32 s61, s61, s7
    v_mov_b32 v19, s61
    ds_write_b32 v16, v19
    buffer_load_dwordx4 v15, s[48:51], s65 offen offset:3072 nt lds
    s_add_u32 s60, s60, 8
    s_add_u32 s65, s65, 4096
    s_mov_b32 s68, s69
    s_mov_b32 s69, s70
    s_mov_b32 s70, s71
    s_mov_b32 s71, s65
    s_add_u32 s62, s62, 1
    s_add_u32 s64, s64, 8192
    s_cmp_eq_u32 s62, 10
    s_cselect_b32 s7, 4, 0
    s_add_u32 s63, s63, s7
    s_cmp_eq_u32 s62, 18
    s_cselect_b32 s62, 0, s62
    s_cselect_b32 s64, 0, s64
    s_sub_u32 s66, s66, 1
    s_cmp_lg_u32 s66, 0
    s_cbranch_scc1 LL_43
    s_mov_b32 s66, 9
LL_46:
    s_waitcnt lgkmcnt(0)
    v_readlane_b32 s79, v18, s62
    s_cmp_lt_u32 s79, s63
    s_cbranch_scc1 ST_48
GO_47:
    s_waitcnt vmcnt(25)
    s_add_u32 s7, s64, 0
    s_mov_b32 m0, s7
    s_add_u32 s65, s68, 0
    buffer_load_dwordx4 v14, s[48:51], s65 offen offset:0 nt lds
    s_waitcnt vmcnt(25)
    s_sub_u32 s7, s60, 24
    s_max_i32 s61, s61, s7
    v_mov_b32 v19, s61
    ds_write_b32 v16, v19
    buffer_load_dwordx4 v15, s[48:51], s65 offen offset:1024 nt lds
    s_waitcnt vmcnt(25)
    buffer_load_dwordx4 v14, s[48:51], s65 offen offset:2048 nt lds
    s_waitcnt vmcnt(25)
    buffer_load_dwordx4 v15, s[48:51], s65 offen offset:3072 nt lds
    s_waitcnt vmcnt(25)
    s_add_u32 s7, s64, 4096
    s_mov_b32 m0, s7
    s_add_u32 s65, s68, 4096
    buffer_load_dwordx4 v14, s[48:51], s65 offen offset:0 nt lds
    s_waitcnt vmcnt(25)
    buffer_load_dwordx4 v15, s[48:51], s65 offen offset:1024 nt lds
    ds_read_b32 v18, v17
    s_waitcnt vmcnt(25)
    buffer_load_dwordx4 v14, s[48:51], s65 offen offset:2048 nt lds
    s_waitcnt vmcnt(25)
    buffer_load_dwordx4 v15, s[48:51], s65 offen offset:3072 nt lds
    s_add_u32 s60, s60, 8
    s_add_u32 s65, s65, 4096
    s_mov_b32 s68, s69
    s_mov_b32 s69, s70
    s_mov_b32 s70, s71
    s_mov_b32 s71, s65
    s_add_u32 s62, s62, 1
    s_add_u32 s64, s64, 8192
    s_cmp_eq_u32 s62, 10
    s_cselect_b32 s7, 4, 0
    s_add_u32 s63, s63, s7
    s_cmp_eq_u32 s62, 18
    s_cselect_b32 s62, 0, s62
    s_cselect_b32 s64, 0, s64
    s_sub_u32 s66, s66, 1
    s_cmp_lg_u32 s66, 0
    s_cbranch_scc1 LL_46
    s_mov_b32 s66, 5
LL_49:
    s_waitcnt lgkmcnt(0)
    v_readlane_b32 s79, v18, s62
    s_cmp_lt_u32 s79, s63
    s_cbranch_scc1 ST_51
GO_50:
    s_waitcnt vmcnt(39)
    s_add_u32 s7, s64, 0
    s_mov_b32 m0, s7
    s_add_u32 s65, s68, 0
    buffer_load_dwordx4 v14, s[48:51], s65 offen offset:0 nt lds
    s_waitcnt vmcnt(39)
    buffer_load_dwordx4 v15, s[48:51], s65 offen offset:1024 nt lds
    s_waitcnt vmcnt(39)
    buffer_load_dwordx4 v14, s[48:51], s65 offen offset:2048 nt lds
    s_waitcnt vmcnt(39)
    buffer_load_dwordx4 v15, s[48:51], s65 offen offset:3072 nt lds
    s_waitcnt vmcnt(39)
    s_add_u32 s7, s64, 4096
    s_mov_b32 m0, s7
    s_add_u32 s65, s68, 4096
    buffer_load_dwordx4 v14, s[48:51], s65 offen offset:0 nt lds
    s_waitcnt vmcnt(39)
    buffer_load_dwordx4 v15, s[48:51], s65 offen offset:1024 nt lds
    ds_read_b32 v18, v17
    s_waitcnt vmcnt(39)
    buffer_load_dwordx4 v14, s[48:51], s65 offen offset:2048 nt lds
    s_waitcnt vmcnt(39)
    s_sub_u32 s7, s60, 32
    s_max_i32 s61, s61, s7
    v_mov_b32 v19, s61
    ds_write_b32 v16, v19
    buffer_load_dwordx4 v15, s[48:51], s65 offen offset:3072 nt lds
    s_add_u32 s60, s60, 8
    s_add_u32 s65, s65, 4096
    s_mov_b32 s68, s69
    s_mov_b32 s69, s70
    s_mov_b32 s70, s71
    s_mov_b32 s71, s65
    s_add_u32 s62, s62, 1
    s_add_u32 s64, s64, 8192
    s_cmp_eq_u32 s62, 10
    s_cselect_b32 s7, 4, 0
    s_add_u32 s63, s63, s7
    s_cmp_eq_u32 s62, 18
    s_cselect_b32 s62, 0, s62
    s_cselect_b32 s64, 0, s64
    s_sub_u32 s66, s66, 1
    s_cmp_lg_u32 s66, 0
    s_cbranch_scc1 LL_49
    s_waitcnt vmcnt(32)
    s_sub_u32 s7, s60, 32
    s_max_i32 s61, s61, s7
    v_mov_b32 v19, s61
    ds_write_b32 v16, v19
    s_waitcnt vmcnt(24)
    s_sub_u32 s7, s60, 24
    s_max_i32 s61, s61, s7
    v_mov_b32 v19, s61
    ds_write_b32 v16, v19
    s_waitcnt vmcnt(16)
    s_sub_u32 s7, s60, 16
    s_max_i32 s61, s61, s7
    v_mov_b32 v19, s61
    ds_write_b32 v16, v19
    s_waitcnt vmcnt(8)
    s_sub_u32 s7, s60, 8
    s_max_i32 s61, s61, s7
    v_mov_b32 v19, s61
    ds_write_b32 v16, v19
    s_waitcnt vmcnt(0)
    s_mov_b32 s61, s60
    v_mov_b32 v19, s61
    ds_write_b32 v16, v19
    s_endpgm
L_LDB:
    s_setprio 3
    v_lshlrev_b32 v20, 4, v1
    v_xor_b32 v21, 0x40, v20
    v_xor_b32 v22, 0x80, v20
    v_xor_b32 v23, 0xc0, v20
    v_xor_b32 v24, 0x10, v20
    v_xor_b32 v25, 0x50, v20
    v_xor_b32 v26, 0x90, v20
    v_xor_b32 v27, 0xd0, v20
    v_xor_b32 v28, 0x20, v20
    v_xor_b32 v29, 0x60, v20
    v_xor_b32 v30, 0xa0, v20
    v_xor_b32 v31, 0xe0, v20
    v_xor_b32 v32, 0x30, v20
    v_xor_b32 v33, 0x70, v20
    v_xor_b32 v34, 0xb0, v20
    v_xor_b32 v35, 0xf0, v20
    s_and_b32 s69, s4, 7
    s_lshl_b32 s69, s69, 3
    s_lshr_b32 s7, s4, 3
    s_lshl_b32 s7, s7, 1
    s_add_u32 s69, s69, s7
    s_add_u32 s69, s69, s5
    s_sub_u32 s69, s69, 6
    s_lshl_b32 s68, s69, 18
    s_mov_b32 s64, 0
    s_waitcnt lgkmcnt(0)
    s_mov_b32 s44, s20
    s_and_b32 s45, s21, 0xffff
    s_mov_b32 s46, 0x1000000
    s_mov_b32 s47, 0x20000
    s_add_u32 s7, s64, 0
    s_mov_b32 m0, s7
    s_add_u32 s65, s68, 0
    buffer_load_dwordx4 v20, s[44:47], s65 offen offset:0 nt lds
    buffer_load_dwordx4 v21, s[44:47], s65 offen offset:1024 nt lds
    buffer_load_dwordx4 v22, s[44:47], s65 offen offset:2048 nt lds
    buffer_load_dwordx4 v23, s[44:47], s65 offen offset:3072 nt lds
    s_add_u32 s7, s64, 4096
    s_mov_b32 m0, s7
    s_add_u32 s65, s68, 4096
    buffer_load_dwordx4 v24, s[44:47], s65 offen offset:0 nt lds
    buffer_load_dwordx4 v25, s[44:47], s65 offen offset:1024 nt lds
    buffer_load_dwordx4 v26, s[44:47], s65 offen offset:2048 nt lds
    buffer_load_dwordx4 v27, s[44:47], s65 offen offset:3072 nt lds
    s_add_u32 s7, s64, 8192
    s_mov_b32 m0, s7
    s_add_u32 s65, s68, 8192
    buffer_load_dwordx4 v28, s[44:47], s65 offen offset:0 nt lds
    buffer_load_dwordx4 v29, s[44:47], s65 offen offset:1024 nt lds
    buffer_load_dwordx4 v30, s[44:47], s65 offen offset:2048 nt lds
    buffer_load_dwordx4 v31, s[44:47], s65 offen offset:3072 nt lds
    s_add_u32 s7, s64, 12288
    s_mov_b32 m0, s7
    s_add_u32 s65, s68, 12288
    buffer_load_dwordx4 v32, s[44:47], s65 offen offset:0 nt lds
    buffer_load_dwordx4 v33, s[44:47], s65 offen offset:1024 nt lds
    buffer_load_dwordx4 v34, s[44:47], s65 offen offset:2048 nt lds
    buffer_load_dwordx4 v35, s[44:47], s65 offen offset:3072 nt lds
    s_barrier
    s_mov_b32 s61, 0
    s_mov_b32 s63, 0
    v_lshlrev_b32 v16, 2, v1
    v_add_u32 v17, 0x24100, v16
    v_add_u32 v16, 0x24000, v16
    v_mov_b32 v18, 0
    s_mov_b32 s60, 16
    s_mov_b32 s36, s34
    s_and_b32 s37, s35, 0xffff
    s_mov_b32 s38, 0x1000000
    s_mov_b32 s39, 0x20000
    s_add_u32 s68, s68, 16384
    s_mov_b32 s64, 16384
    s_mov_b32 s48, s28
    s_and_b32 s49, s29, 0xffff
    s_mov_b32 s50, 0x400000
    s_mov_b32 s51, 0x20000
    v_bfe_u32 v10, v1, 1, 2
    v_xor_b32 v10, v10, v2
    v_lshlrev_b32 v10, 5, v10
    v_lshrrev_b32 v40, 3, v1
    v_lshl_add_u32 v10, v40, 10, v10
    v_and_b32 v40, 1, v1
    v_lshl_add_u32 v10, v40, 4, v10
    s_mov_b32 s72, 0x22111155
    s_mov_b32 s73, 0x2
    s_lshl_b32 s7, s69, 9
    s_add_u32 s7, s7, 0x28000
    v_lshl_add_u32 v44, v1, 4, s7
    s_mov_b32 s66, 6
LL_52:
    s_waitcnt vmcnt(27)
    s_add_u32 s7, s64, 0
    s_mov_b32 m0, s7
    s_add_u32 s65, s68, 0
    buffer_load_dwordx4 v20, s[44:47], s65 offen offset:0 nt lds
    s_waitcnt vmcnt(27)
    buffer_load_dwordx4 v21, s[44:47], s65 offen offset:1024 nt lds
    s_waitcnt vmcnt(27)
    buffer_load_dwordx4 v22, s[44:47], s65 offen offset:2048 nt lds
    s_waitcnt vmcnt(27)
    s_sub_u32 s7, s60, 24
    s_max_i32 s61, s61, s7
    v_mov_b32 v19, s61
    ds_write_b32 v16, v19
    buffer_load_dwordx4 v23, s[44:47], s65 offen offset:3072 nt lds
    s_waitcnt vmcnt(27)
    s_add_u32 s7, s64, 4096
    s_mov_b32 m0, s7
    s_add_u32 s65, s68, 4096
    buffer_load_dwordx4 v24, s[44:47], s65 offen offset:0 nt lds
    s_waitcnt vmcnt(27)
    buffer_load_dwordx4 v25, s[44:47], s65 offen offset:1024 nt lds
    s_waitcnt vmcnt(27)
    buffer_load_dwordx4 v26, s[44:47], s65 offen offset:2048 nt lds
    s_waitcnt vmcnt(27)
    buffer_load_dwordx4 v27, s[44:47], s65 offen offset:3072 nt lds
    s_waitcnt vmcnt(27)
    s_add_u32 s7, s64, 8192
    s_mov_b32 m0, s7
    s_add_u32 s65, s68, 8192
    buffer_load_dwordx4 v28, s[44:47], s65 offen offset:0 nt lds
    s_waitcnt vmcnt(27)
    buffer_load_dwordx4 v29, s[44:47], s65 offen offset:1024 nt lds
    s_waitcnt vmcnt(27)
    buffer_load_dwordx4 v30, s[44:47], s65 offen offset:2048 nt lds
    s_waitcnt vmcnt(27)
    s_sub_u32 s7, s60, 16
    s_max_i32 s61, s61, s7
    v_mov_b32 v19, s61
    ds_write_b32 v16, v19
    buffer_load_dwordx4 v31, s[44:47], s65 offen offset:3072 nt lds
    s_waitcnt vmcnt(27)
    s_add_u32 s7, s64, 12288
    s_mov_b32 m0, s7
    s_add_u32 s65, s68, 12288
    buffer_load_dwordx4 v32, s[44:47], s65 offen offset:0 nt lds
    s_waitcnt vmcnt(27)
    buffer_load_dwordx4 v33, s[44:47], s65 offen offset:1024 nt lds
    s_waitcnt vmcnt(27)
    buffer_load_dwordx4 v34, s[44:47], s65 offen offset:2048 nt lds
    s_waitcnt vmcnt(27)
    buffer_load_dwordx4 v35, s[44:47], s65 offen offset:3072 nt lds
    s_add_u32 s60, s60, 16
    s_add_u32 s68, s68, 16384
    s_add_u32 s64, s64, 16384
    s_sub_u32 s66, s66, 1
    s_cmp_lg_u32 s66, 0
    s_cbranch_scc1 LL_52
    v_mov_b32 v40, 0x24204
    s_mov_b32 s80, 1600000
LW_53:
    ds_read_b32 v41, v40
    s_waitcnt lgkmcnt(0)
    v_readfirstlane_b32 s79, v41
    s_cmp_ge_u32 s79, 1
    s_cbranch_scc1 LWD_54
    s_sleep 1
    s_sub_u32 s80, s80, 1
    s_cmp_lg_u32 s80, 0
    s_cbranch_scc1 LW_53
LWD_54:
    v_mov_b32 v40, 0x24248
    ds_read_b64 v[42:43], v40
    s_waitcnt lgkmcnt(0)
    v_readfirstlane_b32 s92, v42
    v_readfirstlane_b32 s93, v43
    s_lshr_b32 s7, s69, 3
    s_lshl_b32 s7, s7, 7
    s_add_u32 s7, s7, 0x22000
    v_and_b32 v38, 7, v1
    v_lshl_add_u32 v38, v38, 3, s7
    s_mov_b32 s66, 9
LL_55:
    s_and_b32 s63, s72, 3
    s_lshl_b32 s63, s63, 3
    s_bfe_u32 s62, s72, 0x20002
    s_lshr_b64 s[72:73], s[72:73], 4
    s_waitcnt lgkmcnt(0)
    v_readlane_b32 s79, v18, s62
    s_cmp_lt_u32 s79, s63
    s_cbranch_scc1 ST_57
GO_56:
    s_waitcnt vmcnt(31)
    s_add_u32 s7, s64, 0
    s_mov_b32 m0, s7
    s_add_u32 s65, s68, 0
    buffer_load_dwordx4 v20, s[44:47], s65 offen offset:0 nt lds
    s_waitcnt vmcnt(31)
    buffer_load_dwordx4 v21, s[44:47], s65 offen offset:1024 nt lds
    s_waitcnt vmcnt(31)
    buffer_load_dwordx4 v22, s[44:47], s65 offen offset:2048 nt lds
    s_waitcnt vmcnt(31)
    buffer_load_dwordx4 v23, s[44:47], s65 offen offset:3072 nt lds
    s_waitcnt vmcnt(31)
    s_add_u32 s7, s64, 4096
    s_mov_b32 m0, s7
    s_add_u32 s65, s68, 4096
    buffer_load_dwordx4 v24, s[44:47], s65 offen offset:0 nt lds
    s_waitcnt vmcnt(31)
    buffer_load_dwordx4 v25, s[44:47], s65 offen offset:1024 nt lds
    s_waitcnt vmcnt(31)
    buffer_load_dwordx4 v26, s[44:47], s65 offen offset:2048 nt lds
    s_waitcnt vmcnt(31)
    s_sub_u32 s7, s60, 24
    s_max_i32 s61, s61, s7
    v_mov_b32 v19, s61
    ds_write_b32 v16, v19
    buffer_load_dwordx4 v27, s[44:47], s65 offen offset:3072 nt lds
    s_waitcnt vmcnt(31)
    s_add_u32 s7, s64, 8192
    s_mov_b32 m0, s7
    s_add_u32 s65, s68, 8192
    buffer_load_dwordx4 v28, s[44:47], s65 offen offset:0 nt lds
    s_waitcnt vmcnt(31)
    buffer_load_dwordx4 v29, s[44:47], s65 offen offset:1024 nt lds
    s_waitcnt vmcnt(31)
    buffer_load_dwordx4 v30, s[44:47], s65 offen offset:2048 nt lds
    s_waitcnt vmcnt(31)
    buffer_load_dwordx4 v31, s[44:47], s65 offen offset:3072 nt lds
    s_waitcnt vmcnt(31)
    s_add_u32 s7, s64, 12288
    s_mov_b32 m0, s7
    s_add_u32 s65, s68, 12288
    buffer_load_dwordx4 v32, s[44:47], s65 offen offset:0 nt lds
    s_waitcnt vmcnt(31)
    buffer_load_dwordx4 v33, s[44:47], s65 offen offset:1024 nt lds
    ds_read_b32 v18, v17
    s_waitcnt vmcnt(31)
    buffer_load_dwordx4 v34, s[44:47], s65 offen offset:2048 nt lds
    s_waitcnt vmcnt(31)
    s_sub_u32 s7, s60, 16
    s_max_i32 s61, s61, s7
    v_mov_b32 v19, s61
    ds_write_b32 v16, v19
    buffer_load_dwordx4 v35, s[44:47], s65 offen offset:3072 nt lds
    s_add_u32 s60, s60, 16
    s_add_u32 s68, s68, 16384
    s_add_u32 s64, s64, 16384
    s_cmp_eq_u32 s64, 147456
    s_cselect_b32 s64, 0, s64
    s_sub_u32 s66, s66, 1
    s_cmp_lg_u32 s66, 0
    s_cbranch_scc1 LL_55
    s_and_b32 s7, s69, 7
    s_lshl_b64 exec, 1, s7
    buffer_store_dwordx2 v[42:43], v38, s[36:39], 0 offen offset:2048 sc1
    s_mov_b64 exec, -1
    buffer_load_dwordx2 v[46:47], v38, s[36:39], 0 offen sc1 nt
    s_lshr_b32 s65, s69, 3
    s_lshl_b32 s65, s65, 17
    s_and_b32 s7, s69, 7
    s_lshl_b32 s7, s7, 7
    s_add_u32 s65, s65, s7
    s_mov_b32 s64, 114688
    s_mov_b32 s63, 24
    s_waitcnt lgkmcnt(0)
    v_readlane_b32 s79, v18, 0
    s_cmp_lt_u32 s79, s63
    s_cbranch_scc1 ST_59
GO_58:
    s_mov_b32 s66, 1
LL_60:
    s_waitcnt vmcnt(31)
    s_mov_b32 m0, s64
    s_add_u32 s64, s64, 1024
    buffer_load_dwordx4 v10, s[48:51], s65 offen nt lds
    s_add_u32 s65, s65, 8192
    s_waitcnt vmcnt(31)
    s_mov_b32 m0, s64
    s_add_u32 s64, s64, 1024
    buffer_load_dwordx4 v10, s[48:51], s65 offen nt lds
    s_add_u32 s65, s65, 8192
    s_waitcnt vmcnt(31)
    s_mov_b32 m0, s64
    s_add_u32 s64, s64, 1024
    buffer_load_dwordx4 v10, s[48:51], s65 offen nt lds
    s_add_u32 s65, s65, 8192
    s_waitcnt vmcnt(31)
    s_mov_b32 m0, s64
    s_add_u32 s64, s64, 1024
    buffer_load_dwordx4 v10, s[48:51], s65 offen nt lds
    s_add_u32 s65, s65, 8192
    s_waitcnt vmcnt(31)
    s_mov_b32 m0, s64
    s_add_u32 s64, s64, 1024
    buffer_load_dwordx4 v10, s[48:51], s65 offen nt lds
    s_add_u32 s65, s65, 8192
    s_waitcnt vmcnt(31)
    s_mov_b32 m0, s64
    s_add_u32 s64, s64, 1024
    buffer_load_dwordx4 v10, s[48:51], s65 offen nt lds
    s_add_u32 s65, s65, 8192
    s_waitcnt vmcnt(31)
    s_mov_b32 m0, s64
    s_add_u32 s64, s64, 1024
    buffer_load_dwordx4 v10, s[48:51], s65 offen nt lds
    s_add_u32 s65, s65, 8192
    s_waitcnt vmcnt(31)
    s_sub_u32 s7, s60, 24
    s_max_i32 s61, s61, s7
    v_mov_b32 v19, s61
    ds_write_b32 v16, v19
    s_mov_b32 m0, s64
    s_add_u32 s64, s64, 1024
    buffer_load_dwordx4 v10, s[48:51], s65 offen nt lds
    s_add_u32 s65, s65, 8192
    s_waitcnt vmcnt(31)
    s_mov_b32 m0, s64
    s_add_u32 s64, s64, 1024
    buffer_load_dwordx4 v10, s[48:51], s65 offen nt lds
    s_add_u32 s65, s65, 8192
    s_waitcnt vmcnt(31)
    s_mov_b32 m0, s64
    s_add_u32 s64, s64, 1024
    buffer_load_dwordx4 v10, s[48:51], s65 offen nt lds
    s_add_u32 s65, s65, 8192
    s_waitcnt vmcnt(31)
    s_mov_b32 m0, s64
    s_add_u32 s64, s64, 1024
    buffer_load_dwordx4 v10, s[48:51], s65 offen nt lds
    s_add_u32 s65, s65, 8192
    s_waitcnt vmcnt(31)
    s_mov_b32 m0, s64
    s_add_u32 s64, s64, 1024
    buffer_load_dwordx4 v10, s[48:51], s65 offen nt lds
    s_add_u32 s65, s65, 8192
    s_waitcnt vmcnt(31)
    s_mov_b32 m0, s64
    s_add_u32 s64, s64, 1024
    buffer_load_dwordx4 v10, s[48:51], s65 offen nt lds
    s_add_u32 s65, s65, 8192
    s_waitcnt vmcnt(31)
    s_mov_b32 m0, s64
    s_add_u32 s64, s64, 1024
    buffer_load_dwordx4 v10, s[48:51], s65 offen nt lds
    s_add_u32 s65, s65, 8192
    s_waitcnt vmcnt(31)
    s_mov_b32 m0, s64
    s_add_u32 s64, s64, 1024
    buffer_load_dwordx4 v10, s[48:51], s65 offen nt lds
    s_add_u32 s65, s65, 8192
    s_waitcnt vmcnt(31)
    s_sub_u32 s7, s60, 16
    s_max_i32 s61, s61, s7
    v_mov_b32 v19, s61
    ds_write_b32 v16, v19
    s_mov_b32 m0, s64
    s_add_u32 s64, s64, 1024
    buffer_load_dwordx4 v10, s[48:51], s65 offen nt lds
    s_add_u32 s65, s65, 8192
    s_add_u32 s60, s60, 16
    s_add_u32 s65, s65, 917504
    s_cmp_eq_u32 s64, 147456
    s_cselect_b32 s64, 0, s64
    s_sub_u32 s66, s66, 1
    s_cmp_lg_u32 s66, 0
    s_cbranch_scc1 LL_60
    s_waitcnt vmcnt(24)
    s_sub_u32 s7, s60, 24
    s_max_i32 s61, s61, s7
    v_mov_b32 v19, s61
    ds_write_b32 v16, v19
    s_waitcnt vmcnt(16)
    s_sub_u32 s7, s60, 16
    s_max_i32 s61, s61, s7
    v_mov_b32 v19, s61
    ds_write_b32 v16, v19
    s_waitcnt vmcnt(8)
    s_sub_u32 s7, s60, 8
    s_max_i32 s61, s61, s7
    v_mov_b32 v19, s61
    ds_write_b32 v16, v19
    s_waitcnt vmcnt(0)
    s_mov_b32 s61, s60
    v_mov_b32 v19, s61
    ds_write_b32 v16, v19
    v_and_b32 v45, 31, v1
    v_lshlrev_b32 v45, 3, v45
    v_lshrrev_b32 v48, 5, v1
    v_lshl_add_u32 v45, v48, 11, v45
    v_add_u32 v45, 0x24400, v45
    s_or_b32 s95, s95, s78
    s_add_u32 s88, s94, 0x10000
    s_addc_u32 s89, s95, 0
    s_mov_b32 s101, 1
    s_mov_b64 exec, 0xff
    s_branch UU_63
U_62:
    buffer_load_dwordx2 v[46:47], v38, s[36:39], 0 offen sc1 nt
UU_63:
    s_waitcnt vmcnt(0)
    v_cmp_gt_u64 s[90:91], s[94:95], v[46:47]
    v_cmp_le_u64 vcc, s[88:89], v[46:47]
    s_or_b64 vcc, vcc, s[90:91]
    s_cbranch_scc0 UD_64
    s_sleep 0
    s_sub_u32 s101, s101, 1
    s_cmp_lg_u32 s101, 0
    s_cbranch_scc1 U_62
UD_64:
    s_mov_b64 exec, -1
    v_mov_b32 v48, 0x2420c
    s_mov_b32 s80, 1600000
LW_65:
    ds_read_b32 v49, v48
    s_waitcnt lgkmcnt(0)
    v_readfirstlane_b32 s79, v49
    s_cmp_ge_u32 s79, 40
    s_cbranch_scc1 LWD_66
    s_sub_u32 s80, s80, 1
    s_cmp_lg_u32 s80, 0
    s_cbranch_scc1 LW_65
LWD_66:
    ds_read_b64 v[48:49], v45 offset:0
    ds_read_b64 v[50:51], v45 offset:256
    ds_read_b64 v[52:53], v45 offset:512
    ds_read_b64 v[54:55], v45 offset:768
    ds_read_b64 v[56:57], v45 offset:1024
    ds_read_b64 v[58:59], v45 offset:1280
    ds_read_b64 v[60:61], v45 offset:1536
    ds_read_b64 v[62:63], v45 offset:1792
    s_waitcnt lgkmcnt(0)
    v_max3_f32 v40, v48, v50, v52
    v_max3_f32 v40, v40, v54, v56
    v_max3_f32 v40, v40, v58, v60
    v_max_f32 v40, v40, v62
    v_mov_b32 v41, v40
    s_nop 1
    v_permlane32_swap_b32 v40, v41
    v_max_f32 v40, v40, v41
    v_sub_f32 v48, v48, v40
    v_sub_f32 v50, v50, v40
    v_sub_f32 v52, v52, v40
    v_sub_f32 v54, v54, v40
    v_sub_f32 v56, v56, v40
    v_sub_f32 v58, v58, v40
    v_sub_f32 v60, v60, v40
    v_sub_f32 v62, v62, v40
    v_exp_f32 v48, v48
    v_exp_f32 v50, v50
    v_exp_f32 v52, v52
    v_exp_f32 v54, v54
    v_exp_f32 v56, v56
    v_exp_f32 v58, v58
    v_exp_f32 v60, v60
    v_exp_f32 v62, v62
    v_mul_f32 v41, v48, v49
    v_fmac_f32 v41, v50, v51
    v_fmac_f32 v41, v52, v53
    v_fmac_f32 v41, v54, v55
    v_fmac_f32 v41, v56, v57
    v_fmac_f32 v41, v58, v59
    v_fmac_f32 v41, v60, v61
    v_fmac_f32 v41, v62, v63
    v_mov_b32 v48, v41
    s_nop 1
    v_permlane32_swap_b32 v41, v48
    v_add_f32 v41, v41, v48
    s_mov_b64 exec, 0xffffffff
    s_cmp_eq_u32 s101, 0
    s_cbranch_scc1 SU_67
    buffer_store_dwordx4 v[40:43], v44, s[36:39], 0 offen
SV_68:
    s_mov_b64 exec, -1
    v_mov_b32 v48, 0x24218
    s_mov_b32 s80, 1600000
LW_69:
    ds_read_b32 v49, v48
    s_waitcnt lgkmcnt(0)
    v_readfirstlane_b32 s79, v49
    s_cmp_ge_u32 s79, 16
    s_cbranch_scc1 LWD_70
    s_sleep 1
    s_sub_u32 s80, s80, 1
    s_cmp_lg_u32 s80, 0
    s_cbranch_scc1 LW_69
LWD_70:
LWO_61:
    s_mov_b32 s66, 3
LL_71:
    s_waitcnt vmcnt(31)
    s_mov_b32 m0, s64
    s_add_u32 s64, s64, 1024
    buffer_load_dwordx4 v10, s[48:51], s65 offen nt lds
    s_add_u32 s65, s65, 8192
    s_waitcnt vmcnt(31)
    s_mov_b32 m0, s64
    s_add_u32 s64, s64, 1024
    buffer_load_dwordx4 v10, s[48:51], s65 offen nt lds
    s_add_u32 s65, s65, 8192
    s_waitcnt vmcnt(31)
    s_mov_b32 m0, s64
    s_add_u32 s64, s64, 1024
    buffer_load_dwordx4 v10, s[48:51], s65 offen nt lds
    s_add_u32 s65, s65, 8192
    s_waitcnt vmcnt(31)
    s_mov_b32 m0, s64
    s_add_u32 s64, s64, 1024
    buffer_load_dwordx4 v10, s[48:51], s65 offen nt lds
    s_add_u32 s65, s65, 8192
    s_waitcnt vmcnt(31)
    s_mov_b32 m0, s64
    s_add_u32 s64, s64, 1024
    buffer_load_dwordx4 v10, s[48:51], s65 offen nt lds
    s_add_u32 s65, s65, 8192
    s_waitcnt vmcnt(31)
    s_mov_b32 m0, s64
    s_add_u32 s64, s64, 1024
    buffer_load_dwordx4 v10, s[48:51], s65 offen nt lds
    s_add_u32 s65, s65, 8192
    s_waitcnt vmcnt(31)
    s_mov_b32 m0, s64
    s_add_u32 s64, s64, 1024
    buffer_load_dwordx4 v10, s[48:51], s65 offen nt lds
    s_add_u32 s65, s65, 8192
    s_waitcnt vmcnt(31)
    s_sub_u32 s7, s60, 24
    s_max_i32 s61, s61, s7
    v_mov_b32 v19, s61
    ds_write_b32 v16, v19
    s_mov_b32 m0, s64
    s_add_u32 s64, s64, 1024
    buffer_load_dwordx4 v10, s[48:51], s65 offen nt lds
    s_add_u32 s65, s65, 8192
    s_waitcnt vmcnt(31)
    s_mov_b32 m0, s64
    s_add_u32 s64, s64, 1024
    buffer_load_dwordx4 v10, s[48:51], s65 offen nt lds
    s_add_u32 s65, s65, 8192
    s_waitcnt vmcnt(31)
    s_mov_b32 m0, s64
    s_add_u32 s64, s64, 1024
    buffer_load_dwordx4 v10, s[48:51], s65 offen nt lds
    s_add_u32 s65, s65, 8192
    s_waitcnt vmcnt(31)
    s_mov_b32 m0, s64
    s_add_u32 s64, s64, 1024
    buffer_load_dwordx4 v10, s[48:51], s65 offen nt lds
    s_add_u32 s65, s65, 8192
    s_waitcnt vmcnt(31)
    s_mov_b32 m0, s64
    s_add_u32 s64, s64, 1024
    buffer_load_dwordx4 v10, s[48:51], s65 offen nt lds
    s_add_u32 s65, s65, 8192
    s_waitcnt vmcnt(31)
    s_mov_b32 m0, s64
    s_add_u32 s64, s64, 1024
    buffer_load_dwordx4 v10, s[48:51], s65 offen nt lds
    s_add_u32 s65, s65, 8192
    s_waitcnt vmcnt(31)
    s_mov_b32 m0, s64
    s_add_u32 s64, s64, 1024
    buffer_load_dwordx4 v10, s[48:51], s65 offen nt lds
    s_add_u32 s65, s65, 8192
    s_waitcnt vmcnt(31)
    s_mov_b32 m0, s64
    s_add_u32 s64, s64, 1024
    buffer_load_dwordx4 v10, s[48:51], s65 offen nt lds
    s_add_u32 s65, s65, 8192
    s_waitcnt vmcnt(31)
    s_sub_u32 s7, s60, 16
    s_max_i32 s61, s61, s7
    v_mov_b32 v19, s61
    ds_write_b32 v16, v19
    s_mov_b32 m0, s64
    s_add_u32 s64, s64, 1024
    buffer_load_dwordx4 v10, s[48:51], s65 offen nt lds
    s_add_u32 s65, s65, 8192
    s_add_u32 s60, s60, 16
    s_add_u32 s65, s65, 917504
    s_cmp_eq_u32 s64, 147456
    s_cselect_b32 s64, 0, s64
    s_sub_u32 s66, s66, 1
    s_cmp_lg_u32 s66, 0
    s_cbranch_scc1 LL_71
    s_waitcnt vmcnt(24)
    s_sub_u32 s7, s60, 24
    s_max_i32 s61, s61, s7
    v_mov_b32 v19, s61
    ds_write_b32 v16, v19
    s_waitcnt vmcnt(16)
    s_sub_u32 s7, s60, 16
    s_max_i32 s61, s61, s7
    v_mov_b32 v19, s61
    ds_write_b32 v16, v19
    s_waitcnt vmcnt(8)
    s_sub_u32 s7, s60, 8
    s_max_i32 s61, s61, s7
    v_mov_b32 v19, s61
    ds_write_b32 v16, v19
    s_waitcnt vmcnt(0)
    s_mov_b32 s61, s60
    v_mov_b32 v19, s61
    ds_write_b32 v16, v19
    s_cmp_eq_u32 s5, 7
    s_cbranch_scc1 L_END
    s_mov_b32 s52, s30
    s_and_b32 s53, s31, 0xffff
    s_mov_b32 s54, 0x2000
    s_mov_b32 s55, 0x20000
    s_mov_b32 s84, 0x3f80
    s_mov_b32 s85, 0x3f800000
    s_lshl_b32 s7, s4, 11
    s_add_u32 s7, s7, 0x2c0000
    v_lshl_add_u32 v36, v1, 4, s7
    s_lshl_b32 s7, s4, 5
    s_add_u32 s7, s7, 1024
    v_and_b32 v38, 3, v1
    v_lshl_add_u32 v37, v38, 3, s7
    v_lshrrev_b32 v38, 2, v3
    v_lshl_add_u32 v37, v38, 11, v37
    v_mov_b32 v38, 0x24214
    s_mov_b32 s80, 1600000
LW_72:
    ds_read_b32 v39, v38
    s_waitcnt lgkmcnt(0)
    v_readfirstlane_b32 s79, v39
    s_cmp_ge_u32 s79, 4
    s_cbranch_scc1 LWD_73
    s_sleep 1
    s_sub_u32 s80, s80, 1
    s_cmp_lg_u32 s80, 0
    s_cbranch_scc1 LW_72
LWD_73:
    s_mov_b64 exec, -1
    buffer_load_dwordx4 v[48:51], v36, s[36:39], 0 offen offset:0 sc1
    buffer_load_dwordx4 v[52:55], v36, s[36:39], 0 offen offset:1024 sc1
    s_mov_b32 s80, 200000
MC_75:
    s_mov_b64 exec, -1
    s_waitcnt vmcnt(0)
    v_cmp_ne_u64 s[62:63], s[92:93], v[50:51]
    v_cmp_ne_u64 s[64:65], s[92:93], v[54:55]
    s_or_b64 s[90:91], s[62:63], s[64:65]
    s_cbranch_scc1 M_74
MD_76:
    s_mov_b64 exec, -1
    v_dot2_f32_bf16 v44, v48, s84, 0
    v_dot2_f32_bf16 v45, v48, s85, 0
    v_dot2_f32_bf16 v46, v49, s84, 0
    v_dot2_f32_bf16 v47, v49, s85, 0
    v_dot2_f32_bf16 v44, v52, s84, v44
    v_dot2_f32_bf16 v45, v52, s85, v45
    v_dot2_f32_bf16 v46, v53, s84, v46
    v_dot2_f32_bf16 v47, v53, s85, v47
    s_nop 1
    v_permlane32_swap_b32 v44, v46
    v_permlane32_swap_b32 v45, v47
    v_add_f32 v44, v44, v46
    v_add_f32 v45, v45, v47
    v_mov_b32 v46, v44
    v_mov_b32 v47, v45
    s_nop 0
    v_permlane16_swap_b32 v44, v46
    v_permlane16_swap_b32 v45, v47
    v_add_f32 v44, v44, v46
    v_add_f32 v45, v45, v47
    v_cvt_pk_bf16_f32 v44, v44, v45
    v_mov_b32 v45, v44
    s_nop 1
    v_permlane32_swap_b32 v44, v45
    s_mov_b64 exec, 0xffff
    buffer_store_dwordx2 v[44:45], v37, s[52:55], 0 offen
    s_mov_b64 exec, -1
    s_endpgm
L_SIDE:
    v_lshlrev_b32 v10, 2, v0
    v_mov_b32 v24, 0
    v_add_u32 v10, 0x23c00, v10
    ds_write_b32 v10, v24
    s_mov_b32 s61, s6
    v_mov_b32 v28, -1
    v_mov_b32 v29, -1
    v_mov_b32 v30, -1
    v_mov_b32 v31, -1
    s_and_b32 s64, s4, 7
    s_lshl_b32 s64, s64, 3
    s_lshr_b32 s7, s4, 3
    s_lshl_b32 s7, s7, 1
    s_add_u32 s64, s64, s7
    s_add_u32 s64, s64, s5
    s_sub_u32 s64, s64, 6
    s_waitcnt lgkmcnt(0)
    s_mov_b32 s40, s32
    s_and_b32 s41, s33, 0xffff
    s_mov_b32 s42, 0x100
    s_mov_b32 s43, 0x20000
    s_or_b32 s7, s6, s2
    s_cbranch_scc1 NC_77
    s_lshl_b64 s[92:93], s[94:95], 5
    s_or_b32 s93, s93, 0x80000000
    v_mov_b32 v12, s92
    v_mov_b32 v13, s93
    s_mov_b64 exec, 1
    buffer_store_dwordx2 v[12:13], v24, s[40:43], 0 offen sc1
    s_mov_b64 exec, -1
NC_77:
    s_mov_b32 s36, s34
    s_and_b32 s37, s35, 0xffff
    s_mov_b32 s38, 0x1000000
    s_mov_b32 s39, 0x20000
    s_cmp_lt_u32 s5, 4
    s_cbranch_scc1 NB_79
    s_cmp_ge_u32 s5, 6
    s_cbranch_scc1 NQ_78
    s_cmp_lg_u32 s6, 2
    s_cbranch_scc1 NB_79
    s_lshl_b32 s7, s4, 1
    s_add_u32 s7, s7, s5
    s_lshl_b32 s7, s7, 9
    s_sub_u32 s7, s7, 2048
    v_lshl_add_u32 v10, v3, 4, s7
    v_lshl_add_u32 v10, v2, 15, v10
    buffer_store_dwordx4 v[28:31], v10, s[36:39], 0 offen sc1
    buffer_store_dwordx4 v[28:31], v10, s[36:39], 0 offen offset:256 sc1
    s_branch NB_79
NQ_78:
    s_lshl_b32 s65, s64, 2
    s_add_u32 s65, s65, s6
    s_and_b32 s7, s65, 31
    s_lshl_b32 s7, s7, 13
    s_lshr_b32 s62, s64, 3
    s_lshl_b32 s62, s62, 10
    s_add_u32 s7, s7, s62
    s_add_u32 s7, s7, 0x200000
    v_lshl_add_u32 v10, v1, 4, s7
    buffer_store_dwordx4 v[28:31], v10, s[36:39], 0 offen sc1
    s_lshl_b32 s7, s65, 10
    s_add_u32 s7, s7, 0x280000
    v_lshl_add_u32 v10, v1, 7, s7
    s_lshl_b32 s62, s65, 8
    s_add_u32 s7, s62, 0x2c0000
    v_writelane_b32 v10, s7, 8
    s_add_u32 s7, s62, 0x2c0080
    v_writelane_b32 v10, s7, 9
    s_add_u32 s7, s62, 0xc0000
    v_writelane_b32 v10, s7, 10
    s_add_u32 s7, s62, 0xc0080
    v_writelane_b32 v10, s7, 11
    s_lshl_b32 s7, s65, 7
    s_add_u32 s7, s7, 0x28000
    v_writelane_b32 v10, s7, 12
    s_lshl_b32 s7, s65, 4
    s_add_u32 s7, s7, 0x23000
    v_writelane_b32 v10, s7, 13
    s_mov_b64 exec, 0x3fff
    buffer_load_dword v15, v10, s[36:39], 0 offen sc1
    s_mov_b64 exec, -1
NB_79:
    s_barrier
    s_cmp_lg_u32 s6, 0
    s_cbranch_scc1 NF_81
    s_mov_b32 s80, 800000
    s_sleep 4
NL_83:
    s_mov_b64 exec, 1
    buffer_load_dwordx2 v[12:13], v24, s[40:43], 0 offen sc1
    s_mov_b64 exec, -1
    s_waitcnt vmcnt(0)
    v_readfirstlane_b32 s92, v12
    v_readfirstlane_b32 s93, v13
    s_sub_u32 s80, s80, 1
    s_cbranch_scc1 NH_84
    s_cmp_eq_u32 s93, 0
    s_cbranch_scc1 NL_83
NH_84:
    v_mov_b32 v11, 0x24248
    v_mov_b32 v12, s92
    v_mov_b32 v13, s93
    ds_write_b64 v11, v[12:13]
    v_mov_b32 v11, 0x24204
    v_mov_b32 v14, 1
    s_mov_b64 exec, 1
    ds_add_u32 v11, v14
    s_mov_b64 exec, -1
NF_81:
    s_cmp_lg_u32 s6, 1
    s_cbranch_scc1 NP_80
    s_lshl_b32 s65, s4, 7
    s_add_u32 s65, s65, 0x21000
    s_lshr_b32 s7, s64, 3
    s_lshl_b32 s7, s7, 7
    s_add_u32 s7, s7, 0x22000
    s_and_b32 s62, s64, 7
    s_cmp_lt_u32 s5, 6
    s_cselect_b32 s7, s65, s7
    s_cselect_b32 s62, s5, s62
    v_lshl_add_u32 v11, v1, 3, s7
    s_sleep 12
    s_memrealtime s[88:89]
    s_waitcnt lgkmcnt(0)
    s_or_b32 s89, s89, s78
    v_mov_b32 v12, s88
    v_mov_b32 v13, s89
    s_lshl_b64 exec, 1, s62
    buffer_store_dwordx2 v[12:13], v11, s[36:39], 0 offen
    s_mov_b64 exec, -1
    s_cmp_ge_u32 s5, 6
    s_cbranch_scc1 NP_80
    s_sleep 24
    s_or_b32 s95, s95, s78
    s_add_u32 s88, s94, 0x10000
    s_addc_u32 s89, s95, 0
    s_mov_b32 s101, 16
    s_mov_b64 exec, 0x3f
U_85:
    buffer_load_dwordx2 v[14:15], v11, s[36:39], 0 offen sc1 nt
UU_86:
    s_waitcnt vmcnt(0)
    v_cmp_gt_u64 s[90:91], s[94:95], v[14:15]
    v_cmp_le_u64 vcc, s[88:89], v[14:15]
    s_or_b64 vcc, vcc, s[90:91]
    s_cbranch_scc0 UD_87
    s_sleep 8
    s_sub_u32 s101, s101, 1
    s_cmp_lg_u32 s101, 0
    s_cbranch_scc1 U_85
UD_87:
    s_mov_b64 exec, -1
    s_min_u32 s7, s101, 1
    s_add_u32 s7, s7, 16
    v_mov_b32 v12, 0x24200
    v_mov_b32 v13, s7
    s_mov_b64 exec, 1
    ds_add_u32 v12, v13
    s_mov_b64 exec, -1
NP_80:
    s_cmp_ge_u32 s5, 6
    s_cbranch_scc1 L_BATT
    s_cmp_lt_u32 s5, 4
    s_cbranch_scc1 NG_82
    s_cmp_lg_u32 s6, 2
    s_cbranch_scc1 NG_82
    s_lshl_b32 s7, s4, 4
    s_add_u32 s7, s7, s5
    s_lshl_b32 s7, s7, 3
    s_add_u32 s7, s7, 0x1ffe0
    v_mov_b32 v11, s7
    s_waitcnt vmcnt(0)
    v_mov_b32 v12, 0x24208
    v_mov_b32 v13, 16
    s_mov_b64 exec, 1
    ds_add_u32 v12, v13
    s_mov_b64 exec, -1
    v_mov_b32 v16, 0x24204
    s_mov_b32 s80, 1600000
LW_88:
    ds_read_b32 v17, v16
    s_waitcnt lgkmcnt(0)
    v_readfirstlane_b32 s79, v17
    s_cmp_ge_u32 s79, 1
    s_cbranch_scc1 LWD_89
    s_sleep 1
    s_sub_u32 s80, s80, 1
    s_cmp_lg_u32 s80, 0
    s_cbranch_scc1 LW_88
LWD_89:
    v_mov_b32 v16, 0x24248
    ds_read_b64 v[18:19], v16
    s_waitcnt lgkmcnt(0)
    v_readfirstlane_b32 s92, v18
    v_readfirstlane_b32 s93, v19
    s_mov_b64 exec, 1
    buffer_store_dwordx2 v[18:19], v11, s[36:39], 0 offen sc1
    s_mov_b64 exec, -1
NG_82:
    s_mov_b32 s96, 0x6010600
    s_mov_b32 s97, 0x5030602
    s_cmp_eq_u32 s5, 1
    s_cselect_b32 s96, 0x6190618, s96
    s_cselect_b32 s97, 0x51a0617, s97
    s_cmp_eq_u32 s5, 2
    s_cselect_b32 s96, 0x62e0630, s96
    s_cselect_b32 s97, 0x531062f, s97
    s_cmp_eq_u32 s5, 3
    s_cselect_b32 s96, 0x6460645, s96
    s_cselect_b32 s97, 0x5480647, s97
    s_cmp_eq_u32 s5, 4
    s_cselect_b32 s96, 0x55d055c, s96
    s_cselect_b32 s97, 0x45f045e, s97
    s_cmp_eq_u32 s5, 5
    s_cselect_b32 s96, 0x56f056e, s96
    s_cselect_b32 s97, 0x4710470, s97
    s_lshl_b32 s7, s61, 4
    s_lshr_b64 s[90:91], s[96:97], s7
    s_and_b32 s66, s90, 3
    s_bfe_u32 s67, s90, 0x50002
    s_bfe_u32 s68, s90, 0x40008
    s_lshl_b32 s7, s4, 15
    s_lshl_b32 s63, s66, 9
    s_add_u32 s7, s7, s63
    s_add_u32 s7, s7, 0x100000
    v_and_b32 v20, 31, v1
    v_lshl_add_u32 v7, v20, 4, s7
    v_lshrrev_b32 v21, 5, v1
    v_lshl_add_u32 v7, v21, 11, v7
    v_add_u32 v22, 4096, v7
    s_mul_i32 s7, s66, 320
    s_add_u32 s63, s7, 0x24400
    v_lshl_add_u32 v6, v20, 3, s63
    v_lshl_add_u32 v6, v21, 2, v6
    s_mov_b32 s70, 0x3f80
    s_mov_b32 s71, 0x3f800000
    v_mov_b32 v12, 0x24200
    s_mov_b32 s80, 1600000
LW_90:
    ds_read_b32 v13, v12
    s_waitcnt lgkmcnt(0)
    v_readfirstlane_b32 s79, v13
    s_cmp_ge_u32 s79, 16
    s_cbranch_scc1 LWD_91
    s_sleep 4
    s_sub_u32 s80, s80, 1
    s_cmp_lg_u32 s80, 0
    s_cbranch_scc1 LW_90
LWD_91:
    s_and_b32 s101, s79, 15
    v_mov_b32 v16, 0x24204
    s_mov_b32 s80, 1600000
LW_92:
    ds_read_b32 v17, v16
    s_waitcnt lgkmcnt(0)
    v_readfirstlane_b32 s79, v17
    s_cmp_ge_u32 s79, 1
    s_cbranch_scc1 LWD_93
    s_sleep 1
    s_sub_u32 s80, s80, 1
    s_cmp_lg_u32 s80, 0
    s_cbranch_scc1 LW_92
LWD_93:
    v_mov_b32 v16, 0x24248
    ds_read_b64 v[18:19], v16
    s_waitcnt lgkmcnt(0)
    v_readfirstlane_b32 s92, v18
    v_readfirstlane_b32 s93, v19
    s_sleep 16
    s_mov_b64 exec, -1
    buffer_load_dwordx4 v[48:51], v7, s[36:39], 0 offen sc1 nt
    buffer_load_dwordx4 v[52:55], v22, s[36:39], 0 offen sc1 nt
    s_mov_b32 s80, 200000
MC_95:
    s_mov_b64 exec, -1
    s_waitcnt vmcnt(0)
    v_cmp_ne_u64 s[44:45], s[92:93], v[50:51]
    v_cmp_ne_u64 s[46:47], s[92:93], v[54:55]
    s_or_b64 s[90:91], s[44:45], s[46:47]
    s_cbranch_scc1 M_94
MD_96:
    s_mov_b64 exec, -1
    v_dot2_f32_bf16 v24, v48, s70, 0
    v_dot2_f32_bf16 v25, v48, s71, 0
    v_dot2_f32_bf16 v26, v49, s70, 0
    v_dot2_f32_bf16 v27, v49, s71, 0
    v_dot2_f32_bf16 v24, v52, s70, v24
    v_dot2_f32_bf16 v25, v52, s71, v25
    v_dot2_f32_bf16 v26, v53, s70, v26
    v_dot2_f32_bf16 v27, v53, s71, v27
    s_nop 1
    v_permlane32_swap_b32 v24, v26
    v_permlane32_swap_b32 v25, v27
    v_add_f32 v24, v24, v26
    v_add_f32 v25, v25, v27
    v_cvt_pk_bf16_f32 v24, v24, v25
    ds_write_b32 v6, v24
L_AATT:
    v_lshl_add_u32 v8, v2, 4, s63
    s_waitcnt lgkmcnt(0)
    ds_read_b128 v[16:19], v8 offset:0
    ds_read_b128 v[20:23], v8 offset:64
    ds_read_b128 v[24:27], v8 offset:128
    ds_read_b128 v[28:31], v8 offset:192
    v_xor_b32 v4, v3, v2
    v_lshlrev_b32 v4, 4, v4
    v_lshl_add_u32 v4, v3, 8, v4
    v_lshrrev_b32 v9, 2, v1
    v_and_b32 v5, 7, v9
    v_lshlrev_b32 v5, 5, v5
    v_lshl_add_u32 v5, v9, 8, v5
    v_and_b32 v10, 3, v1
    v_lshl_add_u32 v5, v10, 3, v5
    s_lshl_b32 s7, s61, 10
    s_add_u32 s7, s7, 0x24e00
    v_lshl_add_u32 v6, v2, 4, s7
    v_cmp_eq_u32 s[84:85], 0, v3
    s_mov_b32 s72, 0x3e0293ee
    s_cmp_ge_u32 s5, 4
    s_cselect_b32 s73, 8, 9
    s_cselect_b32 s69, 8, 4
    s_cselect_b32 s70, 17, 5
    s_cselect_b32 s74, 18, 23
    s_add_u32 s70, s70, s61
    s_add_u32 s74, s74, s70
    s_lshl_b32 s70, s70, 3
    s_add_u32 s69, s69, s61
    s_cmp_ge_u32 s69, 18
    s_cselect_b32 s7, 18, 0
    s_sub_u32 s69, s69, s7
    s_mov_b32 s71, s68
AK_97:
    s_lshl_b32 s7, s69, 13
    v_add_u32 v104, s7, v4
    v_xor_b32 v105, 0x40, v104
    v_xor_b32 v106, 0x80, v104
    v_xor_b32 v107, 0xc0, v104
    s_lshl_b32 s62, s69, 2
    s_add_u32 s62, s62, 0x24100
    v_mov_b32 v8, 0x24000
    s_mov_b32 s80, 1600000
LW_98:
    ds_read_b32 v9, v8
    s_waitcnt lgkmcnt(0)
    v_readfirstlane_b32 s79, v9
    s_cmp_ge_u32 s79, s70
    s_cbranch_scc1 LWD_99
    s_sleep 2
    s_sub_u32 s80, s80, 1
    s_cmp_lg_u32 s80, 0
    s_cbranch_scc1 LW_98
LWD_99:
    ds_read_b128 v[32:35], v104 offset:0
    ds_read_b128 v[36:39], v104 offset:4096
    ds_read_b128 v[40:43], v105 offset:0
    ds_read_b128 v[44:47], v105 offset:4096
    ds_read_b128 v[48:51], v106 offset:0
    ds_read_b128 v[52:55], v106 offset:4096
    ds_read_b128 v[56:59], v107 offset:0
    ds_read_b128 v[60:63], v107 offset:4096
    s_waitcnt lgkmcnt(6)
    v_mfma_f32_16x16x32_bf16 v[64:67], v[32:35], v[16:19], 0
    v_mfma_f32_16x16x32_bf16 v[68:71], v[36:39], v[16:19], 0
    s_waitcnt lgkmcnt(4)
    v_mfma_f32_16x16x32_bf16 v[64:67], v[40:43], v[20:23], v[64:67]
    v_mfma_f32_16x16x32_bf16 v[68:71], v[44:47], v[20:23], v[68:71]
    s_waitcnt lgkmcnt(2)
    v_mfma_f32_16x16x32_bf16 v[64:67], v[48:51], v[24:27], v[64:67]
    v_mfma_f32_16x16x32_bf16 v[68:71], v[52:55], v[24:27], v[68:71]
    s_waitcnt lgkmcnt(0)
    v_mfma_f32_16x16x32_bf16 v[64:67], v[56:59], v[28:31], v[64:67]
    v_mfma_f32_16x16x32_bf16 v[68:71], v[60:63], v[28:31], v[68:71]
    v_mov_b32 v8, s62
    v_mov_b32 v9, 4
    s_mov_b64 exec, 1
    ds_add_u32 v8, v9
    s_mov_b64 exec, -1
    s_mov_b64 exec, s[84:85]
    s_nop 0
    ds_write_b128 v6, v[64:67] offset:0
    ds_write_b128 v6, v[68:71] offset:64
    s_mov_b64 exec, -1
    v_add_u32 v6, 128, v6
    s_add_u32 s69, s69, 4
    s_cmp_ge_u32 s69, 18
    s_cselect_b32 s7, 18, 0
    s_sub_u32 s69, s69, s7
    s_add_u32 s70, s70, 32
    s_sub_u32 s71, s71, 1
    s_cmp_lg_u32 s71, 0
    s_cbranch_scc1 AK_97
    v_lshrrev_b32 v8, 2, v1
    v_cmp_gt_u32 s[86:87], s68, v8
    v_and_b32 v8, 7, v8
    v_and_b32 v9, 3, v1
    v_lshlrev_b32 v9, 4, v9
    v_lshl_add_u32 v10, v8, 7, v9
    s_lshl_b32 s7, s61, 10
    s_add_u32 s7, s7, 0x24e00
    v_add_u32 v10, s7, v10
    s_waitcnt lgkmcnt(0)
    ds_read_b128 v[32:35], v10
    ds_read_b128 v[36:39], v10 offset:64
    s_lshl_b32 s7, s61, 9
    s_add_u32 s7, s7, 0x25e00
    v_lshl_add_u32 v10, v8, 6, v9
    v_add_u32 v10, s7, v10
    v_lshl_add_u32 v7, v2, 4, s7
    v_mov_b32 v11, 0xff800000
    s_waitcnt lgkmcnt(0)
    v_cndmask_b32 v32, v11, v32, s[86:87]
    v_cndmask_b32 v33, v11, v33, s[86:87]
    v_cndmask_b32 v34, v11, v34, s[86:87]
    v_cndmask_b32 v35, v11, v35, s[86:87]
    v_cndmask_b32 v36, v11, v36, s[86:87]
    v_cndmask_b32 v37, v11, v37, s[86:87]
    v_cndmask_b32 v38, v11, v38, s[86:87]
    v_cndmask_b32 v39, v11, v39, s[86:87]
    v_max3_f32 v64, v32, v33, v34
    v_max3_f32 v64, v64, v35, v36
    v_max3_f32 v64, v64, v37, v38
    v_max_f32 v64, v64, v39
    s_nop 1
    v_max_f32_dpp v64, v64, v64 row_ror:1 row_mask:0xf bank_mask:0xf
    s_nop 1
    v_max_f32_dpp v64, v64, v64 row_ror:2 row_mask:0xf bank_mask:0xf
    s_nop 1
    v_max_f32_dpp v64, v64, v64 row_ror:4 row_mask:0xf bank_mask:0xf
    s_nop 1
    v_max_f32_dpp v64, v64, v64 row_ror:8 row_mask:0xf bank_mask:0xf
    v_mov_b32 v11, v64
    s_nop 1
    v_permlane32_swap_b32 v64, v11
    v_max_f32 v64, v64, v11
    v_mov_b32 v11, v64
    s_nop 1
    v_permlane16_swap_b32 v64, v11
    v_max_f32 v64, v64, v11
    v_mul_f32 v64, s72, v64
    v_fma_f32 v32, v32, s72, -v64
    v_fma_f32 v33, v33, s72, -v64
    v_fma_f32 v34, v34, s72, -v64
    v_fma_f32 v35, v35, s72, -v64
    v_fma_f32 v36, v36, s72, -v64
    v_fma_f32 v37, v37, s72, -v64
    v_fma_f32 v38, v38, s72, -v64
    v_fma_f32 v39, v39, s72, -v64
    v_exp_f32 v32, v32
    v_exp_f32 v33, v33
    v_exp_f32 v34, v34
    v_exp_f32 v35, v35
    v_exp_f32 v36, v36
    v_exp_f32 v37, v37
    v_exp_f32 v38, v38
    v_exp_f32 v39, v39
    v_cvt_pk_bf16_f32 v112, v32, v33
    v_cvt_pk_bf16_f32 v113, v34, v35
    v_cvt_pk_bf16_f32 v114, v36, v37
    v_cvt_pk_bf16_f32 v115, v38, v39
    s_mov_b64 exec, s[86:87]
    ds_write_b128 v10, v[112:115]
    s_mov_b64 exec, -1
    v_add_f32 v32, v32, v36
    v_add_f32 v33, v33, v37
    v_add_f32 v34, v34, v38
    v_add_f32 v35, v35, v39
    v_add_f32 v32, v32, v34
    v_add_f32 v33, v33, v35
    v_add_f32 v32, v32, v33
    v_mov_b32 v65, v32
    s_nop 1
    v_add_f32_dpp v65, v65, v65 row_ror:1 row_mask:0xf bank_mask:0xf
    s_nop 1
    v_add_f32_dpp v65, v65, v65 row_ror:2 row_mask:0xf bank_mask:0xf
    s_nop 1
    v_add_f32_dpp v65, v65, v65 row_ror:4 row_mask:0xf bank_mask:0xf
    s_nop 1
    v_add_f32_dpp v65, v65, v65 row_ror:8 row_mask:0xf bank_mask:0xf
    v_mov_b32 v11, v65
    s_nop 1
    v_permlane32_swap_b32 v65, v11
    v_add_f32 v65, v65, v11
    v_mov_b32 v11, v65
    s_nop 1
    v_permlane16_swap_b32 v65, v11
    v_add_f32 v65, v65, v11
    v_mov_b32 v8, 0x24204
    s_mov_b32 s80, 1600000
LW_100:
    ds_read_b32 v9, v8
    s_waitcnt lgkmcnt(0)
    v_readfirstlane_b32 s79, v9
    s_cmp_ge_u32 s79, 1
    s_cbranch_scc1 LWD_101
    s_sleep 1
    s_sub_u32 s80, s80, 1
    s_cmp_lg_u32 s80, 0
    s_cbranch_scc1 LW_100
LWD_101:
    v_mov_b32 v8, 0x24248
    ds_read_b64 v[10:11], v8
    s_waitcnt lgkmcnt(0)
    v_readfirstlane_b32 s92, v10
    v_readfirstlane_b32 s93, v11
    s_nop 0
    v_mov_b32 v66, s92
    v_mov_b32 v67, s93
    s_lshl_b32 s7, s4, 2
    s_add_u32 s7, s7, s66
    s_lshl_b32 s7, s7, 3
    s_add_u32 s7, s7, s5
    s_lshl_b32 s7, s7, 4
    s_add_u32 s7, s7, 0x24000
    v_mov_b32 v8, s7
    s_mov_b64 exec, 1
    s_cmp_eq_u32 s101, 0
    s_cbranch_scc1 SU_102
    buffer_store_dwordx4 v[64:67], v8, s[36:39], 0 offen
SV_103:
    s_mov_b64 exec, -1
    s_and_b32 s7, s7, -128
    v_lshl_add_u32 v12, v1, 4, s7
    v_or_b32 v70, 1, v66
    v_mov_b32 v71, v67
    v_mov_b32 v116, 0xff800000
    v_mov_b32 v117, 0
    v_mov_b32 v72, 0
    v_mov_b32 v73, 0
    v_mov_b32 v74, 0
    v_mov_b32 v75, 0
    v_mov_b32 v76, 0
    v_mov_b32 v77, 0
    v_mov_b32 v78, 0
    v_mov_b32 v79, 0
    v_mov_b32 v80, 0
    v_mov_b32 v81, 0
    v_mov_b32 v82, 0
    v_mov_b32 v83, 0
    v_mov_b32 v84, 0
    v_mov_b32 v85, 0
    v_mov_b32 v86, 0
    v_mov_b32 v87, 0
    v_mov_b32 v88, 0
    v_mov_b32 v89, 0
    v_mov_b32 v90, 0
    v_mov_b32 v91, 0
    v_mov_b32 v92, 0
    v_mov_b32 v93, 0
    v_mov_b32 v94, 0
    v_mov_b32 v95, 0
    v_mov_b32 v96, 0
    v_mov_b32 v97, 0
    v_mov_b32 v98, 0
    v_mov_b32 v99, 0
    v_mov_b32 v100, 0
    v_mov_b32 v101, 0
    v_mov_b32 v102, 0
    v_mov_b32 v103, 0
    s_lshl_b32 s7, s4, 4
    s_add_u32 s7, s7, s5
    s_lshl_b32 s7, s7, 2
    s_add_u32 s7, s7, s66
    s_lshl_b32 s7, s7, 9
    s_add_u32 s7, s7, 0x100000
    v_lshl_add_u32 v6, v1, 4, s7
    s_cmp_lt_u32 s5, 4
    s_cbranch_scc1 AE_104
    v_mov_b32 v13, 0
    s_mov_b64 exec, 0x01010101
    buffer_store_dword v13, v6, s[36:39], 0 offen
    buffer_load_dword v13, v6, s[36:39], 0 offen sc1 nt
    s_mov_b64 exec, -1
AE_104:
    s_add_u32 s69, s73, s61
    s_lshl_b32 s70, s74, 3
    s_cmp_ge_u32 s69, 18
    s_cselect_b32 s7, 18, 0
    s_sub_u32 s69, s69, s7
    s_mov_b32 s71, s68
AV_105:
    s_lshl_b32 s7, s69, 13
    v_add_u32 v104, s7, v5
    v_xor_b32 v105, 0x20, v104
    v_xor_b32 v106, 0x40, v104
    v_xor_b32 v107, 0x60, v104
    v_xor_b32 v108, 0x80, v104
    v_xor_b32 v109, 0xa0, v104
    v_xor_b32 v110, 0xc0, v104
    v_xor_b32 v111, 0xe0, v104
    s_lshl_b32 s62, s69, 2
    s_add_u32 s62, s62, 0x24100
    ds_read_b128 v[112:115], v7
    v_add_u32 v7, 64, v7
    s_cmp_le_u32 s71, 2
    s_cbranch_scc1 AW_106
AWB_107:
    v_mov_b32 v8, 0x24000
    s_mov_b32 s80, 1600000
LW_108:
    ds_read_b32 v9, v8
    s_waitcnt lgkmcnt(0)
    v_readfirstlane_b32 s79, v9
    s_cmp_ge_u32 s79, s70
    s_cbranch_scc1 LWD_109
    s_sleep 1
    s_sub_u32 s80, s80, 1
    s_cmp_lg_u32 s80, 0
    s_cbranch_scc1 LW_108
LWD_109:
    ds_read_b64_tr_b16 v[32:33], v104
    ds_read_b64_tr_b16 v[34:35], v104 offset:4096
    ds_read_b64_tr_b16 v[36:37], v105
    ds_read_b64_tr_b16 v[38:39], v105 offset:4096
    ds_read_b64_tr_b16 v[40:41], v106
    ds_read_b64_tr_b16 v[42:43], v106 offset:4096
    ds_read_b64_tr_b16 v[44:45], v107
    ds_read_b64_tr_b16 v[46:47], v107 offset:4096
    ds_read_b64_tr_b16 v[48:49], v108
    ds_read_b64_tr_b16 v[50:51], v108 offset:4096
    ds_read_b64_tr_b16 v[52:53], v109
    ds_read_b64_tr_b16 v[54:55], v109 offset:4096
    ds_read_b64_tr_b16 v[56:57], v110
    ds_read_b64_tr_b16 v[58:59], v110 offset:4096
    s_waitcnt lgkmcnt(12)
    v_mfma_f32_16x16x32_bf16 v[72:75], v[112:115], v[32:35], v[72:75]
    ds_read_b64_tr_b16 v[60:61], v111
    ds_read_b64_tr_b16 v[62:63], v111 offset:4096
    s_waitcnt lgkmcnt(12)
    v_mfma_f32_16x16x32_bf16 v[76:79], v[112:115], v[36:39], v[76:79]
    s_waitcnt lgkmcnt(10)
    v_mfma_f32_16x16x32_bf16 v[80:83], v[112:115], v[40:43], v[80:83]
    s_waitcnt lgkmcnt(8)
    v_mfma_f32_16x16x32_bf16 v[84:87], v[112:115], v[44:47], v[84:87]
    s_waitcnt lgkmcnt(6)
    v_mfma_f32_16x16x32_bf16 v[88:91], v[112:115], v[48:51], v[88:91]
    s_waitcnt lgkmcnt(4)
    v_mfma_f32_16x16x32_bf16 v[92:95], v[112:115], v[52:55], v[92:95]
    s_waitcnt lgkmcnt(2)
    v_mfma_f32_16x16x32_bf16 v[96:99], v[112:115], v[56:59], v[96:99]
    s_waitcnt lgkmcnt(0)
    v_mfma_f32_16x16x32_bf16 v[100:103], v[112:115], v[60:63], v[100:103]
    v_mov_b32 v8, s62
    v_mov_b32 v9, 4
    s_mov_b64 exec, 1
    ds_add_u32 v8, v9
    s_mov_b64 exec, -1
    s_add_u32 s69, s69, 4
    s_cmp_ge_u32 s69, 18
    s_cselect_b32 s7, 18, 0
    s_sub_u32 s69, s69, s7
    s_add_u32 s70, s70, 32
    s_sub_u32 s71, s71, 1
    s_cmp_lg_u32 s71, 0
    s_cbranch_scc1 AV_105
    v_mov_b32_dpp v72, v88 quad_perm:[0,1,2,3] row_mask:0x2 bank_mask:0xf
    v_mov_b32_dpp v76, v92 quad_perm:[0,1,2,3] row_mask:0x2 bank_mask:0xf
    v_mov_b32_dpp v80, v96 quad_perm:[0,1,2,3] row_mask:0x2 bank_mask:0xf
    v_mov_b32_dpp v84, v100 quad_perm:[0,1,2,3] row_mask:0x2 bank_mask:0xf
    v_mul_f32 v72, s72, v72
    v_mul_f32 v76, s72, v76
    v_mul_f32 v80, s72, v80
    v_mul_f32 v84, s72, v84
    v_cvt_pk_bf16_f32 v68, v72, v76
    v_cvt_pk_bf16_f32 v69, v80, v84
    s_mov_b64 exec, 0xffffffff
    s_cmp_eq_u32 s101, 0
    s_cbranch_scc1 SU_110
    buffer_store_dwordx4 v[68:71], v6, s[36:39], 0 offen
SV_111:
    s_mov_b64 exec, -1
    v_mov_b32 v8, 0x24214
    v_mov_b32 v9, 1
    s_mov_b64 exec, 1
    ds_add_u32 v8, v9
    s_mov_b64 exec, -1
    s_endpgm
L_ASVC:
    v_bfe_u32 v24, v1, 2, 2
    v_lshl_add_u32 v4, v24, 4, v2
    v_lshlrev_b32 v4, 8, v4
    v_and_b32 v25, 1, v2
    v_lshl_or_b32 v24, v24, 1, v25
    s_lshl_b32 s7, s61, 1
    v_xor_b32 v24, s7, v24
    v_lshl_add_u32 v4, v24, 5, v4
    v_and_b32 v24, 3, v1
    v_lshl_add_u32 v4, v24, 3, v4
    v_mov_b32 v28, 0x24000
    s_mov_b32 s80, 1600000
LW_112:
    ds_read_b32 v29, v28
    s_waitcnt lgkmcnt(0)
    v_readfirstlane_b32 s79, v29
    s_cmp_ge_u32 s79, 32
    s_cbranch_scc1 LWD_113
    s_sleep 4
    s_sub_u32 s80, s80, 1
    s_cmp_lg_u32 s80, 0
    s_cbranch_scc1 LW_112
LWD_113:
    v_xor_b32 v28, 0, v4
    ds_read_b64_tr_b16 v[32:33], v28 offset:0
    ds_read_b64_tr_b16 v[34:35], v28 offset:16384
    ds_read_b64_tr_b16 v[36:37], v28 offset:1024
    ds_read_b64_tr_b16 v[38:39], v28 offset:17408
    ds_read_b64_tr_b16 v[40:41], v28 offset:2048
    ds_read_b64_tr_b16 v[42:43], v28 offset:18432
    ds_read_b64_tr_b16 v[44:45], v28 offset:3072
    ds_read_b64_tr_b16 v[46:47], v28 offset:19456
    v_xor_b32 v28, 32, v4
    ds_read_b64_tr_b16 v[48:49], v28 offset:0
    ds_read_b64_tr_b16 v[50:51], v28 offset:16384
    ds_read_b64_tr_b16 v[52:53], v28 offset:1024
    ds_read_b64_tr_b16 v[54:55], v28 offset:17408
    ds_read_b64_tr_b16 v[56:57], v28 offset:2048
    ds_read_b64_tr_b16 v[58:59], v28 offset:18432
    ds_read_b64_tr_b16 v[60:61], v28 offset:3072
    ds_read_b64_tr_b16 v[62:63], v28 offset:19456
    v_lshlrev_b32 v28, 2, v1
    v_add_u32 v28, 0x24100, v28
    v_mov_b32 v29, 1
    s_mov_b64 exec, 15
    ds_add_u32 v28, v29
    s_mov_b64 exec, -1
    v_and_b32 v25, 4, v1
    v_lshlrev_b32 v26, 2, v1
    v_mov_b32 v27, 0
    v_add_u32 v26, 0x27e00, v26
    ds_write_b32 v26, v27
    v_lshlrev_b32 v8, 16, v24
    v_lshl_add_u32 v8, v25, 4, v8
    v_lshl_add_u32 v8, v2, 4, v8
    s_lshl_b32 s7, s5, 2
    s_add_u32 s7, s7, s61
    s_lshl_b32 s7, s7, 5
    s_add_u32 s7, s7, s4
    s_lshl_b32 s7, s7, 7
    s_add_u32 s7, s7, 0x280000
    v_add_u32 v8, s7, v8
    v_cmp_gt_u32 s[84:85], 8, v3
    s_lshl_b32 s7, s4, 15
    s_lshl_b32 s62, s61, 10
    s_add_u32 s7, s7, s62
    s_add_u32 s7, s7, 0x100000
    v_lshl_add_u32 v5, v1, 4, s7
    v_lshrrev_b32 v24, 5, v1
    s_lshl_b32 s7, s61, 1
    v_add_u32 v24, s7, v24
    v_xor_b32 v6, v24, v3
    v_lshlrev_b32 v6, 4, v6
    v_lshl_add_u32 v6, v24, 8, v6
    v_and_b32 v24, 1, v2
    v_lshl_add_u32 v6, v24, 3, v6
    v_add_u32 v6, 0x26600, v6
    v_xor_b32 v7, 0x80, v6
    v_xor_b32 v12, v3, v2
    v_lshlrev_b32 v12, 4, v12
    v_lshl_add_u32 v12, v3, 8, v12
    v_add_u32 v12, 0x26600, v12
    v_min_u32 v24, 8, v3
    v_xor_b32 v124, v24, v2
    v_lshlrev_b32 v124, 4, v124
    v_lshl_add_u32 v124, v24, 8, v124
    v_add_u32 v124, 0x27600, v124
    v_xor_b32 v13, 64, v12
    v_xor_b32 v125, 64, v124
    v_xor_b32 v14, 128, v12
    v_xor_b32 v126, 128, v124
    v_xor_b32 v15, 192, v12
    v_xor_b32 v127, 192, v124
    v_mov_b32 v28, 0x24204
    s_mov_b32 s80, 1600000
LW_114:
    ds_read_b32 v29, v28
    s_waitcnt lgkmcnt(0)
    v_readfirstlane_b32 s79, v29
    s_cmp_ge_u32 s79, 1
    s_cbranch_scc1 LWD_115
    s_sleep 1
    s_sub_u32 s80, s80, 1
    s_cmp_lg_u32 s80, 0
    s_cbranch_scc1 LW_114
LWD_115:
    v_mov_b32 v28, 0x24248
    ds_read_b64 v[30:31], v28
    s_waitcnt lgkmcnt(0)
    v_readfirstlane_b32 s92, v30
    v_readfirstlane_b32 s93, v31
    s_or_b64 s[94:95], s[92:93], 1
    v_mov_b32 v18, s92
    v_mov_b32 v19, s93
    s_mov_b32 s62, 4096
    s_mov_b32 s63, 8192
    v_mov_b32 v28, 0x24214
    s_mov_b32 s80, 1600000
LW_116:
    ds_read_b32 v29, v28
    s_waitcnt lgkmcnt(0)
    v_readfirstlane_b32 s79, v29
    s_cmp_ge_u32 s79, 4
    s_cbranch_scc1 LWD_117
    s_sleep 2
    s_sub_u32 s80, s80, 1
    s_cmp_lg_u32 s80, 0
    s_cbranch_scc1 LW_116
LWD_117:
    s_setprio 2
    s_mov_b64 exec, -1
    buffer_load_dwordx4 v[112:115], v5, s[36:39], 0 offen sc1 nt
    buffer_load_dwordx4 v[116:119], v5, s[36:39], s62 offen sc1 nt
    buffer_load_dwordx4 v[120:123], v5, s[36:39], s63 offen sc1 nt
    s_mov_b32 s80, 200000
MC_119:
    s_mov_b64 exec, -1
    s_waitcnt vmcnt(0)
    v_cmp_ne_u64 s[64:65], s[94:95], v[114:115]
    v_cmp_ne_u64 s[66:67], s[94:95], v[118:119]
    v_cmp_ne_u64 s[68:69], s[94:95], v[122:123]
    s_or_b64 s[90:91], s[64:65], s[66:67]
    s_or_b64 s[90:91], s[90:91], s[68:69]
    s_cbranch_scc1 M_118
MD_120:
    s_mov_b64 exec, -1
    ds_write_b64 v6, v[112:113]
    ds_write_b64 v7, v[116:117] offset:2048
    ds_write_b64 v6, v[120:121] offset:4096
    s_add_u32 s81, s81, 4
    v_mov_b32 v24, 0x2420c
    v_mov_b32 v25, 1
    s_mov_b64 exec, 1
    ds_add_u32 v24, v25
    s_mov_b64 exec, -1
    v_mov_b32 v24, 0x2420c
    s_mov_b32 s80, 1600000
LW_121:
    ds_read_b32 v25, v24
    s_waitcnt lgkmcnt(0)
    v_readfirstlane_b32 s79, v25
    s_cmp_ge_u32 s79, s81
    s_cbranch_scc1 LWD_122
    s_sub_u32 s80, s80, 1
    s_cmp_lg_u32 s80, 0
    s_cbranch_scc1 LW_121
LWD_122:
    ds_read_b128 v[64:67], v12
    ds_read_b128 v[68:71], v124
    ds_read_b128 v[72:75], v13
    ds_read_b128 v[76:79], v125
    ds_read_b128 v[80:83], v14
    ds_read_b128 v[84:87], v126
    ds_read_b128 v[88:91], v15
    ds_read_b128 v[92:95], v127
    s_waitcnt lgkmcnt(7)
    v_mfma_f32_16x16x32_bf16 v[96:99], v[32:35], v[64:67], 0
    v_mfma_f32_16x16x32_bf16 v[100:103], v[48:51], v[64:67], 0
    s_waitcnt lgkmcnt(6)
    v_mfma_f32_16x16x32_bf16 v[96:99], v[32:35], v[68:71], v[96:99]
    v_mfma_f32_16x16x32_bf16 v[100:103], v[48:51], v[68:71], v[100:103]
    s_waitcnt lgkmcnt(5)
    v_mfma_f32_16x16x32_bf16 v[96:99], v[36:39], v[72:75], v[96:99]
    v_mfma_f32_16x16x32_bf16 v[100:103], v[52:55], v[72:75], v[100:103]
    s_waitcnt lgkmcnt(4)
    v_mfma_f32_16x16x32_bf16 v[96:99], v[36:39], v[76:79], v[96:99]
    v_mfma_f32_16x16x32_bf16 v[100:103], v[52:55], v[76:79], v[100:103]
    s_waitcnt lgkmcnt(3)
    v_mfma_f32_16x16x32_bf16 v[96:99], v[40:43], v[80:83], v[96:99]
    v_mfma_f32_16x16x32_bf16 v[100:103], v[56:59], v[80:83], v[100:103]
    s_waitcnt lgkmcnt(2)
    v_mfma_f32_16x16x32_bf16 v[96:99], v[40:43], v[84:87], v[96:99]
    v_mfma_f32_16x16x32_bf16 v[100:103], v[56:59], v[84:87], v[100:103]
    s_waitcnt lgkmcnt(1)
    v_mfma_f32_16x16x32_bf16 v[96:99], v[44:47], v[88:91], v[96:99]
    v_mfma_f32_16x16x32_bf16 v[100:103], v[60:63], v[88:91], v[100:103]
    s_waitcnt lgkmcnt(0)
    v_mfma_f32_16x16x32_bf16 v[96:99], v[44:47], v[92:95], v[96:99]
    v_mfma_f32_16x16x32_bf16 v[100:103], v[60:63], v[92:95], v[100:103]
    s_nop 6
    v_add_f32_dpp v96, v96, v96 row_ror:8 row_mask:0xf bank_mask:0xf
    v_add_f32_dpp v97, v97, v97 row_ror:8 row_mask:0xf bank_mask:0xf
    v_add_f32_dpp v98, v98, v98 row_ror:8 row_mask:0xf bank_mask:0xf
    v_add_f32_dpp v99, v99, v99 row_ror:8 row_mask:0xf bank_mask:0xf
    v_add_f32_dpp v100, v100, v100 row_ror:8 row_mask:0xf bank_mask:0xf
    v_add_f32_dpp v101, v101, v101 row_ror:8 row_mask:0xf bank_mask:0xf
    v_add_f32_dpp v102, v102, v102 row_ror:8 row_mask:0xf bank_mask:0xf
    v_add_f32_dpp v103, v103, v103 row_ror:8 row_mask:0xf bank_mask:0xf
    v_add_f32_dpp v104, v96, v96 row_ror:4 row_mask:0xf bank_mask:0x1
    v_add_f32_dpp v105, v97, v97 row_ror:4 row_mask:0xf bank_mask:0x1
    v_add_f32_dpp v106, v98, v98 row_ror:4 row_mask:0xf bank_mask:0x1
    v_add_f32_dpp v107, v99, v99 row_ror:4 row_mask:0xf bank_mask:0x1
    v_add_f32_dpp v104, v100, v100 row_ror:4 row_mask:0xf bank_mask:0x2
    v_add_f32_dpp v105, v101, v101 row_ror:4 row_mask:0xf bank_mask:0x2
    v_add_f32_dpp v106, v102, v102 row_ror:4 row_mask:0xf bank_mask:0x2
    v_add_f32_dpp v107, v103, v103 row_ror:4 row_mask:0xf bank_mask:0x2
    v_cvt_pk_bf16_f32 v16, v104, v105
    v_cvt_pk_bf16_f32 v17, v106, v107
    s_mov_b64 exec, s[84:85]
    buffer_store_dwordx4 v[16:19], v8, s[36:39], 0 offen sc1
    s_mov_b64 exec, -1
    s_endpgm
L_QABS:
    s_and_b32 s61, s6, 3
    s_waitcnt lgkmcnt(0)
    s_mov_b32 s36, s34
    s_and_b32 s37, s35, 0xffff
    s_mov_b32 s38, 0x1000000
    s_mov_b32 s39, 0x20000
    s_barrier
    s_cmp_ge_u32 s5, 6
    s_cbranch_scc1 L_BATT
    v_and_b32 v8, 3, v1
    v_lshlrev_b32 v5, 15, v8
    v_lshl_add_u32 v5, v2, 3, v5
    v_lshrrev_b32 v10, 2, v3
    v_lshl_add_u32 v5, v10, 5, v5
    s_lshl_b32 s7, s4, 1
    s_add_u32 s7, s7, s5
    s_lshl_b32 s7, s7, 2
    s_add_u32 s7, s7, s61
    s_lshl_b32 s7, s7, 7
    s_sub_u32 s7, s7, 2048
    v_add_u32 v5, s7, v5
    s_or_b32 s95, s95, s78
    s_add_u32 s72, s94, 0x10000
    s_addc_u32 s73, s95, 0
    s_lshl_b32 s7, s4, 15
    s_lshl_b32 s63, s61, 9
    s_add_u32 s7, s7, s63
    s_add_u32 s7, s7, 0x104000
    v_and_b32 v20, 31, v1
    v_lshl_add_u32 v7, v20, 4, s7
    v_lshrrev_b32 v21, 5, v1
    v_lshl_add_u32 v7, v21, 11, v7
    v_add_u32 v22, 4096, v7
    s_mul_i32 s7, s61, 320
    s_add_u32 s63, s7, 0x24900
    v_lshl_add_u32 v6, v20, 3, s63
    v_lshl_add_u32 v6, v21, 2, v6
    s_mov_b32 s70, 0x3f80
    s_mov_b32 s71, 0x3f800000
    v_xor_b32 v10, v3, v2
    v_lshlrev_b32 v10, 4, v10
    v_lshl_add_u32 v10, v3, 8, v10
    s_lshl_b32 s7, s61, 14
    s_add_u32 s7, s7, 0x14000
    v_add_u32 v10, s7, v10
    s_lshl_b32 s65, s61, 4
    s_add_u32 s65, s65, 16
    s_lshl_b32 s64, s61, 3
    s_add_u32 s64, s64, 0x24128
    v_mul_u32_u24 v9, 320, v8
    v_lshl_add_u32 v9, v2, 4, v9
    v_add_u32 v9, 0x24900, v9
    v_mov_b32 v12, 0x24000
    s_mov_b32 s80, 1600000
LW_124:
    ds_read_b32 v13, v12
    s_waitcnt lgkmcnt(0)
    v_readfirstlane_b32 s79, v13
    s_cmp_ge_u32 s79, 32
    s_cbranch_scc1 LWD_125
    s_sleep 1
    s_sub_u32 s80, s80, 1
    s_cmp_lg_u32 s80, 0
    s_cbranch_scc1 LW_124
LWD_125:
    s_mov_b64 exec, -1
    buffer_load_dwordx4 v[48:51], v7, s[36:39], 0 offen sc1 nt
    buffer_load_dwordx4 v[52:55], v22, s[36:39], 0 offen sc1 nt
    s_mov_b32 s80, 200000
MC_127:
    s_mov_b64 exec, -1
    s_waitcnt vmcnt(0)
    v_cmp_gt_u64 s[44:45], s[94:95], v[50:51]
    v_cmp_le_u64 vcc, s[72:73], v[50:51]
    s_or_b64 s[44:45], s[44:45], vcc
    v_cmp_gt_u64 s[46:47], s[94:95], v[54:55]
    v_cmp_le_u64 vcc, s[72:73], v[54:55]
    s_or_b64 s[46:47], s[46:47], vcc
    s_or_b64 s[90:91], s[44:45], s[46:47]
    s_cbranch_scc1 M_126
MD_128:
    s_mov_b64 exec, -1
    v_dot2_f32_bf16 v24, v48, s70, 0
    v_dot2_f32_bf16 v25, v48, s71, 0
    v_dot2_f32_bf16 v26, v49, s70, 0
    v_dot2_f32_bf16 v27, v49, s71, 0
    v_dot2_f32_bf16 v24, v52, s70, v24
    v_dot2_f32_bf16 v25, v52, s71, v25
    v_dot2_f32_bf16 v26, v53, s70, v26
    v_dot2_f32_bf16 v27, v53, s71, v27
    s_nop 1
    v_permlane32_swap_b32 v24, v26
    v_permlane32_swap_b32 v25, v27
    v_add_f32 v24, v24, v26
    v_add_f32 v25, v25, v27
    v_cvt_pk_bf16_f32 v24, v24, v25
    ds_write_b32 v6, v24
    v_mov_b32 v48, 0x24208
    v_mov_b32 v49, 1
    s_mov_b64 exec, 1
    ds_add_u32 v48, v49
    s_mov_b64 exec, -1
    v_mov_b32 v12, 0x24000
    s_mov_b32 s80, 1600000
LW_129:
    ds_read_b32 v13, v12
    s_waitcnt lgkmcnt(0)
    v_readfirstlane_b32 s79, v13
    s_cmp_ge_u32 s79, s65
    s_cbranch_scc1 LWD_130
    s_sub_u32 s80, s80, 1
    s_cmp_lg_u32 s80, 0
    s_cbranch_scc1 LW_129
LWD_130:
    v_xor_b32 v11, 0x0, v10
    ds_read_b128 v[64:67], v11 offset:0
    ds_read_b128 v[80:83], v11 offset:4096
    ds_read_b128 v[96:99], v11 offset:8192
    ds_read_b128 v[112:115], v11 offset:12288
    v_xor_b32 v11, 0x40, v10
    ds_read_b128 v[68:71], v11 offset:0
    ds_read_b128 v[84:87], v11 offset:4096
    ds_read_b128 v[100:103], v11 offset:8192
    ds_read_b128 v[116:119], v11 offset:12288
    v_xor_b32 v11, 0x80, v10
    ds_read_b128 v[72:75], v11 offset:0
    ds_read_b128 v[88:91], v11 offset:4096
    ds_read_b128 v[104:107], v11 offset:8192
    ds_read_b128 v[120:123], v11 offset:12288
    v_xor_b32 v11, 0xc0, v10
    ds_read_b128 v[76:79], v11 offset:0
    ds_read_b128 v[92:95], v11 offset:4096
    ds_read_b128 v[108:111], v11 offset:8192
    ds_read_b128 v[124:127], v11 offset:12288
    v_lshl_add_u32 v12, v1, 2, s64
    v_mov_b32 v13, 4
    s_mov_b64 exec, 3
    ds_add_u32 v12, v13
    s_mov_b64 exec, -1
    v_mov_b32 v12, 0x24208
    s_mov_b32 s80, 1600000
LW_131:
    ds_read_b32 v13, v12
    s_waitcnt lgkmcnt(0)
    v_readfirstlane_b32 s79, v13
    s_cmp_ge_u32 s79, 20
    s_cbranch_scc1 LWD_132
    s_sub_u32 s80, s80, 1
    s_cmp_lg_u32 s80, 0
    s_cbranch_scc1 LW_131
LWD_132:
    ds_read_b128 v[48:51], v9 offset:0
    ds_read_b128 v[52:55], v9 offset:64
    ds_read_b128 v[56:59], v9 offset:128
    ds_read_b128 v[60:63], v9 offset:192
    s_waitcnt lgkmcnt(3)
    v_mfma_f32_16x16x32_bf16 v[128:131], v[64:67], v[48:51], 0
    v_mfma_f32_16x16x32_bf16 v[132:135], v[80:83], v[48:51], 0
    v_mfma_f32_16x16x32_bf16 v[136:139], v[96:99], v[48:51], 0
    v_mfma_f32_16x16x32_bf16 v[140:143], v[112:115], v[48:51], 0
    s_waitcnt lgkmcnt(2)
    v_mfma_f32_16x16x32_bf16 v[128:131], v[68:71], v[52:55], v[128:131]
    v_mfma_f32_16x16x32_bf16 v[132:135], v[84:87], v[52:55], v[132:135]
    v_mfma_f32_16x16x32_bf16 v[136:139], v[100:103], v[52:55], v[136:139]
    v_mfma_f32_16x16x32_bf16 v[140:143], v[116:119], v[52:55], v[140:143]
    s_waitcnt lgkmcnt(1)
    v_mfma_f32_16x16x32_bf16 v[128:131], v[72:75], v[56:59], v[128:131]
    v_mfma_f32_16x16x32_bf16 v[132:135], v[88:91], v[56:59], v[132:135]
    v_mfma_f32_16x16x32_bf16 v[136:139], v[104:107], v[56:59], v[136:139]
    v_mfma_f32_16x16x32_bf16 v[140:143], v[120:123], v[56:59], v[140:143]
    s_waitcnt lgkmcnt(0)
    v_mfma_f32_16x16x32_bf16 v[128:131], v[76:79], v[60:63], v[128:131]
    v_mfma_f32_16x16x32_bf16 v[132:135], v[92:95], v[60:63], v[132:135]
    v_mfma_f32_16x16x32_bf16 v[136:139], v[108:111], v[60:63], v[136:139]
    v_mfma_f32_16x16x32_bf16 v[140:143], v[124:127], v[60:63], v[140:143]
    s_nop 4
    v_cvt_pk_bf16_f32 v24, v128, v129
    v_cvt_pk_bf16_f32 v25, v130, v131
    v_cvt_pk_bf16_f32 v26, v132, v133
    v_cvt_pk_bf16_f32 v27, v134, v135
    v_cvt_pk_bf16_f32 v28, v136, v137
    v_cvt_pk_bf16_f32 v29, v138, v139
    v_cvt_pk_bf16_f32 v30, v140, v141
    v_cvt_pk_bf16_f32 v31, v142, v143
    v_mov_b32_dpp v24, v26 quad_perm:[0,1,2,3] row_mask:0xf bank_mask:0x2
    v_mov_b32_dpp v25, v27 quad_perm:[0,1,2,3] row_mask:0xf bank_mask:0x2
    v_mov_b32_dpp v24, v28 quad_perm:[0,1,2,3] row_mask:0xf bank_mask:0x4
    v_mov_b32_dpp v25, v29 quad_perm:[0,1,2,3] row_mask:0xf bank_mask:0x4
    v_mov_b32_dpp v24, v30 quad_perm:[0,1,2,3] row_mask:0xf bank_mask:0x8
    v_mov_b32_dpp v25, v31 quad_perm:[0,1,2,3] row_mask:0xf bank_mask:0x8
    buffer_store_dwordx2 v[24:25], v5, s[36:39], 0 offen sc1
    v_mov_b32 v48, 0x24208
    v_mov_b32 v49, 32
    s_mov_b64 exec, 1
    ds_add_u32 v48, v49
    s_mov_b64 exec, -1
L_ESVC:
    v_lshrrev_b32 v160, 2, v1
    v_bfe_u32 v161, v1, 3, 2
    v_xor_b32 v161, s61, v161
    v_lshlrev_b32 v161, 5, v161
    v_lshl_add_u32 v161, v160, 7, v161
    v_and_b32 v162, 3, v1
    v_lshl_add_u32 v161, v162, 3, v161
    s_lshl_b32 s7, s61, 10
    s_lshl_b32 s62, s4, 4
    s_add_u32 s7, s7, s62
    s_add_u32 s7, s7, 0x30000
    v_and_b32 v164, 1, v1
    v_lshl_add_u32 v4, v164, 9, s7
    s_lshl_b32 s7, s4, 13
    s_lshl_b32 s62, s61, 11
    s_add_u32 s7, s7, s62
    s_add_u32 s7, s7, 0x200000
    v_lshl_add_u32 v5, v1, 4, s7
    s_mul_i32 s7, s61, 1088
    s_add_u32 s7, s7, 0x26600
    v_lshl_add_u32 v6, v160, 6, s7
    v_lshl_add_u32 v6, v164, 5, v6
    v_and_b32 v164, 2, v1
    v_lshl_add_u32 v6, v164, 2, v6
    v_mul_u32_u24 v7, 1088, v162
    v_lshl_add_u32 v7, v2, 4, v7
    v_add_u32 v7, 0x26600, v7
    v_cmp_gt_u32 s[84:85], 4, v3
    s_and_b32 s62, s4, 7
    s_lshl_b32 s62, s62, 3
    s_lshr_b32 s7, s4, 3
    s_lshl_b32 s7, s7, 1
    s_add_u32 s62, s62, s7
    s_add_u32 s62, s62, s5
    s_sub_u32 s62, s62, 6
    s_add_u32 s62, s62, 2
    s_lshl_b32 s7, s62, 10
    s_lshl_b32 s64, s61, 8
    s_add_u32 s7, s7, s64
    s_add_u32 s7, s7, 0xc0000
    v_lshl_add_u32 v10, v162, 6, s7
    v_lshl_add_u32 v10, v2, 4, v10
    s_lshr_b32 s7, s62, 3
    s_lshl_b32 s7, s7, 7
    s_add_u32 s7, s7, 0x22000
    v_and_b32 v164, 7, v1
    v_lshl_add_u32 v9, v164, 3, s7
    v_mov_b32 v16, 0x24204
    s_mov_b32 s80, 1600000
LW_133:
    ds_read_b32 v17, v16
    s_waitcnt lgkmcnt(0)
    v_readfirstlane_b32 s79, v17
    s_cmp_ge_u32 s79, 1
    s_cbranch_scc1 LWD_134
    s_sleep 1
    s_sub_u32 s80, s80, 1
    s_cmp_lg_u32 s80, 0
    s_cbranch_scc1 LW_133
LWD_134:
    v_mov_b32 v16, 0x24248
    ds_read_b64 v[18:19], v16
    s_waitcnt lgkmcnt(0)
    v_readfirstlane_b32 s92, v18
    v_readfirstlane_b32 s93, v19
    v_mov_b32 v16, 0x24000
    s_mov_b32 s80, 1600000
LW_135:
    ds_read_b32 v17, v16
    s_waitcnt lgkmcnt(0)
    v_readfirstlane_b32 s79, v17
    s_cmp_ge_u32 s79, 96
    s_cbranch_scc1 LWD_136
    s_sleep 4
    s_sub_u32 s80, s80, 1
    s_cmp_lg_u32 s80, 0
    s_cbranch_scc1 LW_135
LWD_136:
    s_or_b32 s95, s95, s78
    s_add_u32 s88, s94, 0x10000
    s_addc_u32 s89, s95, 0
    s_mov_b32 s101, 4
    s_mov_b64 exec, 0xff
U_137:
    buffer_load_dwordx2 v[16:17], v9, s[36:39], 0 offen sc1 nt
UU_138:
    s_waitcnt vmcnt(0)
    v_cmp_gt_u64 s[90:91], s[94:95], v[16:17]
    v_cmp_le_u64 vcc, s[88:89], v[16:17]
    s_or_b64 vcc, vcc, s[90:91]
    s_cbranch_scc0 UD_139
    s_sleep 8
    s_sub_u32 s101, s101, 1
    s_cmp_lg_u32 s101, 0
    s_cbranch_scc1 U_137
UD_139:
    s_mov_b64 exec, -1
    v_mov_b32 v16, 0x24000
    s_mov_b32 s80, 1600000
LW_140:
    ds_read_b32 v17, v16
    s_waitcnt lgkmcnt(0)
    v_readfirstlane_b32 s79, v17
    s_cmp_ge_u32 s79, 128
    s_cbranch_scc1 LWD_141
    s_sleep 4
    s_sub_u32 s80, s80, 1
    s_cmp_lg_u32 s80, 0
    s_cbranch_scc1 LW_140
LWD_141:
    ds_read_b64_tr_b16 v[32:33], v161 offset:0
    ds_read_b64_tr_b16 v[34:35], v161 offset:2048
    ds_read_b64_tr_b16 v[36:37], v161 offset:4096
    ds_read_b64_tr_b16 v[38:39], v161 offset:6144
    ds_read_b64_tr_b16 v[40:41], v161 offset:8192
    ds_read_b64_tr_b16 v[42:43], v161 offset:10240
    ds_read_b64_tr_b16 v[44:45], v161 offset:12288
    ds_read_b64_tr_b16 v[46:47], v161 offset:14336
    s_waitcnt lgkmcnt(4)
    ds_read_b64_tr_b16 v[48:49], v161 offset:16384
    ds_read_b64_tr_b16 v[50:51], v161 offset:18432
    ds_read_b64_tr_b16 v[52:53], v161 offset:20480
    ds_read_b64_tr_b16 v[54:55], v161 offset:22528
    ds_read_b64_tr_b16 v[56:57], v161 offset:24576
    ds_read_b64_tr_b16 v[58:59], v161 offset:26624
    ds_read_b64_tr_b16 v[60:61], v161 offset:28672
    ds_read_b64_tr_b16 v[62:63], v161 offset:30720
    s_waitcnt lgkmcnt(4)
    ds_read_b64_tr_b16 v[64:65], v161 offset:32768
    ds_read_b64_tr_b16 v[66:67], v161 offset:34816
    ds_read_b64_tr_b16 v[68:69], v161 offset:36864
    ds_read_b64_tr_b16 v[70:71], v161 offset:38912
    ds_read_b64_tr_b16 v[72:73], v161 offset:40960
    ds_read_b64_tr_b16 v[74:75], v161 offset:43008
    ds_read_b64_tr_b16 v[76:77], v161 offset:45056
    ds_read_b64_tr_b16 v[78:79], v161 offset:47104
    s_waitcnt lgkmcnt(4)
    ds_read_b64_tr_b16 v[80:81], v161 offset:49152
    ds_read_b64_tr_b16 v[82:83], v161 offset:51200
    ds_read_b64_tr_b16 v[84:85], v161 offset:53248
    ds_read_b64_tr_b16 v[86:87], v161 offset:55296
    ds_read_b64_tr_b16 v[88:89], v161 offset:57344
    ds_read_b64_tr_b16 v[90:91], v161 offset:59392
    ds_read_b64_tr_b16 v[92:93], v161 offset:61440
    ds_read_b64_tr_b16 v[94:95], v161 offset:63488
    s_waitcnt lgkmcnt(4)
    v_lshlrev_b32 v16, 2, v1
    v_add_u32 v16, 0x24100, v16
    v_mov_b32 v17, 1
    s_mov_b64 exec, 255
    ds_add_u32 v16, v17
    s_mov_b64 exec, -1
    s_and_b32 s7, s4, 7
    s_lshl_b32 s7, s7, 12
    s_add_u32 s7, s7, 0x28008
    v_lshl_add_u32 v9, v1, 9, s7
    s_lshl_b32 s7, s61, 8
    s_lshr_b32 s64, s4, 2
    s_lshl_b32 s64, s64, 3
    s_add_u32 s7, s7, s64
    s_add_u32 s7, s7, 0x22800
    v_writelane_b32 v9, s7, 8
    s_add_u32 s7, s7, 128
    v_writelane_b32 v9, s7, 9
    s_cmp_eq_u32 s101, 0
    s_cbranch_scc1 EH_142
    s_mov_b64 exec, 0xff
    buffer_load_dwordx2 v[12:13], v9, s[36:39], 0 offen sc1 nt
    s_mov_b32 s80, 200000
MC_144:
    s_mov_b64 exec, 0xff
    s_waitcnt vmcnt(0)
    v_cmp_ne_u64 s[64:65], s[92:93], v[12:13]
    s_cmp_lg_u64 s[64:65], 0
    s_cbranch_scc1 M_143
MD_145:
    s_mov_b64 exec, -1
EH_142:
    s_mov_b64 exec, 0x300
    buffer_load_dwordx2 v[12:13], v9, s[36:39], 0 offen sc1
    s_mov_b32 s80, 200000
MC_147:
    s_mov_b64 exec, 0x300
    s_waitcnt vmcnt(0)
    v_cmp_ne_u64 s[64:65], s[92:93], v[12:13]
    s_cmp_lg_u64 s[64:65], 0
    s_cbranch_scc1 M_146
MD_148:
    s_mov_b64 exec, -1
    s_setprio 2
    s_mov_b64 exec, -1
    buffer_load_dwordx4 v[16:19], v5, s[36:39], 0 offen offset:0 sc1
    buffer_load_dwordx4 v[20:23], v5, s[36:39], 0 offen offset:1024 sc1
    buffer_load_dwordx4 v[12:15], v4, s[36:39], 0 offen sc1
    s_mov_b32 s80, 200000
MC_150:
    s_mov_b64 exec, -1
    s_waitcnt vmcnt(0)
    v_max3_u32 v160, v16, v17, v18
    v_max_u32 v160, v160, v19
    v_cmp_eq_u32 s[64:65], -1, v160
    v_max3_u32 v161, v20, v21, v22
    v_max_u32 v161, v161, v23
    v_cmp_eq_u32 s[66:67], -1, v161
    v_cmp_ne_u64 s[68:69], s[92:93], v[14:15]
    s_or_b64 s[90:91], s[64:65], s[66:67]
    s_or_b64 s[90:91], s[90:91], s[68:69]
    s_cbranch_scc1 M_149
MD_151:
    s_mov_b64 exec, -1
    v_readlane_b32 s74, v12, 0
    v_readlane_b32 s76, v13, 0
    v_readlane_b32 s75, v12, 1
    v_readlane_b32 s77, v13, 1
    v_mov_b32 v160, s74
    v_max_f32 v160, s75, v160
    v_sub_f32 v11, s74, v160
    v_sub_f32 v12, s75, v160
    v_exp_f32 v11, v11
    v_exp_f32 v12, v12
    v_mul_f32 v160, s76, v11
    v_fmac_f32 v160, s77, v12
    v_rcp_f32 v160, v160
    s_nop 0
    v_mul_f32 v11, v11, v160
    v_mul_f32 v12, v12, v160
    v_lshlrev_b32 v96, 16, v16
    v_and_b32 v97, 0xffff0000, v16
    v_lshlrev_b32 v98, 16, v17
    v_and_b32 v99, 0xffff0000, v17
    v_lshlrev_b32 v100, 16, v18
    v_and_b32 v101, 0xffff0000, v18
    v_lshlrev_b32 v102, 16, v19
    v_and_b32 v103, 0xffff0000, v19
    v_lshlrev_b32 v104, 16, v20
    v_and_b32 v105, 0xffff0000, v20
    v_lshlrev_b32 v106, 16, v21
    v_and_b32 v107, 0xffff0000, v21
    v_lshlrev_b32 v108, 16, v22
    v_and_b32 v109, 0xffff0000, v22
    v_lshlrev_b32 v110, 16, v23
    v_and_b32 v111, 0xffff0000, v23
    v_mul_f32 v96, v96, v11
    v_mul_f32 v97, v97, v11
    v_mul_f32 v98, v98, v11
    v_mul_f32 v99, v99, v11
    v_mul_f32 v100, v100, v11
    v_mul_f32 v101, v101, v11
    v_mul_f32 v102, v102, v11
    v_mul_f32 v103, v103, v11
    v_fmac_f32 v96, v104, v12
    v_fmac_f32 v97, v105, v12
    v_fmac_f32 v98, v106, v12
    v_fmac_f32 v99, v107, v12
    v_fmac_f32 v100, v108, v12
    v_fmac_f32 v101, v109, v12
    v_fmac_f32 v102, v110, v12
    v_fmac_f32 v103, v111, v12
    v_cvt_pk_bf16_f32 v24, v96, v97
    v_cvt_pk_bf16_f32 v25, v98, v99
    v_cvt_pk_bf16_f32 v26, v100, v101
    v_cvt_pk_bf16_f32 v27, v102, v103
    ds_write_b64 v6, v[24:25]
    ds_write_b64 v6, v[26:27] offset:16
    s_add_u32 s81, s81, 4
    v_mov_b32 v160, 0x2420c
    v_mov_b32 v161, 1
    s_mov_b64 exec, 1
    ds_add_u32 v160, v161
    s_mov_b64 exec, -1
    v_mov_b32 v160, 0x2420c
    s_mov_b32 s80, 1600000
LW_152:
    ds_read_b32 v161, v160
    s_waitcnt lgkmcnt(0)
    v_readfirstlane_b32 s79, v161
    s_cmp_ge_u32 s79, s81
    s_cbranch_scc1 LWD_153
    s_sub_u32 s80, s80, 1
    s_cmp_lg_u32 s80, 0
    s_cbranch_scc1 LW_152
LWD_153:
    ds_read_b128 v[96:99], v7 offset:0
    ds_read_b128 v[100:103], v7 offset:64
    ds_read_b128 v[104:107], v7 offset:128
    ds_read_b128 v[108:111], v7 offset:192
    ds_read_b128 v[112:115], v7 offset:256
    ds_read_b128 v[116:119], v7 offset:320
    ds_read_b128 v[120:123], v7 offset:384
    ds_read_b128 v[124:127], v7 offset:448
    ds_read_b128 v[128:131], v7 offset:512
    ds_read_b128 v[132:135], v7 offset:576
    ds_read_b128 v[136:139], v7 offset:640
    ds_read_b128 v[140:143], v7 offset:704
    v_mov_b32 v18, s92
    v_mov_b32 v19, s93
    s_waitcnt lgkmcnt(8)
    ds_read_b128 v[144:147], v7 offset:768
    ds_read_b128 v[148:151], v7 offset:832
    ds_read_b128 v[152:155], v7 offset:896
    ds_read_b128 v[156:159], v7 offset:960
    v_mfma_f32_16x16x32_bf16 v[12:15], v[32:35], v[96:99], 0
    v_mfma_f32_16x16x32_bf16 v[12:15], v[36:39], v[100:103], v[12:15]
    v_mfma_f32_16x16x32_bf16 v[12:15], v[40:43], v[104:107], v[12:15]
    v_mfma_f32_16x16x32_bf16 v[12:15], v[44:47], v[108:111], v[12:15]
    s_waitcnt lgkmcnt(11)
    v_mfma_f32_16x16x32_bf16 v[12:15], v[48:51], v[112:115], v[12:15]
    s_waitcnt lgkmcnt(10)
    v_mfma_f32_16x16x32_bf16 v[12:15], v[52:55], v[116:119], v[12:15]
    s_waitcnt lgkmcnt(9)
    v_mfma_f32_16x16x32_bf16 v[12:15], v[56:59], v[120:123], v[12:15]
    s_waitcnt lgkmcnt(8)
    v_mfma_f32_16x16x32_bf16 v[12:15], v[60:63], v[124:127], v[12:15]
    s_waitcnt lgkmcnt(7)
    v_mfma_f32_16x16x32_bf16 v[12:15], v[64:67], v[128:131], v[12:15]
    s_waitcnt lgkmcnt(6)
    v_mfma_f32_16x16x32_bf16 v[12:15], v[68:71], v[132:135], v[12:15]
    s_waitcnt lgkmcnt(5)
    v_mfma_f32_16x16x32_bf16 v[12:15], v[72:75], v[136:139], v[12:15]
    s_waitcnt lgkmcnt(4)
    v_mfma_f32_16x16x32_bf16 v[12:15], v[76:79], v[140:143], v[12:15]
    s_waitcnt lgkmcnt(3)
    v_mfma_f32_16x16x32_bf16 v[12:15], v[80:83], v[144:147], v[12:15]
    s_waitcnt lgkmcnt(2)
    v_mfma_f32_16x16x32_bf16 v[12:15], v[84:87], v[148:151], v[12:15]
    s_waitcnt lgkmcnt(1)
    v_mfma_f32_16x16x32_bf16 v[12:15], v[88:91], v[152:155], v[12:15]
    s_waitcnt lgkmcnt(0)
    v_mfma_f32_16x16x32_bf16 v[12:15], v[92:95], v[156:159], v[12:15]
    s_nop 7
    v_cvt_pk_bf16_f32 v16, v12, v13
    v_cvt_pk_bf16_f32 v17, v14, v15
    s_mov_b64 exec, s[84:85]
    s_cmp_eq_u32 s101, 0
    s_cbranch_scc1 SU_154
    buffer_store_dwordx4 v[16:19], v10, s[36:39], 0 offen
SV_155:
    s_mov_b64 exec, -1
    s_endpgm
L_BATT:
    s_and_b32 s60, s4, 7
    s_lshl_b32 s60, s60, 3
    s_lshr_b32 s7, s4, 3
    s_lshl_b32 s7, s7, 1
    s_add_u32 s60, s60, s7
    s_add_u32 s60, s60, s5
    s_sub_u32 s60, s60, 6
    s_lshr_b32 s61, s6, 1
    s_and_b32 s62, s6, 1
    s_mov_b32 s64, 0x3e0293ee
    v_lshlrev_b32 v4, 10, v3
    v_lshl_add_u32 v4, v2, 8, v4
    v_lshl_add_u32 v96, v3, 4, v4
    s_lshl_b32 s7, s62, 14
    s_add_u32 s7, s7, 0x1c000
    v_add_u32 v96, s7, v96
    v_and_b32 v162, 3, v1
    v_lshl_add_u32 v4, v162, 6, v4
    v_bfe_u32 v162, v1, 2, 2
    v_lshl_add_u32 v4, v162, 4, v4
    s_lshl_b32 s7, s6, 7
    s_add_u32 s7, s7, 0x24400
    v_lshl_add_u32 v5, v3, 3, s7
    s_lshl_b32 s7, s61, 10
    s_lshl_b32 s63, s62, 8
    s_add_u32 s7, s7, s63
    s_add_u32 s7, s7, 0x26000
    v_lshl_add_u32 v6, v3, 4, s7
    v_lshrrev_b32 v163, 5, v1
    v_lshl_add_u32 v6, v163, 9, v6
    v_and_b32 v162, 1, v2
    v_lshl_add_u32 v6, v162, 3, v6
    v_lshlrev_b32 v7, 4, v1
    v_add_u32 v7, 0x26000, v7
    v_and_b32 v162, 31, v1
    v_lshlrev_b32 v8, 3, v162
    v_add_u32 v8, 0x24400, v8
    v_bfe_u32 v162, v1, 2, 2
    v_lshl_add_u32 v164, v163, 3, v162
    v_lshlrev_b32 v164, 10, v164
    v_and_b32 v165, 1, v1
    v_lshl_add_u32 v164, v165, 3, v164
    s_lshl_b32 s7, s61, 8
    v_add_u32 v164, s7, v164
    v_bfe_u32 v165, v1, 4, 1
    v_lshlrev_b32 v165, 1, v165
    v_bfe_u32 v160, v1, 1, 1
    v_or_b32 v165, v165, v160
    s_lshl_b32 s7, s62, 3
    v_or_b32 v165, s7, v165
    v_lshlrev_b32 v162, 2, v162
    v_xor_b32 v165, v165, v162
    v_lshlrev_b32 v163, 1, v163
    v_xor_b32 v165, v165, v163
    v_xor_b32 v160, 0, v165
    v_lshl_add_u32 v9, v160, 4, v164
    v_xor_b32 v160, 4, v165
    v_lshl_add_u32 v10, v160, 4, v164
    v_xor_b32 v160, 1, v165
    v_lshl_add_u32 v11, v160, 4, v164
    v_add_u32 v11, 0x1000, v11
    v_xor_b32 v160, 5, v165
    v_lshl_add_u32 v12, v160, 4, v164
    v_add_u32 v12, 0x1000, v12
    v_mov_b32 v13, 0xff800000
    v_mov_b32 v128, 0
    v_mov_b32 v129, 0
    v_mov_b32 v130, 0
    v_mov_b32 v131, 0
    v_mov_b32 v132, 0
    v_mov_b32 v133, 0
    v_mov_b32 v134, 0
    v_mov_b32 v135, 0
    v_mov_b32 v136, 0
    v_mov_b32 v137, 0
    v_mov_b32 v138, 0
    v_mov_b32 v139, 0
    v_mov_b32 v140, 0
    v_mov_b32 v141, 0
    v_mov_b32 v142, 0
    v_mov_b32 v143, 0
    v_mov_b32 v144, 0
    v_mov_b32 v145, 0
    v_mov_b32 v146, 0
    v_mov_b32 v147, 0
    v_mov_b32 v148, 0
    v_mov_b32 v149, 0
    v_mov_b32 v150, 0
    v_mov_b32 v151, 0
    v_mov_b32 v152, 0
    v_mov_b32 v153, 0
    v_mov_b32 v154, 0
    v_mov_b32 v155, 0
    v_mov_b32 v156, 0
    v_mov_b32 v157, 0
    v_mov_b32 v158, 0
    v_mov_b32 v159, 0
    s_mov_b64 s[84:85], 0xffff
    s_lshl_b32 s7, s60, 15
    s_lshl_b32 s63, s6, 12
    s_add_u32 s7, s7, s63
    s_add_u32 s7, s7, 0x600000
    v_lshl_add_u32 v97, v1, 7, s7
    v_mov_b32 v160, 0x24000
    s_mov_b32 s80, 1600000
LW_156:
    ds_read_b32 v161, v160
    s_waitcnt lgkmcnt(0)
    v_readfirstlane_b32 s79, v161
    s_cmp_ge_u32 s79, 48
    s_cbranch_scc1 LWD_157
    s_sleep 4
    s_sub_u32 s80, s80, 1
    s_cmp_lg_u32 s80, 0
    s_cbranch_scc1 LW_156
LWD_157:
    v_mov_b32 v15, 0
    s_mov_b64 exec, 0xffffffff
    buffer_store_dword v15, v97, s[36:39], 0 offen
    buffer_load_dword v15, v97, s[36:39], 0 offen sc1 nt
    s_mov_b64 exec, -1
    v_mov_b32 v160, 0x24204
    s_mov_b32 s80, 1600000
LW_158:
    ds_read_b32 v161, v160
    s_waitcnt lgkmcnt(0)
    v_readfirstlane_b32 s79, v161
    s_cmp_ge_u32 s79, 1
    s_cbranch_scc1 LWD_159
    s_sleep 1
    s_sub_u32 s80, s80, 1
    s_cmp_lg_u32 s80, 0
    s_cbranch_scc1 LW_158
LWD_159:
    v_mov_b32 v160, 0x24248
    ds_read_b64 v[162:163], v160
    s_waitcnt lgkmcnt(0)
    v_readfirstlane_b32 s92, v162
    v_readfirstlane_b32 s93, v163
    s_lshl_b32 s7, s6, 9
    s_add_u32 s7, s7, 0x20000
    v_and_b32 v100, 1, v1
    v_lshl_add_u32 v100, v100, 3, s7
    v_lshrrev_b32 v101, 1, v1
    v_lshl_add_u32 v100, v101, 7, v100
    s_lshr_b32 s7, s60, 4
    s_lshl_b32 s7, s7, 15
    s_add_u32 s7, s7, s63
    v_lshl_add_u32 v101, v1, 4, s7
    s_and_b32 s7, s6, 3
    s_lshl_b32 s7, s7, 6
    v_lshlrev_b32 v102, 4, v1
    v_xor_b32 v102, s7, v102
    s_add_u32 s7, s63, 0x1c000
    v_add_u32 v102, s7, v102
    v_xor_b32 v103, 0x10, v102
    v_xor_b32 v104, 0x20, v102
    v_xor_b32 v105, 0x30, v102
    s_lshr_b32 s7, s60, 3
    s_lshl_b32 s7, s7, 7
    s_add_u32 s7, s7, 0x22000
    v_lshl_add_u32 v160, v1, 3, s7
    s_or_b32 s95, s95, s78
    s_add_u32 s88, s94, 0x10000
    s_addc_u32 s89, s95, 0
    s_mov_b32 s101, 4
    s_mov_b64 exec, 0xff
U_160:
    buffer_load_dwordx2 v[16:17], v160, s[36:39], 0 offen sc1 nt
UU_161:
    s_waitcnt vmcnt(0)
    v_cmp_gt_u64 s[90:91], s[94:95], v[16:17]
    v_cmp_le_u64 vcc, s[88:89], v[16:17]
    s_or_b64 vcc, vcc, s[90:91]
    s_cbranch_scc0 UD_162
    s_sleep 8
    s_sub_u32 s101, s101, 1
    s_cmp_lg_u32 s101, 0
    s_cbranch_scc1 U_160
UD_162:
    s_mov_b64 exec, -1
    v_mov_b32 v160, 0x24000
    s_mov_b32 s80, 1600000
LW_163:
    ds_read_b32 v161, v160
    s_waitcnt lgkmcnt(0)
    v_readfirstlane_b32 s79, v161
    s_cmp_ge_u32 s79, 64
    s_cbranch_scc1 LWD_164
    s_sleep 2
    s_sub_u32 s80, s80, 1
    s_cmp_lg_u32 s80, 0
    s_cbranch_scc1 LW_163
LWD_164:
    s_mov_b64 exec, 0xff
    buffer_load_dwordx2 v[16:17], v100, s[36:39], 0 offen sc1
    s_mov_b32 s80, 200000
MC_166:
    s_mov_b64 exec, 0xff
    s_waitcnt vmcnt(0)
    v_cmp_ne_u64 s[44:45], s[92:93], v[16:17]
    s_cmp_lg_u64 s[44:45], 0
    s_cbranch_scc1 M_165
MD_167:
    s_mov_b64 exec, -1
    v_mov_b32 v160, 0x24000
    s_mov_b32 s80, 1600000
LW_168:
    ds_read_b32 v161, v160
    s_waitcnt lgkmcnt(0)
    v_readfirstlane_b32 s79, v161
    s_cmp_ge_u32 s79, 88
    s_cbranch_scc1 LWD_169
    s_sleep 1
    s_sub_u32 s80, s80, 1
    s_cmp_lg_u32 s80, 0
    s_cbranch_scc1 LW_168
LWD_169:
    s_mov_b64 exec, -1
    buffer_load_dwordx4 v[32:35], v101, s[36:39], 0 offen offset:0 sc1
    buffer_load_dwordx4 v[36:39], v101, s[36:39], 0 offen offset:1024 sc1
    buffer_load_dwordx4 v[40:43], v101, s[36:39], 0 offen offset:2048 sc1
    buffer_load_dwordx4 v[44:47], v101, s[36:39], 0 offen offset:3072 sc1
    s_mov_b32 s80, 200000
MC_171:
    s_mov_b64 exec, -1
    s_waitcnt vmcnt(0)
    v_max3_u32 v160, v32, v33, v34
    v_max_u32 v160, v160, v35
    v_cmp_eq_u32 s[44:45], -1, v160
    v_max3_u32 v161, v36, v37, v38
    v_max_u32 v161, v161, v39
    v_cmp_eq_u32 s[46:47], -1, v161
    v_max3_u32 v162, v40, v41, v42
    v_max_u32 v162, v162, v43
    v_cmp_eq_u32 s[48:49], -1, v162
    v_max3_u32 v163, v44, v45, v46
    v_max_u32 v163, v163, v47
    v_cmp_eq_u32 s[50:51], -1, v163
    s_or_b64 s[90:91], s[44:45], s[46:47]
    s_or_b64 s[90:91], s[90:91], s[48:49]
    s_or_b64 s[90:91], s[90:91], s[50:51]
    s_cbranch_scc1 M_170
MD_172:
    s_mov_b64 exec, -1
    ds_write_b128 v102, v[32:35] offset:0
    ds_write_b128 v103, v[36:39] offset:1024
    ds_write_b128 v104, v[40:43] offset:2048
    ds_write_b128 v105, v[44:47] offset:3072
    s_add_u32 s81, s81, 8
    v_mov_b32 v162, 0x2420c
    v_mov_b32 v163, 1
    s_mov_b64 exec, 1
    ds_add_u32 v162, v163
    s_mov_b64 exec, -1
    v_mov_b32 v162, 0x2420c
    s_mov_b32 s80, 1600000
LW_173:
    ds_read_b32 v163, v162
    s_waitcnt lgkmcnt(0)
    v_readfirstlane_b32 s79, v163
    s_cmp_ge_u32 s79, s81
    s_cbranch_scc1 LWD_174
    s_sub_u32 s80, s80, 1
    s_cmp_lg_u32 s80, 0
    s_cbranch_scc1 LW_173
LWD_174:
    v_xor_b32 v160, 0x0, v96
    ds_read_b128 v[32:35], v160
    v_xor_b32 v161, 0x10, v96
    ds_read_b128 v[36:39], v161
    v_xor_b32 v160, 0x20, v96
    ds_read_b128 v[40:43], v160
    v_xor_b32 v161, 0x30, v96
    ds_read_b128 v[44:47], v161
    v_xor_b32 v160, 0x40, v96
    ds_read_b128 v[48:51], v160
    v_xor_b32 v161, 0x50, v96
    ds_read_b128 v[52:55], v161
    v_xor_b32 v160, 0x60, v96
    ds_read_b128 v[56:59], v160
    v_xor_b32 v161, 0x70, v96
    ds_read_b128 v[60:63], v161
    v_xor_b32 v160, 0x80, v96
    ds_read_b128 v[64:67], v160
    v_xor_b32 v161, 0x90, v96
    ds_read_b128 v[68:71], v161
    s_waitcnt lgkmcnt(4)
    v_xor_b32 v160, 0xa0, v96
    ds_read_b128 v[72:75], v160
    v_xor_b32 v161, 0xb0, v96
    ds_read_b128 v[76:79], v161
    v_xor_b32 v160, 0xc0, v96
    ds_read_b128 v[80:83], v160
    v_xor_b32 v161, 0xd0, v96
    ds_read_b128 v[84:87], v161
    v_xor_b32 v160, 0xe0, v96
    ds_read_b128 v[88:91], v160
    v_xor_b32 v161, 0xf0, v96
    ds_read_b128 v[92:95], v161
    v_mov_b32 v162, 0x24104
    v_mov_b32 v163, 1
    s_mov_b64 exec, 1
    ds_add_u32 v162, v163
    s_mov_b64 exec, -1
    s_lshl_b32 s66, s61, 4
    s_add_u32 s66, s66, 16
    s_mov_b32 s70, 64
    s_mov_b32 s71, 0x800080
    s_mov_b32 s67, s61
    s_mov_b32 s68, 0
    s_mov_b32 s69, 4
BS_175:
    s_lshl_b32 s7, s67, 14
    v_add_u32 v20, s7, v4
    v_xor_b32 v21, 0x10, v20
    v_xor_b32 v22, 0x20, v20
    v_xor_b32 v23, 0x30, v20
    v_xor_b32 v24, 0x40, v20
    v_xor_b32 v25, 0x50, v20
    v_xor_b32 v26, 0x60, v20
    v_xor_b32 v27, 0x70, v20
    v_mov_b32 v162, 0x24000
    s_mov_b32 s80, 1600000
LW_176:
    ds_read_b32 v163, v162
    s_waitcnt lgkmcnt(0)
    v_readfirstlane_b32 s79, v163
    s_cmp_ge_u32 s79, s66
    s_cbranch_scc1 LWD_177
    s_sleep 1
    s_sub_u32 s80, s80, 1
    s_cmp_lg_u32 s80, 0
    s_cbranch_scc1 LW_176
LWD_177:
    ds_read_b128 v[96:99], v20
    ds_read_b128 v[100:103], v21
    ds_read_b128 v[104:107], v22
    ds_read_b128 v[108:111], v23
    ds_read_b128 v[112:115], v24
    ds_read_b128 v[116:119], v25
    ds_read_b128 v[120:123], v26
    ds_read_b128 v[124:127], v27
    v_xor_b32 v20, 0x80, v20
    v_xor_b32 v21, 0x80, v21
    v_xor_b32 v22, 0x80, v22
    v_xor_b32 v23, 0x80, v23
    v_xor_b32 v24, 0x80, v24
    v_xor_b32 v25, 0x80, v25
    v_xor_b32 v26, 0x80, v26
    v_xor_b32 v27, 0x80, v27
    s_waitcnt lgkmcnt(7)
    v_mfma_f32_16x16x32_bf16 v[16:19], v[96:99], v[32:35], 0
    ds_read_b128 v[96:99], v20
    s_waitcnt lgkmcnt(7)
    v_mfma_f32_16x16x32_bf16 v[16:19], v[100:103], v[36:39], v[16:19]
    ds_read_b128 v[100:103], v21
    s_waitcnt lgkmcnt(7)
    v_mfma_f32_16x16x32_bf16 v[16:19], v[104:107], v[40:43], v[16:19]
    ds_read_b128 v[104:107], v22
    s_waitcnt lgkmcnt(7)
    v_mfma_f32_16x16x32_bf16 v[16:19], v[108:111], v[44:47], v[16:19]
    ds_read_b128 v[108:111], v23
    s_waitcnt lgkmcnt(7)
    v_mfma_f32_16x16x32_bf16 v[16:19], v[112:115], v[48:51], v[16:19]
    ds_read_b128 v[112:115], v24
    s_waitcnt lgkmcnt(7)
    v_mfma_f32_16x16x32_bf16 v[16:19], v[116:119], v[52:55], v[16:19]
    ds_read_b128 v[116:119], v25
    s_waitcnt lgkmcnt(7)
    v_mfma_f32_16x16x32_bf16 v[16:19], v[120:123], v[56:59], v[16:19]
    ds_read_b128 v[120:123], v26
    s_waitcnt lgkmcnt(7)
    v_mfma_f32_16x16x32_bf16 v[16:19], v[124:127], v[60:63], v[16:19]
    ds_read_b128 v[124:127], v27
    s_waitcnt lgkmcnt(7)
    v_mfma_f32_16x16x32_bf16 v[16:19], v[96:99], v[64:67], v[16:19]
    s_waitcnt lgkmcnt(6)
    v_mfma_f32_16x16x32_bf16 v[16:19], v[100:103], v[68:71], v[16:19]
    v_add_u32 v20, s68, v9
    v_add_u32 v21, s68, v10
    v_add_u32 v22, s68, v11
    v_add_u32 v23, s68, v12
    s_add_u32 s68, s68, 16384
    s_cmp_eq_u32 s68, 147456
    s_cselect_b32 s68, 0, s68
    s_waitcnt lgkmcnt(5)
    v_mfma_f32_16x16x32_bf16 v[16:19], v[104:107], v[72:75], v[16:19]
    s_waitcnt lgkmcnt(4)
    v_mfma_f32_16x16x32_bf16 v[16:19], v[108:111], v[76:79], v[16:19]
    v_add_u32 v24, s68, v9
    v_add_u32 v25, s68, v10
    v_add_u32 v26, s68, v11
    v_add_u32 v27, s68, v12
    s_add_u32 s68, s68, 16384
    s_cmp_eq_u32 s68, 147456
    s_cselect_b32 s68, 0, s68
    s_waitcnt lgkmcnt(3)
    v_mfma_f32_16x16x32_bf16 v[16:19], v[112:115], v[80:83], v[16:19]
    s_waitcnt lgkmcnt(2)
    v_mfma_f32_16x16x32_bf16 v[16:19], v[116:119], v[84:87], v[16:19]
    v_add_u32 v28, s68, v9
    v_add_u32 v29, s68, v10
    v_add_u32 v30, s68, v11
    v_add_u32 v31, s68, v12
    s_add_u32 s68, s68, 16384
    s_cmp_eq_u32 s68, 147456
    s_cselect_b32 s68, 0, s68
    s_waitcnt lgkmcnt(1)
    v_mfma_f32_16x16x32_bf16 v[16:19], v[120:123], v[88:91], v[16:19]
    s_waitcnt lgkmcnt(0)
    v_mfma_f32_16x16x32_bf16 v[16:19], v[124:127], v[92:95], v[16:19]
    s_cmp_ge_u32 s79, s70
    s_cbranch_scc1 BA_178
    v_mov_b32 v162, 0x24000
    s_mov_b32 s80, 1600000
LW_179:
    ds_read_b32 v163, v162
    s_waitcnt lgkmcnt(0)
    v_readfirstlane_b32 s79, v163
    s_cmp_ge_u32 s79, s70
    s_cbranch_scc1 LWD_180
    s_sleep 1
    s_sub_u32 s80, s80, 1
    s_cmp_lg_u32 s80, 0
    s_cbranch_scc1 LW_179
LWD_180:
BA_178:
    ds_read_b64_tr_b16 v[96:97], v20
    ds_read_b64_tr_b16 v[98:99], v22
    ds_read_b64_tr_b16 v[100:101], v21
    ds_read_b64_tr_b16 v[102:103], v23
    ds_read_b64_tr_b16 v[104:105], v24
    ds_read_b64_tr_b16 v[106:107], v26
    ds_read_b64_tr_b16 v[108:109], v25
    ds_read_b64_tr_b16 v[110:111], v27
    ds_read_b64_tr_b16 v[112:113], v28
    ds_read_b64_tr_b16 v[114:115], v30
    ds_read_b64_tr_b16 v[116:117], v29
    ds_read_b64_tr_b16 v[118:119], v31
    v_add_u32 v20, s68, v9
    v_add_u32 v21, s68, v10
    v_add_u32 v22, s68, v11
    v_add_u32 v23, s68, v12
    s_add_u32 s68, s68, 16384
    s_cmp_eq_u32 s68, 147456
    s_cselect_b32 s68, 0, s68
    ds_read_b64_tr_b16 v[120:121], v20
    ds_read_b64_tr_b16 v[122:123], v22
    ds_read_b64_tr_b16 v[124:125], v21
    ds_read_b64_tr_b16 v[126:127], v23
    v_mov_b32 v162, 0x24100
    v_mov_b32 v163, 1
    s_mov_b64 exec, 1
    ds_add_u32 v162, v163
    s_mov_b64 exec, -1
    v_max3_f32 v160, v16, v17, v18
    v_max_f32 v160, v160, v19
    v_mov_b32 v161, v160
    s_nop 1
    v_permlane32_swap_b32 v160, v161
    v_max_f32 v160, v160, v161
    v_mov_b32 v161, v160
    s_nop 1
    v_permlane16_swap_b32 v160, v161
    v_max_f32 v160, v160, v161
    v_mul_f32 v160, s64, v160
    v_ceil_f32 v160, v160
    v_fma_f32 v16, v16, s64, -v160
    v_fma_f32 v17, v17, s64, -v160
    v_fma_f32 v18, v18, s64, -v160
    v_fma_f32 v19, v19, s64, -v160
    v_exp_f32 v16, v16
    v_exp_f32 v17, v17
    v_exp_f32 v18, v18
    v_exp_f32 v19, v19
    v_cvt_pk_bf16_f32 v162, v16, v17
    v_cvt_pk_bf16_f32 v163, v18, v19
    v_add_f32 v16, v16, v17
    v_add_f32 v18, v18, v19
    ds_write_b64 v6, v[162:163]
    v_add_f32 v161, v16, v18
    v_mov_b32 v16, v161
    s_nop 1
    v_permlane32_swap_b32 v161, v16
    v_add_f32 v161, v161, v16
    v_mov_b32 v16, v161
    s_nop 1
    v_permlane16_swap_b32 v161, v16
    v_add_f32 v161, v161, v16
    s_mov_b64 exec, s[84:85]
    ds_write_b64 v5, v[160:161]
    s_add_u32 s81, s81, 8
    v_mov_b32 v164, 0x2420c
    v_mov_b32 v165, 1
    s_mov_b64 exec, 1
    ds_add_u32 v164, v165
    s_mov_b64 exec, -1
    v_mov_b32 v164, 0x2420c
    s_mov_b32 s80, 1600000
LW_181:
    ds_read_b32 v165, v164
    s_waitcnt lgkmcnt(0)
    v_readfirstlane_b32 s79, v165
    s_cmp_ge_u32 s79, s81
    s_cbranch_scc1 LWD_182
    s_sub_u32 s80, s80, 1
    s_cmp_lg_u32 s80, 0
    s_cbranch_scc1 LW_181
LWD_182:
    ds_read_b32 v160, v8 offset:0
    ds_read_b32 v161, v8 offset:256
    ds_read_b32 v162, v8 offset:512
    ds_read_b32 v163, v8 offset:768
    ds_read_b128 v[16:19], v7 offset:0
    ds_read_b128 v[20:23], v7 offset:1024
    ds_read_b128 v[24:27], v7 offset:2048
    ds_read_b128 v[28:31], v7 offset:3072
    v_xor_b32 v6, 0x1000, v6
    v_xor_b32 v7, 0x1000, v7
    v_add_u32 v5, 1024, v5
    v_add_u32 v8, 1024, v8
    s_waitcnt lgkmcnt(4)
    v_max3_f32 v14, v13, v160, v161
    v_max3_f32 v14, v14, v162, v163
    v_cmp_neq_f32 vcc, v14, v13
    v_sub_f32 v160, v14, v160
    v_sub_f32 v161, v14, v161
    v_sub_f32 v162, v14, v162
    v_sub_f32 v163, v14, v163
    v_cvt_u32_f32 v160, v160
    v_cvt_u32_f32 v161, v161
    v_cvt_u32_f32 v162, v162
    v_cvt_u32_f32 v163, v163
    v_min_u32 v160, 0xff, v160
    v_min_u32 v161, 0xff, v161
    v_min_u32 v162, 0xff, v162
    v_min_u32 v163, 0xff, v163
    v_mul_u32_u24 v160, s71, v160
    v_mul_u32_u24 v161, s71, v161
    v_mul_u32_u24 v162, s71, v162
    v_mul_u32_u24 v163, s71, v163
    s_cbranch_vccz BR_183
    v_sub_f32 v164, v13, v14
    v_exp_f32 v164, v164
    v_mov_b32 v13, v14
    v_pk_mul_f32 v[128:129], v[128:129], v[164:165] op_sel_hi:[1,0]
    v_pk_mul_f32 v[130:131], v[130:131], v[164:165] op_sel_hi:[1,0]
    v_pk_mul_f32 v[132:133], v[132:133], v[164:165] op_sel_hi:[1,0]
    v_pk_mul_f32 v[134:135], v[134:135], v[164:165] op_sel_hi:[1,0]
    v_pk_mul_f32 v[136:137], v[136:137], v[164:165] op_sel_hi:[1,0]
    v_pk_mul_f32 v[138:139], v[138:139], v[164:165] op_sel_hi:[1,0]
    v_pk_mul_f32 v[140:141], v[140:141], v[164:165] op_sel_hi:[1,0]
    v_pk_mul_f32 v[142:143], v[142:143], v[164:165] op_sel_hi:[1,0]
    v_pk_mul_f32 v[144:145], v[144:145], v[164:165] op_sel_hi:[1,0]
    v_pk_mul_f32 v[146:147], v[146:147], v[164:165] op_sel_hi:[1,0]
    v_pk_mul_f32 v[148:149], v[148:149], v[164:165] op_sel_hi:[1,0]
    v_pk_mul_f32 v[150:151], v[150:151], v[164:165] op_sel_hi:[1,0]
    v_pk_mul_f32 v[152:153], v[152:153], v[164:165] op_sel_hi:[1,0]
    v_pk_mul_f32 v[154:155], v[154:155], v[164:165] op_sel_hi:[1,0]
    v_pk_mul_f32 v[156:157], v[156:157], v[164:165] op_sel_hi:[1,0]
    v_pk_mul_f32 v[158:159], v[158:159], v[164:165] op_sel_hi:[1,0]
BR_183:
    s_waitcnt lgkmcnt(3)
    v_pk_sub_u16 v16, v16, v160 clamp
    v_pk_sub_u16 v17, v17, v160 clamp
    v_pk_sub_u16 v18, v18, v160 clamp
    v_pk_sub_u16 v19, v19, v160 clamp
    s_nop 1
    v_mfma_f32_32x32x16_bf16 v[128:143], v[96:99], v[16:19], v[128:143]
    v_mfma_f32_32x32x16_bf16 v[144:159], v[100:103], v[16:19], v[144:159]
    s_waitcnt lgkmcnt(2)
    v_pk_sub_u16 v20, v20, v161 clamp
    v_pk_sub_u16 v21, v21, v161 clamp
    v_pk_sub_u16 v22, v22, v161 clamp
    v_pk_sub_u16 v23, v23, v161 clamp
    s_nop 1
    v_mfma_f32_32x32x16_bf16 v[128:143], v[104:107], v[20:23], v[128:143]
    v_mfma_f32_32x32x16_bf16 v[144:159], v[108:111], v[20:23], v[144:159]
    s_waitcnt lgkmcnt(1)
    v_pk_sub_u16 v24, v24, v162 clamp
    v_pk_sub_u16 v25, v25, v162 clamp
    v_pk_sub_u16 v26, v26, v162 clamp
    v_pk_sub_u16 v27, v27, v162 clamp
    s_nop 1
    v_mfma_f32_32x32x16_bf16 v[128:143], v[112:115], v[24:27], v[128:143]
    v_mfma_f32_32x32x16_bf16 v[144:159], v[116:119], v[24:27], v[144:159]
    s_waitcnt lgkmcnt(0)
    v_pk_sub_u16 v28, v28, v163 clamp
    v_pk_sub_u16 v29, v29, v163 clamp
    v_pk_sub_u16 v30, v30, v163 clamp
    v_pk_sub_u16 v31, v31, v163 clamp
    s_nop 1
    v_mfma_f32_32x32x16_bf16 v[128:143], v[120:123], v[28:31], v[128:143]
    v_mfma_f32_32x32x16_bf16 v[144:159], v[124:127], v[28:31], v[144:159]
    s_add_u32 s67, s67, 4
    s_cmp_ge_u32 s67, 9
    s_cselect_b32 s7, 9, 0
    s_sub_u32 s67, s67, s7
    s_add_u32 s66, s66, 64
    s_add_u32 s70, s70, 64
    s_sub_u32 s69, s69, 1
    s_cmp_lg_u32 s69, 0
    s_cbranch_scc1 BS_175
    s_lshr_b32 s67, s60, 3
    s_and_b32 s68, s60, 7
    s_lshl_b32 s7, s60, 15
    s_lshl_b32 s63, s6, 12
    s_add_u32 s7, s7, s63
    s_add_u32 s7, s7, 0x600000
    v_lshl_add_u32 v5, v1, 4, s7
    v_mov_b32 v38, s92
    v_mov_b32 v39, s93
    v_permlane32_swap_b32 v128, v132
    v_permlane32_swap_b32 v129, v133
    v_permlane32_swap_b32 v130, v134
    v_permlane32_swap_b32 v131, v135
    v_cvt_pk_bf16_f32 v16, v128, v129
    v_cvt_pk_bf16_f32 v17, v130, v131
    v_cvt_pk_bf16_f32 v18, v132, v133
    v_cvt_pk_bf16_f32 v19, v134, v135
    v_permlane32_swap_b32 v136, v140
    v_permlane32_swap_b32 v137, v141
    v_permlane32_swap_b32 v138, v142
    v_permlane32_swap_b32 v139, v143
    v_cvt_pk_bf16_f32 v20, v136, v137
    v_cvt_pk_bf16_f32 v21, v138, v139
    v_cvt_pk_bf16_f32 v22, v140, v141
    v_cvt_pk_bf16_f32 v23, v142, v143
    v_permlane32_swap_b32 v144, v148
    v_permlane32_swap_b32 v145, v149
    v_permlane32_swap_b32 v146, v150
    v_permlane32_swap_b32 v147, v151
    v_cvt_pk_bf16_f32 v24, v144, v145
    v_cvt_pk_bf16_f32 v25, v146, v147
    v_cvt_pk_bf16_f32 v26, v148, v149
    v_cvt_pk_bf16_f32 v27, v150, v151
    v_permlane32_swap_b32 v152, v156
    v_permlane32_swap_b32 v153, v157
    v_permlane32_swap_b32 v154, v158
    v_permlane32_swap_b32 v155, v159
    v_cvt_pk_bf16_f32 v28, v152, v153
    v_cvt_pk_bf16_f32 v29, v154, v155
    v_cvt_pk_bf16_f32 v30, v156, v157
    v_cvt_pk_bf16_f32 v31, v158, v159
    s_lshl_b32 s7, s67, 9
    s_lshl_b32 s65, s6, 6
    s_add_u32 s7, s7, s65
    s_add_u32 s7, s7, 0x23000
    v_and_b32 v160, 7, v1
    v_lshl_add_u32 v7, v160, 3, s7
    s_lshl_b64 s[88:89], 1, s68
    s_cmp_eq_u32 s101, 0
    s_cbranch_scc1 SU_184
    buffer_store_dwordx4 v[16:19], v5, s[36:39], 0 offen offset:0
    buffer_store_dwordx4 v[20:23], v5, s[36:39], 0 offen offset:1024
    buffer_store_dwordx4 v[24:27], v5, s[36:39], 0 offen offset:2048
    buffer_store_dwordx4 v[28:31], v5, s[36:39], 0 offen offset:3072
    s_waitcnt vmcnt(0)
    s_mov_b64 exec, s[88:89]
    buffer_store_dwordx2 v[38:39], v7, s[36:39], 0 offen
    s_mov_b64 exec, -1
SV_185:
    s_lshl_b32 s7, s67, 18
    s_add_u32 s7, s7, s63
    s_lshl_b32 s65, s68, 6
    s_add_u32 s7, s7, s65
    s_add_u32 s7, s7, 0x600000
    v_and_b32 v160, 3, v1
    v_lshl_add_u32 v5, v160, 4, s7
    v_bfe_u32 v161, v1, 2, 3
    v_lshl_add_u32 v5, v161, 9, v5
    v_lshrrev_b32 v162, 5, v1
    v_lshl_add_u32 v5, v162, 15, v5
    s_lshl_b32 s7, s67, 12
    s_add_u32 s7, s7, s65
    s_add_u32 s7, s7, 0x28000
    v_lshl_add_u32 v6, v160, 4, s7
    v_lshl_add_u32 v6, v162, 9, v6
    s_lshl_b32 s7, s68, 15
    s_lshl_b32 s63, s67, 10
    s_add_u32 s7, s7, s63
    s_lshl_b32 s63, s6, 7
    s_add_u32 s7, s7, s63
    s_add_u32 s7, s7, 0x200000
    v_lshl_add_u32 v8, v160, 13, s7
    v_lshl_add_u32 v8, v161, 4, v8
    v_lshl_add_u32 v8, v162, 3, v8
    s_lshl_b32 s7, s67, 9
    s_add_u32 s7, s7, s65
    s_add_u32 s7, s7, 0x30000
    v_lshl_add_u32 v9, v160, 4, s7
    s_mov_b64 exec, 0xff
    buffer_load_dwordx2 v[40:41], v7, s[36:39], 0 offen sc1 nt
    s_mov_b32 s80, 200000
MC_187:
    s_mov_b64 exec, 0xff
    s_waitcnt vmcnt(0)
    v_cmp_ne_u64 s[86:87], s[92:93], v[40:41]
    s_cmp_lg_u64 s[86:87], 0
    s_cbranch_scc1 M_186
MD_188:
    s_mov_b64 exec, -1
    buffer_load_dwordx4 v[64:67], v6, s[36:39], 0 offen offset:0 sc1 nt
    buffer_load_dwordx4 v[68:71], v6, s[36:39], 0 offen offset:1024 sc1 nt
    buffer_load_dwordx4 v[72:75], v6, s[36:39], 0 offen offset:2048 sc1 nt
    buffer_load_dwordx4 v[76:79], v6, s[36:39], 0 offen offset:3072 sc1 nt
    s_mov_b32 s63, 0
    buffer_load_dwordx4 v[48:51], v5, s[36:39], s63 offen sc1 nt
    s_add_u32 s63, s63, 65536
    buffer_load_dwordx4 v[52:55], v5, s[36:39], s63 offen sc1 nt
    s_add_u32 s63, s63, 65536
    buffer_load_dwordx4 v[56:59], v5, s[36:39], s63 offen sc1 nt
    s_add_u32 s63, s63, 65536
    buffer_load_dwordx4 v[60:63], v5, s[36:39], s63 offen sc1 nt
    s_add_u32 s63, s63, 65536
    s_waitcnt vmcnt(4)
    v_cmp_ne_u64 s[90:91], s[92:93], v[66:67]
    v_cmp_ne_u64 vcc, s[92:93], v[70:71]
    s_or_b64 s[90:91], s[90:91], vcc
    v_cmp_ne_u64 vcc, s[92:93], v[74:75]
    s_or_b64 s[90:91], s[90:91], vcc
    v_cmp_ne_u64 vcc, s[92:93], v[78:79]
    s_or_b64 s[90:91], s[90:91], vcc
    s_cmp_lg_u64 s[90:91], 0
    s_cbranch_scc1 BL_189
BLD_190:
    v_max3_f32 v36, v64, v68, v72
    v_max_f32 v36, v36, v76
    v_mov_b32 v37, v36
    s_nop 1
    v_permlane32_swap_b32 v36, v37
    v_max_f32 v36, v36, v37
    v_sub_f32 v80, v64, v36
    v_sub_f32 v81, v68, v36
    v_sub_f32 v82, v72, v36
    v_sub_f32 v83, v76, v36
    v_exp_f32 v80, v80
    v_exp_f32 v81, v81
    v_exp_f32 v82, v82
    v_exp_f32 v83, v83
    v_mul_f32 v37, v80, v65
    v_fmac_f32 v37, v81, v69
    v_fmac_f32 v37, v82, v73
    v_fmac_f32 v37, v83, v77
    v_mov_b32 v40, v37
    s_nop 1
    v_permlane32_swap_b32 v37, v40
    v_add_f32 v37, v37, v40
    s_waitcnt vmcnt(3)
    v_lshlrev_b32 v88, 16, v48
    v_and_b32 v89, 0xffff0000, v48
    v_lshlrev_b32 v90, 16, v49
    v_and_b32 v91, 0xffff0000, v49
    v_lshlrev_b32 v92, 16, v50
    v_and_b32 v93, 0xffff0000, v50
    v_lshlrev_b32 v94, 16, v51
    v_and_b32 v95, 0xffff0000, v51
    v_mul_f32 v16, v88, v80
    v_mul_f32 v17, v89, v80
    v_mul_f32 v18, v90, v80
    v_mul_f32 v19, v91, v80
    v_mul_f32 v20, v92, v80
    v_mul_f32 v21, v93, v80
    v_mul_f32 v22, v94, v80
    v_mul_f32 v23, v95, v80
    s_waitcnt vmcnt(2)
    v_lshlrev_b32 v88, 16, v52
    v_and_b32 v89, 0xffff0000, v52
    v_lshlrev_b32 v90, 16, v53
    v_and_b32 v91, 0xffff0000, v53
    v_lshlrev_b32 v92, 16, v54
    v_and_b32 v93, 0xffff0000, v54
    v_lshlrev_b32 v94, 16, v55
    v_and_b32 v95, 0xffff0000, v55
    v_fmac_f32 v16, v88, v81
    v_fmac_f32 v17, v89, v81
    v_fmac_f32 v18, v90, v81
    v_fmac_f32 v19, v91, v81
    v_fmac_f32 v20, v92, v81
    v_fmac_f32 v21, v93, v81
    v_fmac_f32 v22, v94, v81
    v_fmac_f32 v23, v95, v81
    s_waitcnt vmcnt(1)
    v_lshlrev_b32 v88, 16, v56
    v_and_b32 v89, 0xffff0000, v56
    v_lshlrev_b32 v90, 16, v57
    v_and_b32 v91, 0xffff0000, v57
    v_lshlrev_b32 v92, 16, v58
    v_and_b32 v93, 0xffff0000, v58
    v_lshlrev_b32 v94, 16, v59
    v_and_b32 v95, 0xffff0000, v59
    v_fmac_f32 v16, v88, v82
    v_fmac_f32 v17, v89, v82
    v_fmac_f32 v18, v90, v82
    v_fmac_f32 v19, v91, v82
    v_fmac_f32 v20, v92, v82
    v_fmac_f32 v21, v93, v82
    v_fmac_f32 v22, v94, v82
    v_fmac_f32 v23, v95, v82
    s_waitcnt vmcnt(0)
    v_mov_b32 v160, 0x24218
    v_mov_b32 v161, 1
    s_mov_b64 exec, 1
    ds_add_u32 v160, v161
    s_mov_b64 exec, -1
    v_lshlrev_b32 v88, 16, v60
    v_and_b32 v89, 0xffff0000, v60
    v_lshlrev_b32 v90, 16, v61
    v_and_b32 v91, 0xffff0000, v61
    v_lshlrev_b32 v92, 16, v62
    v_and_b32 v93, 0xffff0000, v62
    v_lshlrev_b32 v94, 16, v63
    v_and_b32 v95, 0xffff0000, v63
    v_fmac_f32 v16, v88, v83
    v_fmac_f32 v17, v89, v83
    v_fmac_f32 v18, v90, v83
    v_fmac_f32 v19, v91, v83
    v_fmac_f32 v20, v92, v83
    v_fmac_f32 v21, v93, v83
    v_fmac_f32 v22, v94, v83
    v_fmac_f32 v23, v95, v83
    v_permlane32_swap_b32 v16, v20
    v_permlane32_swap_b32 v17, v21
    v_permlane32_swap_b32 v18, v22
    v_permlane32_swap_b32 v19, v23
    v_add_f32 v16, v16, v20
    v_add_f32 v17, v17, v21
    v_add_f32 v18, v18, v22
    v_add_f32 v19, v19, v23
    v_cvt_pk_bf16_f32 v44, v16, v17
    v_cvt_pk_bf16_f32 v45, v18, v19
    v_mov_b32 v160, 0x24218
    s_mov_b32 s80, 1600000
LW_191:
    ds_read_b32 v161, v160
    s_waitcnt lgkmcnt(0)
    v_readfirstlane_b32 s79, v161
    s_cmp_ge_u32 s79, 8
    s_cbranch_scc1 LWD_192
    s_sub_u32 s80, s80, 1
    s_cmp_lg_u32 s80, 0
    s_cbranch_scc1 LW_191
LWD_192:
    buffer_store_dwordx2 v[44:45], v8, s[36:39], 0 offen sc1
    s_cmp_lg_u32 s6, 0
    s_cbranch_scc1 BM2_193
    s_mov_b64 exec, 15
    buffer_store_dwordx4 v[36:39], v9, s[36:39], 0 offen sc1
    s_mov_b64 exec, -1
BM2_193:
    v_mov_b32 v160, 0x24218
    v_mov_b32 v161, 1
    s_mov_b64 exec, 1
    ds_add_u32 v160, v161
    s_mov_b64 exec, -1
    s_lshl_b32 s7, s67, 13
    s_lshl_b32 s63, s6, 10
    s_add_u32 s7, s7, s63
    s_add_u32 s7, s7, 0xc0000
    v_lshl_add_u32 v4, v1, 4, s7
    v_lshrrev_b32 v160, 2, v3
    v_mul_u32_u24 v5, 1088, v160
    v_and_b32 v160, 3, v1
    v_lshl_add_u32 v5, v160, 4, v5
    v_lshrrev_b32 v161, 5, v1
    v_lshl_add_u32 v5, v161, 6, v5
    v_and_b32 v161, 1, v2
    v_lshl_add_u32 v5, v161, 3, v5
    s_lshl_b32 s7, s6, 7
    s_add_u32 s7, s7, 0x26000
    v_add_u32 v5, s7, v5
    v_mul_u32_u24 v6, 1088, v160
    v_lshl_add_u32 v6, v2, 4, v6
    v_add_u32 v6, 0x26000, v6
    s_lshl_b32 s7, s68, 2
    s_add_u32 s7, s7, s6
    s_lshl_b32 s7, s7, 3
    s_add_u32 s7, s7, s67
    s_lshl_b32 s7, s7, 8
    s_add_u32 s7, s7, 0x2c0000
    v_lshl_add_u32 v7, v160, 6, s7
    v_lshl_add_u32 v7, v2, 4, v7
    v_cmp_gt_u32 s[84:85], 4, v3
    v_bfe_u32 v8, v1, 3, 2
    v_xor_b32 v8, s6, v8
    v_lshlrev_b32 v8, 5, v8
    v_lshrrev_b32 v161, 2, v1
    v_lshl_add_u32 v8, v161, 7, v8
    v_lshl_add_u32 v8, v160, 3, v8
    s_cmp_ge_u32 s6, 4
    s_cbranch_scc1 W4_194
    v_add_u32 v9, 114688, v8
    v_mov_b32 v162, 0x24000
    s_mov_b32 s80, 1600000
LW_195:
    ds_read_b32 v163, v162
    s_waitcnt lgkmcnt(0)
    v_readfirstlane_b32 s79, v163
    s_cmp_ge_u32 s79, 288
    s_cbranch_scc1 LWD_196
    s_sleep 1
    s_sub_u32 s80, s80, 1
    s_cmp_lg_u32 s80, 0
    s_cbranch_scc1 LW_195
LWD_196:
    ds_read_b64_tr_b16 v[48:49], v9 offset:0
    ds_read_b64_tr_b16 v[50:51], v9 offset:2048
    ds_read_b64_tr_b16 v[52:53], v9 offset:4096
    ds_read_b64_tr_b16 v[54:55], v9 offset:6144
    ds_read_b64_tr_b16 v[56:57], v9 offset:8192
    ds_read_b64_tr_b16 v[58:59], v9 offset:10240
    ds_read_b64_tr_b16 v[60:61], v9 offset:12288
    ds_read_b64_tr_b16 v[62:63], v9 offset:14336
    s_waitcnt lgkmcnt(4)
    ds_read_b64_tr_b16 v[64:65], v9 offset:16384
    ds_read_b64_tr_b16 v[66:67], v9 offset:18432
    ds_read_b64_tr_b16 v[68:69], v9 offset:20480
    ds_read_b64_tr_b16 v[70:71], v9 offset:22528
    ds_read_b64_tr_b16 v[72:73], v9 offset:24576
    ds_read_b64_tr_b16 v[74:75], v9 offset:26624
    ds_read_b64_tr_b16 v[76:77], v9 offset:28672
    ds_read_b64_tr_b16 v[78:79], v9 offset:30720
    s_waitcnt lgkmcnt(4)
    v_mov_b32 v162, 0x24000
    s_mov_b32 s80, 1600000
LW_197:
    ds_read_b32 v163, v162
    s_waitcnt lgkmcnt(0)
    v_readfirstlane_b32 s79, v163
    s_cmp_ge_u32 s79, 320
    s_cbranch_scc1 LWD_198
    s_sleep 1
    s_sub_u32 s80, s80, 1
    s_cmp_lg_u32 s80, 0
    s_cbranch_scc1 LW_197
LWD_198:
    ds_read_b64_tr_b16 v[80:81], v8 offset:0
    ds_read_b64_tr_b16 v[82:83], v8 offset:2048
    ds_read_b64_tr_b16 v[84:85], v8 offset:4096
    ds_read_b64_tr_b16 v[86:87], v8 offset:6144
    ds_read_b64_tr_b16 v[88:89], v8 offset:8192
    ds_read_b64_tr_b16 v[90:91], v8 offset:10240
    ds_read_b64_tr_b16 v[92:93], v8 offset:12288
    ds_read_b64_tr_b16 v[94:95], v8 offset:14336
    s_waitcnt lgkmcnt(4)
    ds_read_b64_tr_b16 v[96:97], v8 offset:16384
    ds_read_b64_tr_b16 v[98:99], v8 offset:18432
    ds_read_b64_tr_b16 v[100:101], v8 offset:20480
    ds_read_b64_tr_b16 v[102:103], v8 offset:22528
    ds_read_b64_tr_b16 v[104:105], v8 offset:24576
    ds_read_b64_tr_b16 v[106:107], v8 offset:26624
    ds_read_b64_tr_b16 v[108:109], v8 offset:28672
    ds_read_b64_tr_b16 v[110:111], v8 offset:30720
    s_waitcnt lgkmcnt(4)
W4_194:
    s_mov_b64 exec, -1
    buffer_load_dwordx4 v[16:19], v4, s[36:39], 0 offen sc1 nt
    s_mov_b32 s80, 200000
MC_200:
    s_mov_b64 exec, -1
    s_waitcnt vmcnt(0)
    v_cmp_ne_u64 s[86:87], s[92:93], v[18:19]
    s_cmp_lg_u64 s[86:87], 0
    s_cbranch_scc1 M_199
MD_201:
    s_mov_b64 exec, -1
    ds_write_b64 v5, v[16:17]
    s_add_u32 s81, s81, 8
    v_mov_b32 v160, 0x2420c
    v_mov_b32 v161, 1
    s_mov_b64 exec, 1
    ds_add_u32 v160, v161
    s_mov_b64 exec, -1
    s_cmp_ge_u32 s6, 4
    s_cbranch_scc1 L_END
    v_mov_b32 v160, 0x2420c
    s_mov_b32 s80, 1600000
LW_202:
    ds_read_b32 v161, v160
    s_waitcnt lgkmcnt(0)
    v_readfirstlane_b32 s79, v161
    s_cmp_ge_u32 s79, s81
    s_cbranch_scc1 LWD_203
    s_sub_u32 s80, s80, 1
    s_cmp_lg_u32 s80, 0
    s_cbranch_scc1 LW_202
LWD_203:
    ds_read_b128 v[112:115], v6 offset:0
    ds_read_b128 v[116:119], v6 offset:64
    ds_read_b128 v[120:123], v6 offset:128
    ds_read_b128 v[124:127], v6 offset:192
    ds_read_b128 v[128:131], v6 offset:256
    ds_read_b128 v[132:135], v6 offset:320
    ds_read_b128 v[136:139], v6 offset:384
    ds_read_b128 v[140:143], v6 offset:448
    ds_read_b128 v[144:147], v6 offset:512
    ds_read_b128 v[148:151], v6 offset:576
    ds_read_b128 v[152:155], v6 offset:640
    ds_read_b128 v[156:159], v6 offset:704
    s_waitcnt lgkmcnt(8)
    ds_read_b128 v[20:23], v6 offset:768
    ds_read_b128 v[24:27], v6 offset:832
    ds_read_b128 v[28:31], v6 offset:896
    ds_read_b128 v[32:35], v6 offset:960
    v_mfma_f32_16x16x32_bf16 v[12:15], v[48:51], v[112:115], 0
    v_mfma_f32_16x16x32_bf16 v[12:15], v[52:55], v[116:119], v[12:15]
    v_mfma_f32_16x16x32_bf16 v[12:15], v[56:59], v[120:123], v[12:15]
    v_mfma_f32_16x16x32_bf16 v[12:15], v[60:63], v[124:127], v[12:15]
    s_waitcnt lgkmcnt(11)
    v_mfma_f32_16x16x32_bf16 v[12:15], v[64:67], v[128:131], v[12:15]
    s_waitcnt lgkmcnt(10)
    v_mfma_f32_16x16x32_bf16 v[12:15], v[68:71], v[132:135], v[12:15]
    s_waitcnt lgkmcnt(9)
    v_mfma_f32_16x16x32_bf16 v[12:15], v[72:75], v[136:139], v[12:15]
    s_waitcnt lgkmcnt(8)
    v_mfma_f32_16x16x32_bf16 v[12:15], v[76:79], v[140:143], v[12:15]
    s_waitcnt lgkmcnt(7)
    v_mfma_f32_16x16x32_bf16 v[12:15], v[80:83], v[144:147], v[12:15]
    s_waitcnt lgkmcnt(6)
    v_mfma_f32_16x16x32_bf16 v[12:15], v[84:87], v[148:151], v[12:15]
    s_waitcnt lgkmcnt(5)
    v_mfma_f32_16x16x32_bf16 v[12:15], v[88:91], v[152:155], v[12:15]
    s_waitcnt lgkmcnt(4)
    v_mfma_f32_16x16x32_bf16 v[12:15], v[92:95], v[156:159], v[12:15]
    s_waitcnt lgkmcnt(3)
    v_mfma_f32_16x16x32_bf16 v[12:15], v[96:99], v[20:23], v[12:15]
    s_waitcnt lgkmcnt(2)
    v_mfma_f32_16x16x32_bf16 v[12:15], v[100:103], v[24:27], v[12:15]
    s_waitcnt lgkmcnt(1)
    v_mfma_f32_16x16x32_bf16 v[12:15], v[104:107], v[28:31], v[12:15]
    s_waitcnt lgkmcnt(0)
    v_mfma_f32_16x16x32_bf16 v[12:15], v[108:111], v[32:35], v[12:15]
    s_nop 7
    v_cvt_pk_bf16_f32 v16, v12, v13
    v_cvt_pk_bf16_f32 v17, v14, v15
    s_mov_b64 exec, s[84:85]
    buffer_store_dwordx4 v[16:19], v7, s[36:39], 0 offen sc1
    s_mov_b64 exec, -1
    v_mov_b32 v160, 0x24214
    v_mov_b32 v161, 1
    s_mov_b64 exec, 1
    ds_add_u32 v160, v161
    s_mov_b64 exec, -1
    s_endpgm
SU_9:
    s_nop 3
    buffer_store_dwordx4 v[72:75], v4, s[36:39], 0 offen sc1
    buffer_store_dwordx4 v[64:67], v5, s[36:39], 0 offen sc1
    s_branch SV_10
ST_16:
    ds_read_b32 v18, v17
    s_waitcnt lgkmcnt(0)
    v_readlane_b32 s79, v18, s62
    s_cmp_ge_u32 s79, s63
    s_cbranch_scc1 GO_15
    s_waitcnt vmcnt(16)
    s_sub_u32 s7, s60, 16
    s_max_i32 s61, s61, s7
    v_mov_b32 v19, s61
    ds_write_b32 v16, v19
    ds_read_b32 v18, v17
    s_waitcnt lgkmcnt(0)
    v_readlane_b32 s79, v18, s62
    s_cmp_ge_u32 s79, s63
    s_cbranch_scc1 GO_15
    s_waitcnt vmcnt(8)
    s_sub_u32 s7, s60, 8
    s_max_i32 s61, s61, s7
    v_mov_b32 v19, s61
    ds_write_b32 v16, v19
    ds_read_b32 v18, v17
    s_waitcnt lgkmcnt(0)
    v_readlane_b32 s79, v18, s62
    s_cmp_ge_u32 s79, s63
    s_cbranch_scc1 GO_15
    s_waitcnt vmcnt(0)
    s_mov_b32 s61, s60
    v_mov_b32 v19, s61
    ds_write_b32 v16, v19
    ds_read_b32 v18, v17
    s_waitcnt lgkmcnt(0)
    v_readlane_b32 s79, v18, s62
    s_cmp_ge_u32 s79, s63
    s_cbranch_scc1 GO_15
    s_mov_b32 s80, 1600000
SP_204:
    ds_read_b32 v18, v17
    s_waitcnt lgkmcnt(0)
    v_readlane_b32 s79, v18, s62
    s_cmp_ge_u32 s79, s63
    s_cbranch_scc1 GO_15
    s_sub_u32 s80, s80, 1
    s_cmp_lg_u32 s80, 0
    s_cbranch_scc1 SP_204
    s_branch GO_15
ST_19:
    ds_read_b32 v18, v17
    s_waitcnt lgkmcnt(0)
    v_readlane_b32 s79, v18, s62
    s_cmp_ge_u32 s79, s63
    s_cbranch_scc1 GO_18
    s_waitcnt vmcnt(16)
    s_sub_u32 s7, s60, 16
    s_max_i32 s61, s61, s7
    v_mov_b32 v19, s61
    ds_write_b32 v16, v19
    ds_read_b32 v18, v17
    s_waitcnt lgkmcnt(0)
    v_readlane_b32 s79, v18, s62
    s_cmp_ge_u32 s79, s63
    s_cbranch_scc1 GO_18
    s_waitcnt vmcnt(8)
    s_sub_u32 s7, s60, 8
    s_max_i32 s61, s61, s7
    v_mov_b32 v19, s61
    ds_write_b32 v16, v19
    ds_read_b32 v18, v17
    s_waitcnt lgkmcnt(0)
    v_readlane_b32 s79, v18, s62
    s_cmp_ge_u32 s79, s63
    s_cbranch_scc1 GO_18
    s_waitcnt vmcnt(0)
    s_mov_b32 s61, s60
    v_mov_b32 v19, s61
    ds_write_b32 v16, v19
    ds_read_b32 v18, v17
    s_waitcnt lgkmcnt(0)
    v_readlane_b32 s79, v18, s62
    s_cmp_ge_u32 s79, s63
    s_cbranch_scc1 GO_18
    s_mov_b32 s80, 1600000
SP_205:
    ds_read_b32 v18, v17
    s_waitcnt lgkmcnt(0)
    v_readlane_b32 s79, v18, s62
    s_cmp_ge_u32 s79, s63
    s_cbranch_scc1 GO_18
    s_sub_u32 s80, s80, 1
    s_cmp_lg_u32 s80, 0
    s_cbranch_scc1 SP_205
    s_branch GO_18
ST_22:
    ds_read_b32 v18, v17
    s_waitcnt lgkmcnt(0)
    v_readlane_b32 s79, v18, s62
    s_cmp_ge_u32 s79, s63
    s_cbranch_scc1 GO_21
    s_waitcnt vmcnt(16)
    s_sub_u32 s7, s60, 16
    s_max_i32 s61, s61, s7
    v_mov_b32 v19, s61
    ds_write_b32 v16, v19
    ds_read_b32 v18, v17
    s_waitcnt lgkmcnt(0)
    v_readlane_b32 s79, v18, s62
    s_cmp_ge_u32 s79, s63
    s_cbranch_scc1 GO_21
    s_waitcnt vmcnt(8)
    s_sub_u32 s7, s60, 8
    s_max_i32 s61, s61, s7
    v_mov_b32 v19, s61
    ds_write_b32 v16, v19
    ds_read_b32 v18, v17
    s_waitcnt lgkmcnt(0)
    v_readlane_b32 s79, v18, s62
    s_cmp_ge_u32 s79, s63
    s_cbranch_scc1 GO_21
    s_waitcnt vmcnt(0)
    s_mov_b32 s61, s60
    v_mov_b32 v19, s61
    ds_write_b32 v16, v19
    ds_read_b32 v18, v17
    s_waitcnt lgkmcnt(0)
    v_readlane_b32 s79, v18, s62
    s_cmp_ge_u32 s79, s63
    s_cbranch_scc1 GO_21
    s_mov_b32 s80, 1600000
SP_206:
    ds_read_b32 v18, v17
    s_waitcnt lgkmcnt(0)
    v_readlane_b32 s79, v18, s62
    s_cmp_ge_u32 s79, s63
    s_cbranch_scc1 GO_21
    s_sub_u32 s80, s80, 1
    s_cmp_lg_u32 s80, 0
    s_cbranch_scc1 SP_206
    s_branch GO_21
ST_25:
    ds_read_b32 v18, v17
    s_waitcnt lgkmcnt(0)
    v_readlane_b32 s79, v18, s62
    s_cmp_ge_u32 s79, s63
    s_cbranch_scc1 GO_24
    s_waitcnt vmcnt(24)
    s_sub_u32 s7, s60, 24
    s_max_i32 s61, s61, s7
    v_mov_b32 v19, s61
    ds_write_b32 v16, v19
    ds_read_b32 v18, v17
    s_waitcnt lgkmcnt(0)
    v_readlane_b32 s79, v18, s62
    s_cmp_ge_u32 s79, s63
    s_cbranch_scc1 GO_24
    s_waitcnt vmcnt(16)
    s_sub_u32 s7, s60, 16
    s_max_i32 s61, s61, s7
    v_mov_b32 v19, s61
    ds_write_b32 v16, v19
    ds_read_b32 v18, v17
    s_waitcnt lgkmcnt(0)
    v_readlane_b32 s79, v18, s62
    s_cmp_ge_u32 s79, s63
    s_cbranch_scc1 GO_24
    s_waitcnt vmcnt(8)
    s_sub_u32 s7, s60, 8
    s_max_i32 s61, s61, s7
    v_mov_b32 v19, s61
    ds_write_b32 v16, v19
    ds_read_b32 v18, v17
    s_waitcnt lgkmcnt(0)
    v_readlane_b32 s79, v18, s62
    s_cmp_ge_u32 s79, s63
    s_cbranch_scc1 GO_24
    s_waitcnt vmcnt(0)
    s_mov_b32 s61, s60
    v_mov_b32 v19, s61
    ds_write_b32 v16, v19
    ds_read_b32 v18, v17
    s_waitcnt lgkmcnt(0)
    v_readlane_b32 s79, v18, s62
    s_cmp_ge_u32 s79, s63
    s_cbranch_scc1 GO_24
    s_mov_b32 s80, 1600000
SP_207:
    ds_read_b32 v18, v17
    s_waitcnt lgkmcnt(0)
    v_readlane_b32 s79, v18, s62
    s_cmp_ge_u32 s79, s63
    s_cbranch_scc1 GO_24
    s_sub_u32 s80, s80, 1
    s_cmp_lg_u32 s80, 0
    s_cbranch_scc1 SP_207
    s_branch GO_24
ST_28:
    ds_read_b32 v18, v17
    s_waitcnt lgkmcnt(0)
    v_readlane_b32 s79, v18, s62
    s_cmp_ge_u32 s79, s63
    s_cbranch_scc1 GO_27
    s_waitcnt vmcnt(32)
    s_sub_u32 s7, s60, 32
    s_max_i32 s61, s61, s7
    v_mov_b32 v19, s61
    ds_write_b32 v16, v19
    ds_read_b32 v18, v17
    s_waitcnt lgkmcnt(0)
    v_readlane_b32 s79, v18, s62
    s_cmp_ge_u32 s79, s63
    s_cbranch_scc1 GO_27
    s_waitcnt vmcnt(24)
    s_sub_u32 s7, s60, 24
    s_max_i32 s61, s61, s7
    v_mov_b32 v19, s61
    ds_write_b32 v16, v19
    ds_read_b32 v18, v17
    s_waitcnt lgkmcnt(0)
    v_readlane_b32 s79, v18, s62
    s_cmp_ge_u32 s79, s63
    s_cbranch_scc1 GO_27
    s_waitcnt vmcnt(16)
    s_sub_u32 s7, s60, 16
    s_max_i32 s61, s61, s7
    v_mov_b32 v19, s61
    ds_write_b32 v16, v19
    ds_read_b32 v18, v17
    s_waitcnt lgkmcnt(0)
    v_readlane_b32 s79, v18, s62
    s_cmp_ge_u32 s79, s63
    s_cbranch_scc1 GO_27
    s_waitcnt vmcnt(8)
    s_sub_u32 s7, s60, 8
    s_max_i32 s61, s61, s7
    v_mov_b32 v19, s61
    ds_write_b32 v16, v19
    ds_read_b32 v18, v17
    s_waitcnt lgkmcnt(0)
    v_readlane_b32 s79, v18, s62
    s_cmp_ge_u32 s79, s63
    s_cbranch_scc1 GO_27
    s_waitcnt vmcnt(0)
    s_mov_b32 s61, s60
    v_mov_b32 v19, s61
    ds_write_b32 v16, v19
    ds_read_b32 v18, v17
    s_waitcnt lgkmcnt(0)
    v_readlane_b32 s79, v18, s62
    s_cmp_ge_u32 s79, s63
    s_cbranch_scc1 GO_27
    s_mov_b32 s80, 1600000
SP_208:
    ds_read_b32 v18, v17
    s_waitcnt lgkmcnt(0)
    v_readlane_b32 s79, v18, s62
    s_cmp_ge_u32 s79, s63
    s_cbranch_scc1 GO_27
    s_sub_u32 s80, s80, 1
    s_cmp_lg_u32 s80, 0
    s_cbranch_scc1 SP_208
    s_branch GO_27
M_33:
    s_sub_u32 s80, s80, 1
    s_cmp_le_u32 s80, 0
    s_cbranch_scc1 MD_35
    s_mov_b64 exec, s[62:63]
    s_cbranch_execz RS_209
    buffer_load_dwordx4 v[48:51], v36, s[36:39], 0 offen offset:0 sc1
RS_209:
    s_mov_b64 exec, s[64:65]
    s_cbranch_execz RS_210
    buffer_load_dwordx4 v[52:55], v36, s[36:39], 0 offen offset:1024 sc1
RS_210:
    s_mov_b64 exec, s[66:67]
    s_cbranch_execz RS_211
    buffer_load_dwordx4 v[56:59], v36, s[36:39], 0 offen offset:2048 sc1
RS_211:
    s_mov_b64 exec, s[68:69]
    s_cbranch_execz RS_212
    buffer_load_dwordx4 v[60:63], v36, s[36:39], 0 offen offset:3072 sc1
RS_212:
    s_branch MC_34
ST_42:
    ds_read_b32 v18, v17
    s_waitcnt lgkmcnt(0)
    v_readlane_b32 s79, v18, s62
    s_cmp_ge_u32 s79, s63
    s_cbranch_scc1 GO_41
    s_waitcnt vmcnt(16)
    s_sub_u32 s7, s60, 16
    s_max_i32 s61, s61, s7
    v_mov_b32 v19, s61
    ds_write_b32 v16, v19
    ds_read_b32 v18, v17
    s_waitcnt lgkmcnt(0)
    v_readlane_b32 s79, v18, s62
    s_cmp_ge_u32 s79, s63
    s_cbranch_scc1 GO_41
    s_waitcnt vmcnt(8)
    s_sub_u32 s7, s60, 8
    s_max_i32 s61, s61, s7
    v_mov_b32 v19, s61
    ds_write_b32 v16, v19
    ds_read_b32 v18, v17
    s_waitcnt lgkmcnt(0)
    v_readlane_b32 s79, v18, s62
    s_cmp_ge_u32 s79, s63
    s_cbranch_scc1 GO_41
    s_waitcnt vmcnt(0)
    s_mov_b32 s61, s60
    v_mov_b32 v19, s61
    ds_write_b32 v16, v19
    ds_read_b32 v18, v17
    s_waitcnt lgkmcnt(0)
    v_readlane_b32 s79, v18, s62
    s_cmp_ge_u32 s79, s63
    s_cbranch_scc1 GO_41
    s_mov_b32 s80, 1600000
SP_213:
    ds_read_b32 v18, v17
    s_waitcnt lgkmcnt(0)
    v_readlane_b32 s79, v18, s62
    s_cmp_ge_u32 s79, s63
    s_cbranch_scc1 GO_41
    s_sub_u32 s80, s80, 1
    s_cmp_lg_u32 s80, 0
    s_cbranch_scc1 SP_213
    s_branch GO_41
ST_45:
    ds_read_b32 v18, v17
    s_waitcnt lgkmcnt(0)
    v_readlane_b32 s79, v18, s62
    s_cmp_ge_u32 s79, s63
    s_cbranch_scc1 GO_44
    s_waitcnt vmcnt(16)
    s_sub_u32 s7, s60, 16
    s_max_i32 s61, s61, s7
    v_mov_b32 v19, s61
    ds_write_b32 v16, v19
    ds_read_b32 v18, v17
    s_waitcnt lgkmcnt(0)
    v_readlane_b32 s79, v18, s62
    s_cmp_ge_u32 s79, s63
    s_cbranch_scc1 GO_44
    s_waitcnt vmcnt(8)
    s_sub_u32 s7, s60, 8
    s_max_i32 s61, s61, s7
    v_mov_b32 v19, s61
    ds_write_b32 v16, v19
    ds_read_b32 v18, v17
    s_waitcnt lgkmcnt(0)
    v_readlane_b32 s79, v18, s62
    s_cmp_ge_u32 s79, s63
    s_cbranch_scc1 GO_44
    s_waitcnt vmcnt(0)
    s_mov_b32 s61, s60
    v_mov_b32 v19, s61
    ds_write_b32 v16, v19
    ds_read_b32 v18, v17
    s_waitcnt lgkmcnt(0)
    v_readlane_b32 s79, v18, s62
    s_cmp_ge_u32 s79, s63
    s_cbranch_scc1 GO_44
    s_mov_b32 s80, 1600000
SP_214:
    ds_read_b32 v18, v17
    s_waitcnt lgkmcnt(0)
    v_readlane_b32 s79, v18, s62
    s_cmp_ge_u32 s79, s63
    s_cbranch_scc1 GO_44
    s_sub_u32 s80, s80, 1
    s_cmp_lg_u32 s80, 0
    s_cbranch_scc1 SP_214
    s_branch GO_44
ST_48:
    ds_read_b32 v18, v17
    s_waitcnt lgkmcnt(0)
    v_readlane_b32 s79, v18, s62
    s_cmp_ge_u32 s79, s63
    s_cbranch_scc1 GO_47
    s_waitcnt vmcnt(24)
    s_sub_u32 s7, s60, 24
    s_max_i32 s61, s61, s7
    v_mov_b32 v19, s61
    ds_write_b32 v16, v19
    ds_read_b32 v18, v17
    s_waitcnt lgkmcnt(0)
    v_readlane_b32 s79, v18, s62
    s_cmp_ge_u32 s79, s63
    s_cbranch_scc1 GO_47
    s_waitcnt vmcnt(16)
    s_sub_u32 s7, s60, 16
    s_max_i32 s61, s61, s7
    v_mov_b32 v19, s61
    ds_write_b32 v16, v19
    ds_read_b32 v18, v17
    s_waitcnt lgkmcnt(0)
    v_readlane_b32 s79, v18, s62
    s_cmp_ge_u32 s79, s63
    s_cbranch_scc1 GO_47
    s_waitcnt vmcnt(8)
    s_sub_u32 s7, s60, 8
    s_max_i32 s61, s61, s7
    v_mov_b32 v19, s61
    ds_write_b32 v16, v19
    ds_read_b32 v18, v17
    s_waitcnt lgkmcnt(0)
    v_readlane_b32 s79, v18, s62
    s_cmp_ge_u32 s79, s63
    s_cbranch_scc1 GO_47
    s_waitcnt vmcnt(0)
    s_mov_b32 s61, s60
    v_mov_b32 v19, s61
    ds_write_b32 v16, v19
    ds_read_b32 v18, v17
    s_waitcnt lgkmcnt(0)
    v_readlane_b32 s79, v18, s62
    s_cmp_ge_u32 s79, s63
    s_cbranch_scc1 GO_47
    s_mov_b32 s80, 1600000
SP_215:
    ds_read_b32 v18, v17
    s_waitcnt lgkmcnt(0)
    v_readlane_b32 s79, v18, s62
    s_cmp_ge_u32 s79, s63
    s_cbranch_scc1 GO_47
    s_sub_u32 s80, s80, 1
    s_cmp_lg_u32 s80, 0
    s_cbranch_scc1 SP_215
    s_branch GO_47
ST_51:
    ds_read_b32 v18, v17
    s_waitcnt lgkmcnt(0)
    v_readlane_b32 s79, v18, s62
    s_cmp_ge_u32 s79, s63
    s_cbranch_scc1 GO_50
    s_waitcnt vmcnt(32)
    s_sub_u32 s7, s60, 32
    s_max_i32 s61, s61, s7
    v_mov_b32 v19, s61
    ds_write_b32 v16, v19
    ds_read_b32 v18, v17
    s_waitcnt lgkmcnt(0)
    v_readlane_b32 s79, v18, s62
    s_cmp_ge_u32 s79, s63
    s_cbranch_scc1 GO_50
    s_waitcnt vmcnt(24)
    s_sub_u32 s7, s60, 24
    s_max_i32 s61, s61, s7
    v_mov_b32 v19, s61
    ds_write_b32 v16, v19
    ds_read_b32 v18, v17
    s_waitcnt lgkmcnt(0)
    v_readlane_b32 s79, v18, s62
    s_cmp_ge_u32 s79, s63
    s_cbranch_scc1 GO_50
    s_waitcnt vmcnt(16)
    s_sub_u32 s7, s60, 16
    s_max_i32 s61, s61, s7
    v_mov_b32 v19, s61
    ds_write_b32 v16, v19
    ds_read_b32 v18, v17
    s_waitcnt lgkmcnt(0)
    v_readlane_b32 s79, v18, s62
    s_cmp_ge_u32 s79, s63
    s_cbranch_scc1 GO_50
    s_waitcnt vmcnt(8)
    s_sub_u32 s7, s60, 8
    s_max_i32 s61, s61, s7
    v_mov_b32 v19, s61
    ds_write_b32 v16, v19
    ds_read_b32 v18, v17
    s_waitcnt lgkmcnt(0)
    v_readlane_b32 s79, v18, s62
    s_cmp_ge_u32 s79, s63
    s_cbranch_scc1 GO_50
    s_waitcnt vmcnt(0)
    s_mov_b32 s61, s60
    v_mov_b32 v19, s61
    ds_write_b32 v16, v19
    ds_read_b32 v18, v17
    s_waitcnt lgkmcnt(0)
    v_readlane_b32 s79, v18, s62
    s_cmp_ge_u32 s79, s63
    s_cbranch_scc1 GO_50
    s_mov_b32 s80, 1600000
SP_216:
    ds_read_b32 v18, v17
    s_waitcnt lgkmcnt(0)
    v_readlane_b32 s79, v18, s62
    s_cmp_ge_u32 s79, s63
    s_cbranch_scc1 GO_50
    s_sub_u32 s80, s80, 1
    s_cmp_lg_u32 s80, 0
    s_cbranch_scc1 SP_216
    s_branch GO_50
ST_57:
    ds_read_b32 v18, v17
    s_waitcnt lgkmcnt(0)
    v_readlane_b32 s79, v18, s62
    s_cmp_ge_u32 s79, s63
    s_cbranch_scc1 GO_56
    s_waitcnt vmcnt(24)
    s_sub_u32 s7, s60, 24
    s_max_i32 s61, s61, s7
    v_mov_b32 v19, s61
    ds_write_b32 v16, v19
    ds_read_b32 v18, v17
    s_waitcnt lgkmcnt(0)
    v_readlane_b32 s79, v18, s62
    s_cmp_ge_u32 s79, s63
    s_cbranch_scc1 GO_56
    s_waitcnt vmcnt(16)
    s_sub_u32 s7, s60, 16
    s_max_i32 s61, s61, s7
    v_mov_b32 v19, s61
    ds_write_b32 v16, v19
    ds_read_b32 v18, v17
    s_waitcnt lgkmcnt(0)
    v_readlane_b32 s79, v18, s62
    s_cmp_ge_u32 s79, s63
    s_cbranch_scc1 GO_56
    s_waitcnt vmcnt(8)
    s_sub_u32 s7, s60, 8
    s_max_i32 s61, s61, s7
    v_mov_b32 v19, s61
    ds_write_b32 v16, v19
    ds_read_b32 v18, v17
    s_waitcnt lgkmcnt(0)
    v_readlane_b32 s79, v18, s62
    s_cmp_ge_u32 s79, s63
    s_cbranch_scc1 GO_56
    s_waitcnt vmcnt(0)
    s_mov_b32 s61, s60
    v_mov_b32 v19, s61
    ds_write_b32 v16, v19
    ds_read_b32 v18, v17
    s_waitcnt lgkmcnt(0)
    v_readlane_b32 s79, v18, s62
    s_cmp_ge_u32 s79, s63
    s_cbranch_scc1 GO_56
    s_mov_b32 s80, 1600000
SP_217:
    ds_read_b32 v18, v17
    s_waitcnt lgkmcnt(0)
    v_readlane_b32 s79, v18, s62
    s_cmp_ge_u32 s79, s63
    s_cbranch_scc1 GO_56
    s_sub_u32 s80, s80, 1
    s_cmp_lg_u32 s80, 0
    s_cbranch_scc1 SP_217
    s_branch GO_56
ST_59:
    ds_read_b32 v18, v17
    s_waitcnt lgkmcnt(0)
    v_readlane_b32 s79, v18, 0
    s_cmp_ge_u32 s79, s63
    s_cbranch_scc1 GO_58
    s_waitcnt vmcnt(24)
    s_sub_u32 s7, s60, 24
    s_max_i32 s61, s61, s7
    v_mov_b32 v19, s61
    ds_write_b32 v16, v19
    ds_read_b32 v18, v17
    s_waitcnt lgkmcnt(0)
    v_readlane_b32 s79, v18, 0
    s_cmp_ge_u32 s79, s63
    s_cbranch_scc1 GO_58
    s_waitcnt vmcnt(16)
    s_sub_u32 s7, s60, 16
    s_max_i32 s61, s61, s7
    v_mov_b32 v19, s61
    ds_write_b32 v16, v19
    ds_read_b32 v18, v17
    s_waitcnt lgkmcnt(0)
    v_readlane_b32 s79, v18, 0
    s_cmp_ge_u32 s79, s63
    s_cbranch_scc1 GO_58
    s_waitcnt vmcnt(8)
    s_sub_u32 s7, s60, 8
    s_max_i32 s61, s61, s7
    v_mov_b32 v19, s61
    ds_write_b32 v16, v19
    ds_read_b32 v18, v17
    s_waitcnt lgkmcnt(0)
    v_readlane_b32 s79, v18, 0
    s_cmp_ge_u32 s79, s63
    s_cbranch_scc1 GO_58
    s_waitcnt vmcnt(0)
    s_mov_b32 s61, s60
    v_mov_b32 v19, s61
    ds_write_b32 v16, v19
    ds_read_b32 v18, v17
    s_waitcnt lgkmcnt(0)
    v_readlane_b32 s79, v18, 0
    s_cmp_ge_u32 s79, s63
    s_cbranch_scc1 GO_58
    s_mov_b32 s80, 1600000
SP_218:
    ds_read_b32 v18, v17
    s_waitcnt lgkmcnt(0)
    v_readlane_b32 s79, v18, 0
    s_cmp_ge_u32 s79, s63
    s_cbranch_scc1 GO_58
    s_sub_u32 s80, s80, 1
    s_cmp_lg_u32 s80, 0
    s_cbranch_scc1 SP_218
    s_branch GO_58
SU_67:
    s_nop 3
    buffer_store_dwordx4 v[40:43], v44, s[36:39], 0 offen sc1
    s_branch SV_68
M_74:
    s_sub_u32 s80, s80, 1
    s_cmp_le_u32 s80, 0
    s_cbranch_scc1 MD_76
    s_mov_b64 exec, s[62:63]
    s_cbranch_execz RS_219
    buffer_load_dwordx4 v[48:51], v36, s[36:39], 0 offen offset:0 sc1
RS_219:
    s_mov_b64 exec, s[64:65]
    s_cbranch_execz RS_220
    buffer_load_dwordx4 v[52:55], v36, s[36:39], 0 offen offset:1024 sc1
RS_220:
    s_branch MC_75
M_94:
    s_sleep 4
    s_sub_u32 s80, s80, 1
    s_cmp_le_u32 s80, 0
    s_cbranch_scc1 MD_96
    s_mov_b64 exec, s[44:45]
    s_cbranch_execz RS_221
    buffer_load_dwordx4 v[48:51], v7, s[36:39], 0 offen sc1 nt
RS_221:
    s_mov_b64 exec, s[46:47]
    s_cbranch_execz RS_222
    buffer_load_dwordx4 v[52:55], v22, s[36:39], 0 offen sc1 nt
RS_222:
    s_branch MC_95
SU_102:
    s_nop 3
    buffer_store_dwordx4 v[64:67], v8, s[36:39], 0 offen sc1
    s_branch SV_103
AW_106:
    s_mov_b64 exec, 0x3f
    s_cmp_eq_u32 s71, 1
    s_cbranch_scc1 AX_223
    buffer_load_dwordx4 v[116:119], v12, s[36:39], 0 offen sc1 nt
    s_mov_b64 exec, -1
    s_branch AWB_107
AX_223:
    s_mov_b32 s80, 200000
    s_branch PP_225
P_224:
    buffer_load_dwordx4 v[116:119], v12, s[36:39], 0 offen sc1 nt
PP_225:
    s_waitcnt vmcnt(0)
    v_cmp_ne_u64 s[90:91], s[92:93], v[118:119]
    s_cmp_lg_u64 s[90:91], 0
    s_cbranch_scc0 PD_226
    s_sleep 2
    s_sub_u32 s80, s80, 1
    s_cmp_lg_u32 s80, 0
    s_cbranch_scc1 P_224
PD_226:
    s_mov_b64 exec, -1
    v_mov_b32 v118, v116
    s_nop 1
    v_max_f32_dpp v118, v118, v118 row_ror:1 row_mask:0xf bank_mask:0xf
    s_nop 1
    v_max_f32_dpp v118, v118, v118 row_ror:2 row_mask:0xf bank_mask:0xf
    s_nop 1
    v_max_f32_dpp v118, v118, v118 row_ror:4 row_mask:0xf bank_mask:0xf
    s_nop 1
    v_max_f32_dpp v118, v118, v118 row_ror:8 row_mask:0xf bank_mask:0xf
    v_sub_f32 v116, v116, v118
    v_sub_f32 v119, v64, v118
    v_exp_f32 v116, v116
    v_exp_f32 v119, v119
    v_mul_f32 v116, v116, v117
    s_nop 1
    v_add_f32_dpp v116, v116, v116 row_ror:1 row_mask:0xf bank_mask:0xf
    s_nop 1
    v_add_f32_dpp v116, v116, v116 row_ror:2 row_mask:0xf bank_mask:0xf
    s_nop 1
    v_add_f32_dpp v116, v116, v116 row_ror:4 row_mask:0xf bank_mask:0xf
    s_nop 1
    v_add_f32_dpp v116, v116, v116 row_ror:8 row_mask:0xf bank_mask:0xf
    v_rcp_f32 v116, v116
    s_nop 0
    v_mul_f32 v116, v116, v119
    s_nop 0
    v_readfirstlane_b32 s72, v116
    s_branch AWB_107
SU_110:
    s_nop 3
    buffer_store_dwordx4 v[68:71], v6, s[36:39], 0 offen sc1
    s_branch SV_111
M_118:
    s_sub_u32 s80, s80, 1
    s_cmp_le_u32 s80, 0
    s_cbranch_scc1 MD_120
    s_mov_b64 exec, s[64:65]
    s_cbranch_execz RS_227
    buffer_load_dwordx4 v[112:115], v5, s[36:39], 0 offen sc1 nt
RS_227:
    s_mov_b64 exec, s[66:67]
    s_cbranch_execz RS_228
    buffer_load_dwordx4 v[116:119], v5, s[36:39], s62 offen sc1 nt
RS_228:
    s_mov_b64 exec, s[68:69]
    s_cbranch_execz RS_229
    buffer_load_dwordx4 v[120:123], v5, s[36:39], s63 offen sc1 nt
RS_229:
    s_branch MC_119
M_126:
    s_sub_u32 s80, s80, 1
    s_cmp_le_u32 s80, 199994
    s_cbranch_scc1 G2_123
    s_mov_b64 exec, s[44:45]
    s_cbranch_execz RS_230
    buffer_load_dwordx4 v[48:51], v7, s[36:39], 0 offen sc1 nt
RS_230:
    s_mov_b64 exec, s[46:47]
    s_cbranch_execz RS_231
    buffer_load_dwordx4 v[52:55], v22, s[36:39], 0 offen sc1 nt
RS_231:
    s_branch MC_127
G2_123:
    s_mov_b64 exec, -1
    v_mov_b32 v12, 0x24204
    s_mov_b32 s80, 1600000
LW_232:
    ds_read_b32 v13, v12
    s_waitcnt lgkmcnt(0)
    v_readfirstlane_b32 s79, v13
    s_cmp_ge_u32 s79, 1
    s_cbranch_scc1 LWD_233
    s_sleep 1
    s_sub_u32 s80, s80, 1
    s_cmp_lg_u32 s80, 0
    s_cbranch_scc1 LW_232
LWD_233:
    v_mov_b32 v12, 0x24248
    ds_read_b64 v[14:15], v12
    s_waitcnt lgkmcnt(0)
    v_readfirstlane_b32 s92, v14
    v_readfirstlane_b32 s93, v15
    s_mov_b32 s80, 200000
P_234:
    buffer_load_dwordx4 v[48:51], v7, s[36:39], 0 offen sc1 nt
    buffer_load_dwordx4 v[52:55], v22, s[36:39], 0 offen sc1 nt
PP_235:
    s_waitcnt vmcnt(0)
    s_mov_b64 s[90:91], 0
    v_cmp_gt_u64 s[88:89], s[94:95], v[50:51]
    v_cmp_le_u64 vcc, s[72:73], v[50:51]
    s_or_b64 s[88:89], s[88:89], vcc
    v_cmp_ne_u64 vcc, s[92:93], v[50:51]
    s_and_b64 vcc, vcc, s[88:89]
    s_or_b64 s[90:91], s[90:91], vcc
    v_cmp_gt_u64 s[88:89], s[94:95], v[54:55]
    v_cmp_le_u64 vcc, s[72:73], v[54:55]
    s_or_b64 s[88:89], s[88:89], vcc
    v_cmp_ne_u64 vcc, s[92:93], v[54:55]
    s_and_b64 vcc, vcc, s[88:89]
    s_or_b64 s[90:91], s[90:91], vcc
    s_cbranch_scc0 PD_236
    s_sleep 1
    s_sub_u32 s80, s80, 1
    s_cmp_lg_u32 s80, 0
    s_cbranch_scc1 P_234
PD_236:
    s_branch MD_128
M_143:
    s_sleep 6
    s_sub_u32 s80, s80, 1
    s_cmp_le_u32 s80, 0
    s_cbranch_scc1 MD_145
    s_mov_b64 exec, s[64:65]
    s_cbranch_execz RS_237
    buffer_load_dwordx2 v[12:13], v9, s[36:39], 0 offen sc1 nt
RS_237:
    s_branch MC_144
M_146:
    s_sleep 2
    s_sub_u32 s80, s80, 1
    s_cmp_le_u32 s80, 0
    s_cbranch_scc1 MD_148
    s_mov_b64 exec, s[64:65]
    s_cbranch_execz RS_238
    buffer_load_dwordx2 v[12:13], v9, s[36:39], 0 offen sc1
RS_238:
    s_branch MC_147
M_149:
    s_sub_u32 s80, s80, 1
    s_cmp_le_u32 s80, 0
    s_cbranch_scc1 MD_151
    s_mov_b64 exec, s[64:65]
    s_cbranch_execz RS_239
    buffer_load_dwordx4 v[16:19], v5, s[36:39], 0 offen offset:0 sc1
RS_239:
    s_mov_b64 exec, s[66:67]
    s_cbranch_execz RS_240
    buffer_load_dwordx4 v[20:23], v5, s[36:39], 0 offen offset:1024 sc1
RS_240:
    s_mov_b64 exec, s[68:69]
    s_cbranch_execz RS_241
    buffer_load_dwordx4 v[12:15], v4, s[36:39], 0 offen sc1
RS_241:
    s_branch MC_150
SU_154:
    s_nop 3
    buffer_store_dwordx4 v[16:19], v10, s[36:39], 0 offen sc1
    s_branch SV_155
M_165:
    s_sleep 2
    s_sub_u32 s80, s80, 1
    s_cmp_le_u32 s80, 0
    s_cbranch_scc1 MD_167
    s_mov_b64 exec, s[44:45]
    s_cbranch_execz RS_242
    buffer_load_dwordx2 v[16:17], v100, s[36:39], 0 offen sc1
RS_242:
    s_branch MC_166
M_170:
    s_sleep 1
    s_sub_u32 s80, s80, 1
    s_cmp_le_u32 s80, 0
    s_cbranch_scc1 MD_172
    s_mov_b64 exec, s[44:45]
    s_cbranch_execz RS_243
    buffer_load_dwordx4 v[32:35], v101, s[36:39], 0 offen offset:0 sc1
RS_243:
    s_mov_b64 exec, s[46:47]
    s_cbranch_execz RS_244
    buffer_load_dwordx4 v[36:39], v101, s[36:39], 0 offen offset:1024 sc1
RS_244:
    s_mov_b64 exec, s[48:49]
    s_cbranch_execz RS_245
    buffer_load_dwordx4 v[40:43], v101, s[36:39], 0 offen offset:2048 sc1
RS_245:
    s_mov_b64 exec, s[50:51]
    s_cbranch_execz RS_246
    buffer_load_dwordx4 v[44:47], v101, s[36:39], 0 offen offset:3072 sc1
RS_246:
    s_branch MC_171
SU_184:
    s_nop 3
    buffer_store_dwordx4 v[16:19], v5, s[36:39], 0 offen offset:0 sc1
    buffer_store_dwordx4 v[20:23], v5, s[36:39], 0 offen offset:1024 sc1
    buffer_store_dwordx4 v[24:27], v5, s[36:39], 0 offen offset:2048 sc1
    buffer_store_dwordx4 v[28:31], v5, s[36:39], 0 offen offset:3072 sc1
    s_waitcnt vmcnt(0)
    s_mov_b64 exec, s[88:89]
    buffer_store_dwordx2 v[38:39], v7, s[36:39], 0 offen sc1
    s_mov_b64 exec, -1
    s_branch SV_185
M_186:
    s_sub_u32 s80, s80, 1
    s_cmp_le_u32 s80, 0
    s_cbranch_scc1 MD_188
    s_mov_b64 exec, s[86:87]
    s_cbranch_execz RS_247
    buffer_load_dwordx2 v[40:41], v7, s[36:39], 0 offen sc1 nt
RS_247:
    s_branch MC_187
BL_189:
    s_mov_b32 s80, 200000
P_248:
    buffer_load_dwordx4 v[64:67], v6, s[36:39], 0 offen offset:0 sc1 nt
    buffer_load_dwordx4 v[68:71], v6, s[36:39], 0 offen offset:1024 sc1 nt
    buffer_load_dwordx4 v[72:75], v6, s[36:39], 0 offen offset:2048 sc1 nt
    buffer_load_dwordx4 v[76:79], v6, s[36:39], 0 offen offset:3072 sc1 nt
PP_249:
    s_waitcnt vmcnt(0)
    v_cmp_ne_u64 s[90:91], s[92:93], v[66:67]
    v_cmp_ne_u64 vcc, s[92:93], v[70:71]
    s_or_b64 s[90:91], s[90:91], vcc
    v_cmp_ne_u64 vcc, s[92:93], v[74:75]
    s_or_b64 s[90:91], s[90:91], vcc
    v_cmp_ne_u64 vcc, s[92:93], v[78:79]
    s_or_b64 s[90:91], s[90:91], vcc
    s_cmp_lg_u64 s[90:91], 0
    s_cbranch_scc0 PD_250
    s_sub_u32 s80, s80, 1
    s_cmp_lg_u32 s80, 0
    s_cbranch_scc1 P_248
PD_250:
    s_branch BLD_190
M_199:
    s_sleep 1
    s_sub_u32 s80, s80, 1
    s_cmp_le_u32 s80, 0
    s_cbranch_scc1 MD_201
    s_mov_b64 exec, s[86:87]
    s_cbranch_execz RS_251
    buffer_load_dwordx4 v[16:19], v4, s[36:39], 0 offen sc1 nt
RS_251:
    s_branch MC_200
L_END:
    s_endpgm
.section .rodata,"a"
.p2align 6
.amdhsa_kernel concat_heads__sliding_block_cached__compressed_kv_cla__decode_kernel
  .amdhsa_next_free_vgpr 168
  .amdhsa_next_free_sgpr 102
  .amdhsa_accum_offset 168
  .amdhsa_group_segment_fixed_size 0
  .amdhsa_kernarg_size 112
  .amdhsa_user_sgpr_count 2
  .amdhsa_user_sgpr_kernarg_segment_ptr 1
  .amdhsa_system_sgpr_workgroup_id_x 1
  .amdhsa_float_denorm_mode_32 3
.end_amdhsa_kernel
```

```asm
; @launch grid=(256,1,1) block=(576,1,1) lds=163840
.amdgcn_target "amdgcn-amd-amdhsa--gfx950"
.text
.globl concat_heads__sliding_block_cached__compressed_kv_cla__decode_kernel
.p2align 8
.type concat_heads__sliding_block_cached__compressed_kv_cla__decode_kernel,@function
concat_heads__sliding_block_cached__compressed_kv_cla__decode_kernel:
    s_cmp_ge_u32 s2, 256
    s_cbranch_scc1 L_END
    s_load_dwordx16 s[8:23], s[0:1], 0
    s_load_dwordx8 s[24:31], s[0:1], 64
    s_load_dwordx4 s[32:35], s[0:1], 96
    s_memrealtime s[94:95]
    v_lshrrev_b32 v1, 6, v0
    s_nop 0
    v_readfirstlane_b32 s3, v1
    v_and_b32 v1, 63, v0
    v_lshrrev_b32 v2, 4, v1
    v_and_b32 v3, 15, v1
    s_and_b32 s4, s2, 7
    s_lshr_b32 s7, s2, 6
    s_lshl_b32 s7, s7, 3
    s_or_b32 s4, s4, s7
    s_bfe_u32 s5, s2, 0x30003
    s_getreg_b32 s78, hwreg(HW_REG_XCC_ID, 0, 4)
    s_lshl_b32 s78, s78, 26
    s_xor_b32 s6, s3, 4
    s_cmp_eq_u32 s3, 8
    s_cselect_b32 s7, 8, 0
    s_add_u32 s7, s7, s5
    s_cmp_ge_u32 s7, 14
    s_cbranch_scc1 L_LDB
    s_cmp_ge_u32 s7, 12
    s_cbranch_scc1 L_LDE
    s_cmp_ge_u32 s7, 8
    s_cbranch_scc1 L_LDA
    s_mov_b32 s81, 0
    s_cmp_lt_u32 s6, 4
    s_cbranch_scc1 L_SIDE
    s_cmp_ge_u32 s7, 4
    s_cbranch_scc1 L_QABS
    s_and_b32 s61, s6, 3
    v_lshrrev_b32 v10, 1, v3
    v_xor_b32 v10, v10, v2
    v_lshlrev_b32 v10, 5, v10
    v_lshl_add_u32 v10, v2, 13, v10
    v_and_b32 v40, 1, v1
    v_lshl_add_u32 v10, v40, 4, v10
    v_xor_b32 v11, 0x80, v10
    s_lshl_b32 s65, s5, 20
    s_lshl_b32 s7, s4, 8
    s_add_u32 s65, s65, s7
    s_lshl_b32 s7, s61, 18
    s_add_u32 s65, s65, s7
    s_lshl_b32 s64, s61, 13
    s_add_u32 s64, s64, 0x1c000
    v_and_b32 v8, 3, v1
    v_lshlrev_b32 v9, 10, v8
    v_lshl_add_u32 v9, v2, 4, v9
    s_lshl_b32 s62, s5, 8
    s_waitcnt lgkmcnt(0)
    s_mov_b32 s48, s22
    s_and_b32 s49, s23, 0xffff
    s_mov_b32 s50, 0x400000
    s_mov_b32 s51, 0x20000
    s_mov_b32 s63, s65
    s_mov_b32 m0, s64
    s_add_u32 s64, s64, 1024
    buffer_load_dwordx4 v10, s[48:51], s63 offen nt lds
    s_add_u32 s63, s63, 32768
    s_mov_b32 m0, s64
    s_add_u32 s64, s64, 1024
    buffer_load_dwordx4 v11, s[48:51], s63 offen nt lds
    s_add_u32 s63, s63, 32768
    s_mov_b32 m0, s64
    s_add_u32 s64, s64, 1024
    buffer_load_dwordx4 v10, s[48:51], s63 offen nt lds
    s_add_u32 s63, s63, 32768
    s_mov_b32 m0, s64
    s_add_u32 s64, s64, 1024
    buffer_load_dwordx4 v11, s[48:51], s63 offen nt lds
    s_add_u32 s63, s63, 32768
    s_mov_b32 m0, s64
    s_add_u32 s64, s64, 1024
    buffer_load_dwordx4 v10, s[48:51], s63 offen nt lds
    s_add_u32 s63, s63, 32768
    s_mov_b32 m0, s64
    s_add_u32 s64, s64, 1024
    buffer_load_dwordx4 v11, s[48:51], s63 offen nt lds
    s_add_u32 s63, s63, 32768
    s_mov_b32 m0, s64
    s_add_u32 s64, s64, 1024
    buffer_load_dwordx4 v10, s[48:51], s63 offen nt lds
    s_add_u32 s63, s63, 32768
    s_mov_b32 m0, s64
    s_add_u32 s64, s64, 1024
    buffer_load_dwordx4 v11, s[48:51], s63 offen nt lds
    s_add_u32 s63, s63, 32768
    s_mov_b32 s44, s18
    s_and_b32 s45, s19, 0xffff
    s_mov_b32 s46, 0x1000
    s_mov_b32 s47, 0x20000
    buffer_load_dwordx4 v[128:131], v9, s[44:47], s62 offen offset:0
    buffer_load_dwordx4 v[132:135], v9, s[44:47], s62 offen offset:64
    buffer_load_dwordx4 v[136:139], v9, s[44:47], s62 offen offset:128
    buffer_load_dwordx4 v[140:143], v9, s[44:47], s62 offen offset:192
    s_barrier
    s_mov_b32 s36, s34
    s_and_b32 s37, s35, 0xffff
    s_mov_b32 s38, 0x1000000
    s_mov_b32 s39, 0x20000
    s_lshl_b32 s7, s4, 4
    s_add_u32 s7, s7, s5
    s_lshl_b32 s7, s7, 4
    s_add_u32 s7, s7, s61
    s_lshl_b32 s7, s7, 7
    s_add_u32 s7, s7, 0x100000
    v_lshl_add_u32 v4, v8, 9, s7
    v_lshl_add_u32 v4, v2, 4, v4
    v_and_b32 v12, 4, v1
    v_lshl_add_u32 v4, v12, 4, v4
    v_add_u32 v5, 16384, v4
    v_mov_b32 v16, 0
    s_mov_b64 exec, 15
    buffer_store_dword v16, v5, s[36:39], 0 offen
    buffer_load_dword v16, v5, s[36:39], 0 offen sc1 nt
    s_mov_b64 exec, -1
    s_sub_u32 s64, s64, 40960
    v_cmp_gt_u32 s[84:85], 8, v3
    v_bfe_u32 v21, v1, 2, 2
    v_lshl_add_u32 v20, v2, 3, v21
    s_lshl_b32 s7, s61, 1
    v_xor_b32 v21, s7, v21
    v_lshlrev_b32 v20, 8, v20
    v_lshl_add_u32 v20, v21, 5, v20
    v_lshl_add_u32 v20, v8, 3, v20
    v_add_u32 v20, 0x14000, v20
    v_xor_b32 v21, 32, v20
    v_xor_b32 v22, 0x480, v20
    v_xor_b32 v23, 0x4a0, v20
    s_waitcnt vmcnt(2)
    v_mov_b32 v14, 0x24210
    v_mov_b32 v15, 1
    s_mov_b64 exec, 1
    ds_add_u32 v14, v15
    s_mov_b64 exec, -1
    v_mov_b32 v14, 0x24210
    s_mov_b32 s80, 1600000
LW_1:
    ds_read_b32 v15, v14
    s_waitcnt lgkmcnt(0)
    v_readfirstlane_b32 s79, v15
    s_cmp_ge_u32 s79, 4
    s_cbranch_scc1 LWD_2
    s_sub_u32 s80, s80, 1
    s_cmp_lg_u32 s80, 0
    s_cbranch_scc1 LW_1
LWD_2:
    ds_read_b64_tr_b16 v[32:33], v20 offset:32768
    ds_read_b64_tr_b16 v[34:35], v22 offset:32768
    ds_read_b64_tr_b16 v[36:37], v21 offset:32768
    ds_read_b64_tr_b16 v[38:39], v23 offset:32768
    ds_read_b64_tr_b16 v[40:41], v20 offset:40960
    ds_read_b64_tr_b16 v[42:43], v22 offset:40960
    ds_read_b64_tr_b16 v[44:45], v21 offset:40960
    ds_read_b64_tr_b16 v[46:47], v23 offset:40960
    ds_read_b64_tr_b16 v[48:49], v20 offset:49152
    ds_read_b64_tr_b16 v[50:51], v22 offset:49152
    ds_read_b64_tr_b16 v[52:53], v21 offset:49152
    ds_read_b64_tr_b16 v[54:55], v23 offset:49152
    s_waitcnt lgkmcnt(8)
    ds_read_b64_tr_b16 v[56:57], v20 offset:57344
    ds_read_b64_tr_b16 v[58:59], v22 offset:57344
    ds_read_b64_tr_b16 v[60:61], v21 offset:57344
    ds_read_b64_tr_b16 v[62:63], v23 offset:57344
    s_waitcnt lgkmcnt(12)
    v_mfma_f32_16x16x32_bf16 v[24:27], v[32:35], v[128:131], 0
    v_mfma_f32_16x16x32_bf16 v[28:31], v[36:39], v[128:131], 0
    s_waitcnt lgkmcnt(8)
    v_mfma_f32_16x16x32_bf16 v[24:27], v[40:43], v[132:135], v[24:27]
    v_mfma_f32_16x16x32_bf16 v[28:31], v[44:47], v[132:135], v[28:31]
    s_waitcnt lgkmcnt(4)
    v_mfma_f32_16x16x32_bf16 v[24:27], v[48:51], v[136:139], v[24:27]
    v_mfma_f32_16x16x32_bf16 v[28:31], v[52:55], v[136:139], v[28:31]
    s_waitcnt lgkmcnt(0)
    v_mfma_f32_16x16x32_bf16 v[24:27], v[56:59], v[140:143], v[24:27]
    v_mfma_f32_16x16x32_bf16 v[28:31], v[60:63], v[140:143], v[28:31]
    s_memrealtime s[88:89]
    v_lshlrev_b32 v14, 2, v1
    v_add_u32 v14, 0x24138, v14
    v_mov_b32 v15, 1
    s_mov_b64 exec, 15
    ds_add_u32 v14, v15
    s_mov_b64 exec, -1
    v_cvt_pk_bf16_f32 v64, v24, v25
    v_cvt_pk_bf16_f32 v65, v26, v27
    v_cvt_pk_bf16_f32 v68, v28, v29
    v_cvt_pk_bf16_f32 v69, v30, v31
    s_nop 0
    v_mov_b32_dpp v64, v68 quad_perm:[0,1,2,3] row_mask:0xf bank_mask:0x2
    v_mov_b32_dpp v65, v69 quad_perm:[0,1,2,3] row_mask:0xf bank_mask:0x2
    s_waitcnt lgkmcnt(0)
    s_or_b32 s89, s89, s78
    v_mov_b32 v66, s88
    v_mov_b32 v67, s89
    s_mov_b64 exec, s[84:85]
    buffer_store_dwordx4 v[64:67], v5, s[36:39], 0 offen
    s_mov_b64 exec, -1
    v_mov_b32 v14, 0x24210
    v_mov_b32 v15, 1
    s_mov_b64 exec, 1
    ds_add_u32 v14, v15
    s_mov_b64 exec, -1
    s_mov_b32 s48, s14
    s_and_b32 s49, s15, 0xffff
    s_mov_b32 s50, 0x400000
    s_mov_b32 s51, 0x20000
    s_mov_b32 s63, s65
    s_mov_b32 m0, s64
    s_add_u32 s64, s64, 1024
    buffer_load_dwordx4 v10, s[48:51], s63 offen nt lds
    s_add_u32 s63, s63, 32768
    s_mov_b32 m0, s64
    s_add_u32 s64, s64, 1024
    buffer_load_dwordx4 v11, s[48:51], s63 offen nt lds
    s_add_u32 s63, s63, 32768
    s_mov_b32 m0, s64
    s_add_u32 s64, s64, 1024
    buffer_load_dwordx4 v10, s[48:51], s63 offen nt lds
    s_add_u32 s63, s63, 32768
    s_mov_b32 m0, s64
    s_add_u32 s64, s64, 1024
    buffer_load_dwordx4 v11, s[48:51], s63 offen nt lds
    s_add_u32 s63, s63, 32768
    s_mov_b32 m0, s64
    s_add_u32 s64, s64, 1024
    buffer_load_dwordx4 v10, s[48:51], s63 offen nt lds
    s_add_u32 s63, s63, 32768
    s_mov_b32 m0, s64
    s_add_u32 s64, s64, 1024
    buffer_load_dwordx4 v11, s[48:51], s63 offen nt lds
    s_add_u32 s63, s63, 32768
    s_mov_b32 m0, s64
    s_add_u32 s64, s64, 1024
    buffer_load_dwordx4 v10, s[48:51], s63 offen nt lds
    s_add_u32 s63, s63, 32768
    s_mov_b32 m0, s64
    s_add_u32 s64, s64, 1024
    buffer_load_dwordx4 v11, s[48:51], s63 offen nt lds
    s_add_u32 s63, s63, 32768
    s_mov_b32 s44, s8
    s_and_b32 s45, s9, 0xffff
    s_mov_b32 s46, 0x1000
    s_mov_b32 s47, 0x20000
    buffer_load_dwordx4 v[144:147], v9, s[44:47], s62 offen offset:0
    buffer_load_dwordx4 v[148:151], v9, s[44:47], s62 offen offset:64
    buffer_load_dwordx4 v[152:155], v9, s[44:47], s62 offen offset:128
    buffer_load_dwordx4 v[156:159], v9, s[44:47], s62 offen offset:192
    s_waitcnt vmcnt(0)
    v_mov_b32 v14, 0x24210
    v_mov_b32 v15, 1
    s_mov_b64 exec, 1
    ds_add_u32 v14, v15
    s_mov_b64 exec, -1
    v_mov_b32 v14, 0x24210
    s_mov_b32 s80, 1600000
LW_3:
    ds_read_b32 v15, v14
    s_waitcnt lgkmcnt(0)
    v_readfirstlane_b32 s79, v15
    s_cmp_ge_u32 s79, 12
    s_cbranch_scc1 LWD_4
    s_sub_u32 s80, s80, 1
    s_cmp_lg_u32 s80, 0
    s_cbranch_scc1 LW_3
LWD_4:
    ds_read_b64_tr_b16 v[32:33], v20 offset:0
    ds_read_b64_tr_b16 v[34:35], v22 offset:0
    ds_read_b64_tr_b16 v[36:37], v21 offset:0
    ds_read_b64_tr_b16 v[38:39], v23 offset:0
    ds_read_b64_tr_b16 v[40:41], v20 offset:8192
    ds_read_b64_tr_b16 v[42:43], v22 offset:8192
    ds_read_b64_tr_b16 v[44:45], v21 offset:8192
    ds_read_b64_tr_b16 v[46:47], v23 offset:8192
    ds_read_b64_tr_b16 v[48:49], v20 offset:16384
    ds_read_b64_tr_b16 v[50:51], v22 offset:16384
    ds_read_b64_tr_b16 v[52:53], v21 offset:16384
    ds_read_b64_tr_b16 v[54:55], v23 offset:16384
    s_waitcnt lgkmcnt(8)
    ds_read_b64_tr_b16 v[56:57], v20 offset:24576
    ds_read_b64_tr_b16 v[58:59], v22 offset:24576
    ds_read_b64_tr_b16 v[60:61], v21 offset:24576
    ds_read_b64_tr_b16 v[62:63], v23 offset:24576
    s_waitcnt lgkmcnt(12)
    v_mfma_f32_16x16x32_bf16 v[24:27], v[32:35], v[144:147], 0
    v_mfma_f32_16x16x32_bf16 v[28:31], v[36:39], v[144:147], 0
    s_waitcnt lgkmcnt(8)
    v_mfma_f32_16x16x32_bf16 v[24:27], v[40:43], v[148:151], v[24:27]
    v_mfma_f32_16x16x32_bf16 v[28:31], v[44:47], v[148:151], v[28:31]
    s_waitcnt lgkmcnt(4)
    v_mfma_f32_16x16x32_bf16 v[24:27], v[48:51], v[152:155], v[24:27]
    v_mfma_f32_16x16x32_bf16 v[28:31], v[52:55], v[152:155], v[28:31]
    s_waitcnt lgkmcnt(0)
    v_mfma_f32_16x16x32_bf16 v[24:27], v[56:59], v[156:159], v[24:27]
    v_mfma_f32_16x16x32_bf16 v[28:31], v[60:63], v[156:159], v[28:31]
    v_lshlrev_b32 v14, 2, v1
    v_add_u32 v14, 0x24128, v14
    v_mov_b32 v15, 1
    s_mov_b64 exec, 15
    ds_add_u32 v14, v15
    s_mov_b64 exec, -1
    s_nop 0
    v_cvt_pk_bf16_f32 v72, v24, v25
    v_cvt_pk_bf16_f32 v73, v26, v27
    v_cvt_pk_bf16_f32 v76, v28, v29
    v_cvt_pk_bf16_f32 v77, v30, v31
    s_nop 0
    v_mov_b32_dpp v72, v76 quad_perm:[0,1,2,3] row_mask:0xf bank_mask:0x2
    v_mov_b32_dpp v73, v77 quad_perm:[0,1,2,3] row_mask:0xf bank_mask:0x2
    v_mov_b32 v10, 0x24200
    s_mov_b32 s80, 1600000
LW_5:
    ds_read_b32 v11, v10
    s_waitcnt lgkmcnt(0)
    v_readfirstlane_b32 s79, v11
    s_cmp_ge_u32 s79, 16
    s_cbranch_scc1 LWD_6
    s_sleep 1
    s_sub_u32 s80, s80, 1
    s_cmp_lg_u32 s80, 0
    s_cbranch_scc1 LW_5
LWD_6:
    s_and_b32 s101, s79, 15
    v_mov_b32 v12, 0x24204
    s_mov_b32 s80, 1600000
LW_7:
    ds_read_b32 v13, v12
    s_waitcnt lgkmcnt(0)
    v_readfirstlane_b32 s79, v13
    s_cmp_ge_u32 s79, 1
    s_cbranch_scc1 LWD_8
    s_sleep 1
    s_sub_u32 s80, s80, 1
    s_cmp_lg_u32 s80, 0
    s_cbranch_scc1 LW_7
LWD_8:
    v_mov_b32 v12, 0x24248
    ds_read_b64 v[14:15], v12
    s_waitcnt lgkmcnt(0)
    v_readfirstlane_b32 s92, v14
    v_readfirstlane_b32 s93, v15
    s_nop 0
    v_mov_b32 v66, s92
    v_mov_b32 v67, s93
    v_mov_b32 v74, s92
    v_mov_b32 v75, s93
    s_mov_b64 exec, s[84:85]
    s_cmp_eq_u32 s101, 0
    s_cbranch_scc1 SU_9
    buffer_store_dwordx4 v[72:75], v4, s[36:39], 0 offen
SV_10:
    s_mov_b64 exec, -1
    v_mov_b32 v14, 0x24210
    v_mov_b32 v15, 1
    s_mov_b64 exec, 1
    ds_add_u32 v14, v15
    s_mov_b64 exec, -1
    v_mov_b32 v14, 0x24000
    s_mov_b32 s80, 1600000
LW_11:
    ds_read_b32 v15, v14
    s_waitcnt lgkmcnt(0)
    v_readfirstlane_b32 s79, v15
    s_cmp_ge_u32 s79, 128
    s_cbranch_scc1 LWD_12
    s_sleep 16
    s_sub_u32 s80, s80, 1
    s_cmp_lg_u32 s80, 0
    s_cbranch_scc1 LW_11
LWD_12:
    s_mov_b64 exec, s[84:85]
    s_cmp_eq_u32 s101, 0
    s_cbranch_scc1 SU_13
    buffer_store_dwordx4 v[64:67], v5, s[36:39], 0 offen
SV_14:
    s_mov_b64 exec, -1
    s_branch L_ASVC
L_LDA:
    s_setprio 3
    v_lshrrev_b32 v20, 1, v3
    v_and_b32 v40, 1, v2
    v_xor_b32 v20, v20, v40
    v_lshlrev_b32 v20, 5, v20
    v_lshl_add_u32 v20, v2, 10, v20
    v_and_b32 v40, 1, v1
    v_lshl_add_u32 v20, v40, 4, v20
    v_xor_b32 v21, 0x40, v20
    v_xor_b32 v22, 0x80, v20
    v_xor_b32 v23, 0xc0, v20
    s_lshl_b32 s65, s4, 17
    s_lshl_b32 s7, s5, 8
    s_add_u32 s65, s65, s7
    s_mov_b32 s67, s65
    s_mov_b32 s64, 0
    s_mov_b32 s96, 0x6010600
    s_mov_b32 s97, 0x6030602
    s_cmp_eq_u32 s5, 1
    s_cselect_b32 s96, 0x6190618, s96
    s_cselect_b32 s97, 0x61b061a, s97
    s_cmp_eq_u32 s5, 2
    s_cselect_b32 s96, 0x6310630, s96
    s_cselect_b32 s97, 0x6330632, s97
    s_cmp_eq_u32 s5, 3
    s_cselect_b32 s96, 0x6490648, s96
    s_cselect_b32 s97, 0x64b064a, s97
    s_cmp_eq_u32 s5, 4
    s_cselect_b32 s96, 0x4610460, s96
    s_cselect_b32 s97, 0x4630462, s97
    s_cmp_eq_u32 s5, 5
    s_cselect_b32 s96, 0x4710470, s96
    s_cselect_b32 s97, 0x4730472, s97
    v_xor_b32 v10, v3, v2
    v_lshlrev_b32 v10, 4, v10
    v_lshl_add_u32 v10, v2, 8, v10
    v_xor_b32 v11, 0x40, v10
    v_xor_b32 v12, 0x80, v10
    v_xor_b32 v13, 0xc0, v10
    v_lshrrev_b32 v14, 1, v3
    v_xor_b32 v14, v14, v2
    v_lshlrev_b32 v14, 5, v14
    v_lshl_add_u32 v14, v2, 8, v14
    v_and_b32 v40, 1, v1
    v_lshl_add_u32 v14, v40, 4, v14
    v_xor_b32 v15, 0x80, v14
    s_mov_b32 s76, 0
    s_lshl_b32 s7, s76, 4
    s_lshr_b64 s[90:91], s[96:97], s7
    s_and_b32 s68, s90, 3
    s_bfe_u32 s72, s90, 0x50002
    s_lshl_b32 s68, s68, 5
    s_add_u32 s68, s68, s4
    s_lshl_b32 s68, s68, 20
    s_lshl_b32 s72, s72, 13
    s_add_u32 s72, s72, s68
    s_add_u32 s72, s72, 0xC0000
    s_mov_b32 s76, 1
    s_lshl_b32 s7, s76, 4
    s_lshr_b64 s[90:91], s[96:97], s7
    s_and_b32 s69, s90, 3
    s_bfe_u32 s73, s90, 0x50002
    s_lshl_b32 s69, s69, 5
    s_add_u32 s69, s69, s4
    s_lshl_b32 s69, s69, 20
    s_lshl_b32 s73, s73, 13
    s_add_u32 s73, s73, s69
    s_add_u32 s73, s73, 0xC0000
    s_mov_b32 s76, 2
    s_lshl_b32 s7, s76, 4
    s_lshr_b64 s[90:91], s[96:97], s7
    s_and_b32 s70, s90, 3
    s_bfe_u32 s74, s90, 0x50002
    s_lshl_b32 s70, s70, 5
    s_add_u32 s70, s70, s4
    s_lshl_b32 s70, s70, 20
    s_lshl_b32 s74, s74, 13
    s_add_u32 s74, s74, s70
    s_add_u32 s74, s74, 0xC0000
    s_mov_b32 s76, 3
    s_lshl_b32 s7, s76, 4
    s_lshr_b64 s[90:91], s[96:97], s7
    s_and_b32 s71, s90, 3
    s_bfe_u32 s75, s90, 0x50002
    s_lshl_b32 s71, s71, 5
    s_add_u32 s71, s71, s4
    s_lshl_b32 s71, s71, 20
    s_lshl_b32 s75, s75, 13
    s_add_u32 s75, s75, s71
    s_add_u32 s75, s75, 0xC0000
    s_waitcnt lgkmcnt(0)
    s_mov_b32 s56, s16
    s_and_b32 s57, s17, 0xffff
    s_mov_b32 s58, 0x400000
    s_mov_b32 s59, 0x20000
    s_barrier
    s_mov_b32 s61, 0
    s_mov_b32 s63, 0
    v_lshlrev_b32 v16, 2, v1
    v_add_u32 v17, 0x24100, v16
    v_add_u32 v16, 0x24000, v16
    v_mov_b32 v18, 0
    s_mov_b32 s60, 0
    s_mov_b32 s36, s34
    s_and_b32 s37, s35, 0xffff
    s_mov_b32 s38, 0x1000000
    s_mov_b32 s39, 0x20000
    v_mov_b32 v40, 0x24210
    s_mov_b32 s80, 1600000
LW_15:
    ds_read_b32 v41, v40
    s_waitcnt lgkmcnt(0)
    v_readfirstlane_b32 s79, v41
    s_cmp_ge_u32 s79, 8
    s_cbranch_scc1 LWD_16
    s_sub_u32 s80, s80, 1
    s_cmp_lg_u32 s80, 0
    s_cbranch_scc1 LW_15
LWD_16:
    s_mov_b32 s62, 0
    s_mov_b32 s44, s10
    s_and_b32 s45, s11, 0xffff
    s_mov_b32 s46, 0x8000000
    s_mov_b32 s47, 0x20000
    s_mov_b32 s48, s12
    s_and_b32 s49, s13, 0xffff
    s_mov_b32 s50, 0x8000000
    s_mov_b32 s51, 0x20000
    s_mov_b32 s68, s72
    s_mov_b32 s69, s73
    s_mov_b32 s70, s74
    s_mov_b32 s71, s75
    s_mov_b32 s66, 2
LL_17:
    s_waitcnt lgkmcnt(0)
    v_readlane_b32 s79, v18, s62
    s_cmp_lt_u32 s79, s63
    s_cbranch_scc1 ST_19
GO_18:
    s_waitcnt vmcnt(23)
    s_add_u32 s7, s64, 0
    s_mov_b32 m0, s7
    s_add_u32 s65, s68, 0
    buffer_load_dwordx4 v10, s[44:47], s65 offen offset:0 nt lds
    s_waitcnt vmcnt(23)
    buffer_load_dwordx4 v11, s[44:47], s65 offen offset:1024 nt lds
    s_waitcnt vmcnt(23)
    buffer_load_dwordx4 v12, s[44:47], s65 offen offset:2048 nt lds
    s_waitcnt vmcnt(23)
    buffer_load_dwordx4 v13, s[44:47], s65 offen offset:3072 nt lds
    s_waitcnt vmcnt(23)
    s_add_u32 s7, s64, 4096
    s_mov_b32 m0, s7
    s_add_u32 s65, s68, 4096
    buffer_load_dwordx4 v10, s[44:47], s65 offen offset:0 nt lds
    s_waitcnt vmcnt(23)
    buffer_load_dwordx4 v11, s[44:47], s65 offen offset:1024 nt lds
    ds_read_b32 v18, v17
    s_waitcnt vmcnt(23)
    buffer_load_dwordx4 v12, s[44:47], s65 offen offset:2048 nt lds
    s_waitcnt vmcnt(23)
    s_sub_u32 s7, s60, 16
    s_max_i32 s61, s61, s7
    v_mov_b32 v19, s61
    ds_write_b32 v16, v19
    buffer_load_dwordx4 v13, s[44:47], s65 offen offset:3072 nt lds
    s_add_u32 s60, s60, 8
TJ_21:
    s_add_u32 s65, s65, 4096
    s_mov_b32 s68, s69
    s_mov_b32 s69, s70
    s_mov_b32 s70, s71
    s_mov_b32 s71, s65
    s_add_u32 s62, s62, 1
    s_add_u32 s64, s64, 8192
    s_cmp_eq_u32 s62, 10
    s_cselect_b32 s7, 4, 0
    s_add_u32 s63, s63, s7
    s_cmp_eq_u32 s62, 18
    s_cselect_b32 s62, 0, s62
    s_cselect_b32 s64, 0, s64
    s_sub_u32 s66, s66, 1
    s_cmp_lg_u32 s66, 0
    s_cbranch_scc1 LL_17
    s_mov_b32 s66, 22
LL_22:
    s_waitcnt lgkmcnt(0)
    v_readlane_b32 s79, v18, s62
    s_cmp_lt_u32 s79, s63
    s_cbranch_scc1 ST_24
GO_23:
    s_waitcnt vmcnt(23)
    s_add_u32 s7, s64, 0
    s_mov_b32 m0, s7
    s_add_u32 s65, s68, 0
    buffer_load_dwordx4 v10, s[44:47], s65 offen offset:0 nt lds
    s_waitcnt vmcnt(23)
    buffer_load_dwordx4 v11, s[44:47], s65 offen offset:1024 nt lds
    s_waitcnt vmcnt(23)
    buffer_load_dwordx4 v12, s[44:47], s65 offen offset:2048 nt lds
    s_waitcnt vmcnt(23)
    buffer_load_dwordx4 v13, s[44:47], s65 offen offset:3072 nt lds
    s_waitcnt vmcnt(23)
    s_add_u32 s7, s64, 4096
    s_mov_b32 m0, s7
    s_add_u32 s65, s68, 4096
    buffer_load_dwordx4 v10, s[44:47], s65 offen offset:0 nt lds
    s_waitcnt vmcnt(23)
    buffer_load_dwordx4 v11, s[44:47], s65 offen offset:1024 nt lds
    ds_read_b32 v18, v17
    s_waitcnt vmcnt(23)
    buffer_load_dwordx4 v12, s[44:47], s65 offen offset:2048 nt lds
    s_waitcnt vmcnt(23)
    s_sub_u32 s7, s60, 16
    s_max_i32 s61, s61, s7
    v_mov_b32 v19, s61
    ds_write_b32 v16, v19
    buffer_load_dwordx4 v13, s[44:47], s65 offen offset:3072 nt lds
    s_add_u32 s60, s60, 8
TJ_26:
    s_add_u32 s65, s65, 4096
    s_mov_b32 s68, s69
    s_mov_b32 s69, s70
    s_mov_b32 s70, s71
    s_mov_b32 s71, s65
    s_add_u32 s62, s62, 1
    s_add_u32 s64, s64, 8192
    s_cmp_eq_u32 s62, 10
    s_cselect_b32 s7, 4, 0
    s_add_u32 s63, s63, s7
    s_cmp_eq_u32 s62, 18
    s_cselect_b32 s62, 0, s62
    s_cselect_b32 s64, 0, s64
    s_sub_u32 s66, s66, 1
    s_cmp_lg_u32 s66, 0
    s_cbranch_scc1 LL_22
    s_mov_b32 s68, s72
    s_mov_b32 s69, s73
    s_mov_b32 s70, s74
    s_mov_b32 s71, s75
    s_mov_b32 s66, 4
LL_27:
    s_waitcnt lgkmcnt(0)
    v_readlane_b32 s79, v18, s62
    s_cmp_lt_u32 s79, s63
    s_cbranch_scc1 ST_29
GO_28:
    s_waitcnt vmcnt(23)
    s_add_u32 s7, s64, 0
    s_mov_b32 m0, s7
    s_add_u32 s65, s68, 0
    buffer_load_dwordx4 v14, s[48:51], s65 offen offset:0 nt lds
    s_waitcnt vmcnt(23)
    buffer_load_dwordx4 v15, s[48:51], s65 offen offset:1024 nt lds
    s_waitcnt vmcnt(23)
    buffer_load_dwordx4 v14, s[48:51], s65 offen offset:2048 nt lds
    s_waitcnt vmcnt(23)
    buffer_load_dwordx4 v15, s[48:51], s65 offen offset:3072 nt lds
    s_waitcnt vmcnt(23)
    s_add_u32 s7, s64, 4096
    s_mov_b32 m0, s7
    s_add_u32 s65, s68, 4096
    buffer_load_dwordx4 v14, s[48:51], s65 offen offset:0 nt lds
    s_waitcnt vmcnt(23)
    buffer_load_dwordx4 v15, s[48:51], s65 offen offset:1024 nt lds
    ds_read_b32 v18, v17
    s_waitcnt vmcnt(23)
    buffer_load_dwordx4 v14, s[48:51], s65 offen offset:2048 nt lds
    s_waitcnt vmcnt(23)
    s_sub_u32 s7, s60, 16
    s_max_i32 s61, s61, s7
    v_mov_b32 v19, s61
    ds_write_b32 v16, v19
    buffer_load_dwordx4 v15, s[48:51], s65 offen offset:3072 nt lds
    s_add_u32 s60, s60, 8
TJ_31:
    s_add_u32 s65, s65, 4096
    s_mov_b32 s68, s69
    s_mov_b32 s69, s70
    s_mov_b32 s70, s71
    s_mov_b32 s71, s65
    s_add_u32 s62, s62, 1
    s_add_u32 s64, s64, 8192
    s_cmp_eq_u32 s62, 10
    s_cselect_b32 s7, 4, 0
    s_add_u32 s63, s63, s7
    s_cmp_eq_u32 s62, 18
    s_cselect_b32 s62, 0, s62
    s_cselect_b32 s64, 0, s64
    s_sub_u32 s66, s66, 1
    s_cmp_lg_u32 s66, 0
    s_cbranch_scc1 LL_27
    s_mov_b32 s66, 15
LL_32:
    s_waitcnt lgkmcnt(0)
    v_readlane_b32 s79, v18, s62
    s_cmp_lt_u32 s79, s63
    s_cbranch_scc1 ST_34
GO_33:
    s_waitcnt vmcnt(27)
    s_add_u32 s7, s64, 0
    s_mov_b32 m0, s7
    s_add_u32 s65, s68, 0
    buffer_load_dwordx4 v14, s[48:51], s65 offen offset:0 nt lds
    s_waitcnt vmcnt(27)
    buffer_load_dwordx4 v15, s[48:51], s65 offen offset:1024 nt lds
    s_waitcnt vmcnt(27)
    buffer_load_dwordx4 v14, s[48:51], s65 offen offset:2048 nt lds
    s_waitcnt vmcnt(27)
    s_sub_u32 s7, s60, 24
    s_max_i32 s61, s61, s7
    v_mov_b32 v19, s61
    ds_write_b32 v16, v19
    buffer_load_dwordx4 v15, s[48:51], s65 offen offset:3072 nt lds
    s_waitcnt vmcnt(27)
    s_add_u32 s7, s64, 4096
    s_mov_b32 m0, s7
    s_add_u32 s65, s68, 4096
    buffer_load_dwordx4 v14, s[48:51], s65 offen offset:0 nt lds
    s_waitcnt vmcnt(27)
    buffer_load_dwordx4 v15, s[48:51], s65 offen offset:1024 nt lds
    ds_read_b32 v18, v17
    s_waitcnt vmcnt(27)
    buffer_load_dwordx4 v14, s[48:51], s65 offen offset:2048 nt lds
    s_waitcnt vmcnt(27)
    buffer_load_dwordx4 v15, s[48:51], s65 offen offset:3072 nt lds
    s_add_u32 s60, s60, 8
TJ_36:
    s_add_u32 s65, s65, 4096
    s_mov_b32 s68, s69
    s_mov_b32 s69, s70
    s_mov_b32 s70, s71
    s_mov_b32 s71, s65
    s_add_u32 s62, s62, 1
    s_add_u32 s64, s64, 8192
    s_cmp_eq_u32 s62, 10
    s_cselect_b32 s7, 4, 0
    s_add_u32 s63, s63, s7
    s_cmp_eq_u32 s62, 18
    s_cselect_b32 s62, 0, s62
    s_cselect_b32 s64, 0, s64
    s_sub_u32 s66, s66, 1
    s_cmp_lg_u32 s66, 0
    s_cbranch_scc1 LL_32
    s_mov_b32 s66, 5
LL_37:
    s_waitcnt lgkmcnt(0)
    v_readlane_b32 s79, v18, s62
    s_cmp_lt_u32 s79, s63
    s_cbranch_scc1 ST_39
GO_38:
    s_waitcnt vmcnt(39)
    s_add_u32 s7, s64, 0
    s_mov_b32 m0, s7
    s_add_u32 s65, s68, 0
    buffer_load_dwordx4 v14, s[48:51], s65 offen offset:0 nt lds
    s_waitcnt vmcnt(39)
    buffer_load_dwordx4 v15, s[48:51], s65 offen offset:1024 nt lds
    s_waitcnt vmcnt(39)
    buffer_load_dwordx4 v14, s[48:51], s65 offen offset:2048 nt lds
    s_waitcnt vmcnt(39)
    buffer_load_dwordx4 v15, s[48:51], s65 offen offset:3072 nt lds
    s_waitcnt vmcnt(39)
    s_add_u32 s7, s64, 4096
    s_mov_b32 m0, s7
    s_add_u32 s65, s68, 4096
    buffer_load_dwordx4 v14, s[48:51], s65 offen offset:0 nt lds
    s_waitcnt vmcnt(39)
    buffer_load_dwordx4 v15, s[48:51], s65 offen offset:1024 nt lds
    ds_read_b32 v18, v17
    s_waitcnt vmcnt(39)
    buffer_load_dwordx4 v14, s[48:51], s65 offen offset:2048 nt lds
    s_waitcnt vmcnt(39)
    s_sub_u32 s7, s60, 32
    s_max_i32 s61, s61, s7
    v_mov_b32 v19, s61
    ds_write_b32 v16, v19
    buffer_load_dwordx4 v15, s[48:51], s65 offen offset:3072 nt lds
    s_add_u32 s60, s60, 8
TJ_41:
    s_add_u32 s65, s65, 4096
    s_mov_b32 s68, s69
    s_mov_b32 s69, s70
    s_mov_b32 s70, s71
    s_mov_b32 s71, s65
    s_add_u32 s62, s62, 1
    s_add_u32 s64, s64, 8192
    s_cmp_eq_u32 s62, 10
    s_cselect_b32 s7, 4, 0
    s_add_u32 s63, s63, s7
    s_cmp_eq_u32 s62, 18
    s_cselect_b32 s62, 0, s62
    s_cselect_b32 s64, 0, s64
    s_sub_u32 s66, s66, 1
    s_cmp_lg_u32 s66, 0
    s_cbranch_scc1 LL_37
    s_mov_b32 s65, s67
    s_mov_b32 s66, 2
LL_42:
    s_waitcnt lgkmcnt(0)
    v_readlane_b32 s79, v18, s62
    s_cmp_lt_u32 s79, s63
    s_cbranch_scc1 ST_44
GO_43:
    s_waitcnt vmcnt(39)
    s_mov_b32 m0, s64
    s_add_u32 s64, s64, 1024
    buffer_load_dwordx4 v20, s[56:59], s65 offen nt lds
    s_add_u32 s65, s65, 4096
    s_waitcnt vmcnt(39)
    s_mov_b32 m0, s64
    s_add_u32 s64, s64, 1024
    buffer_load_dwordx4 v20, s[56:59], s65 offen nt lds
    s_add_u32 s65, s65, 4096
    s_waitcnt vmcnt(39)
    s_mov_b32 m0, s64
    s_add_u32 s64, s64, 1024
    buffer_load_dwordx4 v20, s[56:59], s65 offen nt lds
    s_add_u32 s65, s65, 4096
    s_waitcnt vmcnt(39)
    s_mov_b32 m0, s64
    s_add_u32 s64, s64, 1024
    buffer_load_dwordx4 v20, s[56:59], s65 offen nt lds
    s_add_u32 s65, s65, 4096
    s_waitcnt vmcnt(39)
    s_mov_b32 m0, s64
    s_add_u32 s64, s64, 1024
    buffer_load_dwordx4 v21, s[56:59], s65 offen nt lds
    s_add_u32 s65, s65, 4096
    s_waitcnt vmcnt(39)
    s_mov_b32 m0, s64
    s_add_u32 s64, s64, 1024
    buffer_load_dwordx4 v21, s[56:59], s65 offen nt lds
    s_add_u32 s65, s65, 4096
    ds_read_b32 v18, v17
    s_waitcnt vmcnt(39)
    s_mov_b32 m0, s64
    s_add_u32 s64, s64, 1024
    buffer_load_dwordx4 v21, s[56:59], s65 offen nt lds
    s_add_u32 s65, s65, 4096
    s_waitcnt vmcnt(39)
    s_sub_u32 s7, s60, 32
    s_max_i32 s61, s61, s7
    v_mov_b32 v19, s61
    ds_write_b32 v16, v19
    s_mov_b32 m0, s64
    s_add_u32 s64, s64, 1024
    buffer_load_dwordx4 v21, s[56:59], s65 offen nt lds
    s_add_u32 s65, s65, 4096
    s_add_u32 s60, s60, 8
    s_add_u32 s62, s62, 1
    s_cmp_eq_u32 s62, 10
    s_cselect_b32 s7, 4, 0
    s_add_u32 s63, s63, s7
    s_cmp_eq_u32 s62, 18
    s_cselect_b32 s62, 0, s62
    s_cselect_b32 s64, 0, s64
    s_waitcnt lgkmcnt(0)
    v_readlane_b32 s79, v18, s62
    s_cmp_lt_u32 s79, s63
    s_cbranch_scc1 ST_46
GO_45:
    s_waitcnt vmcnt(39)
    s_mov_b32 m0, s64
    s_add_u32 s64, s64, 1024
    buffer_load_dwordx4 v22, s[56:59], s65 offen nt lds
    s_add_u32 s65, s65, 4096
    s_waitcnt vmcnt(39)
    s_mov_b32 m0, s64
    s_add_u32 s64, s64, 1024
    buffer_load_dwordx4 v22, s[56:59], s65 offen nt lds
    s_add_u32 s65, s65, 4096
    s_waitcnt vmcnt(39)
    s_mov_b32 m0, s64
    s_add_u32 s64, s64, 1024
    buffer_load_dwordx4 v22, s[56:59], s65 offen nt lds
    s_add_u32 s65, s65, 4096
    s_waitcnt vmcnt(39)
    s_mov_b32 m0, s64
    s_add_u32 s64, s64, 1024
    buffer_load_dwordx4 v22, s[56:59], s65 offen nt lds
    s_add_u32 s65, s65, 4096
    s_waitcnt vmcnt(39)
    s_mov_b32 m0, s64
    s_add_u32 s64, s64, 1024
    buffer_load_dwordx4 v23, s[56:59], s65 offen nt lds
    s_add_u32 s65, s65, 4096
    s_waitcnt vmcnt(39)
    s_mov_b32 m0, s64
    s_add_u32 s64, s64, 1024
    buffer_load_dwordx4 v23, s[56:59], s65 offen nt lds
    s_add_u32 s65, s65, 4096
    ds_read_b32 v18, v17
    s_waitcnt vmcnt(39)
    s_mov_b32 m0, s64
    s_add_u32 s64, s64, 1024
    buffer_load_dwordx4 v23, s[56:59], s65 offen nt lds
    s_add_u32 s65, s65, 4096
    s_waitcnt vmcnt(39)
    s_sub_u32 s7, s60, 32
    s_max_i32 s61, s61, s7
    v_mov_b32 v19, s61
    ds_write_b32 v16, v19
    s_mov_b32 m0, s64
    s_add_u32 s64, s64, 1024
    buffer_load_dwordx4 v23, s[56:59], s65 offen nt lds
    s_add_u32 s65, s65, 4096
    s_add_u32 s60, s60, 8
    s_add_u32 s62, s62, 1
    s_cmp_eq_u32 s62, 10
    s_cselect_b32 s7, 4, 0
    s_add_u32 s63, s63, s7
    s_cmp_eq_u32 s62, 18
    s_cselect_b32 s62, 0, s62
    s_cselect_b32 s64, 0, s64
    s_sub_u32 s66, s66, 1
    s_cmp_lg_u32 s66, 0
    s_cbranch_scc1 LL_42
    s_waitcnt vmcnt(32)
    s_sub_u32 s7, s60, 32
    s_max_i32 s61, s61, s7
    v_mov_b32 v19, s61
    ds_write_b32 v16, v19
    s_waitcnt vmcnt(24)
    s_sub_u32 s7, s60, 24
    s_max_i32 s61, s61, s7
    v_mov_b32 v19, s61
    ds_write_b32 v16, v19
    s_waitcnt vmcnt(16)
    s_sub_u32 s7, s60, 16
    s_max_i32 s61, s61, s7
    v_mov_b32 v19, s61
    ds_write_b32 v16, v19
    s_waitcnt vmcnt(8)
    s_sub_u32 s7, s60, 8
    s_max_i32 s61, s61, s7
    v_mov_b32 v19, s61
    ds_write_b32 v16, v19
    s_waitcnt vmcnt(0)
    s_mov_b32 s61, s60
    v_mov_b32 v19, s61
    ds_write_b32 v16, v19
    s_cmp_ge_u32 s5, 2
    s_cbranch_scc1 L_END
    v_mov_b32 v40, 0x24204
    s_mov_b32 s80, 1600000
LW_47:
    ds_read_b32 v41, v40
    s_waitcnt lgkmcnt(0)
    v_readfirstlane_b32 s79, v41
    s_cmp_ge_u32 s79, 1
    s_cbranch_scc1 LWD_48
    s_sleep 1
    s_sub_u32 s80, s80, 1
    s_cmp_lg_u32 s80, 0
    s_cbranch_scc1 LW_47
LWD_48:
    v_mov_b32 v40, 0x24248
    ds_read_b64 v[42:43], v40
    s_waitcnt lgkmcnt(0)
    v_readfirstlane_b32 s92, v42
    v_readfirstlane_b32 s93, v43
    s_mov_b32 s52, s30
    s_and_b32 s53, s31, 0xffff
    s_mov_b32 s54, 0x2000
    s_mov_b32 s55, 0x20000
    s_mov_b32 s84, 0x3f80
    s_mov_b32 s85, 0x3f800000
    s_lshl_b32 s60, s4, 1
    s_add_u32 s60, s60, s5
    s_lshl_b32 s7, s60, 12
    s_add_u32 s7, s7, 0x280000
    v_lshl_add_u32 v36, v1, 4, s7
    s_lshr_b32 s7, s60, 4
    s_lshl_b32 s7, s7, 11
    s_and_b32 s61, s60, 15
    s_lshl_b32 s61, s61, 6
    s_add_u32 s7, s7, s61
    v_lshl_add_u32 v37, v1, 3, s7
    v_mov_b32 v38, 0x24214
    s_mov_b32 s80, 1600000
LW_49:
    ds_read_b32 v39, v38
    s_waitcnt lgkmcnt(0)
    v_readfirstlane_b32 s79, v39
    s_cmp_ge_u32 s79, 4
    s_cbranch_scc1 LWD_50
    s_sleep 1
    s_sub_u32 s80, s80, 1
    s_cmp_lg_u32 s80, 0
    s_cbranch_scc1 LW_49
LWD_50:
    s_mov_b64 exec, -1
    buffer_load_dwordx4 v[48:51], v36, s[36:39], 0 offen offset:0 sc1
    buffer_load_dwordx4 v[52:55], v36, s[36:39], 0 offen offset:1024 sc1
    buffer_load_dwordx4 v[56:59], v36, s[36:39], 0 offen offset:2048 sc1
    buffer_load_dwordx4 v[60:63], v36, s[36:39], 0 offen offset:3072 sc1
    s_mov_b32 s80, 200000
MC_52:
    s_mov_b64 exec, -1
    s_waitcnt vmcnt(0)
    v_cmp_ne_u64 s[62:63], s[92:93], v[50:51]
    v_cmp_ne_u64 s[64:65], s[92:93], v[54:55]
    v_cmp_ne_u64 s[66:67], s[92:93], v[58:59]
    v_cmp_ne_u64 s[68:69], s[92:93], v[62:63]
    s_or_b64 s[90:91], s[62:63], s[64:65]
    s_or_b64 s[90:91], s[90:91], s[66:67]
    s_or_b64 s[90:91], s[90:91], s[68:69]
    s_cbranch_scc1 M_51
MD_53:
    s_mov_b64 exec, -1
    v_dot2_f32_bf16 v44, v48, s84, 0
    v_dot2_f32_bf16 v45, v48, s85, 0
    v_dot2_f32_bf16 v46, v49, s84, 0
    v_dot2_f32_bf16 v47, v49, s85, 0
    v_dot2_f32_bf16 v44, v52, s84, v44
    v_dot2_f32_bf16 v45, v52, s85, v45
    v_dot2_f32_bf16 v46, v53, s84, v46
    v_dot2_f32_bf16 v47, v53, s85, v47
    v_dot2_f32_bf16 v44, v56, s84, v44
    v_dot2_f32_bf16 v45, v56, s85, v45
    v_dot2_f32_bf16 v46, v57, s84, v46
    v_dot2_f32_bf16 v47, v57, s85, v47
    v_dot2_f32_bf16 v44, v60, s84, v44
    v_dot2_f32_bf16 v45, v60, s85, v45
    v_dot2_f32_bf16 v46, v61, s84, v46
    v_dot2_f32_bf16 v47, v61, s85, v47
    v_add_f32_dpp v44, v44, v44 row_ror:8 row_mask:0xf bank_mask:0xf
    v_add_f32_dpp v45, v45, v45 row_ror:8 row_mask:0xf bank_mask:0xf
    v_add_f32_dpp v46, v46, v46 row_ror:8 row_mask:0xf bank_mask:0xf
    v_add_f32_dpp v47, v47, v47 row_ror:8 row_mask:0xf bank_mask:0xf
    s_nop 0
    v_permlane32_swap_b32 v44, v46
    v_permlane32_swap_b32 v45, v47
    v_add_f32 v44, v44, v46
    v_add_f32 v45, v45, v47
    v_mov_b32 v46, v44
    v_mov_b32 v47, v45
    s_nop 0
    v_permlane16_swap_b32 v44, v46
    v_permlane16_swap_b32 v45, v47
    v_add_f32 v44, v44, v46
    v_add_f32 v45, v45, v47
    v_cvt_pk_bf16_f32 v44, v44, v45
    v_mov_b32 v45, v44
    s_nop 1
    v_permlane32_swap_b32 v44, v45
    s_mov_b64 exec, 0xff
    buffer_store_dwordx2 v[44:45], v37, s[52:55], 0 offen
    s_mov_b64 exec, -1
    s_endpgm
L_LDE:
    s_setprio 3
    v_xor_b32 v6, v3, v2
    v_lshlrev_b32 v6, 4, v6
    v_lshl_add_u32 v6, v2, 13, v6
    v_xor_b32 v7, 0x40, v6
    v_xor_b32 v8, 0x80, v6
    v_xor_b32 v9, 0xc0, v6
    s_lshl_b32 s65, s5, 21
    s_lshl_b32 s7, s4, 8
    s_add_u32 s65, s65, s7
    s_sub_u32 s65, s65, 0x800000
    s_mov_b32 s64, 0x14000
    s_waitcnt lgkmcnt(0)
    s_mov_b32 s52, s24
    s_and_b32 s53, s25, 0xffff
    s_mov_b32 s54, 0x400000
    s_mov_b32 s55, 0x20000
    s_mov_b32 m0, s64
    s_add_u32 s64, s64, 1024
    buffer_load_dwordx4 v6, s[52:55], s65 offen nt lds
    s_add_u32 s65, s65, 32768
    s_mov_b32 m0, s64
    s_add_u32 s64, s64, 1024
    buffer_load_dwordx4 v7, s[52:55], s65 offen nt lds
    s_add_u32 s65, s65, 32768
    s_mov_b32 m0, s64
    s_add_u32 s64, s64, 1024
    buffer_load_dwordx4 v8, s[52:55], s65 offen nt lds
    s_add_u32 s65, s65, 32768
    s_mov_b32 m0, s64
    s_add_u32 s64, s64, 1024
    buffer_load_dwordx4 v9, s[52:55], s65 offen nt lds
    s_add_u32 s65, s65, 32768
    s_mov_b32 m0, s64
    s_add_u32 s64, s64, 1024
    buffer_load_dwordx4 v6, s[52:55], s65 offen nt lds
    s_add_u32 s65, s65, 32768
    s_mov_b32 m0, s64
    s_add_u32 s64, s64, 1024
    buffer_load_dwordx4 v7, s[52:55], s65 offen nt lds
    s_add_u32 s65, s65, 32768
    s_mov_b32 m0, s64
    s_add_u32 s64, s64, 1024
    buffer_load_dwordx4 v8, s[52:55], s65 offen nt lds
    s_add_u32 s65, s65, 32768
    s_mov_b32 m0, s64
    s_add_u32 s64, s64, 1024
    buffer_load_dwordx4 v9, s[52:55], s65 offen nt lds
    s_add_u32 s65, s65, 32768
    s_mov_b32 m0, s64
    s_add_u32 s64, s64, 1024
    buffer_load_dwordx4 v6, s[52:55], s65 offen nt lds
    s_add_u32 s65, s65, 32768
    s_mov_b32 m0, s64
    s_add_u32 s64, s64, 1024
    buffer_load_dwordx4 v7, s[52:55], s65 offen nt lds
    s_add_u32 s65, s65, 32768
    s_mov_b32 m0, s64
    s_add_u32 s64, s64, 1024
    buffer_load_dwordx4 v8, s[52:55], s65 offen nt lds
    s_add_u32 s65, s65, 32768
    s_mov_b32 m0, s64
    s_add_u32 s64, s64, 1024
    buffer_load_dwordx4 v9, s[52:55], s65 offen nt lds
    s_add_u32 s65, s65, 32768
    s_mov_b32 m0, s64
    s_add_u32 s64, s64, 1024
    buffer_load_dwordx4 v6, s[52:55], s65 offen nt lds
    s_add_u32 s65, s65, 32768
    s_mov_b32 m0, s64
    s_add_u32 s64, s64, 1024
    buffer_load_dwordx4 v7, s[52:55], s65 offen nt lds
    s_add_u32 s65, s65, 32768
    s_mov_b32 m0, s64
    s_add_u32 s64, s64, 1024
    buffer_load_dwordx4 v8, s[52:55], s65 offen nt lds
    s_add_u32 s65, s65, 32768
    s_mov_b32 m0, s64
    s_add_u32 s64, s64, 1024
    buffer_load_dwordx4 v9, s[52:55], s65 offen nt lds
    s_add_u32 s65, s65, 32768
    s_mov_b32 m0, s64
    s_add_u32 s64, s64, 1024
    buffer_load_dwordx4 v6, s[52:55], s65 offen nt lds
    s_add_u32 s65, s65, 32768
    s_mov_b32 m0, s64
    s_add_u32 s64, s64, 1024
    buffer_load_dwordx4 v7, s[52:55], s65 offen nt lds
    s_add_u32 s65, s65, 32768
    s_mov_b32 m0, s64
    s_add_u32 s64, s64, 1024
    buffer_load_dwordx4 v8, s[52:55], s65 offen nt lds
    s_add_u32 s65, s65, 32768
    s_mov_b32 m0, s64
    s_add_u32 s64, s64, 1024
    buffer_load_dwordx4 v9, s[52:55], s65 offen nt lds
    s_add_u32 s65, s65, 32768
    s_mov_b32 m0, s64
    s_add_u32 s64, s64, 1024
    buffer_load_dwordx4 v6, s[52:55], s65 offen nt lds
    s_add_u32 s65, s65, 32768
    s_mov_b32 m0, s64
    s_add_u32 s64, s64, 1024
    buffer_load_dwordx4 v7, s[52:55], s65 offen nt lds
    s_add_u32 s65, s65, 32768
    s_mov_b32 m0, s64
    s_add_u32 s64, s64, 1024
    buffer_load_dwordx4 v8, s[52:55], s65 offen nt lds
    s_add_u32 s65, s65, 32768
    s_mov_b32 m0, s64
    s_add_u32 s64, s64, 1024
    buffer_load_dwordx4 v9, s[52:55], s65 offen nt lds
    s_add_u32 s65, s65, 32768
    s_mov_b32 m0, s64
    s_add_u32 s64, s64, 1024
    buffer_load_dwordx4 v6, s[52:55], s65 offen nt lds
    s_add_u32 s65, s65, 32768
    s_mov_b32 m0, s64
    s_add_u32 s64, s64, 1024
    buffer_load_dwordx4 v7, s[52:55], s65 offen nt lds
    s_add_u32 s65, s65, 32768
    s_mov_b32 m0, s64
    s_add_u32 s64, s64, 1024
    buffer_load_dwordx4 v8, s[52:55], s65 offen nt lds
    s_add_u32 s65, s65, 32768
    s_mov_b32 m0, s64
    s_add_u32 s64, s64, 1024
    buffer_load_dwordx4 v9, s[52:55], s65 offen nt lds
    s_add_u32 s65, s65, 32768
    s_mov_b32 m0, s64
    s_add_u32 s64, s64, 1024
    buffer_load_dwordx4 v6, s[52:55], s65 offen nt lds
    s_add_u32 s65, s65, 32768
    s_mov_b32 m0, s64
    s_add_u32 s64, s64, 1024
    buffer_load_dwordx4 v7, s[52:55], s65 offen nt lds
    s_add_u32 s65, s65, 32768
    s_mov_b32 m0, s64
    s_add_u32 s64, s64, 1024
    buffer_load_dwordx4 v8, s[52:55], s65 offen nt lds
    s_add_u32 s65, s65, 32768
    s_mov_b32 m0, s64
    s_add_u32 s64, s64, 1024
    buffer_load_dwordx4 v9, s[52:55], s65 offen nt lds
    s_add_u32 s65, s65, 32768
    s_barrier
    s_mov_b32 s61, 0
    s_mov_b32 s63, 0
    v_lshlrev_b32 v16, 2, v1
    v_add_u32 v17, 0x24100, v16
    v_add_u32 v16, 0x24000, v16
    v_mov_b32 v18, 0
    s_mov_b32 s60, 32
    s_mov_b32 s36, s34
    s_and_b32 s37, s35, 0xffff
    s_mov_b32 s38, 0x1000000
    s_mov_b32 s39, 0x20000
    s_mov_b32 s44, s26
    s_and_b32 s45, s27, 0xffff
    s_mov_b32 s46, 0x400000
    s_mov_b32 s47, 0x20000
    v_bfe_u32 v20, v1, 1, 2
    v_xor_b32 v20, v20, v2
    v_lshlrev_b32 v20, 5, v20
    v_lshrrev_b32 v40, 3, v1
    v_lshl_add_u32 v20, v40, 13, v20
    v_and_b32 v40, 1, v1
    v_lshl_add_u32 v20, v40, 4, v20
    s_mov_b32 s96, 0x6010600
    s_mov_b32 s97, 0x6030602
    s_cmp_eq_u32 s5, 1
    s_cselect_b32 s96, 0x6190618, s96
    s_cselect_b32 s97, 0x61b061a, s97
    s_cmp_eq_u32 s5, 2
    s_cselect_b32 s96, 0x6310630, s96
    s_cselect_b32 s97, 0x6330632, s97
    s_cmp_eq_u32 s5, 3
    s_cselect_b32 s96, 0x6490648, s96
    s_cselect_b32 s97, 0x64b064a, s97
    s_cmp_eq_u32 s5, 4
    s_cselect_b32 s96, 0x4610460, s96
    s_cselect_b32 s97, 0x4630462, s97
    s_cmp_eq_u32 s5, 5
    s_cselect_b32 s96, 0x4710470, s96
    s_cselect_b32 s97, 0x4730472, s97
    v_xor_b32 v10, v3, v2
    v_lshlrev_b32 v10, 4, v10
    v_lshl_add_u32 v10, v2, 8, v10
    v_xor_b32 v11, 0x40, v10
    v_xor_b32 v12, 0x80, v10
    v_xor_b32 v13, 0xc0, v10
    v_lshrrev_b32 v14, 1, v3
    v_xor_b32 v14, v14, v2
    v_lshlrev_b32 v14, 5, v14
    v_lshl_add_u32 v14, v2, 8, v14
    v_and_b32 v40, 1, v1
    v_lshl_add_u32 v14, v40, 4, v14
    v_xor_b32 v15, 0x80, v14
    s_mov_b32 s76, 0
    s_lshl_b32 s7, s76, 4
    s_lshr_b64 s[90:91], s[96:97], s7
    s_and_b32 s68, s90, 3
    s_bfe_u32 s72, s90, 0x50002
    s_lshl_b32 s68, s68, 5
    s_add_u32 s68, s68, s4
    s_lshl_b32 s68, s68, 20
    s_lshl_b32 s72, s72, 13
    s_add_u32 s72, s72, s68
    s_add_u32 s72, s72, 0xC0000
    s_mov_b32 s76, 1
    s_lshl_b32 s7, s76, 4
    s_lshr_b64 s[90:91], s[96:97], s7
    s_and_b32 s69, s90, 3
    s_bfe_u32 s73, s90, 0x50002
    s_lshl_b32 s69, s69, 5
    s_add_u32 s69, s69, s4
    s_lshl_b32 s69, s69, 20
    s_lshl_b32 s73, s73, 13
    s_add_u32 s73, s73, s69
    s_add_u32 s73, s73, 0xC0000
    s_mov_b32 s76, 2
    s_lshl_b32 s7, s76, 4
    s_lshr_b64 s[90:91], s[96:97], s7
    s_and_b32 s70, s90, 3
    s_bfe_u32 s74, s90, 0x50002
    s_lshl_b32 s70, s70, 5
    s_add_u32 s70, s70, s4
    s_lshl_b32 s70, s70, 20
    s_lshl_b32 s74, s74, 13
    s_add_u32 s74, s74, s70
    s_add_u32 s74, s74, 0xC0000
    s_mov_b32 s76, 3
    s_lshl_b32 s7, s76, 4
    s_lshr_b64 s[90:91], s[96:97], s7
    s_and_b32 s71, s90, 3
    s_bfe_u32 s75, s90, 0x50002
    s_lshl_b32 s71, s71, 5
    s_add_u32 s71, s71, s4
    s_lshl_b32 s71, s71, 20
    s_lshl_b32 s75, s75, 13
    s_add_u32 s75, s75, s71
    s_add_u32 s75, s75, 0xC0000
    s_mov_b32 s66, 4
LL_54:
    s_waitcnt vmcnt(39)
    s_mov_b32 m0, s64
    s_add_u32 s64, s64, 1024
    buffer_load_dwordx4 v6, s[52:55], s65 offen nt lds
    s_add_u32 s65, s65, 32768
    s_waitcnt vmcnt(39)
    s_mov_b32 m0, s64
    s_add_u32 s64, s64, 1024
    buffer_load_dwordx4 v7, s[52:55], s65 offen nt lds
    s_add_u32 s65, s65, 32768
    s_waitcnt vmcnt(39)
    s_mov_b32 m0, s64
    s_add_u32 s64, s64, 1024
    buffer_load_dwordx4 v8, s[52:55], s65 offen nt lds
    s_add_u32 s65, s65, 32768
    s_waitcnt vmcnt(39)
    s_mov_b32 m0, s64
    s_add_u32 s64, s64, 1024
    buffer_load_dwordx4 v9, s[52:55], s65 offen nt lds
    s_add_u32 s65, s65, 32768
    s_waitcnt vmcnt(39)
    s_mov_b32 m0, s64
    s_add_u32 s64, s64, 1024
    buffer_load_dwordx4 v6, s[52:55], s65 offen nt lds
    s_add_u32 s65, s65, 32768
    s_waitcnt vmcnt(39)
    s_mov_b32 m0, s64
    s_add_u32 s64, s64, 1024
    buffer_load_dwordx4 v7, s[52:55], s65 offen nt lds
    s_add_u32 s65, s65, 32768
    s_waitcnt vmcnt(39)
    s_mov_b32 m0, s64
    s_add_u32 s64, s64, 1024
    buffer_load_dwordx4 v8, s[52:55], s65 offen nt lds
    s_add_u32 s65, s65, 32768
    s_waitcnt vmcnt(39)
    s_sub_u32 s7, s60, 32
    s_max_i32 s61, s61, s7
    v_mov_b32 v19, s61
    ds_write_b32 v16, v19
    s_mov_b32 m0, s64
    s_add_u32 s64, s64, 1024
    buffer_load_dwordx4 v9, s[52:55], s65 offen nt lds
    s_add_u32 s65, s65, 32768
    s_add_u32 s60, s60, 8
    s_sub_u32 s66, s66, 1
    s_cmp_lg_u32 s66, 0
    s_cbranch_scc1 LL_54
    s_waitcnt vmcnt(32)
    s_sub_u32 s7, s60, 32
    s_max_i32 s61, s61, s7
    v_mov_b32 v19, s61
    ds_write_b32 v16, v19
    s_waitcnt vmcnt(24)
    s_sub_u32 s7, s60, 24
    s_max_i32 s61, s61, s7
    v_mov_b32 v19, s61
    ds_write_b32 v16, v19
    s_waitcnt vmcnt(16)
    s_sub_u32 s7, s60, 16
    s_max_i32 s61, s61, s7
    v_mov_b32 v19, s61
    ds_write_b32 v16, v19
    s_waitcnt vmcnt(8)
    s_sub_u32 s7, s60, 8
    s_max_i32 s61, s61, s7
    v_mov_b32 v19, s61
    ds_write_b32 v16, v19
    s_waitcnt vmcnt(0)
    s_mov_b32 s61, s60
    v_mov_b32 v19, s61
    ds_write_b32 v16, v19
    v_mov_b32 v40, 0x24208
    s_mov_b32 s80, 1600000
LW_55:
    ds_read_b32 v41, v40
    s_waitcnt lgkmcnt(0)
    v_readfirstlane_b32 s79, v41
    s_cmp_ge_u32 s79, 148
    s_cbranch_scc1 LWD_56
    s_sub_u32 s80, s80, 1
    s_cmp_lg_u32 s80, 0
    s_cbranch_scc1 LW_55
LWD_56:
    s_lshl_b32 s65, s4, 8
    s_lshl_b32 s7, s5, 7
    s_add_u32 s65, s65, s7
    s_sub_u32 s65, s65, 512
    s_mov_b32 s64, 0
    s_mov_b32 s66, 8
LL_57:
    s_waitcnt vmcnt(23)
    s_mov_b32 m0, s64
    s_add_u32 s64, s64, 1024
    buffer_load_dwordx4 v20, s[44:47], s65 offen nt lds
    s_add_u32 s65, s65, 65536
    s_waitcnt vmcnt(23)
    s_mov_b32 m0, s64
    s_add_u32 s64, s64, 1024
    buffer_load_dwordx4 v20, s[44:47], s65 offen nt lds
    s_add_u32 s65, s65, 65536
    s_waitcnt vmcnt(23)
    s_mov_b32 m0, s64
    s_add_u32 s64, s64, 1024
    buffer_load_dwordx4 v20, s[44:47], s65 offen nt lds
    s_add_u32 s65, s65, 65536
    s_waitcnt vmcnt(23)
    s_mov_b32 m0, s64
    s_add_u32 s64, s64, 1024
    buffer_load_dwordx4 v20, s[44:47], s65 offen nt lds
    s_add_u32 s65, s65, 65536
    s_waitcnt vmcnt(23)
    s_mov_b32 m0, s64
    s_add_u32 s64, s64, 1024
    buffer_load_dwordx4 v20, s[44:47], s65 offen nt lds
    s_add_u32 s65, s65, 65536
    s_waitcnt vmcnt(23)
    s_mov_b32 m0, s64
    s_add_u32 s64, s64, 1024
    buffer_load_dwordx4 v20, s[44:47], s65 offen nt lds
    s_add_u32 s65, s65, 65536
    s_waitcnt vmcnt(23)
    s_mov_b32 m0, s64
    s_add_u32 s64, s64, 1024
    buffer_load_dwordx4 v20, s[44:47], s65 offen nt lds
    s_add_u32 s65, s65, 65536
    s_waitcnt vmcnt(23)
    s_sub_u32 s7, s60, 16
    s_max_i32 s61, s61, s7
    v_mov_b32 v19, s61
    ds_write_b32 v16, v19
    s_mov_b32 m0, s64
    s_add_u32 s64, s64, 1024
    buffer_load_dwordx4 v20, s[44:47], s65 offen nt lds
    s_add_u32 s65, s65, 65536
    s_add_u32 s60, s60, 8
    s_sub_u32 s66, s66, 1
    s_cmp_lg_u32 s66, 0
    s_cbranch_scc1 LL_57
    s_mov_b32 s62, 8
    s_mov_b32 s44, s10
    s_and_b32 s45, s11, 0xffff
    s_mov_b32 s46, 0x8000000
    s_mov_b32 s47, 0x20000
    s_mov_b32 s48, s12
    s_and_b32 s49, s13, 0xffff
    s_mov_b32 s50, 0x8000000
    s_mov_b32 s51, 0x20000
    s_mov_b32 s68, s72
    s_mov_b32 s69, s73
    s_mov_b32 s70, s74
    s_mov_b32 s71, s75
    s_mov_b32 s66, 16
LL_58:
    s_waitcnt lgkmcnt(0)
    v_readlane_b32 s79, v18, s62
    s_cmp_lt_u32 s79, s63
    s_cbranch_scc1 ST_60
GO_59:
    s_waitcnt vmcnt(23)
    s_add_u32 s7, s64, 0
    s_mov_b32 m0, s7
    s_add_u32 s65, s68, 0
    buffer_load_dwordx4 v10, s[44:47], s65 offen offset:0 nt lds
    s_waitcnt vmcnt(23)
    buffer_load_dwordx4 v11, s[44:47], s65 offen offset:1024 nt lds
    s_waitcnt vmcnt(23)
    buffer_load_dwordx4 v12, s[44:47], s65 offen offset:2048 nt lds
    s_waitcnt vmcnt(23)
    buffer_load_dwordx4 v13, s[44:47], s65 offen offset:3072 nt lds
    s_waitcnt vmcnt(23)
    s_add_u32 s7, s64, 4096
    s_mov_b32 m0, s7
    s_add_u32 s65, s68, 4096
    buffer_load_dwordx4 v10, s[44:47], s65 offen offset:0 nt lds
    s_waitcnt vmcnt(23)
    buffer_load_dwordx4 v11, s[44:47], s65 offen offset:1024 nt lds
    ds_read_b32 v18, v17
    s_waitcnt vmcnt(23)
    buffer_load_dwordx4 v12, s[44:47], s65 offen offset:2048 nt lds
    s_waitcnt vmcnt(23)
    s_sub_u32 s7, s60, 16
    s_max_i32 s61, s61, s7
    v_mov_b32 v19, s61
    ds_write_b32 v16, v19
    buffer_load_dwordx4 v13, s[44:47], s65 offen offset:3072 nt lds
    s_add_u32 s60, s60, 8
TJ_62:
    s_add_u32 s65, s65, 4096
    s_mov_b32 s68, s69
    s_mov_b32 s69, s70
    s_mov_b32 s70, s71
    s_mov_b32 s71, s65
    s_add_u32 s62, s62, 1
    s_add_u32 s64, s64, 8192
    s_cmp_eq_u32 s62, 10
    s_cselect_b32 s7, 4, 0
    s_add_u32 s63, s63, s7
    s_cmp_eq_u32 s62, 18
    s_cselect_b32 s62, 0, s62
    s_cselect_b32 s64, 0, s64
    s_sub_u32 s66, s66, 1
    s_cmp_lg_u32 s66, 0
    s_cbranch_scc1 LL_58
    s_mov_b32 s68, s72
    s_mov_b32 s69, s73
    s_mov_b32 s70, s74
    s_mov_b32 s71, s75
    s_mov_b32 s66, 4
LL_63:
    s_waitcnt lgkmcnt(0)
    v_readlane_b32 s79, v18, s62
    s_cmp_lt_u32 s79, s63
    s_cbranch_scc1 ST_65
GO_64:
    s_waitcnt vmcnt(23)
    s_add_u32 s7, s64, 0
    s_mov_b32 m0, s7
    s_add_u32 s65, s68, 0
    buffer_load_dwordx4 v14, s[48:51], s65 offen offset:0 nt lds
    s_waitcnt vmcnt(23)
    buffer_load_dwordx4 v15, s[48:51], s65 offen offset:1024 nt lds
    s_waitcnt vmcnt(23)
    buffer_load_dwordx4 v14, s[48:51], s65 offen offset:2048 nt lds
    s_waitcnt vmcnt(23)
    buffer_load_dwordx4 v15, s[48:51], s65 offen offset:3072 nt lds
    s_waitcnt vmcnt(23)
    s_add_u32 s7, s64, 4096
    s_mov_b32 m0, s7
    s_add_u32 s65, s68, 4096
    buffer_load_dwordx4 v14, s[48:51], s65 offen offset:0 nt lds
    s_waitcnt vmcnt(23)
    buffer_load_dwordx4 v15, s[48:51], s65 offen offset:1024 nt lds
    ds_read_b32 v18, v17
    s_waitcnt vmcnt(23)
    buffer_load_dwordx4 v14, s[48:51], s65 offen offset:2048 nt lds
    s_waitcnt vmcnt(23)
    s_sub_u32 s7, s60, 16
    s_max_i32 s61, s61, s7
    v_mov_b32 v19, s61
    ds_write_b32 v16, v19
    buffer_load_dwordx4 v15, s[48:51], s65 offen offset:3072 nt lds
    s_add_u32 s60, s60, 8
TJ_67:
    s_add_u32 s65, s65, 4096
    s_mov_b32 s68, s69
    s_mov_b32 s69, s70
    s_mov_b32 s70, s71
    s_mov_b32 s71, s65
    s_add_u32 s62, s62, 1
    s_add_u32 s64, s64, 8192
    s_cmp_eq_u32 s62, 10
    s_cselect_b32 s7, 4, 0
    s_add_u32 s63, s63, s7
    s_cmp_eq_u32 s62, 18
    s_cselect_b32 s62, 0, s62
    s_cselect_b32 s64, 0, s64
    s_sub_u32 s66, s66, 1
    s_cmp_lg_u32 s66, 0
    s_cbranch_scc1 LL_63
    s_mov_b32 s66, 7
LL_68:
    s_waitcnt lgkmcnt(0)
    v_readlane_b32 s79, v18, s62
    s_cmp_lt_u32 s79, s63
    s_cbranch_scc1 ST_70
GO_69:
    s_waitcnt vmcnt(25)
    s_add_u32 s7, s64, 0
    s_mov_b32 m0, s7
    s_add_u32 s65, s68, 0
    buffer_load_dwordx4 v14, s[48:51], s65 offen offset:0 nt lds
    s_waitcnt vmcnt(25)
    s_sub_u32 s7, s60, 24
    s_max_i32 s61, s61, s7
    v_mov_b32 v19, s61
    ds_write_b32 v16, v19
    buffer_load_dwordx4 v15, s[48:51], s65 offen offset:1024 nt lds
    s_waitcnt vmcnt(25)
    buffer_load_dwordx4 v14, s[48:51], s65 offen offset:2048 nt lds
    s_waitcnt vmcnt(25)
    buffer_load_dwordx4 v15, s[48:51], s65 offen offset:3072 nt lds
    s_waitcnt vmcnt(25)
    s_add_u32 s7, s64, 4096
    s_mov_b32 m0, s7
    s_add_u32 s65, s68, 4096
    buffer_load_dwordx4 v14, s[48:51], s65 offen offset:0 nt lds
    s_waitcnt vmcnt(25)
    buffer_load_dwordx4 v15, s[48:51], s65 offen offset:1024 nt lds
    ds_read_b32 v18, v17
    s_waitcnt vmcnt(25)
    buffer_load_dwordx4 v14, s[48:51], s65 offen offset:2048 nt lds
    s_waitcnt vmcnt(25)
    buffer_load_dwordx4 v15, s[48:51], s65 offen offset:3072 nt lds
    s_add_u32 s60, s60, 8
TJ_72:
    s_add_u32 s65, s65, 4096
    s_mov_b32 s68, s69
    s_mov_b32 s69, s70
    s_mov_b32 s70, s71
    s_mov_b32 s71, s65
    s_add_u32 s62, s62, 1
    s_add_u32 s64, s64, 8192
    s_cmp_eq_u32 s62, 10
    s_cselect_b32 s7, 4, 0
    s_add_u32 s63, s63, s7
    s_cmp_eq_u32 s62, 18
    s_cselect_b32 s62, 0, s62
    s_cselect_b32 s64, 0, s64
    s_sub_u32 s66, s66, 1
    s_cmp_lg_u32 s66, 0
    s_cbranch_scc1 LL_68
    s_mov_b32 s66, 5
LL_73:
    s_waitcnt lgkmcnt(0)
    v_readlane_b32 s79, v18, s62
    s_cmp_lt_u32 s79, s63
    s_cbranch_scc1 ST_75
GO_74:
    s_waitcnt vmcnt(39)
    s_add_u32 s7, s64, 0
    s_mov_b32 m0, s7
    s_add_u32 s65, s68, 0
    buffer_load_dwordx4 v14, s[48:51], s65 offen offset:0 nt lds
    s_waitcnt vmcnt(39)
    buffer_load_dwordx4 v15, s[48:51], s65 offen offset:1024 nt lds
    s_waitcnt vmcnt(39)
    buffer_load_dwordx4 v14, s[48:51], s65 offen offset:2048 nt lds
    s_waitcnt vmcnt(39)
    buffer_load_dwordx4 v15, s[48:51], s65 offen offset:3072 nt lds
    s_waitcnt vmcnt(39)
    s_add_u32 s7, s64, 4096
    s_mov_b32 m0, s7
    s_add_u32 s65, s68, 4096
    buffer_load_dwordx4 v14, s[48:51], s65 offen offset:0 nt lds
    s_waitcnt vmcnt(39)
    buffer_load_dwordx4 v15, s[48:51], s65 offen offset:1024 nt lds
    ds_read_b32 v18, v17
    s_waitcnt vmcnt(39)
    buffer_load_dwordx4 v14, s[48:51], s65 offen offset:2048 nt lds
    s_waitcnt vmcnt(39)
    s_sub_u32 s7, s60, 32
    s_max_i32 s61, s61, s7
    v_mov_b32 v19, s61
    ds_write_b32 v16, v19
    buffer_load_dwordx4 v15, s[48:51], s65 offen offset:3072 nt lds
    s_add_u32 s60, s60, 8
TJ_77:
    s_add_u32 s65, s65, 4096
    s_mov_b32 s68, s69
    s_mov_b32 s69, s70
    s_mov_b32 s70, s71
    s_mov_b32 s71, s65
    s_add_u32 s62, s62, 1
    s_add_u32 s64, s64, 8192
    s_cmp_eq_u32 s62, 10
    s_cselect_b32 s7, 4, 0
    s_add_u32 s63, s63, s7
    s_cmp_eq_u32 s62, 18
    s_cselect_b32 s62, 0, s62
    s_cselect_b32 s64, 0, s64
    s_sub_u32 s66, s66, 1
    s_cmp_lg_u32 s66, 0
    s_cbranch_scc1 LL_73
    s_waitcnt vmcnt(32)
    s_sub_u32 s7, s60, 32
    s_max_i32 s61, s61, s7
    v_mov_b32 v19, s61
    ds_write_b32 v16, v19
    s_waitcnt vmcnt(24)
    s_sub_u32 s7, s60, 24
    s_max_i32 s61, s61, s7
    v_mov_b32 v19, s61
    ds_write_b32 v16, v19
    s_waitcnt vmcnt(16)
    s_sub_u32 s7, s60, 16
    s_max_i32 s61, s61, s7
    v_mov_b32 v19, s61
    ds_write_b32 v16, v19
    s_waitcnt vmcnt(8)
    s_sub_u32 s7, s60, 8
    s_max_i32 s61, s61, s7
    v_mov_b32 v19, s61
    ds_write_b32 v16, v19
    s_waitcnt vmcnt(0)
    s_mov_b32 s61, s60
    v_mov_b32 v19, s61
    ds_write_b32 v16, v19
    s_endpgm
L_LDB:
    s_setprio 3
    v_lshlrev_b32 v20, 4, v1
    v_xor_b32 v21, 0x40, v20
    v_xor_b32 v22, 0x80, v20
    v_xor_b32 v23, 0xc0, v20
    v_xor_b32 v24, 0x10, v20
    v_xor_b32 v25, 0x50, v20
    v_xor_b32 v26, 0x90, v20
    v_xor_b32 v27, 0xd0, v20
    v_xor_b32 v28, 0x20, v20
    v_xor_b32 v29, 0x60, v20
    v_xor_b32 v30, 0xa0, v20
    v_xor_b32 v31, 0xe0, v20
    v_xor_b32 v32, 0x30, v20
    v_xor_b32 v33, 0x70, v20
    v_xor_b32 v34, 0xb0, v20
    v_xor_b32 v35, 0xf0, v20
    s_and_b32 s69, s4, 7
    s_lshl_b32 s69, s69, 3
    s_lshr_b32 s7, s4, 3
    s_lshl_b32 s7, s7, 1
    s_add_u32 s69, s69, s7
    s_add_u32 s69, s69, s5
    s_sub_u32 s69, s69, 6
    s_lshl_b32 s68, s69, 18
    s_mov_b32 s64, 0
    s_waitcnt lgkmcnt(0)
    s_mov_b32 s44, s20
    s_and_b32 s45, s21, 0xffff
    s_mov_b32 s46, 0x1000000
    s_mov_b32 s47, 0x20000
    s_add_u32 s7, s64, 0
    s_mov_b32 m0, s7
    s_add_u32 s65, s68, 0
    buffer_load_dwordx4 v20, s[44:47], s65 offen offset:0 nt lds
    buffer_load_dwordx4 v21, s[44:47], s65 offen offset:1024 nt lds
    buffer_load_dwordx4 v22, s[44:47], s65 offen offset:2048 nt lds
    buffer_load_dwordx4 v23, s[44:47], s65 offen offset:3072 nt lds
    s_add_u32 s7, s64, 4096
    s_mov_b32 m0, s7
    s_add_u32 s65, s68, 4096
    buffer_load_dwordx4 v24, s[44:47], s65 offen offset:0 nt lds
    buffer_load_dwordx4 v25, s[44:47], s65 offen offset:1024 nt lds
    buffer_load_dwordx4 v26, s[44:47], s65 offen offset:2048 nt lds
    buffer_load_dwordx4 v27, s[44:47], s65 offen offset:3072 nt lds
    s_add_u32 s7, s64, 8192
    s_mov_b32 m0, s7
    s_add_u32 s65, s68, 8192
    buffer_load_dwordx4 v28, s[44:47], s65 offen offset:0 nt lds
    buffer_load_dwordx4 v29, s[44:47], s65 offen offset:1024 nt lds
    buffer_load_dwordx4 v30, s[44:47], s65 offen offset:2048 nt lds
    buffer_load_dwordx4 v31, s[44:47], s65 offen offset:3072 nt lds
    s_add_u32 s7, s64, 12288
    s_mov_b32 m0, s7
    s_add_u32 s65, s68, 12288
    buffer_load_dwordx4 v32, s[44:47], s65 offen offset:0 nt lds
    buffer_load_dwordx4 v33, s[44:47], s65 offen offset:1024 nt lds
    buffer_load_dwordx4 v34, s[44:47], s65 offen offset:2048 nt lds
    buffer_load_dwordx4 v35, s[44:47], s65 offen offset:3072 nt lds
    s_barrier
    s_mov_b32 s61, 0
    s_mov_b32 s63, 0
    v_lshlrev_b32 v16, 2, v1
    v_add_u32 v17, 0x24100, v16
    v_add_u32 v16, 0x24000, v16
    v_mov_b32 v18, 0
    s_mov_b32 s60, 16
    s_mov_b32 s36, s34
    s_and_b32 s37, s35, 0xffff
    s_mov_b32 s38, 0x1000000
    s_mov_b32 s39, 0x20000
    s_add_u32 s68, s68, 16384
    s_mov_b32 s64, 16384
    s_mov_b32 s48, s28
    s_and_b32 s49, s29, 0xffff
    s_mov_b32 s50, 0x400000
    s_mov_b32 s51, 0x20000
    v_bfe_u32 v10, v1, 1, 2
    v_xor_b32 v10, v10, v2
    v_lshlrev_b32 v10, 5, v10
    v_lshrrev_b32 v40, 3, v1
    v_lshl_add_u32 v10, v40, 10, v10
    v_and_b32 v40, 1, v1
    v_lshl_add_u32 v10, v40, 4, v10
    s_mov_b32 s72, 0x22551111
    s_mov_b32 s73, 0x2
    s_mov_b32 s74, 0x54873210
    s_mov_b32 s75, 0x6
    s_lshl_b32 s7, s69, 9
    s_add_u32 s7, s7, 0x28000
    v_lshl_add_u32 v44, v1, 4, s7
    s_mov_b32 s66, 6
LL_78:
    s_waitcnt vmcnt(27)
    s_add_u32 s7, s64, 0
    s_mov_b32 m0, s7
    s_add_u32 s65, s68, 0
    buffer_load_dwordx4 v20, s[44:47], s65 offen offset:0 nt lds
    s_waitcnt vmcnt(27)
    buffer_load_dwordx4 v21, s[44:47], s65 offen offset:1024 nt lds
    s_waitcnt vmcnt(27)
    buffer_load_dwordx4 v22, s[44:47], s65 offen offset:2048 nt lds
    s_waitcnt vmcnt(27)
    s_sub_u32 s7, s60, 24
    s_max_i32 s61, s61, s7
    v_mov_b32 v19, s61
    ds_write_b32 v16, v19
    buffer_load_dwordx4 v23, s[44:47], s65 offen offset:3072 nt lds
    s_waitcnt vmcnt(27)
    s_add_u32 s7, s64, 4096
    s_mov_b32 m0, s7
    s_add_u32 s65, s68, 4096
    buffer_load_dwordx4 v24, s[44:47], s65 offen offset:0 nt lds
    s_waitcnt vmcnt(27)
    buffer_load_dwordx4 v25, s[44:47], s65 offen offset:1024 nt lds
    s_waitcnt vmcnt(27)
    buffer_load_dwordx4 v26, s[44:47], s65 offen offset:2048 nt lds
    s_waitcnt vmcnt(27)
    buffer_load_dwordx4 v27, s[44:47], s65 offen offset:3072 nt lds
    s_waitcnt vmcnt(27)
    s_add_u32 s7, s64, 8192
    s_mov_b32 m0, s7
    s_add_u32 s65, s68, 8192
    buffer_load_dwordx4 v28, s[44:47], s65 offen offset:0 nt lds
    s_waitcnt vmcnt(27)
    buffer_load_dwordx4 v29, s[44:47], s65 offen offset:1024 nt lds
    s_waitcnt vmcnt(27)
    buffer_load_dwordx4 v30, s[44:47], s65 offen offset:2048 nt lds
    s_waitcnt vmcnt(27)
    s_sub_u32 s7, s60, 16
    s_max_i32 s61, s61, s7
    v_mov_b32 v19, s61
    ds_write_b32 v16, v19
    buffer_load_dwordx4 v31, s[44:47], s65 offen offset:3072 nt lds
    s_waitcnt vmcnt(27)
    s_add_u32 s7, s64, 12288
    s_mov_b32 m0, s7
    s_add_u32 s65, s68, 12288
    buffer_load_dwordx4 v32, s[44:47], s65 offen offset:0 nt lds
    s_waitcnt vmcnt(27)
    buffer_load_dwordx4 v33, s[44:47], s65 offen offset:1024 nt lds
    s_waitcnt vmcnt(27)
    buffer_load_dwordx4 v34, s[44:47], s65 offen offset:2048 nt lds
    s_waitcnt vmcnt(27)
    buffer_load_dwordx4 v35, s[44:47], s65 offen offset:3072 nt lds
    s_add_u32 s60, s60, 16
    s_add_u32 s68, s68, 16384
    s_add_u32 s64, s64, 16384
    s_sub_u32 s66, s66, 1
    s_cmp_lg_u32 s66, 0
    s_cbranch_scc1 LL_78
    v_mov_b32 v40, 0x24204
    s_mov_b32 s80, 1600000
LW_79:
    ds_read_b32 v41, v40
    s_waitcnt lgkmcnt(0)
    v_readfirstlane_b32 s79, v41
    s_cmp_ge_u32 s79, 1
    s_cbranch_scc1 LWD_80
    s_sleep 1
    s_sub_u32 s80, s80, 1
    s_cmp_lg_u32 s80, 0
    s_cbranch_scc1 LW_79
LWD_80:
    v_mov_b32 v40, 0x24248
    ds_read_b64 v[42:43], v40
    s_waitcnt lgkmcnt(0)
    v_readfirstlane_b32 s92, v42
    v_readfirstlane_b32 s93, v43
    s_lshr_b32 s7, s69, 3
    s_lshl_b32 s7, s7, 7
    s_add_u32 s7, s7, 0x22000
    v_and_b32 v38, 7, v1
    v_lshl_add_u32 v38, v38, 3, s7
    s_mov_b32 s66, 4
LL_81:
    s_and_b32 s63, s72, 3
    s_lshl_b32 s63, s63, 3
    s_bfe_u32 s62, s72, 0x20002
    s_lshr_b64 s[72:73], s[72:73], 4
    s_and_b32 s64, s74, 15
    s_lshl_b32 s64, s64, 14
    s_lshr_b64 s[74:75], s[74:75], 4
    s_waitcnt lgkmcnt(0)
    v_readlane_b32 s79, v18, s62
    s_cmp_lt_u32 s79, s63
    s_cbranch_scc1 ST_83
GO_82:
    s_waitcnt vmcnt(19)
    s_add_u32 s7, s64, 0
    s_mov_b32 m0, s7
    s_add_u32 s65, s68, 0
    buffer_load_dwordx4 v20, s[44:47], s65 offen offset:0 nt lds
    s_waitcnt vmcnt(19)
    buffer_load_dwordx4 v21, s[44:47], s65 offen offset:1024 nt lds
    s_waitcnt vmcnt(19)
    buffer_load_dwordx4 v22, s[44:47], s65 offen offset:2048 nt lds
    s_waitcnt vmcnt(19)
    s_sub_u32 s7, s60, 16
    s_max_i32 s61, s61, s7
    v_mov_b32 v19, s61
    ds_write_b32 v16, v19
    buffer_load_dwordx4 v23, s[44:47], s65 offen offset:3072 nt lds
    s_waitcnt vmcnt(19)
    s_add_u32 s7, s64, 4096
    s_mov_b32 m0, s7
    s_add_u32 s65, s68, 4096
    buffer_load_dwordx4 v24, s[44:47], s65 offen offset:0 nt lds
    s_waitcnt vmcnt(19)
    buffer_load_dwordx4 v25, s[44:47], s65 offen offset:1024 nt lds
    s_waitcnt vmcnt(19)
    buffer_load_dwordx4 v26, s[44:47], s65 offen offset:2048 nt lds
    s_waitcnt vmcnt(19)
    buffer_load_dwordx4 v27, s[44:47], s65 offen offset:3072 nt lds
    s_waitcnt vmcnt(19)
    s_add_u32 s7, s64, 8192
    s_mov_b32 m0, s7
    s_add_u32 s65, s68, 8192
    buffer_load_dwordx4 v28, s[44:47], s65 offen offset:0 nt lds
    s_waitcnt vmcnt(19)
    buffer_load_dwordx4 v29, s[44:47], s65 offen offset:1024 nt lds
    s_waitcnt vmcnt(19)
    buffer_load_dwordx4 v30, s[44:47], s65 offen offset:2048 nt lds
    s_waitcnt vmcnt(19)
    s_sub_u32 s7, s60, 8
    s_max_i32 s61, s61, s7
    v_mov_b32 v19, s61
    ds_write_b32 v16, v19
    buffer_load_dwordx4 v31, s[44:47], s65 offen offset:3072 nt lds
    s_waitcnt vmcnt(19)
    s_add_u32 s7, s64, 12288
    s_mov_b32 m0, s7
    s_add_u32 s65, s68, 12288
    buffer_load_dwordx4 v32, s[44:47], s65 offen offset:0 nt lds
    s_waitcnt vmcnt(19)
    buffer_load_dwordx4 v33, s[44:47], s65 offen offset:1024 nt lds
    ds_read_b32 v18, v17
    s_waitcnt vmcnt(19)
    buffer_load_dwordx4 v34, s[44:47], s65 offen offset:2048 nt lds
    s_waitcnt vmcnt(19)
    buffer_load_dwordx4 v35, s[44:47], s65 offen offset:3072 nt lds
    s_add_u32 s60, s60, 16
    s_add_u32 s68, s68, 16384
    s_sub_u32 s66, s66, 1
    s_cmp_lg_u32 s66, 0
    s_cbranch_scc1 LL_81
    s_mov_b32 s66, 5
LL_84:
    s_and_b32 s63, s72, 3
    s_lshl_b32 s63, s63, 3
    s_bfe_u32 s62, s72, 0x20002
    s_lshr_b64 s[72:73], s[72:73], 4
    s_and_b32 s64, s74, 15
    s_lshl_b32 s64, s64, 14
    s_lshr_b64 s[74:75], s[74:75], 4
    s_waitcnt lgkmcnt(0)
    v_readlane_b32 s79, v18, s62
    s_cmp_lt_u32 s79, s63
    s_cbranch_scc1 ST_86
GO_85:
    s_waitcnt vmcnt(31)
    s_add_u32 s7, s64, 0
    s_mov_b32 m0, s7
    s_add_u32 s65, s68, 0
    buffer_load_dwordx4 v20, s[44:47], s65 offen offset:0 nt lds
    s_waitcnt vmcnt(31)
    buffer_load_dwordx4 v21, s[44:47], s65 offen offset:1024 nt lds
    s_waitcnt vmcnt(31)
    buffer_load_dwordx4 v22, s[44:47], s65 offen offset:2048 nt lds
    s_waitcnt vmcnt(31)
    buffer_load_dwordx4 v23, s[44:47], s65 offen offset:3072 nt lds
    s_waitcnt vmcnt(31)
    s_add_u32 s7, s64, 4096
    s_mov_b32 m0, s7
    s_add_u32 s65, s68, 4096
    buffer_load_dwordx4 v24, s[44:47], s65 offen offset:0 nt lds
    s_waitcnt vmcnt(31)
    buffer_load_dwordx4 v25, s[44:47], s65 offen offset:1024 nt lds
    s_waitcnt vmcnt(31)
    buffer_load_dwordx4 v26, s[44:47], s65 offen offset:2048 nt lds
    s_waitcnt vmcnt(31)
    s_sub_u32 s7, s60, 24
    s_max_i32 s61, s61, s7
    v_mov_b32 v19, s61
    ds_write_b32 v16, v19
    buffer_load_dwordx4 v27, s[44:47], s65 offen offset:3072 nt lds
    s_waitcnt vmcnt(31)
    s_add_u32 s7, s64, 8192
    s_mov_b32 m0, s7
    s_add_u32 s65, s68, 8192
    buffer_load_dwordx4 v28, s[44:47], s65 offen offset:0 nt lds
    s_waitcnt vmcnt(31)
    buffer_load_dwordx4 v29, s[44:47], s65 offen offset:1024 nt lds
    s_waitcnt vmcnt(31)
    buffer_load_dwordx4 v30, s[44:47], s65 offen offset:2048 nt lds
    s_waitcnt vmcnt(31)
    buffer_load_dwordx4 v31, s[44:47], s65 offen offset:3072 nt lds
    s_waitcnt vmcnt(31)
    s_add_u32 s7, s64, 12288
    s_mov_b32 m0, s7
    s_add_u32 s65, s68, 12288
    buffer_load_dwordx4 v32, s[44:47], s65 offen offset:0 nt lds
    s_waitcnt vmcnt(31)
    buffer_load_dwordx4 v33, s[44:47], s65 offen offset:1024 nt lds
    ds_read_b32 v18, v17
    s_waitcnt vmcnt(31)
    buffer_load_dwordx4 v34, s[44:47], s65 offen offset:2048 nt lds
    s_waitcnt vmcnt(31)
    s_sub_u32 s7, s60, 16
    s_max_i32 s61, s61, s7
    v_mov_b32 v19, s61
    ds_write_b32 v16, v19
    buffer_load_dwordx4 v35, s[44:47], s65 offen offset:3072 nt lds
    s_add_u32 s60, s60, 16
    s_add_u32 s68, s68, 16384
    s_sub_u32 s66, s66, 1
    s_cmp_lg_u32 s66, 0
    s_cbranch_scc1 LL_84
    s_and_b32 s7, s69, 7
    s_lshl_b64 exec, 1, s7
    buffer_store_dwordx2 v[42:43], v38, s[36:39], 0 offen offset:2048 sc1
    s_mov_b64 exec, -1
    buffer_load_dwordx2 v[46:47], v38, s[36:39], 0 offen sc1 nt
    s_lshr_b32 s65, s69, 3
    s_lshl_b32 s65, s65, 17
    s_and_b32 s7, s69, 7
    s_lshl_b32 s7, s7, 7
    s_add_u32 s65, s65, s7
    s_mov_b32 s64, 0
    s_mov_b32 s63, 24
    s_waitcnt lgkmcnt(0)
    v_readlane_b32 s79, v18, 0
    s_cmp_lt_u32 s79, s63
    s_cbranch_scc1 ST_88
GO_87:
    s_mov_b32 s66, 1
LL_89:
    s_waitcnt vmcnt(31)
    s_mov_b32 m0, s64
    s_add_u32 s64, s64, 1024
    buffer_load_dwordx4 v10, s[48:51], s65 offen nt lds
    s_add_u32 s65, s65, 8192
    s_waitcnt vmcnt(31)
    s_mov_b32 m0, s64
    s_add_u32 s64, s64, 1024
    buffer_load_dwordx4 v10, s[48:51], s65 offen nt lds
    s_add_u32 s65, s65, 8192
    s_waitcnt vmcnt(31)
    s_mov_b32 m0, s64
    s_add_u32 s64, s64, 1024
    buffer_load_dwordx4 v10, s[48:51], s65 offen nt lds
    s_add_u32 s65, s65, 8192
    s_waitcnt vmcnt(31)
    s_mov_b32 m0, s64
    s_add_u32 s64, s64, 1024
    buffer_load_dwordx4 v10, s[48:51], s65 offen nt lds
    s_add_u32 s65, s65, 8192
    s_waitcnt vmcnt(31)
    s_mov_b32 m0, s64
    s_add_u32 s64, s64, 1024
    buffer_load_dwordx4 v10, s[48:51], s65 offen nt lds
    s_add_u32 s65, s65, 8192
    s_waitcnt vmcnt(31)
    s_mov_b32 m0, s64
    s_add_u32 s64, s64, 1024
    buffer_load_dwordx4 v10, s[48:51], s65 offen nt lds
    s_add_u32 s65, s65, 8192
    s_waitcnt vmcnt(31)
    s_mov_b32 m0, s64
    s_add_u32 s64, s64, 1024
    buffer_load_dwordx4 v10, s[48:51], s65 offen nt lds
    s_add_u32 s65, s65, 8192
    s_waitcnt vmcnt(31)
    s_sub_u32 s7, s60, 24
    s_max_i32 s61, s61, s7
    v_mov_b32 v19, s61
    ds_write_b32 v16, v19
    s_mov_b32 m0, s64
    s_add_u32 s64, s64, 1024
    buffer_load_dwordx4 v10, s[48:51], s65 offen nt lds
    s_add_u32 s65, s65, 8192
    s_waitcnt vmcnt(31)
    s_mov_b32 m0, s64
    s_add_u32 s64, s64, 1024
    buffer_load_dwordx4 v10, s[48:51], s65 offen nt lds
    s_add_u32 s65, s65, 8192
    s_waitcnt vmcnt(31)
    s_mov_b32 m0, s64
    s_add_u32 s64, s64, 1024
    buffer_load_dwordx4 v10, s[48:51], s65 offen nt lds
    s_add_u32 s65, s65, 8192
    s_waitcnt vmcnt(31)
    s_mov_b32 m0, s64
    s_add_u32 s64, s64, 1024
    buffer_load_dwordx4 v10, s[48:51], s65 offen nt lds
    s_add_u32 s65, s65, 8192
    s_waitcnt vmcnt(31)
    s_mov_b32 m0, s64
    s_add_u32 s64, s64, 1024
    buffer_load_dwordx4 v10, s[48:51], s65 offen nt lds
    s_add_u32 s65, s65, 8192
    s_waitcnt vmcnt(31)
    s_mov_b32 m0, s64
    s_add_u32 s64, s64, 1024
    buffer_load_dwordx4 v10, s[48:51], s65 offen nt lds
    s_add_u32 s65, s65, 8192
    s_waitcnt vmcnt(31)
    s_mov_b32 m0, s64
    s_add_u32 s64, s64, 1024
    buffer_load_dwordx4 v10, s[48:51], s65 offen nt lds
    s_add_u32 s65, s65, 8192
    s_waitcnt vmcnt(31)
    s_mov_b32 m0, s64
    s_add_u32 s64, s64, 1024
    buffer_load_dwordx4 v10, s[48:51], s65 offen nt lds
    s_add_u32 s65, s65, 8192
    s_waitcnt vmcnt(31)
    s_sub_u32 s7, s60, 16
    s_max_i32 s61, s61, s7
    v_mov_b32 v19, s61
    ds_write_b32 v16, v19
    s_mov_b32 m0, s64
    s_add_u32 s64, s64, 1024
    buffer_load_dwordx4 v10, s[48:51], s65 offen nt lds
    s_add_u32 s65, s65, 8192
    s_add_u32 s60, s60, 16
    s_add_u32 s65, s65, 917504
    s_sub_u32 s66, s66, 1
    s_cmp_lg_u32 s66, 0
    s_cbranch_scc1 LL_89
    s_waitcnt vmcnt(24)
    s_sub_u32 s7, s60, 24
    s_max_i32 s61, s61, s7
    v_mov_b32 v19, s61
    ds_write_b32 v16, v19
    s_waitcnt vmcnt(16)
    s_sub_u32 s7, s60, 16
    s_max_i32 s61, s61, s7
    v_mov_b32 v19, s61
    ds_write_b32 v16, v19
    s_waitcnt vmcnt(8)
    s_sub_u32 s7, s60, 8
    s_max_i32 s61, s61, s7
    v_mov_b32 v19, s61
    ds_write_b32 v16, v19
    s_waitcnt vmcnt(0)
    s_mov_b32 s61, s60
    v_mov_b32 v19, s61
    ds_write_b32 v16, v19
    v_and_b32 v45, 31, v1
    v_lshlrev_b32 v45, 3, v45
    v_lshrrev_b32 v48, 5, v1
    v_lshl_add_u32 v45, v48, 11, v45
    v_add_u32 v45, 0x24400, v45
    s_or_b32 s95, s95, s78
    s_add_u32 s88, s94, 0x10000
    s_addc_u32 s89, s95, 0
    s_mov_b32 s101, 1
    s_mov_b64 exec, 0xff
    s_branch UU_92
U_91:
    buffer_load_dwordx2 v[46:47], v38, s[36:39], 0 offen sc1 nt
UU_92:
    s_waitcnt vmcnt(0)
    v_cmp_gt_u64 s[90:91], s[94:95], v[46:47]
    v_cmp_le_u64 vcc, s[88:89], v[46:47]
    s_or_b64 vcc, vcc, s[90:91]
    s_cbranch_scc0 UD_93
    s_sleep 0
    s_sub_u32 s101, s101, 1
    s_cmp_lg_u32 s101, 0
    s_cbranch_scc1 U_91
UD_93:
    s_mov_b64 exec, -1
    v_mov_b32 v48, 0x2420c
    s_mov_b32 s80, 1600000
LW_94:
    ds_read_b32 v49, v48
    s_waitcnt lgkmcnt(0)
    v_readfirstlane_b32 s79, v49
    s_cmp_ge_u32 s79, 40
    s_cbranch_scc1 LWD_95
    s_sub_u32 s80, s80, 1
    s_cmp_lg_u32 s80, 0
    s_cbranch_scc1 LW_94
LWD_95:
    ds_read_b64 v[48:49], v45 offset:0
    ds_read_b64 v[50:51], v45 offset:256
    ds_read_b64 v[52:53], v45 offset:512
    ds_read_b64 v[54:55], v45 offset:768
    ds_read_b64 v[56:57], v45 offset:1024
    ds_read_b64 v[58:59], v45 offset:1280
    ds_read_b64 v[60:61], v45 offset:1536
    ds_read_b64 v[62:63], v45 offset:1792
    s_waitcnt lgkmcnt(0)
    v_max3_f32 v40, v48, v50, v52
    v_max3_f32 v40, v40, v54, v56
    v_max3_f32 v40, v40, v58, v60
    v_max_f32 v40, v40, v62
    v_mov_b32 v41, v40
    s_nop 1
    v_permlane32_swap_b32 v40, v41
    v_max_f32 v40, v40, v41
    v_sub_f32 v48, v48, v40
    v_sub_f32 v50, v50, v40
    v_sub_f32 v52, v52, v40
    v_sub_f32 v54, v54, v40
    v_sub_f32 v56, v56, v40
    v_sub_f32 v58, v58, v40
    v_sub_f32 v60, v60, v40
    v_sub_f32 v62, v62, v40
    v_exp_f32 v48, v48
    v_exp_f32 v50, v50
    v_exp_f32 v52, v52
    v_exp_f32 v54, v54
    v_exp_f32 v56, v56
    v_exp_f32 v58, v58
    v_exp_f32 v60, v60
    v_exp_f32 v62, v62
    v_mul_f32 v41, v48, v49
    v_fmac_f32 v41, v50, v51
    v_fmac_f32 v41, v52, v53
    v_fmac_f32 v41, v54, v55
    v_fmac_f32 v41, v56, v57
    v_fmac_f32 v41, v58, v59
    v_fmac_f32 v41, v60, v61
    v_fmac_f32 v41, v62, v63
    v_mov_b32 v48, v41
    s_nop 1
    v_permlane32_swap_b32 v41, v48
    v_add_f32 v41, v41, v48
    s_mov_b64 exec, 0xffffffff
    s_cmp_eq_u32 s101, 0
    s_cbranch_scc1 SU_96
    buffer_store_dwordx4 v[40:43], v44, s[36:39], 0 offen
SV_97:
    s_mov_b64 exec, -1
    v_mov_b32 v48, 0x24218
    s_mov_b32 s80, 1600000
LW_98:
    ds_read_b32 v49, v48
    s_waitcnt lgkmcnt(0)
    v_readfirstlane_b32 s79, v49
    s_cmp_ge_u32 s79, 16
    s_cbranch_scc1 LWD_99
    s_sleep 1
    s_sub_u32 s80, s80, 1
    s_cmp_lg_u32 s80, 0
    s_cbranch_scc1 LW_98
LWD_99:
LWO_90:
    s_mov_b32 s66, 3
LL_100:
    s_waitcnt vmcnt(31)
    s_mov_b32 m0, s64
    s_add_u32 s64, s64, 1024
    buffer_load_dwordx4 v10, s[48:51], s65 offen nt lds
    s_add_u32 s65, s65, 8192
    s_waitcnt vmcnt(31)
    s_mov_b32 m0, s64
    s_add_u32 s64, s64, 1024
    buffer_load_dwordx4 v10, s[48:51], s65 offen nt lds
    s_add_u32 s65, s65, 8192
    s_waitcnt vmcnt(31)
    s_mov_b32 m0, s64
    s_add_u32 s64, s64, 1024
    buffer_load_dwordx4 v10, s[48:51], s65 offen nt lds
    s_add_u32 s65, s65, 8192
    s_waitcnt vmcnt(31)
    s_mov_b32 m0, s64
    s_add_u32 s64, s64, 1024
    buffer_load_dwordx4 v10, s[48:51], s65 offen nt lds
    s_add_u32 s65, s65, 8192
    s_waitcnt vmcnt(31)
    s_mov_b32 m0, s64
    s_add_u32 s64, s64, 1024
    buffer_load_dwordx4 v10, s[48:51], s65 offen nt lds
    s_add_u32 s65, s65, 8192
    s_waitcnt vmcnt(31)
    s_mov_b32 m0, s64
    s_add_u32 s64, s64, 1024
    buffer_load_dwordx4 v10, s[48:51], s65 offen nt lds
    s_add_u32 s65, s65, 8192
    s_waitcnt vmcnt(31)
    s_mov_b32 m0, s64
    s_add_u32 s64, s64, 1024
    buffer_load_dwordx4 v10, s[48:51], s65 offen nt lds
    s_add_u32 s65, s65, 8192
    s_waitcnt vmcnt(31)
    s_sub_u32 s7, s60, 24
    s_max_i32 s61, s61, s7
    v_mov_b32 v19, s61
    ds_write_b32 v16, v19
    s_mov_b32 m0, s64
    s_add_u32 s64, s64, 1024
    buffer_load_dwordx4 v10, s[48:51], s65 offen nt lds
    s_add_u32 s65, s65, 8192
    s_waitcnt vmcnt(31)
    s_mov_b32 m0, s64
    s_add_u32 s64, s64, 1024
    buffer_load_dwordx4 v10, s[48:51], s65 offen nt lds
    s_add_u32 s65, s65, 8192
    s_waitcnt vmcnt(31)
    s_mov_b32 m0, s64
    s_add_u32 s64, s64, 1024
    buffer_load_dwordx4 v10, s[48:51], s65 offen nt lds
    s_add_u32 s65, s65, 8192
    s_waitcnt vmcnt(31)
    s_mov_b32 m0, s64
    s_add_u32 s64, s64, 1024
    buffer_load_dwordx4 v10, s[48:51], s65 offen nt lds
    s_add_u32 s65, s65, 8192
    s_waitcnt vmcnt(31)
    s_mov_b32 m0, s64
    s_add_u32 s64, s64, 1024
    buffer_load_dwordx4 v10, s[48:51], s65 offen nt lds
    s_add_u32 s65, s65, 8192
    s_waitcnt vmcnt(31)
    s_mov_b32 m0, s64
    s_add_u32 s64, s64, 1024
    buffer_load_dwordx4 v10, s[48:51], s65 offen nt lds
    s_add_u32 s65, s65, 8192
    s_waitcnt vmcnt(31)
    s_mov_b32 m0, s64
    s_add_u32 s64, s64, 1024
    buffer_load_dwordx4 v10, s[48:51], s65 offen nt lds
    s_add_u32 s65, s65, 8192
    s_waitcnt vmcnt(31)
    s_mov_b32 m0, s64
    s_add_u32 s64, s64, 1024
    buffer_load_dwordx4 v10, s[48:51], s65 offen nt lds
    s_add_u32 s65, s65, 8192
    s_waitcnt vmcnt(31)
    s_sub_u32 s7, s60, 16
    s_max_i32 s61, s61, s7
    v_mov_b32 v19, s61
    ds_write_b32 v16, v19
    s_mov_b32 m0, s64
    s_add_u32 s64, s64, 1024
    buffer_load_dwordx4 v10, s[48:51], s65 offen nt lds
    s_add_u32 s65, s65, 8192
    s_add_u32 s60, s60, 16
    s_add_u32 s65, s65, 917504
    s_sub_u32 s66, s66, 1
    s_cmp_lg_u32 s66, 0
    s_cbranch_scc1 LL_100
    s_waitcnt vmcnt(24)
    s_sub_u32 s7, s60, 24
    s_max_i32 s61, s61, s7
    v_mov_b32 v19, s61
    ds_write_b32 v16, v19
    s_waitcnt vmcnt(16)
    s_sub_u32 s7, s60, 16
    s_max_i32 s61, s61, s7
    v_mov_b32 v19, s61
    ds_write_b32 v16, v19
    s_waitcnt vmcnt(8)
    s_sub_u32 s7, s60, 8
    s_max_i32 s61, s61, s7
    v_mov_b32 v19, s61
    ds_write_b32 v16, v19
    s_waitcnt vmcnt(0)
    s_mov_b32 s61, s60
    v_mov_b32 v19, s61
    ds_write_b32 v16, v19
    s_cmp_eq_u32 s5, 7
    s_cbranch_scc1 L_END
    s_mov_b32 s52, s30
    s_and_b32 s53, s31, 0xffff
    s_mov_b32 s54, 0x2000
    s_mov_b32 s55, 0x20000
    s_mov_b32 s84, 0x3f80
    s_mov_b32 s85, 0x3f800000
    s_lshl_b32 s7, s4, 11
    s_add_u32 s7, s7, 0x2c0000
    v_lshl_add_u32 v36, v1, 4, s7
    s_lshl_b32 s7, s4, 5
    s_add_u32 s7, s7, 1024
    v_and_b32 v38, 3, v1
    v_lshl_add_u32 v37, v38, 3, s7
    v_lshrrev_b32 v38, 2, v3
    v_lshl_add_u32 v37, v38, 11, v37
    v_mov_b32 v38, 0x24214
    s_mov_b32 s80, 1600000
LW_101:
    ds_read_b32 v39, v38
    s_waitcnt lgkmcnt(0)
    v_readfirstlane_b32 s79, v39
    s_cmp_ge_u32 s79, 4
    s_cbranch_scc1 LWD_102
    s_sleep 1
    s_sub_u32 s80, s80, 1
    s_cmp_lg_u32 s80, 0
    s_cbranch_scc1 LW_101
LWD_102:
    s_mov_b64 exec, -1
    buffer_load_dwordx4 v[48:51], v36, s[36:39], 0 offen offset:0 sc1
    buffer_load_dwordx4 v[52:55], v36, s[36:39], 0 offen offset:1024 sc1
    s_mov_b32 s80, 200000
MC_104:
    s_mov_b64 exec, -1
    s_waitcnt vmcnt(0)
    v_cmp_ne_u64 s[62:63], s[92:93], v[50:51]
    v_cmp_ne_u64 s[64:65], s[92:93], v[54:55]
    s_or_b64 s[90:91], s[62:63], s[64:65]
    s_cbranch_scc1 M_103
MD_105:
    s_mov_b64 exec, -1
    v_dot2_f32_bf16 v44, v48, s84, 0
    v_dot2_f32_bf16 v45, v48, s85, 0
    v_dot2_f32_bf16 v46, v49, s84, 0
    v_dot2_f32_bf16 v47, v49, s85, 0
    v_dot2_f32_bf16 v44, v52, s84, v44
    v_dot2_f32_bf16 v45, v52, s85, v45
    v_dot2_f32_bf16 v46, v53, s84, v46
    v_dot2_f32_bf16 v47, v53, s85, v47
    s_nop 1
    v_permlane32_swap_b32 v44, v46
    v_permlane32_swap_b32 v45, v47
    v_add_f32 v44, v44, v46
    v_add_f32 v45, v45, v47
    v_mov_b32 v46, v44
    v_mov_b32 v47, v45
    s_nop 0
    v_permlane16_swap_b32 v44, v46
    v_permlane16_swap_b32 v45, v47
    v_add_f32 v44, v44, v46
    v_add_f32 v45, v45, v47
    v_cvt_pk_bf16_f32 v44, v44, v45
    v_mov_b32 v45, v44
    s_nop 1
    v_permlane32_swap_b32 v44, v45
    s_mov_b64 exec, 0xffff
    buffer_store_dwordx2 v[44:45], v37, s[52:55], 0 offen
    s_mov_b64 exec, -1
    s_endpgm
L_SIDE:
    v_lshlrev_b32 v10, 2, v0
    v_mov_b32 v24, 0
    v_add_u32 v10, 0x23c00, v10
    ds_write_b32 v10, v24
    s_mov_b32 s61, s6
    v_mov_b32 v28, -1
    v_mov_b32 v29, -1
    v_mov_b32 v30, -1
    v_mov_b32 v31, -1
    s_and_b32 s64, s4, 7
    s_lshl_b32 s64, s64, 3
    s_lshr_b32 s7, s4, 3
    s_lshl_b32 s7, s7, 1
    s_add_u32 s64, s64, s7
    s_add_u32 s64, s64, s5
    s_sub_u32 s64, s64, 6
    s_waitcnt lgkmcnt(0)
    s_mov_b32 s40, s32
    s_and_b32 s41, s33, 0xffff
    s_mov_b32 s42, 0x100
    s_mov_b32 s43, 0x20000
    s_or_b32 s7, s6, s2
    s_cbranch_scc1 NC_106
    s_lshl_b64 s[92:93], s[94:95], 5
    s_or_b32 s93, s93, 0x80000000
    v_mov_b32 v12, s92
    v_mov_b32 v13, s93
    s_mov_b64 exec, 1
    buffer_store_dwordx2 v[12:13], v24, s[40:43], 0 offen sc1
    s_mov_b64 exec, -1
NC_106:
    s_mov_b32 s36, s34
    s_and_b32 s37, s35, 0xffff
    s_mov_b32 s38, 0x1000000
    s_mov_b32 s39, 0x20000
    s_cmp_lt_u32 s5, 4
    s_cbranch_scc1 NB_108
    s_cmp_ge_u32 s5, 6
    s_cbranch_scc1 NQ_107
    s_cmp_lg_u32 s6, 2
    s_cbranch_scc1 NB_108
    s_lshl_b32 s7, s4, 1
    s_add_u32 s7, s7, s5
    s_lshl_b32 s7, s7, 9
    s_sub_u32 s7, s7, 2048
    v_lshl_add_u32 v10, v3, 4, s7
    v_lshl_add_u32 v10, v2, 15, v10
    buffer_store_dwordx4 v[28:31], v10, s[36:39], 0 offen sc1
    buffer_store_dwordx4 v[28:31], v10, s[36:39], 0 offen offset:256 sc1
    s_branch NB_108
NQ_107:
    s_lshl_b32 s65, s64, 2
    s_add_u32 s65, s65, s6
    s_and_b32 s7, s65, 31
    s_lshl_b32 s7, s7, 13
    s_lshr_b32 s62, s64, 3
    s_lshl_b32 s62, s62, 10
    s_add_u32 s7, s7, s62
    s_add_u32 s7, s7, 0x200000
    v_lshl_add_u32 v10, v1, 4, s7
    buffer_store_dwordx4 v[28:31], v10, s[36:39], 0 offen sc1
    s_lshl_b32 s7, s65, 10
    s_add_u32 s7, s7, 0x280000
    v_lshl_add_u32 v10, v1, 7, s7
    s_lshl_b32 s62, s65, 8
    s_add_u32 s7, s62, 0x2c0000
    v_writelane_b32 v10, s7, 8
    s_add_u32 s7, s62, 0x2c0080
    v_writelane_b32 v10, s7, 9
    s_add_u32 s7, s62, 0xc0000
    v_writelane_b32 v10, s7, 10
    s_add_u32 s7, s62, 0xc0080
    v_writelane_b32 v10, s7, 11
    s_lshl_b32 s7, s65, 7
    s_add_u32 s7, s7, 0x28000
    v_writelane_b32 v10, s7, 12
    s_add_u32 s7, s7, 0x8000
    v_writelane_b32 v10, s7, 14
    s_lshl_b32 s7, s65, 4
    s_add_u32 s7, s7, 0x23000
    v_writelane_b32 v10, s7, 13
    s_mov_b64 exec, 0x7fff
    buffer_load_dword v15, v10, s[36:39], 0 offen sc1
    s_mov_b64 exec, -1
    s_getpc_b64 s[84:85]
L_PC:
    s_and_b32 s7, s65, 31
    s_mul_i32 s7, s7, 1280
    v_lshl_add_u32 v10, v1, 7, s7
    v_min_u32 v10, L_END-concat_heads__sliding_block_cached__compressed_kv_cla__decode_kernel, v10
    s_sub_u32 s84, s84, L_PC-concat_heads__sliding_block_cached__compressed_kv_cla__decode_kernel
    s_subb_u32 s85, s85, 0
    v_mov_b32 v11, s85
    v_add_co_u32 v10, vcc, s84, v10
    s_nop 1
    v_addc_co_u32 v11, vcc, 0, v11, vcc
    s_mov_b64 exec, 0x3ff
    global_load_dword v15, v[10:11], off
    s_mov_b64 exec, -1
NB_108:
    s_barrier
    s_cmp_lg_u32 s6, 0
    s_cbranch_scc1 NF_110
    s_mov_b32 s80, 800000
    s_sleep 4
NL_112:
    s_mov_b64 exec, 1
    buffer_load_dwordx2 v[12:13], v24, s[40:43], 0 offen sc1
    s_mov_b64 exec, -1
    s_waitcnt vmcnt(0)
    v_readfirstlane_b32 s92, v12
    v_readfirstlane_b32 s93, v13
    s_sub_u32 s80, s80, 1
    s_cbranch_scc1 NH_113
    s_cmp_eq_u32 s93, 0
    s_cbranch_scc1 NL_112
    s_sub_u32 s7, s94, 1500
    s_lshl_b32 s7, s7, 5
    s_sub_u32 s7, s92, s7
    s_cmp_ge_i32 s7, 0
    s_cbranch_scc1 NH_113
    s_cmp_gt_u32 s80, 799960
    s_cbranch_scc1 NL_112
NH_113:
    v_mov_b32 v11, 0x24248
    v_mov_b32 v12, s92
    v_mov_b32 v13, s93
    ds_write_b64 v11, v[12:13]
    v_mov_b32 v11, 0x24204
    v_mov_b32 v14, 1
    s_mov_b64 exec, 1
    ds_add_u32 v11, v14
    s_mov_b64 exec, -1
NF_110:
    s_cmp_lg_u32 s6, 1
    s_cbranch_scc1 NP_109
    s_lshl_b32 s65, s4, 7
    s_add_u32 s65, s65, 0x21000
    s_lshr_b32 s7, s64, 3
    s_lshl_b32 s7, s7, 7
    s_add_u32 s7, s7, 0x22000
    s_and_b32 s62, s64, 7
    s_cmp_lt_u32 s5, 6
    s_cselect_b32 s7, s65, s7
    s_cselect_b32 s62, s5, s62
    v_lshl_add_u32 v11, v1, 3, s7
    s_sleep 12
    s_memrealtime s[88:89]
    s_waitcnt lgkmcnt(0)
    s_or_b32 s89, s89, s78
    v_mov_b32 v12, s88
    v_mov_b32 v13, s89
    s_lshl_b64 exec, 1, s62
    buffer_store_dwordx2 v[12:13], v11, s[36:39], 0 offen
    s_mov_b64 exec, -1
    s_cmp_ge_u32 s5, 6
    s_cbranch_scc1 NP_109
    s_sleep 24
    s_or_b32 s95, s95, s78
    s_add_u32 s88, s94, 0x10000
    s_addc_u32 s89, s95, 0
    s_mov_b32 s101, 16
    s_mov_b64 exec, 0x3f
U_114:
    buffer_load_dwordx2 v[14:15], v11, s[36:39], 0 offen sc1 nt
UU_115:
    s_waitcnt vmcnt(0)
    v_cmp_gt_u64 s[90:91], s[94:95], v[14:15]
    v_cmp_le_u64 vcc, s[88:89], v[14:15]
    s_or_b64 vcc, vcc, s[90:91]
    s_cbranch_scc0 UD_116
    s_sleep 8
    s_sub_u32 s101, s101, 1
    s_cmp_lg_u32 s101, 0
    s_cbranch_scc1 U_114
UD_116:
    s_mov_b64 exec, -1
    s_min_u32 s7, s101, 1
    s_add_u32 s7, s7, 16
    v_mov_b32 v12, 0x24200
    v_mov_b32 v13, s7
    s_mov_b64 exec, 1
    ds_add_u32 v12, v13
    s_mov_b64 exec, -1
NP_109:
    s_cmp_ge_u32 s5, 6
    s_cbranch_scc1 L_BATT
    s_cmp_lt_u32 s5, 4
    s_cbranch_scc1 NG_111
    s_cmp_lg_u32 s6, 2
    s_cbranch_scc1 NG_111
    s_lshl_b32 s7, s4, 4
    s_add_u32 s7, s7, s5
    s_lshl_b32 s7, s7, 3
    s_add_u32 s7, s7, 0x1ffe0
    v_mov_b32 v11, s7
    s_waitcnt vmcnt(0)
    v_mov_b32 v12, 0x24208
    v_mov_b32 v13, 16
    s_mov_b64 exec, 1
    ds_add_u32 v12, v13
    s_mov_b64 exec, -1
    v_mov_b32 v16, 0x24204
    s_mov_b32 s80, 1600000
LW_117:
    ds_read_b32 v17, v16
    s_waitcnt lgkmcnt(0)
    v_readfirstlane_b32 s79, v17
    s_cmp_ge_u32 s79, 1
    s_cbranch_scc1 LWD_118
    s_sleep 1
    s_sub_u32 s80, s80, 1
    s_cmp_lg_u32 s80, 0
    s_cbranch_scc1 LW_117
LWD_118:
    v_mov_b32 v16, 0x24248
    ds_read_b64 v[18:19], v16
    s_waitcnt lgkmcnt(0)
    v_readfirstlane_b32 s92, v18
    v_readfirstlane_b32 s93, v19
    s_mov_b64 exec, 1
    buffer_store_dwordx2 v[18:19], v11, s[36:39], 0 offen sc1
    s_mov_b64 exec, -1
NG_111:
    s_mov_b32 s96, 0x6010600
    s_mov_b32 s97, 0x6030602
    s_cmp_eq_u32 s5, 1
    s_cselect_b32 s96, 0x6190618, s96
    s_cselect_b32 s97, 0x61b061a, s97
    s_cmp_eq_u32 s5, 2
    s_cselect_b32 s96, 0x6310630, s96
    s_cselect_b32 s97, 0x6330632, s97
    s_cmp_eq_u32 s5, 3
    s_cselect_b32 s96, 0x6490648, s96
    s_cselect_b32 s97, 0x64b064a, s97
    s_cmp_eq_u32 s5, 4
    s_cselect_b32 s96, 0x4610460, s96
    s_cselect_b32 s97, 0x4630462, s97
    s_cmp_eq_u32 s5, 5
    s_cselect_b32 s96, 0x4710470, s96
    s_cselect_b32 s97, 0x4730472, s97
    s_lshl_b32 s7, s61, 4
    s_lshr_b64 s[90:91], s[96:97], s7
    s_and_b32 s66, s90, 3
    s_bfe_u32 s67, s90, 0x50002
    s_bfe_u32 s68, s90, 0x40008
    s_lshl_b32 s7, s4, 15
    s_lshl_b32 s63, s66, 9
    s_add_u32 s7, s7, s63
    s_add_u32 s7, s7, 0x100000
    v_and_b32 v20, 31, v1
    v_lshl_add_u32 v7, v20, 4, s7
    v_lshrrev_b32 v21, 5, v1
    v_lshl_add_u32 v7, v21, 11, v7
    v_add_u32 v22, 4096, v7
    s_mul_i32 s7, s66, 320
    s_add_u32 s63, s7, 0x24400
    v_lshl_add_u32 v6, v20, 3, s63
    v_lshl_add_u32 v6, v21, 2, v6
    s_mov_b32 s70, 0x3f80
    s_mov_b32 s71, 0x3f800000
    v_mov_b32 v12, 0x24200
    s_mov_b32 s80, 1600000
LW_119:
    ds_read_b32 v13, v12
    s_waitcnt lgkmcnt(0)
    v_readfirstlane_b32 s79, v13
    s_cmp_ge_u32 s79, 16
    s_cbranch_scc1 LWD_120
    s_sleep 4
    s_sub_u32 s80, s80, 1
    s_cmp_lg_u32 s80, 0
    s_cbranch_scc1 LW_119
LWD_120:
    s_and_b32 s101, s79, 15
    v_mov_b32 v16, 0x24204
    s_mov_b32 s80, 1600000
LW_121:
    ds_read_b32 v17, v16
    s_waitcnt lgkmcnt(0)
    v_readfirstlane_b32 s79, v17
    s_cmp_ge_u32 s79, 1
    s_cbranch_scc1 LWD_122
    s_sleep 1
    s_sub_u32 s80, s80, 1
    s_cmp_lg_u32 s80, 0
    s_cbranch_scc1 LW_121
LWD_122:
    v_mov_b32 v16, 0x24248
    ds_read_b64 v[18:19], v16
    s_waitcnt lgkmcnt(0)
    v_readfirstlane_b32 s92, v18
    v_readfirstlane_b32 s93, v19
    s_cmp_lt_u32 s5, 4
    s_cselect_b32 s65, 16, 148
    s_cselect_b32 s7, 0, 4294967288
    s_add_u32 s7, s7, 0x24210
    v_mov_b32 v12, s7
    s_mov_b32 s80, 1600000
LW_123:
    ds_read_b32 v13, v12
    s_waitcnt lgkmcnt(0)
    v_readfirstlane_b32 s79, v13
    s_cmp_ge_u32 s79, s65
    s_cbranch_scc1 LWD_124
    s_sleep 4
    s_sub_u32 s80, s80, 1
    s_cmp_lg_u32 s80, 0
    s_cbranch_scc1 LW_123
LWD_124:
    s_sleep 16
    s_mov_b64 exec, -1
    buffer_load_dwordx4 v[48:51], v7, s[36:39], 0 offen sc1 nt
    buffer_load_dwordx4 v[52:55], v22, s[36:39], 0 offen sc1 nt
    s_mov_b32 s80, 200000
MC_126:
    s_mov_b64 exec, -1
    s_waitcnt vmcnt(0)
    v_cmp_ne_u64 s[44:45], s[92:93], v[50:51]
    v_cmp_ne_u64 s[46:47], s[92:93], v[54:55]
    s_or_b64 s[90:91], s[44:45], s[46:47]
    s_cbranch_scc1 M_125
MD_127:
    s_mov_b64 exec, -1
    v_dot2_f32_bf16 v24, v48, s70, 0
    v_dot2_f32_bf16 v25, v48, s71, 0
    v_dot2_f32_bf16 v26, v49, s70, 0
    v_dot2_f32_bf16 v27, v49, s71, 0
    v_dot2_f32_bf16 v24, v52, s70, v24
    v_dot2_f32_bf16 v25, v52, s71, v25
    v_dot2_f32_bf16 v26, v53, s70, v26
    v_dot2_f32_bf16 v27, v53, s71, v27
    s_nop 1
    v_permlane32_swap_b32 v24, v26
    v_permlane32_swap_b32 v25, v27
    v_add_f32 v24, v24, v26
    v_add_f32 v25, v25, v27
    v_cvt_pk_bf16_f32 v24, v24, v25
    ds_write_b32 v6, v24
L_AATT:
    v_lshl_add_u32 v8, v2, 4, s63
    s_waitcnt lgkmcnt(0)
    ds_read_b128 v[16:19], v8 offset:0
    ds_read_b128 v[20:23], v8 offset:64
    ds_read_b128 v[24:27], v8 offset:128
    ds_read_b128 v[28:31], v8 offset:192
    v_xor_b32 v4, v3, v2
    v_lshlrev_b32 v4, 4, v4
    v_lshl_add_u32 v4, v3, 8, v4
    v_lshrrev_b32 v9, 2, v1
    v_and_b32 v5, 7, v9
    v_lshlrev_b32 v5, 5, v5
    v_lshl_add_u32 v5, v9, 8, v5
    v_and_b32 v10, 3, v1
    v_lshl_add_u32 v5, v10, 3, v5
    s_lshl_b32 s7, s61, 10
    s_add_u32 s7, s7, 0x24e00
    v_lshl_add_u32 v6, v2, 4, s7
    v_cmp_eq_u32 s[84:85], 0, v3
    s_mov_b32 s72, 0x3e0293ee
    s_cmp_ge_u32 s5, 4
    s_cselect_b32 s73, 6, 6
    s_cselect_b32 s69, 8, 0
    s_cselect_b32 s70, 17, 1
    s_cselect_b32 s74, 16, 24
    s_add_u32 s70, s70, s61
    s_add_u32 s74, s74, s70
    s_lshl_b32 s70, s70, 3
    s_add_u32 s69, s69, s61
    s_cmp_ge_u32 s69, 18
    s_cselect_b32 s7, 18, 0
    s_sub_u32 s69, s69, s7
    s_mov_b32 s71, s68
AK_128:
    s_lshl_b32 s7, s69, 13
    v_add_u32 v104, s7, v4
    v_xor_b32 v105, 0x40, v104
    v_xor_b32 v106, 0x80, v104
    v_xor_b32 v107, 0xc0, v104
    s_lshl_b32 s62, s69, 2
    s_add_u32 s62, s62, 0x24100
    v_mov_b32 v8, 0x24000
    s_mov_b32 s80, 1600000
LW_129:
    ds_read_b32 v9, v8
    s_waitcnt lgkmcnt(0)
    v_readfirstlane_b32 s79, v9
    s_cmp_ge_u32 s79, s70
    s_cbranch_scc1 LWD_130
    s_sleep 2
    s_sub_u32 s80, s80, 1
    s_cmp_lg_u32 s80, 0
    s_cbranch_scc1 LW_129
LWD_130:
    ds_read_b128 v[32:35], v104 offset:0
    ds_read_b128 v[36:39], v104 offset:4096
    ds_read_b128 v[40:43], v105 offset:0
    ds_read_b128 v[44:47], v105 offset:4096
    ds_read_b128 v[48:51], v106 offset:0
    ds_read_b128 v[52:55], v106 offset:4096
    ds_read_b128 v[56:59], v107 offset:0
    ds_read_b128 v[60:63], v107 offset:4096
    s_waitcnt lgkmcnt(6)
    v_mfma_f32_16x16x32_bf16 v[64:67], v[32:35], v[16:19], 0
    v_mfma_f32_16x16x32_bf16 v[68:71], v[36:39], v[16:19], 0
    s_waitcnt lgkmcnt(4)
    v_mfma_f32_16x16x32_bf16 v[64:67], v[40:43], v[20:23], v[64:67]
    v_mfma_f32_16x16x32_bf16 v[68:71], v[44:47], v[20:23], v[68:71]
    s_waitcnt lgkmcnt(2)
    v_mfma_f32_16x16x32_bf16 v[64:67], v[48:51], v[24:27], v[64:67]
    v_mfma_f32_16x16x32_bf16 v[68:71], v[52:55], v[24:27], v[68:71]
    s_waitcnt lgkmcnt(0)
    v_mfma_f32_16x16x32_bf16 v[64:67], v[56:59], v[28:31], v[64:67]
    v_mfma_f32_16x16x32_bf16 v[68:71], v[60:63], v[28:31], v[68:71]
    v_mov_b32 v8, s62
    v_mov_b32 v9, 4
    s_mov_b64 exec, 1
    ds_add_u32 v8, v9
    s_mov_b64 exec, -1
    s_mov_b64 exec, s[84:85]
    s_nop 0
    ds_write_b128 v6, v[64:67] offset:0
    ds_write_b128 v6, v[68:71] offset:64
    s_mov_b64 exec, -1
    v_add_u32 v6, 128, v6
    s_add_u32 s69, s69, 4
    s_cmp_ge_u32 s69, 18
    s_cselect_b32 s7, 18, 0
    s_sub_u32 s69, s69, s7
    s_add_u32 s70, s70, 32
    s_sub_u32 s71, s71, 1
    s_cmp_lg_u32 s71, 0
    s_cbranch_scc1 AK_128
    v_lshrrev_b32 v8, 2, v1
    v_cmp_gt_u32 s[86:87], s68, v8
    v_and_b32 v8, 7, v8
    v_and_b32 v9, 3, v1
    v_lshlrev_b32 v9, 4, v9
    v_lshl_add_u32 v10, v8, 7, v9
    s_lshl_b32 s7, s61, 10
    s_add_u32 s7, s7, 0x24e00
    v_add_u32 v10, s7, v10
    s_waitcnt lgkmcnt(0)
    ds_read_b128 v[32:35], v10
    ds_read_b128 v[36:39], v10 offset:64
    s_lshl_b32 s7, s61, 9
    s_add_u32 s7, s7, 0x25e00
    v_lshl_add_u32 v10, v8, 6, v9
    v_add_u32 v10, s7, v10
    v_lshl_add_u32 v7, v2, 4, s7
    v_mov_b32 v11, 0xff800000
    s_waitcnt lgkmcnt(0)
    v_cndmask_b32 v32, v11, v32, s[86:87]
    v_cndmask_b32 v33, v11, v33, s[86:87]
    v_cndmask_b32 v34, v11, v34, s[86:87]
    v_cndmask_b32 v35, v11, v35, s[86:87]
    v_cndmask_b32 v36, v11, v36, s[86:87]
    v_cndmask_b32 v37, v11, v37, s[86:87]
    v_cndmask_b32 v38, v11, v38, s[86:87]
    v_cndmask_b32 v39, v11, v39, s[86:87]
    v_max3_f32 v64, v32, v33, v34
    v_max3_f32 v64, v64, v35, v36
    v_max3_f32 v64, v64, v37, v38
    v_max_f32 v64, v64, v39
    s_nop 1
    v_max_f32_dpp v64, v64, v64 row_ror:1 row_mask:0xf bank_mask:0xf
    s_nop 1
    v_max_f32_dpp v64, v64, v64 row_ror:2 row_mask:0xf bank_mask:0xf
    s_nop 1
    v_max_f32_dpp v64, v64, v64 row_ror:4 row_mask:0xf bank_mask:0xf
    s_nop 1
    v_max_f32_dpp v64, v64, v64 row_ror:8 row_mask:0xf bank_mask:0xf
    v_mov_b32 v11, v64
    s_nop 1
    v_permlane32_swap_b32 v64, v11
    v_max_f32 v64, v64, v11
    v_mov_b32 v11, v64
    s_nop 1
    v_permlane16_swap_b32 v64, v11
    v_max_f32 v64, v64, v11
    v_mul_f32 v64, s72, v64
    v_fma_f32 v32, v32, s72, -v64
    v_fma_f32 v33, v33, s72, -v64
    v_fma_f32 v34, v34, s72, -v64
    v_fma_f32 v35, v35, s72, -v64
    v_fma_f32 v36, v36, s72, -v64
    v_fma_f32 v37, v37, s72, -v64
    v_fma_f32 v38, v38, s72, -v64
    v_fma_f32 v39, v39, s72, -v64
    v_exp_f32 v32, v32
    v_exp_f32 v33, v33
    v_exp_f32 v34, v34
    v_exp_f32 v35, v35
    v_exp_f32 v36, v36
    v_exp_f32 v37, v37
    v_exp_f32 v38, v38
    v_exp_f32 v39, v39
    v_cvt_pk_bf16_f32 v112, v32, v33
    v_cvt_pk_bf16_f32 v113, v34, v35
    v_cvt_pk_bf16_f32 v114, v36, v37
    v_cvt_pk_bf16_f32 v115, v38, v39
    s_mov_b64 exec, s[86:87]
    ds_write_b128 v10, v[112:115]
    s_mov_b64 exec, -1
    v_add_f32 v32, v32, v36
    v_add_f32 v33, v33, v37
    v_add_f32 v34, v34, v38
    v_add_f32 v35, v35, v39
    v_add_f32 v32, v32, v34
    v_add_f32 v33, v33, v35
    v_add_f32 v32, v32, v33
    v_mov_b32 v65, v32
    s_nop 1
    v_add_f32_dpp v65, v65, v65 row_ror:1 row_mask:0xf bank_mask:0xf
    s_nop 1
    v_add_f32_dpp v65, v65, v65 row_ror:2 row_mask:0xf bank_mask:0xf
    s_nop 1
    v_add_f32_dpp v65, v65, v65 row_ror:4 row_mask:0xf bank_mask:0xf
    s_nop 1
    v_add_f32_dpp v65, v65, v65 row_ror:8 row_mask:0xf bank_mask:0xf
    v_mov_b32 v11, v65
    s_nop 1
    v_permlane32_swap_b32 v65, v11
    v_add_f32 v65, v65, v11
    v_mov_b32 v11, v65
    s_nop 1
    v_permlane16_swap_b32 v65, v11
    v_add_f32 v65, v65, v11
    v_mov_b32 v8, 0x24204
    s_mov_b32 s80, 1600000
LW_131:
    ds_read_b32 v9, v8
    s_waitcnt lgkmcnt(0)
    v_readfirstlane_b32 s79, v9
    s_cmp_ge_u32 s79, 1
    s_cbranch_scc1 LWD_132
    s_sleep 1
    s_sub_u32 s80, s80, 1
    s_cmp_lg_u32 s80, 0
    s_cbranch_scc1 LW_131
LWD_132:
    v_mov_b32 v8, 0x24248
    ds_read_b64 v[10:11], v8
    s_waitcnt lgkmcnt(0)
    v_readfirstlane_b32 s92, v10
    v_readfirstlane_b32 s93, v11
    s_nop 0
    v_mov_b32 v66, s92
    v_mov_b32 v67, s93
    s_lshl_b32 s7, s4, 2
    s_add_u32 s7, s7, s66
    s_lshl_b32 s7, s7, 3
    s_add_u32 s7, s7, s5
    s_lshl_b32 s7, s7, 4
    s_add_u32 s7, s7, 0x24000
    v_mov_b32 v8, s7
    s_mov_b64 exec, 1
    s_cmp_eq_u32 s101, 0
    s_cbranch_scc1 SU_133
    buffer_store_dwordx4 v[64:67], v8, s[36:39], 0 offen
SV_134:
    s_mov_b64 exec, -1
    s_and_b32 s7, s7, -128
    v_lshl_add_u32 v12, v1, 4, s7
    v_or_b32 v70, 1, v66
    v_mov_b32 v71, v67
    v_mov_b32 v116, 0xff800000
    v_mov_b32 v117, 0
    v_mov_b32 v72, 0
    v_mov_b32 v73, 0
    v_mov_b32 v74, 0
    v_mov_b32 v75, 0
    v_mov_b32 v76, 0
    v_mov_b32 v77, 0
    v_mov_b32 v78, 0
    v_mov_b32 v79, 0
    v_mov_b32 v80, 0
    v_mov_b32 v81, 0
    v_mov_b32 v82, 0
    v_mov_b32 v83, 0
    v_mov_b32 v84, 0
    v_mov_b32 v85, 0
    v_mov_b32 v86, 0
    v_mov_b32 v87, 0
    v_mov_b32 v88, 0
    v_mov_b32 v89, 0
    v_mov_b32 v90, 0
    v_mov_b32 v91, 0
    v_mov_b32 v92, 0
    v_mov_b32 v93, 0
    v_mov_b32 v94, 0
    v_mov_b32 v95, 0
    v_mov_b32 v96, 0
    v_mov_b32 v97, 0
    v_mov_b32 v98, 0
    v_mov_b32 v99, 0
    v_mov_b32 v100, 0
    v_mov_b32 v101, 0
    v_mov_b32 v102, 0
    v_mov_b32 v103, 0
    s_lshl_b32 s7, s4, 4
    s_add_u32 s7, s7, s5
    s_lshl_b32 s7, s7, 2
    s_add_u32 s7, s7, s66
    s_lshl_b32 s7, s7, 9
    s_add_u32 s7, s7, 0x100000
    v_lshl_add_u32 v6, v1, 4, s7
    s_cmp_lt_u32 s5, 4
    s_cbranch_scc1 AE_135
    v_mov_b32 v13, 0
    s_mov_b64 exec, 0x01010101
    buffer_store_dword v13, v6, s[36:39], 0 offen
    buffer_load_dword v13, v6, s[36:39], 0 offen sc1 nt
    s_mov_b64 exec, -1
AE_135:
    s_add_u32 s69, s73, s61
    s_lshl_b32 s70, s74, 3
    s_cmp_ge_u32 s69, 18
    s_cselect_b32 s7, 18, 0
    s_sub_u32 s69, s69, s7
    s_mov_b32 s71, s68
AV_136:
    s_lshl_b32 s7, s69, 13
    v_add_u32 v104, s7, v5
    v_xor_b32 v105, 0x20, v104
    v_xor_b32 v106, 0x40, v104
    v_xor_b32 v107, 0x60, v104
    v_xor_b32 v108, 0x80, v104
    v_xor_b32 v109, 0xa0, v104
    v_xor_b32 v110, 0xc0, v104
    v_xor_b32 v111, 0xe0, v104
    s_lshl_b32 s62, s69, 2
    s_add_u32 s62, s62, 0x24100
    ds_read_b128 v[112:115], v7
    v_add_u32 v7, 64, v7
    s_cmp_le_u32 s71, 2
    s_cbranch_scc1 AW_137
AWB_138:
    v_mov_b32 v8, 0x24000
    s_mov_b32 s80, 1600000
LW_139:
    ds_read_b32 v9, v8
    s_waitcnt lgkmcnt(0)
    v_readfirstlane_b32 s79, v9
    s_cmp_ge_u32 s79, s70
    s_cbranch_scc1 LWD_140
    s_sleep 1
    s_sub_u32 s80, s80, 1
    s_cmp_lg_u32 s80, 0
    s_cbranch_scc1 LW_139
LWD_140:
    ds_read_b64_tr_b16 v[32:33], v104
    ds_read_b64_tr_b16 v[34:35], v104 offset:4096
    ds_read_b64_tr_b16 v[36:37], v105
    ds_read_b64_tr_b16 v[38:39], v105 offset:4096
    ds_read_b64_tr_b16 v[40:41], v106
    ds_read_b64_tr_b16 v[42:43], v106 offset:4096
    ds_read_b64_tr_b16 v[44:45], v107
    ds_read_b64_tr_b16 v[46:47], v107 offset:4096
    ds_read_b64_tr_b16 v[48:49], v108
    ds_read_b64_tr_b16 v[50:51], v108 offset:4096
    ds_read_b64_tr_b16 v[52:53], v109
    ds_read_b64_tr_b16 v[54:55], v109 offset:4096
    ds_read_b64_tr_b16 v[56:57], v110
    ds_read_b64_tr_b16 v[58:59], v110 offset:4096
    s_waitcnt lgkmcnt(12)
    v_mfma_f32_16x16x32_bf16 v[72:75], v[112:115], v[32:35], v[72:75]
    ds_read_b64_tr_b16 v[60:61], v111
    ds_read_b64_tr_b16 v[62:63], v111 offset:4096
    s_waitcnt lgkmcnt(12)
    v_mfma_f32_16x16x32_bf16 v[76:79], v[112:115], v[36:39], v[76:79]
    s_waitcnt lgkmcnt(10)
    v_mfma_f32_16x16x32_bf16 v[80:83], v[112:115], v[40:43], v[80:83]
    s_waitcnt lgkmcnt(8)
    v_mfma_f32_16x16x32_bf16 v[84:87], v[112:115], v[44:47], v[84:87]
    s_waitcnt lgkmcnt(6)
    v_mfma_f32_16x16x32_bf16 v[88:91], v[112:115], v[48:51], v[88:91]
    s_waitcnt lgkmcnt(4)
    v_mfma_f32_16x16x32_bf16 v[92:95], v[112:115], v[52:55], v[92:95]
    s_waitcnt lgkmcnt(2)
    v_mfma_f32_16x16x32_bf16 v[96:99], v[112:115], v[56:59], v[96:99]
    s_waitcnt lgkmcnt(0)
    v_mfma_f32_16x16x32_bf16 v[100:103], v[112:115], v[60:63], v[100:103]
    v_mov_b32 v8, s62
    v_mov_b32 v9, 4
    s_mov_b64 exec, 1
    ds_add_u32 v8, v9
    s_mov_b64 exec, -1
    s_add_u32 s69, s69, 4
    s_cmp_ge_u32 s69, 18
    s_cselect_b32 s7, 18, 0
    s_sub_u32 s69, s69, s7
    s_add_u32 s70, s70, 32
    s_sub_u32 s71, s71, 1
    s_cmp_lg_u32 s71, 0
    s_cbranch_scc1 AV_136
    v_mov_b32_dpp v72, v88 quad_perm:[0,1,2,3] row_mask:0x2 bank_mask:0xf
    v_mov_b32_dpp v76, v92 quad_perm:[0,1,2,3] row_mask:0x2 bank_mask:0xf
    v_mov_b32_dpp v80, v96 quad_perm:[0,1,2,3] row_mask:0x2 bank_mask:0xf
    v_mov_b32_dpp v84, v100 quad_perm:[0,1,2,3] row_mask:0x2 bank_mask:0xf
    v_mul_f32 v72, s72, v72
    v_mul_f32 v76, s72, v76
    v_mul_f32 v80, s72, v80
    v_mul_f32 v84, s72, v84
    v_cvt_pk_bf16_f32 v68, v72, v76
    v_cvt_pk_bf16_f32 v69, v80, v84
    s_mov_b64 exec, 0xffffffff
    s_cmp_eq_u32 s101, 0
    s_cbranch_scc1 SU_141
    buffer_store_dwordx4 v[68:71], v6, s[36:39], 0 offen
SV_142:
    s_mov_b64 exec, -1
    v_mov_b32 v8, 0x24214
    v_mov_b32 v9, 1
    s_mov_b64 exec, 1
    ds_add_u32 v8, v9
    s_mov_b64 exec, -1
    s_endpgm
L_ASVC:
    v_bfe_u32 v24, v1, 2, 2
    v_lshl_add_u32 v4, v24, 4, v2
    v_lshlrev_b32 v4, 8, v4
    v_and_b32 v25, 1, v2
    v_lshl_or_b32 v24, v24, 1, v25
    s_lshl_b32 s7, s61, 1
    v_xor_b32 v24, s7, v24
    v_lshl_add_u32 v4, v24, 5, v4
    v_and_b32 v24, 3, v1
    v_lshl_add_u32 v4, v24, 3, v4
    v_add_u32 v4, 0x18000, v4
    v_xor_b32 v9, 32, v4
    v_lshlrev_b32 v8, 16, v24
    v_and_b32 v26, 4, v1
    v_lshl_add_u32 v8, v26, 4, v8
    v_lshl_add_u32 v8, v2, 4, v8
    s_lshl_b32 s7, s5, 2
    s_add_u32 s7, s7, s61
    s_lshl_b32 s7, s7, 5
    s_add_u32 s7, s7, s4
    s_lshl_b32 s7, s7, 7
    s_add_u32 s7, s7, 0x280000
    v_add_u32 v8, s7, v8
    v_cmp_gt_u32 s[84:85], 8, v3
    s_lshl_b32 s7, s4, 15
    s_lshl_b32 s62, s61, 9
    s_add_u32 s7, s7, s62
    s_add_u32 s7, s7, 0x100000
    v_and_b32 v26, 31, v1
    v_lshl_add_u32 v5, v26, 4, s7
    v_lshrrev_b32 v26, 5, v1
    v_lshl_add_u32 v5, v26, 11, v5
    s_mul_i32 s7, s61, 320
    s_add_u32 s7, s7, 0x26600
    v_lshl_add_u32 v6, v3, 4, s7
    v_lshl_add_u32 v6, v25, 3, v6
    v_lshl_add_u32 v6, v26, 2, v6
    v_mul_u32_u24 v7, 320, v24
    v_lshl_add_u32 v7, v2, 4, v7
    v_add_u32 v7, 0x26600, v7
    s_or_b64 s[94:95], s[92:93], 1
    v_mov_b32 v18, s92
    v_mov_b32 v19, s93
    s_mov_b32 s62, 4096
    s_mov_b32 s63, 8192
    s_mov_b32 s70, 0x3f80
    s_mov_b32 s71, 0x3f800000
    v_mov_b32 v28, 0x24214
    s_mov_b32 s80, 1600000
LW_143:
    ds_read_b32 v29, v28
    s_waitcnt lgkmcnt(0)
    v_readfirstlane_b32 s79, v29
    s_cmp_ge_u32 s79, 4
    s_cbranch_scc1 LWD_144
    s_sleep 2
    s_sub_u32 s80, s80, 1
    s_cmp_lg_u32 s80, 0
    s_cbranch_scc1 LW_143
LWD_144:
    s_setprio 2
    s_mov_b64 exec, -1
    buffer_load_dwordx4 v[112:115], v5, s[36:39], 0 offen sc1 nt
    buffer_load_dwordx4 v[116:119], v5, s[36:39], s62 offen sc1 nt
    buffer_load_dwordx4 v[120:123], v5, s[36:39], s63 offen sc1 nt
    v_mov_b32 v28, 0x24000
    s_mov_b32 s80, 1600000
LW_148:
    ds_read_b32 v29, v28
    s_waitcnt lgkmcnt(0)
    v_readfirstlane_b32 s79, v29
    s_cmp_ge_u32 s79, 416
    s_cbranch_scc1 LWD_149
    s_sub_u32 s80, s80, 1
    s_cmp_lg_u32 s80, 0
    s_cbranch_scc1 LW_148
LWD_149:
    ds_read_b64_tr_b16 v[32:33], v4 offset:0
    ds_read_b64_tr_b16 v[34:35], v4 offset:16384
    ds_read_b64_tr_b16 v[48:49], v9 offset:0
    ds_read_b64_tr_b16 v[50:51], v9 offset:16384
    ds_read_b64_tr_b16 v[36:37], v4 offset:1024
    ds_read_b64_tr_b16 v[38:39], v4 offset:17408
    ds_read_b64_tr_b16 v[52:53], v9 offset:1024
    ds_read_b64_tr_b16 v[54:55], v9 offset:17408
    ds_read_b64_tr_b16 v[40:41], v4 offset:2048
    ds_read_b64_tr_b16 v[42:43], v4 offset:18432
    ds_read_b64_tr_b16 v[56:57], v9 offset:2048
    ds_read_b64_tr_b16 v[58:59], v9 offset:18432
    ds_read_b64_tr_b16 v[44:45], v4 offset:3072
    ds_read_b64_tr_b16 v[46:47], v4 offset:19456
    ds_read_b64_tr_b16 v[60:61], v9 offset:3072
    ds_read_b64_tr_b16 v[62:63], v9 offset:19456
    s_mov_b32 s80, 200000
MC_146:
    s_mov_b64 exec, -1
    s_waitcnt vmcnt(0)
    v_cmp_ne_u64 s[64:65], s[94:95], v[114:115]
    v_cmp_ne_u64 s[66:67], s[94:95], v[118:119]
    v_cmp_ne_u64 s[68:69], s[94:95], v[122:123]
    s_or_b64 s[90:91], s[64:65], s[66:67]
    s_or_b64 s[90:91], s[90:91], s[68:69]
    s_cbranch_scc1 M_145
MD_147:
    s_mov_b64 exec, -1
    v_dot2_f32_bf16 v104, v112, s70, 0
    v_dot2_f32_bf16 v105, v112, s71, 0
    v_dot2_f32_bf16 v106, v113, s70, 0
    v_dot2_f32_bf16 v107, v113, s71, 0
    v_dot2_f32_bf16 v104, v116, s70, v104
    v_dot2_f32_bf16 v105, v116, s71, v105
    v_dot2_f32_bf16 v106, v117, s70, v106
    v_dot2_f32_bf16 v107, v117, s71, v107
    v_dot2_f32_bf16 v104, v120, s70, v104
    v_dot2_f32_bf16 v105, v120, s71, v105
    v_dot2_f32_bf16 v106, v121, s70, v106
    v_dot2_f32_bf16 v107, v121, s71, v107
    s_nop 1
    v_permlane32_swap_b32 v104, v106
    v_permlane32_swap_b32 v105, v107
    v_add_f32 v104, v104, v106
    v_add_f32 v105, v105, v107
    v_cvt_pk_bf16_f32 v104, v104, v105
    ds_write_b32 v6, v104
    s_add_u32 s81, s81, 4
    v_mov_b32 v24, 0x2420c
    v_mov_b32 v25, 1
    s_mov_b64 exec, 1
    ds_add_u32 v24, v25
    s_mov_b64 exec, -1
    v_mov_b32 v24, 0x2420c
    s_mov_b32 s80, 1600000
LW_150:
    ds_read_b32 v25, v24
    s_waitcnt lgkmcnt(0)
    v_readfirstlane_b32 s79, v25
    s_cmp_ge_u32 s79, s81
    s_cbranch_scc1 LWD_151
    s_sub_u32 s80, s80, 1
    s_cmp_lg_u32 s80, 0
    s_cbranch_scc1 LW_150
LWD_151:
    ds_read_b128 v[64:67], v7 offset:0
    ds_read_b128 v[68:71], v7 offset:64
    ds_read_b128 v[72:75], v7 offset:128
    ds_read_b128 v[76:79], v7 offset:192
    s_waitcnt lgkmcnt(3)
    v_mfma_f32_16x16x32_bf16 v[96:99], v[32:35], v[64:67], 0
    v_mfma_f32_16x16x32_bf16 v[100:103], v[48:51], v[64:67], 0
    s_waitcnt lgkmcnt(2)
    v_mfma_f32_16x16x32_bf16 v[96:99], v[36:39], v[68:71], v[96:99]
    v_mfma_f32_16x16x32_bf16 v[100:103], v[52:55], v[68:71], v[100:103]
    s_waitcnt lgkmcnt(1)
    v_mfma_f32_16x16x32_bf16 v[96:99], v[40:43], v[72:75], v[96:99]
    v_mfma_f32_16x16x32_bf16 v[100:103], v[56:59], v[72:75], v[100:103]
    s_waitcnt lgkmcnt(0)
    v_mfma_f32_16x16x32_bf16 v[96:99], v[44:47], v[76:79], v[96:99]
    v_mfma_f32_16x16x32_bf16 v[100:103], v[60:63], v[76:79], v[100:103]
    s_nop 6
    v_cvt_pk_bf16_f32 v16, v96, v97
    v_cvt_pk_bf16_f32 v17, v98, v99
    v_cvt_pk_bf16_f32 v104, v100, v101
    v_cvt_pk_bf16_f32 v105, v102, v103
    s_nop 0
    v_mov_b32_dpp v16, v104 quad_perm:[0,1,2,3] row_mask:0xf bank_mask:0x2
    v_mov_b32_dpp v17, v105 quad_perm:[0,1,2,3] row_mask:0xf bank_mask:0x2
    s_mov_b64 exec, s[84:85]
    buffer_store_dwordx4 v[16:19], v8, s[36:39], 0 offen sc1
    s_mov_b64 exec, -1
    s_endpgm
L_QABS:
    s_and_b32 s61, s6, 3
    s_waitcnt lgkmcnt(0)
    s_mov_b32 s36, s34
    s_and_b32 s37, s35, 0xffff
    s_mov_b32 s38, 0x1000000
    s_mov_b32 s39, 0x20000
    s_barrier
    s_cmp_ge_u32 s5, 6
    s_cbranch_scc1 L_BATT
    v_and_b32 v8, 3, v1
    v_lshlrev_b32 v5, 15, v8
    v_lshl_add_u32 v5, v2, 3, v5
    v_lshrrev_b32 v10, 2, v3
    v_lshl_add_u32 v5, v10, 5, v5
    s_lshl_b32 s7, s4, 1
    s_add_u32 s7, s7, s5
    s_lshl_b32 s7, s7, 2
    s_add_u32 s7, s7, s61
    s_lshl_b32 s7, s7, 7
    s_sub_u32 s7, s7, 2048
    v_add_u32 v5, s7, v5
    s_or_b32 s95, s95, s78
    s_add_u32 s72, s94, 0x10000
    s_addc_u32 s73, s95, 0
    s_lshl_b32 s7, s4, 15
    s_lshl_b32 s63, s61, 9
    s_add_u32 s7, s7, s63
    s_add_u32 s7, s7, 0x104000
    v_and_b32 v20, 31, v1
    v_lshl_add_u32 v7, v20, 4, s7
    v_lshrrev_b32 v21, 5, v1
    v_lshl_add_u32 v7, v21, 11, v7
    v_add_u32 v22, 4096, v7
    s_mul_i32 s7, s61, 320
    s_add_u32 s63, s7, 0x24900
    v_lshl_add_u32 v6, v20, 3, s63
    v_lshl_add_u32 v6, v21, 2, v6
    s_mov_b32 s70, 0x3f80
    s_mov_b32 s71, 0x3f800000
    v_xor_b32 v10, v3, v2
    v_lshlrev_b32 v10, 4, v10
    v_lshl_add_u32 v10, v3, 8, v10
    s_lshl_b32 s7, s61, 14
    s_add_u32 s7, s7, 0x14000
    v_add_u32 v10, s7, v10
    s_lshl_b32 s65, s61, 4
    s_add_u32 s65, s65, 16
    s_lshl_b32 s64, s61, 3
    s_add_u32 s64, s64, 0x24128
    v_mul_u32_u24 v9, 320, v8
    v_lshl_add_u32 v9, v2, 4, v9
    v_add_u32 v9, 0x24900, v9
    v_mov_b32 v12, 0x24000
    s_mov_b32 s80, 1600000
LW_153:
    ds_read_b32 v13, v12
    s_waitcnt lgkmcnt(0)
    v_readfirstlane_b32 s79, v13
    s_cmp_ge_u32 s79, 32
    s_cbranch_scc1 LWD_154
    s_sleep 1
    s_sub_u32 s80, s80, 1
    s_cmp_lg_u32 s80, 0
    s_cbranch_scc1 LW_153
LWD_154:
    s_mov_b64 exec, -1
    buffer_load_dwordx4 v[48:51], v7, s[36:39], 0 offen sc1 nt
    buffer_load_dwordx4 v[52:55], v22, s[36:39], 0 offen sc1 nt
    s_mov_b32 s80, 200000
MC_156:
    s_mov_b64 exec, -1
    s_waitcnt vmcnt(0)
    v_cmp_gt_u64 s[44:45], s[94:95], v[50:51]
    v_cmp_le_u64 vcc, s[72:73], v[50:51]
    s_or_b64 s[44:45], s[44:45], vcc
    v_cmp_gt_u64 s[46:47], s[94:95], v[54:55]
    v_cmp_le_u64 vcc, s[72:73], v[54:55]
    s_or_b64 s[46:47], s[46:47], vcc
    s_or_b64 s[90:91], s[44:45], s[46:47]
    s_cbranch_scc1 M_155
MD_157:
    s_mov_b64 exec, -1
    v_dot2_f32_bf16 v24, v48, s70, 0
    v_dot2_f32_bf16 v25, v48, s71, 0
    v_dot2_f32_bf16 v26, v49, s70, 0
    v_dot2_f32_bf16 v27, v49, s71, 0
    v_dot2_f32_bf16 v24, v52, s70, v24
    v_dot2_f32_bf16 v25, v52, s71, v25
    v_dot2_f32_bf16 v26, v53, s70, v26
    v_dot2_f32_bf16 v27, v53, s71, v27
    s_nop 1
    v_permlane32_swap_b32 v24, v26
    v_permlane32_swap_b32 v25, v27
    v_add_f32 v24, v24, v26
    v_add_f32 v25, v25, v27
    v_cvt_pk_bf16_f32 v24, v24, v25
    ds_write_b32 v6, v24
    v_mov_b32 v48, 0x24208
    v_mov_b32 v49, 1
    s_mov_b64 exec, 1
    ds_add_u32 v48, v49
    s_mov_b64 exec, -1
    v_mov_b32 v12, 0x24000
    s_mov_b32 s80, 1600000
LW_158:
    ds_read_b32 v13, v12
    s_waitcnt lgkmcnt(0)
    v_readfirstlane_b32 s79, v13
    s_cmp_ge_u32 s79, s65
    s_cbranch_scc1 LWD_159
    s_sub_u32 s80, s80, 1
    s_cmp_lg_u32 s80, 0
    s_cbranch_scc1 LW_158
LWD_159:
    v_xor_b32 v11, 0x0, v10
    ds_read_b128 v[64:67], v11 offset:0
    ds_read_b128 v[80:83], v11 offset:4096
    ds_read_b128 v[96:99], v11 offset:8192
    ds_read_b128 v[112:115], v11 offset:12288
    v_xor_b32 v11, 0x40, v10
    ds_read_b128 v[68:71], v11 offset:0
    ds_read_b128 v[84:87], v11 offset:4096
    ds_read_b128 v[100:103], v11 offset:8192
    ds_read_b128 v[116:119], v11 offset:12288
    v_xor_b32 v11, 0x80, v10
    ds_read_b128 v[72:75], v11 offset:0
    ds_read_b128 v[88:91], v11 offset:4096
    ds_read_b128 v[104:107], v11 offset:8192
    ds_read_b128 v[120:123], v11 offset:12288
    v_xor_b32 v11, 0xc0, v10
    ds_read_b128 v[76:79], v11 offset:0
    ds_read_b128 v[92:95], v11 offset:4096
    ds_read_b128 v[108:111], v11 offset:8192
    ds_read_b128 v[124:127], v11 offset:12288
    v_lshl_add_u32 v12, v1, 2, s64
    v_mov_b32 v13, 4
    s_mov_b64 exec, 3
    ds_add_u32 v12, v13
    s_mov_b64 exec, -1
    v_mov_b32 v12, 0x24208
    s_mov_b32 s80, 1600000
LW_160:
    ds_read_b32 v13, v12
    s_waitcnt lgkmcnt(0)
    v_readfirstlane_b32 s79, v13
    s_cmp_ge_u32 s79, 20
    s_cbranch_scc1 LWD_161
    s_sub_u32 s80, s80, 1
    s_cmp_lg_u32 s80, 0
    s_cbranch_scc1 LW_160
LWD_161:
    ds_read_b128 v[48:51], v9 offset:0
    ds_read_b128 v[52:55], v9 offset:64
    ds_read_b128 v[56:59], v9 offset:128
    ds_read_b128 v[60:63], v9 offset:192
    s_waitcnt lgkmcnt(3)
    v_mfma_f32_16x16x32_bf16 v[128:131], v[64:67], v[48:51], 0
    v_mfma_f32_16x16x32_bf16 v[132:135], v[80:83], v[48:51], 0
    v_mfma_f32_16x16x32_bf16 v[136:139], v[96:99], v[48:51], 0
    v_mfma_f32_16x16x32_bf16 v[140:143], v[112:115], v[48:51], 0
    s_waitcnt lgkmcnt(2)
    v_mfma_f32_16x16x32_bf16 v[128:131], v[68:71], v[52:55], v[128:131]
    v_mfma_f32_16x16x32_bf16 v[132:135], v[84:87], v[52:55], v[132:135]
    v_mfma_f32_16x16x32_bf16 v[136:139], v[100:103], v[52:55], v[136:139]
    v_mfma_f32_16x16x32_bf16 v[140:143], v[116:119], v[52:55], v[140:143]
    s_waitcnt lgkmcnt(1)
    v_mfma_f32_16x16x32_bf16 v[128:131], v[72:75], v[56:59], v[128:131]
    v_mfma_f32_16x16x32_bf16 v[132:135], v[88:91], v[56:59], v[132:135]
    v_mfma_f32_16x16x32_bf16 v[136:139], v[104:107], v[56:59], v[136:139]
    v_mfma_f32_16x16x32_bf16 v[140:143], v[120:123], v[56:59], v[140:143]
    s_waitcnt lgkmcnt(0)
    v_mfma_f32_16x16x32_bf16 v[128:131], v[76:79], v[60:63], v[128:131]
    v_mfma_f32_16x16x32_bf16 v[132:135], v[92:95], v[60:63], v[132:135]
    v_mfma_f32_16x16x32_bf16 v[136:139], v[108:111], v[60:63], v[136:139]
    v_mfma_f32_16x16x32_bf16 v[140:143], v[124:127], v[60:63], v[140:143]
    s_nop 4
    v_cvt_pk_bf16_f32 v24, v128, v129
    v_cvt_pk_bf16_f32 v25, v130, v131
    v_cvt_pk_bf16_f32 v26, v132, v133
    v_cvt_pk_bf16_f32 v27, v134, v135
    v_cvt_pk_bf16_f32 v28, v136, v137
    v_cvt_pk_bf16_f32 v29, v138, v139
    v_cvt_pk_bf16_f32 v30, v140, v141
    v_cvt_pk_bf16_f32 v31, v142, v143
    v_mov_b32_dpp v24, v26 quad_perm:[0,1,2,3] row_mask:0xf bank_mask:0x2
    v_mov_b32_dpp v25, v27 quad_perm:[0,1,2,3] row_mask:0xf bank_mask:0x2
    v_mov_b32_dpp v24, v28 quad_perm:[0,1,2,3] row_mask:0xf bank_mask:0x4
    v_mov_b32_dpp v25, v29 quad_perm:[0,1,2,3] row_mask:0xf bank_mask:0x4
    v_mov_b32_dpp v24, v30 quad_perm:[0,1,2,3] row_mask:0xf bank_mask:0x8
    v_mov_b32_dpp v25, v31 quad_perm:[0,1,2,3] row_mask:0xf bank_mask:0x8
    buffer_store_dwordx2 v[24:25], v5, s[36:39], 0 offen sc1
    v_mov_b32 v48, 0x24208
    v_mov_b32 v49, 32
    s_mov_b64 exec, 1
    ds_add_u32 v48, v49
    s_mov_b64 exec, -1
L_ESVC:
    v_lshrrev_b32 v160, 2, v1
    v_bfe_u32 v161, v1, 3, 2
    v_xor_b32 v161, s61, v161
    v_lshlrev_b32 v161, 5, v161
    v_lshl_add_u32 v161, v160, 7, v161
    v_and_b32 v162, 3, v1
    v_lshl_add_u32 v161, v162, 3, v161
    s_lshl_b32 s7, s61, 8
    s_lshl_b32 s62, s4, 10
    s_add_u32 s7, s7, s62
    s_add_u32 s7, s7, 0x30000
    v_and_b32 v164, 1, v1
    v_lshl_add_u32 v4, v164, 7, s7
    s_lshl_b32 s7, s4, 13
    s_lshl_b32 s62, s61, 11
    s_add_u32 s7, s7, s62
    s_add_u32 s7, s7, 0x200000
    v_lshl_add_u32 v5, v1, 4, s7
    s_mul_i32 s7, s61, 1088
    s_add_u32 s7, s7, 0x26600
    v_lshl_add_u32 v6, v160, 6, s7
    v_lshl_add_u32 v6, v164, 5, v6
    v_and_b32 v164, 2, v1
    v_lshl_add_u32 v6, v164, 2, v6
    v_mul_u32_u24 v7, 1088, v162
    v_lshl_add_u32 v7, v2, 4, v7
    v_add_u32 v7, 0x26600, v7
    v_cmp_gt_u32 s[84:85], 4, v3
    s_and_b32 s62, s4, 7
    s_lshl_b32 s62, s62, 3
    s_lshr_b32 s7, s4, 3
    s_lshl_b32 s7, s7, 1
    s_add_u32 s62, s62, s7
    s_add_u32 s62, s62, s5
    s_sub_u32 s62, s62, 6
    s_add_u32 s62, s62, 2
    s_lshl_b32 s7, s62, 10
    s_lshl_b32 s64, s61, 8
    s_add_u32 s7, s7, s64
    s_add_u32 s7, s7, 0xc0000
    v_lshl_add_u32 v10, v162, 6, s7
    v_lshl_add_u32 v10, v2, 4, v10
    s_lshr_b32 s7, s62, 3
    s_lshl_b32 s7, s7, 7
    s_add_u32 s7, s7, 0x22000
    v_and_b32 v164, 7, v1
    v_lshl_add_u32 v9, v164, 3, s7
    v_mov_b32 v16, 0x24204
    s_mov_b32 s80, 1600000
LW_162:
    ds_read_b32 v17, v16
    s_waitcnt lgkmcnt(0)
    v_readfirstlane_b32 s79, v17
    s_cmp_ge_u32 s79, 1
    s_cbranch_scc1 LWD_163
    s_sleep 1
    s_sub_u32 s80, s80, 1
    s_cmp_lg_u32 s80, 0
    s_cbranch_scc1 LW_162
LWD_163:
    v_mov_b32 v16, 0x24248
    ds_read_b64 v[18:19], v16
    s_waitcnt lgkmcnt(0)
    v_readfirstlane_b32 s92, v18
    v_readfirstlane_b32 s93, v19
    v_mov_b32 v16, 0x24000
    s_mov_b32 s80, 1600000
LW_164:
    ds_read_b32 v17, v16
    s_waitcnt lgkmcnt(0)
    v_readfirstlane_b32 s79, v17
    s_cmp_ge_u32 s79, 96
    s_cbranch_scc1 LWD_165
    s_sleep 4
    s_sub_u32 s80, s80, 1
    s_cmp_lg_u32 s80, 0
    s_cbranch_scc1 LW_164
LWD_165:
    s_or_b32 s95, s95, s78
    s_add_u32 s88, s94, 0x10000
    s_addc_u32 s89, s95, 0
    s_mov_b32 s101, 4
    s_mov_b64 exec, 0xff
U_166:
    buffer_load_dwordx2 v[16:17], v9, s[36:39], 0 offen sc1 nt
UU_167:
    s_waitcnt vmcnt(0)
    v_cmp_gt_u64 s[90:91], s[94:95], v[16:17]
    v_cmp_le_u64 vcc, s[88:89], v[16:17]
    s_or_b64 vcc, vcc, s[90:91]
    s_cbranch_scc0 UD_168
    s_sleep 8
    s_sub_u32 s101, s101, 1
    s_cmp_lg_u32 s101, 0
    s_cbranch_scc1 U_166
UD_168:
    s_mov_b64 exec, -1
    v_mov_b32 v16, 0x24000
    s_mov_b32 s80, 1600000
LW_169:
    ds_read_b32 v17, v16
    s_waitcnt lgkmcnt(0)
    v_readfirstlane_b32 s79, v17
    s_cmp_ge_u32 s79, 128
    s_cbranch_scc1 LWD_170
    s_sleep 4
    s_sub_u32 s80, s80, 1
    s_cmp_lg_u32 s80, 0
    s_cbranch_scc1 LW_169
LWD_170:
    ds_read_b64_tr_b16 v[32:33], v161 offset:0
    ds_read_b64_tr_b16 v[34:35], v161 offset:2048
    ds_read_b64_tr_b16 v[36:37], v161 offset:4096
    ds_read_b64_tr_b16 v[38:39], v161 offset:6144
    ds_read_b64_tr_b16 v[40:41], v161 offset:8192
    ds_read_b64_tr_b16 v[42:43], v161 offset:10240
    ds_read_b64_tr_b16 v[44:45], v161 offset:12288
    ds_read_b64_tr_b16 v[46:47], v161 offset:14336
    s_waitcnt lgkmcnt(4)
    ds_read_b64_tr_b16 v[48:49], v161 offset:16384
    ds_read_b64_tr_b16 v[50:51], v161 offset:18432
    ds_read_b64_tr_b16 v[52:53], v161 offset:20480
    ds_read_b64_tr_b16 v[54:55], v161 offset:22528
    ds_read_b64_tr_b16 v[56:57], v161 offset:24576
    ds_read_b64_tr_b16 v[58:59], v161 offset:26624
    ds_read_b64_tr_b16 v[60:61], v161 offset:28672
    ds_read_b64_tr_b16 v[62:63], v161 offset:30720
    s_waitcnt lgkmcnt(4)
    ds_read_b64_tr_b16 v[64:65], v161 offset:32768
    ds_read_b64_tr_b16 v[66:67], v161 offset:34816
    ds_read_b64_tr_b16 v[68:69], v161 offset:36864
    ds_read_b64_tr_b16 v[70:71], v161 offset:38912
    ds_read_b64_tr_b16 v[72:73], v161 offset:40960
    ds_read_b64_tr_b16 v[74:75], v161 offset:43008
    ds_read_b64_tr_b16 v[76:77], v161 offset:45056
    ds_read_b64_tr_b16 v[78:79], v161 offset:47104
    s_waitcnt lgkmcnt(4)
    ds_read_b64_tr_b16 v[80:81], v161 offset:49152
    ds_read_b64_tr_b16 v[82:83], v161 offset:51200
    ds_read_b64_tr_b16 v[84:85], v161 offset:53248
    ds_read_b64_tr_b16 v[86:87], v161 offset:55296
    ds_read_b64_tr_b16 v[88:89], v161 offset:57344
    ds_read_b64_tr_b16 v[90:91], v161 offset:59392
    ds_read_b64_tr_b16 v[92:93], v161 offset:61440
    ds_read_b64_tr_b16 v[94:95], v161 offset:63488
    s_waitcnt lgkmcnt(4)
    v_lshlrev_b32 v16, 2, v1
    v_add_u32 v16, 0x24100, v16
    v_mov_b32 v17, 1
    s_mov_b64 exec, 255
    ds_add_u32 v16, v17
    s_mov_b64 exec, -1
    s_lshl_b32 s7, s62, 2
    s_add_u32 s7, s7, s61
    s_lshl_b32 s7, s7, 13
    s_add_u32 s7, s7, 0x600000
    v_lshl_add_u32 v8, v1, 7, s7
    buffer_load_dword v8, v8, s[36:39], 0 offen sc1 nt
    s_and_b32 s7, s4, 7
    s_lshl_b32 s7, s7, 12
    s_add_u32 s7, s7, 0x28008
    v_lshl_add_u32 v9, v1, 9, s7
    s_lshl_b32 s7, s61, 8
    s_lshr_b32 s64, s4, 2
    s_lshl_b32 s64, s64, 3
    s_add_u32 s7, s7, s64
    s_add_u32 s7, s7, 0x22800
    v_writelane_b32 v9, s7, 8
    s_add_u32 s7, s7, 128
    v_writelane_b32 v9, s7, 9
    s_cmp_eq_u32 s101, 0
    s_cbranch_scc1 EH_171
    s_mov_b64 exec, 0xff
    buffer_load_dwordx2 v[12:13], v9, s[36:39], 0 offen sc1 nt
    s_mov_b32 s80, 200000
MC_173:
    s_mov_b64 exec, 0xff
    s_waitcnt vmcnt(0)
    v_cmp_ne_u64 s[64:65], s[92:93], v[12:13]
    s_cmp_lg_u64 s[64:65], 0
    s_cbranch_scc1 M_172
MD_174:
    s_mov_b64 exec, -1
EH_171:
    s_mov_b64 exec, 0x300
    buffer_load_dwordx2 v[12:13], v9, s[36:39], 0 offen sc1
    s_mov_b32 s80, 200000
MC_176:
    s_mov_b64 exec, 0x300
    s_waitcnt vmcnt(0)
    v_cmp_ne_u64 s[64:65], s[92:93], v[12:13]
    s_cmp_lg_u64 s[64:65], 0
    s_cbranch_scc1 M_175
MD_177:
    s_mov_b64 exec, -1
    s_setprio 2
    s_mov_b64 exec, -1
    buffer_load_dwordx4 v[16:19], v5, s[36:39], 0 offen offset:0 sc1
    buffer_load_dwordx4 v[20:23], v5, s[36:39], 0 offen offset:1024 sc1
    buffer_load_dwordx4 v[12:15], v4, s[36:39], 0 offen sc1
    s_mov_b32 s80, 200000
MC_179:
    s_mov_b64 exec, -1
    s_waitcnt vmcnt(0)
    v_max3_u32 v160, v16, v17, v18
    v_max_u32 v160, v160, v19
    v_cmp_eq_u32 s[64:65], -1, v160
    v_max3_u32 v161, v20, v21, v22
    v_max_u32 v161, v161, v23
    v_cmp_eq_u32 s[66:67], -1, v161
    v_cmp_ne_u64 s[68:69], s[92:93], v[14:15]
    s_or_b64 s[90:91], s[64:65], s[66:67]
    s_or_b64 s[90:91], s[90:91], s[68:69]
    s_cbranch_scc1 M_178
MD_180:
    s_mov_b64 exec, -1
    v_readlane_b32 s74, v12, 0
    v_readlane_b32 s76, v13, 0
    v_readlane_b32 s75, v12, 1
    v_readlane_b32 s77, v13, 1
    v_mov_b32 v160, s74
    v_max_f32 v160, s75, v160
    v_sub_f32 v11, s74, v160
    v_sub_f32 v12, s75, v160
    v_exp_f32 v11, v11
    v_exp_f32 v12, v12
    v_mul_f32 v160, s76, v11
    v_fmac_f32 v160, s77, v12
    v_rcp_f32 v160, v160
    s_nop 0
    v_mul_f32 v11, v11, v160
    v_mul_f32 v12, v12, v160
    v_lshlrev_b32 v96, 16, v16
    v_and_b32 v97, 0xffff0000, v16
    v_lshlrev_b32 v98, 16, v17
    v_and_b32 v99, 0xffff0000, v17
    v_lshlrev_b32 v100, 16, v18
    v_and_b32 v101, 0xffff0000, v18
    v_lshlrev_b32 v102, 16, v19
    v_and_b32 v103, 0xffff0000, v19
    v_lshlrev_b32 v104, 16, v20
    v_and_b32 v105, 0xffff0000, v20
    v_lshlrev_b32 v106, 16, v21
    v_and_b32 v107, 0xffff0000, v21
    v_lshlrev_b32 v108, 16, v22
    v_and_b32 v109, 0xffff0000, v22
    v_lshlrev_b32 v110, 16, v23
    v_and_b32 v111, 0xffff0000, v23
    v_mul_f32 v96, v96, v11
    v_mul_f32 v97, v97, v11
    v_mul_f32 v98, v98, v11
    v_mul_f32 v99, v99, v11
    v_mul_f32 v100, v100, v11
    v_mul_f32 v101, v101, v11
    v_mul_f32 v102, v102, v11
    v_mul_f32 v103, v103, v11
    v_fmac_f32 v96, v104, v12
    v_fmac_f32 v97, v105, v12
    v_fmac_f32 v98, v106, v12
    v_fmac_f32 v99, v107, v12
    v_fmac_f32 v100, v108, v12
    v_fmac_f32 v101, v109, v12
    v_fmac_f32 v102, v110, v12
    v_fmac_f32 v103, v111, v12
    v_cvt_pk_bf16_f32 v24, v96, v97
    v_cvt_pk_bf16_f32 v25, v98, v99
    v_cvt_pk_bf16_f32 v26, v100, v101
    v_cvt_pk_bf16_f32 v27, v102, v103
    ds_write_b64 v6, v[24:25]
    ds_write_b64 v6, v[26:27] offset:16
    s_add_u32 s81, s81, 4
    v_mov_b32 v160, 0x2420c
    v_mov_b32 v161, 1
    s_mov_b64 exec, 1
    ds_add_u32 v160, v161
    s_mov_b64 exec, -1
    v_mov_b32 v160, 0x2420c
    s_mov_b32 s80, 1600000
LW_181:
    ds_read_b32 v161, v160
    s_waitcnt lgkmcnt(0)
    v_readfirstlane_b32 s79, v161
    s_cmp_ge_u32 s79, s81
    s_cbranch_scc1 LWD_182
    s_sub_u32 s80, s80, 1
    s_cmp_lg_u32 s80, 0
    s_cbranch_scc1 LW_181
LWD_182:
    ds_read_b128 v[96:99], v7 offset:0
    ds_read_b128 v[100:103], v7 offset:64
    ds_read_b128 v[104:107], v7 offset:128
    ds_read_b128 v[108:111], v7 offset:192
    ds_read_b128 v[112:115], v7 offset:256
    ds_read_b128 v[116:119], v7 offset:320
    ds_read_b128 v[120:123], v7 offset:384
    ds_read_b128 v[124:127], v7 offset:448
    ds_read_b128 v[128:131], v7 offset:512
    ds_read_b128 v[132:135], v7 offset:576
    ds_read_b128 v[136:139], v7 offset:640
    ds_read_b128 v[140:143], v7 offset:704
    v_mov_b32 v18, s92
    v_mov_b32 v19, s93
    s_waitcnt lgkmcnt(8)
    ds_read_b128 v[144:147], v7 offset:768
    ds_read_b128 v[148:151], v7 offset:832
    ds_read_b128 v[152:155], v7 offset:896
    ds_read_b128 v[156:159], v7 offset:960
    v_mfma_f32_16x16x32_bf16 v[12:15], v[32:35], v[96:99], 0
    v_mfma_f32_16x16x32_bf16 v[12:15], v[36:39], v[100:103], v[12:15]
    v_mfma_f32_16x16x32_bf16 v[12:15], v[40:43], v[104:107], v[12:15]
    v_mfma_f32_16x16x32_bf16 v[12:15], v[44:47], v[108:111], v[12:15]
    s_waitcnt lgkmcnt(11)
    v_mfma_f32_16x16x32_bf16 v[12:15], v[48:51], v[112:115], v[12:15]
    s_waitcnt lgkmcnt(10)
    v_mfma_f32_16x16x32_bf16 v[12:15], v[52:55], v[116:119], v[12:15]
    s_waitcnt lgkmcnt(9)
    v_mfma_f32_16x16x32_bf16 v[12:15], v[56:59], v[120:123], v[12:15]
    s_waitcnt lgkmcnt(8)
    v_mfma_f32_16x16x32_bf16 v[12:15], v[60:63], v[124:127], v[12:15]
    s_waitcnt lgkmcnt(7)
    v_mfma_f32_16x16x32_bf16 v[12:15], v[64:67], v[128:131], v[12:15]
    s_waitcnt lgkmcnt(6)
    v_mfma_f32_16x16x32_bf16 v[12:15], v[68:71], v[132:135], v[12:15]
    s_waitcnt lgkmcnt(5)
    v_mfma_f32_16x16x32_bf16 v[12:15], v[72:75], v[136:139], v[12:15]
    s_waitcnt lgkmcnt(4)
    v_mfma_f32_16x16x32_bf16 v[12:15], v[76:79], v[140:143], v[12:15]
    s_waitcnt lgkmcnt(3)
    v_mfma_f32_16x16x32_bf16 v[12:15], v[80:83], v[144:147], v[12:15]
    s_waitcnt lgkmcnt(2)
    v_mfma_f32_16x16x32_bf16 v[12:15], v[84:87], v[148:151], v[12:15]
    s_waitcnt lgkmcnt(1)
    v_mfma_f32_16x16x32_bf16 v[12:15], v[88:91], v[152:155], v[12:15]
    s_waitcnt lgkmcnt(0)
    v_mfma_f32_16x16x32_bf16 v[12:15], v[92:95], v[156:159], v[12:15]
    s_nop 7
    v_cvt_pk_bf16_f32 v16, v12, v13
    v_cvt_pk_bf16_f32 v17, v14, v15
    s_mov_b64 exec, s[84:85]
    s_cmp_eq_u32 s101, 0
    s_cbranch_scc1 SU_183
    buffer_store_dwordx4 v[16:19], v10, s[36:39], 0 offen
SV_184:
    s_mov_b64 exec, -1
    s_endpgm
L_BATT:
    s_and_b32 s60, s4, 7
    s_lshl_b32 s60, s60, 3
    s_lshr_b32 s7, s4, 3
    s_lshl_b32 s7, s7, 1
    s_add_u32 s60, s60, s7
    s_add_u32 s60, s60, s5
    s_sub_u32 s60, s60, 6
    s_lshr_b32 s61, s6, 1
    s_and_b32 s62, s6, 1
    s_mov_b32 s64, 0x3e0293ee
    v_lshlrev_b32 v4, 10, v3
    v_lshl_add_u32 v4, v2, 8, v4
    v_lshl_add_u32 v0, v3, 4, v4
    s_lshl_b32 s7, s62, 14
    s_add_u32 s7, s7, 0x1c000
    v_add_u32 v0, s7, v0
    v_and_b32 v162, 3, v1
    v_lshl_add_u32 v4, v162, 6, v4
    v_bfe_u32 v162, v1, 2, 2
    v_lshl_add_u32 v4, v162, 4, v4
    s_lshl_b32 s7, s6, 7
    s_add_u32 s7, s7, 0x24400
    v_lshl_add_u32 v5, v3, 3, s7
    s_lshl_b32 s7, s61, 10
    s_lshl_b32 s63, s62, 8
    s_add_u32 s7, s7, s63
    s_add_u32 s7, s7, 0x26000
    v_lshl_add_u32 v6, v3, 4, s7
    v_lshrrev_b32 v163, 5, v1
    v_lshl_add_u32 v6, v163, 9, v6
    v_and_b32 v162, 1, v2
    v_lshl_add_u32 v6, v162, 3, v6
    v_lshlrev_b32 v7, 4, v1
    v_add_u32 v7, 0x26000, v7
    v_and_b32 v162, 31, v1
    v_lshlrev_b32 v8, 3, v162
    v_add_u32 v8, 0x24400, v8
    v_bfe_u32 v162, v1, 2, 2
    v_lshl_add_u32 v164, v163, 3, v162
    v_lshlrev_b32 v164, 10, v164
    v_and_b32 v165, 1, v1
    v_lshl_add_u32 v164, v165, 3, v164
    s_lshl_b32 s7, s61, 8
    v_add_u32 v164, s7, v164
    v_bfe_u32 v165, v1, 4, 1
    v_lshlrev_b32 v165, 1, v165
    v_bfe_u32 v160, v1, 1, 1
    v_or_b32 v165, v165, v160
    s_lshl_b32 s7, s62, 3
    v_or_b32 v165, s7, v165
    v_lshlrev_b32 v162, 2, v162
    v_xor_b32 v165, v165, v162
    v_lshlrev_b32 v163, 1, v163
    v_xor_b32 v165, v165, v163
    v_xor_b32 v160, 0, v165
    v_lshl_add_u32 v9, v160, 4, v164
    v_xor_b32 v160, 4, v165
    v_lshl_add_u32 v10, v160, 4, v164
    v_xor_b32 v160, 1, v165
    v_lshl_add_u32 v11, v160, 4, v164
    v_add_u32 v11, 0x1000, v11
    v_xor_b32 v160, 5, v165
    v_lshl_add_u32 v12, v160, 4, v164
    v_add_u32 v12, 0x1000, v12
    v_mov_b32 v13, 0xff800000
    s_mov_b64 s[84:85], 0xffff
    s_lshl_b32 s7, s60, 15
    s_lshl_b32 s63, s6, 12
    s_add_u32 s7, s7, s63
    s_add_u32 s7, s7, 0x600000
    v_lshl_add_u32 v152, v1, 7, s7
    s_mov_b64 exec, 0xffffffff
    buffer_store_dword v1, v152, s[36:39], 0 offen
    s_mov_b64 exec, -1
    v_mov_b32 v160, 0x24204
    s_mov_b32 s80, 1600000
LW_185:
    ds_read_b32 v161, v160
    s_waitcnt lgkmcnt(0)
    v_readfirstlane_b32 s79, v161
    s_cmp_ge_u32 s79, 1
    s_cbranch_scc1 LWD_186
    s_sleep 1
    s_sub_u32 s80, s80, 1
    s_cmp_lg_u32 s80, 0
    s_cbranch_scc1 LW_185
LWD_186:
    v_mov_b32 v160, 0x24248
    ds_read_b64 v[162:163], v160
    s_waitcnt lgkmcnt(0)
    v_readfirstlane_b32 s92, v162
    v_readfirstlane_b32 s93, v163
    s_lshl_b32 s7, s6, 9
    s_add_u32 s7, s7, 0x20000
    v_and_b32 v144, 1, v1
    v_lshl_add_u32 v144, v144, 3, s7
    v_lshrrev_b32 v145, 1, v1
    v_lshl_add_u32 v144, v145, 7, v144
    s_lshr_b32 s7, s60, 4
    s_lshl_b32 s7, s7, 15
    s_add_u32 s7, s7, s63
    v_lshl_add_u32 v145, v1, 4, s7
    s_and_b32 s7, s6, 3
    s_lshl_b32 s7, s7, 6
    v_lshlrev_b32 v146, 4, v1
    v_xor_b32 v146, s7, v146
    s_add_u32 s7, s63, 0x1c000
    v_add_u32 v146, s7, v146
    v_xor_b32 v147, 0x10, v146
    v_xor_b32 v148, 0x20, v146
    v_xor_b32 v149, 0x30, v146
    s_lshl_b32 s66, s61, 4
    s_add_u32 s66, s66, 16
    s_mov_b32 s70, 64
    s_mov_b32 s71, 0x800080
    s_lshl_b32 s67, s61, 2
    s_or_b32 s67, s67, 0x40000
    s_mov_b32 s72, 0x6543210
    s_mov_b32 s73, 0x65487321
    s_mov_b32 s69, 4
    s_lshl_b32 s7, s61, 14
    v_add_u32 v16, s7, v4
    v_mov_b32 v160, 0x24000
    s_mov_b32 s80, 1600000
LW_187:
    ds_read_b32 v161, v160
    s_waitcnt lgkmcnt(0)
    v_readfirstlane_b32 s79, v161
    s_cmp_ge_u32 s79, 64
    s_cbranch_scc1 LWD_188
    s_sleep 2
    s_sub_u32 s80, s80, 1
    s_cmp_lg_u32 s80, 0
    s_cbranch_scc1 LW_187
LWD_188:
    v_xor_b32 v160, 0x0, v16
    ds_read_b128 v[32:35], v160
    v_xor_b32 v161, 0x10, v16
    ds_read_b128 v[36:39], v161
    v_xor_b32 v160, 0x20, v16
    ds_read_b128 v[40:43], v160
    v_xor_b32 v161, 0x30, v16
    ds_read_b128 v[44:47], v161
    v_xor_b32 v160, 0x40, v16
    ds_read_b128 v[48:51], v160
    v_xor_b32 v161, 0x50, v16
    ds_read_b128 v[52:55], v161
    v_xor_b32 v160, 0x60, v16
    ds_read_b128 v[56:59], v160
    v_xor_b32 v161, 0x70, v16
    ds_read_b128 v[60:63], v161
    v_xor_b32 v160, 0x80, v16
    ds_read_b128 v[64:67], v160
    v_xor_b32 v161, 0x90, v16
    ds_read_b128 v[68:71], v161
    v_xor_b32 v160, 0xa0, v16
    ds_read_b128 v[72:75], v160
    v_xor_b32 v161, 0xb0, v16
    ds_read_b128 v[76:79], v161
    v_xor_b32 v160, 0xc0, v16
    ds_read_b128 v[80:83], v160
    v_xor_b32 v161, 0xd0, v16
    ds_read_b128 v[84:87], v161
    v_xor_b32 v160, 0xe0, v16
    ds_read_b128 v[88:91], v160
    v_xor_b32 v161, 0xf0, v16
    ds_read_b128 v[92:95], v161
    s_bfe_u32 s7, s72, 0x40000
    s_lshl_b32 s7, s7, 14
    v_add_u32 v20, s7, v9
    v_add_u32 v21, s7, v10
    v_add_u32 v22, s7, v11
    v_add_u32 v23, s7, v12
    ds_read_b64_tr_b16 v[96:97], v20
    ds_read_b64_tr_b16 v[98:99], v22
    ds_read_b64_tr_b16 v[100:101], v21
    ds_read_b64_tr_b16 v[102:103], v23
    s_bfe_u32 s7, s72, 0x40004
    s_lshl_b32 s7, s7, 14
    v_add_u32 v24, s7, v9
    v_add_u32 v25, s7, v10
    v_add_u32 v26, s7, v11
    v_add_u32 v27, s7, v12
    ds_read_b64_tr_b16 v[104:105], v24
    ds_read_b64_tr_b16 v[106:107], v26
    ds_read_b64_tr_b16 v[108:109], v25
    ds_read_b64_tr_b16 v[110:111], v27
    s_bfe_u32 s7, s72, 0x40008
    s_lshl_b32 s7, s7, 14
    v_add_u32 v28, s7, v9
    v_add_u32 v29, s7, v10
    v_add_u32 v30, s7, v11
    v_add_u32 v31, s7, v12
    ds_read_b64_tr_b16 v[112:113], v28
    ds_read_b64_tr_b16 v[114:115], v30
    ds_read_b64_tr_b16 v[116:117], v29
    ds_read_b64_tr_b16 v[118:119], v31
    s_bfe_u32 s7, s72, 0x4000c
    s_lshl_b32 s7, s7, 14
    v_add_u32 v20, s7, v9
    v_add_u32 v21, s7, v10
    v_add_u32 v22, s7, v11
    v_add_u32 v23, s7, v12
    ds_read_b64_tr_b16 v[120:121], v20
    ds_read_b64_tr_b16 v[122:123], v22
    ds_read_b64_tr_b16 v[124:125], v21
    ds_read_b64_tr_b16 v[126:127], v23
    v_mov_b32 v162, 0x24100
    v_mov_b32 v163, 1
    s_mov_b64 exec, 1
    ds_add_u32 v162, v163
    s_mov_b64 exec, -1
    s_lshr_b32 s7, s60, 3
    s_lshl_b32 s7, s7, 7
    s_add_u32 s7, s7, 0x22000
    v_lshl_add_u32 v160, v1, 3, s7
    s_mov_b64 exec, 0xff
    buffer_load_dwordx2 v[16:17], v144, s[36:39], 0 offen sc1
    buffer_load_dwordx2 v[18:19], v160, s[36:39], 0 offen sc1 nt
    s_mov_b32 s80, 200000
MC_190:
    s_mov_b64 exec, 0xff
    s_waitcnt vmcnt(0)
    v_cmp_ne_u64 s[44:45], s[92:93], v[16:17]
    s_cmp_lg_u64 s[44:45], 0
    s_cbranch_scc1 M_189
MD_191:
    s_mov_b64 exec, -1
    s_or_b32 s95, s95, s78
    s_add_u32 s88, s94, 0x10000
    s_addc_u32 s89, s95, 0
    s_mov_b32 s101, 4
    s_mov_b64 exec, 0xff
    s_branch UU_193
U_192:
    buffer_load_dwordx2 v[18:19], v160, s[36:39], 0 offen sc1 nt
UU_193:
    s_waitcnt vmcnt(0)
    v_cmp_gt_u64 s[90:91], s[94:95], v[18:19]
    v_cmp_le_u64 vcc, s[88:89], v[18:19]
    s_or_b64 vcc, vcc, s[90:91]
    s_cbranch_scc0 UD_194
    s_sleep 8
    s_sub_u32 s101, s101, 1
    s_cmp_lg_u32 s101, 0
    s_cbranch_scc1 U_192
UD_194:
    s_mov_b64 exec, -1
    v_mov_b32 v160, 0x24000
    s_mov_b32 s80, 1600000
LW_195:
    ds_read_b32 v161, v160
    s_waitcnt lgkmcnt(0)
    v_readfirstlane_b32 s79, v161
    s_cmp_ge_u32 s79, 112
    s_cbranch_scc1 LWD_196
    s_sleep 1
    s_sub_u32 s80, s80, 1
    s_cmp_lg_u32 s80, 0
    s_cbranch_scc1 LW_195
LWD_196:
    s_mov_b64 exec, -1
    buffer_load_dwordx4 v[128:131], v145, s[36:39], 0 offen offset:0 sc1
    buffer_load_dwordx4 v[132:135], v145, s[36:39], 0 offen offset:1024 sc1
    buffer_load_dwordx4 v[136:139], v145, s[36:39], 0 offen offset:2048 sc1
    buffer_load_dwordx4 v[140:143], v145, s[36:39], 0 offen offset:3072 sc1
    s_mov_b32 s80, 200000
MC_198:
    s_mov_b64 exec, -1
    s_waitcnt vmcnt(0)
    v_max3_u32 v160, v128, v129, v130
    v_max_u32 v160, v160, v131
    v_cmp_eq_u32 s[44:45], -1, v160
    v_max3_u32 v161, v132, v133, v134
    v_max_u32 v161, v161, v135
    v_cmp_eq_u32 s[46:47], -1, v161
    v_max3_u32 v162, v136, v137, v138
    v_max_u32 v162, v162, v139
    v_cmp_eq_u32 s[48:49], -1, v162
    v_max3_u32 v163, v140, v141, v142
    v_max_u32 v163, v163, v143
    v_cmp_eq_u32 s[50:51], -1, v163
    s_or_b64 s[90:91], s[44:45], s[46:47]
    s_or_b64 s[90:91], s[90:91], s[48:49]
    s_or_b64 s[90:91], s[90:91], s[50:51]
    s_cbranch_scc1 M_197
MD_199:
    s_mov_b64 exec, -1
    ds_write_b128 v146, v[128:131] offset:0
    ds_write_b128 v147, v[132:135] offset:1024
    ds_write_b128 v148, v[136:139] offset:2048
    ds_write_b128 v149, v[140:143] offset:3072
    v_xor_b32 v20, 0x0, v0
    v_xor_b32 v21, 0x10, v0
    v_xor_b32 v22, 0x20, v0
    v_xor_b32 v23, 0x30, v0
    v_xor_b32 v24, 0x40, v0
    v_xor_b32 v25, 0x50, v0
    v_xor_b32 v26, 0x60, v0
    v_xor_b32 v27, 0x70, v0
    v_mov_b32 v0, v152
    s_add_u32 s81, s81, 8
    v_mov_b32 v162, 0x2420c
    v_mov_b32 v163, 1
    s_mov_b64 exec, 1
    ds_add_u32 v162, v163
    s_mov_b64 exec, -1
    v_mov_b32 v162, 0x2420c
    s_mov_b32 s80, 1600000
LW_200:
    ds_read_b32 v163, v162
    s_waitcnt lgkmcnt(0)
    v_readfirstlane_b32 s79, v163
    s_cmp_ge_u32 s79, s81
    s_cbranch_scc1 LWD_201
    s_sub_u32 s80, s80, 1
    s_cmp_lg_u32 s80, 0
    s_cbranch_scc1 LW_200
LWD_201:
    ds_read_b128 v[128:131], v20
    ds_read_b128 v[132:135], v21
    ds_read_b128 v[136:139], v22
    ds_read_b128 v[140:143], v23
    ds_read_b128 v[144:147], v24
    ds_read_b128 v[148:151], v25
    ds_read_b128 v[152:155], v26
    ds_read_b128 v[156:159], v27
    v_xor_b32 v20, 0x80, v20
    v_xor_b32 v21, 0x80, v21
    v_xor_b32 v22, 0x80, v22
    v_xor_b32 v23, 0x80, v23
    v_xor_b32 v24, 0x80, v24
    v_xor_b32 v25, 0x80, v25
    v_xor_b32 v26, 0x80, v26
    v_xor_b32 v27, 0x80, v27
    s_waitcnt lgkmcnt(7)
    v_mfma_f32_16x16x32_bf16 v[16:19], v[32:35], v[128:131], 0
    v_pk_mov_b32 v[32:33], v[128:129], v[128:129] op_sel:[0,1]
    v_pk_mov_b32 v[34:35], v[130:131], v[130:131] op_sel:[0,1]
    ds_read_b128 v[128:131], v20
    s_waitcnt lgkmcnt(7)
    v_mfma_f32_16x16x32_bf16 v[16:19], v[36:39], v[132:135], v[16:19]
    v_pk_mov_b32 v[36:37], v[132:133], v[132:133] op_sel:[0,1]
    v_pk_mov_b32 v[38:39], v[134:135], v[134:135] op_sel:[0,1]
    ds_read_b128 v[132:135], v21
    s_waitcnt lgkmcnt(7)
    v_mfma_f32_16x16x32_bf16 v[16:19], v[40:43], v[136:139], v[16:19]
    v_pk_mov_b32 v[40:41], v[136:137], v[136:137] op_sel:[0,1]
    v_pk_mov_b32 v[42:43], v[138:139], v[138:139] op_sel:[0,1]
    ds_read_b128 v[136:139], v22
    s_waitcnt lgkmcnt(7)
    v_mfma_f32_16x16x32_bf16 v[16:19], v[44:47], v[140:143], v[16:19]
    v_pk_mov_b32 v[44:45], v[140:141], v[140:141] op_sel:[0,1]
    v_pk_mov_b32 v[46:47], v[142:143], v[142:143] op_sel:[0,1]
    ds_read_b128 v[140:143], v23
    s_waitcnt lgkmcnt(7)
    v_mfma_f32_16x16x32_bf16 v[16:19], v[48:51], v[144:147], v[16:19]
    v_pk_mov_b32 v[48:49], v[144:145], v[144:145] op_sel:[0,1]
    v_pk_mov_b32 v[50:51], v[146:147], v[146:147] op_sel:[0,1]
    ds_read_b128 v[144:147], v24
    s_waitcnt lgkmcnt(7)
    v_mfma_f32_16x16x32_bf16 v[16:19], v[52:55], v[148:151], v[16:19]
    v_pk_mov_b32 v[52:53], v[148:149], v[148:149] op_sel:[0,1]
    v_pk_mov_b32 v[54:55], v[150:151], v[150:151] op_sel:[0,1]
    ds_read_b128 v[148:151], v25
    s_waitcnt lgkmcnt(7)
    v_mfma_f32_16x16x32_bf16 v[16:19], v[56:59], v[152:155], v[16:19]
    v_pk_mov_b32 v[56:57], v[152:153], v[152:153] op_sel:[0,1]
    v_pk_mov_b32 v[58:59], v[154:155], v[154:155] op_sel:[0,1]
    ds_read_b128 v[152:155], v26
    s_waitcnt lgkmcnt(7)
    v_mfma_f32_16x16x32_bf16 v[16:19], v[60:63], v[156:159], v[16:19]
    v_pk_mov_b32 v[60:61], v[156:157], v[156:157] op_sel:[0,1]
    v_pk_mov_b32 v[62:63], v[158:159], v[158:159] op_sel:[0,1]
    ds_read_b128 v[156:159], v27
    s_waitcnt lgkmcnt(7)
    v_mfma_f32_16x16x32_bf16 v[16:19], v[64:67], v[128:131], v[16:19]
    v_pk_mov_b32 v[64:65], v[128:129], v[128:129] op_sel:[0,1]
    v_pk_mov_b32 v[66:67], v[130:131], v[130:131] op_sel:[0,1]
    v_pk_mov_b32 v[128:129], 0, 0
    v_pk_mov_b32 v[130:131], 0, 0
    s_waitcnt lgkmcnt(6)
    v_mfma_f32_16x16x32_bf16 v[16:19], v[68:71], v[132:135], v[16:19]
    v_pk_mov_b32 v[68:69], v[132:133], v[132:133] op_sel:[0,1]
    v_pk_mov_b32 v[70:71], v[134:135], v[134:135] op_sel:[0,1]
    v_pk_mov_b32 v[132:133], 0, 0
    v_pk_mov_b32 v[134:135], 0, 0
    s_waitcnt lgkmcnt(5)
    v_mfma_f32_16x16x32_bf16 v[16:19], v[72:75], v[136:139], v[16:19]
    v_pk_mov_b32 v[72:73], v[136:137], v[136:137] op_sel:[0,1]
    v_pk_mov_b32 v[74:75], v[138:139], v[138:139] op_sel:[0,1]
    v_pk_mov_b32 v[136:137], 0, 0
    v_pk_mov_b32 v[138:139], 0, 0
    s_waitcnt lgkmcnt(4)
    v_mfma_f32_16x16x32_bf16 v[16:19], v[76:79], v[140:143], v[16:19]
    v_pk_mov_b32 v[76:77], v[140:141], v[140:141] op_sel:[0,1]
    v_pk_mov_b32 v[78:79], v[142:143], v[142:143] op_sel:[0,1]
    v_pk_mov_b32 v[140:141], 0, 0
    v_pk_mov_b32 v[142:143], 0, 0
    s_waitcnt lgkmcnt(3)
    v_mfma_f32_16x16x32_bf16 v[16:19], v[80:83], v[144:147], v[16:19]
    v_pk_mov_b32 v[80:81], v[144:145], v[144:145] op_sel:[0,1]
    v_pk_mov_b32 v[82:83], v[146:147], v[146:147] op_sel:[0,1]
    v_pk_mov_b32 v[144:145], 0, 0
    v_pk_mov_b32 v[146:147], 0, 0
    s_waitcnt lgkmcnt(2)
    v_mfma_f32_16x16x32_bf16 v[16:19], v[84:87], v[148:151], v[16:19]
    v_pk_mov_b32 v[84:85], v[148:149], v[148:149] op_sel:[0,1]
    v_pk_mov_b32 v[86:87], v[150:151], v[150:151] op_sel:[0,1]
    v_pk_mov_b32 v[148:149], 0, 0
    v_pk_mov_b32 v[150:151], 0, 0
    s_waitcnt lgkmcnt(1)
    v_mfma_f32_16x16x32_bf16 v[16:19], v[88:91], v[152:155], v[16:19]
    v_pk_mov_b32 v[88:89], v[152:153], v[152:153] op_sel:[0,1]
    v_pk_mov_b32 v[90:91], v[154:155], v[154:155] op_sel:[0,1]
    v_pk_mov_b32 v[152:153], 0, 0
    v_pk_mov_b32 v[154:155], 0, 0
    s_waitcnt lgkmcnt(0)
    v_mfma_f32_16x16x32_bf16 v[16:19], v[92:95], v[156:159], v[16:19]
    v_pk_mov_b32 v[92:93], v[156:157], v[156:157] op_sel:[0,1]
    v_pk_mov_b32 v[94:95], v[158:159], v[158:159] op_sel:[0,1]
    v_pk_mov_b32 v[156:157], 0, 0
    v_pk_mov_b32 v[158:159], 0, 0
    v_mov_b32 v162, 0x24104
    v_mov_b32 v163, 1
    s_mov_b64 exec, 1
    ds_add_u32 v162, v163
    s_mov_b64 exec, -1
    s_branch BM_202
BS_203:
    s_bfe_u32 s7, s72, s67
    s_lshl_b32 s7, s7, 14
    v_add_u32 v20, s7, v4
    v_xor_b32 v21, 0x10, v20
    v_xor_b32 v22, 0x20, v20
    v_xor_b32 v23, 0x30, v20
    v_xor_b32 v24, 0x40, v20
    v_xor_b32 v25, 0x50, v20
    v_xor_b32 v26, 0x60, v20
    v_xor_b32 v27, 0x70, v20
    v_mov_b32 v162, 0x24000
    s_mov_b32 s80, 1600000
LW_204:
    ds_read_b32 v163, v162
    s_waitcnt lgkmcnt(0)
    v_readfirstlane_b32 s79, v163
    s_cmp_ge_u32 s79, s66
    s_cbranch_scc1 LWD_205
    s_sleep 1
    s_sub_u32 s80, s80, 1
    s_cmp_lg_u32 s80, 0
    s_cbranch_scc1 LW_204
LWD_205:
    ds_read_b128 v[96:99], v20
    ds_read_b128 v[100:103], v21
    ds_read_b128 v[104:107], v22
    ds_read_b128 v[108:111], v23
    ds_read_b128 v[112:115], v24
    ds_read_b128 v[116:119], v25
    ds_read_b128 v[120:123], v26
    ds_read_b128 v[124:127], v27
    v_xor_b32 v20, 0x80, v20
    v_xor_b32 v21, 0x80, v21
    v_xor_b32 v22, 0x80, v22
    v_xor_b32 v23, 0x80, v23
    v_xor_b32 v24, 0x80, v24
    v_xor_b32 v25, 0x80, v25
    v_xor_b32 v26, 0x80, v26
    v_xor_b32 v27, 0x80, v27
    s_waitcnt lgkmcnt(7)
    v_mfma_f32_16x16x32_bf16 v[16:19], v[96:99], v[32:35], 0
    ds_read_b128 v[96:99], v20
    s_waitcnt lgkmcnt(7)
    v_mfma_f32_16x16x32_bf16 v[16:19], v[100:103], v[36:39], v[16:19]
    ds_read_b128 v[100:103], v21
    s_waitcnt lgkmcnt(7)
    v_mfma_f32_16x16x32_bf16 v[16:19], v[104:107], v[40:43], v[16:19]
    ds_read_b128 v[104:107], v22
    s_waitcnt lgkmcnt(7)
    v_mfma_f32_16x16x32_bf16 v[16:19], v[108:111], v[44:47], v[16:19]
    ds_read_b128 v[108:111], v23
    s_waitcnt lgkmcnt(7)
    v_mfma_f32_16x16x32_bf16 v[16:19], v[112:115], v[48:51], v[16:19]
    ds_read_b128 v[112:115], v24
    s_waitcnt lgkmcnt(7)
    v_mfma_f32_16x16x32_bf16 v[16:19], v[116:119], v[52:55], v[16:19]
    ds_read_b128 v[116:119], v25
    s_waitcnt lgkmcnt(7)
    v_mfma_f32_16x16x32_bf16 v[16:19], v[120:123], v[56:59], v[16:19]
    ds_read_b128 v[120:123], v26
    s_waitcnt lgkmcnt(7)
    v_mfma_f32_16x16x32_bf16 v[16:19], v[124:127], v[60:63], v[16:19]
    ds_read_b128 v[124:127], v27
    s_waitcnt lgkmcnt(7)
    v_mfma_f32_16x16x32_bf16 v[16:19], v[96:99], v[64:67], v[16:19]
    s_waitcnt lgkmcnt(6)
    v_mfma_f32_16x16x32_bf16 v[16:19], v[100:103], v[68:71], v[16:19]
    s_bfe_u32 s7, s72, 0x40000
    s_lshl_b32 s7, s7, 14
    v_add_u32 v20, s7, v9
    v_add_u32 v21, s7, v10
    v_add_u32 v22, s7, v11
    v_add_u32 v23, s7, v12
    s_waitcnt lgkmcnt(5)
    v_mfma_f32_16x16x32_bf16 v[16:19], v[104:107], v[72:75], v[16:19]
    s_waitcnt lgkmcnt(4)
    v_mfma_f32_16x16x32_bf16 v[16:19], v[108:111], v[76:79], v[16:19]
    s_bfe_u32 s7, s72, 0x40004
    s_lshl_b32 s7, s7, 14
    v_add_u32 v24, s7, v9
    v_add_u32 v25, s7, v10
    v_add_u32 v26, s7, v11
    v_add_u32 v27, s7, v12
    s_waitcnt lgkmcnt(3)
    v_mfma_f32_16x16x32_bf16 v[16:19], v[112:115], v[80:83], v[16:19]
    s_waitcnt lgkmcnt(2)
    v_mfma_f32_16x16x32_bf16 v[16:19], v[116:119], v[84:87], v[16:19]
    s_bfe_u32 s7, s72, 0x40008
    s_lshl_b32 s7, s7, 14
    v_add_u32 v28, s7, v9
    v_add_u32 v29, s7, v10
    v_add_u32 v30, s7, v11
    v_add_u32 v31, s7, v12
    s_waitcnt lgkmcnt(1)
    v_mfma_f32_16x16x32_bf16 v[16:19], v[120:123], v[88:91], v[16:19]
    s_waitcnt lgkmcnt(0)
    v_mfma_f32_16x16x32_bf16 v[16:19], v[124:127], v[92:95], v[16:19]
    s_cmp_ge_u32 s79, s70
    s_cbranch_scc1 BA_206
    v_mov_b32 v162, 0x24000
    s_mov_b32 s80, 1600000
LW_207:
    ds_read_b32 v163, v162
    s_waitcnt lgkmcnt(0)
    v_readfirstlane_b32 s79, v163
    s_cmp_ge_u32 s79, s70
    s_cbranch_scc1 LWD_208
    s_sleep 1
    s_sub_u32 s80, s80, 1
    s_cmp_lg_u32 s80, 0
    s_cbranch_scc1 LW_207
LWD_208:
BA_206:
    ds_read_b64_tr_b16 v[96:97], v20
    ds_read_b64_tr_b16 v[98:99], v22
    ds_read_b64_tr_b16 v[100:101], v21
    ds_read_b64_tr_b16 v[102:103], v23
    ds_read_b64_tr_b16 v[104:105], v24
    ds_read_b64_tr_b16 v[106:107], v26
    ds_read_b64_tr_b16 v[108:109], v25
    ds_read_b64_tr_b16 v[110:111], v27
    ds_read_b64_tr_b16 v[112:113], v28
    ds_read_b64_tr_b16 v[114:115], v30
    ds_read_b64_tr_b16 v[116:117], v29
    ds_read_b64_tr_b16 v[118:119], v31
    s_bfe_u32 s7, s72, 0x4000c
    s_lshl_b32 s7, s7, 14
    v_add_u32 v20, s7, v9
    v_add_u32 v21, s7, v10
    v_add_u32 v22, s7, v11
    v_add_u32 v23, s7, v12
    ds_read_b64_tr_b16 v[120:121], v20
    ds_read_b64_tr_b16 v[122:123], v22
    ds_read_b64_tr_b16 v[124:125], v21
    ds_read_b64_tr_b16 v[126:127], v23
    v_mov_b32 v162, 0x24100
    v_mov_b32 v163, 1
    s_mov_b64 exec, 1
    ds_add_u32 v162, v163
    s_mov_b64 exec, -1
BM_202:
    v_max3_f32 v160, v16, v17, v18
    v_max_f32 v160, v160, v19
    v_mov_b32 v161, v160
    s_nop 1
    v_permlane32_swap_b32 v160, v161
    v_max_f32 v160, v160, v161
    v_mov_b32 v161, v160
    s_nop 1
    v_permlane16_swap_b32 v160, v161
    v_max_f32 v160, v160, v161
    v_mul_f32 v160, s64, v160
    v_ceil_f32 v160, v160
    v_fma_f32 v16, v16, s64, -v160
    v_fma_f32 v17, v17, s64, -v160
    v_fma_f32 v18, v18, s64, -v160
    v_fma_f32 v19, v19, s64, -v160
    v_exp_f32 v16, v16
    v_exp_f32 v17, v17
    v_exp_f32 v18, v18
    v_exp_f32 v19, v19
    v_cvt_pk_bf16_f32 v162, v16, v17
    v_cvt_pk_bf16_f32 v163, v18, v19
    v_add_f32 v16, v16, v17
    v_add_f32 v18, v18, v19
    ds_write_b64 v6, v[162:163]
    v_add_f32 v161, v16, v18
    v_mov_b32 v16, v161
    s_nop 1
    v_permlane32_swap_b32 v161, v16
    v_add_f32 v161, v161, v16
    v_mov_b32 v16, v161
    s_nop 1
    v_permlane16_swap_b32 v161, v16
    v_add_f32 v161, v161, v16
    s_mov_b64 exec, s[84:85]
    ds_write_b64 v5, v[160:161]
    s_add_u32 s81, s81, 8
    v_mov_b32 v164, 0x2420c
    v_mov_b32 v165, 1
    s_mov_b64 exec, 1
    ds_add_u32 v164, v165
    s_mov_b64 exec, -1
    v_mov_b32 v164, 0x2420c
    s_mov_b32 s80, 1600000
LW_209:
    ds_read_b32 v165, v164
    s_waitcnt lgkmcnt(0)
    v_readfirstlane_b32 s79, v165
    s_cmp_ge_u32 s79, s81
    s_cbranch_scc1 LWD_210
    s_sub_u32 s80, s80, 1
    s_cmp_lg_u32 s80, 0
    s_cbranch_scc1 LW_209
LWD_210:
    ds_read_b32 v160, v8 offset:0
    ds_read_b32 v161, v8 offset:256
    ds_read_b32 v162, v8 offset:512
    ds_read_b32 v163, v8 offset:768
    ds_read_b128 v[16:19], v7 offset:0
    ds_read_b128 v[20:23], v7 offset:1024
    ds_read_b128 v[24:27], v7 offset:2048
    ds_read_b128 v[28:31], v7 offset:3072
    v_xor_b32 v6, 0x1000, v6
    v_xor_b32 v7, 0x1000, v7
    v_add_u32 v5, 1024, v5
    v_add_u32 v8, 1024, v8
    s_waitcnt lgkmcnt(4)
    v_max3_f32 v14, v13, v160, v161
    v_max3_f32 v14, v14, v162, v163
    v_cmp_neq_f32 vcc, v14, v13
    v_sub_f32 v160, v14, v160
    v_sub_f32 v161, v14, v161
    v_sub_f32 v162, v14, v162
    v_sub_f32 v163, v14, v163
    v_cvt_u32_f32 v160, v160
    v_cvt_u32_f32 v161, v161
    v_cvt_u32_f32 v162, v162
    v_cvt_u32_f32 v163, v163
    v_min_u32 v160, 0xff, v160
    v_min_u32 v161, 0xff, v161
    v_min_u32 v162, 0xff, v162
    v_min_u32 v163, 0xff, v163
    v_mul_u32_u24 v160, s71, v160
    v_mul_u32_u24 v161, s71, v161
    v_mul_u32_u24 v162, s71, v162
    v_mul_u32_u24 v163, s71, v163
    s_cbranch_vccz BR_211
    v_sub_f32 v164, v13, v14
    v_exp_f32 v164, v164
    v_mov_b32 v13, v14
    v_pk_mul_f32 v[128:129], v[128:129], v[164:165] op_sel_hi:[1,0]
    v_pk_mul_f32 v[130:131], v[130:131], v[164:165] op_sel_hi:[1,0]
    v_pk_mul_f32 v[132:133], v[132:133], v[164:165] op_sel_hi:[1,0]
    v_pk_mul_f32 v[134:135], v[134:135], v[164:165] op_sel_hi:[1,0]
    v_pk_mul_f32 v[136:137], v[136:137], v[164:165] op_sel_hi:[1,0]
    v_pk_mul_f32 v[138:139], v[138:139], v[164:165] op_sel_hi:[1,0]
    v_pk_mul_f32 v[140:141], v[140:141], v[164:165] op_sel_hi:[1,0]
    v_pk_mul_f32 v[142:143], v[142:143], v[164:165] op_sel_hi:[1,0]
    v_pk_mul_f32 v[144:145], v[144:145], v[164:165] op_sel_hi:[1,0]
    v_pk_mul_f32 v[146:147], v[146:147], v[164:165] op_sel_hi:[1,0]
    v_pk_mul_f32 v[148:149], v[148:149], v[164:165] op_sel_hi:[1,0]
    v_pk_mul_f32 v[150:151], v[150:151], v[164:165] op_sel_hi:[1,0]
    v_pk_mul_f32 v[152:153], v[152:153], v[164:165] op_sel_hi:[1,0]
    v_pk_mul_f32 v[154:155], v[154:155], v[164:165] op_sel_hi:[1,0]
    v_pk_mul_f32 v[156:157], v[156:157], v[164:165] op_sel_hi:[1,0]
    v_pk_mul_f32 v[158:159], v[158:159], v[164:165] op_sel_hi:[1,0]
BR_211:
    s_waitcnt lgkmcnt(3)
    v_pk_sub_u16 v16, v16, v160 clamp
    v_pk_sub_u16 v17, v17, v160 clamp
    v_pk_sub_u16 v18, v18, v160 clamp
    v_pk_sub_u16 v19, v19, v160 clamp
    s_nop 1
    v_mfma_f32_32x32x16_bf16 v[128:143], v[96:99], v[16:19], v[128:143]
    v_mfma_f32_32x32x16_bf16 v[144:159], v[100:103], v[16:19], v[144:159]
    s_waitcnt lgkmcnt(2)
    v_pk_sub_u16 v20, v20, v161 clamp
    v_pk_sub_u16 v21, v21, v161 clamp
    v_pk_sub_u16 v22, v22, v161 clamp
    v_pk_sub_u16 v23, v23, v161 clamp
    s_nop 1
    v_mfma_f32_32x32x16_bf16 v[128:143], v[104:107], v[20:23], v[128:143]
    v_mfma_f32_32x32x16_bf16 v[144:159], v[108:111], v[20:23], v[144:159]
    s_waitcnt lgkmcnt(1)
    v_pk_sub_u16 v24, v24, v162 clamp
    v_pk_sub_u16 v25, v25, v162 clamp
    v_pk_sub_u16 v26, v26, v162 clamp
    v_pk_sub_u16 v27, v27, v162 clamp
    s_nop 1
    v_mfma_f32_32x32x16_bf16 v[128:143], v[112:115], v[24:27], v[128:143]
    v_mfma_f32_32x32x16_bf16 v[144:159], v[116:119], v[24:27], v[144:159]
    s_waitcnt lgkmcnt(0)
    v_pk_sub_u16 v28, v28, v163 clamp
    v_pk_sub_u16 v29, v29, v163 clamp
    v_pk_sub_u16 v30, v30, v163 clamp
    v_pk_sub_u16 v31, v31, v163 clamp
    s_nop 1
    v_mfma_f32_32x32x16_bf16 v[128:143], v[120:123], v[28:31], v[128:143]
    v_mfma_f32_32x32x16_bf16 v[144:159], v[124:127], v[28:31], v[144:159]
    s_lshr_b64 s[72:73], s[72:73], 16
    s_add_u32 s66, s66, 64
    s_add_u32 s70, s70, 64
    s_sub_u32 s69, s69, 1
    s_cmp_lg_u32 s69, 0
    s_cbranch_scc1 BS_203
    s_lshr_b32 s67, s60, 3
    s_and_b32 s68, s60, 7
    s_lshl_b32 s7, s60, 15
    s_lshl_b32 s63, s6, 12
    s_add_u32 s7, s7, s63
    s_add_u32 s7, s7, 0x600000
    v_lshl_add_u32 v5, v1, 4, s7
    v_mov_b32 v38, s92
    v_mov_b32 v39, s93
    v_permlane32_swap_b32 v128, v132
    v_permlane32_swap_b32 v129, v133
    v_permlane32_swap_b32 v130, v134
    v_permlane32_swap_b32 v131, v135
    v_cvt_pk_bf16_f32 v16, v128, v129
    v_cvt_pk_bf16_f32 v17, v130, v131
    v_cvt_pk_bf16_f32 v18, v132, v133
    v_cvt_pk_bf16_f32 v19, v134, v135
    v_permlane32_swap_b32 v136, v140
    v_permlane32_swap_b32 v137, v141
    v_permlane32_swap_b32 v138, v142
    v_permlane32_swap_b32 v139, v143
    v_cvt_pk_bf16_f32 v20, v136, v137
    v_cvt_pk_bf16_f32 v21, v138, v139
    v_cvt_pk_bf16_f32 v22, v140, v141
    v_cvt_pk_bf16_f32 v23, v142, v143
    v_permlane32_swap_b32 v144, v148
    v_permlane32_swap_b32 v145, v149
    v_permlane32_swap_b32 v146, v150
    v_permlane32_swap_b32 v147, v151
    v_cvt_pk_bf16_f32 v24, v144, v145
    v_cvt_pk_bf16_f32 v25, v146, v147
    v_cvt_pk_bf16_f32 v26, v148, v149
    v_cvt_pk_bf16_f32 v27, v150, v151
    v_permlane32_swap_b32 v152, v156
    v_permlane32_swap_b32 v153, v157
    v_permlane32_swap_b32 v154, v158
    v_permlane32_swap_b32 v155, v159
    v_cvt_pk_bf16_f32 v28, v152, v153
    v_cvt_pk_bf16_f32 v29, v154, v155
    v_cvt_pk_bf16_f32 v30, v156, v157
    v_cvt_pk_bf16_f32 v31, v158, v159
    s_lshl_b32 s7, s67, 9
    s_lshl_b32 s65, s6, 6
    s_add_u32 s7, s7, s65
    s_add_u32 s7, s7, 0x23000
    v_and_b32 v160, 7, v1
    v_lshl_add_u32 v7, v160, 3, s7
    s_lshl_b64 s[88:89], 1, s68
    s_cmp_eq_u32 s101, 0
    s_cbranch_scc1 SU_212
    buffer_store_dwordx4 v[16:19], v5, s[36:39], 0 offen offset:0
    buffer_store_dwordx4 v[20:23], v5, s[36:39], 0 offen offset:1024
    buffer_store_dwordx4 v[24:27], v5, s[36:39], 0 offen offset:2048
    buffer_store_dwordx4 v[28:31], v5, s[36:39], 0 offen offset:3072
    s_waitcnt vmcnt(0)
    s_mov_b64 exec, s[88:89]
    buffer_store_dwordx2 v[38:39], v7, s[36:39], 0 offen
    s_mov_b64 exec, -1
SV_213:
    s_lshl_b32 s7, s67, 18
    s_add_u32 s7, s7, s63
    s_lshl_b32 s65, s68, 6
    s_add_u32 s7, s7, s65
    s_add_u32 s7, s7, 0x600000
    v_and_b32 v160, 3, v1
    v_lshl_add_u32 v5, v160, 4, s7
    v_bfe_u32 v161, v1, 2, 3
    v_lshl_add_u32 v5, v161, 9, v5
    v_lshrrev_b32 v162, 5, v1
    v_lshl_add_u32 v5, v162, 15, v5
    s_lshl_b32 s7, s67, 12
    s_add_u32 s7, s7, s65
    s_add_u32 s7, s7, 0x28000
    v_lshl_add_u32 v6, v160, 4, s7
    v_lshl_add_u32 v6, v162, 9, v6
    s_lshl_b32 s7, s68, 15
    s_lshl_b32 s63, s67, 10
    s_add_u32 s7, s7, s63
    s_lshl_b32 s63, s6, 7
    s_add_u32 s7, s7, s63
    s_add_u32 s7, s7, 0x200000
    v_lshl_add_u32 v8, v160, 13, s7
    v_lshl_add_u32 v8, v161, 4, v8
    v_lshl_add_u32 v8, v162, 3, v8
    s_lshl_b32 s7, s67, 7
    s_lshl_b32 s63, s68, 12
    s_add_u32 s7, s7, s63
    s_add_u32 s7, s7, 0x30000
    v_lshl_add_u32 v9, v160, 10, s7
    s_mov_b64 exec, 0xff
    buffer_load_dwordx2 v[40:41], v7, s[36:39], 0 offen sc1 nt
    s_mov_b32 s80, 200000
MC_215:
    s_mov_b64 exec, 0xff
    s_waitcnt vmcnt(0)
    v_cmp_ne_u64 s[86:87], s[92:93], v[40:41]
    s_cmp_lg_u64 s[86:87], 0
    s_cbranch_scc1 M_214
MD_216:
    s_mov_b64 exec, -1
    buffer_load_dwordx4 v[64:67], v6, s[36:39], 0 offen offset:0 sc1 nt
    buffer_load_dwordx4 v[68:71], v6, s[36:39], 0 offen offset:1024 sc1 nt
    buffer_load_dwordx4 v[72:75], v6, s[36:39], 0 offen offset:2048 sc1 nt
    buffer_load_dwordx4 v[76:79], v6, s[36:39], 0 offen offset:3072 sc1 nt
    s_mov_b32 s63, 0
    buffer_load_dwordx4 v[48:51], v5, s[36:39], s63 offen sc1 nt
    s_add_u32 s63, s63, 65536
    buffer_load_dwordx4 v[52:55], v5, s[36:39], s63 offen sc1 nt
    s_add_u32 s63, s63, 65536
    buffer_load_dwordx4 v[56:59], v5, s[36:39], s63 offen sc1 nt
    s_add_u32 s63, s63, 65536
    buffer_load_dwordx4 v[60:63], v5, s[36:39], s63 offen sc1 nt
    s_add_u32 s63, s63, 65536
    s_waitcnt vmcnt(4)
    v_cmp_ne_u64 s[90:91], s[92:93], v[66:67]
    v_cmp_ne_u64 vcc, s[92:93], v[70:71]
    s_or_b64 s[90:91], s[90:91], vcc
    v_cmp_ne_u64 vcc, s[92:93], v[74:75]
    s_or_b64 s[90:91], s[90:91], vcc
    v_cmp_ne_u64 vcc, s[92:93], v[78:79]
    s_or_b64 s[90:91], s[90:91], vcc
    s_cmp_lg_u64 s[90:91], 0
    s_cbranch_scc1 BL_217
BLD_218:
    v_max3_f32 v36, v64, v68, v72
    v_max_f32 v36, v36, v76
    v_mov_b32 v37, v36
    s_nop 1
    v_permlane32_swap_b32 v36, v37
    v_max_f32 v36, v36, v37
    v_sub_f32 v80, v64, v36
    v_sub_f32 v81, v68, v36
    v_sub_f32 v82, v72, v36
    v_sub_f32 v83, v76, v36
    v_exp_f32 v80, v80
    v_exp_f32 v81, v81
    v_exp_f32 v82, v82
    v_exp_f32 v83, v83
    v_mul_f32 v37, v80, v65
    v_fmac_f32 v37, v81, v69
    v_fmac_f32 v37, v82, v73
    v_fmac_f32 v37, v83, v77
    v_mov_b32 v40, v37
    s_nop 1
    v_permlane32_swap_b32 v37, v40
    v_add_f32 v37, v37, v40
    s_waitcnt vmcnt(3)
    v_lshlrev_b32 v88, 16, v48
    v_and_b32 v89, 0xffff0000, v48
    v_lshlrev_b32 v90, 16, v49
    v_and_b32 v91, 0xffff0000, v49
    v_lshlrev_b32 v92, 16, v50
    v_and_b32 v93, 0xffff0000, v50
    v_lshlrev_b32 v94, 16, v51
    v_and_b32 v95, 0xffff0000, v51
    v_mul_f32 v16, v88, v80
    v_mul_f32 v17, v89, v80
    v_mul_f32 v18, v90, v80
    v_mul_f32 v19, v91, v80
    v_mul_f32 v20, v92, v80
    v_mul_f32 v21, v93, v80
    v_mul_f32 v22, v94, v80
    v_mul_f32 v23, v95, v80
    s_waitcnt vmcnt(2)
    v_lshlrev_b32 v88, 16, v52
    v_and_b32 v89, 0xffff0000, v52
    v_lshlrev_b32 v90, 16, v53
    v_and_b32 v91, 0xffff0000, v53
    v_lshlrev_b32 v92, 16, v54
    v_and_b32 v93, 0xffff0000, v54
    v_lshlrev_b32 v94, 16, v55
    v_and_b32 v95, 0xffff0000, v55
    v_fmac_f32 v16, v88, v81
    v_fmac_f32 v17, v89, v81
    v_fmac_f32 v18, v90, v81
    v_fmac_f32 v19, v91, v81
    v_fmac_f32 v20, v92, v81
    v_fmac_f32 v21, v93, v81
    v_fmac_f32 v22, v94, v81
    v_fmac_f32 v23, v95, v81
    s_waitcnt vmcnt(1)
    v_lshlrev_b32 v88, 16, v56
    v_and_b32 v89, 0xffff0000, v56
    v_lshlrev_b32 v90, 16, v57
    v_and_b32 v91, 0xffff0000, v57
    v_lshlrev_b32 v92, 16, v58
    v_and_b32 v93, 0xffff0000, v58
    v_lshlrev_b32 v94, 16, v59
    v_and_b32 v95, 0xffff0000, v59
    v_fmac_f32 v16, v88, v82
    v_fmac_f32 v17, v89, v82
    v_fmac_f32 v18, v90, v82
    v_fmac_f32 v19, v91, v82
    v_fmac_f32 v20, v92, v82
    v_fmac_f32 v21, v93, v82
    v_fmac_f32 v22, v94, v82
    v_fmac_f32 v23, v95, v82
    s_waitcnt vmcnt(0)
    v_mov_b32 v160, 0x24218
    v_mov_b32 v161, 1
    s_mov_b64 exec, 1
    ds_add_u32 v160, v161
    s_mov_b64 exec, -1
    v_lshlrev_b32 v88, 16, v60
    v_and_b32 v89, 0xffff0000, v60
    v_lshlrev_b32 v90, 16, v61
    v_and_b32 v91, 0xffff0000, v61
    v_lshlrev_b32 v92, 16, v62
    v_and_b32 v93, 0xffff0000, v62
    v_lshlrev_b32 v94, 16, v63
    v_and_b32 v95, 0xffff0000, v63
    v_fmac_f32 v16, v88, v83
    v_fmac_f32 v17, v89, v83
    v_fmac_f32 v18, v90, v83
    v_fmac_f32 v19, v91, v83
    v_fmac_f32 v20, v92, v83
    v_fmac_f32 v21, v93, v83
    v_fmac_f32 v22, v94, v83
    v_fmac_f32 v23, v95, v83
    v_permlane32_swap_b32 v16, v20
    v_permlane32_swap_b32 v17, v21
    v_permlane32_swap_b32 v18, v22
    v_permlane32_swap_b32 v19, v23
    v_add_f32 v16, v16, v20
    v_add_f32 v17, v17, v21
    v_add_f32 v18, v18, v22
    v_add_f32 v19, v19, v23
    v_cvt_pk_bf16_f32 v44, v16, v17
    v_cvt_pk_bf16_f32 v45, v18, v19
    v_mov_b32 v160, 0x24218
    s_mov_b32 s80, 1600000
LW_219:
    ds_read_b32 v161, v160
    s_waitcnt lgkmcnt(0)
    v_readfirstlane_b32 s79, v161
    s_cmp_ge_u32 s79, 8
    s_cbranch_scc1 LWD_220
    s_sub_u32 s80, s80, 1
    s_cmp_lg_u32 s80, 0
    s_cbranch_scc1 LW_219
LWD_220:
    buffer_store_dwordx2 v[44:45], v8, s[36:39], 0 offen sc1
    s_cmp_lg_u32 s6, 0
    s_cbranch_scc1 BM2_221
    s_mov_b64 exec, 15
    buffer_store_dwordx4 v[36:39], v9, s[36:39], 0 offen sc1
    s_mov_b64 exec, -1
BM2_221:
    v_mov_b32 v160, 0x24218
    v_mov_b32 v161, 1
    s_mov_b64 exec, 1
    ds_add_u32 v160, v161
    s_mov_b64 exec, -1
    s_lshl_b32 s7, s67, 13
    s_lshl_b32 s63, s6, 10
    s_add_u32 s7, s7, s63
    s_add_u32 s7, s7, 0xc0000
    v_lshl_add_u32 v4, v1, 4, s7
    v_lshrrev_b32 v160, 2, v3
    v_mul_u32_u24 v5, 1088, v160
    v_and_b32 v160, 3, v1
    v_lshl_add_u32 v5, v160, 4, v5
    v_lshrrev_b32 v161, 5, v1
    v_lshl_add_u32 v5, v161, 6, v5
    v_and_b32 v161, 1, v2
    v_lshl_add_u32 v5, v161, 3, v5
    s_lshl_b32 s7, s6, 7
    s_add_u32 s7, s7, 0x26000
    v_add_u32 v5, s7, v5
    v_mul_u32_u24 v6, 1088, v160
    v_lshl_add_u32 v6, v2, 4, v6
    v_add_u32 v6, 0x26000, v6
    s_lshl_b32 s7, s68, 2
    s_add_u32 s7, s7, s6
    s_lshl_b32 s7, s7, 3
    s_add_u32 s7, s7, s67
    s_lshl_b32 s7, s7, 8
    s_add_u32 s7, s7, 0x2c0000
    v_lshl_add_u32 v7, v160, 6, s7
    v_lshl_add_u32 v7, v2, 4, v7
    v_cmp_gt_u32 s[84:85], 4, v3
    v_bfe_u32 v8, v1, 3, 2
    v_xor_b32 v8, s6, v8
    v_lshlrev_b32 v8, 5, v8
    v_lshrrev_b32 v161, 2, v1
    v_lshl_add_u32 v8, v161, 7, v8
    v_lshl_add_u32 v8, v160, 3, v8
    s_cmp_ge_u32 s6, 4
    s_cbranch_scc1 W4_222
    v_mov_b32 v162, 0x24000
    s_mov_b32 s80, 1600000
LW_223:
    ds_read_b32 v163, v162
    s_waitcnt lgkmcnt(0)
    v_readfirstlane_b32 s79, v163
    s_cmp_ge_u32 s79, 288
    s_cbranch_scc1 LWD_224
    s_sleep 1
    s_sub_u32 s80, s80, 1
    s_cmp_lg_u32 s80, 0
    s_cbranch_scc1 LW_223
LWD_224:
    ds_read_b64_tr_b16 v[48:49], v8 offset:0
    ds_read_b64_tr_b16 v[50:51], v8 offset:2048
    ds_read_b64_tr_b16 v[52:53], v8 offset:4096
    ds_read_b64_tr_b16 v[54:55], v8 offset:6144
    ds_read_b64_tr_b16 v[56:57], v8 offset:8192
    ds_read_b64_tr_b16 v[58:59], v8 offset:10240
    ds_read_b64_tr_b16 v[60:61], v8 offset:12288
    ds_read_b64_tr_b16 v[62:63], v8 offset:14336
    s_waitcnt lgkmcnt(4)
    ds_read_b64_tr_b16 v[64:65], v8 offset:16384
    ds_read_b64_tr_b16 v[66:67], v8 offset:18432
    ds_read_b64_tr_b16 v[68:69], v8 offset:20480
    ds_read_b64_tr_b16 v[70:71], v8 offset:22528
    ds_read_b64_tr_b16 v[72:73], v8 offset:24576
    ds_read_b64_tr_b16 v[74:75], v8 offset:26624
    ds_read_b64_tr_b16 v[76:77], v8 offset:28672
    ds_read_b64_tr_b16 v[78:79], v8 offset:30720
    s_waitcnt lgkmcnt(4)
    v_mov_b32 v162, 0x24000
    s_mov_b32 s80, 1600000
LW_225:
    ds_read_b32 v163, v162
    s_waitcnt lgkmcnt(0)
    v_readfirstlane_b32 s79, v163
    s_cmp_ge_u32 s79, 320
    s_cbranch_scc1 LWD_226
    s_sleep 1
    s_sub_u32 s80, s80, 1
    s_cmp_lg_u32 s80, 0
    s_cbranch_scc1 LW_225
LWD_226:
    ds_read_b64_tr_b16 v[80:81], v8 offset:32768
    ds_read_b64_tr_b16 v[82:83], v8 offset:34816
    ds_read_b64_tr_b16 v[84:85], v8 offset:36864
    ds_read_b64_tr_b16 v[86:87], v8 offset:38912
    ds_read_b64_tr_b16 v[88:89], v8 offset:40960
    ds_read_b64_tr_b16 v[90:91], v8 offset:43008
    ds_read_b64_tr_b16 v[92:93], v8 offset:45056
    ds_read_b64_tr_b16 v[94:95], v8 offset:47104
    s_waitcnt lgkmcnt(4)
    ds_read_b64_tr_b16 v[96:97], v8 offset:49152
    ds_read_b64_tr_b16 v[98:99], v8 offset:51200
    ds_read_b64_tr_b16 v[100:101], v8 offset:53248
    ds_read_b64_tr_b16 v[102:103], v8 offset:55296
    ds_read_b64_tr_b16 v[104:105], v8 offset:57344
    ds_read_b64_tr_b16 v[106:107], v8 offset:59392
    ds_read_b64_tr_b16 v[108:109], v8 offset:61440
    ds_read_b64_tr_b16 v[110:111], v8 offset:63488
    s_waitcnt lgkmcnt(4)
W4_222:
    s_mov_b64 exec, -1
    buffer_load_dwordx4 v[16:19], v4, s[36:39], 0 offen sc1 nt
    s_mov_b32 s80, 200000
MC_228:
    s_mov_b64 exec, -1
    s_waitcnt vmcnt(0)
    v_cmp_ne_u64 s[86:87], s[92:93], v[18:19]
    s_cmp_lg_u64 s[86:87], 0
    s_cbranch_scc1 M_227
MD_229:
    s_mov_b64 exec, -1
    ds_write_b64 v5, v[16:17]
    s_add_u32 s81, s81, 8
    v_mov_b32 v160, 0x2420c
    v_mov_b32 v161, 1
    s_mov_b64 exec, 1
    ds_add_u32 v160, v161
    s_mov_b64 exec, -1
    s_cmp_ge_u32 s6, 4
    s_cbranch_scc1 L_END
    v_mov_b32 v160, 0x2420c
    s_mov_b32 s80, 1600000
LW_230:
    ds_read_b32 v161, v160
    s_waitcnt lgkmcnt(0)
    v_readfirstlane_b32 s79, v161
    s_cmp_ge_u32 s79, s81
    s_cbranch_scc1 LWD_231
    s_sub_u32 s80, s80, 1
    s_cmp_lg_u32 s80, 0
    s_cbranch_scc1 LW_230
LWD_231:
    ds_read_b128 v[112:115], v6 offset:0
    ds_read_b128 v[116:119], v6 offset:64
    ds_read_b128 v[120:123], v6 offset:128
    ds_read_b128 v[124:127], v6 offset:192
    ds_read_b128 v[128:131], v6 offset:256
    ds_read_b128 v[132:135], v6 offset:320
    ds_read_b128 v[136:139], v6 offset:384
    ds_read_b128 v[140:143], v6 offset:448
    ds_read_b128 v[144:147], v6 offset:512
    ds_read_b128 v[148:151], v6 offset:576
    ds_read_b128 v[152:155], v6 offset:640
    ds_read_b128 v[156:159], v6 offset:704
    s_waitcnt lgkmcnt(8)
    ds_read_b128 v[20:23], v6 offset:768
    ds_read_b128 v[24:27], v6 offset:832
    ds_read_b128 v[28:31], v6 offset:896
    ds_read_b128 v[32:35], v6 offset:960
    v_mfma_f32_16x16x32_bf16 v[12:15], v[48:51], v[112:115], 0
    v_mfma_f32_16x16x32_bf16 v[12:15], v[52:55], v[116:119], v[12:15]
    v_mfma_f32_16x16x32_bf16 v[12:15], v[56:59], v[120:123], v[12:15]
    v_mfma_f32_16x16x32_bf16 v[12:15], v[60:63], v[124:127], v[12:15]
    s_waitcnt lgkmcnt(11)
    v_mfma_f32_16x16x32_bf16 v[12:15], v[64:67], v[128:131], v[12:15]
    s_waitcnt lgkmcnt(10)
    v_mfma_f32_16x16x32_bf16 v[12:15], v[68:71], v[132:135], v[12:15]
    s_waitcnt lgkmcnt(9)
    v_mfma_f32_16x16x32_bf16 v[12:15], v[72:75], v[136:139], v[12:15]
    s_waitcnt lgkmcnt(8)
    v_mfma_f32_16x16x32_bf16 v[12:15], v[76:79], v[140:143], v[12:15]
    s_waitcnt lgkmcnt(7)
    v_mfma_f32_16x16x32_bf16 v[12:15], v[80:83], v[144:147], v[12:15]
    s_waitcnt lgkmcnt(6)
    v_mfma_f32_16x16x32_bf16 v[12:15], v[84:87], v[148:151], v[12:15]
    s_waitcnt lgkmcnt(5)
    v_mfma_f32_16x16x32_bf16 v[12:15], v[88:91], v[152:155], v[12:15]
    s_waitcnt lgkmcnt(4)
    v_mfma_f32_16x16x32_bf16 v[12:15], v[92:95], v[156:159], v[12:15]
    s_waitcnt lgkmcnt(3)
    v_mfma_f32_16x16x32_bf16 v[12:15], v[96:99], v[20:23], v[12:15]
    s_waitcnt lgkmcnt(2)
    v_mfma_f32_16x16x32_bf16 v[12:15], v[100:103], v[24:27], v[12:15]
    s_waitcnt lgkmcnt(1)
    v_mfma_f32_16x16x32_bf16 v[12:15], v[104:107], v[28:31], v[12:15]
    s_waitcnt lgkmcnt(0)
    v_mfma_f32_16x16x32_bf16 v[12:15], v[108:111], v[32:35], v[12:15]
    s_nop 7
    v_cvt_pk_bf16_f32 v16, v12, v13
    v_cvt_pk_bf16_f32 v17, v14, v15
    s_mov_b64 exec, s[84:85]
    buffer_store_dwordx4 v[16:19], v7, s[36:39], 0 offen sc1
    s_mov_b64 exec, -1
    v_mov_b32 v160, 0x24214
    v_mov_b32 v161, 1
    s_mov_b64 exec, 1
    ds_add_u32 v160, v161
    s_mov_b64 exec, -1
    s_endpgm
SU_9:
    s_nop 3
    buffer_store_dwordx4 v[72:75], v4, s[36:39], 0 offen sc1
    s_branch SV_10
SU_13:
    s_nop 3
    buffer_store_dwordx4 v[64:67], v5, s[36:39], 0 offen sc1
    s_branch SV_14
ST_19:
    ds_read_b32 v18, v17
    s_waitcnt lgkmcnt(0)
    v_readlane_b32 s79, v18, s62
    s_cmp_ge_u32 s79, s63
    s_cbranch_scc1 GO_18
    s_waitcnt vmcnt(16)
    s_sub_u32 s7, s60, 16
    s_max_i32 s61, s61, s7
    v_mov_b32 v19, s61
    ds_write_b32 v16, v19
    ds_read_b32 v18, v17
    s_waitcnt lgkmcnt(0)
    v_readlane_b32 s79, v18, s62
    s_cmp_ge_u32 s79, s63
    s_cbranch_scc1 GO_18
    s_waitcnt vmcnt(8)
    s_sub_u32 s7, s60, 8
    s_max_i32 s61, s61, s7
    v_mov_b32 v19, s61
    ds_write_b32 v16, v19
    ds_read_b32 v18, v17
    s_waitcnt lgkmcnt(0)
    v_readlane_b32 s79, v18, s62
    s_cmp_ge_u32 s79, s63
    s_cbranch_scc1 GO_18
    s_waitcnt vmcnt(0)
    s_mov_b32 s61, s60
    v_mov_b32 v19, s61
    ds_write_b32 v16, v19
    ds_read_b32 v18, v17
    s_waitcnt lgkmcnt(0)
    v_readlane_b32 s79, v18, s62
    s_cmp_ge_u32 s79, s63
    s_cbranch_scc1 GO_18
    s_mov_b32 s80, 1600000
SP_232:
    ds_read_b32 v18, v17
    s_waitcnt lgkmcnt(0)
    v_readlane_b32 s79, v18, s62
    s_cmp_ge_u32 s79, s63
    s_cbranch_scc1 GO_18
    s_sub_u32 s80, s80, 1
    s_cmp_lg_u32 s80, 0
    s_cbranch_scc1 SP_232
    s_branch GO_18
ST_24:
    ds_read_b32 v18, v17
    s_waitcnt lgkmcnt(0)
    v_readlane_b32 s79, v18, s62
    s_cmp_ge_u32 s79, s63
    s_cbranch_scc1 GO_23
    s_waitcnt vmcnt(16)
    s_sub_u32 s7, s60, 16
    s_max_i32 s61, s61, s7
    v_mov_b32 v19, s61
    ds_write_b32 v16, v19
    ds_read_b32 v18, v17
    s_waitcnt lgkmcnt(0)
    v_readlane_b32 s79, v18, s62
    s_cmp_ge_u32 s79, s63
    s_cbranch_scc1 GO_23
    s_waitcnt vmcnt(8)
    s_sub_u32 s7, s60, 8
    s_max_i32 s61, s61, s7
    v_mov_b32 v19, s61
    ds_write_b32 v16, v19
    ds_read_b32 v18, v17
    s_waitcnt lgkmcnt(0)
    v_readlane_b32 s79, v18, s62
    s_cmp_ge_u32 s79, s63
    s_cbranch_scc1 GO_23
    s_waitcnt vmcnt(0)
    s_mov_b32 s61, s60
    v_mov_b32 v19, s61
    ds_write_b32 v16, v19
    ds_read_b32 v18, v17
    s_waitcnt lgkmcnt(0)
    v_readlane_b32 s79, v18, s62
    s_cmp_ge_u32 s79, s63
    s_cbranch_scc1 GO_23
    s_mov_b32 s80, 1600000
SP_233:
    ds_read_b32 v18, v17
    s_waitcnt lgkmcnt(0)
    v_readlane_b32 s79, v18, s62
    s_cmp_ge_u32 s79, s63
    s_cbranch_scc1 GO_23
    s_sub_u32 s80, s80, 1
    s_cmp_lg_u32 s80, 0
    s_cbranch_scc1 SP_233
    s_branch GO_23
ST_29:
    ds_read_b32 v18, v17
    s_waitcnt lgkmcnt(0)
    v_readlane_b32 s79, v18, s62
    s_cmp_ge_u32 s79, s63
    s_cbranch_scc1 GO_28
    s_waitcnt vmcnt(16)
    s_sub_u32 s7, s60, 16
    s_max_i32 s61, s61, s7
    v_mov_b32 v19, s61
    ds_write_b32 v16, v19
    ds_read_b32 v18, v17
    s_waitcnt lgkmcnt(0)
    v_readlane_b32 s79, v18, s62
    s_cmp_ge_u32 s79, s63
    s_cbranch_scc1 GO_28
    s_waitcnt vmcnt(8)
    s_sub_u32 s7, s60, 8
    s_max_i32 s61, s61, s7
    v_mov_b32 v19, s61
    ds_write_b32 v16, v19
    ds_read_b32 v18, v17
    s_waitcnt lgkmcnt(0)
    v_readlane_b32 s79, v18, s62
    s_cmp_ge_u32 s79, s63
    s_cbranch_scc1 GO_28
    s_waitcnt vmcnt(0)
    s_mov_b32 s61, s60
    v_mov_b32 v19, s61
    ds_write_b32 v16, v19
    ds_read_b32 v18, v17
    s_waitcnt lgkmcnt(0)
    v_readlane_b32 s79, v18, s62
    s_cmp_ge_u32 s79, s63
    s_cbranch_scc1 GO_28
    s_mov_b32 s80, 1600000
SP_234:
    ds_read_b32 v18, v17
    s_waitcnt lgkmcnt(0)
    v_readlane_b32 s79, v18, s62
    s_cmp_ge_u32 s79, s63
    s_cbranch_scc1 GO_28
    s_sub_u32 s80, s80, 1
    s_cmp_lg_u32 s80, 0
    s_cbranch_scc1 SP_234
    s_branch GO_28
ST_34:
    ds_read_b32 v18, v17
    s_waitcnt lgkmcnt(0)
    v_readlane_b32 s79, v18, s62
    s_cmp_ge_u32 s79, s63
    s_cbranch_scc1 GO_33
    s_waitcnt vmcnt(24)
    s_sub_u32 s7, s60, 24
    s_max_i32 s61, s61, s7
    v_mov_b32 v19, s61
    ds_write_b32 v16, v19
    ds_read_b32 v18, v17
    s_waitcnt lgkmcnt(0)
    v_readlane_b32 s79, v18, s62
    s_cmp_ge_u32 s79, s63
    s_cbranch_scc1 GO_33
    s_waitcnt vmcnt(16)
    s_sub_u32 s7, s60, 16
    s_max_i32 s61, s61, s7
    v_mov_b32 v19, s61
    ds_write_b32 v16, v19
    ds_read_b32 v18, v17
    s_waitcnt lgkmcnt(0)
    v_readlane_b32 s79, v18, s62
    s_cmp_ge_u32 s79, s63
    s_cbranch_scc1 GO_33
    s_waitcnt vmcnt(8)
    s_sub_u32 s7, s60, 8
    s_max_i32 s61, s61, s7
    v_mov_b32 v19, s61
    ds_write_b32 v16, v19
    ds_read_b32 v18, v17
    s_waitcnt lgkmcnt(0)
    v_readlane_b32 s79, v18, s62
    s_cmp_ge_u32 s79, s63
    s_cbranch_scc1 GO_33
    s_waitcnt vmcnt(0)
    s_mov_b32 s61, s60
    v_mov_b32 v19, s61
    ds_write_b32 v16, v19
    ds_read_b32 v18, v17
    s_waitcnt lgkmcnt(0)
    v_readlane_b32 s79, v18, s62
    s_cmp_ge_u32 s79, s63
    s_cbranch_scc1 GO_33
    s_mov_b32 s80, 1600000
SP_235:
    ds_read_b32 v18, v17
    s_waitcnt lgkmcnt(0)
    v_readlane_b32 s79, v18, s62
    s_cmp_ge_u32 s79, s63
    s_cbranch_scc1 GO_33
    s_sub_u32 s80, s80, 1
    s_cmp_lg_u32 s80, 0
    s_cbranch_scc1 SP_235
    s_branch GO_33
ST_39:
    ds_read_b32 v18, v17
    s_waitcnt lgkmcnt(0)
    v_readlane_b32 s79, v18, s62
    s_cmp_ge_u32 s79, s63
    s_cbranch_scc1 GO_38
    s_waitcnt vmcnt(32)
    s_sub_u32 s7, s60, 32
    s_max_i32 s61, s61, s7
    v_mov_b32 v19, s61
    ds_write_b32 v16, v19
    ds_read_b32 v18, v17
    s_waitcnt lgkmcnt(0)
    v_readlane_b32 s79, v18, s62
    s_cmp_ge_u32 s79, s63
    s_cbranch_scc1 GO_38
    s_waitcnt vmcnt(24)
    s_sub_u32 s7, s60, 24
    s_max_i32 s61, s61, s7
    v_mov_b32 v19, s61
    ds_write_b32 v16, v19
    ds_read_b32 v18, v17
    s_waitcnt lgkmcnt(0)
    v_readlane_b32 s79, v18, s62
    s_cmp_ge_u32 s79, s63
    s_cbranch_scc1 GO_38
    s_waitcnt vmcnt(16)
    s_sub_u32 s7, s60, 16
    s_max_i32 s61, s61, s7
    v_mov_b32 v19, s61
    ds_write_b32 v16, v19
    ds_read_b32 v18, v17
    s_waitcnt lgkmcnt(0)
    v_readlane_b32 s79, v18, s62
    s_cmp_ge_u32 s79, s63
    s_cbranch_scc1 GO_38
    s_waitcnt vmcnt(8)
    s_sub_u32 s7, s60, 8
    s_max_i32 s61, s61, s7
    v_mov_b32 v19, s61
    ds_write_b32 v16, v19
    ds_read_b32 v18, v17
    s_waitcnt lgkmcnt(0)
    v_readlane_b32 s79, v18, s62
    s_cmp_ge_u32 s79, s63
    s_cbranch_scc1 GO_38
    s_waitcnt vmcnt(0)
    s_mov_b32 s61, s60
    v_mov_b32 v19, s61
    ds_write_b32 v16, v19
    ds_read_b32 v18, v17
    s_waitcnt lgkmcnt(0)
    v_readlane_b32 s79, v18, s62
    s_cmp_ge_u32 s79, s63
    s_cbranch_scc1 GO_38
    s_mov_b32 s80, 1600000
SP_236:
    ds_read_b32 v18, v17
    s_waitcnt lgkmcnt(0)
    v_readlane_b32 s79, v18, s62
    s_cmp_ge_u32 s79, s63
    s_cbranch_scc1 GO_38
    s_sub_u32 s80, s80, 1
    s_cmp_lg_u32 s80, 0
    s_cbranch_scc1 SP_236
    s_branch GO_38
ST_44:
    ds_read_b32 v18, v17
    s_waitcnt lgkmcnt(0)
    v_readlane_b32 s79, v18, s62
    s_cmp_ge_u32 s79, s63
    s_cbranch_scc1 GO_43
    s_waitcnt vmcnt(32)
    s_sub_u32 s7, s60, 32
    s_max_i32 s61, s61, s7
    v_mov_b32 v19, s61
    ds_write_b32 v16, v19
    ds_read_b32 v18, v17
    s_waitcnt lgkmcnt(0)
    v_readlane_b32 s79, v18, s62
    s_cmp_ge_u32 s79, s63
    s_cbranch_scc1 GO_43
    s_waitcnt vmcnt(24)
    s_sub_u32 s7, s60, 24
    s_max_i32 s61, s61, s7
    v_mov_b32 v19, s61
    ds_write_b32 v16, v19
    ds_read_b32 v18, v17
    s_waitcnt lgkmcnt(0)
    v_readlane_b32 s79, v18, s62
    s_cmp_ge_u32 s79, s63
    s_cbranch_scc1 GO_43
    s_waitcnt vmcnt(16)
    s_sub_u32 s7, s60, 16
    s_max_i32 s61, s61, s7
    v_mov_b32 v19, s61
    ds_write_b32 v16, v19
    ds_read_b32 v18, v17
    s_waitcnt lgkmcnt(0)
    v_readlane_b32 s79, v18, s62
    s_cmp_ge_u32 s79, s63
    s_cbranch_scc1 GO_43
    s_waitcnt vmcnt(8)
    s_sub_u32 s7, s60, 8
    s_max_i32 s61, s61, s7
    v_mov_b32 v19, s61
    ds_write_b32 v16, v19
    ds_read_b32 v18, v17
    s_waitcnt lgkmcnt(0)
    v_readlane_b32 s79, v18, s62
    s_cmp_ge_u32 s79, s63
    s_cbranch_scc1 GO_43
    s_waitcnt vmcnt(0)
    s_mov_b32 s61, s60
    v_mov_b32 v19, s61
    ds_write_b32 v16, v19
    ds_read_b32 v18, v17
    s_waitcnt lgkmcnt(0)
    v_readlane_b32 s79, v18, s62
    s_cmp_ge_u32 s79, s63
    s_cbranch_scc1 GO_43
    s_mov_b32 s80, 1600000
SP_237:
    ds_read_b32 v18, v17
    s_waitcnt lgkmcnt(0)
    v_readlane_b32 s79, v18, s62
    s_cmp_ge_u32 s79, s63
    s_cbranch_scc1 GO_43
    s_sub_u32 s80, s80, 1
    s_cmp_lg_u32 s80, 0
    s_cbranch_scc1 SP_237
    s_branch GO_43
ST_46:
    ds_read_b32 v18, v17
    s_waitcnt lgkmcnt(0)
    v_readlane_b32 s79, v18, s62
    s_cmp_ge_u32 s79, s63
    s_cbranch_scc1 GO_45
    s_waitcnt vmcnt(32)
    s_sub_u32 s7, s60, 32
    s_max_i32 s61, s61, s7
    v_mov_b32 v19, s61
    ds_write_b32 v16, v19
    ds_read_b32 v18, v17
    s_waitcnt lgkmcnt(0)
    v_readlane_b32 s79, v18, s62
    s_cmp_ge_u32 s79, s63
    s_cbranch_scc1 GO_45
    s_waitcnt vmcnt(24)
    s_sub_u32 s7, s60, 24
    s_max_i32 s61, s61, s7
    v_mov_b32 v19, s61
    ds_write_b32 v16, v19
    ds_read_b32 v18, v17
    s_waitcnt lgkmcnt(0)
    v_readlane_b32 s79, v18, s62
    s_cmp_ge_u32 s79, s63
    s_cbranch_scc1 GO_45
    s_waitcnt vmcnt(16)
    s_sub_u32 s7, s60, 16
    s_max_i32 s61, s61, s7
    v_mov_b32 v19, s61
    ds_write_b32 v16, v19
    ds_read_b32 v18, v17
    s_waitcnt lgkmcnt(0)
    v_readlane_b32 s79, v18, s62
    s_cmp_ge_u32 s79, s63
    s_cbranch_scc1 GO_45
    s_waitcnt vmcnt(8)
    s_sub_u32 s7, s60, 8
    s_max_i32 s61, s61, s7
    v_mov_b32 v19, s61
    ds_write_b32 v16, v19
    ds_read_b32 v18, v17
    s_waitcnt lgkmcnt(0)
    v_readlane_b32 s79, v18, s62
    s_cmp_ge_u32 s79, s63
    s_cbranch_scc1 GO_45
    s_waitcnt vmcnt(0)
    s_mov_b32 s61, s60
    v_mov_b32 v19, s61
    ds_write_b32 v16, v19
    ds_read_b32 v18, v17
    s_waitcnt lgkmcnt(0)
    v_readlane_b32 s79, v18, s62
    s_cmp_ge_u32 s79, s63
    s_cbranch_scc1 GO_45
    s_mov_b32 s80, 1600000
SP_238:
    ds_read_b32 v18, v17
    s_waitcnt lgkmcnt(0)
    v_readlane_b32 s79, v18, s62
    s_cmp_ge_u32 s79, s63
    s_cbranch_scc1 GO_45
    s_sub_u32 s80, s80, 1
    s_cmp_lg_u32 s80, 0
    s_cbranch_scc1 SP_238
    s_branch GO_45
M_51:
    s_sub_u32 s80, s80, 1
    s_cmp_le_u32 s80, 0
    s_cbranch_scc1 MD_53
    s_mov_b64 exec, s[62:63]
    s_cbranch_execz RS_239
    buffer_load_dwordx4 v[48:51], v36, s[36:39], 0 offen offset:0 sc1
RS_239:
    s_mov_b64 exec, s[64:65]
    s_cbranch_execz RS_240
    buffer_load_dwordx4 v[52:55], v36, s[36:39], 0 offen offset:1024 sc1
RS_240:
    s_mov_b64 exec, s[66:67]
    s_cbranch_execz RS_241
    buffer_load_dwordx4 v[56:59], v36, s[36:39], 0 offen offset:2048 sc1
RS_241:
    s_mov_b64 exec, s[68:69]
    s_cbranch_execz RS_242
    buffer_load_dwordx4 v[60:63], v36, s[36:39], 0 offen offset:3072 sc1
RS_242:
    s_branch MC_52
ST_60:
    ds_read_b32 v18, v17
    s_waitcnt lgkmcnt(0)
    v_readlane_b32 s79, v18, s62
    s_cmp_ge_u32 s79, s63
    s_cbranch_scc1 GO_59
    s_waitcnt vmcnt(16)
    s_sub_u32 s7, s60, 16
    s_max_i32 s61, s61, s7
    v_mov_b32 v19, s61
    ds_write_b32 v16, v19
    ds_read_b32 v18, v17
    s_waitcnt lgkmcnt(0)
    v_readlane_b32 s79, v18, s62
    s_cmp_ge_u32 s79, s63
    s_cbranch_scc1 GO_59
    s_waitcnt vmcnt(8)
    s_sub_u32 s7, s60, 8
    s_max_i32 s61, s61, s7
    v_mov_b32 v19, s61
    ds_write_b32 v16, v19
    ds_read_b32 v18, v17
    s_waitcnt lgkmcnt(0)
    v_readlane_b32 s79, v18, s62
    s_cmp_ge_u32 s79, s63
    s_cbranch_scc1 GO_59
    s_waitcnt vmcnt(0)
    s_mov_b32 s61, s60
    v_mov_b32 v19, s61
    ds_write_b32 v16, v19
    ds_read_b32 v18, v17
    s_waitcnt lgkmcnt(0)
    v_readlane_b32 s79, v18, s62
    s_cmp_ge_u32 s79, s63
    s_cbranch_scc1 GO_59
    s_mov_b32 s80, 1600000
SP_243:
    ds_read_b32 v18, v17
    s_waitcnt lgkmcnt(0)
    v_readlane_b32 s79, v18, s62
    s_cmp_ge_u32 s79, s63
    s_cbranch_scc1 GO_59
    s_sub_u32 s80, s80, 1
    s_cmp_lg_u32 s80, 0
    s_cbranch_scc1 SP_243
    s_branch GO_59
ST_65:
    ds_read_b32 v18, v17
    s_waitcnt lgkmcnt(0)
    v_readlane_b32 s79, v18, s62
    s_cmp_ge_u32 s79, s63
    s_cbranch_scc1 GO_64
    s_waitcnt vmcnt(16)
    s_sub_u32 s7, s60, 16
    s_max_i32 s61, s61, s7
    v_mov_b32 v19, s61
    ds_write_b32 v16, v19
    ds_read_b32 v18, v17
    s_waitcnt lgkmcnt(0)
    v_readlane_b32 s79, v18, s62
    s_cmp_ge_u32 s79, s63
    s_cbranch_scc1 GO_64
    s_waitcnt vmcnt(8)
    s_sub_u32 s7, s60, 8
    s_max_i32 s61, s61, s7
    v_mov_b32 v19, s61
    ds_write_b32 v16, v19
    ds_read_b32 v18, v17
    s_waitcnt lgkmcnt(0)
    v_readlane_b32 s79, v18, s62
    s_cmp_ge_u32 s79, s63
    s_cbranch_scc1 GO_64
    s_waitcnt vmcnt(0)
    s_mov_b32 s61, s60
    v_mov_b32 v19, s61
    ds_write_b32 v16, v19
    ds_read_b32 v18, v17
    s_waitcnt lgkmcnt(0)
    v_readlane_b32 s79, v18, s62
    s_cmp_ge_u32 s79, s63
    s_cbranch_scc1 GO_64
    s_mov_b32 s80, 1600000
SP_244:
    ds_read_b32 v18, v17
    s_waitcnt lgkmcnt(0)
    v_readlane_b32 s79, v18, s62
    s_cmp_ge_u32 s79, s63
    s_cbranch_scc1 GO_64
    s_sub_u32 s80, s80, 1
    s_cmp_lg_u32 s80, 0
    s_cbranch_scc1 SP_244
    s_branch GO_64
ST_70:
    ds_read_b32 v18, v17
    s_waitcnt lgkmcnt(0)
    v_readlane_b32 s79, v18, s62
    s_cmp_ge_u32 s79, s63
    s_cbranch_scc1 GO_69
    s_waitcnt vmcnt(24)
    s_sub_u32 s7, s60, 24
    s_max_i32 s61, s61, s7
    v_mov_b32 v19, s61
    ds_write_b32 v16, v19
    ds_read_b32 v18, v17
    s_waitcnt lgkmcnt(0)
    v_readlane_b32 s79, v18, s62
    s_cmp_ge_u32 s79, s63
    s_cbranch_scc1 GO_69
    s_waitcnt vmcnt(16)
    s_sub_u32 s7, s60, 16
    s_max_i32 s61, s61, s7
    v_mov_b32 v19, s61
    ds_write_b32 v16, v19
    ds_read_b32 v18, v17
    s_waitcnt lgkmcnt(0)
    v_readlane_b32 s79, v18, s62
    s_cmp_ge_u32 s79, s63
    s_cbranch_scc1 GO_69
    s_waitcnt vmcnt(8)
    s_sub_u32 s7, s60, 8
    s_max_i32 s61, s61, s7
    v_mov_b32 v19, s61
    ds_write_b32 v16, v19
    ds_read_b32 v18, v17
    s_waitcnt lgkmcnt(0)
    v_readlane_b32 s79, v18, s62
    s_cmp_ge_u32 s79, s63
    s_cbranch_scc1 GO_69
    s_waitcnt vmcnt(0)
    s_mov_b32 s61, s60
    v_mov_b32 v19, s61
    ds_write_b32 v16, v19
    ds_read_b32 v18, v17
    s_waitcnt lgkmcnt(0)
    v_readlane_b32 s79, v18, s62
    s_cmp_ge_u32 s79, s63
    s_cbranch_scc1 GO_69
    s_mov_b32 s80, 1600000
SP_245:
    ds_read_b32 v18, v17
    s_waitcnt lgkmcnt(0)
    v_readlane_b32 s79, v18, s62
    s_cmp_ge_u32 s79, s63
    s_cbranch_scc1 GO_69
    s_sub_u32 s80, s80, 1
    s_cmp_lg_u32 s80, 0
    s_cbranch_scc1 SP_245
    s_branch GO_69
ST_75:
    ds_read_b32 v18, v17
    s_waitcnt lgkmcnt(0)
    v_readlane_b32 s79, v18, s62
    s_cmp_ge_u32 s79, s63
    s_cbranch_scc1 GO_74
    s_waitcnt vmcnt(32)
    s_sub_u32 s7, s60, 32
    s_max_i32 s61, s61, s7
    v_mov_b32 v19, s61
    ds_write_b32 v16, v19
    ds_read_b32 v18, v17
    s_waitcnt lgkmcnt(0)
    v_readlane_b32 s79, v18, s62
    s_cmp_ge_u32 s79, s63
    s_cbranch_scc1 GO_74
    s_waitcnt vmcnt(24)
    s_sub_u32 s7, s60, 24
    s_max_i32 s61, s61, s7
    v_mov_b32 v19, s61
    ds_write_b32 v16, v19
    ds_read_b32 v18, v17
    s_waitcnt lgkmcnt(0)
    v_readlane_b32 s79, v18, s62
    s_cmp_ge_u32 s79, s63
    s_cbranch_scc1 GO_74
    s_waitcnt vmcnt(16)
    s_sub_u32 s7, s60, 16
    s_max_i32 s61, s61, s7
    v_mov_b32 v19, s61
    ds_write_b32 v16, v19
    ds_read_b32 v18, v17
    s_waitcnt lgkmcnt(0)
    v_readlane_b32 s79, v18, s62
    s_cmp_ge_u32 s79, s63
    s_cbranch_scc1 GO_74
    s_waitcnt vmcnt(8)
    s_sub_u32 s7, s60, 8
    s_max_i32 s61, s61, s7
    v_mov_b32 v19, s61
    ds_write_b32 v16, v19
    ds_read_b32 v18, v17
    s_waitcnt lgkmcnt(0)
    v_readlane_b32 s79, v18, s62
    s_cmp_ge_u32 s79, s63
    s_cbranch_scc1 GO_74
    s_waitcnt vmcnt(0)
    s_mov_b32 s61, s60
    v_mov_b32 v19, s61
    ds_write_b32 v16, v19
    ds_read_b32 v18, v17
    s_waitcnt lgkmcnt(0)
    v_readlane_b32 s79, v18, s62
    s_cmp_ge_u32 s79, s63
    s_cbranch_scc1 GO_74
    s_mov_b32 s80, 1600000
SP_246:
    ds_read_b32 v18, v17
    s_waitcnt lgkmcnt(0)
    v_readlane_b32 s79, v18, s62
    s_cmp_ge_u32 s79, s63
    s_cbranch_scc1 GO_74
    s_sub_u32 s80, s80, 1
    s_cmp_lg_u32 s80, 0
    s_cbranch_scc1 SP_246
    s_branch GO_74
ST_83:
    ds_read_b32 v18, v17
    s_waitcnt lgkmcnt(0)
    v_readlane_b32 s79, v18, s62
    s_cmp_ge_u32 s79, s63
    s_cbranch_scc1 GO_82
    s_waitcnt vmcnt(16)
    s_sub_u32 s7, s60, 16
    s_max_i32 s61, s61, s7
    v_mov_b32 v19, s61
    ds_write_b32 v16, v19
    ds_read_b32 v18, v17
    s_waitcnt lgkmcnt(0)
    v_readlane_b32 s79, v18, s62
    s_cmp_ge_u32 s79, s63
    s_cbranch_scc1 GO_82
    s_waitcnt vmcnt(8)
    s_sub_u32 s7, s60, 8
    s_max_i32 s61, s61, s7
    v_mov_b32 v19, s61
    ds_write_b32 v16, v19
    ds_read_b32 v18, v17
    s_waitcnt lgkmcnt(0)
    v_readlane_b32 s79, v18, s62
    s_cmp_ge_u32 s79, s63
    s_cbranch_scc1 GO_82
    s_waitcnt vmcnt(0)
    s_mov_b32 s61, s60
    v_mov_b32 v19, s61
    ds_write_b32 v16, v19
    ds_read_b32 v18, v17
    s_waitcnt lgkmcnt(0)
    v_readlane_b32 s79, v18, s62
    s_cmp_ge_u32 s79, s63
    s_cbranch_scc1 GO_82
    s_mov_b32 s80, 1600000
SP_247:
    ds_read_b32 v18, v17
    s_waitcnt lgkmcnt(0)
    v_readlane_b32 s79, v18, s62
    s_cmp_ge_u32 s79, s63
    s_cbranch_scc1 GO_82
    s_sub_u32 s80, s80, 1
    s_cmp_lg_u32 s80, 0
    s_cbranch_scc1 SP_247
    s_branch GO_82
ST_86:
    ds_read_b32 v18, v17
    s_waitcnt lgkmcnt(0)
    v_readlane_b32 s79, v18, s62
    s_cmp_ge_u32 s79, s63
    s_cbranch_scc1 GO_85
    s_waitcnt vmcnt(24)
    s_sub_u32 s7, s60, 24
    s_max_i32 s61, s61, s7
    v_mov_b32 v19, s61
    ds_write_b32 v16, v19
    ds_read_b32 v18, v17
    s_waitcnt lgkmcnt(0)
    v_readlane_b32 s79, v18, s62
    s_cmp_ge_u32 s79, s63
    s_cbranch_scc1 GO_85
    s_waitcnt vmcnt(16)
    s_sub_u32 s7, s60, 16
    s_max_i32 s61, s61, s7
    v_mov_b32 v19, s61
    ds_write_b32 v16, v19
    ds_read_b32 v18, v17
    s_waitcnt lgkmcnt(0)
    v_readlane_b32 s79, v18, s62
    s_cmp_ge_u32 s79, s63
    s_cbranch_scc1 GO_85
    s_waitcnt vmcnt(8)
    s_sub_u32 s7, s60, 8
    s_max_i32 s61, s61, s7
    v_mov_b32 v19, s61
    ds_write_b32 v16, v19
    ds_read_b32 v18, v17
    s_waitcnt lgkmcnt(0)
    v_readlane_b32 s79, v18, s62
    s_cmp_ge_u32 s79, s63
    s_cbranch_scc1 GO_85
    s_waitcnt vmcnt(0)
    s_mov_b32 s61, s60
    v_mov_b32 v19, s61
    ds_write_b32 v16, v19
    ds_read_b32 v18, v17
    s_waitcnt lgkmcnt(0)
    v_readlane_b32 s79, v18, s62
    s_cmp_ge_u32 s79, s63
    s_cbranch_scc1 GO_85
    s_mov_b32 s80, 1600000
SP_248:
    ds_read_b32 v18, v17
    s_waitcnt lgkmcnt(0)
    v_readlane_b32 s79, v18, s62
    s_cmp_ge_u32 s79, s63
    s_cbranch_scc1 GO_85
    s_sub_u32 s80, s80, 1
    s_cmp_lg_u32 s80, 0
    s_cbranch_scc1 SP_248
    s_branch GO_85
ST_88:
    ds_read_b32 v18, v17
    s_waitcnt lgkmcnt(0)
    v_readlane_b32 s79, v18, 0
    s_cmp_ge_u32 s79, s63
    s_cbranch_scc1 GO_87
    s_waitcnt vmcnt(24)
    s_sub_u32 s7, s60, 24
    s_max_i32 s61, s61, s7
    v_mov_b32 v19, s61
    ds_write_b32 v16, v19
    ds_read_b32 v18, v17
    s_waitcnt lgkmcnt(0)
    v_readlane_b32 s79, v18, 0
    s_cmp_ge_u32 s79, s63
    s_cbranch_scc1 GO_87
    s_waitcnt vmcnt(16)
    s_sub_u32 s7, s60, 16
    s_max_i32 s61, s61, s7
    v_mov_b32 v19, s61
    ds_write_b32 v16, v19
    ds_read_b32 v18, v17
    s_waitcnt lgkmcnt(0)
    v_readlane_b32 s79, v18, 0
    s_cmp_ge_u32 s79, s63
    s_cbranch_scc1 GO_87
    s_waitcnt vmcnt(8)
    s_sub_u32 s7, s60, 8
    s_max_i32 s61, s61, s7
    v_mov_b32 v19, s61
    ds_write_b32 v16, v19
    ds_read_b32 v18, v17
    s_waitcnt lgkmcnt(0)
    v_readlane_b32 s79, v18, 0
    s_cmp_ge_u32 s79, s63
    s_cbranch_scc1 GO_87
    s_waitcnt vmcnt(0)
    s_mov_b32 s61, s60
    v_mov_b32 v19, s61
    ds_write_b32 v16, v19
    ds_read_b32 v18, v17
    s_waitcnt lgkmcnt(0)
    v_readlane_b32 s79, v18, 0
    s_cmp_ge_u32 s79, s63
    s_cbranch_scc1 GO_87
    s_mov_b32 s80, 1600000
SP_249:
    ds_read_b32 v18, v17
    s_waitcnt lgkmcnt(0)
    v_readlane_b32 s79, v18, 0
    s_cmp_ge_u32 s79, s63
    s_cbranch_scc1 GO_87
    s_sub_u32 s80, s80, 1
    s_cmp_lg_u32 s80, 0
    s_cbranch_scc1 SP_249
    s_branch GO_87
SU_96:
    s_nop 3
    buffer_store_dwordx4 v[40:43], v44, s[36:39], 0 offen sc1
    s_branch SV_97
M_103:
    s_sub_u32 s80, s80, 1
    s_cmp_le_u32 s80, 0
    s_cbranch_scc1 MD_105
    s_mov_b64 exec, s[62:63]
    s_cbranch_execz RS_250
    buffer_load_dwordx4 v[48:51], v36, s[36:39], 0 offen offset:0 sc1
RS_250:
    s_mov_b64 exec, s[64:65]
    s_cbranch_execz RS_251
    buffer_load_dwordx4 v[52:55], v36, s[36:39], 0 offen offset:1024 sc1
RS_251:
    s_branch MC_104
M_125:
    s_sleep 4
    s_sub_u32 s80, s80, 1
    s_cmp_le_u32 s80, 0
    s_cbranch_scc1 MD_127
    s_mov_b64 exec, s[44:45]
    s_cbranch_execz RS_252
    buffer_load_dwordx4 v[48:51], v7, s[36:39], 0 offen sc1 nt
RS_252:
    s_mov_b64 exec, s[46:47]
    s_cbranch_execz RS_253
    buffer_load_dwordx4 v[52:55], v22, s[36:39], 0 offen sc1 nt
RS_253:
    s_branch MC_126
SU_133:
    s_nop 3
    buffer_store_dwordx4 v[64:67], v8, s[36:39], 0 offen sc1
    s_branch SV_134
AW_137:
    s_mov_b64 exec, 0x3f
    s_cmp_eq_u32 s71, 1
    s_cbranch_scc1 AX_254
    buffer_load_dwordx4 v[116:119], v12, s[36:39], 0 offen sc1 nt
    s_mov_b64 exec, -1
    s_branch AWB_138
AX_254:
    s_mov_b32 s80, 200000
    s_branch PP_256
P_255:
    buffer_load_dwordx4 v[116:119], v12, s[36:39], 0 offen sc1 nt
PP_256:
    s_waitcnt vmcnt(0)
    v_cmp_ne_u64 s[90:91], s[92:93], v[118:119]
    s_cmp_lg_u64 s[90:91], 0
    s_cbranch_scc0 PD_257
    s_sleep 2
    s_sub_u32 s80, s80, 1
    s_cmp_lg_u32 s80, 0
    s_cbranch_scc1 P_255
PD_257:
    s_mov_b64 exec, -1
    v_mov_b32 v118, v116
    s_nop 1
    v_max_f32_dpp v118, v118, v118 row_ror:1 row_mask:0xf bank_mask:0xf
    s_nop 1
    v_max_f32_dpp v118, v118, v118 row_ror:2 row_mask:0xf bank_mask:0xf
    s_nop 1
    v_max_f32_dpp v118, v118, v118 row_ror:4 row_mask:0xf bank_mask:0xf
    s_nop 1
    v_max_f32_dpp v118, v118, v118 row_ror:8 row_mask:0xf bank_mask:0xf
    v_sub_f32 v116, v116, v118
    v_sub_f32 v119, v64, v118
    v_exp_f32 v116, v116
    v_exp_f32 v119, v119
    v_mul_f32 v116, v116, v117
    s_nop 1
    v_add_f32_dpp v116, v116, v116 row_ror:1 row_mask:0xf bank_mask:0xf
    s_nop 1
    v_add_f32_dpp v116, v116, v116 row_ror:2 row_mask:0xf bank_mask:0xf
    s_nop 1
    v_add_f32_dpp v116, v116, v116 row_ror:4 row_mask:0xf bank_mask:0xf
    s_nop 1
    v_add_f32_dpp v116, v116, v116 row_ror:8 row_mask:0xf bank_mask:0xf
    v_rcp_f32 v116, v116
    s_nop 0
    v_mul_f32 v116, v116, v119
    s_nop 0
    v_readfirstlane_b32 s72, v116
    s_branch AWB_138
SU_141:
    s_nop 3
    buffer_store_dwordx4 v[68:71], v6, s[36:39], 0 offen sc1
    s_branch SV_142
M_145:
    s_sub_u32 s80, s80, 1
    s_cmp_le_u32 s80, 0
    s_cbranch_scc1 MD_147
    s_mov_b64 exec, s[64:65]
    s_cbranch_execz RS_258
    buffer_load_dwordx4 v[112:115], v5, s[36:39], 0 offen sc1 nt
RS_258:
    s_mov_b64 exec, s[66:67]
    s_cbranch_execz RS_259
    buffer_load_dwordx4 v[116:119], v5, s[36:39], s62 offen sc1 nt
RS_259:
    s_mov_b64 exec, s[68:69]
    s_cbranch_execz RS_260
    buffer_load_dwordx4 v[120:123], v5, s[36:39], s63 offen sc1 nt
RS_260:
    s_branch MC_146
M_155:
    s_sub_u32 s80, s80, 1
    s_cmp_le_u32 s80, 199994
    s_cbranch_scc1 G2_152
    s_mov_b64 exec, s[44:45]
    s_cbranch_execz RS_261
    buffer_load_dwordx4 v[48:51], v7, s[36:39], 0 offen sc1 nt
RS_261:
    s_mov_b64 exec, s[46:47]
    s_cbranch_execz RS_262
    buffer_load_dwordx4 v[52:55], v22, s[36:39], 0 offen sc1 nt
RS_262:
    s_branch MC_156
G2_152:
    s_mov_b64 exec, -1
    v_mov_b32 v12, 0x24204
    s_mov_b32 s80, 1600000
LW_263:
    ds_read_b32 v13, v12
    s_waitcnt lgkmcnt(0)
    v_readfirstlane_b32 s79, v13
    s_cmp_ge_u32 s79, 1
    s_cbranch_scc1 LWD_264
    s_sleep 1
    s_sub_u32 s80, s80, 1
    s_cmp_lg_u32 s80, 0
    s_cbranch_scc1 LW_263
LWD_264:
    v_mov_b32 v12, 0x24248
    ds_read_b64 v[14:15], v12
    s_waitcnt lgkmcnt(0)
    v_readfirstlane_b32 s92, v14
    v_readfirstlane_b32 s93, v15
    s_mov_b32 s80, 200000
P_265:
    buffer_load_dwordx4 v[48:51], v7, s[36:39], 0 offen sc1 nt
    buffer_load_dwordx4 v[52:55], v22, s[36:39], 0 offen sc1 nt
PP_266:
    s_waitcnt vmcnt(0)
    s_mov_b64 s[90:91], 0
    v_cmp_gt_u64 s[88:89], s[94:95], v[50:51]
    v_cmp_le_u64 vcc, s[72:73], v[50:51]
    s_or_b64 s[88:89], s[88:89], vcc
    v_cmp_ne_u64 vcc, s[92:93], v[50:51]
    s_and_b64 vcc, vcc, s[88:89]
    s_or_b64 s[90:91], s[90:91], vcc
    v_cmp_gt_u64 s[88:89], s[94:95], v[54:55]
    v_cmp_le_u64 vcc, s[72:73], v[54:55]
    s_or_b64 s[88:89], s[88:89], vcc
    v_cmp_ne_u64 vcc, s[92:93], v[54:55]
    s_and_b64 vcc, vcc, s[88:89]
    s_or_b64 s[90:91], s[90:91], vcc
    s_cbranch_scc0 PD_267
    s_sleep 1
    s_sub_u32 s80, s80, 1
    s_cmp_lg_u32 s80, 0
    s_cbranch_scc1 P_265
PD_267:
    s_branch MD_157
M_172:
    s_sleep 6
    s_sub_u32 s80, s80, 1
    s_cmp_le_u32 s80, 0
    s_cbranch_scc1 MD_174
    s_mov_b64 exec, s[64:65]
    s_cbranch_execz RS_268
    buffer_load_dwordx2 v[12:13], v9, s[36:39], 0 offen sc1 nt
RS_268:
    s_branch MC_173
M_175:
    s_sleep 2
    s_sub_u32 s80, s80, 1
    s_cmp_le_u32 s80, 0
    s_cbranch_scc1 MD_177
    s_mov_b64 exec, s[64:65]
    s_cbranch_execz RS_269
    buffer_load_dwordx2 v[12:13], v9, s[36:39], 0 offen sc1
RS_269:
    s_branch MC_176
M_178:
    s_sub_u32 s80, s80, 1
    s_cmp_le_u32 s80, 0
    s_cbranch_scc1 MD_180
    s_mov_b64 exec, s[64:65]
    s_cbranch_execz RS_270
    buffer_load_dwordx4 v[16:19], v5, s[36:39], 0 offen offset:0 sc1
RS_270:
    s_mov_b64 exec, s[66:67]
    s_cbranch_execz RS_271
    buffer_load_dwordx4 v[20:23], v5, s[36:39], 0 offen offset:1024 sc1
RS_271:
    s_mov_b64 exec, s[68:69]
    s_cbranch_execz RS_272
    buffer_load_dwordx4 v[12:15], v4, s[36:39], 0 offen sc1
RS_272:
    s_branch MC_179
SU_183:
    s_nop 3
    buffer_store_dwordx4 v[16:19], v10, s[36:39], 0 offen sc1
    s_branch SV_184
M_189:
    s_sleep 2
    s_sub_u32 s80, s80, 1
    s_cmp_le_u32 s80, 0
    s_cbranch_scc1 MD_191
    s_mov_b64 exec, s[44:45]
    s_cbranch_execz RS_273
    buffer_load_dwordx2 v[16:17], v144, s[36:39], 0 offen sc1
RS_273:
    s_branch MC_190
M_197:
    s_sleep 1
    s_sub_u32 s80, s80, 1
    s_cmp_le_u32 s80, 0
    s_cbranch_scc1 MD_199
    s_mov_b64 exec, s[44:45]
    s_cbranch_execz RS_274
    buffer_load_dwordx4 v[128:131], v145, s[36:39], 0 offen offset:0 sc1
RS_274:
    s_mov_b64 exec, s[46:47]
    s_cbranch_execz RS_275
    buffer_load_dwordx4 v[132:135], v145, s[36:39], 0 offen offset:1024 sc1
RS_275:
    s_mov_b64 exec, s[48:49]
    s_cbranch_execz RS_276
    buffer_load_dwordx4 v[136:139], v145, s[36:39], 0 offen offset:2048 sc1
RS_276:
    s_mov_b64 exec, s[50:51]
    s_cbranch_execz RS_277
    buffer_load_dwordx4 v[140:143], v145, s[36:39], 0 offen offset:3072 sc1
RS_277:
    s_branch MC_198
SU_212:
    s_nop 3
    buffer_store_dwordx4 v[16:19], v5, s[36:39], 0 offen offset:0 sc1
    buffer_store_dwordx4 v[20:23], v5, s[36:39], 0 offen offset:1024 sc1
    buffer_store_dwordx4 v[24:27], v5, s[36:39], 0 offen offset:2048 sc1
    buffer_store_dwordx4 v[28:31], v5, s[36:39], 0 offen offset:3072 sc1
    s_waitcnt vmcnt(0)
    s_mov_b64 exec, s[88:89]
    buffer_store_dwordx2 v[38:39], v7, s[36:39], 0 offen sc1
    s_mov_b64 exec, -1
    s_branch SV_213
M_214:
    s_sub_u32 s80, s80, 1
    s_cmp_le_u32 s80, 0
    s_cbranch_scc1 MD_216
    s_mov_b64 exec, s[86:87]
    s_cbranch_execz RS_278
    buffer_load_dwordx2 v[40:41], v7, s[36:39], 0 offen sc1 nt
RS_278:
    s_branch MC_215
BL_217:
    s_mov_b32 s80, 200000
P_279:
    buffer_load_dwordx4 v[64:67], v6, s[36:39], 0 offen offset:0 sc1 nt
    buffer_load_dwordx4 v[68:71], v6, s[36:39], 0 offen offset:1024 sc1 nt
    buffer_load_dwordx4 v[72:75], v6, s[36:39], 0 offen offset:2048 sc1 nt
    buffer_load_dwordx4 v[76:79], v6, s[36:39], 0 offen offset:3072 sc1 nt
PP_280:
    s_waitcnt vmcnt(0)
    v_cmp_ne_u64 s[90:91], s[92:93], v[66:67]
    v_cmp_ne_u64 vcc, s[92:93], v[70:71]
    s_or_b64 s[90:91], s[90:91], vcc
    v_cmp_ne_u64 vcc, s[92:93], v[74:75]
    s_or_b64 s[90:91], s[90:91], vcc
    v_cmp_ne_u64 vcc, s[92:93], v[78:79]
    s_or_b64 s[90:91], s[90:91], vcc
    s_cmp_lg_u64 s[90:91], 0
    s_cbranch_scc0 PD_281
    s_sub_u32 s80, s80, 1
    s_cmp_lg_u32 s80, 0
    s_cbranch_scc1 P_279
PD_281:
    s_branch BLD_218
M_227:
    s_sleep 1
    s_sub_u32 s80, s80, 1
    s_cmp_le_u32 s80, 0
    s_cbranch_scc1 MD_229
    s_mov_b64 exec, s[86:87]
    s_cbranch_execz RS_282
    buffer_load_dwordx4 v[16:19], v4, s[36:39], 0 offen sc1 nt
RS_282:
    s_branch MC_228
L_END:
    s_endpgm
.section .rodata,"a"
.p2align 6
.amdhsa_kernel concat_heads__sliding_block_cached__compressed_kv_cla__decode_kernel
  .amdhsa_next_free_vgpr 168
  .amdhsa_next_free_sgpr 102
  .amdhsa_accum_offset 168
  .amdhsa_group_segment_fixed_size 0
  .amdhsa_kernarg_size 112
  .amdhsa_user_sgpr_count 2
  .amdhsa_user_sgpr_kernarg_segment_ptr 1
  .amdhsa_system_sgpr_workgroup_id_x 1
  .amdhsa_float_denorm_mode_32 3
.end_amdhsa_kernel
```

```asm
; @launch grid=(256,1,1) block=(576,1,1) lds=163840
.amdgcn_target "amdgcn-amd-amdhsa--gfx950"
.text
.globl concat_heads__sliding_block_cached__compressed_kv_cla__decode_kernel
.p2align 8
.type concat_heads__sliding_block_cached__compressed_kv_cla__decode_kernel,@function
concat_heads__sliding_block_cached__compressed_kv_cla__decode_kernel:
    s_cmp_ge_u32 s2, 256
    s_cbranch_scc1 L_END
    s_load_dwordx16 s[8:23], s[0:1], 0
    s_load_dwordx8 s[24:31], s[0:1], 64
    s_load_dwordx4 s[32:35], s[0:1], 96
    s_memrealtime s[94:95]
    v_lshrrev_b32 v1, 6, v0
    s_nop 0
    v_readfirstlane_b32 s3, v1
    v_and_b32 v1, 63, v0
    v_lshrrev_b32 v2, 4, v1
    v_and_b32 v3, 15, v1
    s_and_b32 s4, s2, 7
    s_lshr_b32 s7, s2, 6
    s_lshl_b32 s7, s7, 3
    s_or_b32 s4, s4, s7
    s_bfe_u32 s5, s2, 0x30003
    s_getreg_b32 s78, hwreg(HW_REG_XCC_ID, 0, 4)
    s_lshl_b32 s78, s78, 26
    s_xor_b32 s6, s3, 4
    s_cmp_eq_u32 s3, 8
    s_cselect_b32 s7, 8, 0
    s_add_u32 s7, s7, s5
    s_cmp_ge_u32 s7, 14
    s_cbranch_scc1 L_LDB
    s_cmp_ge_u32 s7, 12
    s_cbranch_scc1 L_LDE
    s_cmp_ge_u32 s7, 8
    s_cbranch_scc1 L_LDA
    s_mov_b32 s81, 0
    s_cmp_lt_u32 s6, 4
    s_cbranch_scc1 L_SIDE
    s_cmp_ge_u32 s7, 4
    s_cbranch_scc1 L_QABS
    s_and_b32 s61, s6, 3
    v_lshrrev_b32 v10, 1, v3
    v_xor_b32 v10, v10, v2
    v_lshlrev_b32 v10, 5, v10
    v_lshl_add_u32 v10, v2, 13, v10
    v_and_b32 v40, 1, v1
    v_lshl_add_u32 v10, v40, 4, v10
    v_xor_b32 v11, 0x80, v10
    s_lshl_b32 s65, s5, 20
    s_lshl_b32 s7, s4, 8
    s_add_u32 s65, s65, s7
    s_lshl_b32 s7, s61, 18
    s_add_u32 s65, s65, s7
    s_lshl_b32 s64, s61, 13
    s_add_u32 s64, s64, 0x1c000
    v_and_b32 v8, 3, v1
    v_lshlrev_b32 v9, 10, v8
    v_lshl_add_u32 v9, v2, 4, v9
    s_lshl_b32 s62, s5, 8
    s_waitcnt lgkmcnt(0)
    s_mov_b32 s48, s22
    s_and_b32 s49, s23, 0xffff
    s_mov_b32 s50, 0x400000
    s_mov_b32 s51, 0x20000
    s_mov_b32 s63, s65
    s_mov_b32 m0, s64
    s_add_u32 s64, s64, 1024
    buffer_load_dwordx4 v10, s[48:51], s63 offen nt lds
    s_add_u32 s63, s63, 32768
    s_mov_b32 m0, s64
    s_add_u32 s64, s64, 1024
    buffer_load_dwordx4 v11, s[48:51], s63 offen nt lds
    s_add_u32 s63, s63, 32768
    s_mov_b32 m0, s64
    s_add_u32 s64, s64, 1024
    buffer_load_dwordx4 v10, s[48:51], s63 offen nt lds
    s_add_u32 s63, s63, 32768
    s_mov_b32 m0, s64
    s_add_u32 s64, s64, 1024
    buffer_load_dwordx4 v11, s[48:51], s63 offen nt lds
    s_add_u32 s63, s63, 32768
    s_mov_b32 m0, s64
    s_add_u32 s64, s64, 1024
    buffer_load_dwordx4 v10, s[48:51], s63 offen nt lds
    s_add_u32 s63, s63, 32768
    s_mov_b32 m0, s64
    s_add_u32 s64, s64, 1024
    buffer_load_dwordx4 v11, s[48:51], s63 offen nt lds
    s_add_u32 s63, s63, 32768
    s_mov_b32 m0, s64
    s_add_u32 s64, s64, 1024
    buffer_load_dwordx4 v10, s[48:51], s63 offen nt lds
    s_add_u32 s63, s63, 32768
    s_mov_b32 m0, s64
    s_add_u32 s64, s64, 1024
    buffer_load_dwordx4 v11, s[48:51], s63 offen nt lds
    s_add_u32 s63, s63, 32768
    s_mov_b32 s44, s18
    s_and_b32 s45, s19, 0xffff
    s_mov_b32 s46, 0x1000
    s_mov_b32 s47, 0x20000
    buffer_load_dwordx4 v[128:131], v9, s[44:47], s62 offen offset:0
    buffer_load_dwordx4 v[132:135], v9, s[44:47], s62 offen offset:64
    buffer_load_dwordx4 v[136:139], v9, s[44:47], s62 offen offset:128
    buffer_load_dwordx4 v[140:143], v9, s[44:47], s62 offen offset:192
    s_barrier
    s_mov_b32 s36, s34
    s_and_b32 s37, s35, 0xffff
    s_mov_b32 s38, 0x1000000
    s_mov_b32 s39, 0x20000
    s_lshl_b32 s7, s4, 4
    s_add_u32 s7, s7, s5
    s_lshl_b32 s7, s7, 4
    s_add_u32 s7, s7, s61
    s_lshl_b32 s7, s7, 7
    s_add_u32 s7, s7, 0x100000
    v_lshl_add_u32 v4, v8, 9, s7
    v_lshl_add_u32 v4, v2, 4, v4
    v_and_b32 v12, 4, v1
    v_lshl_add_u32 v4, v12, 4, v4
    v_add_u32 v5, 16384, v4
    v_mov_b32 v16, 0
    s_mov_b64 exec, 15
    buffer_store_dword v16, v5, s[36:39], 0 offen
    buffer_load_dword v16, v5, s[36:39], 0 offen sc1 nt
    s_mov_b64 exec, -1
    s_sub_u32 s64, s64, 40960
    v_cmp_gt_u32 s[84:85], 8, v3
    v_bfe_u32 v21, v1, 2, 2
    v_lshl_add_u32 v20, v2, 3, v21
    s_lshl_b32 s7, s61, 1
    v_xor_b32 v21, s7, v21
    v_lshlrev_b32 v20, 8, v20
    v_lshl_add_u32 v20, v21, 5, v20
    v_lshl_add_u32 v20, v8, 3, v20
    v_add_u32 v20, 0x14000, v20
    v_xor_b32 v21, 32, v20
    v_xor_b32 v22, 0x480, v20
    v_xor_b32 v23, 0x4a0, v20
    s_waitcnt vmcnt(2)
    v_mov_b32 v14, 0x24210
    v_mov_b32 v15, 1
    s_mov_b64 exec, 1
    ds_add_u32 v14, v15
    s_mov_b64 exec, -1
    v_mov_b32 v14, 0x24210
    s_mov_b32 s80, 1600000
LW_1:
    ds_read_b32 v15, v14
    s_waitcnt lgkmcnt(0)
    v_readfirstlane_b32 s79, v15
    s_cmp_ge_u32 s79, 4
    s_cbranch_scc1 LWD_2
    s_sub_u32 s80, s80, 1
    s_cmp_lg_u32 s80, 0
    s_cbranch_scc1 LW_1
LWD_2:
    ds_read_b64_tr_b16 v[32:33], v20 offset:32768
    ds_read_b64_tr_b16 v[34:35], v22 offset:32768
    ds_read_b64_tr_b16 v[36:37], v21 offset:32768
    ds_read_b64_tr_b16 v[38:39], v23 offset:32768
    ds_read_b64_tr_b16 v[40:41], v20 offset:40960
    ds_read_b64_tr_b16 v[42:43], v22 offset:40960
    ds_read_b64_tr_b16 v[44:45], v21 offset:40960
    ds_read_b64_tr_b16 v[46:47], v23 offset:40960
    ds_read_b64_tr_b16 v[48:49], v20 offset:49152
    ds_read_b64_tr_b16 v[50:51], v22 offset:49152
    ds_read_b64_tr_b16 v[52:53], v21 offset:49152
    ds_read_b64_tr_b16 v[54:55], v23 offset:49152
    s_waitcnt lgkmcnt(8)
    ds_read_b64_tr_b16 v[56:57], v20 offset:57344
    ds_read_b64_tr_b16 v[58:59], v22 offset:57344
    ds_read_b64_tr_b16 v[60:61], v21 offset:57344
    ds_read_b64_tr_b16 v[62:63], v23 offset:57344
    s_waitcnt lgkmcnt(12)
    v_mfma_f32_16x16x32_bf16 v[24:27], v[32:35], v[128:131], 0
    v_mfma_f32_16x16x32_bf16 v[28:31], v[36:39], v[128:131], 0
    s_waitcnt lgkmcnt(8)
    v_mfma_f32_16x16x32_bf16 v[24:27], v[40:43], v[132:135], v[24:27]
    v_mfma_f32_16x16x32_bf16 v[28:31], v[44:47], v[132:135], v[28:31]
    s_waitcnt lgkmcnt(4)
    v_mfma_f32_16x16x32_bf16 v[24:27], v[48:51], v[136:139], v[24:27]
    v_mfma_f32_16x16x32_bf16 v[28:31], v[52:55], v[136:139], v[28:31]
    s_waitcnt lgkmcnt(0)
    v_mfma_f32_16x16x32_bf16 v[24:27], v[56:59], v[140:143], v[24:27]
    v_mfma_f32_16x16x32_bf16 v[28:31], v[60:63], v[140:143], v[28:31]
    s_memrealtime s[88:89]
    v_lshlrev_b32 v14, 2, v1
    v_add_u32 v14, 0x24138, v14
    v_mov_b32 v15, 1
    s_mov_b64 exec, 15
    ds_add_u32 v14, v15
    s_mov_b64 exec, -1
    v_cvt_pk_bf16_f32 v64, v24, v25
    v_cvt_pk_bf16_f32 v65, v26, v27
    v_cvt_pk_bf16_f32 v68, v28, v29
    v_cvt_pk_bf16_f32 v69, v30, v31
    s_nop 0
    v_mov_b32_dpp v64, v68 quad_perm:[0,1,2,3] row_mask:0xf bank_mask:0x2
    v_mov_b32_dpp v65, v69 quad_perm:[0,1,2,3] row_mask:0xf bank_mask:0x2
    s_waitcnt lgkmcnt(0)
    s_or_b32 s89, s89, s78
    v_mov_b32 v66, s88
    v_mov_b32 v67, s89
    s_mov_b64 exec, s[84:85]
    buffer_store_dwordx4 v[64:67], v5, s[36:39], 0 offen
    s_mov_b64 exec, -1
    v_mov_b32 v14, 0x24210
    v_mov_b32 v15, 1
    s_mov_b64 exec, 1
    ds_add_u32 v14, v15
    s_mov_b64 exec, -1
    s_mov_b32 s48, s14
    s_and_b32 s49, s15, 0xffff
    s_mov_b32 s50, 0x400000
    s_mov_b32 s51, 0x20000
    s_mov_b32 s63, s65
    s_mov_b32 m0, s64
    s_add_u32 s64, s64, 1024
    buffer_load_dwordx4 v10, s[48:51], s63 offen nt lds
    s_add_u32 s63, s63, 32768
    s_mov_b32 m0, s64
    s_add_u32 s64, s64, 1024
    buffer_load_dwordx4 v11, s[48:51], s63 offen nt lds
    s_add_u32 s63, s63, 32768
    s_mov_b32 m0, s64
    s_add_u32 s64, s64, 1024
    buffer_load_dwordx4 v10, s[48:51], s63 offen nt lds
    s_add_u32 s63, s63, 32768
    s_mov_b32 m0, s64
    s_add_u32 s64, s64, 1024
    buffer_load_dwordx4 v11, s[48:51], s63 offen nt lds
    s_add_u32 s63, s63, 32768
    s_mov_b32 m0, s64
    s_add_u32 s64, s64, 1024
    buffer_load_dwordx4 v10, s[48:51], s63 offen nt lds
    s_add_u32 s63, s63, 32768
    s_mov_b32 m0, s64
    s_add_u32 s64, s64, 1024
    buffer_load_dwordx4 v11, s[48:51], s63 offen nt lds
    s_add_u32 s63, s63, 32768
    s_mov_b32 m0, s64
    s_add_u32 s64, s64, 1024
    buffer_load_dwordx4 v10, s[48:51], s63 offen nt lds
    s_add_u32 s63, s63, 32768
    s_mov_b32 m0, s64
    s_add_u32 s64, s64, 1024
    buffer_load_dwordx4 v11, s[48:51], s63 offen nt lds
    s_add_u32 s63, s63, 32768
    s_mov_b32 s44, s8
    s_and_b32 s45, s9, 0xffff
    s_mov_b32 s46, 0x1000
    s_mov_b32 s47, 0x20000
    buffer_load_dwordx4 v[144:147], v9, s[44:47], s62 offen offset:0
    buffer_load_dwordx4 v[148:151], v9, s[44:47], s62 offen offset:64
    buffer_load_dwordx4 v[152:155], v9, s[44:47], s62 offen offset:128
    buffer_load_dwordx4 v[156:159], v9, s[44:47], s62 offen offset:192
    s_waitcnt vmcnt(0)
    v_mov_b32 v14, 0x24210
    v_mov_b32 v15, 1
    s_mov_b64 exec, 1
    ds_add_u32 v14, v15
    s_mov_b64 exec, -1
    v_mov_b32 v14, 0x24210
    s_mov_b32 s80, 1600000
LW_3:
    ds_read_b32 v15, v14
    s_waitcnt lgkmcnt(0)
    v_readfirstlane_b32 s79, v15
    s_cmp_ge_u32 s79, 12
    s_cbranch_scc1 LWD_4
    s_sub_u32 s80, s80, 1
    s_cmp_lg_u32 s80, 0
    s_cbranch_scc1 LW_3
LWD_4:
    ds_read_b64_tr_b16 v[32:33], v20 offset:0
    ds_read_b64_tr_b16 v[34:35], v22 offset:0
    ds_read_b64_tr_b16 v[36:37], v21 offset:0
    ds_read_b64_tr_b16 v[38:39], v23 offset:0
    ds_read_b64_tr_b16 v[40:41], v20 offset:8192
    ds_read_b64_tr_b16 v[42:43], v22 offset:8192
    ds_read_b64_tr_b16 v[44:45], v21 offset:8192
    ds_read_b64_tr_b16 v[46:47], v23 offset:8192
    ds_read_b64_tr_b16 v[48:49], v20 offset:16384
    ds_read_b64_tr_b16 v[50:51], v22 offset:16384
    ds_read_b64_tr_b16 v[52:53], v21 offset:16384
    ds_read_b64_tr_b16 v[54:55], v23 offset:16384
    s_waitcnt lgkmcnt(8)
    ds_read_b64_tr_b16 v[56:57], v20 offset:24576
    ds_read_b64_tr_b16 v[58:59], v22 offset:24576
    ds_read_b64_tr_b16 v[60:61], v21 offset:24576
    ds_read_b64_tr_b16 v[62:63], v23 offset:24576
    s_waitcnt lgkmcnt(12)
    v_mfma_f32_16x16x32_bf16 v[24:27], v[32:35], v[144:147], 0
    v_mfma_f32_16x16x32_bf16 v[28:31], v[36:39], v[144:147], 0
    s_waitcnt lgkmcnt(8)
    v_mfma_f32_16x16x32_bf16 v[24:27], v[40:43], v[148:151], v[24:27]
    v_mfma_f32_16x16x32_bf16 v[28:31], v[44:47], v[148:151], v[28:31]
    s_waitcnt lgkmcnt(4)
    v_mfma_f32_16x16x32_bf16 v[24:27], v[48:51], v[152:155], v[24:27]
    v_mfma_f32_16x16x32_bf16 v[28:31], v[52:55], v[152:155], v[28:31]
    s_waitcnt lgkmcnt(0)
    v_mfma_f32_16x16x32_bf16 v[24:27], v[56:59], v[156:159], v[24:27]
    v_mfma_f32_16x16x32_bf16 v[28:31], v[60:63], v[156:159], v[28:31]
    v_lshlrev_b32 v14, 2, v1
    v_add_u32 v14, 0x24128, v14
    v_mov_b32 v15, 1
    s_mov_b64 exec, 15
    ds_add_u32 v14, v15
    s_mov_b64 exec, -1
    s_nop 0
    v_cvt_pk_bf16_f32 v72, v24, v25
    v_cvt_pk_bf16_f32 v73, v26, v27
    v_cvt_pk_bf16_f32 v76, v28, v29
    v_cvt_pk_bf16_f32 v77, v30, v31
    s_nop 0
    v_mov_b32_dpp v72, v76 quad_perm:[0,1,2,3] row_mask:0xf bank_mask:0x2
    v_mov_b32_dpp v73, v77 quad_perm:[0,1,2,3] row_mask:0xf bank_mask:0x2
    v_mov_b32 v10, 0x24200
    s_mov_b32 s80, 1600000
LW_5:
    ds_read_b32 v11, v10
    s_waitcnt lgkmcnt(0)
    v_readfirstlane_b32 s79, v11
    s_cmp_ge_u32 s79, 16
    s_cbranch_scc1 LWD_6
    s_sleep 1
    s_sub_u32 s80, s80, 1
    s_cmp_lg_u32 s80, 0
    s_cbranch_scc1 LW_5
LWD_6:
    s_and_b32 s101, s79, 15
    v_mov_b32 v12, 0x24204
    s_mov_b32 s80, 1600000
LW_7:
    ds_read_b32 v13, v12
    s_waitcnt lgkmcnt(0)
    v_readfirstlane_b32 s79, v13
    s_cmp_ge_u32 s79, 1
    s_cbranch_scc1 LWD_8
    s_sleep 1
    s_sub_u32 s80, s80, 1
    s_cmp_lg_u32 s80, 0
    s_cbranch_scc1 LW_7
LWD_8:
    v_mov_b32 v12, 0x24248
    ds_read_b64 v[14:15], v12
    s_waitcnt lgkmcnt(0)
    v_readfirstlane_b32 s92, v14
    v_readfirstlane_b32 s93, v15
    s_nop 0
    v_mov_b32 v66, s92
    v_mov_b32 v67, s93
    v_mov_b32 v74, s92
    v_mov_b32 v75, s93
    s_mov_b64 exec, s[84:85]
    s_cmp_eq_u32 s101, 0
    s_cbranch_scc1 SU_9
    buffer_store_dwordx4 v[72:75], v4, s[36:39], 0 offen
SV_10:
    s_mov_b64 exec, -1
    v_mov_b32 v14, 0x24210
    v_mov_b32 v15, 1
    s_mov_b64 exec, 1
    ds_add_u32 v14, v15
    s_mov_b64 exec, -1
    v_mov_b32 v14, 0x24000
    s_mov_b32 s80, 1600000
LW_11:
    ds_read_b32 v15, v14
    s_waitcnt lgkmcnt(0)
    v_readfirstlane_b32 s79, v15
    s_cmp_ge_u32 s79, 128
    s_cbranch_scc1 LWD_12
    s_sleep 16
    s_sub_u32 s80, s80, 1
    s_cmp_lg_u32 s80, 0
    s_cbranch_scc1 LW_11
LWD_12:
    s_mov_b64 exec, s[84:85]
    s_cmp_eq_u32 s101, 0
    s_cbranch_scc1 SU_13
    buffer_store_dwordx4 v[64:67], v5, s[36:39], 0 offen
SV_14:
    s_mov_b64 exec, -1
    s_branch L_ASVC
L_LDA:
    s_setprio 3
    v_lshrrev_b32 v20, 1, v3
    v_and_b32 v40, 1, v2
    v_xor_b32 v20, v20, v40
    v_lshlrev_b32 v20, 5, v20
    v_lshl_add_u32 v20, v2, 10, v20
    v_and_b32 v40, 1, v1
    v_lshl_add_u32 v20, v40, 4, v20
    v_xor_b32 v21, 0x40, v20
    v_xor_b32 v22, 0x80, v20
    v_xor_b32 v23, 0xc0, v20
    s_lshl_b32 s65, s4, 17
    s_lshl_b32 s7, s5, 8
    s_add_u32 s65, s65, s7
    s_mov_b32 s67, s65
    s_mov_b32 s64, 0
    s_mov_b32 s96, 0x6010600
    s_mov_b32 s97, 0x6030602
    s_cmp_eq_u32 s5, 1
    s_cselect_b32 s96, 0x6190618, s96
    s_cselect_b32 s97, 0x61b061a, s97
    s_cmp_eq_u32 s5, 2
    s_cselect_b32 s96, 0x6310630, s96
    s_cselect_b32 s97, 0x6330632, s97
    s_cmp_eq_u32 s5, 3
    s_cselect_b32 s96, 0x6490648, s96
    s_cselect_b32 s97, 0x64b064a, s97
    s_cmp_eq_u32 s5, 4
    s_cselect_b32 s96, 0x4610460, s96
    s_cselect_b32 s97, 0x4630462, s97
    s_cmp_eq_u32 s5, 5
    s_cselect_b32 s96, 0x4710470, s96
    s_cselect_b32 s97, 0x4730472, s97
    v_xor_b32 v10, v3, v2
    v_lshlrev_b32 v10, 4, v10
    v_lshl_add_u32 v10, v2, 8, v10
    v_xor_b32 v11, 0x40, v10
    v_xor_b32 v12, 0x80, v10
    v_xor_b32 v13, 0xc0, v10
    v_lshrrev_b32 v14, 1, v3
    v_xor_b32 v14, v14, v2
    v_lshlrev_b32 v14, 5, v14
    v_lshl_add_u32 v14, v2, 8, v14
    v_and_b32 v40, 1, v1
    v_lshl_add_u32 v14, v40, 4, v14
    v_xor_b32 v15, 0x80, v14
    s_mov_b32 s76, 0
    s_lshl_b32 s7, s76, 4
    s_lshr_b64 s[90:91], s[96:97], s7
    s_and_b32 s68, s90, 3
    s_bfe_u32 s72, s90, 0x50002
    s_lshl_b32 s68, s68, 5
    s_add_u32 s68, s68, s4
    s_lshl_b32 s68, s68, 20
    s_lshl_b32 s72, s72, 13
    s_add_u32 s72, s72, s68
    s_add_u32 s72, s72, 0xC0000
    s_mov_b32 s76, 1
    s_lshl_b32 s7, s76, 4
    s_lshr_b64 s[90:91], s[96:97], s7
    s_and_b32 s69, s90, 3
    s_bfe_u32 s73, s90, 0x50002
    s_lshl_b32 s69, s69, 5
    s_add_u32 s69, s69, s4
    s_lshl_b32 s69, s69, 20
    s_lshl_b32 s73, s73, 13
    s_add_u32 s73, s73, s69
    s_add_u32 s73, s73, 0xC0000
    s_mov_b32 s76, 2
    s_lshl_b32 s7, s76, 4
    s_lshr_b64 s[90:91], s[96:97], s7
    s_and_b32 s70, s90, 3
    s_bfe_u32 s74, s90, 0x50002
    s_lshl_b32 s70, s70, 5
    s_add_u32 s70, s70, s4
    s_lshl_b32 s70, s70, 20
    s_lshl_b32 s74, s74, 13
    s_add_u32 s74, s74, s70
    s_add_u32 s74, s74, 0xC0000
    s_mov_b32 s76, 3
    s_lshl_b32 s7, s76, 4
    s_lshr_b64 s[90:91], s[96:97], s7
    s_and_b32 s71, s90, 3
    s_bfe_u32 s75, s90, 0x50002
    s_lshl_b32 s71, s71, 5
    s_add_u32 s71, s71, s4
    s_lshl_b32 s71, s71, 20
    s_lshl_b32 s75, s75, 13
    s_add_u32 s75, s75, s71
    s_add_u32 s75, s75, 0xC0000
    s_waitcnt lgkmcnt(0)
    s_mov_b32 s56, s16
    s_and_b32 s57, s17, 0xffff
    s_mov_b32 s58, 0x400000
    s_mov_b32 s59, 0x20000
    s_barrier
    s_mov_b32 s61, 0
    s_mov_b32 s63, 0
    v_lshlrev_b32 v16, 2, v1
    v_add_u32 v17, 0x24100, v16
    v_add_u32 v16, 0x24000, v16
    v_mov_b32 v18, 0
    s_mov_b32 s60, 0
    s_mov_b32 s36, s34
    s_and_b32 s37, s35, 0xffff
    s_mov_b32 s38, 0x1000000
    s_mov_b32 s39, 0x20000
    v_mov_b32 v40, 0x24210
    s_mov_b32 s80, 1600000
LW_15:
    ds_read_b32 v41, v40
    s_waitcnt lgkmcnt(0)
    v_readfirstlane_b32 s79, v41
    s_cmp_ge_u32 s79, 8
    s_cbranch_scc1 LWD_16
    s_sub_u32 s80, s80, 1
    s_cmp_lg_u32 s80, 0
    s_cbranch_scc1 LW_15
LWD_16:
    s_mov_b32 s62, 0
    s_mov_b32 s44, s10
    s_and_b32 s45, s11, 0xffff
    s_mov_b32 s46, 0x8000000
    s_mov_b32 s47, 0x20000
    s_mov_b32 s48, s12
    s_and_b32 s49, s13, 0xffff
    s_mov_b32 s50, 0x8000000
    s_mov_b32 s51, 0x20000
    s_mov_b32 s68, s72
    s_mov_b32 s69, s73
    s_mov_b32 s70, s74
    s_mov_b32 s71, s75
    s_mov_b32 s66, 4
LL_17:
    s_waitcnt lgkmcnt(0)
    v_readlane_b32 s79, v18, s62
    s_cmp_lt_u32 s79, s63
    s_cbranch_scc1 ST_19
GO_18:
    s_waitcnt vmcnt(27)
    s_add_u32 s7, s64, 0
    s_mov_b32 m0, s7
    s_add_u32 s65, s68, 0
    buffer_load_dwordx4 v10, s[44:47], s65 offen offset:0 nt lds
    s_waitcnt vmcnt(27)
    buffer_load_dwordx4 v11, s[44:47], s65 offen offset:1024 nt lds
    s_waitcnt vmcnt(27)
    buffer_load_dwordx4 v12, s[44:47], s65 offen offset:2048 nt lds
    s_waitcnt vmcnt(27)
    s_sub_u32 s7, s60, 24
    s_max_i32 s61, s61, s7
    v_mov_b32 v19, s61
    ds_write_b32 v16, v19
    buffer_load_dwordx4 v13, s[44:47], s65 offen offset:3072 nt lds
    s_waitcnt vmcnt(27)
    s_add_u32 s7, s64, 4096
    s_mov_b32 m0, s7
    s_add_u32 s65, s68, 4096
    buffer_load_dwordx4 v10, s[44:47], s65 offen offset:0 nt lds
    s_waitcnt vmcnt(27)
    buffer_load_dwordx4 v11, s[44:47], s65 offen offset:1024 nt lds
    ds_read_b32 v18, v17
    s_waitcnt vmcnt(27)
    buffer_load_dwordx4 v12, s[44:47], s65 offen offset:2048 nt lds
    s_waitcnt vmcnt(27)
    buffer_load_dwordx4 v13, s[44:47], s65 offen offset:3072 nt lds
    s_add_u32 s60, s60, 8
TJ_21:
    s_add_u32 s65, s65, 4096
    s_mov_b32 s68, s69
    s_mov_b32 s69, s70
    s_mov_b32 s70, s71
    s_mov_b32 s71, s65
    s_add_u32 s62, s62, 1
    s_add_u32 s64, s64, 8192
    s_cmp_eq_u32 s62, 10
    s_cselect_b32 s7, 4, 0
    s_add_u32 s63, s63, s7
    s_cmp_eq_u32 s62, 18
    s_cselect_b32 s62, 0, s62
    s_cselect_b32 s64, 0, s64
    s_sub_u32 s66, s66, 1
    s_cmp_lg_u32 s66, 0
    s_cbranch_scc1 LL_17
    v_mov_b32 v40, 0x24204
    s_mov_b32 s80, 1600000
LW_22:
    ds_read_b32 v41, v40
    s_waitcnt lgkmcnt(0)
    v_readfirstlane_b32 s79, v41
    s_cmp_ge_u32 s79, 1
    s_cbranch_scc1 LWD_23
    s_sleep 1
    s_sub_u32 s80, s80, 1
    s_cmp_lg_u32 s80, 0
    s_cbranch_scc1 LW_22
LWD_23:
    v_mov_b32 v40, 0x24248
    ds_read_b64 v[42:43], v40
    s_waitcnt lgkmcnt(0)
    v_readfirstlane_b32 s92, v42
    v_readfirstlane_b32 s93, v43
    s_add_u32 s77, s92, 12096
    s_memrealtime s[84:85]
    s_mov_b32 s66, 20
LL_24:
    s_waitcnt lgkmcnt(0)
    v_readlane_b32 s79, v18, s62
    s_cmp_lt_u32 s79, s63
    s_cbranch_scc1 ST_26
GO_25:
    s_waitcnt lgkmcnt(0)
    s_lshl_b32 s7, s84, 5
    s_sub_u32 s7, s7, s77
    s_add_u32 s77, s77, 1024
    s_cmp_lt_i32 s7, -640
    s_cbranch_scc1 WS_27
    s_cmp_gt_i32 s7, 2240
    s_cbranch_scc1 WB_28
    s_waitcnt vmcnt(23)
    s_add_u32 s7, s64, 0
    s_mov_b32 m0, s7
    s_add_u32 s65, s68, 0
    buffer_load_dwordx4 v10, s[44:47], s65 offen offset:0 nt lds
    s_waitcnt vmcnt(23)
    buffer_load_dwordx4 v11, s[44:47], s65 offen offset:1024 nt lds
    s_waitcnt vmcnt(23)
    buffer_load_dwordx4 v12, s[44:47], s65 offen offset:2048 nt lds
    s_waitcnt vmcnt(23)
    buffer_load_dwordx4 v13, s[44:47], s65 offen offset:3072 nt lds
    s_waitcnt vmcnt(23)
    s_add_u32 s7, s64, 4096
    s_mov_b32 m0, s7
    s_add_u32 s65, s68, 4096
    buffer_load_dwordx4 v10, s[44:47], s65 offen offset:0 nt lds
    s_waitcnt vmcnt(23)
    buffer_load_dwordx4 v11, s[44:47], s65 offen offset:1024 nt lds
    s_memrealtime s[84:85]
    ds_read_b32 v18, v17
    s_waitcnt vmcnt(23)
    buffer_load_dwordx4 v12, s[44:47], s65 offen offset:2048 nt lds
    s_waitcnt vmcnt(23)
    s_sub_u32 s7, s60, 16
    s_max_i32 s61, s61, s7
    v_mov_b32 v19, s61
    ds_write_b32 v16, v19
    buffer_load_dwordx4 v13, s[44:47], s65 offen offset:3072 nt lds
    s_add_u32 s60, s60, 8
    s_branch WJ_29
WS_27:
    s_waitcnt vmcnt(15)
    s_add_u32 s7, s64, 0
    s_mov_b32 m0, s7
    s_add_u32 s65, s68, 0
    buffer_load_dwordx4 v10, s[44:47], s65 offen offset:0 nt lds
    s_waitcnt vmcnt(15)
    buffer_load_dwordx4 v11, s[44:47], s65 offen offset:1024 nt lds
    s_waitcnt vmcnt(15)
    buffer_load_dwordx4 v12, s[44:47], s65 offen offset:2048 nt lds
    s_waitcnt vmcnt(15)
    buffer_load_dwordx4 v13, s[44:47], s65 offen offset:3072 nt lds
    s_waitcnt vmcnt(15)
    s_add_u32 s7, s64, 4096
    s_mov_b32 m0, s7
    s_add_u32 s65, s68, 4096
    buffer_load_dwordx4 v10, s[44:47], s65 offen offset:0 nt lds
    s_waitcnt vmcnt(15)
    buffer_load_dwordx4 v11, s[44:47], s65 offen offset:1024 nt lds
    s_memrealtime s[84:85]
    ds_read_b32 v18, v17
    s_waitcnt vmcnt(15)
    buffer_load_dwordx4 v12, s[44:47], s65 offen offset:2048 nt lds
    s_waitcnt vmcnt(15)
    s_sub_u32 s7, s60, 8
    s_max_i32 s61, s61, s7
    v_mov_b32 v19, s61
    ds_write_b32 v16, v19
    buffer_load_dwordx4 v13, s[44:47], s65 offen offset:3072 nt lds
    s_add_u32 s60, s60, 8
    s_branch WJ_29
WB_28:
    s_waitcnt vmcnt(31)
    s_add_u32 s7, s64, 0
    s_mov_b32 m0, s7
    s_add_u32 s65, s68, 0
    buffer_load_dwordx4 v10, s[44:47], s65 offen offset:0 nt lds
    s_waitcnt vmcnt(31)
    buffer_load_dwordx4 v11, s[44:47], s65 offen offset:1024 nt lds
    s_waitcnt vmcnt(31)
    buffer_load_dwordx4 v12, s[44:47], s65 offen offset:2048 nt lds
    s_waitcnt vmcnt(31)
    buffer_load_dwordx4 v13, s[44:47], s65 offen offset:3072 nt lds
    s_waitcnt vmcnt(31)
    s_add_u32 s7, s64, 4096
    s_mov_b32 m0, s7
    s_add_u32 s65, s68, 4096
    buffer_load_dwordx4 v10, s[44:47], s65 offen offset:0 nt lds
    s_waitcnt vmcnt(31)
    buffer_load_dwordx4 v11, s[44:47], s65 offen offset:1024 nt lds
    s_memrealtime s[84:85]
    ds_read_b32 v18, v17
    s_waitcnt vmcnt(31)
    buffer_load_dwordx4 v12, s[44:47], s65 offen offset:2048 nt lds
    s_waitcnt vmcnt(31)
    s_sub_u32 s7, s60, 24
    s_max_i32 s61, s61, s7
    v_mov_b32 v19, s61
    ds_write_b32 v16, v19
    buffer_load_dwordx4 v13, s[44:47], s65 offen offset:3072 nt lds
    s_add_u32 s60, s60, 8
WJ_29:
    s_add_u32 s65, s65, 4096
    s_mov_b32 s68, s69
    s_mov_b32 s69, s70
    s_mov_b32 s70, s71
    s_mov_b32 s71, s65
    s_add_u32 s62, s62, 1
    s_add_u32 s64, s64, 8192
    s_cmp_eq_u32 s62, 10
    s_cselect_b32 s7, 4, 0
    s_add_u32 s63, s63, s7
    s_cmp_eq_u32 s62, 18
    s_cselect_b32 s62, 0, s62
    s_cselect_b32 s64, 0, s64
    s_sub_u32 s66, s66, 1
    s_cmp_lg_u32 s66, 0
    s_cbranch_scc1 LL_24
    s_mov_b32 s68, s72
    s_mov_b32 s69, s73
    s_mov_b32 s70, s74
    s_mov_b32 s71, s75
    s_memrealtime s[84:85]
    s_mov_b32 s66, 24
LL_30:
    s_waitcnt lgkmcnt(0)
    v_readlane_b32 s79, v18, s62
    s_cmp_lt_u32 s79, s63
    s_cbranch_scc1 ST_32
GO_31:
    s_waitcnt lgkmcnt(0)
    s_lshl_b32 s7, s84, 5
    s_sub_u32 s7, s7, s77
    s_add_u32 s77, s77, 768
    s_cmp_lt_i32 s7, -640
    s_cbranch_scc1 WS_33
    s_cmp_gt_i32 s7, 2240
    s_cbranch_scc1 WB_34
    s_waitcnt vmcnt(29)
    s_add_u32 s7, s64, 0
    s_mov_b32 m0, s7
    s_add_u32 s65, s68, 0
    buffer_load_dwordx4 v14, s[48:51], s65 offen offset:0 nt lds
    s_waitcnt vmcnt(29)
    buffer_load_dwordx4 v15, s[48:51], s65 offen offset:1024 nt lds
    s_waitcnt vmcnt(29)
    buffer_load_dwordx4 v14, s[48:51], s65 offen offset:2048 nt lds
    s_waitcnt vmcnt(29)
    buffer_load_dwordx4 v15, s[48:51], s65 offen offset:3072 nt lds
    s_waitcnt vmcnt(29)
    s_add_u32 s7, s64, 4096
    s_mov_b32 m0, s7
    s_add_u32 s65, s68, 4096
    buffer_load_dwordx4 v14, s[48:51], s65 offen offset:0 nt lds
    s_waitcnt vmcnt(29)
    s_sub_u32 s7, s60, 24
    s_max_i32 s61, s61, s7
    v_mov_b32 v19, s61
    ds_write_b32 v16, v19
    buffer_load_dwordx4 v15, s[48:51], s65 offen offset:1024 nt lds
    s_memrealtime s[84:85]
    ds_read_b32 v18, v17
    s_waitcnt vmcnt(29)
    buffer_load_dwordx4 v14, s[48:51], s65 offen offset:2048 nt lds
    s_waitcnt vmcnt(29)
    buffer_load_dwordx4 v15, s[48:51], s65 offen offset:3072 nt lds
    s_add_u32 s60, s60, 8
    s_branch WJ_35
WS_33:
    s_waitcnt vmcnt(19)
    s_add_u32 s7, s64, 0
    s_mov_b32 m0, s7
    s_add_u32 s65, s68, 0
    buffer_load_dwordx4 v14, s[48:51], s65 offen offset:0 nt lds
    s_waitcnt vmcnt(19)
    buffer_load_dwordx4 v15, s[48:51], s65 offen offset:1024 nt lds
    s_waitcnt vmcnt(19)
    buffer_load_dwordx4 v14, s[48:51], s65 offen offset:2048 nt lds
    s_waitcnt vmcnt(19)
    s_sub_u32 s7, s60, 16
    s_max_i32 s61, s61, s7
    v_mov_b32 v19, s61
    ds_write_b32 v16, v19
    buffer_load_dwordx4 v15, s[48:51], s65 offen offset:3072 nt lds
    s_waitcnt vmcnt(19)
    s_add_u32 s7, s64, 4096
    s_mov_b32 m0, s7
    s_add_u32 s65, s68, 4096
    buffer_load_dwordx4 v14, s[48:51], s65 offen offset:0 nt lds
    s_waitcnt vmcnt(19)
    buffer_load_dwordx4 v15, s[48:51], s65 offen offset:1024 nt lds
    s_memrealtime s[84:85]
    ds_read_b32 v18, v17
    s_waitcnt vmcnt(19)
    buffer_load_dwordx4 v14, s[48:51], s65 offen offset:2048 nt lds
    s_waitcnt vmcnt(19)
    buffer_load_dwordx4 v15, s[48:51], s65 offen offset:3072 nt lds
    s_add_u32 s60, s60, 8
    s_branch WJ_35
WB_34:
    s_waitcnt vmcnt(43)
    s_add_u32 s7, s64, 0
    s_mov_b32 m0, s7
    s_add_u32 s65, s68, 0
    buffer_load_dwordx4 v14, s[48:51], s65 offen offset:0 nt lds
    s_waitcnt vmcnt(43)
    buffer_load_dwordx4 v15, s[48:51], s65 offen offset:1024 nt lds
    s_waitcnt vmcnt(43)
    buffer_load_dwordx4 v14, s[48:51], s65 offen offset:2048 nt lds
    s_waitcnt vmcnt(43)
    s_sub_u32 s7, s60, 40
    s_max_i32 s61, s61, s7
    v_mov_b32 v19, s61
    ds_write_b32 v16, v19
    buffer_load_dwordx4 v15, s[48:51], s65 offen offset:3072 nt lds
    s_waitcnt vmcnt(43)
    s_add_u32 s7, s64, 4096
    s_mov_b32 m0, s7
    s_add_u32 s65, s68, 4096
    buffer_load_dwordx4 v14, s[48:51], s65 offen offset:0 nt lds
    s_waitcnt vmcnt(43)
    buffer_load_dwordx4 v15, s[48:51], s65 offen offset:1024 nt lds
    s_memrealtime s[84:85]
    ds_read_b32 v18, v17
    s_waitcnt vmcnt(43)
    buffer_load_dwordx4 v14, s[48:51], s65 offen offset:2048 nt lds
    s_waitcnt vmcnt(43)
    buffer_load_dwordx4 v15, s[48:51], s65 offen offset:3072 nt lds
    s_add_u32 s60, s60, 8
WJ_35:
    s_add_u32 s65, s65, 4096
    s_mov_b32 s68, s69
    s_mov_b32 s69, s70
    s_mov_b32 s70, s71
    s_mov_b32 s71, s65
    s_add_u32 s62, s62, 1
    s_add_u32 s64, s64, 8192
    s_cmp_eq_u32 s62, 10
    s_cselect_b32 s7, 4, 0
    s_add_u32 s63, s63, s7
    s_cmp_eq_u32 s62, 18
    s_cselect_b32 s62, 0, s62
    s_cselect_b32 s64, 0, s64
    s_sub_u32 s66, s66, 1
    s_cmp_lg_u32 s66, 0
    s_cbranch_scc1 LL_30
    s_mov_b32 s65, s67
    s_mov_b32 s66, 2
LL_36:
    s_waitcnt lgkmcnt(0)
    v_readlane_b32 s79, v18, s62
    s_cmp_lt_u32 s79, s63
    s_cbranch_scc1 ST_38
GO_37:
    s_waitcnt vmcnt(43)
    s_mov_b32 m0, s64
    s_add_u32 s64, s64, 1024
    buffer_load_dwordx4 v20, s[56:59], s65 offen nt lds
    s_add_u32 s65, s65, 4096
    s_waitcnt vmcnt(43)
    s_mov_b32 m0, s64
    s_add_u32 s64, s64, 1024
    buffer_load_dwordx4 v20, s[56:59], s65 offen nt lds
    s_add_u32 s65, s65, 4096
    s_waitcnt vmcnt(43)
    s_mov_b32 m0, s64
    s_add_u32 s64, s64, 1024
    buffer_load_dwordx4 v20, s[56:59], s65 offen nt lds
    s_add_u32 s65, s65, 4096
    s_waitcnt vmcnt(43)
    s_sub_u32 s7, s60, 40
    s_max_i32 s61, s61, s7
    v_mov_b32 v19, s61
    ds_write_b32 v16, v19
    s_mov_b32 m0, s64
    s_add_u32 s64, s64, 1024
    buffer_load_dwordx4 v20, s[56:59], s65 offen nt lds
    s_add_u32 s65, s65, 4096
    s_waitcnt vmcnt(43)
    s_mov_b32 m0, s64
    s_add_u32 s64, s64, 1024
    buffer_load_dwordx4 v21, s[56:59], s65 offen nt lds
    s_add_u32 s65, s65, 4096
    s_waitcnt vmcnt(43)
    s_mov_b32 m0, s64
    s_add_u32 s64, s64, 1024
    buffer_load_dwordx4 v21, s[56:59], s65 offen nt lds
    s_add_u32 s65, s65, 4096
    ds_read_b32 v18, v17
    s_waitcnt vmcnt(43)
    s_mov_b32 m0, s64
    s_add_u32 s64, s64, 1024
    buffer_load_dwordx4 v21, s[56:59], s65 offen nt lds
    s_add_u32 s65, s65, 4096
    s_waitcnt vmcnt(43)
    s_mov_b32 m0, s64
    s_add_u32 s64, s64, 1024
    buffer_load_dwordx4 v21, s[56:59], s65 offen nt lds
    s_add_u32 s65, s65, 4096
    s_add_u32 s60, s60, 8
    s_add_u32 s62, s62, 1
    s_cmp_eq_u32 s62, 10
    s_cselect_b32 s7, 4, 0
    s_add_u32 s63, s63, s7
    s_cmp_eq_u32 s62, 18
    s_cselect_b32 s62, 0, s62
    s_cselect_b32 s64, 0, s64
    s_waitcnt lgkmcnt(0)
    v_readlane_b32 s79, v18, s62
    s_cmp_lt_u32 s79, s63
    s_cbranch_scc1 ST_40
GO_39:
    s_waitcnt vmcnt(43)
    s_mov_b32 m0, s64
    s_add_u32 s64, s64, 1024
    buffer_load_dwordx4 v22, s[56:59], s65 offen nt lds
    s_add_u32 s65, s65, 4096
    s_waitcnt vmcnt(43)
    s_mov_b32 m0, s64
    s_add_u32 s64, s64, 1024
    buffer_load_dwordx4 v22, s[56:59], s65 offen nt lds
    s_add_u32 s65, s65, 4096
    s_waitcnt vmcnt(43)
    s_mov_b32 m0, s64
    s_add_u32 s64, s64, 1024
    buffer_load_dwordx4 v22, s[56:59], s65 offen nt lds
    s_add_u32 s65, s65, 4096
    s_waitcnt vmcnt(43)
    s_sub_u32 s7, s60, 40
    s_max_i32 s61, s61, s7
    v_mov_b32 v19, s61
    ds_write_b32 v16, v19
    s_mov_b32 m0, s64
    s_add_u32 s64, s64, 1024
    buffer_load_dwordx4 v22, s[56:59], s65 offen nt lds
    s_add_u32 s65, s65, 4096
    s_waitcnt vmcnt(43)
    s_mov_b32 m0, s64
    s_add_u32 s64, s64, 1024
    buffer_load_dwordx4 v23, s[56:59], s65 offen nt lds
    s_add_u32 s65, s65, 4096
    s_waitcnt vmcnt(43)
    s_mov_b32 m0, s64
    s_add_u32 s64, s64, 1024
    buffer_load_dwordx4 v23, s[56:59], s65 offen nt lds
    s_add_u32 s65, s65, 4096
    ds_read_b32 v18, v17
    s_waitcnt vmcnt(43)
    s_mov_b32 m0, s64
    s_add_u32 s64, s64, 1024
    buffer_load_dwordx4 v23, s[56:59], s65 offen nt lds
    s_add_u32 s65, s65, 4096
    s_waitcnt vmcnt(43)
    s_mov_b32 m0, s64
    s_add_u32 s64, s64, 1024
    buffer_load_dwordx4 v23, s[56:59], s65 offen nt lds
    s_add_u32 s65, s65, 4096
    s_add_u32 s60, s60, 8
    s_add_u32 s62, s62, 1
    s_cmp_eq_u32 s62, 10
    s_cselect_b32 s7, 4, 0
    s_add_u32 s63, s63, s7
    s_cmp_eq_u32 s62, 18
    s_cselect_b32 s62, 0, s62
    s_cselect_b32 s64, 0, s64
    s_sub_u32 s66, s66, 1
    s_cmp_lg_u32 s66, 0
    s_cbranch_scc1 LL_36
    s_mov_b32 s67, s65
    s_waitcnt vmcnt(40)
    s_sub_u32 s7, s60, 40
    s_max_i32 s61, s61, s7
    v_mov_b32 v19, s61
    ds_write_b32 v16, v19
    s_waitcnt vmcnt(32)
    s_sub_u32 s7, s60, 32
    s_max_i32 s61, s61, s7
    v_mov_b32 v19, s61
    ds_write_b32 v16, v19
    s_waitcnt vmcnt(24)
    s_sub_u32 s7, s60, 24
    s_max_i32 s61, s61, s7
    v_mov_b32 v19, s61
    ds_write_b32 v16, v19
    s_waitcnt vmcnt(16)
    s_sub_u32 s7, s60, 16
    s_max_i32 s61, s61, s7
    v_mov_b32 v19, s61
    ds_write_b32 v16, v19
    s_waitcnt vmcnt(8)
    s_sub_u32 s7, s60, 8
    s_max_i32 s61, s61, s7
    v_mov_b32 v19, s61
    ds_write_b32 v16, v19
    s_waitcnt vmcnt(0)
    s_mov_b32 s61, s60
    v_mov_b32 v19, s61
    ds_write_b32 v16, v19
    s_endpgm
L_LDE:
    s_setprio 3
    v_xor_b32 v6, v3, v2
    v_lshlrev_b32 v6, 4, v6
    v_lshl_add_u32 v6, v2, 13, v6
    v_xor_b32 v7, 0x40, v6
    v_xor_b32 v8, 0x80, v6
    v_xor_b32 v9, 0xc0, v6
    s_lshl_b32 s65, s5, 21
    s_lshl_b32 s7, s4, 8
    s_add_u32 s65, s65, s7
    s_sub_u32 s65, s65, 0x800000
    s_mov_b32 s64, 0x14000
    s_waitcnt lgkmcnt(0)
    s_mov_b32 s52, s24
    s_and_b32 s53, s25, 0xffff
    s_mov_b32 s54, 0x400000
    s_mov_b32 s55, 0x20000
    s_mov_b32 m0, s64
    s_add_u32 s64, s64, 1024
    buffer_load_dwordx4 v6, s[52:55], s65 offen nt lds
    s_add_u32 s65, s65, 32768
    s_mov_b32 m0, s64
    s_add_u32 s64, s64, 1024
    buffer_load_dwordx4 v7, s[52:55], s65 offen nt lds
    s_add_u32 s65, s65, 32768
    s_mov_b32 m0, s64
    s_add_u32 s64, s64, 1024
    buffer_load_dwordx4 v8, s[52:55], s65 offen nt lds
    s_add_u32 s65, s65, 32768
    s_mov_b32 m0, s64
    s_add_u32 s64, s64, 1024
    buffer_load_dwordx4 v9, s[52:55], s65 offen nt lds
    s_add_u32 s65, s65, 32768
    s_mov_b32 m0, s64
    s_add_u32 s64, s64, 1024
    buffer_load_dwordx4 v6, s[52:55], s65 offen nt lds
    s_add_u32 s65, s65, 32768
    s_mov_b32 m0, s64
    s_add_u32 s64, s64, 1024
    buffer_load_dwordx4 v7, s[52:55], s65 offen nt lds
    s_add_u32 s65, s65, 32768
    s_mov_b32 m0, s64
    s_add_u32 s64, s64, 1024
    buffer_load_dwordx4 v8, s[52:55], s65 offen nt lds
    s_add_u32 s65, s65, 32768
    s_mov_b32 m0, s64
    s_add_u32 s64, s64, 1024
    buffer_load_dwordx4 v9, s[52:55], s65 offen nt lds
    s_add_u32 s65, s65, 32768
    s_mov_b32 m0, s64
    s_add_u32 s64, s64, 1024
    buffer_load_dwordx4 v6, s[52:55], s65 offen nt lds
    s_add_u32 s65, s65, 32768
    s_mov_b32 m0, s64
    s_add_u32 s64, s64, 1024
    buffer_load_dwordx4 v7, s[52:55], s65 offen nt lds
    s_add_u32 s65, s65, 32768
    s_mov_b32 m0, s64
    s_add_u32 s64, s64, 1024
    buffer_load_dwordx4 v8, s[52:55], s65 offen nt lds
    s_add_u32 s65, s65, 32768
    s_mov_b32 m0, s64
    s_add_u32 s64, s64, 1024
    buffer_load_dwordx4 v9, s[52:55], s65 offen nt lds
    s_add_u32 s65, s65, 32768
    s_mov_b32 m0, s64
    s_add_u32 s64, s64, 1024
    buffer_load_dwordx4 v6, s[52:55], s65 offen nt lds
    s_add_u32 s65, s65, 32768
    s_mov_b32 m0, s64
    s_add_u32 s64, s64, 1024
    buffer_load_dwordx4 v7, s[52:55], s65 offen nt lds
    s_add_u32 s65, s65, 32768
    s_mov_b32 m0, s64
    s_add_u32 s64, s64, 1024
    buffer_load_dwordx4 v8, s[52:55], s65 offen nt lds
    s_add_u32 s65, s65, 32768
    s_mov_b32 m0, s64
    s_add_u32 s64, s64, 1024
    buffer_load_dwordx4 v9, s[52:55], s65 offen nt lds
    s_add_u32 s65, s65, 32768
    s_mov_b32 m0, s64
    s_add_u32 s64, s64, 1024
    buffer_load_dwordx4 v6, s[52:55], s65 offen nt lds
    s_add_u32 s65, s65, 32768
    s_mov_b32 m0, s64
    s_add_u32 s64, s64, 1024
    buffer_load_dwordx4 v7, s[52:55], s65 offen nt lds
    s_add_u32 s65, s65, 32768
    s_mov_b32 m0, s64
    s_add_u32 s64, s64, 1024
    buffer_load_dwordx4 v8, s[52:55], s65 offen nt lds
    s_add_u32 s65, s65, 32768
    s_mov_b32 m0, s64
    s_add_u32 s64, s64, 1024
    buffer_load_dwordx4 v9, s[52:55], s65 offen nt lds
    s_add_u32 s65, s65, 32768
    s_mov_b32 m0, s64
    s_add_u32 s64, s64, 1024
    buffer_load_dwordx4 v6, s[52:55], s65 offen nt lds
    s_add_u32 s65, s65, 32768
    s_mov_b32 m0, s64
    s_add_u32 s64, s64, 1024
    buffer_load_dwordx4 v7, s[52:55], s65 offen nt lds
    s_add_u32 s65, s65, 32768
    s_mov_b32 m0, s64
    s_add_u32 s64, s64, 1024
    buffer_load_dwordx4 v8, s[52:55], s65 offen nt lds
    s_add_u32 s65, s65, 32768
    s_mov_b32 m0, s64
    s_add_u32 s64, s64, 1024
    buffer_load_dwordx4 v9, s[52:55], s65 offen nt lds
    s_add_u32 s65, s65, 32768
    s_mov_b32 m0, s64
    s_add_u32 s64, s64, 1024
    buffer_load_dwordx4 v6, s[52:55], s65 offen nt lds
    s_add_u32 s65, s65, 32768
    s_mov_b32 m0, s64
    s_add_u32 s64, s64, 1024
    buffer_load_dwordx4 v7, s[52:55], s65 offen nt lds
    s_add_u32 s65, s65, 32768
    s_mov_b32 m0, s64
    s_add_u32 s64, s64, 1024
    buffer_load_dwordx4 v8, s[52:55], s65 offen nt lds
    s_add_u32 s65, s65, 32768
    s_mov_b32 m0, s64
    s_add_u32 s64, s64, 1024
    buffer_load_dwordx4 v9, s[52:55], s65 offen nt lds
    s_add_u32 s65, s65, 32768
    s_mov_b32 m0, s64
    s_add_u32 s64, s64, 1024
    buffer_load_dwordx4 v6, s[52:55], s65 offen nt lds
    s_add_u32 s65, s65, 32768
    s_mov_b32 m0, s64
    s_add_u32 s64, s64, 1024
    buffer_load_dwordx4 v7, s[52:55], s65 offen nt lds
    s_add_u32 s65, s65, 32768
    s_mov_b32 m0, s64
    s_add_u32 s64, s64, 1024
    buffer_load_dwordx4 v8, s[52:55], s65 offen nt lds
    s_add_u32 s65, s65, 32768
    s_mov_b32 m0, s64
    s_add_u32 s64, s64, 1024
    buffer_load_dwordx4 v9, s[52:55], s65 offen nt lds
    s_add_u32 s65, s65, 32768
    s_barrier
    s_mov_b32 s61, 0
    s_mov_b32 s63, 0
    v_lshlrev_b32 v16, 2, v1
    v_add_u32 v17, 0x24100, v16
    v_add_u32 v16, 0x24000, v16
    v_mov_b32 v18, 0
    s_mov_b32 s60, 32
    s_mov_b32 s36, s34
    s_and_b32 s37, s35, 0xffff
    s_mov_b32 s38, 0x1000000
    s_mov_b32 s39, 0x20000
    s_mov_b32 s44, s26
    s_and_b32 s45, s27, 0xffff
    s_mov_b32 s46, 0x400000
    s_mov_b32 s47, 0x20000
    v_bfe_u32 v20, v1, 1, 2
    v_xor_b32 v20, v20, v2
    v_lshlrev_b32 v20, 5, v20
    v_lshrrev_b32 v40, 3, v1
    v_lshl_add_u32 v20, v40, 13, v20
    v_and_b32 v40, 1, v1
    v_lshl_add_u32 v20, v40, 4, v20
    s_mov_b32 s96, 0x6010600
    s_mov_b32 s97, 0x6030602
    s_cmp_eq_u32 s5, 1
    s_cselect_b32 s96, 0x6190618, s96
    s_cselect_b32 s97, 0x61b061a, s97
    s_cmp_eq_u32 s5, 2
    s_cselect_b32 s96, 0x6310630, s96
    s_cselect_b32 s97, 0x6330632, s97
    s_cmp_eq_u32 s5, 3
    s_cselect_b32 s96, 0x6490648, s96
    s_cselect_b32 s97, 0x64b064a, s97
    s_cmp_eq_u32 s5, 4
    s_cselect_b32 s96, 0x4610460, s96
    s_cselect_b32 s97, 0x4630462, s97
    s_cmp_eq_u32 s5, 5
    s_cselect_b32 s96, 0x4710470, s96
    s_cselect_b32 s97, 0x4730472, s97
    v_xor_b32 v10, v3, v2
    v_lshlrev_b32 v10, 4, v10
    v_lshl_add_u32 v10, v2, 8, v10
    v_xor_b32 v11, 0x40, v10
    v_xor_b32 v12, 0x80, v10
    v_xor_b32 v13, 0xc0, v10
    v_lshrrev_b32 v14, 1, v3
    v_xor_b32 v14, v14, v2
    v_lshlrev_b32 v14, 5, v14
    v_lshl_add_u32 v14, v2, 8, v14
    v_and_b32 v40, 1, v1
    v_lshl_add_u32 v14, v40, 4, v14
    v_xor_b32 v15, 0x80, v14
    s_mov_b32 s76, 0
    s_lshl_b32 s7, s76, 4
    s_lshr_b64 s[90:91], s[96:97], s7
    s_and_b32 s68, s90, 3
    s_bfe_u32 s72, s90, 0x50002
    s_lshl_b32 s68, s68, 5
    s_add_u32 s68, s68, s4
    s_lshl_b32 s68, s68, 20
    s_lshl_b32 s72, s72, 13
    s_add_u32 s72, s72, s68
    s_add_u32 s72, s72, 0xC0000
    s_mov_b32 s76, 1
    s_lshl_b32 s7, s76, 4
    s_lshr_b64 s[90:91], s[96:97], s7
    s_and_b32 s69, s90, 3
    s_bfe_u32 s73, s90, 0x50002
    s_lshl_b32 s69, s69, 5
    s_add_u32 s69, s69, s4
    s_lshl_b32 s69, s69, 20
    s_lshl_b32 s73, s73, 13
    s_add_u32 s73, s73, s69
    s_add_u32 s73, s73, 0xC0000
    s_mov_b32 s76, 2
    s_lshl_b32 s7, s76, 4
    s_lshr_b64 s[90:91], s[96:97], s7
    s_and_b32 s70, s90, 3
    s_bfe_u32 s74, s90, 0x50002
    s_lshl_b32 s70, s70, 5
    s_add_u32 s70, s70, s4
    s_lshl_b32 s70, s70, 20
    s_lshl_b32 s74, s74, 13
    s_add_u32 s74, s74, s70
    s_add_u32 s74, s74, 0xC0000
    s_mov_b32 s76, 3
    s_lshl_b32 s7, s76, 4
    s_lshr_b64 s[90:91], s[96:97], s7
    s_and_b32 s71, s90, 3
    s_bfe_u32 s75, s90, 0x50002
    s_lshl_b32 s71, s71, 5
    s_add_u32 s71, s71, s4
    s_lshl_b32 s71, s71, 20
    s_lshl_b32 s75, s75, 13
    s_add_u32 s75, s75, s71
    s_add_u32 s75, s75, 0xC0000
    s_mov_b32 s66, 4
LL_41:
    s_waitcnt vmcnt(39)
    s_mov_b32 m0, s64
    s_add_u32 s64, s64, 1024
    buffer_load_dwordx4 v6, s[52:55], s65 offen nt lds
    s_add_u32 s65, s65, 32768
    s_waitcnt vmcnt(39)
    s_mov_b32 m0, s64
    s_add_u32 s64, s64, 1024
    buffer_load_dwordx4 v7, s[52:55], s65 offen nt lds
    s_add_u32 s65, s65, 32768
    s_waitcnt vmcnt(39)
    s_mov_b32 m0, s64
    s_add_u32 s64, s64, 1024
    buffer_load_dwordx4 v8, s[52:55], s65 offen nt lds
    s_add_u32 s65, s65, 32768
    s_waitcnt vmcnt(39)
    s_mov_b32 m0, s64
    s_add_u32 s64, s64, 1024
    buffer_load_dwordx4 v9, s[52:55], s65 offen nt lds
    s_add_u32 s65, s65, 32768
    s_waitcnt vmcnt(39)
    s_mov_b32 m0, s64
    s_add_u32 s64, s64, 1024
    buffer_load_dwordx4 v6, s[52:55], s65 offen nt lds
    s_add_u32 s65, s65, 32768
    s_waitcnt vmcnt(39)
    s_mov_b32 m0, s64
    s_add_u32 s64, s64, 1024
    buffer_load_dwordx4 v7, s[52:55], s65 offen nt lds
    s_add_u32 s65, s65, 32768
    s_waitcnt vmcnt(39)
    s_mov_b32 m0, s64
    s_add_u32 s64, s64, 1024
    buffer_load_dwordx4 v8, s[52:55], s65 offen nt lds
    s_add_u32 s65, s65, 32768
    s_waitcnt vmcnt(39)
    s_sub_u32 s7, s60, 32
    s_max_i32 s61, s61, s7
    v_mov_b32 v19, s61
    ds_write_b32 v16, v19
    s_mov_b32 m0, s64
    s_add_u32 s64, s64, 1024
    buffer_load_dwordx4 v9, s[52:55], s65 offen nt lds
    s_add_u32 s65, s65, 32768
    s_add_u32 s60, s60, 8
    s_sub_u32 s66, s66, 1
    s_cmp_lg_u32 s66, 0
    s_cbranch_scc1 LL_41
    s_waitcnt vmcnt(32)
    s_sub_u32 s7, s60, 32
    s_max_i32 s61, s61, s7
    v_mov_b32 v19, s61
    ds_write_b32 v16, v19
    s_waitcnt vmcnt(24)
    s_sub_u32 s7, s60, 24
    s_max_i32 s61, s61, s7
    v_mov_b32 v19, s61
    ds_write_b32 v16, v19
    s_waitcnt vmcnt(16)
    s_sub_u32 s7, s60, 16
    s_max_i32 s61, s61, s7
    v_mov_b32 v19, s61
    ds_write_b32 v16, v19
    s_waitcnt vmcnt(8)
    s_sub_u32 s7, s60, 8
    s_max_i32 s61, s61, s7
    v_mov_b32 v19, s61
    ds_write_b32 v16, v19
    s_waitcnt vmcnt(0)
    s_mov_b32 s61, s60
    v_mov_b32 v19, s61
    ds_write_b32 v16, v19
    v_mov_b32 v40, 0x24208
    s_mov_b32 s80, 1600000
LW_42:
    ds_read_b32 v41, v40
    s_waitcnt lgkmcnt(0)
    v_readfirstlane_b32 s79, v41
    s_cmp_ge_u32 s79, 148
    s_cbranch_scc1 LWD_43
    s_sub_u32 s80, s80, 1
    s_cmp_lg_u32 s80, 0
    s_cbranch_scc1 LW_42
LWD_43:
    s_lshl_b32 s65, s4, 8
    s_lshl_b32 s7, s5, 7
    s_add_u32 s65, s65, s7
    s_sub_u32 s65, s65, 512
    s_mov_b32 s64, 0
    s_mov_b32 s66, 8
LL_44:
    s_waitcnt vmcnt(23)
    s_mov_b32 m0, s64
    s_add_u32 s64, s64, 1024
    buffer_load_dwordx4 v20, s[44:47], s65 offen nt lds
    s_add_u32 s65, s65, 65536
    s_waitcnt vmcnt(23)
    s_mov_b32 m0, s64
    s_add_u32 s64, s64, 1024
    buffer_load_dwordx4 v20, s[44:47], s65 offen nt lds
    s_add_u32 s65, s65, 65536
    s_waitcnt vmcnt(23)
    s_mov_b32 m0, s64
    s_add_u32 s64, s64, 1024
    buffer_load_dwordx4 v20, s[44:47], s65 offen nt lds
    s_add_u32 s65, s65, 65536
    s_waitcnt vmcnt(23)
    s_mov_b32 m0, s64
    s_add_u32 s64, s64, 1024
    buffer_load_dwordx4 v20, s[44:47], s65 offen nt lds
    s_add_u32 s65, s65, 65536
    s_waitcnt vmcnt(23)
    s_mov_b32 m0, s64
    s_add_u32 s64, s64, 1024
    buffer_load_dwordx4 v20, s[44:47], s65 offen nt lds
    s_add_u32 s65, s65, 65536
    s_waitcnt vmcnt(23)
    s_mov_b32 m0, s64
    s_add_u32 s64, s64, 1024
    buffer_load_dwordx4 v20, s[44:47], s65 offen nt lds
    s_add_u32 s65, s65, 65536
    s_waitcnt vmcnt(23)
    s_mov_b32 m0, s64
    s_add_u32 s64, s64, 1024
    buffer_load_dwordx4 v20, s[44:47], s65 offen nt lds
    s_add_u32 s65, s65, 65536
    s_waitcnt vmcnt(23)
    s_sub_u32 s7, s60, 16
    s_max_i32 s61, s61, s7
    v_mov_b32 v19, s61
    ds_write_b32 v16, v19
    s_mov_b32 m0, s64
    s_add_u32 s64, s64, 1024
    buffer_load_dwordx4 v20, s[44:47], s65 offen nt lds
    s_add_u32 s65, s65, 65536
    s_add_u32 s60, s60, 8
    s_sub_u32 s66, s66, 1
    s_cmp_lg_u32 s66, 0
    s_cbranch_scc1 LL_44
    s_mov_b32 s62, 8
    s_mov_b32 s44, s10
    s_and_b32 s45, s11, 0xffff
    s_mov_b32 s46, 0x8000000
    s_mov_b32 s47, 0x20000
    s_mov_b32 s48, s12
    s_and_b32 s49, s13, 0xffff
    s_mov_b32 s50, 0x8000000
    s_mov_b32 s51, 0x20000
    s_mov_b32 s68, s72
    s_mov_b32 s69, s73
    s_mov_b32 s70, s74
    s_mov_b32 s71, s75
    v_mov_b32 v40, 0x24204
    s_mov_b32 s80, 1600000
LW_45:
    ds_read_b32 v41, v40
    s_waitcnt lgkmcnt(0)
    v_readfirstlane_b32 s79, v41
    s_cmp_ge_u32 s79, 1
    s_cbranch_scc1 LWD_46
    s_sleep 1
    s_sub_u32 s80, s80, 1
    s_cmp_lg_u32 s80, 0
    s_cbranch_scc1 LW_45
LWD_46:
    v_mov_b32 v40, 0x24248
    ds_read_b64 v[42:43], v40
    s_waitcnt lgkmcnt(0)
    v_readfirstlane_b32 s92, v42
    v_readfirstlane_b32 s93, v43
    s_add_u32 s77, s92, 20160
    s_memrealtime s[84:85]
    s_mov_b32 s66, 16
LL_47:
    s_waitcnt lgkmcnt(0)
    v_readlane_b32 s79, v18, s62
    s_cmp_lt_u32 s79, s63
    s_cbranch_scc1 ST_49
GO_48:
    s_waitcnt lgkmcnt(0)
    s_lshl_b32 s7, s84, 5
    s_sub_u32 s7, s7, s77
    s_add_u32 s77, s77, 992
    s_cmp_lt_i32 s7, -640
    s_cbranch_scc1 WS_50
    s_cmp_gt_i32 s7, 2240
    s_cbranch_scc1 WB_51
    s_waitcnt vmcnt(23)
    s_add_u32 s7, s64, 0
    s_mov_b32 m0, s7
    s_add_u32 s65, s68, 0
    buffer_load_dwordx4 v10, s[44:47], s65 offen offset:0 nt lds
    s_waitcnt vmcnt(23)
    buffer_load_dwordx4 v11, s[44:47], s65 offen offset:1024 nt lds
    s_waitcnt vmcnt(23)
    buffer_load_dwordx4 v12, s[44:47], s65 offen offset:2048 nt lds
    s_waitcnt vmcnt(23)
    buffer_load_dwordx4 v13, s[44:47], s65 offen offset:3072 nt lds
    s_waitcnt vmcnt(23)
    s_add_u32 s7, s64, 4096
    s_mov_b32 m0, s7
    s_add_u32 s65, s68, 4096
    buffer_load_dwordx4 v10, s[44:47], s65 offen offset:0 nt lds
    s_waitcnt vmcnt(23)
    buffer_load_dwordx4 v11, s[44:47], s65 offen offset:1024 nt lds
    s_memrealtime s[84:85]
    ds_read_b32 v18, v17
    s_waitcnt vmcnt(23)
    buffer_load_dwordx4 v12, s[44:47], s65 offen offset:2048 nt lds
    s_waitcnt vmcnt(23)
    s_sub_u32 s7, s60, 16
    s_max_i32 s61, s61, s7
    v_mov_b32 v19, s61
    ds_write_b32 v16, v19
    buffer_load_dwordx4 v13, s[44:47], s65 offen offset:3072 nt lds
    s_add_u32 s60, s60, 8
    s_branch WJ_52
WS_50:
    s_waitcnt vmcnt(15)
    s_add_u32 s7, s64, 0
    s_mov_b32 m0, s7
    s_add_u32 s65, s68, 0
    buffer_load_dwordx4 v10, s[44:47], s65 offen offset:0 nt lds
    s_waitcnt vmcnt(15)
    buffer_load_dwordx4 v11, s[44:47], s65 offen offset:1024 nt lds
    s_waitcnt vmcnt(15)
    buffer_load_dwordx4 v12, s[44:47], s65 offen offset:2048 nt lds
    s_waitcnt vmcnt(15)
    buffer_load_dwordx4 v13, s[44:47], s65 offen offset:3072 nt lds
    s_waitcnt vmcnt(15)
    s_add_u32 s7, s64, 4096
    s_mov_b32 m0, s7
    s_add_u32 s65, s68, 4096
    buffer_load_dwordx4 v10, s[44:47], s65 offen offset:0 nt lds
    s_waitcnt vmcnt(15)
    buffer_load_dwordx4 v11, s[44:47], s65 offen offset:1024 nt lds
    s_memrealtime s[84:85]
    ds_read_b32 v18, v17
    s_waitcnt vmcnt(15)
    buffer_load_dwordx4 v12, s[44:47], s65 offen offset:2048 nt lds
    s_waitcnt vmcnt(15)
    s_sub_u32 s7, s60, 8
    s_max_i32 s61, s61, s7
    v_mov_b32 v19, s61
    ds_write_b32 v16, v19
    buffer_load_dwordx4 v13, s[44:47], s65 offen offset:3072 nt lds
    s_add_u32 s60, s60, 8
    s_branch WJ_52
WB_51:
    s_waitcnt vmcnt(31)
    s_add_u32 s7, s64, 0
    s_mov_b32 m0, s7
    s_add_u32 s65, s68, 0
    buffer_load_dwordx4 v10, s[44:47], s65 offen offset:0 nt lds
    s_waitcnt vmcnt(31)
    buffer_load_dwordx4 v11, s[44:47], s65 offen offset:1024 nt lds
    s_waitcnt vmcnt(31)
    buffer_load_dwordx4 v12, s[44:47], s65 offen offset:2048 nt lds
    s_waitcnt vmcnt(31)
    buffer_load_dwordx4 v13, s[44:47], s65 offen offset:3072 nt lds
    s_waitcnt vmcnt(31)
    s_add_u32 s7, s64, 4096
    s_mov_b32 m0, s7
    s_add_u32 s65, s68, 4096
    buffer_load_dwordx4 v10, s[44:47], s65 offen offset:0 nt lds
    s_waitcnt vmcnt(31)
    buffer_load_dwordx4 v11, s[44:47], s65 offen offset:1024 nt lds
    s_memrealtime s[84:85]
    ds_read_b32 v18, v17
    s_waitcnt vmcnt(31)
    buffer_load_dwordx4 v12, s[44:47], s65 offen offset:2048 nt lds
    s_waitcnt vmcnt(31)
    s_sub_u32 s7, s60, 24
    s_max_i32 s61, s61, s7
    v_mov_b32 v19, s61
    ds_write_b32 v16, v19
    buffer_load_dwordx4 v13, s[44:47], s65 offen offset:3072 nt lds
    s_add_u32 s60, s60, 8
WJ_52:
    s_add_u32 s65, s65, 4096
    s_mov_b32 s68, s69
    s_mov_b32 s69, s70
    s_mov_b32 s70, s71
    s_mov_b32 s71, s65
    s_add_u32 s62, s62, 1
    s_add_u32 s64, s64, 8192
    s_cmp_eq_u32 s62, 10
    s_cselect_b32 s7, 4, 0
    s_add_u32 s63, s63, s7
    s_cmp_eq_u32 s62, 18
    s_cselect_b32 s62, 0, s62
    s_cselect_b32 s64, 0, s64
    s_sub_u32 s66, s66, 1
    s_cmp_lg_u32 s66, 0
    s_cbranch_scc1 LL_47
    s_mov_b32 s68, s72
    s_mov_b32 s69, s73
    s_mov_b32 s70, s74
    s_mov_b32 s71, s75
    s_memrealtime s[84:85]
    s_mov_b32 s66, 16
LL_53:
    s_waitcnt lgkmcnt(0)
    v_readlane_b32 s79, v18, s62
    s_cmp_lt_u32 s79, s63
    s_cbranch_scc1 ST_55
GO_54:
    s_waitcnt lgkmcnt(0)
    s_lshl_b32 s7, s84, 5
    s_sub_u32 s7, s7, s77
    s_add_u32 s77, s77, 864
    s_cmp_lt_i32 s7, -640
    s_cbranch_scc1 WS_56
    s_cmp_gt_i32 s7, 2240
    s_cbranch_scc1 WB_57
    s_waitcnt vmcnt(29)
    s_add_u32 s7, s64, 0
    s_mov_b32 m0, s7
    s_add_u32 s65, s68, 0
    buffer_load_dwordx4 v14, s[48:51], s65 offen offset:0 nt lds
    s_waitcnt vmcnt(29)
    buffer_load_dwordx4 v15, s[48:51], s65 offen offset:1024 nt lds
    s_waitcnt vmcnt(29)
    buffer_load_dwordx4 v14, s[48:51], s65 offen offset:2048 nt lds
    s_waitcnt vmcnt(29)
    buffer_load_dwordx4 v15, s[48:51], s65 offen offset:3072 nt lds
    s_waitcnt vmcnt(29)
    s_add_u32 s7, s64, 4096
    s_mov_b32 m0, s7
    s_add_u32 s65, s68, 4096
    buffer_load_dwordx4 v14, s[48:51], s65 offen offset:0 nt lds
    s_waitcnt vmcnt(29)
    s_sub_u32 s7, s60, 24
    s_max_i32 s61, s61, s7
    v_mov_b32 v19, s61
    ds_write_b32 v16, v19
    buffer_load_dwordx4 v15, s[48:51], s65 offen offset:1024 nt lds
    s_memrealtime s[84:85]
    ds_read_b32 v18, v17
    s_waitcnt vmcnt(29)
    buffer_load_dwordx4 v14, s[48:51], s65 offen offset:2048 nt lds
    s_waitcnt vmcnt(29)
    buffer_load_dwordx4 v15, s[48:51], s65 offen offset:3072 nt lds
    s_add_u32 s60, s60, 8
    s_branch WJ_58
WS_56:
    s_waitcnt vmcnt(19)
    s_add_u32 s7, s64, 0
    s_mov_b32 m0, s7
    s_add_u32 s65, s68, 0
    buffer_load_dwordx4 v14, s[48:51], s65 offen offset:0 nt lds
    s_waitcnt vmcnt(19)
    buffer_load_dwordx4 v15, s[48:51], s65 offen offset:1024 nt lds
    s_waitcnt vmcnt(19)
    buffer_load_dwordx4 v14, s[48:51], s65 offen offset:2048 nt lds
    s_waitcnt vmcnt(19)
    s_sub_u32 s7, s60, 16
    s_max_i32 s61, s61, s7
    v_mov_b32 v19, s61
    ds_write_b32 v16, v19
    buffer_load_dwordx4 v15, s[48:51], s65 offen offset:3072 nt lds
    s_waitcnt vmcnt(19)
    s_add_u32 s7, s64, 4096
    s_mov_b32 m0, s7
    s_add_u32 s65, s68, 4096
    buffer_load_dwordx4 v14, s[48:51], s65 offen offset:0 nt lds
    s_waitcnt vmcnt(19)
    buffer_load_dwordx4 v15, s[48:51], s65 offen offset:1024 nt lds
    s_memrealtime s[84:85]
    ds_read_b32 v18, v17
    s_waitcnt vmcnt(19)
    buffer_load_dwordx4 v14, s[48:51], s65 offen offset:2048 nt lds
    s_waitcnt vmcnt(19)
    buffer_load_dwordx4 v15, s[48:51], s65 offen offset:3072 nt lds
    s_add_u32 s60, s60, 8
    s_branch WJ_58
WB_57:
    s_waitcnt vmcnt(43)
    s_add_u32 s7, s64, 0
    s_mov_b32 m0, s7
    s_add_u32 s65, s68, 0
    buffer_load_dwordx4 v14, s[48:51], s65 offen offset:0 nt lds
    s_waitcnt vmcnt(43)
    buffer_load_dwordx4 v15, s[48:51], s65 offen offset:1024 nt lds
    s_waitcnt vmcnt(43)
    buffer_load_dwordx4 v14, s[48:51], s65 offen offset:2048 nt lds
    s_waitcnt vmcnt(43)
    s_sub_u32 s7, s60, 40
    s_max_i32 s61, s61, s7
    v_mov_b32 v19, s61
    ds_write_b32 v16, v19
    buffer_load_dwordx4 v15, s[48:51], s65 offen offset:3072 nt lds
    s_waitcnt vmcnt(43)
    s_add_u32 s7, s64, 4096
    s_mov_b32 m0, s7
    s_add_u32 s65, s68, 4096
    buffer_load_dwordx4 v14, s[48:51], s65 offen offset:0 nt lds
    s_waitcnt vmcnt(43)
    buffer_load_dwordx4 v15, s[48:51], s65 offen offset:1024 nt lds
    s_memrealtime s[84:85]
    ds_read_b32 v18, v17
    s_waitcnt vmcnt(43)
    buffer_load_dwordx4 v14, s[48:51], s65 offen offset:2048 nt lds
    s_waitcnt vmcnt(43)
    buffer_load_dwordx4 v15, s[48:51], s65 offen offset:3072 nt lds
    s_add_u32 s60, s60, 8
WJ_58:
    s_add_u32 s65, s65, 4096
    s_mov_b32 s68, s69
    s_mov_b32 s69, s70
    s_mov_b32 s70, s71
    s_mov_b32 s71, s65
    s_add_u32 s62, s62, 1
    s_add_u32 s64, s64, 8192
    s_cmp_eq_u32 s62, 10
    s_cselect_b32 s7, 4, 0
    s_add_u32 s63, s63, s7
    s_cmp_eq_u32 s62, 18
    s_cselect_b32 s62, 0, s62
    s_cselect_b32 s64, 0, s64
    s_sub_u32 s66, s66, 1
    s_cmp_lg_u32 s66, 0
    s_cbranch_scc1 LL_53
    s_waitcnt vmcnt(40)
    s_sub_u32 s7, s60, 40
    s_max_i32 s61, s61, s7
    v_mov_b32 v19, s61
    ds_write_b32 v16, v19
    s_waitcnt vmcnt(32)
    s_sub_u32 s7, s60, 32
    s_max_i32 s61, s61, s7
    v_mov_b32 v19, s61
    ds_write_b32 v16, v19
    s_waitcnt vmcnt(24)
    s_sub_u32 s7, s60, 24
    s_max_i32 s61, s61, s7
    v_mov_b32 v19, s61
    ds_write_b32 v16, v19
    s_waitcnt vmcnt(16)
    s_sub_u32 s7, s60, 16
    s_max_i32 s61, s61, s7
    v_mov_b32 v19, s61
    ds_write_b32 v16, v19
    s_waitcnt vmcnt(8)
    s_sub_u32 s7, s60, 8
    s_max_i32 s61, s61, s7
    v_mov_b32 v19, s61
    ds_write_b32 v16, v19
    s_waitcnt vmcnt(0)
    s_mov_b32 s61, s60
    v_mov_b32 v19, s61
    ds_write_b32 v16, v19
    s_endpgm
L_LDB:
    s_setprio 3
    v_lshlrev_b32 v20, 4, v1
    v_xor_b32 v21, 0x40, v20
    v_xor_b32 v22, 0x80, v20
    v_xor_b32 v23, 0xc0, v20
    v_xor_b32 v24, 0x10, v20
    v_xor_b32 v25, 0x50, v20
    v_xor_b32 v26, 0x90, v20
    v_xor_b32 v27, 0xd0, v20
    v_xor_b32 v28, 0x20, v20
    v_xor_b32 v29, 0x60, v20
    v_xor_b32 v30, 0xa0, v20
    v_xor_b32 v31, 0xe0, v20
    v_xor_b32 v32, 0x30, v20
    v_xor_b32 v33, 0x70, v20
    v_xor_b32 v34, 0xb0, v20
    v_xor_b32 v35, 0xf0, v20
    s_and_b32 s69, s4, 7
    s_lshl_b32 s69, s69, 3
    s_lshr_b32 s7, s4, 3
    s_lshl_b32 s7, s7, 1
    s_add_u32 s69, s69, s7
    s_add_u32 s69, s69, s5
    s_sub_u32 s69, s69, 6
    s_lshl_b32 s68, s69, 18
    s_mov_b32 s64, 0
    s_waitcnt lgkmcnt(0)
    s_mov_b32 s44, s20
    s_and_b32 s45, s21, 0xffff
    s_mov_b32 s46, 0x1000000
    s_mov_b32 s47, 0x20000
    s_add_u32 s7, s64, 0
    s_mov_b32 m0, s7
    s_add_u32 s65, s68, 0
    buffer_load_dwordx4 v20, s[44:47], s65 offen offset:0 nt lds
    buffer_load_dwordx4 v21, s[44:47], s65 offen offset:1024 nt lds
    buffer_load_dwordx4 v22, s[44:47], s65 offen offset:2048 nt lds
    buffer_load_dwordx4 v23, s[44:47], s65 offen offset:3072 nt lds
    s_add_u32 s7, s64, 4096
    s_mov_b32 m0, s7
    s_add_u32 s65, s68, 4096
    buffer_load_dwordx4 v24, s[44:47], s65 offen offset:0 nt lds
    buffer_load_dwordx4 v25, s[44:47], s65 offen offset:1024 nt lds
    buffer_load_dwordx4 v26, s[44:47], s65 offen offset:2048 nt lds
    buffer_load_dwordx4 v27, s[44:47], s65 offen offset:3072 nt lds
    s_add_u32 s7, s64, 8192
    s_mov_b32 m0, s7
    s_add_u32 s65, s68, 8192
    buffer_load_dwordx4 v28, s[44:47], s65 offen offset:0 nt lds
    buffer_load_dwordx4 v29, s[44:47], s65 offen offset:1024 nt lds
    buffer_load_dwordx4 v30, s[44:47], s65 offen offset:2048 nt lds
    buffer_load_dwordx4 v31, s[44:47], s65 offen offset:3072 nt lds
    s_add_u32 s7, s64, 12288
    s_mov_b32 m0, s7
    s_add_u32 s65, s68, 12288
    buffer_load_dwordx4 v32, s[44:47], s65 offen offset:0 nt lds
    buffer_load_dwordx4 v33, s[44:47], s65 offen offset:1024 nt lds
    buffer_load_dwordx4 v34, s[44:47], s65 offen offset:2048 nt lds
    buffer_load_dwordx4 v35, s[44:47], s65 offen offset:3072 nt lds
    s_barrier
    s_mov_b32 s61, 0
    s_mov_b32 s63, 0
    v_lshlrev_b32 v16, 2, v1
    v_add_u32 v17, 0x24100, v16
    v_add_u32 v16, 0x24000, v16
    v_mov_b32 v18, 0
    s_mov_b32 s60, 16
    s_mov_b32 s36, s34
    s_and_b32 s37, s35, 0xffff
    s_mov_b32 s38, 0x1000000
    s_mov_b32 s39, 0x20000
    s_add_u32 s68, s68, 16384
    s_mov_b32 s64, 16384
    s_mov_b32 s48, s28
    s_and_b32 s49, s29, 0xffff
    s_mov_b32 s50, 0x400000
    s_mov_b32 s51, 0x20000
    v_bfe_u32 v10, v1, 1, 2
    v_xor_b32 v10, v10, v2
    v_lshlrev_b32 v10, 5, v10
    v_lshrrev_b32 v40, 3, v1
    v_lshl_add_u32 v10, v40, 10, v10
    v_and_b32 v40, 1, v1
    v_lshl_add_u32 v10, v40, 4, v10
    s_mov_b32 s72, 0x22559911
    s_mov_b32 s73, 0x2
    s_mov_b32 s74, 0x54873210
    s_mov_b32 s75, 0x6
    s_mov_b32 s66, 6
LL_59:
    s_waitcnt vmcnt(27)
    s_add_u32 s7, s64, 0
    s_mov_b32 m0, s7
    s_add_u32 s65, s68, 0
    buffer_load_dwordx4 v20, s[44:47], s65 offen offset:0 nt lds
    s_waitcnt vmcnt(27)
    buffer_load_dwordx4 v21, s[44:47], s65 offen offset:1024 nt lds
    s_waitcnt vmcnt(27)
    buffer_load_dwordx4 v22, s[44:47], s65 offen offset:2048 nt lds
    s_waitcnt vmcnt(27)
    s_sub_u32 s7, s60, 24
    s_max_i32 s61, s61, s7
    v_mov_b32 v19, s61
    ds_write_b32 v16, v19
    buffer_load_dwordx4 v23, s[44:47], s65 offen offset:3072 nt lds
    s_waitcnt vmcnt(27)
    s_add_u32 s7, s64, 4096
    s_mov_b32 m0, s7
    s_add_u32 s65, s68, 4096
    buffer_load_dwordx4 v24, s[44:47], s65 offen offset:0 nt lds
    s_waitcnt vmcnt(27)
    buffer_load_dwordx4 v25, s[44:47], s65 offen offset:1024 nt lds
    s_waitcnt vmcnt(27)
    buffer_load_dwordx4 v26, s[44:47], s65 offen offset:2048 nt lds
    s_waitcnt vmcnt(27)
    buffer_load_dwordx4 v27, s[44:47], s65 offen offset:3072 nt lds
    s_waitcnt vmcnt(27)
    s_add_u32 s7, s64, 8192
    s_mov_b32 m0, s7
    s_add_u32 s65, s68, 8192
    buffer_load_dwordx4 v28, s[44:47], s65 offen offset:0 nt lds
    s_waitcnt vmcnt(27)
    buffer_load_dwordx4 v29, s[44:47], s65 offen offset:1024 nt lds
    s_waitcnt vmcnt(27)
    buffer_load_dwordx4 v30, s[44:47], s65 offen offset:2048 nt lds
    s_waitcnt vmcnt(27)
    s_sub_u32 s7, s60, 16
    s_max_i32 s61, s61, s7
    v_mov_b32 v19, s61
    ds_write_b32 v16, v19
    buffer_load_dwordx4 v31, s[44:47], s65 offen offset:3072 nt lds
    s_waitcnt vmcnt(27)
    s_add_u32 s7, s64, 12288
    s_mov_b32 m0, s7
    s_add_u32 s65, s68, 12288
    buffer_load_dwordx4 v32, s[44:47], s65 offen offset:0 nt lds
    s_waitcnt vmcnt(27)
    buffer_load_dwordx4 v33, s[44:47], s65 offen offset:1024 nt lds
    s_waitcnt vmcnt(27)
    buffer_load_dwordx4 v34, s[44:47], s65 offen offset:2048 nt lds
    s_waitcnt vmcnt(27)
    buffer_load_dwordx4 v35, s[44:47], s65 offen offset:3072 nt lds
    s_add_u32 s60, s60, 16
    s_add_u32 s68, s68, 16384
    s_add_u32 s64, s64, 16384
    s_sub_u32 s66, s66, 1
    s_cmp_lg_u32 s66, 0
    s_cbranch_scc1 LL_59
    v_mov_b32 v40, 0x24204
    s_mov_b32 s80, 1600000
LW_60:
    ds_read_b32 v41, v40
    s_waitcnt lgkmcnt(0)
    v_readfirstlane_b32 s79, v41
    s_cmp_ge_u32 s79, 1
    s_cbranch_scc1 LWD_61
    s_sleep 1
    s_sub_u32 s80, s80, 1
    s_cmp_lg_u32 s80, 0
    s_cbranch_scc1 LW_60
LWD_61:
    v_mov_b32 v40, 0x24248
    ds_read_b64 v[42:43], v40
    s_waitcnt lgkmcnt(0)
    v_readfirstlane_b32 s92, v42
    v_readfirstlane_b32 s93, v43
    s_lshr_b32 s7, s69, 3
    s_lshl_b32 s7, s7, 7
    s_add_u32 s7, s7, 0x22000
    v_and_b32 v38, 7, v1
    v_lshl_add_u32 v38, v38, 3, s7
    s_mov_b32 s66, 2
LL_62:
    s_and_b32 s63, s72, 3
    s_lshl_b32 s63, s63, 3
    s_bfe_u32 s62, s72, 0x20002
    s_lshr_b64 s[72:73], s[72:73], 4
    s_and_b32 s64, s74, 15
    s_lshl_b32 s64, s64, 14
    s_lshr_b64 s[74:75], s[74:75], 4
    s_waitcnt lgkmcnt(0)
    v_readlane_b32 s79, v18, s62
    s_cmp_lt_u32 s79, s63
    s_cbranch_scc1 ST_64
GO_63:
    s_waitcnt vmcnt(19)
    s_add_u32 s7, s64, 0
    s_mov_b32 m0, s7
    s_add_u32 s65, s68, 0
    buffer_load_dwordx4 v20, s[44:47], s65 offen offset:0 nt lds
    s_waitcnt vmcnt(19)
    buffer_load_dwordx4 v21, s[44:47], s65 offen offset:1024 nt lds
    s_waitcnt vmcnt(19)
    buffer_load_dwordx4 v22, s[44:47], s65 offen offset:2048 nt lds
    s_waitcnt vmcnt(19)
    s_sub_u32 s7, s60, 16
    s_max_i32 s61, s61, s7
    v_mov_b32 v19, s61
    ds_write_b32 v16, v19
    buffer_load_dwordx4 v23, s[44:47], s65 offen offset:3072 nt lds
    s_waitcnt vmcnt(19)
    s_add_u32 s7, s64, 4096
    s_mov_b32 m0, s7
    s_add_u32 s65, s68, 4096
    buffer_load_dwordx4 v24, s[44:47], s65 offen offset:0 nt lds
    s_waitcnt vmcnt(19)
    buffer_load_dwordx4 v25, s[44:47], s65 offen offset:1024 nt lds
    s_waitcnt vmcnt(19)
    buffer_load_dwordx4 v26, s[44:47], s65 offen offset:2048 nt lds
    s_waitcnt vmcnt(19)
    buffer_load_dwordx4 v27, s[44:47], s65 offen offset:3072 nt lds
    s_waitcnt vmcnt(19)
    s_add_u32 s7, s64, 8192
    s_mov_b32 m0, s7
    s_add_u32 s65, s68, 8192
    buffer_load_dwordx4 v28, s[44:47], s65 offen offset:0 nt lds
    s_waitcnt vmcnt(19)
    buffer_load_dwordx4 v29, s[44:47], s65 offen offset:1024 nt lds
    s_waitcnt vmcnt(19)
    buffer_load_dwordx4 v30, s[44:47], s65 offen offset:2048 nt lds
    s_waitcnt vmcnt(19)
    s_sub_u32 s7, s60, 8
    s_max_i32 s61, s61, s7
    v_mov_b32 v19, s61
    ds_write_b32 v16, v19
    buffer_load_dwordx4 v31, s[44:47], s65 offen offset:3072 nt lds
    s_waitcnt vmcnt(19)
    s_add_u32 s7, s64, 12288
    s_mov_b32 m0, s7
    s_add_u32 s65, s68, 12288
    buffer_load_dwordx4 v32, s[44:47], s65 offen offset:0 nt lds
    s_waitcnt vmcnt(19)
    buffer_load_dwordx4 v33, s[44:47], s65 offen offset:1024 nt lds
    ds_read_b32 v18, v17
    s_waitcnt vmcnt(19)
    buffer_load_dwordx4 v34, s[44:47], s65 offen offset:2048 nt lds
    s_waitcnt vmcnt(19)
    buffer_load_dwordx4 v35, s[44:47], s65 offen offset:3072 nt lds
    s_add_u32 s60, s60, 16
    s_add_u32 s68, s68, 16384
    s_sub_u32 s66, s66, 1
    s_cmp_lg_u32 s66, 0
    s_cbranch_scc1 LL_62
    s_mov_b32 s66, 7
LL_65:
    s_and_b32 s63, s72, 3
    s_lshl_b32 s63, s63, 3
    s_bfe_u32 s62, s72, 0x20002
    s_lshr_b64 s[72:73], s[72:73], 4
    s_and_b32 s64, s74, 15
    s_lshl_b32 s64, s64, 14
    s_lshr_b64 s[74:75], s[74:75], 4
    s_waitcnt lgkmcnt(0)
    v_readlane_b32 s79, v18, s62
    s_cmp_lt_u32 s79, s63
    s_cbranch_scc1 ST_67
GO_66:
    s_waitcnt vmcnt(31)
    s_add_u32 s7, s64, 0
    s_mov_b32 m0, s7
    s_add_u32 s65, s68, 0
    buffer_load_dwordx4 v20, s[44:47], s65 offen offset:0 nt lds
    s_waitcnt vmcnt(31)
    buffer_load_dwordx4 v21, s[44:47], s65 offen offset:1024 nt lds
    s_waitcnt vmcnt(31)
    buffer_load_dwordx4 v22, s[44:47], s65 offen offset:2048 nt lds
    s_waitcnt vmcnt(31)
    buffer_load_dwordx4 v23, s[44:47], s65 offen offset:3072 nt lds
    s_waitcnt vmcnt(31)
    s_add_u32 s7, s64, 4096
    s_mov_b32 m0, s7
    s_add_u32 s65, s68, 4096
    buffer_load_dwordx4 v24, s[44:47], s65 offen offset:0 nt lds
    s_waitcnt vmcnt(31)
    buffer_load_dwordx4 v25, s[44:47], s65 offen offset:1024 nt lds
    s_waitcnt vmcnt(31)
    buffer_load_dwordx4 v26, s[44:47], s65 offen offset:2048 nt lds
    s_waitcnt vmcnt(31)
    s_sub_u32 s7, s60, 24
    s_max_i32 s61, s61, s7
    v_mov_b32 v19, s61
    ds_write_b32 v16, v19
    buffer_load_dwordx4 v27, s[44:47], s65 offen offset:3072 nt lds
    s_waitcnt vmcnt(31)
    s_add_u32 s7, s64, 8192
    s_mov_b32 m0, s7
    s_add_u32 s65, s68, 8192
    buffer_load_dwordx4 v28, s[44:47], s65 offen offset:0 nt lds
    s_waitcnt vmcnt(31)
    buffer_load_dwordx4 v29, s[44:47], s65 offen offset:1024 nt lds
    s_waitcnt vmcnt(31)
    buffer_load_dwordx4 v30, s[44:47], s65 offen offset:2048 nt lds
    s_waitcnt vmcnt(31)
    buffer_load_dwordx4 v31, s[44:47], s65 offen offset:3072 nt lds
    s_waitcnt vmcnt(31)
    s_add_u32 s7, s64, 12288
    s_mov_b32 m0, s7
    s_add_u32 s65, s68, 12288
    buffer_load_dwordx4 v32, s[44:47], s65 offen offset:0 nt lds
    s_waitcnt vmcnt(31)
    buffer_load_dwordx4 v33, s[44:47], s65 offen offset:1024 nt lds
    ds_read_b32 v18, v17
    s_waitcnt vmcnt(31)
    buffer_load_dwordx4 v34, s[44:47], s65 offen offset:2048 nt lds
    s_waitcnt vmcnt(31)
    s_sub_u32 s7, s60, 16
    s_max_i32 s61, s61, s7
    v_mov_b32 v19, s61
    ds_write_b32 v16, v19
    buffer_load_dwordx4 v35, s[44:47], s65 offen offset:3072 nt lds
    s_add_u32 s60, s60, 16
    s_add_u32 s68, s68, 16384
    s_sub_u32 s66, s66, 1
    s_cmp_lg_u32 s66, 0
    s_cbranch_scc1 LL_65
    s_and_b32 s7, s69, 7
    s_lshl_b64 exec, 1, s7
    buffer_store_dwordx2 v[42:43], v38, s[36:39], 0 offen offset:2048 sc1
    s_mov_b64 exec, -1
    s_lshr_b32 s65, s69, 3
    s_lshl_b32 s65, s65, 17
    s_and_b32 s7, s69, 7
    s_lshl_b32 s7, s7, 7
    s_add_u32 s65, s65, s7
    s_mov_b32 s64, 0
    s_mov_b32 s63, 24
    s_waitcnt lgkmcnt(0)
    v_readlane_b32 s79, v18, 0
    s_cmp_lt_u32 s79, s63
    s_cbranch_scc1 ST_69
GO_68:
    s_mov_b32 m0, s64
    s_add_u32 s64, s64, 1024
    buffer_load_dwordx4 v10, s[48:51], s65 offen nt lds
    s_add_u32 s65, s65, 8192
    s_mov_b32 m0, s64
    s_add_u32 s64, s64, 1024
    buffer_load_dwordx4 v10, s[48:51], s65 offen nt lds
    s_add_u32 s65, s65, 8192
    s_mov_b32 m0, s64
    s_add_u32 s64, s64, 1024
    buffer_load_dwordx4 v10, s[48:51], s65 offen nt lds
    s_add_u32 s65, s65, 8192
    s_mov_b32 m0, s64
    s_add_u32 s64, s64, 1024
    buffer_load_dwordx4 v10, s[48:51], s65 offen nt lds
    s_add_u32 s65, s65, 8192
    s_mov_b32 m0, s64
    s_add_u32 s64, s64, 1024
    buffer_load_dwordx4 v10, s[48:51], s65 offen nt lds
    s_add_u32 s65, s65, 8192
    s_mov_b32 m0, s64
    s_add_u32 s64, s64, 1024
    buffer_load_dwordx4 v10, s[48:51], s65 offen nt lds
    s_add_u32 s65, s65, 8192
    s_mov_b32 m0, s64
    s_add_u32 s64, s64, 1024
    buffer_load_dwordx4 v10, s[48:51], s65 offen nt lds
    s_add_u32 s65, s65, 8192
    s_mov_b32 m0, s64
    s_add_u32 s64, s64, 1024
    buffer_load_dwordx4 v10, s[48:51], s65 offen nt lds
    s_add_u32 s65, s65, 8192
    s_mov_b32 m0, s64
    s_add_u32 s64, s64, 1024
    buffer_load_dwordx4 v10, s[48:51], s65 offen nt lds
    s_add_u32 s65, s65, 8192
    s_mov_b32 m0, s64
    s_add_u32 s64, s64, 1024
    buffer_load_dwordx4 v10, s[48:51], s65 offen nt lds
    s_add_u32 s65, s65, 8192
    s_mov_b32 m0, s64
    s_add_u32 s64, s64, 1024
    buffer_load_dwordx4 v10, s[48:51], s65 offen nt lds
    s_add_u32 s65, s65, 8192
    s_mov_b32 m0, s64
    s_add_u32 s64, s64, 1024
    buffer_load_dwordx4 v10, s[48:51], s65 offen nt lds
    s_add_u32 s65, s65, 8192
    s_mov_b32 m0, s64
    s_add_u32 s64, s64, 1024
    buffer_load_dwordx4 v10, s[48:51], s65 offen nt lds
    s_add_u32 s65, s65, 8192
    s_mov_b32 m0, s64
    s_add_u32 s64, s64, 1024
    buffer_load_dwordx4 v10, s[48:51], s65 offen nt lds
    s_add_u32 s65, s65, 8192
    s_mov_b32 m0, s64
    s_add_u32 s64, s64, 1024
    buffer_load_dwordx4 v10, s[48:51], s65 offen nt lds
    s_add_u32 s65, s65, 8192
    s_mov_b32 m0, s64
    s_add_u32 s64, s64, 1024
    buffer_load_dwordx4 v10, s[48:51], s65 offen nt lds
    s_add_u32 s65, s65, 8192
    s_add_u32 s65, s65, 917504
    s_waitcnt vmcnt(40)
    s_sub_u32 s7, s60, 24
    s_max_i32 s61, s61, s7
    v_mov_b32 v19, s61
    ds_write_b32 v16, v19
    s_waitcnt vmcnt(32)
    s_sub_u32 s7, s60, 16
    s_max_i32 s61, s61, s7
    v_mov_b32 v19, s61
    ds_write_b32 v16, v19
    s_waitcnt vmcnt(24)
    s_sub_u32 s7, s60, 8
    s_max_i32 s61, s61, s7
    v_mov_b32 v19, s61
    ds_write_b32 v16, v19
    s_waitcnt vmcnt(16)
    s_mov_b32 s61, s60
    v_mov_b32 v19, s61
    ds_write_b32 v16, v19
    s_add_u32 s60, s60, 16
    s_waitcnt vmcnt(24)
    s_sub_u32 s7, s60, 24
    s_max_i32 s61, s61, s7
    v_mov_b32 v19, s61
    ds_write_b32 v16, v19
    s_waitcnt vmcnt(16)
    s_sub_u32 s7, s60, 16
    s_max_i32 s61, s61, s7
    v_mov_b32 v19, s61
    ds_write_b32 v16, v19
    s_waitcnt vmcnt(8)
    s_sub_u32 s7, s60, 8
    s_max_i32 s61, s61, s7
    v_mov_b32 v19, s61
    ds_write_b32 v16, v19
    s_waitcnt vmcnt(0)
    s_mov_b32 s61, s60
    v_mov_b32 v19, s61
    ds_write_b32 v16, v19
    v_mov_b32 v48, 0x24218
    s_mov_b32 s80, 1600000
LW_70:
    ds_read_b32 v49, v48
    s_waitcnt lgkmcnt(0)
    v_readfirstlane_b32 s79, v49
    s_cmp_ge_u32 s79, 16
    s_cbranch_scc1 LWD_71
    s_sleep 1
    s_sub_u32 s80, s80, 1
    s_cmp_lg_u32 s80, 0
    s_cbranch_scc1 LW_70
LWD_71:
    s_mov_b32 s66, 3
LL_72:
    s_waitcnt vmcnt(31)
    s_mov_b32 m0, s64
    s_add_u32 s64, s64, 1024
    buffer_load_dwordx4 v10, s[48:51], s65 offen nt lds
    s_add_u32 s65, s65, 8192
    s_waitcnt vmcnt(31)
    s_mov_b32 m0, s64
    s_add_u32 s64, s64, 1024
    buffer_load_dwordx4 v10, s[48:51], s65 offen nt lds
    s_add_u32 s65, s65, 8192
    s_waitcnt vmcnt(31)
    s_mov_b32 m0, s64
    s_add_u32 s64, s64, 1024
    buffer_load_dwordx4 v10, s[48:51], s65 offen nt lds
    s_add_u32 s65, s65, 8192
    s_waitcnt vmcnt(31)
    s_mov_b32 m0, s64
    s_add_u32 s64, s64, 1024
    buffer_load_dwordx4 v10, s[48:51], s65 offen nt lds
    s_add_u32 s65, s65, 8192
    s_waitcnt vmcnt(31)
    s_mov_b32 m0, s64
    s_add_u32 s64, s64, 1024
    buffer_load_dwordx4 v10, s[48:51], s65 offen nt lds
    s_add_u32 s65, s65, 8192
    s_waitcnt vmcnt(31)
    s_mov_b32 m0, s64
    s_add_u32 s64, s64, 1024
    buffer_load_dwordx4 v10, s[48:51], s65 offen nt lds
    s_add_u32 s65, s65, 8192
    s_waitcnt vmcnt(31)
    s_mov_b32 m0, s64
    s_add_u32 s64, s64, 1024
    buffer_load_dwordx4 v10, s[48:51], s65 offen nt lds
    s_add_u32 s65, s65, 8192
    s_waitcnt vmcnt(31)
    s_sub_u32 s7, s60, 24
    s_max_i32 s61, s61, s7
    v_mov_b32 v19, s61
    ds_write_b32 v16, v19
    s_mov_b32 m0, s64
    s_add_u32 s64, s64, 1024
    buffer_load_dwordx4 v10, s[48:51], s65 offen nt lds
    s_add_u32 s65, s65, 8192
    s_waitcnt vmcnt(31)
    s_mov_b32 m0, s64
    s_add_u32 s64, s64, 1024
    buffer_load_dwordx4 v10, s[48:51], s65 offen nt lds
    s_add_u32 s65, s65, 8192
    s_waitcnt vmcnt(31)
    s_mov_b32 m0, s64
    s_add_u32 s64, s64, 1024
    buffer_load_dwordx4 v10, s[48:51], s65 offen nt lds
    s_add_u32 s65, s65, 8192
    s_waitcnt vmcnt(31)
    s_mov_b32 m0, s64
    s_add_u32 s64, s64, 1024
    buffer_load_dwordx4 v10, s[48:51], s65 offen nt lds
    s_add_u32 s65, s65, 8192
    s_waitcnt vmcnt(31)
    s_mov_b32 m0, s64
    s_add_u32 s64, s64, 1024
    buffer_load_dwordx4 v10, s[48:51], s65 offen nt lds
    s_add_u32 s65, s65, 8192
    s_waitcnt vmcnt(31)
    s_mov_b32 m0, s64
    s_add_u32 s64, s64, 1024
    buffer_load_dwordx4 v10, s[48:51], s65 offen nt lds
    s_add_u32 s65, s65, 8192
    s_waitcnt vmcnt(31)
    s_mov_b32 m0, s64
    s_add_u32 s64, s64, 1024
    buffer_load_dwordx4 v10, s[48:51], s65 offen nt lds
    s_add_u32 s65, s65, 8192
    s_waitcnt vmcnt(31)
    s_mov_b32 m0, s64
    s_add_u32 s64, s64, 1024
    buffer_load_dwordx4 v10, s[48:51], s65 offen nt lds
    s_add_u32 s65, s65, 8192
    s_waitcnt vmcnt(31)
    s_sub_u32 s7, s60, 16
    s_max_i32 s61, s61, s7
    v_mov_b32 v19, s61
    ds_write_b32 v16, v19
    s_mov_b32 m0, s64
    s_add_u32 s64, s64, 1024
    buffer_load_dwordx4 v10, s[48:51], s65 offen nt lds
    s_add_u32 s65, s65, 8192
    s_add_u32 s60, s60, 16
    s_add_u32 s65, s65, 917504
    s_sub_u32 s66, s66, 1
    s_cmp_lg_u32 s66, 0
    s_cbranch_scc1 LL_72
    s_waitcnt vmcnt(24)
    s_sub_u32 s7, s60, 24
    s_max_i32 s61, s61, s7
    v_mov_b32 v19, s61
    ds_write_b32 v16, v19
    s_waitcnt vmcnt(16)
    s_sub_u32 s7, s60, 16
    s_max_i32 s61, s61, s7
    v_mov_b32 v19, s61
    ds_write_b32 v16, v19
    s_waitcnt vmcnt(8)
    s_sub_u32 s7, s60, 8
    s_max_i32 s61, s61, s7
    v_mov_b32 v19, s61
    ds_write_b32 v16, v19
    s_waitcnt vmcnt(0)
    s_mov_b32 s61, s60
    v_mov_b32 v19, s61
    ds_write_b32 v16, v19
    s_endpgm
L_RED:
    s_and_b32 s7, s4, 7
    s_cbranch_scc1 L_END
    s_add_u32 s61, s4, s5
    s_and_b32 s7, s6, 3
    s_cmp_eq_u32 s7, 3
    s_cbranch_scc1 L_END
    s_cmp_eq_u32 s7, 2
    s_cbranch_scc1 L_REDB
    s_lshl_b32 s60, s61, 1
    s_add_u32 s60, s60, s7
    s_mov_b32 s52, s30
    s_and_b32 s53, s31, 0xffff
    s_mov_b32 s54, 0x2000
    s_mov_b32 s55, 0x20000
    s_mov_b32 s84, 0x3f80
    s_mov_b32 s85, 0x3f800000
    s_lshl_b32 s7, s60, 12
    s_add_u32 s7, s7, 0x280000
    v_lshl_add_u32 v36, v1, 4, s7
    s_lshr_b32 s7, s60, 4
    s_lshl_b32 s7, s7, 11
    s_and_b32 s61, s60, 15
    s_lshl_b32 s61, s61, 6
    s_add_u32 s7, s7, s61
    v_lshl_add_u32 v37, v1, 3, s7
    s_mov_b64 exec, -1
    buffer_load_dwordx4 v[48:51], v36, s[36:39], 0 offen offset:0 sc1
    buffer_load_dwordx4 v[52:55], v36, s[36:39], 0 offen offset:1024 sc1
    buffer_load_dwordx4 v[56:59], v36, s[36:39], 0 offen offset:2048 sc1
    buffer_load_dwordx4 v[60:63], v36, s[36:39], 0 offen offset:3072 sc1
    s_mov_b32 s80, 200000
MC_74:
    s_mov_b64 exec, -1
    s_waitcnt vmcnt(0)
    v_cmp_ne_u64 s[62:63], s[92:93], v[50:51]
    v_cmp_ne_u64 s[64:65], s[92:93], v[54:55]
    v_cmp_ne_u64 s[66:67], s[92:93], v[58:59]
    v_cmp_ne_u64 s[68:69], s[92:93], v[62:63]
    s_or_b64 s[90:91], s[62:63], s[64:65]
    s_or_b64 s[90:91], s[90:91], s[66:67]
    s_or_b64 s[90:91], s[90:91], s[68:69]
    s_cbranch_scc1 M_73
MD_75:
    s_mov_b64 exec, -1
    v_dot2_f32_bf16 v44, v48, s84, 0
    v_dot2_f32_bf16 v45, v48, s85, 0
    v_dot2_f32_bf16 v46, v49, s84, 0
    v_dot2_f32_bf16 v47, v49, s85, 0
    v_dot2_f32_bf16 v44, v52, s84, v44
    v_dot2_f32_bf16 v45, v52, s85, v45
    v_dot2_f32_bf16 v46, v53, s84, v46
    v_dot2_f32_bf16 v47, v53, s85, v47
    v_dot2_f32_bf16 v44, v56, s84, v44
    v_dot2_f32_bf16 v45, v56, s85, v45
    v_dot2_f32_bf16 v46, v57, s84, v46
    v_dot2_f32_bf16 v47, v57, s85, v47
    v_dot2_f32_bf16 v44, v60, s84, v44
    v_dot2_f32_bf16 v45, v60, s85, v45
    v_dot2_f32_bf16 v46, v61, s84, v46
    v_dot2_f32_bf16 v47, v61, s85, v47
    v_add_f32_dpp v44, v44, v44 row_ror:8 row_mask:0xf bank_mask:0xf
    v_add_f32_dpp v45, v45, v45 row_ror:8 row_mask:0xf bank_mask:0xf
    v_add_f32_dpp v46, v46, v46 row_ror:8 row_mask:0xf bank_mask:0xf
    v_add_f32_dpp v47, v47, v47 row_ror:8 row_mask:0xf bank_mask:0xf
    s_nop 0
    v_permlane32_swap_b32 v44, v46
    v_permlane32_swap_b32 v45, v47
    v_add_f32 v44, v44, v46
    v_add_f32 v45, v45, v47
    v_mov_b32 v46, v44
    v_mov_b32 v47, v45
    s_nop 0
    v_permlane16_swap_b32 v44, v46
    v_permlane16_swap_b32 v45, v47
    v_add_f32 v44, v44, v46
    v_add_f32 v45, v45, v47
    v_cvt_pk_bf16_f32 v44, v44, v45
    v_mov_b32 v45, v44
    s_nop 1
    v_permlane32_swap_b32 v44, v45
    s_mov_b64 exec, 0xff
    buffer_store_dwordx2 v[44:45], v37, s[52:55], 0 offen
    s_mov_b64 exec, -1
    s_endpgm
L_REDB:
    s_mov_b32 s52, s30
    s_and_b32 s53, s31, 0xffff
    s_mov_b32 s54, 0x2000
    s_mov_b32 s55, 0x20000
    s_mov_b32 s84, 0x3f80
    s_mov_b32 s85, 0x3f800000
    s_lshl_b32 s7, s61, 11
    s_add_u32 s7, s7, 0x2c0000
    v_lshl_add_u32 v36, v1, 4, s7
    s_lshl_b32 s7, s61, 5
    s_add_u32 s7, s7, 1024
    v_and_b32 v38, 3, v1
    v_lshl_add_u32 v37, v38, 3, s7
    v_lshrrev_b32 v38, 2, v3
    v_lshl_add_u32 v37, v38, 11, v37
    s_mov_b64 exec, -1
    buffer_load_dwordx4 v[48:51], v36, s[36:39], 0 offen offset:0 sc1
    buffer_load_dwordx4 v[52:55], v36, s[36:39], 0 offen offset:1024 sc1
    s_mov_b32 s80, 200000
MC_77:
    s_mov_b64 exec, -1
    s_waitcnt vmcnt(0)
    v_cmp_ne_u64 s[62:63], s[92:93], v[50:51]
    v_cmp_ne_u64 s[64:65], s[92:93], v[54:55]
    s_or_b64 s[90:91], s[62:63], s[64:65]
    s_cbranch_scc1 M_76
MD_78:
    s_mov_b64 exec, -1
    v_dot2_f32_bf16 v44, v48, s84, 0
    v_dot2_f32_bf16 v45, v48, s85, 0
    v_dot2_f32_bf16 v46, v49, s84, 0
    v_dot2_f32_bf16 v47, v49, s85, 0
    v_dot2_f32_bf16 v44, v52, s84, v44
    v_dot2_f32_bf16 v45, v52, s85, v45
    v_dot2_f32_bf16 v46, v53, s84, v46
    v_dot2_f32_bf16 v47, v53, s85, v47
    s_nop 1
    v_permlane32_swap_b32 v44, v46
    v_permlane32_swap_b32 v45, v47
    v_add_f32 v44, v44, v46
    v_add_f32 v45, v45, v47
    v_mov_b32 v46, v44
    v_mov_b32 v47, v45
    s_nop 0
    v_permlane16_swap_b32 v44, v46
    v_permlane16_swap_b32 v45, v47
    v_add_f32 v44, v44, v46
    v_add_f32 v45, v45, v47
    v_cvt_pk_bf16_f32 v44, v44, v45
    v_mov_b32 v45, v44
    s_nop 1
    v_permlane32_swap_b32 v44, v45
    s_mov_b64 exec, 0xffff
    buffer_store_dwordx2 v[44:45], v37, s[52:55], 0 offen
    s_mov_b64 exec, -1
    s_endpgm
L_SIDE:
    v_lshlrev_b32 v10, 2, v0
    v_mov_b32 v24, 0
    v_add_u32 v10, 0x23c00, v10
    ds_write_b32 v10, v24
    s_mov_b32 s61, s6
    v_mov_b32 v28, -1
    v_mov_b32 v29, -1
    v_mov_b32 v30, -1
    v_mov_b32 v31, -1
    s_and_b32 s64, s4, 7
    s_lshl_b32 s64, s64, 3
    s_lshr_b32 s7, s4, 3
    s_lshl_b32 s7, s7, 1
    s_add_u32 s64, s64, s7
    s_add_u32 s64, s64, s5
    s_sub_u32 s64, s64, 6
    s_waitcnt lgkmcnt(0)
    s_mov_b32 s40, s32
    s_and_b32 s41, s33, 0xffff
    s_mov_b32 s42, 0x100
    s_mov_b32 s43, 0x20000
    s_or_b32 s7, s6, s2
    s_cbranch_scc1 NC_79
    s_lshl_b64 s[92:93], s[94:95], 5
    s_or_b32 s93, s93, 0x80000000
    v_mov_b32 v12, s92
    v_mov_b32 v13, s93
    s_mov_b64 exec, 1
    buffer_store_dwordx2 v[12:13], v24, s[40:43], 0 offen sc1
    s_mov_b64 exec, -1
NC_79:
    s_mov_b32 s36, s34
    s_and_b32 s37, s35, 0xffff
    s_mov_b32 s38, 0x1000000
    s_mov_b32 s39, 0x20000
    s_cmp_lt_u32 s5, 4
    s_cbranch_scc1 NB_81
    s_cmp_ge_u32 s5, 6
    s_cbranch_scc1 NQ_80
    s_cmp_lg_u32 s6, 2
    s_cbranch_scc1 NB_81
    s_lshl_b32 s7, s4, 1
    s_add_u32 s7, s7, s5
    s_lshl_b32 s7, s7, 9
    s_sub_u32 s7, s7, 2048
    v_lshl_add_u32 v10, v3, 4, s7
    v_lshl_add_u32 v10, v2, 15, v10
    buffer_store_dwordx4 v[28:31], v10, s[36:39], 0 offen sc1
    buffer_store_dwordx4 v[28:31], v10, s[36:39], 0 offen offset:256 sc1
    s_branch NB_81
NQ_80:
    s_lshl_b32 s65, s64, 2
    s_add_u32 s65, s65, s6
    s_and_b32 s7, s65, 31
    s_lshl_b32 s7, s7, 13
    s_lshr_b32 s62, s64, 3
    s_lshl_b32 s62, s62, 10
    s_add_u32 s7, s7, s62
    s_add_u32 s7, s7, 0x200000
    v_lshl_add_u32 v10, v1, 4, s7
    buffer_store_dwordx4 v[28:31], v10, s[36:39], 0 offen sc1
    s_lshl_b32 s7, s65, 10
    s_add_u32 s7, s7, 0x280000
    v_lshl_add_u32 v10, v1, 7, s7
    s_lshl_b32 s62, s65, 8
    s_add_u32 s7, s62, 0x2c0000
    v_writelane_b32 v10, s7, 8
    s_add_u32 s7, s62, 0x2c0080
    v_writelane_b32 v10, s7, 9
    s_add_u32 s7, s62, 0xc0000
    v_writelane_b32 v10, s7, 10
    s_add_u32 s7, s62, 0xc0080
    v_writelane_b32 v10, s7, 11
    s_lshl_b32 s7, s65, 7
    s_add_u32 s7, s7, 0x28000
    v_writelane_b32 v10, s7, 12
    s_add_u32 s7, s7, 0x8000
    v_writelane_b32 v10, s7, 14
    s_lshl_b32 s7, s65, 4
    s_add_u32 s7, s7, 0x23000
    v_writelane_b32 v10, s7, 13
    s_mov_b64 exec, 0x7fff
    buffer_load_dword v15, v10, s[36:39], 0 offen sc1
    s_mov_b64 exec, -1
    s_getpc_b64 s[84:85]
L_PC:
    s_and_b32 s7, s65, 31
    s_mul_i32 s7, s7, 1280
    v_lshl_add_u32 v10, v1, 7, s7
    v_min_u32 v10, L_END-concat_heads__sliding_block_cached__compressed_kv_cla__decode_kernel, v10
    s_sub_u32 s84, s84, L_PC-concat_heads__sliding_block_cached__compressed_kv_cla__decode_kernel
    s_subb_u32 s85, s85, 0
    v_mov_b32 v11, s85
    v_add_co_u32 v10, vcc, s84, v10
    s_nop 1
    v_addc_co_u32 v11, vcc, 0, v11, vcc
    s_mov_b64 exec, 0x3ff
    global_load_dword v15, v[10:11], off
    s_mov_b64 exec, -1
NB_81:
    s_barrier
    s_cmp_lg_u32 s6, 0
    s_cbranch_scc1 NF_83
    s_mov_b32 s80, 800000
    s_sleep 4
NL_85:
    s_mov_b64 exec, 1
    buffer_load_dwordx2 v[12:13], v24, s[40:43], 0 offen sc1
    s_mov_b64 exec, -1
    s_waitcnt vmcnt(0)
    v_readfirstlane_b32 s92, v12
    v_readfirstlane_b32 s93, v13
    s_sub_u32 s80, s80, 1
    s_cbranch_scc1 NH_86
    s_cmp_eq_u32 s93, 0
    s_cbranch_scc1 NL_85
    s_sub_u32 s7, s94, 1500
    s_lshl_b32 s7, s7, 5
    s_sub_u32 s7, s92, s7
    s_cmp_ge_i32 s7, 0
    s_cbranch_scc1 NH_86
    s_cmp_gt_u32 s80, 799960
    s_cbranch_scc1 NL_85
NH_86:
    v_mov_b32 v11, 0x24248
    v_mov_b32 v12, s92
    v_mov_b32 v13, s93
    ds_write_b64 v11, v[12:13]
    v_mov_b32 v11, 0x24204
    v_mov_b32 v14, 1
    s_mov_b64 exec, 1
    ds_add_u32 v11, v14
    s_mov_b64 exec, -1
NF_83:
    s_cmp_lg_u32 s6, 1
    s_cbranch_scc1 NP_82
    s_lshl_b32 s65, s4, 7
    s_add_u32 s65, s65, 0x21000
    s_lshr_b32 s7, s64, 3
    s_lshl_b32 s7, s7, 7
    s_add_u32 s7, s7, 0x22000
    s_and_b32 s62, s64, 7
    s_cmp_lt_u32 s5, 6
    s_cselect_b32 s7, s65, s7
    s_cselect_b32 s62, s5, s62
    v_lshl_add_u32 v11, v1, 3, s7
    s_sleep 12
    s_memrealtime s[88:89]
    s_waitcnt lgkmcnt(0)
    s_or_b32 s89, s89, s78
    v_mov_b32 v12, s88
    v_mov_b32 v13, s89
    s_lshl_b64 exec, 1, s62
    buffer_store_dwordx2 v[12:13], v11, s[36:39], 0 offen
    s_mov_b64 exec, -1
    s_cmp_ge_u32 s5, 6
    s_cbranch_scc1 NP_82
    s_sleep 24
    s_or_b32 s95, s95, s78
    s_add_u32 s88, s94, 0x10000
    s_addc_u32 s89, s95, 0
    s_mov_b32 s101, 16
    s_mov_b64 exec, 0x3f
U_87:
    buffer_load_dwordx2 v[14:15], v11, s[36:39], 0 offen sc1 nt
UU_88:
    s_waitcnt vmcnt(0)
    v_cmp_gt_u64 s[90:91], s[94:95], v[14:15]
    v_cmp_le_u64 vcc, s[88:89], v[14:15]
    s_or_b64 vcc, vcc, s[90:91]
    s_cbranch_scc0 UD_89
    s_sleep 8
    s_sub_u32 s101, s101, 1
    s_cmp_lg_u32 s101, 0
    s_cbranch_scc1 U_87
UD_89:
    s_mov_b64 exec, -1
    s_min_u32 s7, s101, 1
    s_add_u32 s7, s7, 16
    v_mov_b32 v12, 0x24200
    v_mov_b32 v13, s7
    s_mov_b64 exec, 1
    ds_add_u32 v12, v13
    s_mov_b64 exec, -1
NP_82:
    s_cmp_ge_u32 s5, 6
    s_cbranch_scc1 L_BATT
    s_cmp_lt_u32 s5, 4
    s_cbranch_scc1 NG_84
    s_cmp_lg_u32 s6, 2
    s_cbranch_scc1 NG_84
    s_lshl_b32 s7, s4, 4
    s_add_u32 s7, s7, s5
    s_lshl_b32 s7, s7, 3
    s_add_u32 s7, s7, 0x1ffe0
    v_mov_b32 v11, s7
    s_waitcnt vmcnt(0)
    v_mov_b32 v12, 0x24208
    v_mov_b32 v13, 16
    s_mov_b64 exec, 1
    ds_add_u32 v12, v13
    s_mov_b64 exec, -1
    v_mov_b32 v16, 0x24204
    s_mov_b32 s80, 1600000
LW_90:
    ds_read_b32 v17, v16
    s_waitcnt lgkmcnt(0)
    v_readfirstlane_b32 s79, v17
    s_cmp_ge_u32 s79, 1
    s_cbranch_scc1 LWD_91
    s_sleep 1
    s_sub_u32 s80, s80, 1
    s_cmp_lg_u32 s80, 0
    s_cbranch_scc1 LW_90
LWD_91:
    v_mov_b32 v16, 0x24248
    ds_read_b64 v[18:19], v16
    s_waitcnt lgkmcnt(0)
    v_readfirstlane_b32 s92, v18
    v_readfirstlane_b32 s93, v19
    s_mov_b64 exec, 1
    buffer_store_dwordx2 v[18:19], v11, s[36:39], 0 offen sc1
    s_mov_b64 exec, -1
NG_84:
    s_mov_b32 s96, 0x6010600
    s_mov_b32 s97, 0x6030602
    s_cmp_eq_u32 s5, 1
    s_cselect_b32 s96, 0x6190618, s96
    s_cselect_b32 s97, 0x61b061a, s97
    s_cmp_eq_u32 s5, 2
    s_cselect_b32 s96, 0x6310630, s96
    s_cselect_b32 s97, 0x6330632, s97
    s_cmp_eq_u32 s5, 3
    s_cselect_b32 s96, 0x6490648, s96
    s_cselect_b32 s97, 0x64b064a, s97
    s_cmp_eq_u32 s5, 4
    s_cselect_b32 s96, 0x4610460, s96
    s_cselect_b32 s97, 0x4630462, s97
    s_cmp_eq_u32 s5, 5
    s_cselect_b32 s96, 0x4710470, s96
    s_cselect_b32 s97, 0x4730472, s97
    s_lshl_b32 s7, s61, 4
    s_lshr_b64 s[90:91], s[96:97], s7
    s_and_b32 s66, s90, 3
    s_bfe_u32 s67, s90, 0x50002
    s_bfe_u32 s68, s90, 0x40008
    s_lshl_b32 s7, s4, 15
    s_lshl_b32 s63, s66, 9
    s_add_u32 s7, s7, s63
    s_add_u32 s7, s7, 0x100000
    v_and_b32 v20, 31, v1
    v_lshl_add_u32 v7, v20, 4, s7
    v_lshrrev_b32 v21, 5, v1
    v_lshl_add_u32 v7, v21, 11, v7
    v_add_u32 v22, 4096, v7
    s_mul_i32 s7, s66, 320
    s_add_u32 s63, s7, 0x24400
    v_lshl_add_u32 v6, v20, 3, s63
    v_lshl_add_u32 v6, v21, 2, v6
    s_mov_b32 s70, 0x3f80
    s_mov_b32 s71, 0x3f800000
    v_mov_b32 v12, 0x24200
    s_mov_b32 s80, 1600000
LW_92:
    ds_read_b32 v13, v12
    s_waitcnt lgkmcnt(0)
    v_readfirstlane_b32 s79, v13
    s_cmp_ge_u32 s79, 16
    s_cbranch_scc1 LWD_93
    s_sleep 4
    s_sub_u32 s80, s80, 1
    s_cmp_lg_u32 s80, 0
    s_cbranch_scc1 LW_92
LWD_93:
    s_and_b32 s101, s79, 15
    v_mov_b32 v16, 0x24204
    s_mov_b32 s80, 1600000
LW_94:
    ds_read_b32 v17, v16
    s_waitcnt lgkmcnt(0)
    v_readfirstlane_b32 s79, v17
    s_cmp_ge_u32 s79, 1
    s_cbranch_scc1 LWD_95
    s_sleep 1
    s_sub_u32 s80, s80, 1
    s_cmp_lg_u32 s80, 0
    s_cbranch_scc1 LW_94
LWD_95:
    v_mov_b32 v16, 0x24248
    ds_read_b64 v[18:19], v16
    s_waitcnt lgkmcnt(0)
    v_readfirstlane_b32 s92, v18
    v_readfirstlane_b32 s93, v19
    s_cmp_lt_u32 s5, 4
    s_cselect_b32 s65, 16, 148
    s_cselect_b32 s7, 0, 4294967288
    s_add_u32 s7, s7, 0x24210
    v_mov_b32 v12, s7
    s_mov_b32 s80, 1600000
LW_96:
    ds_read_b32 v13, v12
    s_waitcnt lgkmcnt(0)
    v_readfirstlane_b32 s79, v13
    s_cmp_ge_u32 s79, s65
    s_cbranch_scc1 LWD_97
    s_sleep 4
    s_sub_u32 s80, s80, 1
    s_cmp_lg_u32 s80, 0
    s_cbranch_scc1 LW_96
LWD_97:
    s_sleep 16
    s_mov_b64 exec, -1
    buffer_load_dwordx4 v[48:51], v7, s[36:39], 0 offen sc1 nt
    buffer_load_dwordx4 v[52:55], v22, s[36:39], 0 offen sc1 nt
    s_mov_b32 s80, 200000
MC_99:
    s_mov_b64 exec, -1
    s_waitcnt vmcnt(0)
    v_cmp_ne_u64 s[44:45], s[92:93], v[50:51]
    v_cmp_ne_u64 s[46:47], s[92:93], v[54:55]
    s_or_b64 s[90:91], s[44:45], s[46:47]
    s_cbranch_scc1 M_98
MD_100:
    s_mov_b64 exec, -1
    v_dot2_f32_bf16 v24, v48, s70, 0
    v_dot2_f32_bf16 v25, v48, s71, 0
    v_dot2_f32_bf16 v26, v49, s70, 0
    v_dot2_f32_bf16 v27, v49, s71, 0
    v_dot2_f32_bf16 v24, v52, s70, v24
    v_dot2_f32_bf16 v25, v52, s71, v25
    v_dot2_f32_bf16 v26, v53, s70, v26
    v_dot2_f32_bf16 v27, v53, s71, v27
    s_nop 1
    v_permlane32_swap_b32 v24, v26
    v_permlane32_swap_b32 v25, v27
    v_add_f32 v24, v24, v26
    v_add_f32 v25, v25, v27
    v_cvt_pk_bf16_f32 v24, v24, v25
    ds_write_b32 v6, v24
L_AATT:
    v_lshl_add_u32 v8, v2, 4, s63
    s_waitcnt lgkmcnt(0)
    ds_read_b128 v[16:19], v8 offset:0
    ds_read_b128 v[20:23], v8 offset:64
    ds_read_b128 v[24:27], v8 offset:128
    ds_read_b128 v[28:31], v8 offset:192
    v_xor_b32 v4, v3, v2
    v_lshlrev_b32 v4, 4, v4
    v_lshl_add_u32 v4, v3, 8, v4
    v_lshrrev_b32 v9, 2, v1
    v_and_b32 v5, 7, v9
    v_lshlrev_b32 v5, 5, v5
    v_lshl_add_u32 v5, v9, 8, v5
    v_and_b32 v10, 3, v1
    v_lshl_add_u32 v5, v10, 3, v5
    s_lshl_b32 s7, s61, 10
    s_add_u32 s7, s7, 0x24e00
    v_lshl_add_u32 v6, v2, 4, s7
    v_cmp_eq_u32 s[84:85], 0, v3
    s_mov_b32 s72, 0x3e0293ee
    s_cmp_ge_u32 s5, 4
    s_cselect_b32 s73, 6, 6
    s_cselect_b32 s69, 8, 0
    s_cselect_b32 s70, 17, 1
    s_cselect_b32 s74, 16, 24
    s_add_u32 s70, s70, s61
    s_add_u32 s74, s74, s70
    s_lshl_b32 s70, s70, 3
    s_add_u32 s69, s69, s61
    s_cmp_ge_u32 s69, 18
    s_cselect_b32 s7, 18, 0
    s_sub_u32 s69, s69, s7
    s_mov_b32 s71, s68
AK_101:
    s_lshl_b32 s7, s69, 13
    v_add_u32 v104, s7, v4
    v_xor_b32 v105, 0x40, v104
    v_xor_b32 v106, 0x80, v104
    v_xor_b32 v107, 0xc0, v104
    s_lshl_b32 s62, s69, 2
    s_add_u32 s62, s62, 0x24100
    v_mov_b32 v8, 0x24000
    s_mov_b32 s80, 1600000
LW_102:
    ds_read_b32 v9, v8
    s_waitcnt lgkmcnt(0)
    v_readfirstlane_b32 s79, v9
    s_cmp_ge_u32 s79, s70
    s_cbranch_scc1 LWD_103
    s_sleep 2
    s_sub_u32 s80, s80, 1
    s_cmp_lg_u32 s80, 0
    s_cbranch_scc1 LW_102
LWD_103:
    ds_read_b128 v[32:35], v104 offset:0
    ds_read_b128 v[36:39], v104 offset:4096
    ds_read_b128 v[40:43], v105 offset:0
    ds_read_b128 v[44:47], v105 offset:4096
    ds_read_b128 v[48:51], v106 offset:0
    ds_read_b128 v[52:55], v106 offset:4096
    ds_read_b128 v[56:59], v107 offset:0
    ds_read_b128 v[60:63], v107 offset:4096
    s_waitcnt lgkmcnt(6)
    v_mfma_f32_16x16x32_bf16 v[64:67], v[32:35], v[16:19], 0
    v_mfma_f32_16x16x32_bf16 v[68:71], v[36:39], v[16:19], 0
    s_waitcnt lgkmcnt(4)
    v_mfma_f32_16x16x32_bf16 v[64:67], v[40:43], v[20:23], v[64:67]
    v_mfma_f32_16x16x32_bf16 v[68:71], v[44:47], v[20:23], v[68:71]
    s_waitcnt lgkmcnt(2)
    v_mfma_f32_16x16x32_bf16 v[64:67], v[48:51], v[24:27], v[64:67]
    v_mfma_f32_16x16x32_bf16 v[68:71], v[52:55], v[24:27], v[68:71]
    s_waitcnt lgkmcnt(0)
    v_mfma_f32_16x16x32_bf16 v[64:67], v[56:59], v[28:31], v[64:67]
    v_mfma_f32_16x16x32_bf16 v[68:71], v[60:63], v[28:31], v[68:71]
    v_mov_b32 v8, s62
    v_mov_b32 v9, 4
    s_mov_b64 exec, 1
    ds_add_u32 v8, v9
    s_mov_b64 exec, -1
    s_mov_b64 exec, s[84:85]
    s_nop 0
    ds_write_b128 v6, v[64:67] offset:0
    ds_write_b128 v6, v[68:71] offset:64
    s_mov_b64 exec, -1
    v_add_u32 v6, 128, v6
    s_add_u32 s69, s69, 4
    s_cmp_ge_u32 s69, 18
    s_cselect_b32 s7, 18, 0
    s_sub_u32 s69, s69, s7
    s_add_u32 s70, s70, 32
    s_sub_u32 s71, s71, 1
    s_cmp_lg_u32 s71, 0
    s_cbranch_scc1 AK_101
    v_lshrrev_b32 v8, 2, v1
    v_cmp_gt_u32 s[86:87], s68, v8
    v_and_b32 v8, 7, v8
    v_and_b32 v9, 3, v1
    v_lshlrev_b32 v9, 4, v9
    v_lshl_add_u32 v10, v8, 7, v9
    s_lshl_b32 s7, s61, 10
    s_add_u32 s7, s7, 0x24e00
    v_add_u32 v10, s7, v10
    s_waitcnt lgkmcnt(0)
    ds_read_b128 v[32:35], v10
    ds_read_b128 v[36:39], v10 offset:64
    s_lshl_b32 s7, s61, 9
    s_add_u32 s7, s7, 0x25e00
    v_lshl_add_u32 v10, v8, 6, v9
    v_add_u32 v10, s7, v10
    v_lshl_add_u32 v7, v2, 4, s7
    v_mov_b32 v11, 0xff800000
    s_waitcnt lgkmcnt(0)
    v_cndmask_b32 v32, v11, v32, s[86:87]
    v_cndmask_b32 v33, v11, v33, s[86:87]
    v_cndmask_b32 v34, v11, v34, s[86:87]
    v_cndmask_b32 v35, v11, v35, s[86:87]
    v_cndmask_b32 v36, v11, v36, s[86:87]
    v_cndmask_b32 v37, v11, v37, s[86:87]
    v_cndmask_b32 v38, v11, v38, s[86:87]
    v_cndmask_b32 v39, v11, v39, s[86:87]
    v_max3_f32 v64, v32, v33, v34
    v_max3_f32 v64, v64, v35, v36
    v_max3_f32 v64, v64, v37, v38
    v_max_f32 v64, v64, v39
    s_nop 1
    v_max_f32_dpp v64, v64, v64 row_ror:1 row_mask:0xf bank_mask:0xf
    s_nop 1
    v_max_f32_dpp v64, v64, v64 row_ror:2 row_mask:0xf bank_mask:0xf
    s_nop 1
    v_max_f32_dpp v64, v64, v64 row_ror:4 row_mask:0xf bank_mask:0xf
    s_nop 1
    v_max_f32_dpp v64, v64, v64 row_ror:8 row_mask:0xf bank_mask:0xf
    v_mov_b32 v11, v64
    s_nop 1
    v_permlane32_swap_b32 v64, v11
    v_max_f32 v64, v64, v11
    v_mov_b32 v11, v64
    s_nop 1
    v_permlane16_swap_b32 v64, v11
    v_max_f32 v64, v64, v11
    v_mul_f32 v64, s72, v64
    v_fma_f32 v32, v32, s72, -v64
    v_fma_f32 v33, v33, s72, -v64
    v_fma_f32 v34, v34, s72, -v64
    v_fma_f32 v35, v35, s72, -v64
    v_fma_f32 v36, v36, s72, -v64
    v_fma_f32 v37, v37, s72, -v64
    v_fma_f32 v38, v38, s72, -v64
    v_fma_f32 v39, v39, s72, -v64
    v_exp_f32 v32, v32
    v_exp_f32 v33, v33
    v_exp_f32 v34, v34
    v_exp_f32 v35, v35
    v_exp_f32 v36, v36
    v_exp_f32 v37, v37
    v_exp_f32 v38, v38
    v_exp_f32 v39, v39
    v_cvt_pk_bf16_f32 v112, v32, v33
    v_cvt_pk_bf16_f32 v113, v34, v35
    v_cvt_pk_bf16_f32 v114, v36, v37
    v_cvt_pk_bf16_f32 v115, v38, v39
    s_mov_b64 exec, s[86:87]
    ds_write_b128 v10, v[112:115]
    s_mov_b64 exec, -1
    v_add_f32 v32, v32, v36
    v_add_f32 v33, v33, v37
    v_add_f32 v34, v34, v38
    v_add_f32 v35, v35, v39
    v_add_f32 v32, v32, v34
    v_add_f32 v33, v33, v35
    v_add_f32 v32, v32, v33
    v_mov_b32 v65, v32
    s_nop 1
    v_add_f32_dpp v65, v65, v65 row_ror:1 row_mask:0xf bank_mask:0xf
    s_nop 1
    v_add_f32_dpp v65, v65, v65 row_ror:2 row_mask:0xf bank_mask:0xf
    s_nop 1
    v_add_f32_dpp v65, v65, v65 row_ror:4 row_mask:0xf bank_mask:0xf
    s_nop 1
    v_add_f32_dpp v65, v65, v65 row_ror:8 row_mask:0xf bank_mask:0xf
    v_mov_b32 v11, v65
    s_nop 1
    v_permlane32_swap_b32 v65, v11
    v_add_f32 v65, v65, v11
    v_mov_b32 v11, v65
    s_nop 1
    v_permlane16_swap_b32 v65, v11
    v_add_f32 v65, v65, v11
    v_mov_b32 v8, 0x24204
    s_mov_b32 s80, 1600000
LW_104:
    ds_read_b32 v9, v8
    s_waitcnt lgkmcnt(0)
    v_readfirstlane_b32 s79, v9
    s_cmp_ge_u32 s79, 1
    s_cbranch_scc1 LWD_105
    s_sleep 1
    s_sub_u32 s80, s80, 1
    s_cmp_lg_u32 s80, 0
    s_cbranch_scc1 LW_104
LWD_105:
    v_mov_b32 v8, 0x24248
    ds_read_b64 v[10:11], v8
    s_waitcnt lgkmcnt(0)
    v_readfirstlane_b32 s92, v10
    v_readfirstlane_b32 s93, v11
    s_nop 0
    v_mov_b32 v66, s92
    v_mov_b32 v67, s93
    s_lshl_b32 s7, s4, 2
    s_add_u32 s7, s7, s66
    s_lshl_b32 s7, s7, 3
    s_add_u32 s7, s7, s5
    s_lshl_b32 s7, s7, 4
    s_add_u32 s7, s7, 0x24000
    v_mov_b32 v8, s7
    s_mov_b64 exec, 1
    s_cmp_eq_u32 s101, 0
    s_cbranch_scc1 SU_106
    buffer_store_dwordx4 v[64:67], v8, s[36:39], 0 offen
SV_107:
    s_mov_b64 exec, -1
    s_and_b32 s7, s7, -128
    v_lshl_add_u32 v12, v1, 4, s7
    v_or_b32 v70, 1, v66
    v_mov_b32 v71, v67
    v_mov_b32 v116, 0xff800000
    v_mov_b32 v117, 0
    v_mov_b32 v72, 0
    v_mov_b32 v73, 0
    v_mov_b32 v74, 0
    v_mov_b32 v75, 0
    v_mov_b32 v76, 0
    v_mov_b32 v77, 0
    v_mov_b32 v78, 0
    v_mov_b32 v79, 0
    v_mov_b32 v80, 0
    v_mov_b32 v81, 0
    v_mov_b32 v82, 0
    v_mov_b32 v83, 0
    v_mov_b32 v84, 0
    v_mov_b32 v85, 0
    v_mov_b32 v86, 0
    v_mov_b32 v87, 0
    v_mov_b32 v88, 0
    v_mov_b32 v89, 0
    v_mov_b32 v90, 0
    v_mov_b32 v91, 0
    v_mov_b32 v92, 0
    v_mov_b32 v93, 0
    v_mov_b32 v94, 0
    v_mov_b32 v95, 0
    v_mov_b32 v96, 0
    v_mov_b32 v97, 0
    v_mov_b32 v98, 0
    v_mov_b32 v99, 0
    v_mov_b32 v100, 0
    v_mov_b32 v101, 0
    v_mov_b32 v102, 0
    v_mov_b32 v103, 0
    s_lshl_b32 s7, s4, 4
    s_add_u32 s7, s7, s5
    s_lshl_b32 s7, s7, 2
    s_add_u32 s7, s7, s66
    s_lshl_b32 s7, s7, 9
    s_add_u32 s7, s7, 0x100000
    v_lshl_add_u32 v6, v1, 4, s7
    s_cmp_lt_u32 s5, 4
    s_cbranch_scc1 AE_108
    v_mov_b32 v13, 0
    s_mov_b64 exec, 0x01010101
    buffer_store_dword v13, v6, s[36:39], 0 offen
    buffer_load_dword v13, v6, s[36:39], 0 offen sc1 nt
    s_mov_b64 exec, -1
AE_108:
    s_add_u32 s69, s73, s61
    s_lshl_b32 s70, s74, 3
    s_cmp_ge_u32 s69, 18
    s_cselect_b32 s7, 18, 0
    s_sub_u32 s69, s69, s7
    s_mov_b32 s71, s68
    s_mov_b32 s73, 0
AV_109:
    s_lshl_b32 s7, s69, 13
    v_add_u32 v104, s7, v5
    v_xor_b32 v105, 0x20, v104
    v_xor_b32 v106, 0x40, v104
    v_xor_b32 v107, 0x60, v104
    v_xor_b32 v108, 0x80, v104
    v_xor_b32 v109, 0xa0, v104
    v_xor_b32 v110, 0xc0, v104
    v_xor_b32 v111, 0xe0, v104
    s_lshl_b32 s62, s69, 2
    s_add_u32 s62, s62, 0x24100
    ds_read_b128 v[112:115], v7
    v_add_u32 v7, 64, v7
    s_cmp_le_u32 s71, 2
    s_cbranch_scc1 AW_110
AWB_111:
    v_mov_b32 v8, 0x24000
    s_mov_b32 s80, 1600000
LW_112:
    ds_read_b32 v9, v8
    s_waitcnt lgkmcnt(0)
    v_readfirstlane_b32 s79, v9
    s_cmp_ge_u32 s79, s70
    s_cbranch_scc1 LWD_113
    s_sleep 1
    s_sub_u32 s80, s80, 1
    s_cmp_lg_u32 s80, 0
    s_cbranch_scc1 LW_112
LWD_113:
    ds_read_b64_tr_b16 v[32:33], v104
    ds_read_b64_tr_b16 v[34:35], v104 offset:4096
    ds_read_b64_tr_b16 v[36:37], v105
    ds_read_b64_tr_b16 v[38:39], v105 offset:4096
    ds_read_b64_tr_b16 v[40:41], v106
    ds_read_b64_tr_b16 v[42:43], v106 offset:4096
    ds_read_b64_tr_b16 v[44:45], v107
    ds_read_b64_tr_b16 v[46:47], v107 offset:4096
    ds_read_b64_tr_b16 v[48:49], v108
    ds_read_b64_tr_b16 v[50:51], v108 offset:4096
    ds_read_b64_tr_b16 v[52:53], v109
    ds_read_b64_tr_b16 v[54:55], v109 offset:4096
    ds_read_b64_tr_b16 v[56:57], v110
    ds_read_b64_tr_b16 v[58:59], v110 offset:4096
    s_waitcnt lgkmcnt(12)
    v_mfma_f32_16x16x32_bf16 v[72:75], v[112:115], v[32:35], v[72:75]
    ds_read_b64_tr_b16 v[60:61], v111
    ds_read_b64_tr_b16 v[62:63], v111 offset:4096
    s_waitcnt lgkmcnt(12)
    v_mfma_f32_16x16x32_bf16 v[76:79], v[112:115], v[36:39], v[76:79]
    s_waitcnt lgkmcnt(10)
    v_mfma_f32_16x16x32_bf16 v[80:83], v[112:115], v[40:43], v[80:83]
    s_waitcnt lgkmcnt(8)
    v_mfma_f32_16x16x32_bf16 v[84:87], v[112:115], v[44:47], v[84:87]
    s_waitcnt lgkmcnt(6)
    v_mfma_f32_16x16x32_bf16 v[88:91], v[112:115], v[48:51], v[88:91]
    s_waitcnt lgkmcnt(4)
    v_mfma_f32_16x16x32_bf16 v[92:95], v[112:115], v[52:55], v[92:95]
    s_waitcnt lgkmcnt(2)
    v_mfma_f32_16x16x32_bf16 v[96:99], v[112:115], v[56:59], v[96:99]
    s_waitcnt lgkmcnt(0)
    v_mfma_f32_16x16x32_bf16 v[100:103], v[112:115], v[60:63], v[100:103]
    v_mov_b32 v8, s62
    v_mov_b32 v9, 4
    s_mov_b64 exec, 1
    ds_add_u32 v8, v9
    s_mov_b64 exec, -1
    s_add_u32 s69, s69, s73
    s_lshl3_add_u32 s70, s73, s70
    s_add_u32 s69, s69, 4
    s_cmp_ge_u32 s69, 18
    s_cselect_b32 s7, 18, 0
    s_sub_u32 s69, s69, s7
    s_add_u32 s70, s70, 32
    s_sub_u32 s71, s71, 1
    s_cmp_lg_u32 s71, 0
    s_cbranch_scc1 AV_109
    v_mov_b32_dpp v72, v88 quad_perm:[0,1,2,3] row_mask:0x2 bank_mask:0xf
    v_mov_b32_dpp v76, v92 quad_perm:[0,1,2,3] row_mask:0x2 bank_mask:0xf
    v_mov_b32_dpp v80, v96 quad_perm:[0,1,2,3] row_mask:0x2 bank_mask:0xf
    v_mov_b32_dpp v84, v100 quad_perm:[0,1,2,3] row_mask:0x2 bank_mask:0xf
    v_mul_f32 v72, s72, v72
    v_mul_f32 v76, s72, v76
    v_mul_f32 v80, s72, v80
    v_mul_f32 v84, s72, v84
    v_cvt_pk_bf16_f32 v68, v72, v76
    v_cvt_pk_bf16_f32 v69, v80, v84
    s_mov_b64 exec, 0xffffffff
    s_cmp_eq_u32 s101, 0
    s_cbranch_scc1 SU_114
    buffer_store_dwordx4 v[68:71], v6, s[36:39], 0 offen
SV_115:
    s_mov_b64 exec, -1
    v_mov_b32 v8, 0x24214
    v_mov_b32 v9, 1
    s_mov_b64 exec, 1
    ds_add_u32 v8, v9
    s_mov_b64 exec, -1
    s_endpgm
L_ASVC:
    v_bfe_u32 v24, v1, 2, 2
    v_lshl_add_u32 v4, v24, 4, v2
    v_lshlrev_b32 v4, 8, v4
    v_and_b32 v25, 1, v2
    v_lshl_or_b32 v24, v24, 1, v25
    s_lshl_b32 s7, s61, 1
    v_xor_b32 v24, s7, v24
    v_lshl_add_u32 v4, v24, 5, v4
    v_and_b32 v24, 3, v1
    v_lshl_add_u32 v4, v24, 3, v4
    v_add_u32 v4, 0x18000, v4
    v_xor_b32 v9, 32, v4
    v_lshlrev_b32 v8, 16, v24
    v_and_b32 v26, 4, v1
    v_lshl_add_u32 v8, v26, 4, v8
    v_lshl_add_u32 v8, v2, 4, v8
    s_lshl_b32 s7, s5, 2
    s_add_u32 s7, s7, s61
    s_lshl_b32 s7, s7, 5
    s_add_u32 s7, s7, s4
    s_lshl_b32 s7, s7, 7
    s_add_u32 s7, s7, 0x280000
    v_add_u32 v8, s7, v8
    v_cmp_gt_u32 s[84:85], 8, v3
    s_lshl_b32 s7, s4, 15
    s_lshl_b32 s62, s61, 9
    s_add_u32 s7, s7, s62
    s_add_u32 s7, s7, 0x100000
    v_and_b32 v26, 31, v1
    v_lshl_add_u32 v5, v26, 4, s7
    v_lshrrev_b32 v26, 5, v1
    v_lshl_add_u32 v5, v26, 11, v5
    s_mul_i32 s7, s61, 320
    s_add_u32 s7, s7, 0x26600
    v_lshl_add_u32 v6, v3, 4, s7
    v_lshl_add_u32 v6, v25, 3, v6
    v_lshl_add_u32 v6, v26, 2, v6
    v_mul_u32_u24 v7, 320, v24
    v_lshl_add_u32 v7, v2, 4, v7
    v_add_u32 v7, 0x26600, v7
    s_or_b64 s[94:95], s[92:93], 1
    v_mov_b32 v18, s92
    v_mov_b32 v19, s93
    s_mov_b32 s62, 4096
    s_mov_b32 s63, 8192
    s_mov_b32 s70, 0x3f80
    s_mov_b32 s71, 0x3f800000
    v_mov_b32 v28, 0x24214
    s_mov_b32 s80, 1600000
LW_116:
    ds_read_b32 v29, v28
    s_waitcnt lgkmcnt(0)
    v_readfirstlane_b32 s79, v29
    s_cmp_ge_u32 s79, 4
    s_cbranch_scc1 LWD_117
    s_sleep 2
    s_sub_u32 s80, s80, 1
    s_cmp_lg_u32 s80, 0
    s_cbranch_scc1 LW_116
LWD_117:
    s_setprio 2
    s_mov_b64 exec, -1
    buffer_load_dwordx4 v[112:115], v5, s[36:39], 0 offen sc1 nt
    buffer_load_dwordx4 v[116:119], v5, s[36:39], s62 offen sc1 nt
    buffer_load_dwordx4 v[120:123], v5, s[36:39], s63 offen sc1 nt
    v_mov_b32 v28, 0x24000
    s_mov_b32 s80, 1600000
LW_121:
    ds_read_b32 v29, v28
    s_waitcnt lgkmcnt(0)
    v_readfirstlane_b32 s79, v29
    s_cmp_ge_u32 s79, 416
    s_cbranch_scc1 LWD_122
    s_sub_u32 s80, s80, 1
    s_cmp_lg_u32 s80, 0
    s_cbranch_scc1 LW_121
LWD_122:
    ds_read_b64_tr_b16 v[32:33], v4 offset:0
    ds_read_b64_tr_b16 v[34:35], v4 offset:16384
    ds_read_b64_tr_b16 v[48:49], v9 offset:0
    ds_read_b64_tr_b16 v[50:51], v9 offset:16384
    ds_read_b64_tr_b16 v[36:37], v4 offset:1024
    ds_read_b64_tr_b16 v[38:39], v4 offset:17408
    ds_read_b64_tr_b16 v[52:53], v9 offset:1024
    ds_read_b64_tr_b16 v[54:55], v9 offset:17408
    ds_read_b64_tr_b16 v[40:41], v4 offset:2048
    ds_read_b64_tr_b16 v[42:43], v4 offset:18432
    ds_read_b64_tr_b16 v[56:57], v9 offset:2048
    ds_read_b64_tr_b16 v[58:59], v9 offset:18432
    ds_read_b64_tr_b16 v[44:45], v4 offset:3072
    ds_read_b64_tr_b16 v[46:47], v4 offset:19456
    ds_read_b64_tr_b16 v[60:61], v9 offset:3072
    ds_read_b64_tr_b16 v[62:63], v9 offset:19456
    s_mov_b32 s80, 200000
MC_119:
    s_mov_b64 exec, -1
    s_waitcnt vmcnt(0)
    v_cmp_ne_u64 s[64:65], s[94:95], v[114:115]
    v_cmp_ne_u64 s[66:67], s[94:95], v[118:119]
    v_cmp_ne_u64 s[68:69], s[94:95], v[122:123]
    s_or_b64 s[90:91], s[64:65], s[66:67]
    s_or_b64 s[90:91], s[90:91], s[68:69]
    s_cbranch_scc1 M_118
MD_120:
    s_mov_b64 exec, -1
    v_dot2_f32_bf16 v104, v112, s70, 0
    v_dot2_f32_bf16 v105, v112, s71, 0
    v_dot2_f32_bf16 v106, v113, s70, 0
    v_dot2_f32_bf16 v107, v113, s71, 0
    v_dot2_f32_bf16 v104, v116, s70, v104
    v_dot2_f32_bf16 v105, v116, s71, v105
    v_dot2_f32_bf16 v106, v117, s70, v106
    v_dot2_f32_bf16 v107, v117, s71, v107
    v_dot2_f32_bf16 v104, v120, s70, v104
    v_dot2_f32_bf16 v105, v120, s71, v105
    v_dot2_f32_bf16 v106, v121, s70, v106
    v_dot2_f32_bf16 v107, v121, s71, v107
    s_nop 1
    v_permlane32_swap_b32 v104, v106
    v_permlane32_swap_b32 v105, v107
    v_add_f32 v104, v104, v106
    v_add_f32 v105, v105, v107
    v_cvt_pk_bf16_f32 v104, v104, v105
    ds_write_b32 v6, v104
    s_add_u32 s81, s81, 4
    v_mov_b32 v24, 0x2420c
    v_mov_b32 v25, 1
    s_mov_b64 exec, 1
    ds_add_u32 v24, v25
    s_mov_b64 exec, -1
    v_mov_b32 v24, 0x2420c
    s_mov_b32 s80, 1600000
LW_123:
    ds_read_b32 v25, v24
    s_waitcnt lgkmcnt(0)
    v_readfirstlane_b32 s79, v25
    s_cmp_ge_u32 s79, s81
    s_cbranch_scc1 LWD_124
    s_sub_u32 s80, s80, 1
    s_cmp_lg_u32 s80, 0
    s_cbranch_scc1 LW_123
LWD_124:
    ds_read_b128 v[64:67], v7 offset:0
    ds_read_b128 v[68:71], v7 offset:64
    ds_read_b128 v[72:75], v7 offset:128
    ds_read_b128 v[76:79], v7 offset:192
    s_waitcnt lgkmcnt(3)
    v_mfma_f32_16x16x32_bf16 v[96:99], v[32:35], v[64:67], 0
    v_mfma_f32_16x16x32_bf16 v[100:103], v[48:51], v[64:67], 0
    s_waitcnt lgkmcnt(2)
    v_mfma_f32_16x16x32_bf16 v[96:99], v[36:39], v[68:71], v[96:99]
    v_mfma_f32_16x16x32_bf16 v[100:103], v[52:55], v[68:71], v[100:103]
    s_waitcnt lgkmcnt(1)
    v_mfma_f32_16x16x32_bf16 v[96:99], v[40:43], v[72:75], v[96:99]
    v_mfma_f32_16x16x32_bf16 v[100:103], v[56:59], v[72:75], v[100:103]
    s_waitcnt lgkmcnt(0)
    v_mfma_f32_16x16x32_bf16 v[96:99], v[44:47], v[76:79], v[96:99]
    v_mfma_f32_16x16x32_bf16 v[100:103], v[60:63], v[76:79], v[100:103]
    s_nop 6
    v_cvt_pk_bf16_f32 v16, v96, v97
    v_cvt_pk_bf16_f32 v17, v98, v99
    v_cvt_pk_bf16_f32 v104, v100, v101
    v_cvt_pk_bf16_f32 v105, v102, v103
    s_nop 0
    v_mov_b32_dpp v16, v104 quad_perm:[0,1,2,3] row_mask:0xf bank_mask:0x2
    v_mov_b32_dpp v17, v105 quad_perm:[0,1,2,3] row_mask:0xf bank_mask:0x2
    s_mov_b64 exec, s[84:85]
    buffer_store_dwordx4 v[16:19], v8, s[36:39], 0 offen sc1
    s_mov_b64 exec, -1
    s_branch L_RED
L_QABS:
    s_and_b32 s61, s6, 3
    s_waitcnt lgkmcnt(0)
    s_mov_b32 s36, s34
    s_and_b32 s37, s35, 0xffff
    s_mov_b32 s38, 0x1000000
    s_mov_b32 s39, 0x20000
    s_barrier
    s_cmp_ge_u32 s5, 6
    s_cbranch_scc1 L_BATT
    v_and_b32 v8, 3, v1
    v_lshlrev_b32 v5, 15, v8
    v_lshl_add_u32 v5, v2, 3, v5
    v_lshrrev_b32 v10, 2, v3
    v_lshl_add_u32 v5, v10, 5, v5
    s_lshl_b32 s7, s4, 1
    s_add_u32 s7, s7, s5
    s_lshl_b32 s7, s7, 2
    s_add_u32 s7, s7, s61
    s_lshl_b32 s7, s7, 7
    s_sub_u32 s7, s7, 2048
    v_add_u32 v5, s7, v5
    s_or_b32 s95, s95, s78
    s_add_u32 s72, s94, 0x10000
    s_addc_u32 s73, s95, 0
    s_lshl_b32 s7, s4, 15
    s_lshl_b32 s63, s61, 9
    s_add_u32 s7, s7, s63
    s_add_u32 s7, s7, 0x104000
    v_and_b32 v20, 31, v1
    v_lshl_add_u32 v7, v20, 4, s7
    v_lshrrev_b32 v21, 5, v1
    v_lshl_add_u32 v7, v21, 11, v7
    v_add_u32 v22, 4096, v7
    s_mul_i32 s7, s61, 320
    s_add_u32 s63, s7, 0x24900
    v_lshl_add_u32 v6, v20, 3, s63
    v_lshl_add_u32 v6, v21, 2, v6
    s_mov_b32 s70, 0x3f80
    s_mov_b32 s71, 0x3f800000
    v_xor_b32 v10, v3, v2
    v_lshlrev_b32 v10, 4, v10
    v_lshl_add_u32 v10, v3, 8, v10
    s_lshl_b32 s7, s61, 14
    s_add_u32 s7, s7, 0x14000
    v_add_u32 v10, s7, v10
    s_lshl_b32 s65, s61, 4
    s_add_u32 s65, s65, 16
    s_lshl_b32 s64, s61, 3
    s_add_u32 s64, s64, 0x24128
    v_mul_u32_u24 v9, 320, v8
    v_lshl_add_u32 v9, v2, 4, v9
    v_add_u32 v9, 0x24900, v9
    v_mov_b32 v12, 0x24000
    s_mov_b32 s80, 1600000
LW_126:
    ds_read_b32 v13, v12
    s_waitcnt lgkmcnt(0)
    v_readfirstlane_b32 s79, v13
    s_cmp_ge_u32 s79, 40
    s_cbranch_scc1 LWD_127
    s_sleep 1
    s_sub_u32 s80, s80, 1
    s_cmp_lg_u32 s80, 0
    s_cbranch_scc1 LW_126
LWD_127:
    s_mov_b64 exec, -1
    buffer_load_dwordx4 v[48:51], v7, s[36:39], 0 offen sc1 nt
    buffer_load_dwordx4 v[52:55], v22, s[36:39], 0 offen sc1 nt
    s_mov_b32 s80, 200000
MC_129:
    s_mov_b64 exec, -1
    s_waitcnt vmcnt(0)
    v_cmp_gt_u64 s[44:45], s[94:95], v[50:51]
    v_cmp_le_u64 vcc, s[72:73], v[50:51]
    s_or_b64 s[44:45], s[44:45], vcc
    v_cmp_gt_u64 s[46:47], s[94:95], v[54:55]
    v_cmp_le_u64 vcc, s[72:73], v[54:55]
    s_or_b64 s[46:47], s[46:47], vcc
    s_or_b64 s[90:91], s[44:45], s[46:47]
    s_cbranch_scc1 M_128
MD_130:
    s_mov_b64 exec, -1
    v_dot2_f32_bf16 v24, v48, s70, 0
    v_dot2_f32_bf16 v25, v48, s71, 0
    v_dot2_f32_bf16 v26, v49, s70, 0
    v_dot2_f32_bf16 v27, v49, s71, 0
    v_dot2_f32_bf16 v24, v52, s70, v24
    v_dot2_f32_bf16 v25, v52, s71, v25
    v_dot2_f32_bf16 v26, v53, s70, v26
    v_dot2_f32_bf16 v27, v53, s71, v27
    s_nop 1
    v_permlane32_swap_b32 v24, v26
    v_permlane32_swap_b32 v25, v27
    v_add_f32 v24, v24, v26
    v_add_f32 v25, v25, v27
    v_cvt_pk_bf16_f32 v24, v24, v25
    ds_write_b32 v6, v24
    v_mov_b32 v48, 0x24208
    v_mov_b32 v49, 1
    s_mov_b64 exec, 1
    ds_add_u32 v48, v49
    s_mov_b64 exec, -1
    v_mov_b32 v12, 0x24000
    s_mov_b32 s80, 1600000
LW_131:
    ds_read_b32 v13, v12
    s_waitcnt lgkmcnt(0)
    v_readfirstlane_b32 s79, v13
    s_cmp_ge_u32 s79, s65
    s_cbranch_scc1 LWD_132
    s_sub_u32 s80, s80, 1
    s_cmp_lg_u32 s80, 0
    s_cbranch_scc1 LW_131
LWD_132:
    v_xor_b32 v11, 0x0, v10
    ds_read_b128 v[64:67], v11 offset:0
    ds_read_b128 v[80:83], v11 offset:4096
    ds_read_b128 v[96:99], v11 offset:8192
    ds_read_b128 v[112:115], v11 offset:12288
    v_xor_b32 v11, 0x40, v10
    ds_read_b128 v[68:71], v11 offset:0
    ds_read_b128 v[84:87], v11 offset:4096
    ds_read_b128 v[100:103], v11 offset:8192
    ds_read_b128 v[116:119], v11 offset:12288
    v_xor_b32 v11, 0x80, v10
    ds_read_b128 v[72:75], v11 offset:0
    ds_read_b128 v[88:91], v11 offset:4096
    ds_read_b128 v[104:107], v11 offset:8192
    ds_read_b128 v[120:123], v11 offset:12288
    v_xor_b32 v11, 0xc0, v10
    ds_read_b128 v[76:79], v11 offset:0
    ds_read_b128 v[92:95], v11 offset:4096
    ds_read_b128 v[108:111], v11 offset:8192
    ds_read_b128 v[124:127], v11 offset:12288
    v_lshl_add_u32 v12, v1, 2, s64
    v_mov_b32 v13, 4
    s_mov_b64 exec, 3
    ds_add_u32 v12, v13
    s_mov_b64 exec, -1
    v_mov_b32 v12, 0x24208
    s_mov_b32 s80, 1600000
LW_133:
    ds_read_b32 v13, v12
    s_waitcnt lgkmcnt(0)
    v_readfirstlane_b32 s79, v13
    s_cmp_ge_u32 s79, 20
    s_cbranch_scc1 LWD_134
    s_sub_u32 s80, s80, 1
    s_cmp_lg_u32 s80, 0
    s_cbranch_scc1 LW_133
LWD_134:
    ds_read_b128 v[48:51], v9 offset:0
    ds_read_b128 v[52:55], v9 offset:64
    ds_read_b128 v[56:59], v9 offset:128
    ds_read_b128 v[60:63], v9 offset:192
    s_waitcnt lgkmcnt(3)
    v_mfma_f32_16x16x32_bf16 v[128:131], v[64:67], v[48:51], 0
    v_mfma_f32_16x16x32_bf16 v[132:135], v[80:83], v[48:51], 0
    v_mfma_f32_16x16x32_bf16 v[136:139], v[96:99], v[48:51], 0
    v_mfma_f32_16x16x32_bf16 v[140:143], v[112:115], v[48:51], 0
    s_waitcnt lgkmcnt(2)
    v_mfma_f32_16x16x32_bf16 v[128:131], v[68:71], v[52:55], v[128:131]
    v_mfma_f32_16x16x32_bf16 v[132:135], v[84:87], v[52:55], v[132:135]
    v_mfma_f32_16x16x32_bf16 v[136:139], v[100:103], v[52:55], v[136:139]
    v_mfma_f32_16x16x32_bf16 v[140:143], v[116:119], v[52:55], v[140:143]
    s_waitcnt lgkmcnt(1)
    v_mfma_f32_16x16x32_bf16 v[128:131], v[72:75], v[56:59], v[128:131]
    v_mfma_f32_16x16x32_bf16 v[132:135], v[88:91], v[56:59], v[132:135]
    v_mfma_f32_16x16x32_bf16 v[136:139], v[104:107], v[56:59], v[136:139]
    v_mfma_f32_16x16x32_bf16 v[140:143], v[120:123], v[56:59], v[140:143]
    s_waitcnt lgkmcnt(0)
    v_mfma_f32_16x16x32_bf16 v[128:131], v[76:79], v[60:63], v[128:131]
    v_mfma_f32_16x16x32_bf16 v[132:135], v[92:95], v[60:63], v[132:135]
    v_mfma_f32_16x16x32_bf16 v[136:139], v[108:111], v[60:63], v[136:139]
    v_mfma_f32_16x16x32_bf16 v[140:143], v[124:127], v[60:63], v[140:143]
    s_nop 4
    v_cvt_pk_bf16_f32 v24, v128, v129
    v_cvt_pk_bf16_f32 v25, v130, v131
    v_cvt_pk_bf16_f32 v26, v132, v133
    v_cvt_pk_bf16_f32 v27, v134, v135
    v_cvt_pk_bf16_f32 v28, v136, v137
    v_cvt_pk_bf16_f32 v29, v138, v139
    v_cvt_pk_bf16_f32 v30, v140, v141
    v_cvt_pk_bf16_f32 v31, v142, v143
    v_mov_b32_dpp v24, v26 quad_perm:[0,1,2,3] row_mask:0xf bank_mask:0x2
    v_mov_b32_dpp v25, v27 quad_perm:[0,1,2,3] row_mask:0xf bank_mask:0x2
    v_mov_b32_dpp v24, v28 quad_perm:[0,1,2,3] row_mask:0xf bank_mask:0x4
    v_mov_b32_dpp v25, v29 quad_perm:[0,1,2,3] row_mask:0xf bank_mask:0x4
    v_mov_b32_dpp v24, v30 quad_perm:[0,1,2,3] row_mask:0xf bank_mask:0x8
    v_mov_b32_dpp v25, v31 quad_perm:[0,1,2,3] row_mask:0xf bank_mask:0x8
    buffer_store_dwordx2 v[24:25], v5, s[36:39], 0 offen sc1
    v_mov_b32 v48, 0x24208
    v_mov_b32 v49, 32
    s_mov_b64 exec, 1
    ds_add_u32 v48, v49
    s_mov_b64 exec, -1
L_ESVC:
    v_lshrrev_b32 v160, 2, v1
    v_bfe_u32 v161, v1, 3, 2
    v_xor_b32 v161, s61, v161
    v_lshlrev_b32 v161, 5, v161
    v_lshl_add_u32 v161, v160, 7, v161
    v_and_b32 v162, 3, v1
    v_lshl_add_u32 v161, v162, 3, v161
    s_lshl_b32 s7, s61, 8
    s_lshl_b32 s62, s4, 10
    s_add_u32 s7, s7, s62
    s_add_u32 s7, s7, 0x30000
    v_and_b32 v164, 1, v1
    v_lshl_add_u32 v4, v164, 7, s7
    s_lshl_b32 s7, s4, 13
    s_lshl_b32 s62, s61, 11
    s_add_u32 s7, s7, s62
    s_add_u32 s7, s7, 0x200000
    v_lshl_add_u32 v5, v1, 4, s7
    s_mul_i32 s7, s61, 1088
    s_add_u32 s7, s7, 0x26600
    v_lshl_add_u32 v6, v160, 6, s7
    v_lshl_add_u32 v6, v164, 5, v6
    v_and_b32 v164, 2, v1
    v_lshl_add_u32 v6, v164, 2, v6
    v_mul_u32_u24 v7, 1088, v162
    v_lshl_add_u32 v7, v2, 4, v7
    v_add_u32 v7, 0x26600, v7
    v_cmp_gt_u32 s[84:85], 4, v3
    s_and_b32 s62, s4, 7
    s_lshl_b32 s62, s62, 3
    s_lshr_b32 s7, s4, 3
    s_lshl_b32 s7, s7, 1
    s_add_u32 s62, s62, s7
    s_add_u32 s62, s62, s5
    s_sub_u32 s62, s62, 6
    s_add_u32 s62, s62, 2
    s_lshl_b32 s7, s62, 10
    s_lshl_b32 s64, s61, 8
    s_add_u32 s7, s7, s64
    s_add_u32 s7, s7, 0xc0000
    v_lshl_add_u32 v10, v162, 6, s7
    v_lshl_add_u32 v10, v2, 4, v10
    s_lshr_b32 s7, s62, 3
    s_lshl_b32 s7, s7, 7
    s_add_u32 s7, s7, 0x22000
    v_and_b32 v164, 7, v1
    v_lshl_add_u32 v9, v164, 3, s7
    v_mov_b32 v16, 0x24204
    s_mov_b32 s80, 1600000
LW_135:
    ds_read_b32 v17, v16
    s_waitcnt lgkmcnt(0)
    v_readfirstlane_b32 s79, v17
    s_cmp_ge_u32 s79, 1
    s_cbranch_scc1 LWD_136
    s_sleep 1
    s_sub_u32 s80, s80, 1
    s_cmp_lg_u32 s80, 0
    s_cbranch_scc1 LW_135
LWD_136:
    v_mov_b32 v16, 0x24248
    ds_read_b64 v[18:19], v16
    s_waitcnt lgkmcnt(0)
    v_readfirstlane_b32 s92, v18
    v_readfirstlane_b32 s93, v19
    v_mov_b32 v16, 0x24000
    s_mov_b32 s80, 1600000
LW_137:
    ds_read_b32 v17, v16
    s_waitcnt lgkmcnt(0)
    v_readfirstlane_b32 s79, v17
    s_cmp_ge_u32 s79, 96
    s_cbranch_scc1 LWD_138
    s_sleep 4
    s_sub_u32 s80, s80, 1
    s_cmp_lg_u32 s80, 0
    s_cbranch_scc1 LW_137
LWD_138:
    s_or_b32 s95, s95, s78
    s_add_u32 s88, s94, 0x10000
    s_addc_u32 s89, s95, 0
    s_mov_b32 s101, 4
    s_mov_b64 exec, 0xff
U_139:
    buffer_load_dwordx2 v[16:17], v9, s[36:39], 0 offen sc1 nt
UU_140:
    s_waitcnt vmcnt(0)
    v_cmp_gt_u64 s[90:91], s[94:95], v[16:17]
    v_cmp_le_u64 vcc, s[88:89], v[16:17]
    s_or_b64 vcc, vcc, s[90:91]
    s_cbranch_scc0 UD_141
    s_sleep 8
    s_sub_u32 s101, s101, 1
    s_cmp_lg_u32 s101, 0
    s_cbranch_scc1 U_139
UD_141:
    s_mov_b64 exec, -1
    v_mov_b32 v16, 0x24000
    s_mov_b32 s80, 1600000
LW_142:
    ds_read_b32 v17, v16
    s_waitcnt lgkmcnt(0)
    v_readfirstlane_b32 s79, v17
    s_cmp_ge_u32 s79, 128
    s_cbranch_scc1 LWD_143
    s_sleep 4
    s_sub_u32 s80, s80, 1
    s_cmp_lg_u32 s80, 0
    s_cbranch_scc1 LW_142
LWD_143:
    ds_read_b64_tr_b16 v[32:33], v161 offset:0
    ds_read_b64_tr_b16 v[34:35], v161 offset:2048
    ds_read_b64_tr_b16 v[36:37], v161 offset:4096
    ds_read_b64_tr_b16 v[38:39], v161 offset:6144
    ds_read_b64_tr_b16 v[40:41], v161 offset:8192
    ds_read_b64_tr_b16 v[42:43], v161 offset:10240
    ds_read_b64_tr_b16 v[44:45], v161 offset:12288
    ds_read_b64_tr_b16 v[46:47], v161 offset:14336
    s_waitcnt lgkmcnt(4)
    ds_read_b64_tr_b16 v[48:49], v161 offset:16384
    ds_read_b64_tr_b16 v[50:51], v161 offset:18432
    ds_read_b64_tr_b16 v[52:53], v161 offset:20480
    ds_read_b64_tr_b16 v[54:55], v161 offset:22528
    ds_read_b64_tr_b16 v[56:57], v161 offset:24576
    ds_read_b64_tr_b16 v[58:59], v161 offset:26624
    ds_read_b64_tr_b16 v[60:61], v161 offset:28672
    ds_read_b64_tr_b16 v[62:63], v161 offset:30720
    s_waitcnt lgkmcnt(4)
    ds_read_b64_tr_b16 v[64:65], v161 offset:32768
    ds_read_b64_tr_b16 v[66:67], v161 offset:34816
    ds_read_b64_tr_b16 v[68:69], v161 offset:36864
    ds_read_b64_tr_b16 v[70:71], v161 offset:38912
    ds_read_b64_tr_b16 v[72:73], v161 offset:40960
    ds_read_b64_tr_b16 v[74:75], v161 offset:43008
    ds_read_b64_tr_b16 v[76:77], v161 offset:45056
    ds_read_b64_tr_b16 v[78:79], v161 offset:47104
    s_waitcnt lgkmcnt(4)
    ds_read_b64_tr_b16 v[80:81], v161 offset:49152
    ds_read_b64_tr_b16 v[82:83], v161 offset:51200
    ds_read_b64_tr_b16 v[84:85], v161 offset:53248
    ds_read_b64_tr_b16 v[86:87], v161 offset:55296
    ds_read_b64_tr_b16 v[88:89], v161 offset:57344
    ds_read_b64_tr_b16 v[90:91], v161 offset:59392
    ds_read_b64_tr_b16 v[92:93], v161 offset:61440
    ds_read_b64_tr_b16 v[94:95], v161 offset:63488
    s_waitcnt lgkmcnt(4)
    v_lshlrev_b32 v16, 2, v1
    v_add_u32 v16, 0x24100, v16
    v_mov_b32 v17, 1
    s_mov_b64 exec, 255
    ds_add_u32 v16, v17
    s_mov_b64 exec, -1
    s_lshl_b32 s7, s62, 2
    s_add_u32 s7, s7, s61
    s_lshl_b32 s7, s7, 13
    s_add_u32 s7, s7, 0x600000
    v_lshl_add_u32 v8, v1, 7, s7
    buffer_load_dword v8, v8, s[36:39], 0 offen sc1 nt
    s_and_b32 s7, s4, 7
    s_lshl_b32 s7, s7, 12
    s_add_u32 s7, s7, 0x28008
    v_lshl_add_u32 v9, v1, 9, s7
    s_lshl_b32 s7, s61, 8
    s_lshr_b32 s64, s4, 2
    s_lshl_b32 s64, s64, 3
    s_add_u32 s7, s7, s64
    s_add_u32 s7, s7, 0x22800
    v_writelane_b32 v9, s7, 8
    s_add_u32 s7, s7, 128
    v_writelane_b32 v9, s7, 9
    s_cmp_eq_u32 s101, 0
    s_cbranch_scc1 EH_144
    s_mov_b64 exec, 0xff
    buffer_load_dwordx2 v[12:13], v9, s[36:39], 0 offen sc1 nt
    s_mov_b32 s80, 200000
MC_146:
    s_mov_b64 exec, 0xff
    s_waitcnt vmcnt(0)
    v_cmp_ne_u64 s[64:65], s[92:93], v[12:13]
    s_cmp_lg_u64 s[64:65], 0
    s_cbranch_scc1 M_145
MD_147:
    s_mov_b64 exec, -1
EH_144:
    s_mov_b64 exec, 0x300
    buffer_load_dwordx2 v[12:13], v9, s[36:39], 0 offen sc1
    s_mov_b32 s80, 200000
MC_149:
    s_mov_b64 exec, 0x300
    s_waitcnt vmcnt(0)
    v_cmp_ne_u64 s[64:65], s[92:93], v[12:13]
    s_cmp_lg_u64 s[64:65], 0
    s_cbranch_scc1 M_148
MD_150:
    s_mov_b64 exec, -1
    s_setprio 2
    s_mov_b64 exec, -1
    buffer_load_dwordx4 v[16:19], v5, s[36:39], 0 offen offset:0 sc1
    buffer_load_dwordx4 v[20:23], v5, s[36:39], 0 offen offset:1024 sc1
    buffer_load_dwordx4 v[12:15], v4, s[36:39], 0 offen sc1
    s_mov_b32 s80, 200000
MC_152:
    s_mov_b64 exec, -1
    s_waitcnt vmcnt(0)
    v_max3_u32 v160, v16, v17, v18
    v_max_u32 v160, v160, v19
    v_cmp_eq_u32 s[64:65], -1, v160
    v_max3_u32 v161, v20, v21, v22
    v_max_u32 v161, v161, v23
    v_cmp_eq_u32 s[66:67], -1, v161
    v_cmp_ne_u64 s[68:69], s[92:93], v[14:15]
    s_or_b64 s[90:91], s[64:65], s[66:67]
    s_or_b64 s[90:91], s[90:91], s[68:69]
    s_cbranch_scc1 M_151
MD_153:
    s_mov_b64 exec, -1
    v_readlane_b32 s74, v12, 0
    v_readlane_b32 s76, v13, 0
    v_readlane_b32 s75, v12, 1
    v_readlane_b32 s77, v13, 1
    v_mov_b32 v160, s74
    v_max_f32 v160, s75, v160
    v_sub_f32 v11, s74, v160
    v_sub_f32 v12, s75, v160
    v_exp_f32 v11, v11
    v_exp_f32 v12, v12
    v_mul_f32 v160, s76, v11
    v_fmac_f32 v160, s77, v12
    v_rcp_f32 v160, v160
    s_nop 0
    v_mul_f32 v11, v11, v160
    v_mul_f32 v12, v12, v160
    v_lshlrev_b32 v96, 16, v16
    v_and_b32 v97, 0xffff0000, v16
    v_lshlrev_b32 v98, 16, v17
    v_and_b32 v99, 0xffff0000, v17
    v_lshlrev_b32 v100, 16, v18
    v_and_b32 v101, 0xffff0000, v18
    v_lshlrev_b32 v102, 16, v19
    v_and_b32 v103, 0xffff0000, v19
    v_lshlrev_b32 v104, 16, v20
    v_and_b32 v105, 0xffff0000, v20
    v_lshlrev_b32 v106, 16, v21
    v_and_b32 v107, 0xffff0000, v21
    v_lshlrev_b32 v108, 16, v22
    v_and_b32 v109, 0xffff0000, v22
    v_lshlrev_b32 v110, 16, v23
    v_and_b32 v111, 0xffff0000, v23
    v_mul_f32 v96, v96, v11
    v_mul_f32 v97, v97, v11
    v_mul_f32 v98, v98, v11
    v_mul_f32 v99, v99, v11
    v_mul_f32 v100, v100, v11
    v_mul_f32 v101, v101, v11
    v_mul_f32 v102, v102, v11
    v_mul_f32 v103, v103, v11
    v_fmac_f32 v96, v104, v12
    v_fmac_f32 v97, v105, v12
    v_fmac_f32 v98, v106, v12
    v_fmac_f32 v99, v107, v12
    v_fmac_f32 v100, v108, v12
    v_fmac_f32 v101, v109, v12
    v_fmac_f32 v102, v110, v12
    v_fmac_f32 v103, v111, v12
    v_cvt_pk_bf16_f32 v24, v96, v97
    v_cvt_pk_bf16_f32 v25, v98, v99
    v_cvt_pk_bf16_f32 v26, v100, v101
    v_cvt_pk_bf16_f32 v27, v102, v103
    ds_write_b64 v6, v[24:25]
    ds_write_b64 v6, v[26:27] offset:16
    s_add_u32 s81, s81, 4
    v_mov_b32 v160, 0x2420c
    v_mov_b32 v161, 1
    s_mov_b64 exec, 1
    ds_add_u32 v160, v161
    s_mov_b64 exec, -1
    v_mov_b32 v160, 0x2420c
    s_mov_b32 s80, 1600000
LW_154:
    ds_read_b32 v161, v160
    s_waitcnt lgkmcnt(0)
    v_readfirstlane_b32 s79, v161
    s_cmp_ge_u32 s79, s81
    s_cbranch_scc1 LWD_155
    s_sub_u32 s80, s80, 1
    s_cmp_lg_u32 s80, 0
    s_cbranch_scc1 LW_154
LWD_155:
    ds_read_b128 v[96:99], v7 offset:0
    ds_read_b128 v[100:103], v7 offset:64
    ds_read_b128 v[104:107], v7 offset:128
    ds_read_b128 v[108:111], v7 offset:192
    ds_read_b128 v[112:115], v7 offset:256
    ds_read_b128 v[116:119], v7 offset:320
    ds_read_b128 v[120:123], v7 offset:384
    ds_read_b128 v[124:127], v7 offset:448
    ds_read_b128 v[128:131], v7 offset:512
    ds_read_b128 v[132:135], v7 offset:576
    ds_read_b128 v[136:139], v7 offset:640
    ds_read_b128 v[140:143], v7 offset:704
    v_mov_b32 v18, s92
    v_mov_b32 v19, s93
    s_waitcnt lgkmcnt(8)
    ds_read_b128 v[144:147], v7 offset:768
    ds_read_b128 v[148:151], v7 offset:832
    ds_read_b128 v[152:155], v7 offset:896
    ds_read_b128 v[156:159], v7 offset:960
    v_mfma_f32_16x16x32_bf16 v[12:15], v[32:35], v[96:99], 0
    v_mfma_f32_16x16x32_bf16 v[12:15], v[36:39], v[100:103], v[12:15]
    v_mfma_f32_16x16x32_bf16 v[12:15], v[40:43], v[104:107], v[12:15]
    v_mfma_f32_16x16x32_bf16 v[12:15], v[44:47], v[108:111], v[12:15]
    s_waitcnt lgkmcnt(11)
    v_mfma_f32_16x16x32_bf16 v[12:15], v[48:51], v[112:115], v[12:15]
    s_waitcnt lgkmcnt(10)
    v_mfma_f32_16x16x32_bf16 v[12:15], v[52:55], v[116:119], v[12:15]
    s_waitcnt lgkmcnt(9)
    v_mfma_f32_16x16x32_bf16 v[12:15], v[56:59], v[120:123], v[12:15]
    s_waitcnt lgkmcnt(8)
    v_mfma_f32_16x16x32_bf16 v[12:15], v[60:63], v[124:127], v[12:15]
    s_waitcnt lgkmcnt(7)
    v_mfma_f32_16x16x32_bf16 v[12:15], v[64:67], v[128:131], v[12:15]
    s_waitcnt lgkmcnt(6)
    v_mfma_f32_16x16x32_bf16 v[12:15], v[68:71], v[132:135], v[12:15]
    s_waitcnt lgkmcnt(5)
    v_mfma_f32_16x16x32_bf16 v[12:15], v[72:75], v[136:139], v[12:15]
    s_waitcnt lgkmcnt(4)
    v_mfma_f32_16x16x32_bf16 v[12:15], v[76:79], v[140:143], v[12:15]
    s_waitcnt lgkmcnt(3)
    v_mfma_f32_16x16x32_bf16 v[12:15], v[80:83], v[144:147], v[12:15]
    s_waitcnt lgkmcnt(2)
    v_mfma_f32_16x16x32_bf16 v[12:15], v[84:87], v[148:151], v[12:15]
    s_waitcnt lgkmcnt(1)
    v_mfma_f32_16x16x32_bf16 v[12:15], v[88:91], v[152:155], v[12:15]
    s_waitcnt lgkmcnt(0)
    v_mfma_f32_16x16x32_bf16 v[12:15], v[92:95], v[156:159], v[12:15]
    s_nop 7
    v_cvt_pk_bf16_f32 v16, v12, v13
    v_cvt_pk_bf16_f32 v17, v14, v15
    s_mov_b64 exec, s[84:85]
    s_cmp_eq_u32 s101, 0
    s_cbranch_scc1 SU_156
    buffer_store_dwordx4 v[16:19], v10, s[36:39], 0 offen
SV_157:
    s_mov_b64 exec, -1
    s_branch L_RED
L_BATT:
    s_and_b32 s60, s4, 7
    s_lshl_b32 s60, s60, 3
    s_lshr_b32 s7, s4, 3
    s_lshl_b32 s7, s7, 1
    s_add_u32 s60, s60, s7
    s_add_u32 s60, s60, s5
    s_sub_u32 s60, s60, 6
    s_lshr_b32 s61, s6, 1
    s_and_b32 s62, s6, 1
    s_mov_b32 s64, 0x3e0293ee
    v_lshlrev_b32 v4, 10, v3
    v_lshl_add_u32 v4, v2, 8, v4
    v_lshl_add_u32 v0, v3, 4, v4
    s_lshl_b32 s7, s62, 14
    s_add_u32 s7, s7, 0x1c000
    v_add_u32 v0, s7, v0
    v_and_b32 v162, 3, v1
    v_lshl_add_u32 v4, v162, 6, v4
    v_bfe_u32 v162, v1, 2, 2
    v_lshl_add_u32 v4, v162, 4, v4
    s_lshl_b32 s7, s6, 7
    s_add_u32 s7, s7, 0x24400
    v_lshl_add_u32 v5, v3, 3, s7
    s_lshl_b32 s7, s61, 10
    s_lshl_b32 s63, s62, 8
    s_add_u32 s7, s7, s63
    s_add_u32 s7, s7, 0x26000
    v_lshl_add_u32 v6, v3, 4, s7
    v_lshrrev_b32 v163, 5, v1
    v_lshl_add_u32 v6, v163, 9, v6
    v_and_b32 v162, 1, v2
    v_lshl_add_u32 v6, v162, 3, v6
    v_lshlrev_b32 v7, 4, v1
    v_add_u32 v7, 0x26000, v7
    v_and_b32 v162, 31, v1
    v_lshlrev_b32 v8, 3, v162
    v_add_u32 v8, 0x24400, v8
    v_bfe_u32 v162, v1, 2, 2
    v_lshl_add_u32 v164, v163, 3, v162
    v_lshlrev_b32 v164, 10, v164
    v_and_b32 v165, 1, v1
    v_lshl_add_u32 v164, v165, 3, v164
    s_lshl_b32 s7, s61, 8
    v_add_u32 v164, s7, v164
    v_bfe_u32 v165, v1, 4, 1
    v_lshlrev_b32 v165, 1, v165
    v_bfe_u32 v160, v1, 1, 1
    v_or_b32 v165, v165, v160
    s_lshl_b32 s7, s62, 3
    v_or_b32 v165, s7, v165
    v_lshlrev_b32 v162, 2, v162
    v_xor_b32 v165, v165, v162
    v_lshlrev_b32 v163, 1, v163
    v_xor_b32 v165, v165, v163
    v_xor_b32 v160, 0, v165
    v_lshl_add_u32 v9, v160, 4, v164
    v_xor_b32 v160, 4, v165
    v_lshl_add_u32 v10, v160, 4, v164
    v_xor_b32 v160, 1, v165
    v_lshl_add_u32 v11, v160, 4, v164
    v_add_u32 v11, 0x1000, v11
    v_xor_b32 v160, 5, v165
    v_lshl_add_u32 v12, v160, 4, v164
    v_add_u32 v12, 0x1000, v12
    v_mov_b32 v13, 0xff800000
    s_mov_b64 s[84:85], 0xffff
    s_lshl_b32 s7, s60, 15
    s_lshl_b32 s63, s6, 12
    s_add_u32 s7, s7, s63
    s_add_u32 s7, s7, 0x600000
    v_lshl_add_u32 v152, v1, 7, s7
    s_mov_b64 exec, 0xffffffff
    buffer_store_dword v1, v152, s[36:39], 0 offen
    s_mov_b64 exec, -1
    v_mov_b32 v160, 0x24204
    s_mov_b32 s80, 1600000
LW_158:
    ds_read_b32 v161, v160
    s_waitcnt lgkmcnt(0)
    v_readfirstlane_b32 s79, v161
    s_cmp_ge_u32 s79, 1
    s_cbranch_scc1 LWD_159
    s_sleep 1
    s_sub_u32 s80, s80, 1
    s_cmp_lg_u32 s80, 0
    s_cbranch_scc1 LW_158
LWD_159:
    v_mov_b32 v160, 0x24248
    ds_read_b64 v[162:163], v160
    s_waitcnt lgkmcnt(0)
    v_readfirstlane_b32 s92, v162
    v_readfirstlane_b32 s93, v163
    s_lshl_b32 s7, s6, 9
    s_add_u32 s7, s7, 0x20000
    v_and_b32 v144, 1, v1
    v_lshl_add_u32 v144, v144, 3, s7
    v_lshrrev_b32 v145, 1, v1
    v_lshl_add_u32 v144, v145, 7, v144
    s_lshr_b32 s7, s60, 4
    s_lshl_b32 s7, s7, 15
    s_add_u32 s7, s7, s63
    v_lshl_add_u32 v145, v1, 4, s7
    s_and_b32 s7, s6, 3
    s_lshl_b32 s7, s7, 6
    v_lshlrev_b32 v146, 4, v1
    v_xor_b32 v146, s7, v146
    s_add_u32 s7, s63, 0x1c000
    v_add_u32 v146, s7, v146
    v_xor_b32 v147, 0x10, v146
    v_xor_b32 v148, 0x20, v146
    v_xor_b32 v149, 0x30, v146
    s_lshl_b32 s66, s61, 4
    s_add_u32 s66, s66, 16
    s_mov_b32 s70, 64
    s_mov_b32 s71, 0x800080
    s_lshl_b32 s67, s61, 2
    s_or_b32 s67, s67, 0x40000
    s_mov_b32 s72, 0x6543210
    s_mov_b32 s73, 0x65487321
    s_mov_b32 s69, 4
    v_mov_b32 v160, 0x24000
    s_mov_b32 s80, 1600000
LW_160:
    ds_read_b32 v161, v160
    s_waitcnt lgkmcnt(0)
    v_readfirstlane_b32 s79, v161
    s_cmp_ge_u32 s79, 32
    s_cbranch_scc1 LWD_161
    s_sleep 2
    s_sub_u32 s80, s80, 1
    s_cmp_lg_u32 s80, 0
    s_cbranch_scc1 LW_160
LWD_161:
    s_lshr_b32 s7, s60, 3
    s_lshl_b32 s7, s7, 7
    s_add_u32 s7, s7, 0x22000
    v_lshl_add_u32 v160, v1, 3, s7
    s_mov_b64 exec, 0xff
    buffer_load_dwordx2 v[16:17], v144, s[36:39], 0 offen sc1
    buffer_load_dwordx2 v[18:19], v160, s[36:39], 0 offen sc1 nt
    s_mov_b32 s80, 200000
MC_163:
    s_mov_b64 exec, 0xff
    s_waitcnt vmcnt(0)
    v_cmp_ne_u64 s[44:45], s[92:93], v[16:17]
    s_cmp_lg_u64 s[44:45], 0
    s_cbranch_scc1 M_162
MD_164:
    s_mov_b64 exec, -1
    s_or_b32 s95, s95, s78
    s_add_u32 s88, s94, 0x10000
    s_addc_u32 s89, s95, 0
    s_mov_b32 s101, 4
    s_mov_b64 exec, 0xff
    s_branch UU_166
U_165:
    buffer_load_dwordx2 v[18:19], v160, s[36:39], 0 offen sc1 nt
UU_166:
    s_waitcnt vmcnt(0)
    v_cmp_gt_u64 s[90:91], s[94:95], v[18:19]
    v_cmp_le_u64 vcc, s[88:89], v[18:19]
    s_or_b64 vcc, vcc, s[90:91]
    s_cbranch_scc0 UD_167
    s_sleep 8
    s_sub_u32 s101, s101, 1
    s_cmp_lg_u32 s101, 0
    s_cbranch_scc1 U_165
UD_167:
    s_mov_b64 exec, -1
    s_lshl_b32 s7, s61, 14
    v_add_u32 v16, s7, v4
    v_mov_b32 v160, 0x24000
    s_mov_b32 s80, 1600000
LW_168:
    ds_read_b32 v161, v160
    s_waitcnt lgkmcnt(0)
    v_readfirstlane_b32 s79, v161
    s_cmp_ge_u32 s79, 64
    s_cbranch_scc1 LWD_169
    s_sleep 2
    s_sub_u32 s80, s80, 1
    s_cmp_lg_u32 s80, 0
    s_cbranch_scc1 LW_168
LWD_169:
    v_xor_b32 v160, 0x0, v16
    ds_read_b128 v[32:35], v160
    v_xor_b32 v161, 0x10, v16
    ds_read_b128 v[36:39], v161
    v_xor_b32 v160, 0x20, v16
    ds_read_b128 v[40:43], v160
    v_xor_b32 v161, 0x30, v16
    ds_read_b128 v[44:47], v161
    v_xor_b32 v160, 0x40, v16
    ds_read_b128 v[48:51], v160
    v_xor_b32 v161, 0x50, v16
    ds_read_b128 v[52:55], v161
    v_xor_b32 v160, 0x60, v16
    ds_read_b128 v[56:59], v160
    v_xor_b32 v161, 0x70, v16
    ds_read_b128 v[60:63], v161
    v_xor_b32 v160, 0x80, v16
    ds_read_b128 v[64:67], v160
    v_xor_b32 v161, 0x90, v16
    ds_read_b128 v[68:71], v161
    v_xor_b32 v160, 0xa0, v16
    ds_read_b128 v[72:75], v160
    v_xor_b32 v161, 0xb0, v16
    ds_read_b128 v[76:79], v161
    v_xor_b32 v160, 0xc0, v16
    ds_read_b128 v[80:83], v160
    v_xor_b32 v161, 0xd0, v16
    ds_read_b128 v[84:87], v161
    v_xor_b32 v160, 0xe0, v16
    ds_read_b128 v[88:91], v160
    v_xor_b32 v161, 0xf0, v16
    ds_read_b128 v[92:95], v161
    s_bfe_u32 s7, s72, 0x40000
    s_lshl_b32 s7, s7, 14
    v_add_u32 v20, s7, v9
    v_add_u32 v21, s7, v10
    v_add_u32 v22, s7, v11
    v_add_u32 v23, s7, v12
    ds_read_b64_tr_b16 v[96:97], v20
    ds_read_b64_tr_b16 v[98:99], v22
    ds_read_b64_tr_b16 v[100:101], v21
    ds_read_b64_tr_b16 v[102:103], v23
    s_bfe_u32 s7, s72, 0x40004
    s_lshl_b32 s7, s7, 14
    v_add_u32 v24, s7, v9
    v_add_u32 v25, s7, v10
    v_add_u32 v26, s7, v11
    v_add_u32 v27, s7, v12
    ds_read_b64_tr_b16 v[104:105], v24
    ds_read_b64_tr_b16 v[106:107], v26
    ds_read_b64_tr_b16 v[108:109], v25
    ds_read_b64_tr_b16 v[110:111], v27
    s_bfe_u32 s7, s72, 0x40008
    s_lshl_b32 s7, s7, 14
    v_add_u32 v28, s7, v9
    v_add_u32 v29, s7, v10
    v_add_u32 v30, s7, v11
    v_add_u32 v31, s7, v12
    ds_read_b64_tr_b16 v[112:113], v28
    ds_read_b64_tr_b16 v[114:115], v30
    ds_read_b64_tr_b16 v[116:117], v29
    ds_read_b64_tr_b16 v[118:119], v31
    s_bfe_u32 s7, s72, 0x4000c
    s_lshl_b32 s7, s7, 14
    v_add_u32 v20, s7, v9
    v_add_u32 v21, s7, v10
    v_add_u32 v22, s7, v11
    v_add_u32 v23, s7, v12
    ds_read_b64_tr_b16 v[120:121], v20
    ds_read_b64_tr_b16 v[122:123], v22
    ds_read_b64_tr_b16 v[124:125], v21
    ds_read_b64_tr_b16 v[126:127], v23
    v_mov_b32 v162, 0x24100
    v_mov_b32 v163, 1
    s_mov_b64 exec, 1
    ds_add_u32 v162, v163
    s_mov_b64 exec, -1
    v_mov_b32 v160, 0x24000
    s_mov_b32 s80, 1600000
LW_170:
    ds_read_b32 v161, v160
    s_waitcnt lgkmcnt(0)
    v_readfirstlane_b32 s79, v161
    s_cmp_ge_u32 s79, 120
    s_cbranch_scc1 LWD_171
    s_sleep 1
    s_sub_u32 s80, s80, 1
    s_cmp_lg_u32 s80, 0
    s_cbranch_scc1 LW_170
LWD_171:
    s_mov_b64 exec, -1
    buffer_load_dwordx4 v[128:131], v145, s[36:39], 0 offen offset:0 sc1
    buffer_load_dwordx4 v[132:135], v145, s[36:39], 0 offen offset:1024 sc1
    buffer_load_dwordx4 v[136:139], v145, s[36:39], 0 offen offset:2048 sc1
    buffer_load_dwordx4 v[140:143], v145, s[36:39], 0 offen offset:3072 sc1
    s_mov_b32 s80, 200000
MC_173:
    s_mov_b64 exec, -1
    s_waitcnt vmcnt(0)
    v_max3_u32 v160, v128, v129, v130
    v_max_u32 v160, v160, v131
    v_cmp_eq_u32 s[44:45], -1, v160
    v_max3_u32 v161, v132, v133, v134
    v_max_u32 v161, v161, v135
    v_cmp_eq_u32 s[46:47], -1, v161
    v_max3_u32 v162, v136, v137, v138
    v_max_u32 v162, v162, v139
    v_cmp_eq_u32 s[48:49], -1, v162
    v_max3_u32 v163, v140, v141, v142
    v_max_u32 v163, v163, v143
    v_cmp_eq_u32 s[50:51], -1, v163
    s_or_b64 s[90:91], s[44:45], s[46:47]
    s_or_b64 s[90:91], s[90:91], s[48:49]
    s_or_b64 s[90:91], s[90:91], s[50:51]
    s_cbranch_scc1 M_172
MD_174:
    s_mov_b64 exec, -1
    v_mov_b32 v160, 0x24108
    v_mov_b32 v161, 1
    s_mov_b64 exec, 1
    ds_add_u32 v160, v161
    s_mov_b64 exec, -1
    ds_write_b128 v146, v[128:131] offset:0
    ds_write_b128 v147, v[132:135] offset:1024
    ds_write_b128 v148, v[136:139] offset:2048
    ds_write_b128 v149, v[140:143] offset:3072
    v_xor_b32 v20, 0x0, v0
    v_xor_b32 v21, 0x10, v0
    v_xor_b32 v22, 0x20, v0
    v_xor_b32 v23, 0x30, v0
    v_xor_b32 v24, 0x40, v0
    v_xor_b32 v25, 0x50, v0
    v_xor_b32 v26, 0x60, v0
    v_xor_b32 v27, 0x70, v0
    v_mov_b32 v0, v152
    s_add_u32 s81, s81, 8
    v_mov_b32 v162, 0x2420c
    v_mov_b32 v163, 1
    s_mov_b64 exec, 1
    ds_add_u32 v162, v163
    s_mov_b64 exec, -1
    v_mov_b32 v162, 0x2420c
    s_mov_b32 s80, 1600000
LW_175:
    ds_read_b32 v163, v162
    s_waitcnt lgkmcnt(0)
    v_readfirstlane_b32 s79, v163
    s_cmp_ge_u32 s79, s81
    s_cbranch_scc1 LWD_176
    s_sub_u32 s80, s80, 1
    s_cmp_lg_u32 s80, 0
    s_cbranch_scc1 LW_175
LWD_176:
    ds_read_b128 v[128:131], v20
    ds_read_b128 v[132:135], v21
    ds_read_b128 v[136:139], v22
    ds_read_b128 v[140:143], v23
    ds_read_b128 v[144:147], v24
    ds_read_b128 v[148:151], v25
    ds_read_b128 v[152:155], v26
    ds_read_b128 v[156:159], v27
    v_xor_b32 v20, 0x80, v20
    v_xor_b32 v21, 0x80, v21
    v_xor_b32 v22, 0x80, v22
    v_xor_b32 v23, 0x80, v23
    v_xor_b32 v24, 0x80, v24
    v_xor_b32 v25, 0x80, v25
    v_xor_b32 v26, 0x80, v26
    v_xor_b32 v27, 0x80, v27
    s_waitcnt lgkmcnt(7)
    v_mfma_f32_16x16x32_bf16 v[16:19], v[32:35], v[128:131], 0
    v_pk_mov_b32 v[32:33], v[128:129], v[128:129] op_sel:[0,1]
    v_pk_mov_b32 v[34:35], v[130:131], v[130:131] op_sel:[0,1]
    ds_read_b128 v[128:131], v20
    s_waitcnt lgkmcnt(7)
    v_mfma_f32_16x16x32_bf16 v[16:19], v[36:39], v[132:135], v[16:19]
    v_pk_mov_b32 v[36:37], v[132:133], v[132:133] op_sel:[0,1]
    v_pk_mov_b32 v[38:39], v[134:135], v[134:135] op_sel:[0,1]
    ds_read_b128 v[132:135], v21
    s_waitcnt lgkmcnt(7)
    v_mfma_f32_16x16x32_bf16 v[16:19], v[40:43], v[136:139], v[16:19]
    v_pk_mov_b32 v[40:41], v[136:137], v[136:137] op_sel:[0,1]
    v_pk_mov_b32 v[42:43], v[138:139], v[138:139] op_sel:[0,1]
    ds_read_b128 v[136:139], v22
    s_waitcnt lgkmcnt(7)
    v_mfma_f32_16x16x32_bf16 v[16:19], v[44:47], v[140:143], v[16:19]
    v_pk_mov_b32 v[44:45], v[140:141], v[140:141] op_sel:[0,1]
    v_pk_mov_b32 v[46:47], v[142:143], v[142:143] op_sel:[0,1]
    ds_read_b128 v[140:143], v23
    s_waitcnt lgkmcnt(7)
    v_mfma_f32_16x16x32_bf16 v[16:19], v[48:51], v[144:147], v[16:19]
    v_pk_mov_b32 v[48:49], v[144:145], v[144:145] op_sel:[0,1]
    v_pk_mov_b32 v[50:51], v[146:147], v[146:147] op_sel:[0,1]
    ds_read_b128 v[144:147], v24
    s_waitcnt lgkmcnt(7)
    v_mfma_f32_16x16x32_bf16 v[16:19], v[52:55], v[148:151], v[16:19]
    v_pk_mov_b32 v[52:53], v[148:149], v[148:149] op_sel:[0,1]
    v_pk_mov_b32 v[54:55], v[150:151], v[150:151] op_sel:[0,1]
    ds_read_b128 v[148:151], v25
    s_waitcnt lgkmcnt(7)
    v_mfma_f32_16x16x32_bf16 v[16:19], v[56:59], v[152:155], v[16:19]
    v_pk_mov_b32 v[56:57], v[152:153], v[152:153] op_sel:[0,1]
    v_pk_mov_b32 v[58:59], v[154:155], v[154:155] op_sel:[0,1]
    ds_read_b128 v[152:155], v26
    s_waitcnt lgkmcnt(7)
    v_mfma_f32_16x16x32_bf16 v[16:19], v[60:63], v[156:159], v[16:19]
    v_pk_mov_b32 v[60:61], v[156:157], v[156:157] op_sel:[0,1]
    v_pk_mov_b32 v[62:63], v[158:159], v[158:159] op_sel:[0,1]
    ds_read_b128 v[156:159], v27
    s_waitcnt lgkmcnt(7)
    v_mfma_f32_16x16x32_bf16 v[16:19], v[64:67], v[128:131], v[16:19]
    v_pk_mov_b32 v[64:65], v[128:129], v[128:129] op_sel:[0,1]
    v_pk_mov_b32 v[66:67], v[130:131], v[130:131] op_sel:[0,1]
    v_pk_mov_b32 v[128:129], 0, 0
    v_pk_mov_b32 v[130:131], 0, 0
    s_waitcnt lgkmcnt(6)
    v_mfma_f32_16x16x32_bf16 v[16:19], v[68:71], v[132:135], v[16:19]
    v_pk_mov_b32 v[68:69], v[132:133], v[132:133] op_sel:[0,1]
    v_pk_mov_b32 v[70:71], v[134:135], v[134:135] op_sel:[0,1]
    v_pk_mov_b32 v[132:133], 0, 0
    v_pk_mov_b32 v[134:135], 0, 0
    s_waitcnt lgkmcnt(5)
    v_mfma_f32_16x16x32_bf16 v[16:19], v[72:75], v[136:139], v[16:19]
    v_pk_mov_b32 v[72:73], v[136:137], v[136:137] op_sel:[0,1]
    v_pk_mov_b32 v[74:75], v[138:139], v[138:139] op_sel:[0,1]
    v_pk_mov_b32 v[136:137], 0, 0
    v_pk_mov_b32 v[138:139], 0, 0
    s_waitcnt lgkmcnt(4)
    v_mfma_f32_16x16x32_bf16 v[16:19], v[76:79], v[140:143], v[16:19]
    v_pk_mov_b32 v[76:77], v[140:141], v[140:141] op_sel:[0,1]
    v_pk_mov_b32 v[78:79], v[142:143], v[142:143] op_sel:[0,1]
    v_pk_mov_b32 v[140:141], 0, 0
    v_pk_mov_b32 v[142:143], 0, 0
    s_waitcnt lgkmcnt(3)
    v_mfma_f32_16x16x32_bf16 v[16:19], v[80:83], v[144:147], v[16:19]
    v_pk_mov_b32 v[80:81], v[144:145], v[144:145] op_sel:[0,1]
    v_pk_mov_b32 v[82:83], v[146:147], v[146:147] op_sel:[0,1]
    v_pk_mov_b32 v[144:145], 0, 0
    v_pk_mov_b32 v[146:147], 0, 0
    s_waitcnt lgkmcnt(2)
    v_mfma_f32_16x16x32_bf16 v[16:19], v[84:87], v[148:151], v[16:19]
    v_pk_mov_b32 v[84:85], v[148:149], v[148:149] op_sel:[0,1]
    v_pk_mov_b32 v[86:87], v[150:151], v[150:151] op_sel:[0,1]
    v_pk_mov_b32 v[148:149], 0, 0
    v_pk_mov_b32 v[150:151], 0, 0
    s_waitcnt lgkmcnt(1)
    v_mfma_f32_16x16x32_bf16 v[16:19], v[88:91], v[152:155], v[16:19]
    v_pk_mov_b32 v[88:89], v[152:153], v[152:153] op_sel:[0,1]
    v_pk_mov_b32 v[90:91], v[154:155], v[154:155] op_sel:[0,1]
    v_pk_mov_b32 v[152:153], 0, 0
    v_pk_mov_b32 v[154:155], 0, 0
    s_waitcnt lgkmcnt(0)
    v_mfma_f32_16x16x32_bf16 v[16:19], v[92:95], v[156:159], v[16:19]
    v_pk_mov_b32 v[92:93], v[156:157], v[156:157] op_sel:[0,1]
    v_pk_mov_b32 v[94:95], v[158:159], v[158:159] op_sel:[0,1]
    v_pk_mov_b32 v[156:157], 0, 0
    v_pk_mov_b32 v[158:159], 0, 0
    v_mov_b32 v162, 0x24104
    v_mov_b32 v163, 1
    s_mov_b64 exec, 1
    ds_add_u32 v162, v163
    s_mov_b64 exec, -1
    s_branch BM_177
BS_178:
    s_bfe_u32 s7, s72, s67
    s_lshl_b32 s7, s7, 14
    v_add_u32 v20, s7, v4
    v_xor_b32 v21, 0x10, v20
    v_xor_b32 v22, 0x20, v20
    v_xor_b32 v23, 0x30, v20
    v_xor_b32 v24, 0x40, v20
    v_xor_b32 v25, 0x50, v20
    v_xor_b32 v26, 0x60, v20
    v_xor_b32 v27, 0x70, v20
    v_mov_b32 v162, 0x24000
    s_mov_b32 s80, 1600000
LW_179:
    ds_read_b32 v163, v162
    s_waitcnt lgkmcnt(0)
    v_readfirstlane_b32 s79, v163
    s_cmp_ge_u32 s79, s66
    s_cbranch_scc1 LWD_180
    s_sleep 1
    s_sub_u32 s80, s80, 1
    s_cmp_lg_u32 s80, 0
    s_cbranch_scc1 LW_179
LWD_180:
    ds_read_b128 v[96:99], v20
    ds_read_b128 v[100:103], v21
    ds_read_b128 v[104:107], v22
    ds_read_b128 v[108:111], v23
    ds_read_b128 v[112:115], v24
    ds_read_b128 v[116:119], v25
    ds_read_b128 v[120:123], v26
    ds_read_b128 v[124:127], v27
    v_xor_b32 v20, 0x80, v20
    v_xor_b32 v21, 0x80, v21
    v_xor_b32 v22, 0x80, v22
    v_xor_b32 v23, 0x80, v23
    v_xor_b32 v24, 0x80, v24
    v_xor_b32 v25, 0x80, v25
    v_xor_b32 v26, 0x80, v26
    v_xor_b32 v27, 0x80, v27
    s_waitcnt lgkmcnt(7)
    v_mfma_f32_16x16x32_bf16 v[16:19], v[96:99], v[32:35], 0
    ds_read_b128 v[96:99], v20
    s_waitcnt lgkmcnt(7)
    v_mfma_f32_16x16x32_bf16 v[16:19], v[100:103], v[36:39], v[16:19]
    ds_read_b128 v[100:103], v21
    s_waitcnt lgkmcnt(7)
    v_mfma_f32_16x16x32_bf16 v[16:19], v[104:107], v[40:43], v[16:19]
    ds_read_b128 v[104:107], v22
    s_waitcnt lgkmcnt(7)
    v_mfma_f32_16x16x32_bf16 v[16:19], v[108:111], v[44:47], v[16:19]
    ds_read_b128 v[108:111], v23
    s_waitcnt lgkmcnt(7)
    v_mfma_f32_16x16x32_bf16 v[16:19], v[112:115], v[48:51], v[16:19]
    ds_read_b128 v[112:115], v24
    s_waitcnt lgkmcnt(7)
    v_mfma_f32_16x16x32_bf16 v[16:19], v[116:119], v[52:55], v[16:19]
    ds_read_b128 v[116:119], v25
    s_waitcnt lgkmcnt(7)
    v_mfma_f32_16x16x32_bf16 v[16:19], v[120:123], v[56:59], v[16:19]
    ds_read_b128 v[120:123], v26
    s_waitcnt lgkmcnt(7)
    v_mfma_f32_16x16x32_bf16 v[16:19], v[124:127], v[60:63], v[16:19]
    ds_read_b128 v[124:127], v27
    s_waitcnt lgkmcnt(7)
    v_mfma_f32_16x16x32_bf16 v[16:19], v[96:99], v[64:67], v[16:19]
    s_waitcnt lgkmcnt(6)
    v_mfma_f32_16x16x32_bf16 v[16:19], v[100:103], v[68:71], v[16:19]
    s_bfe_u32 s7, s72, 0x40000
    s_lshl_b32 s7, s7, 14
    v_add_u32 v20, s7, v9
    v_add_u32 v21, s7, v10
    v_add_u32 v22, s7, v11
    v_add_u32 v23, s7, v12
    s_waitcnt lgkmcnt(5)
    v_mfma_f32_16x16x32_bf16 v[16:19], v[104:107], v[72:75], v[16:19]
    s_waitcnt lgkmcnt(4)
    v_mfma_f32_16x16x32_bf16 v[16:19], v[108:111], v[76:79], v[16:19]
    s_bfe_u32 s7, s72, 0x40004
    s_lshl_b32 s7, s7, 14
    v_add_u32 v24, s7, v9
    v_add_u32 v25, s7, v10
    v_add_u32 v26, s7, v11
    v_add_u32 v27, s7, v12
    s_waitcnt lgkmcnt(3)
    v_mfma_f32_16x16x32_bf16 v[16:19], v[112:115], v[80:83], v[16:19]
    s_waitcnt lgkmcnt(2)
    v_mfma_f32_16x16x32_bf16 v[16:19], v[116:119], v[84:87], v[16:19]
    s_bfe_u32 s7, s72, 0x40008
    s_lshl_b32 s7, s7, 14
    v_add_u32 v28, s7, v9
    v_add_u32 v29, s7, v10
    v_add_u32 v30, s7, v11
    v_add_u32 v31, s7, v12
    s_waitcnt lgkmcnt(1)
    v_mfma_f32_16x16x32_bf16 v[16:19], v[120:123], v[88:91], v[16:19]
    s_waitcnt lgkmcnt(0)
    v_mfma_f32_16x16x32_bf16 v[16:19], v[124:127], v[92:95], v[16:19]
    s_cmp_ge_u32 s79, s70
    s_cbranch_scc1 BA_181
    v_mov_b32 v162, 0x24000
    s_mov_b32 s80, 1600000
LW_182:
    ds_read_b32 v163, v162
    s_waitcnt lgkmcnt(0)
    v_readfirstlane_b32 s79, v163
    s_cmp_ge_u32 s79, s70
    s_cbranch_scc1 LWD_183
    s_sleep 1
    s_sub_u32 s80, s80, 1
    s_cmp_lg_u32 s80, 0
    s_cbranch_scc1 LW_182
LWD_183:
BA_181:
    ds_read_b64_tr_b16 v[96:97], v20
    ds_read_b64_tr_b16 v[98:99], v22
    ds_read_b64_tr_b16 v[100:101], v21
    ds_read_b64_tr_b16 v[102:103], v23
    ds_read_b64_tr_b16 v[104:105], v24
    ds_read_b64_tr_b16 v[106:107], v26
    ds_read_b64_tr_b16 v[108:109], v25
    ds_read_b64_tr_b16 v[110:111], v27
    ds_read_b64_tr_b16 v[112:113], v28
    ds_read_b64_tr_b16 v[114:115], v30
    ds_read_b64_tr_b16 v[116:117], v29
    ds_read_b64_tr_b16 v[118:119], v31
    s_bfe_u32 s7, s72, 0x4000c
    s_lshl_b32 s7, s7, 14
    v_add_u32 v20, s7, v9
    v_add_u32 v21, s7, v10
    v_add_u32 v22, s7, v11
    v_add_u32 v23, s7, v12
    ds_read_b64_tr_b16 v[120:121], v20
    ds_read_b64_tr_b16 v[122:123], v22
    ds_read_b64_tr_b16 v[124:125], v21
    ds_read_b64_tr_b16 v[126:127], v23
    v_mov_b32 v162, 0x24100
    v_mov_b32 v163, 1
    s_mov_b64 exec, 1
    ds_add_u32 v162, v163
    s_mov_b64 exec, -1
BM_177:
    v_max3_f32 v160, v16, v17, v18
    v_max_f32 v160, v160, v19
    v_mov_b32 v161, v160
    s_nop 1
    v_permlane32_swap_b32 v160, v161
    v_max_f32 v160, v160, v161
    v_mov_b32 v161, v160
    s_nop 1
    v_permlane16_swap_b32 v160, v161
    v_max_f32 v160, v160, v161
    v_mul_f32 v160, s64, v160
    v_ceil_f32 v160, v160
    v_fma_f32 v16, v16, s64, -v160
    v_fma_f32 v17, v17, s64, -v160
    v_fma_f32 v18, v18, s64, -v160
    v_fma_f32 v19, v19, s64, -v160
    v_exp_f32 v16, v16
    v_exp_f32 v17, v17
    v_exp_f32 v18, v18
    v_exp_f32 v19, v19
    v_cvt_pk_bf16_f32 v162, v16, v17
    v_cvt_pk_bf16_f32 v163, v18, v19
    v_add_f32 v16, v16, v17
    v_add_f32 v18, v18, v19
    ds_write_b64 v6, v[162:163]
    v_add_f32 v161, v16, v18
    v_mov_b32 v16, v161
    s_nop 1
    v_permlane32_swap_b32 v161, v16
    v_add_f32 v161, v161, v16
    v_mov_b32 v16, v161
    s_nop 1
    v_permlane16_swap_b32 v161, v16
    v_add_f32 v161, v161, v16
    s_mov_b64 exec, s[84:85]
    ds_write_b64 v5, v[160:161]
    s_add_u32 s81, s81, 8
    v_mov_b32 v164, 0x2420c
    v_mov_b32 v165, 1
    s_mov_b64 exec, 1
    ds_add_u32 v164, v165
    s_mov_b64 exec, -1
    v_mov_b32 v164, 0x2420c
    s_mov_b32 s80, 1600000
LW_184:
    ds_read_b32 v165, v164
    s_waitcnt lgkmcnt(0)
    v_readfirstlane_b32 s79, v165
    s_cmp_ge_u32 s79, s81
    s_cbranch_scc1 LWD_185
    s_sub_u32 s80, s80, 1
    s_cmp_lg_u32 s80, 0
    s_cbranch_scc1 LW_184
LWD_185:
    ds_read_b32 v160, v8 offset:0
    ds_read_b32 v161, v8 offset:256
    ds_read_b32 v162, v8 offset:512
    ds_read_b32 v163, v8 offset:768
    ds_read_b128 v[16:19], v7 offset:0
    ds_read_b128 v[20:23], v7 offset:1024
    ds_read_b128 v[24:27], v7 offset:2048
    ds_read_b128 v[28:31], v7 offset:3072
    v_xor_b32 v6, 0x1000, v6
    v_xor_b32 v7, 0x1000, v7
    v_add_u32 v5, 1024, v5
    v_add_u32 v8, 1024, v8
    s_waitcnt lgkmcnt(4)
    v_max3_f32 v14, v13, v160, v161
    v_max3_f32 v14, v14, v162, v163
    v_cmp_neq_f32 vcc, v14, v13
    v_sub_f32 v160, v14, v160
    v_sub_f32 v161, v14, v161
    v_sub_f32 v162, v14, v162
    v_sub_f32 v163, v14, v163
    v_cvt_u32_f32 v160, v160
    v_cvt_u32_f32 v161, v161
    v_cvt_u32_f32 v162, v162
    v_cvt_u32_f32 v163, v163
    v_min_u32 v160, 0xff, v160
    v_min_u32 v161, 0xff, v161
    v_min_u32 v162, 0xff, v162
    v_min_u32 v163, 0xff, v163
    v_mul_u32_u24 v160, s71, v160
    v_mul_u32_u24 v161, s71, v161
    v_mul_u32_u24 v162, s71, v162
    v_mul_u32_u24 v163, s71, v163
    s_cbranch_vccz BR_186
    v_sub_f32 v164, v13, v14
    v_exp_f32 v164, v164
    v_mov_b32 v13, v14
    v_pk_mul_f32 v[128:129], v[128:129], v[164:165] op_sel_hi:[1,0]
    v_pk_mul_f32 v[130:131], v[130:131], v[164:165] op_sel_hi:[1,0]
    v_pk_mul_f32 v[132:133], v[132:133], v[164:165] op_sel_hi:[1,0]
    v_pk_mul_f32 v[134:135], v[134:135], v[164:165] op_sel_hi:[1,0]
    v_pk_mul_f32 v[136:137], v[136:137], v[164:165] op_sel_hi:[1,0]
    v_pk_mul_f32 v[138:139], v[138:139], v[164:165] op_sel_hi:[1,0]
    v_pk_mul_f32 v[140:141], v[140:141], v[164:165] op_sel_hi:[1,0]
    v_pk_mul_f32 v[142:143], v[142:143], v[164:165] op_sel_hi:[1,0]
    v_pk_mul_f32 v[144:145], v[144:145], v[164:165] op_sel_hi:[1,0]
    v_pk_mul_f32 v[146:147], v[146:147], v[164:165] op_sel_hi:[1,0]
    v_pk_mul_f32 v[148:149], v[148:149], v[164:165] op_sel_hi:[1,0]
    v_pk_mul_f32 v[150:151], v[150:151], v[164:165] op_sel_hi:[1,0]
    v_pk_mul_f32 v[152:153], v[152:153], v[164:165] op_sel_hi:[1,0]
    v_pk_mul_f32 v[154:155], v[154:155], v[164:165] op_sel_hi:[1,0]
    v_pk_mul_f32 v[156:157], v[156:157], v[164:165] op_sel_hi:[1,0]
    v_pk_mul_f32 v[158:159], v[158:159], v[164:165] op_sel_hi:[1,0]
BR_186:
    s_waitcnt lgkmcnt(3)
    v_pk_sub_u16 v16, v16, v160 clamp
    v_pk_sub_u16 v17, v17, v160 clamp
    v_pk_sub_u16 v18, v18, v160 clamp
    v_pk_sub_u16 v19, v19, v160 clamp
    s_nop 1
    v_mfma_f32_32x32x16_bf16 v[128:143], v[96:99], v[16:19], v[128:143]
    v_mfma_f32_32x32x16_bf16 v[144:159], v[100:103], v[16:19], v[144:159]
    s_waitcnt lgkmcnt(2)
    v_pk_sub_u16 v20, v20, v161 clamp
    v_pk_sub_u16 v21, v21, v161 clamp
    v_pk_sub_u16 v22, v22, v161 clamp
    v_pk_sub_u16 v23, v23, v161 clamp
    s_nop 1
    v_mfma_f32_32x32x16_bf16 v[128:143], v[104:107], v[20:23], v[128:143]
    v_mfma_f32_32x32x16_bf16 v[144:159], v[108:111], v[20:23], v[144:159]
    s_waitcnt lgkmcnt(1)
    v_pk_sub_u16 v24, v24, v162 clamp
    v_pk_sub_u16 v25, v25, v162 clamp
    v_pk_sub_u16 v26, v26, v162 clamp
    v_pk_sub_u16 v27, v27, v162 clamp
    s_nop 1
    v_mfma_f32_32x32x16_bf16 v[128:143], v[112:115], v[24:27], v[128:143]
    v_mfma_f32_32x32x16_bf16 v[144:159], v[116:119], v[24:27], v[144:159]
    s_waitcnt lgkmcnt(0)
    v_pk_sub_u16 v28, v28, v163 clamp
    v_pk_sub_u16 v29, v29, v163 clamp
    v_pk_sub_u16 v30, v30, v163 clamp
    v_pk_sub_u16 v31, v31, v163 clamp
    s_nop 1
    v_mfma_f32_32x32x16_bf16 v[128:143], v[120:123], v[28:31], v[128:143]
    v_mfma_f32_32x32x16_bf16 v[144:159], v[124:127], v[28:31], v[144:159]
    s_lshr_b64 s[72:73], s[72:73], 16
    s_add_u32 s66, s66, 64
    s_add_u32 s70, s70, 64
    s_sub_u32 s69, s69, 1
    s_cmp_lg_u32 s69, 0
    s_cbranch_scc1 BS_178
    s_lshr_b32 s67, s60, 3
    s_and_b32 s68, s60, 7
    s_lshl_b32 s7, s60, 15
    s_lshl_b32 s63, s6, 12
    s_add_u32 s7, s7, s63
    s_add_u32 s7, s7, 0x600000
    v_lshl_add_u32 v5, v1, 4, s7
    v_mov_b32 v38, s92
    v_mov_b32 v39, s93
    s_cmp_lg_u32 s6, 7
    s_cbranch_scc1 B7_187
    v_lshrrev_b32 v45, 5, v1
    v_lshl_add_u32 v45, v45, 11, v8
    v_add_u32 v45, -4096, v45
    ds_read_b64 v[48:49], v45 offset:0
    ds_read_b64 v[50:51], v45 offset:256
    ds_read_b64 v[52:53], v45 offset:512
    ds_read_b64 v[54:55], v45 offset:768
    ds_read_b64 v[56:57], v45 offset:1024
    ds_read_b64 v[58:59], v45 offset:1280
    ds_read_b64 v[60:61], v45 offset:1536
    ds_read_b64 v[62:63], v45 offset:1792
    s_lshl_b32 s7, s60, 9
    s_add_u32 s7, s7, 0x28000
    v_lshl_add_u32 v44, v1, 4, s7
    v_mov_b32 v36, v13
    s_waitcnt lgkmcnt(0)
    v_sub_f32 v48, v48, v36
    v_sub_f32 v50, v50, v36
    v_sub_f32 v52, v52, v36
    v_sub_f32 v54, v54, v36
    v_sub_f32 v56, v56, v36
    v_sub_f32 v58, v58, v36
    v_sub_f32 v60, v60, v36
    v_sub_f32 v62, v62, v36
    v_exp_f32 v48, v48
    v_exp_f32 v50, v50
    v_exp_f32 v52, v52
    v_exp_f32 v54, v54
    v_exp_f32 v56, v56
    v_exp_f32 v58, v58
    v_exp_f32 v60, v60
    v_exp_f32 v62, v62
    v_mul_f32 v37, v48, v49
    v_fmac_f32 v37, v50, v51
    v_fmac_f32 v37, v52, v53
    v_fmac_f32 v37, v54, v55
    v_fmac_f32 v37, v56, v57
    v_fmac_f32 v37, v58, v59
    v_fmac_f32 v37, v60, v61
    v_fmac_f32 v37, v62, v63
    v_mov_b32 v48, v37
    s_nop 1
    v_permlane32_swap_b32 v37, v48
    v_add_f32 v37, v37, v48
    s_mov_b64 exec, 0xffffffff
    s_cmp_eq_u32 s101, 0
    s_cbranch_scc1 SU_188
    buffer_store_dwordx4 v[36:39], v44, s[36:39], 0 offen
SV_189:
    s_mov_b64 exec, -1
B7_187:
    v_permlane32_swap_b32 v128, v132
    v_permlane32_swap_b32 v129, v133
    v_permlane32_swap_b32 v130, v134
    v_permlane32_swap_b32 v131, v135
    v_cvt_pk_bf16_f32 v16, v128, v129
    v_cvt_pk_bf16_f32 v17, v130, v131
    v_cvt_pk_bf16_f32 v18, v132, v133
    v_cvt_pk_bf16_f32 v19, v134, v135
    v_permlane32_swap_b32 v136, v140
    v_permlane32_swap_b32 v137, v141
    v_permlane32_swap_b32 v138, v142
    v_permlane32_swap_b32 v139, v143
    v_cvt_pk_bf16_f32 v20, v136, v137
    v_cvt_pk_bf16_f32 v21, v138, v139
    v_cvt_pk_bf16_f32 v22, v140, v141
    v_cvt_pk_bf16_f32 v23, v142, v143
    v_permlane32_swap_b32 v144, v148
    v_permlane32_swap_b32 v145, v149
    v_permlane32_swap_b32 v146, v150
    v_permlane32_swap_b32 v147, v151
    v_cvt_pk_bf16_f32 v24, v144, v145
    v_cvt_pk_bf16_f32 v25, v146, v147
    v_cvt_pk_bf16_f32 v26, v148, v149
    v_cvt_pk_bf16_f32 v27, v150, v151
    v_permlane32_swap_b32 v152, v156
    v_permlane32_swap_b32 v153, v157
    v_permlane32_swap_b32 v154, v158
    v_permlane32_swap_b32 v155, v159
    v_cvt_pk_bf16_f32 v28, v152, v153
    v_cvt_pk_bf16_f32 v29, v154, v155
    v_cvt_pk_bf16_f32 v30, v156, v157
    v_cvt_pk_bf16_f32 v31, v158, v159
    s_lshl_b32 s7, s67, 9
    s_lshl_b32 s65, s6, 6
    s_add_u32 s7, s7, s65
    s_add_u32 s7, s7, 0x23000
    v_and_b32 v160, 7, v1
    v_lshl_add_u32 v7, v160, 3, s7
    s_lshl_b64 s[88:89], 1, s68
    s_cmp_eq_u32 s101, 0
    s_cbranch_scc1 SU_190
    buffer_store_dwordx4 v[16:19], v5, s[36:39], 0 offen offset:0
    buffer_store_dwordx4 v[20:23], v5, s[36:39], 0 offen offset:1024
    buffer_store_dwordx4 v[24:27], v5, s[36:39], 0 offen offset:2048
    buffer_store_dwordx4 v[28:31], v5, s[36:39], 0 offen offset:3072
    s_waitcnt vmcnt(0)
    s_mov_b64 exec, s[88:89]
    buffer_store_dwordx2 v[38:39], v7, s[36:39], 0 offen
    s_mov_b64 exec, -1
SV_191:
    s_lshl_b32 s7, s67, 18
    s_add_u32 s7, s7, s63
    s_lshl_b32 s65, s68, 6
    s_add_u32 s7, s7, s65
    s_add_u32 s7, s7, 0x600000
    v_and_b32 v160, 3, v1
    v_lshl_add_u32 v5, v160, 4, s7
    v_bfe_u32 v161, v1, 2, 3
    v_lshl_add_u32 v5, v161, 9, v5
    v_lshrrev_b32 v162, 5, v1
    v_lshl_add_u32 v5, v162, 15, v5
    s_lshl_b32 s7, s67, 12
    s_add_u32 s7, s7, s65
    s_add_u32 s7, s7, 0x28000
    v_lshl_add_u32 v6, v160, 4, s7
    v_lshl_add_u32 v6, v162, 9, v6
    s_lshl_b32 s7, s68, 15
    s_lshl_b32 s63, s67, 10
    s_add_u32 s7, s7, s63
    s_lshl_b32 s63, s6, 7
    s_add_u32 s7, s7, s63
    s_add_u32 s7, s7, 0x200000
    v_lshl_add_u32 v8, v160, 13, s7
    v_lshl_add_u32 v8, v161, 4, v8
    v_lshl_add_u32 v8, v162, 3, v8
    s_lshl_b32 s7, s67, 7
    s_lshl_b32 s63, s68, 12
    s_add_u32 s7, s7, s63
    s_add_u32 s7, s7, 0x30000
    v_lshl_add_u32 v9, v160, 10, s7
    s_mov_b64 exec, 0xff
    buffer_load_dwordx2 v[40:41], v7, s[36:39], 0 offen sc1 nt
    s_mov_b32 s80, 200000
MC_193:
    s_mov_b64 exec, 0xff
    s_waitcnt vmcnt(0)
    v_cmp_ne_u64 s[86:87], s[92:93], v[40:41]
    s_cmp_lg_u64 s[86:87], 0
    s_cbranch_scc1 M_192
MD_194:
    s_mov_b64 exec, -1
    buffer_load_dwordx4 v[64:67], v6, s[36:39], 0 offen offset:0 sc1 nt
    buffer_load_dwordx4 v[68:71], v6, s[36:39], 0 offen offset:1024 sc1 nt
    buffer_load_dwordx4 v[72:75], v6, s[36:39], 0 offen offset:2048 sc1 nt
    buffer_load_dwordx4 v[76:79], v6, s[36:39], 0 offen offset:3072 sc1 nt
    s_mov_b32 s63, 0
    buffer_load_dwordx4 v[48:51], v5, s[36:39], s63 offen sc1 nt
    s_add_u32 s63, s63, 65536
    buffer_load_dwordx4 v[52:55], v5, s[36:39], s63 offen sc1 nt
    s_add_u32 s63, s63, 65536
    buffer_load_dwordx4 v[56:59], v5, s[36:39], s63 offen sc1 nt
    s_add_u32 s63, s63, 65536
    buffer_load_dwordx4 v[60:63], v5, s[36:39], s63 offen sc1 nt
    s_add_u32 s63, s63, 65536
    s_waitcnt vmcnt(4)
    v_cmp_ne_u64 s[90:91], s[92:93], v[66:67]
    v_cmp_ne_u64 vcc, s[92:93], v[70:71]
    s_or_b64 s[90:91], s[90:91], vcc
    v_cmp_ne_u64 vcc, s[92:93], v[74:75]
    s_or_b64 s[90:91], s[90:91], vcc
    v_cmp_ne_u64 vcc, s[92:93], v[78:79]
    s_or_b64 s[90:91], s[90:91], vcc
    s_cmp_lg_u64 s[90:91], 0
    s_cbranch_scc1 BL_195
BLD_196:
    v_max3_f32 v36, v64, v68, v72
    v_max_f32 v36, v36, v76
    v_mov_b32 v37, v36
    s_nop 1
    v_permlane32_swap_b32 v36, v37
    v_max_f32 v36, v36, v37
    v_sub_f32 v80, v64, v36
    v_sub_f32 v81, v68, v36
    v_sub_f32 v82, v72, v36
    v_sub_f32 v83, v76, v36
    v_exp_f32 v80, v80
    v_exp_f32 v81, v81
    v_exp_f32 v82, v82
    v_exp_f32 v83, v83
    v_mul_f32 v37, v80, v65
    v_fmac_f32 v37, v81, v69
    v_fmac_f32 v37, v82, v73
    v_fmac_f32 v37, v83, v77
    v_mov_b32 v40, v37
    s_nop 1
    v_permlane32_swap_b32 v37, v40
    v_add_f32 v37, v37, v40
    s_waitcnt vmcnt(3)
    v_lshlrev_b32 v88, 16, v48
    v_and_b32 v89, 0xffff0000, v48
    v_lshlrev_b32 v90, 16, v49
    v_and_b32 v91, 0xffff0000, v49
    v_lshlrev_b32 v92, 16, v50
    v_and_b32 v93, 0xffff0000, v50
    v_lshlrev_b32 v94, 16, v51
    v_and_b32 v95, 0xffff0000, v51
    v_mul_f32 v16, v88, v80
    v_mul_f32 v17, v89, v80
    v_mul_f32 v18, v90, v80
    v_mul_f32 v19, v91, v80
    v_mul_f32 v20, v92, v80
    v_mul_f32 v21, v93, v80
    v_mul_f32 v22, v94, v80
    v_mul_f32 v23, v95, v80
    s_waitcnt vmcnt(2)
    v_lshlrev_b32 v88, 16, v52
    v_and_b32 v89, 0xffff0000, v52
    v_lshlrev_b32 v90, 16, v53
    v_and_b32 v91, 0xffff0000, v53
    v_lshlrev_b32 v92, 16, v54
    v_and_b32 v93, 0xffff0000, v54
    v_lshlrev_b32 v94, 16, v55
    v_and_b32 v95, 0xffff0000, v55
    v_fmac_f32 v16, v88, v81
    v_fmac_f32 v17, v89, v81
    v_fmac_f32 v18, v90, v81
    v_fmac_f32 v19, v91, v81
    v_fmac_f32 v20, v92, v81
    v_fmac_f32 v21, v93, v81
    v_fmac_f32 v22, v94, v81
    v_fmac_f32 v23, v95, v81
    s_waitcnt vmcnt(1)
    v_lshlrev_b32 v88, 16, v56
    v_and_b32 v89, 0xffff0000, v56
    v_lshlrev_b32 v90, 16, v57
    v_and_b32 v91, 0xffff0000, v57
    v_lshlrev_b32 v92, 16, v58
    v_and_b32 v93, 0xffff0000, v58
    v_lshlrev_b32 v94, 16, v59
    v_and_b32 v95, 0xffff0000, v59
    v_fmac_f32 v16, v88, v82
    v_fmac_f32 v17, v89, v82
    v_fmac_f32 v18, v90, v82
    v_fmac_f32 v19, v91, v82
    v_fmac_f32 v20, v92, v82
    v_fmac_f32 v21, v93, v82
    v_fmac_f32 v22, v94, v82
    v_fmac_f32 v23, v95, v82
    s_waitcnt vmcnt(0)
    v_mov_b32 v160, 0x24218
    v_mov_b32 v161, 1
    s_mov_b64 exec, 1
    ds_add_u32 v160, v161
    s_mov_b64 exec, -1
    v_lshlrev_b32 v88, 16, v60
    v_and_b32 v89, 0xffff0000, v60
    v_lshlrev_b32 v90, 16, v61
    v_and_b32 v91, 0xffff0000, v61
    v_lshlrev_b32 v92, 16, v62
    v_and_b32 v93, 0xffff0000, v62
    v_lshlrev_b32 v94, 16, v63
    v_and_b32 v95, 0xffff0000, v63
    v_fmac_f32 v16, v88, v83
    v_fmac_f32 v17, v89, v83
    v_fmac_f32 v18, v90, v83
    v_fmac_f32 v19, v91, v83
    v_fmac_f32 v20, v92, v83
    v_fmac_f32 v21, v93, v83
    v_fmac_f32 v22, v94, v83
    v_fmac_f32 v23, v95, v83
    v_permlane32_swap_b32 v16, v20
    v_permlane32_swap_b32 v17, v21
    v_permlane32_swap_b32 v18, v22
    v_permlane32_swap_b32 v19, v23
    v_add_f32 v16, v16, v20
    v_add_f32 v17, v17, v21
    v_add_f32 v18, v18, v22
    v_add_f32 v19, v19, v23
    v_cvt_pk_bf16_f32 v44, v16, v17
    v_cvt_pk_bf16_f32 v45, v18, v19
    v_mov_b32 v160, 0x24218
    s_mov_b32 s80, 1600000
LW_197:
    ds_read_b32 v161, v160
    s_waitcnt lgkmcnt(0)
    v_readfirstlane_b32 s79, v161
    s_cmp_ge_u32 s79, 8
    s_cbranch_scc1 LWD_198
    s_sub_u32 s80, s80, 1
    s_cmp_lg_u32 s80, 0
    s_cbranch_scc1 LW_197
LWD_198:
    buffer_store_dwordx2 v[44:45], v8, s[36:39], 0 offen sc1
    s_cmp_lg_u32 s6, 0
    s_cbranch_scc1 BM2_199
    s_mov_b64 exec, 15
    buffer_store_dwordx4 v[36:39], v9, s[36:39], 0 offen sc1
    s_mov_b64 exec, -1
BM2_199:
    v_mov_b32 v160, 0x24218
    v_mov_b32 v161, 1
    s_mov_b64 exec, 1
    ds_add_u32 v160, v161
    s_mov_b64 exec, -1
    s_lshl_b32 s7, s67, 13
    s_lshl_b32 s63, s6, 10
    s_add_u32 s7, s7, s63
    s_add_u32 s7, s7, 0xc0000
    v_lshl_add_u32 v4, v1, 4, s7
    v_lshrrev_b32 v160, 2, v3
    v_mul_u32_u24 v5, 1088, v160
    v_and_b32 v160, 3, v1
    v_lshl_add_u32 v5, v160, 4, v5
    v_lshrrev_b32 v161, 5, v1
    v_lshl_add_u32 v5, v161, 6, v5
    v_and_b32 v161, 1, v2
    v_lshl_add_u32 v5, v161, 3, v5
    s_lshl_b32 s7, s6, 7
    s_add_u32 s7, s7, 0x26000
    v_add_u32 v5, s7, v5
    v_mul_u32_u24 v6, 1088, v160
    v_lshl_add_u32 v6, v2, 4, v6
    v_add_u32 v6, 0x26000, v6
    s_lshl_b32 s7, s68, 2
    s_add_u32 s7, s7, s6
    s_lshl_b32 s7, s7, 3
    s_add_u32 s7, s7, s67
    s_lshl_b32 s7, s7, 8
    s_add_u32 s7, s7, 0x2c0000
    v_lshl_add_u32 v7, v160, 6, s7
    v_lshl_add_u32 v7, v2, 4, v7
    v_cmp_gt_u32 s[84:85], 4, v3
    v_bfe_u32 v8, v1, 3, 2
    v_xor_b32 v8, s6, v8
    v_lshlrev_b32 v8, 5, v8
    v_lshrrev_b32 v161, 2, v1
    v_lshl_add_u32 v8, v161, 7, v8
    v_lshl_add_u32 v8, v160, 3, v8
    s_cmp_ge_u32 s6, 4
    s_cbranch_scc1 W4_200
    v_mov_b32 v162, 0x24000
    s_mov_b32 s80, 1600000
LW_201:
    ds_read_b32 v163, v162
    s_waitcnt lgkmcnt(0)
    v_readfirstlane_b32 s79, v163
    s_cmp_ge_u32 s79, 288
    s_cbranch_scc1 LWD_202
    s_sleep 1
    s_sub_u32 s80, s80, 1
    s_cmp_lg_u32 s80, 0
    s_cbranch_scc1 LW_201
LWD_202:
    ds_read_b64_tr_b16 v[48:49], v8 offset:0
    ds_read_b64_tr_b16 v[50:51], v8 offset:2048
    ds_read_b64_tr_b16 v[52:53], v8 offset:4096
    ds_read_b64_tr_b16 v[54:55], v8 offset:6144
    ds_read_b64_tr_b16 v[56:57], v8 offset:8192
    ds_read_b64_tr_b16 v[58:59], v8 offset:10240
    ds_read_b64_tr_b16 v[60:61], v8 offset:12288
    ds_read_b64_tr_b16 v[62:63], v8 offset:14336
    s_waitcnt lgkmcnt(4)
    ds_read_b64_tr_b16 v[64:65], v8 offset:16384
    ds_read_b64_tr_b16 v[66:67], v8 offset:18432
    ds_read_b64_tr_b16 v[68:69], v8 offset:20480
    ds_read_b64_tr_b16 v[70:71], v8 offset:22528
    ds_read_b64_tr_b16 v[72:73], v8 offset:24576
    ds_read_b64_tr_b16 v[74:75], v8 offset:26624
    ds_read_b64_tr_b16 v[76:77], v8 offset:28672
    ds_read_b64_tr_b16 v[78:79], v8 offset:30720
    s_waitcnt lgkmcnt(4)
    v_mov_b32 v162, 0x24000
    s_mov_b32 s80, 1600000
LW_203:
    ds_read_b32 v163, v162
    s_waitcnt lgkmcnt(0)
    v_readfirstlane_b32 s79, v163
    s_cmp_ge_u32 s79, 320
    s_cbranch_scc1 LWD_204
    s_sleep 1
    s_sub_u32 s80, s80, 1
    s_cmp_lg_u32 s80, 0
    s_cbranch_scc1 LW_203
LWD_204:
    ds_read_b64_tr_b16 v[80:81], v8 offset:32768
    ds_read_b64_tr_b16 v[82:83], v8 offset:34816
    ds_read_b64_tr_b16 v[84:85], v8 offset:36864
    ds_read_b64_tr_b16 v[86:87], v8 offset:38912
    ds_read_b64_tr_b16 v[88:89], v8 offset:40960
    ds_read_b64_tr_b16 v[90:91], v8 offset:43008
    ds_read_b64_tr_b16 v[92:93], v8 offset:45056
    ds_read_b64_tr_b16 v[94:95], v8 offset:47104
    s_waitcnt lgkmcnt(4)
    ds_read_b64_tr_b16 v[96:97], v8 offset:49152
    ds_read_b64_tr_b16 v[98:99], v8 offset:51200
    ds_read_b64_tr_b16 v[100:101], v8 offset:53248
    ds_read_b64_tr_b16 v[102:103], v8 offset:55296
    ds_read_b64_tr_b16 v[104:105], v8 offset:57344
    ds_read_b64_tr_b16 v[106:107], v8 offset:59392
    ds_read_b64_tr_b16 v[108:109], v8 offset:61440
    ds_read_b64_tr_b16 v[110:111], v8 offset:63488
    s_waitcnt lgkmcnt(4)
W4_200:
    s_mov_b64 exec, -1
    buffer_load_dwordx4 v[16:19], v4, s[36:39], 0 offen sc1 nt
    s_mov_b32 s80, 200000
MC_206:
    s_mov_b64 exec, -1
    s_waitcnt vmcnt(0)
    v_cmp_ne_u64 s[86:87], s[92:93], v[18:19]
    s_cmp_lg_u64 s[86:87], 0
    s_cbranch_scc1 M_205
MD_207:
    s_mov_b64 exec, -1
    ds_write_b64 v5, v[16:17]
    s_add_u32 s81, s81, 8
    v_mov_b32 v160, 0x2420c
    v_mov_b32 v161, 1
    s_mov_b64 exec, 1
    ds_add_u32 v160, v161
    s_mov_b64 exec, -1
    s_cmp_ge_u32 s6, 4
    s_cbranch_scc1 L_END
    v_mov_b32 v160, 0x2420c
    s_mov_b32 s80, 1600000
LW_208:
    ds_read_b32 v161, v160
    s_waitcnt lgkmcnt(0)
    v_readfirstlane_b32 s79, v161
    s_cmp_ge_u32 s79, s81
    s_cbranch_scc1 LWD_209
    s_sub_u32 s80, s80, 1
    s_cmp_lg_u32 s80, 0
    s_cbranch_scc1 LW_208
LWD_209:
    ds_read_b128 v[112:115], v6 offset:0
    ds_read_b128 v[116:119], v6 offset:64
    ds_read_b128 v[120:123], v6 offset:128
    ds_read_b128 v[124:127], v6 offset:192
    ds_read_b128 v[128:131], v6 offset:256
    ds_read_b128 v[132:135], v6 offset:320
    ds_read_b128 v[136:139], v6 offset:384
    ds_read_b128 v[140:143], v6 offset:448
    ds_read_b128 v[144:147], v6 offset:512
    ds_read_b128 v[148:151], v6 offset:576
    ds_read_b128 v[152:155], v6 offset:640
    ds_read_b128 v[156:159], v6 offset:704
    s_waitcnt lgkmcnt(8)
    ds_read_b128 v[20:23], v6 offset:768
    ds_read_b128 v[24:27], v6 offset:832
    ds_read_b128 v[28:31], v6 offset:896
    ds_read_b128 v[32:35], v6 offset:960
    v_mfma_f32_16x16x32_bf16 v[12:15], v[48:51], v[112:115], 0
    v_mfma_f32_16x16x32_bf16 v[12:15], v[52:55], v[116:119], v[12:15]
    v_mfma_f32_16x16x32_bf16 v[12:15], v[56:59], v[120:123], v[12:15]
    v_mfma_f32_16x16x32_bf16 v[12:15], v[60:63], v[124:127], v[12:15]
    s_waitcnt lgkmcnt(11)
    v_mfma_f32_16x16x32_bf16 v[12:15], v[64:67], v[128:131], v[12:15]
    s_waitcnt lgkmcnt(10)
    v_mfma_f32_16x16x32_bf16 v[12:15], v[68:71], v[132:135], v[12:15]
    s_waitcnt lgkmcnt(9)
    v_mfma_f32_16x16x32_bf16 v[12:15], v[72:75], v[136:139], v[12:15]
    s_waitcnt lgkmcnt(8)
    v_mfma_f32_16x16x32_bf16 v[12:15], v[76:79], v[140:143], v[12:15]
    s_waitcnt lgkmcnt(7)
    v_mfma_f32_16x16x32_bf16 v[12:15], v[80:83], v[144:147], v[12:15]
    s_waitcnt lgkmcnt(6)
    v_mfma_f32_16x16x32_bf16 v[12:15], v[84:87], v[148:151], v[12:15]
    s_waitcnt lgkmcnt(5)
    v_mfma_f32_16x16x32_bf16 v[12:15], v[88:91], v[152:155], v[12:15]
    s_waitcnt lgkmcnt(4)
    v_mfma_f32_16x16x32_bf16 v[12:15], v[92:95], v[156:159], v[12:15]
    s_waitcnt lgkmcnt(3)
    v_mfma_f32_16x16x32_bf16 v[12:15], v[96:99], v[20:23], v[12:15]
    s_waitcnt lgkmcnt(2)
    v_mfma_f32_16x16x32_bf16 v[12:15], v[100:103], v[24:27], v[12:15]
    s_waitcnt lgkmcnt(1)
    v_mfma_f32_16x16x32_bf16 v[12:15], v[104:107], v[28:31], v[12:15]
    s_waitcnt lgkmcnt(0)
    v_mfma_f32_16x16x32_bf16 v[12:15], v[108:111], v[32:35], v[12:15]
    s_nop 7
    v_cvt_pk_bf16_f32 v16, v12, v13
    v_cvt_pk_bf16_f32 v17, v14, v15
    s_mov_b64 exec, s[84:85]
    buffer_store_dwordx4 v[16:19], v7, s[36:39], 0 offen sc1
    s_mov_b64 exec, -1
    v_mov_b32 v160, 0x24214
    v_mov_b32 v161, 1
    s_mov_b64 exec, 1
    ds_add_u32 v160, v161
    s_mov_b64 exec, -1
    s_branch L_RED
SU_9:
    s_nop 3
    buffer_store_dwordx4 v[72:75], v4, s[36:39], 0 offen sc1
    s_branch SV_10
SU_13:
    s_nop 3
    buffer_store_dwordx4 v[64:67], v5, s[36:39], 0 offen sc1
    s_branch SV_14
ST_19:
    ds_read_b32 v18, v17
    s_waitcnt lgkmcnt(0)
    v_readlane_b32 s79, v18, s62
    s_cmp_ge_u32 s79, s63
    s_cbranch_scc1 GO_18
    s_waitcnt vmcnt(24)
    s_sub_u32 s7, s60, 24
    s_max_i32 s61, s61, s7
    v_mov_b32 v19, s61
    ds_write_b32 v16, v19
    ds_read_b32 v18, v17
    s_waitcnt lgkmcnt(0)
    v_readlane_b32 s79, v18, s62
    s_cmp_ge_u32 s79, s63
    s_cbranch_scc1 GO_18
    s_waitcnt vmcnt(16)
    s_sub_u32 s7, s60, 16
    s_max_i32 s61, s61, s7
    v_mov_b32 v19, s61
    ds_write_b32 v16, v19
    ds_read_b32 v18, v17
    s_waitcnt lgkmcnt(0)
    v_readlane_b32 s79, v18, s62
    s_cmp_ge_u32 s79, s63
    s_cbranch_scc1 GO_18
    s_waitcnt vmcnt(8)
    s_sub_u32 s7, s60, 8
    s_max_i32 s61, s61, s7
    v_mov_b32 v19, s61
    ds_write_b32 v16, v19
    ds_read_b32 v18, v17
    s_waitcnt lgkmcnt(0)
    v_readlane_b32 s79, v18, s62
    s_cmp_ge_u32 s79, s63
    s_cbranch_scc1 GO_18
    s_waitcnt vmcnt(0)
    s_mov_b32 s61, s60
    v_mov_b32 v19, s61
    ds_write_b32 v16, v19
    ds_read_b32 v18, v17
    s_waitcnt lgkmcnt(0)
    v_readlane_b32 s79, v18, s62
    s_cmp_ge_u32 s79, s63
    s_cbranch_scc1 GO_18
    s_mov_b32 s80, 1600000
SP_210:
    ds_read_b32 v18, v17
    s_waitcnt lgkmcnt(0)
    v_readlane_b32 s79, v18, s62
    s_cmp_ge_u32 s79, s63
    s_cbranch_scc1 GO_18
    s_sub_u32 s80, s80, 1
    s_cmp_lg_u32 s80, 0
    s_cbranch_scc1 SP_210
    s_branch GO_18
ST_26:
    ds_read_b32 v18, v17
    s_waitcnt lgkmcnt(0)
    v_readlane_b32 s79, v18, s62
    s_cmp_ge_u32 s79, s63
    s_cbranch_scc1 GO_25
    s_waitcnt vmcnt(24)
    s_sub_u32 s7, s60, 24
    s_max_i32 s61, s61, s7
    v_mov_b32 v19, s61
    ds_write_b32 v16, v19
    ds_read_b32 v18, v17
    s_waitcnt lgkmcnt(0)
    v_readlane_b32 s79, v18, s62
    s_cmp_ge_u32 s79, s63
    s_cbranch_scc1 GO_25
    s_waitcnt vmcnt(16)
    s_sub_u32 s7, s60, 16
    s_max_i32 s61, s61, s7
    v_mov_b32 v19, s61
    ds_write_b32 v16, v19
    ds_read_b32 v18, v17
    s_waitcnt lgkmcnt(0)
    v_readlane_b32 s79, v18, s62
    s_cmp_ge_u32 s79, s63
    s_cbranch_scc1 GO_25
    s_waitcnt vmcnt(8)
    s_sub_u32 s7, s60, 8
    s_max_i32 s61, s61, s7
    v_mov_b32 v19, s61
    ds_write_b32 v16, v19
    ds_read_b32 v18, v17
    s_waitcnt lgkmcnt(0)
    v_readlane_b32 s79, v18, s62
    s_cmp_ge_u32 s79, s63
    s_cbranch_scc1 GO_25
    s_waitcnt vmcnt(0)
    s_mov_b32 s61, s60
    v_mov_b32 v19, s61
    ds_write_b32 v16, v19
    ds_read_b32 v18, v17
    s_waitcnt lgkmcnt(0)
    v_readlane_b32 s79, v18, s62
    s_cmp_ge_u32 s79, s63
    s_cbranch_scc1 GO_25
    s_mov_b32 s80, 1600000
SP_211:
    ds_read_b32 v18, v17
    s_waitcnt lgkmcnt(0)
    v_readlane_b32 s79, v18, s62
    s_cmp_ge_u32 s79, s63
    s_cbranch_scc1 GO_25
    s_sub_u32 s80, s80, 1
    s_cmp_lg_u32 s80, 0
    s_cbranch_scc1 SP_211
    s_branch GO_25
ST_32:
    ds_read_b32 v18, v17
    s_waitcnt lgkmcnt(0)
    v_readlane_b32 s79, v18, s62
    s_cmp_ge_u32 s79, s63
    s_cbranch_scc1 GO_31
    s_waitcnt vmcnt(40)
    s_sub_u32 s7, s60, 40
    s_max_i32 s61, s61, s7
    v_mov_b32 v19, s61
    ds_write_b32 v16, v19
    ds_read_b32 v18, v17
    s_waitcnt lgkmcnt(0)
    v_readlane_b32 s79, v18, s62
    s_cmp_ge_u32 s79, s63
    s_cbranch_scc1 GO_31
    s_waitcnt vmcnt(32)
    s_sub_u32 s7, s60, 32
    s_max_i32 s61, s61, s7
    v_mov_b32 v19, s61
    ds_write_b32 v16, v19
    ds_read_b32 v18, v17
    s_waitcnt lgkmcnt(0)
    v_readlane_b32 s79, v18, s62
    s_cmp_ge_u32 s79, s63
    s_cbranch_scc1 GO_31
    s_waitcnt vmcnt(24)
    s_sub_u32 s7, s60, 24
    s_max_i32 s61, s61, s7
    v_mov_b32 v19, s61
    ds_write_b32 v16, v19
    ds_read_b32 v18, v17
    s_waitcnt lgkmcnt(0)
    v_readlane_b32 s79, v18, s62
    s_cmp_ge_u32 s79, s63
    s_cbranch_scc1 GO_31
    s_waitcnt vmcnt(16)
    s_sub_u32 s7, s60, 16
    s_max_i32 s61, s61, s7
    v_mov_b32 v19, s61
    ds_write_b32 v16, v19
    ds_read_b32 v18, v17
    s_waitcnt lgkmcnt(0)
    v_readlane_b32 s79, v18, s62
    s_cmp_ge_u32 s79, s63
    s_cbranch_scc1 GO_31
    s_waitcnt vmcnt(8)
    s_sub_u32 s7, s60, 8
    s_max_i32 s61, s61, s7
    v_mov_b32 v19, s61
    ds_write_b32 v16, v19
    ds_read_b32 v18, v17
    s_waitcnt lgkmcnt(0)
    v_readlane_b32 s79, v18, s62
    s_cmp_ge_u32 s79, s63
    s_cbranch_scc1 GO_31
    s_waitcnt vmcnt(0)
    s_mov_b32 s61, s60
    v_mov_b32 v19, s61
    ds_write_b32 v16, v19
    ds_read_b32 v18, v17
    s_waitcnt lgkmcnt(0)
    v_readlane_b32 s79, v18, s62
    s_cmp_ge_u32 s79, s63
    s_cbranch_scc1 GO_31
    s_mov_b32 s80, 1600000
SP_212:
    ds_read_b32 v18, v17
    s_waitcnt lgkmcnt(0)
    v_readlane_b32 s79, v18, s62
    s_cmp_ge_u32 s79, s63
    s_cbranch_scc1 GO_31
    s_sub_u32 s80, s80, 1
    s_cmp_lg_u32 s80, 0
    s_cbranch_scc1 SP_212
    s_branch GO_31
ST_38:
    ds_read_b32 v18, v17
    s_waitcnt lgkmcnt(0)
    v_readlane_b32 s79, v18, s62
    s_cmp_ge_u32 s79, s63
    s_cbranch_scc1 GO_37
    s_waitcnt vmcnt(40)
    s_sub_u32 s7, s60, 40
    s_max_i32 s61, s61, s7
    v_mov_b32 v19, s61
    ds_write_b32 v16, v19
    ds_read_b32 v18, v17
    s_waitcnt lgkmcnt(0)
    v_readlane_b32 s79, v18, s62
    s_cmp_ge_u32 s79, s63
    s_cbranch_scc1 GO_37
    s_waitcnt vmcnt(32)
    s_sub_u32 s7, s60, 32
    s_max_i32 s61, s61, s7
    v_mov_b32 v19, s61
    ds_write_b32 v16, v19
    ds_read_b32 v18, v17
    s_waitcnt lgkmcnt(0)
    v_readlane_b32 s79, v18, s62
    s_cmp_ge_u32 s79, s63
    s_cbranch_scc1 GO_37
    s_waitcnt vmcnt(24)
    s_sub_u32 s7, s60, 24
    s_max_i32 s61, s61, s7
    v_mov_b32 v19, s61
    ds_write_b32 v16, v19
    ds_read_b32 v18, v17
    s_waitcnt lgkmcnt(0)
    v_readlane_b32 s79, v18, s62
    s_cmp_ge_u32 s79, s63
    s_cbranch_scc1 GO_37
    s_waitcnt vmcnt(16)
    s_sub_u32 s7, s60, 16
    s_max_i32 s61, s61, s7
    v_mov_b32 v19, s61
    ds_write_b32 v16, v19
    ds_read_b32 v18, v17
    s_waitcnt lgkmcnt(0)
    v_readlane_b32 s79, v18, s62
    s_cmp_ge_u32 s79, s63
    s_cbranch_scc1 GO_37
    s_waitcnt vmcnt(8)
    s_sub_u32 s7, s60, 8
    s_max_i32 s61, s61, s7
    v_mov_b32 v19, s61
    ds_write_b32 v16, v19
    ds_read_b32 v18, v17
    s_waitcnt lgkmcnt(0)
    v_readlane_b32 s79, v18, s62
    s_cmp_ge_u32 s79, s63
    s_cbranch_scc1 GO_37
    s_waitcnt vmcnt(0)
    s_mov_b32 s61, s60
    v_mov_b32 v19, s61
    ds_write_b32 v16, v19
    ds_read_b32 v18, v17
    s_waitcnt lgkmcnt(0)
    v_readlane_b32 s79, v18, s62
    s_cmp_ge_u32 s79, s63
    s_cbranch_scc1 GO_37
    s_mov_b32 s80, 1600000
SP_213:
    ds_read_b32 v18, v17
    s_waitcnt lgkmcnt(0)
    v_readlane_b32 s79, v18, s62
    s_cmp_ge_u32 s79, s63
    s_cbranch_scc1 GO_37
    s_sub_u32 s80, s80, 1
    s_cmp_lg_u32 s80, 0
    s_cbranch_scc1 SP_213
    s_branch GO_37
ST_40:
    ds_read_b32 v18, v17
    s_waitcnt lgkmcnt(0)
    v_readlane_b32 s79, v18, s62
    s_cmp_ge_u32 s79, s63
    s_cbranch_scc1 GO_39
    s_waitcnt vmcnt(40)
    s_sub_u32 s7, s60, 40
    s_max_i32 s61, s61, s7
    v_mov_b32 v19, s61
    ds_write_b32 v16, v19
    ds_read_b32 v18, v17
    s_waitcnt lgkmcnt(0)
    v_readlane_b32 s79, v18, s62
    s_cmp_ge_u32 s79, s63
    s_cbranch_scc1 GO_39
    s_waitcnt vmcnt(32)
    s_sub_u32 s7, s60, 32
    s_max_i32 s61, s61, s7
    v_mov_b32 v19, s61
    ds_write_b32 v16, v19
    ds_read_b32 v18, v17
    s_waitcnt lgkmcnt(0)
    v_readlane_b32 s79, v18, s62
    s_cmp_ge_u32 s79, s63
    s_cbranch_scc1 GO_39
    s_waitcnt vmcnt(24)
    s_sub_u32 s7, s60, 24
    s_max_i32 s61, s61, s7
    v_mov_b32 v19, s61
    ds_write_b32 v16, v19
    ds_read_b32 v18, v17
    s_waitcnt lgkmcnt(0)
    v_readlane_b32 s79, v18, s62
    s_cmp_ge_u32 s79, s63
    s_cbranch_scc1 GO_39
    s_waitcnt vmcnt(16)
    s_sub_u32 s7, s60, 16
    s_max_i32 s61, s61, s7
    v_mov_b32 v19, s61
    ds_write_b32 v16, v19
    ds_read_b32 v18, v17
    s_waitcnt lgkmcnt(0)
    v_readlane_b32 s79, v18, s62
    s_cmp_ge_u32 s79, s63
    s_cbranch_scc1 GO_39
    s_waitcnt vmcnt(8)
    s_sub_u32 s7, s60, 8
    s_max_i32 s61, s61, s7
    v_mov_b32 v19, s61
    ds_write_b32 v16, v19
    ds_read_b32 v18, v17
    s_waitcnt lgkmcnt(0)
    v_readlane_b32 s79, v18, s62
    s_cmp_ge_u32 s79, s63
    s_cbranch_scc1 GO_39
    s_waitcnt vmcnt(0)
    s_mov_b32 s61, s60
    v_mov_b32 v19, s61
    ds_write_b32 v16, v19
    ds_read_b32 v18, v17
    s_waitcnt lgkmcnt(0)
    v_readlane_b32 s79, v18, s62
    s_cmp_ge_u32 s79, s63
    s_cbranch_scc1 GO_39
    s_mov_b32 s80, 1600000
SP_214:
    ds_read_b32 v18, v17
    s_waitcnt lgkmcnt(0)
    v_readlane_b32 s79, v18, s62
    s_cmp_ge_u32 s79, s63
    s_cbranch_scc1 GO_39
    s_sub_u32 s80, s80, 1
    s_cmp_lg_u32 s80, 0
    s_cbranch_scc1 SP_214
    s_branch GO_39
ST_49:
    ds_read_b32 v18, v17
    s_waitcnt lgkmcnt(0)
    v_readlane_b32 s79, v18, s62
    s_cmp_ge_u32 s79, s63
    s_cbranch_scc1 GO_48
    s_waitcnt vmcnt(24)
    s_sub_u32 s7, s60, 24
    s_max_i32 s61, s61, s7
    v_mov_b32 v19, s61
    ds_write_b32 v16, v19
    ds_read_b32 v18, v17
    s_waitcnt lgkmcnt(0)
    v_readlane_b32 s79, v18, s62
    s_cmp_ge_u32 s79, s63
    s_cbranch_scc1 GO_48
    s_waitcnt vmcnt(16)
    s_sub_u32 s7, s60, 16
    s_max_i32 s61, s61, s7
    v_mov_b32 v19, s61
    ds_write_b32 v16, v19
    ds_read_b32 v18, v17
    s_waitcnt lgkmcnt(0)
    v_readlane_b32 s79, v18, s62
    s_cmp_ge_u32 s79, s63
    s_cbranch_scc1 GO_48
    s_waitcnt vmcnt(8)
    s_sub_u32 s7, s60, 8
    s_max_i32 s61, s61, s7
    v_mov_b32 v19, s61
    ds_write_b32 v16, v19
    ds_read_b32 v18, v17
    s_waitcnt lgkmcnt(0)
    v_readlane_b32 s79, v18, s62
    s_cmp_ge_u32 s79, s63
    s_cbranch_scc1 GO_48
    s_waitcnt vmcnt(0)
    s_mov_b32 s61, s60
    v_mov_b32 v19, s61
    ds_write_b32 v16, v19
    ds_read_b32 v18, v17
    s_waitcnt lgkmcnt(0)
    v_readlane_b32 s79, v18, s62
    s_cmp_ge_u32 s79, s63
    s_cbranch_scc1 GO_48
    s_mov_b32 s80, 1600000
SP_215:
    ds_read_b32 v18, v17
    s_waitcnt lgkmcnt(0)
    v_readlane_b32 s79, v18, s62
    s_cmp_ge_u32 s79, s63
    s_cbranch_scc1 GO_48
    s_sub_u32 s80, s80, 1
    s_cmp_lg_u32 s80, 0
    s_cbranch_scc1 SP_215
    s_branch GO_48
ST_55:
    ds_read_b32 v18, v17
    s_waitcnt lgkmcnt(0)
    v_readlane_b32 s79, v18, s62
    s_cmp_ge_u32 s79, s63
    s_cbranch_scc1 GO_54
    s_waitcnt vmcnt(40)
    s_sub_u32 s7, s60, 40
    s_max_i32 s61, s61, s7
    v_mov_b32 v19, s61
    ds_write_b32 v16, v19
    ds_read_b32 v18, v17
    s_waitcnt lgkmcnt(0)
    v_readlane_b32 s79, v18, s62
    s_cmp_ge_u32 s79, s63
    s_cbranch_scc1 GO_54
    s_waitcnt vmcnt(32)
    s_sub_u32 s7, s60, 32
    s_max_i32 s61, s61, s7
    v_mov_b32 v19, s61
    ds_write_b32 v16, v19
    ds_read_b32 v18, v17
    s_waitcnt lgkmcnt(0)
    v_readlane_b32 s79, v18, s62
    s_cmp_ge_u32 s79, s63
    s_cbranch_scc1 GO_54
    s_waitcnt vmcnt(24)
    s_sub_u32 s7, s60, 24
    s_max_i32 s61, s61, s7
    v_mov_b32 v19, s61
    ds_write_b32 v16, v19
    ds_read_b32 v18, v17
    s_waitcnt lgkmcnt(0)
    v_readlane_b32 s79, v18, s62
    s_cmp_ge_u32 s79, s63
    s_cbranch_scc1 GO_54
    s_waitcnt vmcnt(16)
    s_sub_u32 s7, s60, 16
    s_max_i32 s61, s61, s7
    v_mov_b32 v19, s61
    ds_write_b32 v16, v19
    ds_read_b32 v18, v17
    s_waitcnt lgkmcnt(0)
    v_readlane_b32 s79, v18, s62
    s_cmp_ge_u32 s79, s63
    s_cbranch_scc1 GO_54
    s_waitcnt vmcnt(8)
    s_sub_u32 s7, s60, 8
    s_max_i32 s61, s61, s7
    v_mov_b32 v19, s61
    ds_write_b32 v16, v19
    ds_read_b32 v18, v17
    s_waitcnt lgkmcnt(0)
    v_readlane_b32 s79, v18, s62
    s_cmp_ge_u32 s79, s63
    s_cbranch_scc1 GO_54
    s_waitcnt vmcnt(0)
    s_mov_b32 s61, s60
    v_mov_b32 v19, s61
    ds_write_b32 v16, v19
    ds_read_b32 v18, v17
    s_waitcnt lgkmcnt(0)
    v_readlane_b32 s79, v18, s62
    s_cmp_ge_u32 s79, s63
    s_cbranch_scc1 GO_54
    s_mov_b32 s80, 1600000
SP_216:
    ds_read_b32 v18, v17
    s_waitcnt lgkmcnt(0)
    v_readlane_b32 s79, v18, s62
    s_cmp_ge_u32 s79, s63
    s_cbranch_scc1 GO_54
    s_sub_u32 s80, s80, 1
    s_cmp_lg_u32 s80, 0
    s_cbranch_scc1 SP_216
    s_branch GO_54
ST_64:
    ds_read_b32 v18, v17
    s_waitcnt lgkmcnt(0)
    v_readlane_b32 s79, v18, s62
    s_cmp_ge_u32 s79, s63
    s_cbranch_scc1 GO_63
    s_waitcnt vmcnt(16)
    s_sub_u32 s7, s60, 16
    s_max_i32 s61, s61, s7
    v_mov_b32 v19, s61
    ds_write_b32 v16, v19
    ds_read_b32 v18, v17
    s_waitcnt lgkmcnt(0)
    v_readlane_b32 s79, v18, s62
    s_cmp_ge_u32 s79, s63
    s_cbranch_scc1 GO_63
    s_waitcnt vmcnt(8)
    s_sub_u32 s7, s60, 8
    s_max_i32 s61, s61, s7
    v_mov_b32 v19, s61
    ds_write_b32 v16, v19
    ds_read_b32 v18, v17
    s_waitcnt lgkmcnt(0)
    v_readlane_b32 s79, v18, s62
    s_cmp_ge_u32 s79, s63
    s_cbranch_scc1 GO_63
    s_waitcnt vmcnt(0)
    s_mov_b32 s61, s60
    v_mov_b32 v19, s61
    ds_write_b32 v16, v19
    ds_read_b32 v18, v17
    s_waitcnt lgkmcnt(0)
    v_readlane_b32 s79, v18, s62
    s_cmp_ge_u32 s79, s63
    s_cbranch_scc1 GO_63
    s_mov_b32 s80, 1600000
SP_217:
    ds_read_b32 v18, v17
    s_waitcnt lgkmcnt(0)
    v_readlane_b32 s79, v18, s62
    s_cmp_ge_u32 s79, s63
    s_cbranch_scc1 GO_63
    s_sub_u32 s80, s80, 1
    s_cmp_lg_u32 s80, 0
    s_cbranch_scc1 SP_217
    s_branch GO_63
ST_67:
    ds_read_b32 v18, v17
    s_waitcnt lgkmcnt(0)
    v_readlane_b32 s79, v18, s62
    s_cmp_ge_u32 s79, s63
    s_cbranch_scc1 GO_66
    s_waitcnt vmcnt(24)
    s_sub_u32 s7, s60, 24
    s_max_i32 s61, s61, s7
    v_mov_b32 v19, s61
    ds_write_b32 v16, v19
    ds_read_b32 v18, v17
    s_waitcnt lgkmcnt(0)
    v_readlane_b32 s79, v18, s62
    s_cmp_ge_u32 s79, s63
    s_cbranch_scc1 GO_66
    s_waitcnt vmcnt(16)
    s_sub_u32 s7, s60, 16
    s_max_i32 s61, s61, s7
    v_mov_b32 v19, s61
    ds_write_b32 v16, v19
    ds_read_b32 v18, v17
    s_waitcnt lgkmcnt(0)
    v_readlane_b32 s79, v18, s62
    s_cmp_ge_u32 s79, s63
    s_cbranch_scc1 GO_66
    s_waitcnt vmcnt(8)
    s_sub_u32 s7, s60, 8
    s_max_i32 s61, s61, s7
    v_mov_b32 v19, s61
    ds_write_b32 v16, v19
    ds_read_b32 v18, v17
    s_waitcnt lgkmcnt(0)
    v_readlane_b32 s79, v18, s62
    s_cmp_ge_u32 s79, s63
    s_cbranch_scc1 GO_66
    s_waitcnt vmcnt(0)
    s_mov_b32 s61, s60
    v_mov_b32 v19, s61
    ds_write_b32 v16, v19
    ds_read_b32 v18, v17
    s_waitcnt lgkmcnt(0)
    v_readlane_b32 s79, v18, s62
    s_cmp_ge_u32 s79, s63
    s_cbranch_scc1 GO_66
    s_mov_b32 s80, 1600000
SP_218:
    ds_read_b32 v18, v17
    s_waitcnt lgkmcnt(0)
    v_readlane_b32 s79, v18, s62
    s_cmp_ge_u32 s79, s63
    s_cbranch_scc1 GO_66
    s_sub_u32 s80, s80, 1
    s_cmp_lg_u32 s80, 0
    s_cbranch_scc1 SP_218
    s_branch GO_66
ST_69:
    ds_read_b32 v18, v17
    s_waitcnt lgkmcnt(0)
    v_readlane_b32 s79, v18, 0
    s_cmp_ge_u32 s79, s63
    s_cbranch_scc1 GO_68
    s_waitcnt vmcnt(24)
    s_sub_u32 s7, s60, 24
    s_max_i32 s61, s61, s7
    v_mov_b32 v19, s61
    ds_write_b32 v16, v19
    ds_read_b32 v18, v17
    s_waitcnt lgkmcnt(0)
    v_readlane_b32 s79, v18, 0
    s_cmp_ge_u32 s79, s63
    s_cbranch_scc1 GO_68
    s_waitcnt vmcnt(16)
    s_sub_u32 s7, s60, 16
    s_max_i32 s61, s61, s7
    v_mov_b32 v19, s61
    ds_write_b32 v16, v19
    ds_read_b32 v18, v17
    s_waitcnt lgkmcnt(0)
    v_readlane_b32 s79, v18, 0
    s_cmp_ge_u32 s79, s63
    s_cbranch_scc1 GO_68
    s_waitcnt vmcnt(8)
    s_sub_u32 s7, s60, 8
    s_max_i32 s61, s61, s7
    v_mov_b32 v19, s61
    ds_write_b32 v16, v19
    ds_read_b32 v18, v17
    s_waitcnt lgkmcnt(0)
    v_readlane_b32 s79, v18, 0
    s_cmp_ge_u32 s79, s63
    s_cbranch_scc1 GO_68
    s_waitcnt vmcnt(0)
    s_mov_b32 s61, s60
    v_mov_b32 v19, s61
    ds_write_b32 v16, v19
    ds_read_b32 v18, v17
    s_waitcnt lgkmcnt(0)
    v_readlane_b32 s79, v18, 0
    s_cmp_ge_u32 s79, s63
    s_cbranch_scc1 GO_68
    s_mov_b32 s80, 1600000
SP_219:
    ds_read_b32 v18, v17
    s_waitcnt lgkmcnt(0)
    v_readlane_b32 s79, v18, 0
    s_cmp_ge_u32 s79, s63
    s_cbranch_scc1 GO_68
    s_sub_u32 s80, s80, 1
    s_cmp_lg_u32 s80, 0
    s_cbranch_scc1 SP_219
    s_branch GO_68
M_73:
    s_sub_u32 s80, s80, 1
    s_cmp_le_u32 s80, 0
    s_cbranch_scc1 MD_75
    s_mov_b64 exec, s[62:63]
    s_cbranch_execz RS_220
    buffer_load_dwordx4 v[48:51], v36, s[36:39], 0 offen offset:0 sc1
RS_220:
    s_mov_b64 exec, s[64:65]
    s_cbranch_execz RS_221
    buffer_load_dwordx4 v[52:55], v36, s[36:39], 0 offen offset:1024 sc1
RS_221:
    s_mov_b64 exec, s[66:67]
    s_cbranch_execz RS_222
    buffer_load_dwordx4 v[56:59], v36, s[36:39], 0 offen offset:2048 sc1
RS_222:
    s_mov_b64 exec, s[68:69]
    s_cbranch_execz RS_223
    buffer_load_dwordx4 v[60:63], v36, s[36:39], 0 offen offset:3072 sc1
RS_223:
    s_branch MC_74
M_76:
    s_sub_u32 s80, s80, 1
    s_cmp_le_u32 s80, 0
    s_cbranch_scc1 MD_78
    s_mov_b64 exec, s[62:63]
    s_cbranch_execz RS_224
    buffer_load_dwordx4 v[48:51], v36, s[36:39], 0 offen offset:0 sc1
RS_224:
    s_mov_b64 exec, s[64:65]
    s_cbranch_execz RS_225
    buffer_load_dwordx4 v[52:55], v36, s[36:39], 0 offen offset:1024 sc1
RS_225:
    s_branch MC_77
M_98:
    s_sleep 4
    s_sub_u32 s80, s80, 1
    s_cmp_le_u32 s80, 0
    s_cbranch_scc1 MD_100
    s_mov_b64 exec, s[44:45]
    s_cbranch_execz RS_226
    buffer_load_dwordx4 v[48:51], v7, s[36:39], 0 offen sc1 nt
RS_226:
    s_mov_b64 exec, s[46:47]
    s_cbranch_execz RS_227
    buffer_load_dwordx4 v[52:55], v22, s[36:39], 0 offen sc1 nt
RS_227:
    s_branch MC_99
SU_106:
    s_nop 3
    buffer_store_dwordx4 v[64:67], v8, s[36:39], 0 offen sc1
    s_branch SV_107
AW_110:
    s_mov_b64 exec, 0x3f
    s_cmp_eq_u32 s71, 1
    s_cbranch_scc1 AX_228
    buffer_load_dwordx4 v[116:119], v12, s[36:39], 0 offen sc1 nt
    s_mov_b64 exec, -1
    s_branch AWB_111
AX_228:
    s_mov_b32 s80, 200000
    s_branch PP_230
P_229:
    buffer_load_dwordx4 v[116:119], v12, s[36:39], 0 offen sc1 nt
PP_230:
    s_waitcnt vmcnt(0)
    v_cmp_ne_u64 s[90:91], s[92:93], v[118:119]
    s_cmp_lg_u64 s[90:91], 0
    s_cbranch_scc0 PD_231
    s_sleep 2
    s_sub_u32 s80, s80, 1
    s_cmp_lg_u32 s80, 0
    s_cbranch_scc1 P_229
PD_231:
    s_mov_b64 exec, -1
    v_mov_b32 v118, v116
    s_nop 1
    v_max_f32_dpp v118, v118, v118 row_ror:1 row_mask:0xf bank_mask:0xf
    s_nop 1
    v_max_f32_dpp v118, v118, v118 row_ror:2 row_mask:0xf bank_mask:0xf
    s_nop 1
    v_max_f32_dpp v118, v118, v118 row_ror:4 row_mask:0xf bank_mask:0xf
    s_nop 1
    v_max_f32_dpp v118, v118, v118 row_ror:8 row_mask:0xf bank_mask:0xf
    v_sub_f32 v116, v116, v118
    v_sub_f32 v119, v64, v118
    v_exp_f32 v116, v116
    v_exp_f32 v119, v119
    v_mul_f32 v116, v116, v117
    s_nop 1
    v_add_f32_dpp v116, v116, v116 row_ror:1 row_mask:0xf bank_mask:0xf
    s_nop 1
    v_add_f32_dpp v116, v116, v116 row_ror:2 row_mask:0xf bank_mask:0xf
    s_nop 1
    v_add_f32_dpp v116, v116, v116 row_ror:4 row_mask:0xf bank_mask:0xf
    s_nop 1
    v_add_f32_dpp v116, v116, v116 row_ror:8 row_mask:0xf bank_mask:0xf
    v_rcp_f32 v116, v116
    s_nop 0
    v_mul_f32 v116, v116, v119
    s_nop 0
    v_readfirstlane_b32 s72, v116
    s_branch AWB_111
SU_114:
    s_nop 3
    buffer_store_dwordx4 v[68:71], v6, s[36:39], 0 offen sc1
    s_branch SV_115
M_118:
    s_sub_u32 s80, s80, 1
    s_cmp_le_u32 s80, 0
    s_cbranch_scc1 MD_120
    s_mov_b64 exec, s[64:65]
    s_cbranch_execz RS_232
    buffer_load_dwordx4 v[112:115], v5, s[36:39], 0 offen sc1 nt
RS_232:
    s_mov_b64 exec, s[66:67]
    s_cbranch_execz RS_233
    buffer_load_dwordx4 v[116:119], v5, s[36:39], s62 offen sc1 nt
RS_233:
    s_mov_b64 exec, s[68:69]
    s_cbranch_execz RS_234
    buffer_load_dwordx4 v[120:123], v5, s[36:39], s63 offen sc1 nt
RS_234:
    s_branch MC_119
M_128:
    s_sub_u32 s80, s80, 1
    s_cmp_le_u32 s80, 199994
    s_cbranch_scc1 G2_125
    s_mov_b64 exec, s[44:45]
    s_cbranch_execz RS_235
    buffer_load_dwordx4 v[48:51], v7, s[36:39], 0 offen sc1 nt
RS_235:
    s_mov_b64 exec, s[46:47]
    s_cbranch_execz RS_236
    buffer_load_dwordx4 v[52:55], v22, s[36:39], 0 offen sc1 nt
RS_236:
    s_branch MC_129
G2_125:
    s_mov_b64 exec, -1
    v_mov_b32 v12, 0x24204
    s_mov_b32 s80, 1600000
LW_237:
    ds_read_b32 v13, v12
    s_waitcnt lgkmcnt(0)
    v_readfirstlane_b32 s79, v13
    s_cmp_ge_u32 s79, 1
    s_cbranch_scc1 LWD_238
    s_sleep 1
    s_sub_u32 s80, s80, 1
    s_cmp_lg_u32 s80, 0
    s_cbranch_scc1 LW_237
LWD_238:
    v_mov_b32 v12, 0x24248
    ds_read_b64 v[14:15], v12
    s_waitcnt lgkmcnt(0)
    v_readfirstlane_b32 s92, v14
    v_readfirstlane_b32 s93, v15
    s_mov_b32 s80, 200000
P_239:
    buffer_load_dwordx4 v[48:51], v7, s[36:39], 0 offen sc1 nt
    buffer_load_dwordx4 v[52:55], v22, s[36:39], 0 offen sc1 nt
PP_240:
    s_waitcnt vmcnt(0)
    s_mov_b64 s[90:91], 0
    v_cmp_gt_u64 s[88:89], s[94:95], v[50:51]
    v_cmp_le_u64 vcc, s[72:73], v[50:51]
    s_or_b64 s[88:89], s[88:89], vcc
    v_cmp_ne_u64 vcc, s[92:93], v[50:51]
    s_and_b64 vcc, vcc, s[88:89]
    s_or_b64 s[90:91], s[90:91], vcc
    v_cmp_gt_u64 s[88:89], s[94:95], v[54:55]
    v_cmp_le_u64 vcc, s[72:73], v[54:55]
    s_or_b64 s[88:89], s[88:89], vcc
    v_cmp_ne_u64 vcc, s[92:93], v[54:55]
    s_and_b64 vcc, vcc, s[88:89]
    s_or_b64 s[90:91], s[90:91], vcc
    s_cbranch_scc0 PD_241
    s_sleep 1
    s_sub_u32 s80, s80, 1
    s_cmp_lg_u32 s80, 0
    s_cbranch_scc1 P_239
PD_241:
    s_branch MD_130
M_145:
    s_sleep 6
    s_sub_u32 s80, s80, 1
    s_cmp_le_u32 s80, 0
    s_cbranch_scc1 MD_147
    s_mov_b64 exec, s[64:65]
    s_cbranch_execz RS_242
    buffer_load_dwordx2 v[12:13], v9, s[36:39], 0 offen sc1 nt
RS_242:
    s_branch MC_146
M_148:
    s_sleep 2
    s_sub_u32 s80, s80, 1
    s_cmp_le_u32 s80, 0
    s_cbranch_scc1 MD_150
    s_mov_b64 exec, s[64:65]
    s_cbranch_execz RS_243
    buffer_load_dwordx2 v[12:13], v9, s[36:39], 0 offen sc1
RS_243:
    s_branch MC_149
M_151:
    s_sub_u32 s80, s80, 1
    s_cmp_le_u32 s80, 0
    s_cbranch_scc1 MD_153
    s_mov_b64 exec, s[64:65]
    s_cbranch_execz RS_244
    buffer_load_dwordx4 v[16:19], v5, s[36:39], 0 offen offset:0 sc1
RS_244:
    s_mov_b64 exec, s[66:67]
    s_cbranch_execz RS_245
    buffer_load_dwordx4 v[20:23], v5, s[36:39], 0 offen offset:1024 sc1
RS_245:
    s_mov_b64 exec, s[68:69]
    s_cbranch_execz RS_246
    buffer_load_dwordx4 v[12:15], v4, s[36:39], 0 offen sc1
RS_246:
    s_branch MC_152
SU_156:
    s_nop 3
    buffer_store_dwordx4 v[16:19], v10, s[36:39], 0 offen sc1
    s_branch SV_157
M_162:
    s_sleep 2
    s_sub_u32 s80, s80, 1
    s_cmp_le_u32 s80, 0
    s_cbranch_scc1 MD_164
    s_mov_b64 exec, s[44:45]
    s_cbranch_execz RS_247
    buffer_load_dwordx2 v[16:17], v144, s[36:39], 0 offen sc1
RS_247:
    s_branch MC_163
M_172:
    s_sleep 1
    s_sub_u32 s80, s80, 1
    s_cmp_le_u32 s80, 0
    s_cbranch_scc1 MD_174
    s_mov_b64 exec, s[44:45]
    s_cbranch_execz RS_248
    buffer_load_dwordx4 v[128:131], v145, s[36:39], 0 offen offset:0 sc1
RS_248:
    s_mov_b64 exec, s[46:47]
    s_cbranch_execz RS_249
    buffer_load_dwordx4 v[132:135], v145, s[36:39], 0 offen offset:1024 sc1
RS_249:
    s_mov_b64 exec, s[48:49]
    s_cbranch_execz RS_250
    buffer_load_dwordx4 v[136:139], v145, s[36:39], 0 offen offset:2048 sc1
RS_250:
    s_mov_b64 exec, s[50:51]
    s_cbranch_execz RS_251
    buffer_load_dwordx4 v[140:143], v145, s[36:39], 0 offen offset:3072 sc1
RS_251:
    s_branch MC_173
SU_188:
    s_nop 3
    buffer_store_dwordx4 v[36:39], v44, s[36:39], 0 offen sc1
    s_branch SV_189
SU_190:
    s_nop 3
    buffer_store_dwordx4 v[16:19], v5, s[36:39], 0 offen offset:0 sc1
    buffer_store_dwordx4 v[20:23], v5, s[36:39], 0 offen offset:1024 sc1
    buffer_store_dwordx4 v[24:27], v5, s[36:39], 0 offen offset:2048 sc1
    buffer_store_dwordx4 v[28:31], v5, s[36:39], 0 offen offset:3072 sc1
    s_waitcnt vmcnt(0)
    s_mov_b64 exec, s[88:89]
    buffer_store_dwordx2 v[38:39], v7, s[36:39], 0 offen sc1
    s_mov_b64 exec, -1
    s_branch SV_191
M_192:
    s_sub_u32 s80, s80, 1
    s_cmp_le_u32 s80, 0
    s_cbranch_scc1 MD_194
    s_mov_b64 exec, s[86:87]
    s_cbranch_execz RS_252
    buffer_load_dwordx2 v[40:41], v7, s[36:39], 0 offen sc1 nt
RS_252:
    s_branch MC_193
BL_195:
    s_mov_b32 s80, 200000
P_253:
    buffer_load_dwordx4 v[64:67], v6, s[36:39], 0 offen offset:0 sc1 nt
    buffer_load_dwordx4 v[68:71], v6, s[36:39], 0 offen offset:1024 sc1 nt
    buffer_load_dwordx4 v[72:75], v6, s[36:39], 0 offen offset:2048 sc1 nt
    buffer_load_dwordx4 v[76:79], v6, s[36:39], 0 offen offset:3072 sc1 nt
PP_254:
    s_waitcnt vmcnt(0)
    v_cmp_ne_u64 s[90:91], s[92:93], v[66:67]
    v_cmp_ne_u64 vcc, s[92:93], v[70:71]
    s_or_b64 s[90:91], s[90:91], vcc
    v_cmp_ne_u64 vcc, s[92:93], v[74:75]
    s_or_b64 s[90:91], s[90:91], vcc
    v_cmp_ne_u64 vcc, s[92:93], v[78:79]
    s_or_b64 s[90:91], s[90:91], vcc
    s_cmp_lg_u64 s[90:91], 0
    s_cbranch_scc0 PD_255
    s_sub_u32 s80, s80, 1
    s_cmp_lg_u32 s80, 0
    s_cbranch_scc1 P_253
PD_255:
    s_branch BLD_196
M_205:
    s_sleep 1
    s_sub_u32 s80, s80, 1
    s_cmp_le_u32 s80, 0
    s_cbranch_scc1 MD_207
    s_mov_b64 exec, s[86:87]
    s_cbranch_execz RS_256
    buffer_load_dwordx4 v[16:19], v4, s[36:39], 0 offen sc1 nt
RS_256:
    s_branch MC_206
L_END:
    s_endpgm
.section .rodata,"a"
.p2align 6
.amdhsa_kernel concat_heads__sliding_block_cached__compressed_kv_cla__decode_kernel
  .amdhsa_next_free_vgpr 168
  .amdhsa_next_free_sgpr 102
  .amdhsa_accum_offset 168
  .amdhsa_group_segment_fixed_size 0
  .amdhsa_kernarg_size 112
  .amdhsa_user_sgpr_count 2
  .amdhsa_user_sgpr_kernarg_segment_ptr 1
  .amdhsa_system_sgpr_workgroup_id_x 1
  .amdhsa_float_denorm_mode_32 3
.end_amdhsa_kernel
```

```asm
; @launch grid=(256,1,1) block=(576,1,1) lds=163840
.amdgcn_target "amdgcn-amd-amdhsa--gfx950"
.text
.globl concat_heads__sliding_block_cached__compressed_kv_cla__decode_kernel
.p2align 8
.type concat_heads__sliding_block_cached__compressed_kv_cla__decode_kernel,@function
concat_heads__sliding_block_cached__compressed_kv_cla__decode_kernel:
    s_cmp_ge_u32 s2, 256
    s_cbranch_scc1 L_END
    s_load_dwordx16 s[8:23], s[0:1], 0
    s_load_dwordx8 s[24:31], s[0:1], 64
    s_load_dwordx4 s[32:35], s[0:1], 96
    s_memrealtime s[94:95]
    v_lshrrev_b32 v1, 6, v0
    s_nop 0
    v_readfirstlane_b32 s3, v1
    v_and_b32 v1, 63, v0
    v_lshrrev_b32 v2, 4, v1
    v_and_b32 v3, 15, v1
    s_and_b32 s4, s2, 7
    s_lshr_b32 s7, s2, 6
    s_lshl_b32 s7, s7, 3
    s_or_b32 s4, s4, s7
    s_bfe_u32 s5, s2, 0x30003
    s_getreg_b32 s78, hwreg(HW_REG_XCC_ID, 0, 4)
    s_lshl_b32 s78, s78, 26
    s_xor_b32 s6, s3, 4
    s_cmp_eq_u32 s3, 8
    s_cselect_b32 s7, 8, 0
    s_add_u32 s7, s7, s5
    s_cmp_ge_u32 s7, 14
    s_cbranch_scc1 L_LDB
    s_cmp_ge_u32 s7, 12
    s_cbranch_scc1 L_LDE
    s_cmp_ge_u32 s7, 8
    s_cbranch_scc1 L_LDA
    s_mov_b32 s81, 0
    s_cmp_lt_u32 s6, 4
    s_cbranch_scc1 L_SIDE
    s_cmp_ge_u32 s7, 4
    s_cbranch_scc1 L_QABS
    s_and_b32 s61, s6, 3
    v_lshrrev_b32 v10, 1, v3
    v_xor_b32 v10, v10, v2
    v_lshlrev_b32 v10, 5, v10
    v_lshl_add_u32 v10, v2, 13, v10
    v_and_b32 v40, 1, v1
    v_lshl_add_u32 v10, v40, 4, v10
    v_xor_b32 v11, 0x80, v10
    s_lshl_b32 s65, s5, 20
    s_lshl_b32 s7, s4, 8
    s_add_u32 s65, s65, s7
    s_lshl_b32 s7, s61, 18
    s_add_u32 s65, s65, s7
    s_lshl_b32 s64, s61, 13
    s_add_u32 s64, s64, 0x18000
    v_and_b32 v8, 3, v1
    v_lshlrev_b32 v9, 10, v8
    v_lshl_add_u32 v9, v2, 4, v9
    s_lshl_b32 s62, s5, 8
    s_waitcnt lgkmcnt(0)
    s_mov_b32 s48, s22
    s_and_b32 s49, s23, 0xffff
    s_mov_b32 s50, 0x400000
    s_mov_b32 s51, 0x20000
    s_mov_b32 s63, s65
    s_mov_b32 m0, s64
    s_add_u32 s64, s64, 1024
    buffer_load_dwordx4 v10, s[48:51], s63 offen nt lds
    s_add_u32 s63, s63, 32768
    s_mov_b32 m0, s64
    s_add_u32 s64, s64, 1024
    buffer_load_dwordx4 v11, s[48:51], s63 offen nt lds
    s_add_u32 s63, s63, 32768
    s_mov_b32 m0, s64
    s_add_u32 s64, s64, 1024
    buffer_load_dwordx4 v10, s[48:51], s63 offen nt lds
    s_add_u32 s63, s63, 32768
    s_mov_b32 m0, s64
    s_add_u32 s64, s64, 1024
    buffer_load_dwordx4 v11, s[48:51], s63 offen nt lds
    s_add_u32 s63, s63, 32768
    s_mov_b32 m0, s64
    s_add_u32 s64, s64, 1024
    buffer_load_dwordx4 v10, s[48:51], s63 offen nt lds
    s_add_u32 s63, s63, 32768
    s_mov_b32 m0, s64
    s_add_u32 s64, s64, 1024
    buffer_load_dwordx4 v11, s[48:51], s63 offen nt lds
    s_add_u32 s63, s63, 32768
    s_mov_b32 m0, s64
    s_add_u32 s64, s64, 1024
    buffer_load_dwordx4 v10, s[48:51], s63 offen nt lds
    s_add_u32 s63, s63, 32768
    s_mov_b32 m0, s64
    s_add_u32 s64, s64, 1024
    buffer_load_dwordx4 v11, s[48:51], s63 offen nt lds
    s_add_u32 s63, s63, 32768
    s_mov_b32 s44, s18
    s_and_b32 s45, s19, 0xffff
    s_mov_b32 s46, 0x1000
    s_mov_b32 s47, 0x20000
    buffer_load_dwordx4 v[128:131], v9, s[44:47], s62 offen offset:0
    buffer_load_dwordx4 v[132:135], v9, s[44:47], s62 offen offset:64
    buffer_load_dwordx4 v[136:139], v9, s[44:47], s62 offen offset:128
    buffer_load_dwordx4 v[140:143], v9, s[44:47], s62 offen offset:192
    s_barrier
    s_mov_b32 s36, s34
    s_and_b32 s37, s35, 0xffff
    s_mov_b32 s38, 0x1000000
    s_mov_b32 s39, 0x20000
    s_lshl_b32 s7, s4, 4
    s_add_u32 s7, s7, s5
    s_lshl_b32 s7, s7, 4
    s_add_u32 s7, s7, s61
    s_lshl_b32 s7, s7, 7
    s_add_u32 s7, s7, 0x100000
    v_lshl_add_u32 v4, v8, 9, s7
    v_lshl_add_u32 v4, v2, 4, v4
    v_and_b32 v12, 4, v1
    v_lshl_add_u32 v4, v12, 4, v4
    v_add_u32 v5, 16384, v4
    v_mov_b32 v16, 0
    s_mov_b64 exec, 15
    buffer_store_dword v16, v5, s[36:39], 0 offen
    buffer_load_dword v16, v5, s[36:39], 0 offen sc1 nt
    s_mov_b64 exec, -1
    s_sub_u32 s64, s64, 40960
    v_cmp_gt_u32 s[84:85], 8, v3
    v_bfe_u32 v21, v1, 2, 2
    v_lshl_add_u32 v20, v2, 3, v21
    s_lshl_b32 s7, s61, 1
    v_xor_b32 v21, s7, v21
    v_lshlrev_b32 v20, 8, v20
    v_lshl_add_u32 v20, v21, 5, v20
    v_lshl_add_u32 v20, v8, 3, v20
    v_add_u32 v20, 0x10000, v20
    v_xor_b32 v21, 32, v20
    v_xor_b32 v22, 0x480, v20
    v_xor_b32 v23, 0x4a0, v20
    s_waitcnt vmcnt(2)
    v_mov_b32 v14, 0x24210
    v_mov_b32 v15, 1
    s_mov_b64 exec, 1
    ds_add_u32 v14, v15
    s_mov_b64 exec, -1
    v_mov_b32 v14, 0x24210
    s_mov_b32 s80, 1600000
LW_1:
    ds_read_b32 v15, v14
    s_waitcnt lgkmcnt(0)
    v_readfirstlane_b32 s79, v15
    s_cmp_ge_u32 s79, 4
    s_cbranch_scc1 LWD_2
    s_sub_u32 s80, s80, 1
    s_cmp_lg_u32 s80, 0
    s_cbranch_scc1 LW_1
LWD_2:
    ds_read_b64_tr_b16 v[32:33], v20 offset:32768
    ds_read_b64_tr_b16 v[34:35], v22 offset:32768
    ds_read_b64_tr_b16 v[36:37], v21 offset:32768
    ds_read_b64_tr_b16 v[38:39], v23 offset:32768
    ds_read_b64_tr_b16 v[40:41], v20 offset:40960
    ds_read_b64_tr_b16 v[42:43], v22 offset:40960
    ds_read_b64_tr_b16 v[44:45], v21 offset:40960
    ds_read_b64_tr_b16 v[46:47], v23 offset:40960
    ds_read_b64_tr_b16 v[48:49], v20 offset:49152
    ds_read_b64_tr_b16 v[50:51], v22 offset:49152
    ds_read_b64_tr_b16 v[52:53], v21 offset:49152
    ds_read_b64_tr_b16 v[54:55], v23 offset:49152
    s_waitcnt lgkmcnt(8)
    ds_read_b64_tr_b16 v[56:57], v20 offset:57344
    ds_read_b64_tr_b16 v[58:59], v22 offset:57344
    ds_read_b64_tr_b16 v[60:61], v21 offset:57344
    ds_read_b64_tr_b16 v[62:63], v23 offset:57344
    s_waitcnt lgkmcnt(12)
    v_mfma_f32_16x16x32_bf16 v[24:27], v[32:35], v[128:131], 0
    v_mfma_f32_16x16x32_bf16 v[28:31], v[36:39], v[128:131], 0
    s_waitcnt lgkmcnt(8)
    v_mfma_f32_16x16x32_bf16 v[24:27], v[40:43], v[132:135], v[24:27]
    v_mfma_f32_16x16x32_bf16 v[28:31], v[44:47], v[132:135], v[28:31]
    s_waitcnt lgkmcnt(4)
    v_mfma_f32_16x16x32_bf16 v[24:27], v[48:51], v[136:139], v[24:27]
    v_mfma_f32_16x16x32_bf16 v[28:31], v[52:55], v[136:139], v[28:31]
    s_waitcnt lgkmcnt(0)
    v_mfma_f32_16x16x32_bf16 v[24:27], v[56:59], v[140:143], v[24:27]
    v_mfma_f32_16x16x32_bf16 v[28:31], v[60:63], v[140:143], v[28:31]
    s_memrealtime s[88:89]
    v_mov_b32 v14, 0x2410c
    v_mov_b32 v15, 1
    s_mov_b64 exec, 1
    ds_add_u32 v14, v15
    s_mov_b64 exec, -1
    s_nop 0
    v_cvt_pk_bf16_f32 v64, v24, v25
    v_cvt_pk_bf16_f32 v65, v26, v27
    v_cvt_pk_bf16_f32 v68, v28, v29
    v_cvt_pk_bf16_f32 v69, v30, v31
    s_nop 0
    v_mov_b32_dpp v64, v68 quad_perm:[0,1,2,3] row_mask:0xf bank_mask:0x2
    v_mov_b32_dpp v65, v69 quad_perm:[0,1,2,3] row_mask:0xf bank_mask:0x2
    s_waitcnt lgkmcnt(0)
    s_or_b32 s89, s89, s78
    v_mov_b32 v66, s88
    v_mov_b32 v67, s89
    s_mov_b64 exec, s[84:85]
    buffer_store_dwordx4 v[64:67], v5, s[36:39], 0 offen
    s_mov_b64 exec, -1
    v_mov_b32 v14, 0x24210
    v_mov_b32 v15, 1
    s_mov_b64 exec, 1
    ds_add_u32 v14, v15
    s_mov_b64 exec, -1
    s_mov_b32 s48, s14
    s_and_b32 s49, s15, 0xffff
    s_mov_b32 s50, 0x400000
    s_mov_b32 s51, 0x20000
    s_mov_b32 s63, s65
    s_mov_b32 m0, s64
    s_add_u32 s64, s64, 1024
    buffer_load_dwordx4 v10, s[48:51], s63 offen nt lds
    s_add_u32 s63, s63, 32768
    s_mov_b32 m0, s64
    s_add_u32 s64, s64, 1024
    buffer_load_dwordx4 v11, s[48:51], s63 offen nt lds
    s_add_u32 s63, s63, 32768
    s_mov_b32 m0, s64
    s_add_u32 s64, s64, 1024
    buffer_load_dwordx4 v10, s[48:51], s63 offen nt lds
    s_add_u32 s63, s63, 32768
    s_mov_b32 m0, s64
    s_add_u32 s64, s64, 1024
    buffer_load_dwordx4 v11, s[48:51], s63 offen nt lds
    s_add_u32 s63, s63, 32768
    s_mov_b32 m0, s64
    s_add_u32 s64, s64, 1024
    buffer_load_dwordx4 v10, s[48:51], s63 offen nt lds
    s_add_u32 s63, s63, 32768
    s_mov_b32 m0, s64
    s_add_u32 s64, s64, 1024
    buffer_load_dwordx4 v11, s[48:51], s63 offen nt lds
    s_add_u32 s63, s63, 32768
    s_mov_b32 m0, s64
    s_add_u32 s64, s64, 1024
    buffer_load_dwordx4 v10, s[48:51], s63 offen nt lds
    s_add_u32 s63, s63, 32768
    s_mov_b32 m0, s64
    s_add_u32 s64, s64, 1024
    buffer_load_dwordx4 v11, s[48:51], s63 offen nt lds
    s_add_u32 s63, s63, 32768
    s_mov_b32 s44, s8
    s_and_b32 s45, s9, 0xffff
    s_mov_b32 s46, 0x1000
    s_mov_b32 s47, 0x20000
    buffer_load_dwordx4 v[144:147], v9, s[44:47], s62 offen offset:0
    buffer_load_dwordx4 v[148:151], v9, s[44:47], s62 offen offset:64
    buffer_load_dwordx4 v[152:155], v9, s[44:47], s62 offen offset:128
    buffer_load_dwordx4 v[156:159], v9, s[44:47], s62 offen offset:192
    s_waitcnt vmcnt(0)
    v_mov_b32 v14, 0x24210
    v_mov_b32 v15, 1
    s_mov_b64 exec, 1
    ds_add_u32 v14, v15
    s_mov_b64 exec, -1
    v_mov_b32 v14, 0x24210
    s_mov_b32 s80, 1600000
LW_3:
    ds_read_b32 v15, v14
    s_waitcnt lgkmcnt(0)
    v_readfirstlane_b32 s79, v15
    s_cmp_ge_u32 s79, 12
    s_cbranch_scc1 LWD_4
    s_sub_u32 s80, s80, 1
    s_cmp_lg_u32 s80, 0
    s_cbranch_scc1 LW_3
LWD_4:
    ds_read_b64_tr_b16 v[32:33], v20 offset:0
    ds_read_b64_tr_b16 v[34:35], v22 offset:0
    ds_read_b64_tr_b16 v[36:37], v21 offset:0
    ds_read_b64_tr_b16 v[38:39], v23 offset:0
    ds_read_b64_tr_b16 v[40:41], v20 offset:8192
    ds_read_b64_tr_b16 v[42:43], v22 offset:8192
    ds_read_b64_tr_b16 v[44:45], v21 offset:8192
    ds_read_b64_tr_b16 v[46:47], v23 offset:8192
    ds_read_b64_tr_b16 v[48:49], v20 offset:16384
    ds_read_b64_tr_b16 v[50:51], v22 offset:16384
    ds_read_b64_tr_b16 v[52:53], v21 offset:16384
    ds_read_b64_tr_b16 v[54:55], v23 offset:16384
    s_waitcnt lgkmcnt(8)
    ds_read_b64_tr_b16 v[56:57], v20 offset:24576
    ds_read_b64_tr_b16 v[58:59], v22 offset:24576
    ds_read_b64_tr_b16 v[60:61], v21 offset:24576
    ds_read_b64_tr_b16 v[62:63], v23 offset:24576
    s_waitcnt lgkmcnt(12)
    v_mfma_f32_16x16x32_bf16 v[24:27], v[32:35], v[144:147], 0
    v_mfma_f32_16x16x32_bf16 v[28:31], v[36:39], v[144:147], 0
    s_waitcnt lgkmcnt(8)
    v_mfma_f32_16x16x32_bf16 v[24:27], v[40:43], v[148:151], v[24:27]
    v_mfma_f32_16x16x32_bf16 v[28:31], v[44:47], v[148:151], v[28:31]
    s_waitcnt lgkmcnt(4)
    v_mfma_f32_16x16x32_bf16 v[24:27], v[48:51], v[152:155], v[24:27]
    v_mfma_f32_16x16x32_bf16 v[28:31], v[52:55], v[152:155], v[28:31]
    s_waitcnt lgkmcnt(0)
    v_mfma_f32_16x16x32_bf16 v[24:27], v[56:59], v[156:159], v[24:27]
    v_mfma_f32_16x16x32_bf16 v[28:31], v[60:63], v[156:159], v[28:31]
    v_mov_b32 v14, 0x24108
    v_mov_b32 v15, 1
    s_mov_b64 exec, 1
    ds_add_u32 v14, v15
    s_mov_b64 exec, -1
    s_nop 1
    v_cvt_pk_bf16_f32 v72, v24, v25
    v_cvt_pk_bf16_f32 v73, v26, v27
    v_cvt_pk_bf16_f32 v76, v28, v29
    v_cvt_pk_bf16_f32 v77, v30, v31
    s_nop 0
    v_mov_b32_dpp v72, v76 quad_perm:[0,1,2,3] row_mask:0xf bank_mask:0x2
    v_mov_b32_dpp v73, v77 quad_perm:[0,1,2,3] row_mask:0xf bank_mask:0x2
    v_mov_b32 v10, 0x24200
    s_mov_b32 s80, 1600000
LW_5:
    ds_read_b32 v11, v10
    s_waitcnt lgkmcnt(0)
    v_readfirstlane_b32 s79, v11
    s_cmp_ge_u32 s79, 16
    s_cbranch_scc1 LWD_6
    s_sleep 1
    s_sub_u32 s80, s80, 1
    s_cmp_lg_u32 s80, 0
    s_cbranch_scc1 LW_5
LWD_6:
    s_and_b32 s101, s79, 15
    v_mov_b32 v12, 0x24204
    s_mov_b32 s80, 1600000
LW_7:
    ds_read_b32 v13, v12
    s_waitcnt lgkmcnt(0)
    v_readfirstlane_b32 s79, v13
    s_cmp_ge_u32 s79, 1
    s_cbranch_scc1 LWD_8
    s_sleep 1
    s_sub_u32 s80, s80, 1
    s_cmp_lg_u32 s80, 0
    s_cbranch_scc1 LW_7
LWD_8:
    v_mov_b32 v12, 0x24248
    ds_read_b64 v[14:15], v12
    s_waitcnt lgkmcnt(0)
    v_readfirstlane_b32 s92, v14
    v_readfirstlane_b32 s93, v15
    s_nop 0
    v_mov_b32 v66, s92
    v_mov_b32 v67, s93
    v_mov_b32 v74, s92
    v_mov_b32 v75, s93
    s_mov_b64 exec, s[84:85]
    s_cmp_eq_u32 s101, 0
    s_cbranch_scc1 SU_9
    buffer_store_dwordx4 v[72:75], v4, s[36:39], 0 offen
SV_10:
    s_mov_b64 exec, -1
    v_mov_b32 v14, 0x24210
    v_mov_b32 v15, 1
    s_mov_b64 exec, 1
    ds_add_u32 v14, v15
    s_mov_b64 exec, -1
    v_mov_b32 v14, 0x24000
    s_mov_b32 s80, 1600000
LW_11:
    ds_read_b32 v15, v14
    s_waitcnt lgkmcnt(0)
    v_readfirstlane_b32 s79, v15
    s_cmp_ge_u32 s79, 96
    s_cbranch_scc1 LWD_12
    s_sleep 16
    s_sub_u32 s80, s80, 1
    s_cmp_lg_u32 s80, 0
    s_cbranch_scc1 LW_11
LWD_12:
    s_mov_b64 exec, s[84:85]
    s_cmp_eq_u32 s101, 0
    s_cbranch_scc1 SU_13
    buffer_store_dwordx4 v[64:67], v5, s[36:39], 0 offen
SV_14:
    s_mov_b64 exec, -1
    s_branch L_ASVC
L_LDA:
    s_setprio 3
    v_lshrrev_b32 v20, 1, v3
    v_and_b32 v40, 1, v2
    v_xor_b32 v20, v20, v40
    v_lshlrev_b32 v20, 5, v20
    v_lshl_add_u32 v20, v2, 10, v20
    v_and_b32 v40, 1, v1
    v_lshl_add_u32 v20, v40, 4, v20
    v_xor_b32 v21, 0x40, v20
    v_xor_b32 v22, 0x80, v20
    v_xor_b32 v23, 0xc0, v20
    s_lshl_b32 s65, s4, 17
    s_lshl_b32 s7, s5, 8
    s_add_u32 s65, s65, s7
    s_mov_b32 s67, s65
    s_mov_b32 s64, 0
    s_mov_b32 s96, 0x6010600
    s_mov_b32 s97, 0x6030602
    s_cmp_eq_u32 s5, 1
    s_cselect_b32 s96, 0x6190618, s96
    s_cselect_b32 s97, 0x61b061a, s97
    s_cmp_eq_u32 s5, 2
    s_cselect_b32 s96, 0x6310630, s96
    s_cselect_b32 s97, 0x6330632, s97
    s_cmp_eq_u32 s5, 3
    s_cselect_b32 s96, 0x6490648, s96
    s_cselect_b32 s97, 0x64b064a, s97
    s_cmp_eq_u32 s5, 4
    s_cselect_b32 s96, 0x4610460, s96
    s_cselect_b32 s97, 0x4630462, s97
    s_cmp_eq_u32 s5, 5
    s_cselect_b32 s96, 0x4710470, s96
    s_cselect_b32 s97, 0x4730472, s97
    v_xor_b32 v10, v3, v2
    v_lshlrev_b32 v10, 4, v10
    v_lshl_add_u32 v10, v2, 8, v10
    v_xor_b32 v11, 0x40, v10
    v_xor_b32 v12, 0x80, v10
    v_xor_b32 v13, 0xc0, v10
    v_lshrrev_b32 v14, 1, v3
    v_xor_b32 v14, v14, v2
    v_lshlrev_b32 v14, 5, v14
    v_lshl_add_u32 v14, v2, 8, v14
    v_and_b32 v40, 1, v1
    v_lshl_add_u32 v14, v40, 4, v14
    v_xor_b32 v15, 0x80, v14
    v_add_u32 v24, 4096, v10
    v_add_u32 v25, 4096, v11
    v_add_u32 v26, 4096, v12
    v_add_u32 v27, 4096, v13
    v_add_u32 v28, 4096, v14
    v_add_u32 v29, 4096, v15
    s_mov_b32 s76, 0
    s_lshl_b32 s7, s76, 4
    s_lshr_b64 s[90:91], s[96:97], s7
    s_and_b32 s68, s90, 3
    s_bfe_u32 s72, s90, 0x50002
    s_lshl_b32 s68, s68, 5
    s_add_u32 s68, s68, s4
    s_lshl_b32 s68, s68, 20
    s_lshl_b32 s72, s72, 13
    s_add_u32 s72, s72, s68
    s_add_u32 s72, s72, 0xC0000
    s_mov_b32 s68, s72
    s_mov_b32 s76, 1
    s_lshl_b32 s7, s76, 4
    s_lshr_b64 s[90:91], s[96:97], s7
    s_and_b32 s69, s90, 3
    s_bfe_u32 s73, s90, 0x50002
    s_lshl_b32 s69, s69, 5
    s_add_u32 s69, s69, s4
    s_lshl_b32 s69, s69, 20
    s_lshl_b32 s73, s73, 13
    s_add_u32 s73, s73, s69
    s_add_u32 s73, s73, 0xC0000
    s_mov_b32 s69, s73
    s_mov_b32 s76, 2
    s_lshl_b32 s7, s76, 4
    s_lshr_b64 s[90:91], s[96:97], s7
    s_and_b32 s70, s90, 3
    s_bfe_u32 s74, s90, 0x50002
    s_lshl_b32 s70, s70, 5
    s_add_u32 s70, s70, s4
    s_lshl_b32 s70, s70, 20
    s_lshl_b32 s74, s74, 13
    s_add_u32 s74, s74, s70
    s_add_u32 s74, s74, 0xC0000
    s_mov_b32 s70, s74
    s_mov_b32 s76, 3
    s_lshl_b32 s7, s76, 4
    s_lshr_b64 s[90:91], s[96:97], s7
    s_and_b32 s71, s90, 3
    s_bfe_u32 s75, s90, 0x50002
    s_lshl_b32 s71, s71, 5
    s_add_u32 s71, s71, s4
    s_lshl_b32 s71, s71, 20
    s_lshl_b32 s75, s75, 13
    s_add_u32 s75, s75, s71
    s_add_u32 s75, s75, 0xC0000
    s_mov_b32 s71, s75
    s_waitcnt lgkmcnt(0)
    s_mov_b32 s56, s16
    s_and_b32 s57, s17, 0xffff
    s_mov_b32 s58, 0x400000
    s_mov_b32 s59, 0x20000
    s_mov_b32 s44, s10
    s_and_b32 s45, s11, 0xffff
    s_mov_b32 s46, 0x8000000
    s_mov_b32 s47, 0x20000
    s_mov_b32 s48, s12
    s_and_b32 s49, s13, 0xffff
    s_mov_b32 s50, 0x8000000
    s_mov_b32 s51, 0x20000
    s_barrier
    s_mov_b32 s63, 0
    v_lshlrev_b32 v16, 2, v1
    v_add_u32 v17, 0x24100, v16
    v_add_u32 v16, 0x24000, v16
    v_mov_b32 v18, 0
    s_mov_b32 s60, 0
    s_mov_b32 s36, s34
    s_and_b32 s37, s35, 0xffff
    s_mov_b32 s38, 0x1000000
    s_mov_b32 s39, 0x20000
    v_mov_b32 v40, 0x24210
    s_mov_b32 s80, 1600000
LW_15:
    ds_read_b32 v41, v40
    s_waitcnt lgkmcnt(0)
    v_readfirstlane_b32 s79, v41
    s_cmp_ge_u32 s79, 8
    s_cbranch_scc1 LWD_16
    s_sub_u32 s80, s80, 1
    s_cmp_lg_u32 s80, 0
    s_cbranch_scc1 LW_15
LWD_16:
    s_mov_b32 s62, 0
    s_add_u32 m0, s64, 0
    s_waitcnt vmcnt(26)
    buffer_load_dwordx4 v10, s[44:47], s68 offen offset:0 nt lds
    buffer_load_dwordx4 v11, s[44:47], s68 offen offset:1024 nt lds
    s_waitcnt vmcnt(26)
    s_sub_u32 s7, s60, 24
    v_mov_b32 v19, s7
    ds_max_i32 v16, v19
    buffer_load_dwordx4 v12, s[44:47], s68 offen offset:2048 nt lds
    buffer_load_dwordx4 v13, s[44:47], s68 offen offset:3072 nt lds
    s_add_u32 m0, s64, 4096
    s_waitcnt vmcnt(26)
    buffer_load_dwordx4 v24, s[44:47], s68 offen offset:0 nt lds
    buffer_load_dwordx4 v25, s[44:47], s68 offen offset:1024 nt lds
    s_waitcnt vmcnt(26)
    buffer_load_dwordx4 v26, s[44:47], s68 offen offset:2048 nt lds
    buffer_load_dwordx4 v27, s[44:47], s68 offen offset:3072 nt lds
    s_add_u32 s68, s68, 8192
    s_add_u32 m0, s64, 8192
    s_waitcnt vmcnt(26)
    buffer_load_dwordx4 v10, s[44:47], s69 offen offset:0 nt lds
    buffer_load_dwordx4 v11, s[44:47], s69 offen offset:1024 nt lds
    s_waitcnt vmcnt(26)
    s_sub_u32 s7, s60, 16
    v_mov_b32 v19, s7
    ds_max_i32 v16, v19
    buffer_load_dwordx4 v12, s[44:47], s69 offen offset:2048 nt lds
    buffer_load_dwordx4 v13, s[44:47], s69 offen offset:3072 nt lds
    s_add_u32 m0, s64, 12288
    s_waitcnt vmcnt(26)
    buffer_load_dwordx4 v24, s[44:47], s69 offen offset:0 nt lds
    s_memrealtime s[84:85]
    buffer_load_dwordx4 v25, s[44:47], s69 offen offset:1024 nt lds
    s_waitcnt vmcnt(26)
    buffer_load_dwordx4 v26, s[44:47], s69 offen offset:2048 nt lds
    buffer_load_dwordx4 v27, s[44:47], s69 offen offset:3072 nt lds
    s_add_u32 s69, s69, 8192
    s_add_u32 s60, s60, 16
    s_add_u32 m0, s64, 16384
    s_waitcnt vmcnt(26)
    buffer_load_dwordx4 v10, s[44:47], s70 offen offset:0 nt lds
    buffer_load_dwordx4 v11, s[44:47], s70 offen offset:1024 nt lds
    s_waitcnt vmcnt(26)
    s_sub_u32 s7, s60, 24
    v_mov_b32 v19, s7
    ds_max_i32 v16, v19
    buffer_load_dwordx4 v12, s[44:47], s70 offen offset:2048 nt lds
    buffer_load_dwordx4 v13, s[44:47], s70 offen offset:3072 nt lds
    s_add_u32 m0, s64, 20480
    s_waitcnt vmcnt(26)
    buffer_load_dwordx4 v24, s[44:47], s70 offen offset:0 nt lds
    buffer_load_dwordx4 v25, s[44:47], s70 offen offset:1024 nt lds
    s_waitcnt vmcnt(26)
    buffer_load_dwordx4 v26, s[44:47], s70 offen offset:2048 nt lds
    buffer_load_dwordx4 v27, s[44:47], s70 offen offset:3072 nt lds
    s_add_u32 s70, s70, 8192
    s_add_u32 m0, s64, 24576
    s_waitcnt vmcnt(26)
    buffer_load_dwordx4 v10, s[44:47], s71 offen offset:0 nt lds
    buffer_load_dwordx4 v11, s[44:47], s71 offen offset:1024 nt lds
    s_waitcnt vmcnt(26)
    s_sub_u32 s7, s60, 16
    v_mov_b32 v19, s7
    ds_max_i32 v16, v19
    buffer_load_dwordx4 v12, s[44:47], s71 offen offset:2048 nt lds
    buffer_load_dwordx4 v13, s[44:47], s71 offen offset:3072 nt lds
    s_add_u32 m0, s64, 28672
    s_waitcnt vmcnt(26)
    buffer_load_dwordx4 v24, s[44:47], s71 offen offset:0 nt lds
    s_memrealtime s[84:85]
    ds_read_b32 v18, v17
    buffer_load_dwordx4 v25, s[44:47], s71 offen offset:1024 nt lds
    s_waitcnt vmcnt(26)
    buffer_load_dwordx4 v26, s[44:47], s71 offen offset:2048 nt lds
    buffer_load_dwordx4 v27, s[44:47], s71 offen offset:3072 nt lds
    s_add_u32 s71, s71, 8192
    s_add_u32 s60, s60, 16
    s_add_u32 s62, s62, 1
    s_and_b32 s62, s62, 3
    s_lshl_b32 s64, s62, 15
    s_cmp_eq_u32 s62, 2
    s_cselect_b32 s7, 4, 0
    s_add_u32 s63, s63, s7
    v_mov_b32 v40, 0x24204
    s_mov_b32 s80, 1600000
LW_17:
    ds_read_b32 v41, v40
    s_waitcnt lgkmcnt(0)
    v_readfirstlane_b32 s79, v41
    s_cmp_ge_u32 s79, 1
    s_cbranch_scc1 LWD_18
    s_sleep 1
    s_sub_u32 s80, s80, 1
    s_cmp_lg_u32 s80, 0
    s_cbranch_scc1 LW_17
LWD_18:
    v_mov_b32 v40, 0x24248
    ds_read_b64 v[42:43], v40
    s_waitcnt lgkmcnt(0)
    v_readfirstlane_b32 s92, v42
    v_readfirstlane_b32 s93, v43
    s_add_u32 s77, s92, 10176
    s_mov_b32 s61, 2048
    s_mov_b32 s86, 1536
    s_mov_b32 s66, 5
    s_mov_b32 s87, 6
    s_memrealtime s[84:85]
L_KV:
RD_19:
    s_waitcnt lgkmcnt(0)
    v_readlane_b32 s79, v18, s62
    s_cmp_lt_u32 s79, s63
    s_cbranch_scc1 ST_21
GO_20:
    s_lshl_b32 s7, s84, 5
    s_sub_u32 s7, s7, s77
    s_add_u32 s77, s77, s61
    s_cmp_lt_i32 s7, -640
    s_cbranch_scc1 WS_22
    s_cmp_gt_i32 s7, 2240
    s_cbranch_scc1 WB_23
    s_add_u32 m0, s64, 0
    s_waitcnt vmcnt(22)
    buffer_load_dwordx4 v10, s[44:47], s68 offen offset:0 nt lds
    buffer_load_dwordx4 v11, s[44:47], s68 offen offset:1024 nt lds
    s_waitcnt vmcnt(22)
    buffer_load_dwordx4 v12, s[44:47], s68 offen offset:2048 nt lds
    buffer_load_dwordx4 v13, s[44:47], s68 offen offset:3072 nt lds
    s_add_u32 m0, s64, 4096
    s_waitcnt vmcnt(22)
    buffer_load_dwordx4 v24, s[44:47], s68 offen offset:0 nt lds
    buffer_load_dwordx4 v25, s[44:47], s68 offen offset:1024 nt lds
    s_waitcnt vmcnt(22)
    s_sub_u32 s7, s60, 16
    v_mov_b32 v19, s7
    ds_max_i32 v16, v19
    buffer_load_dwordx4 v26, s[44:47], s68 offen offset:2048 nt lds
    buffer_load_dwordx4 v27, s[44:47], s68 offen offset:3072 nt lds
    s_add_u32 s68, s68, 8192
    s_add_u32 m0, s64, 8192
    s_waitcnt vmcnt(22)
    buffer_load_dwordx4 v10, s[44:47], s69 offen offset:0 nt lds
    buffer_load_dwordx4 v11, s[44:47], s69 offen offset:1024 nt lds
    s_waitcnt vmcnt(22)
    buffer_load_dwordx4 v12, s[44:47], s69 offen offset:2048 nt lds
    buffer_load_dwordx4 v13, s[44:47], s69 offen offset:3072 nt lds
    s_add_u32 m0, s64, 12288
    s_waitcnt vmcnt(22)
    buffer_load_dwordx4 v24, s[44:47], s69 offen offset:0 nt lds
    s_memrealtime s[84:85]
    buffer_load_dwordx4 v25, s[44:47], s69 offen offset:1024 nt lds
    s_waitcnt vmcnt(22)
    s_sub_u32 s7, s60, 8
    v_mov_b32 v19, s7
    ds_max_i32 v16, v19
    buffer_load_dwordx4 v26, s[44:47], s69 offen offset:2048 nt lds
    buffer_load_dwordx4 v27, s[44:47], s69 offen offset:3072 nt lds
    s_add_u32 s69, s69, 8192
    s_branch WJ_24
WS_22:
    s_add_u32 m0, s64, 0
    s_waitcnt vmcnt(14)
    buffer_load_dwordx4 v10, s[44:47], s68 offen offset:0 nt lds
    buffer_load_dwordx4 v11, s[44:47], s68 offen offset:1024 nt lds
    s_waitcnt vmcnt(14)
    buffer_load_dwordx4 v12, s[44:47], s68 offen offset:2048 nt lds
    buffer_load_dwordx4 v13, s[44:47], s68 offen offset:3072 nt lds
    s_add_u32 m0, s64, 4096
    s_waitcnt vmcnt(14)
    buffer_load_dwordx4 v24, s[44:47], s68 offen offset:0 nt lds
    buffer_load_dwordx4 v25, s[44:47], s68 offen offset:1024 nt lds
    s_waitcnt vmcnt(14)
    s_sub_u32 s7, s60, 8
    v_mov_b32 v19, s7
    ds_max_i32 v16, v19
    buffer_load_dwordx4 v26, s[44:47], s68 offen offset:2048 nt lds
    buffer_load_dwordx4 v27, s[44:47], s68 offen offset:3072 nt lds
    s_add_u32 s68, s68, 8192
    s_add_u32 m0, s64, 8192
    s_waitcnt vmcnt(14)
    buffer_load_dwordx4 v10, s[44:47], s69 offen offset:0 nt lds
    buffer_load_dwordx4 v11, s[44:47], s69 offen offset:1024 nt lds
    s_waitcnt vmcnt(14)
    buffer_load_dwordx4 v12, s[44:47], s69 offen offset:2048 nt lds
    buffer_load_dwordx4 v13, s[44:47], s69 offen offset:3072 nt lds
    s_add_u32 m0, s64, 12288
    s_waitcnt vmcnt(14)
    buffer_load_dwordx4 v24, s[44:47], s69 offen offset:0 nt lds
    s_memrealtime s[84:85]
    buffer_load_dwordx4 v25, s[44:47], s69 offen offset:1024 nt lds
    s_waitcnt vmcnt(14)
    v_mov_b32 v19, s60
    ds_max_i32 v16, v19
    buffer_load_dwordx4 v26, s[44:47], s69 offen offset:2048 nt lds
    buffer_load_dwordx4 v27, s[44:47], s69 offen offset:3072 nt lds
    s_add_u32 s69, s69, 8192
    s_branch WJ_24
WB_23:
    s_add_u32 m0, s64, 0
    s_waitcnt vmcnt(30)
    buffer_load_dwordx4 v10, s[44:47], s68 offen offset:0 nt lds
    buffer_load_dwordx4 v11, s[44:47], s68 offen offset:1024 nt lds
    s_waitcnt vmcnt(30)
    buffer_load_dwordx4 v12, s[44:47], s68 offen offset:2048 nt lds
    buffer_load_dwordx4 v13, s[44:47], s68 offen offset:3072 nt lds
    s_add_u32 m0, s64, 4096
    s_waitcnt vmcnt(30)
    buffer_load_dwordx4 v24, s[44:47], s68 offen offset:0 nt lds
    buffer_load_dwordx4 v25, s[44:47], s68 offen offset:1024 nt lds
    s_waitcnt vmcnt(30)
    s_sub_u32 s7, s60, 24
    v_mov_b32 v19, s7
    ds_max_i32 v16, v19
    buffer_load_dwordx4 v26, s[44:47], s68 offen offset:2048 nt lds
    buffer_load_dwordx4 v27, s[44:47], s68 offen offset:3072 nt lds
    s_add_u32 s68, s68, 8192
    s_add_u32 m0, s64, 8192
    s_waitcnt vmcnt(30)
    buffer_load_dwordx4 v10, s[44:47], s69 offen offset:0 nt lds
    buffer_load_dwordx4 v11, s[44:47], s69 offen offset:1024 nt lds
    s_waitcnt vmcnt(30)
    buffer_load_dwordx4 v12, s[44:47], s69 offen offset:2048 nt lds
    buffer_load_dwordx4 v13, s[44:47], s69 offen offset:3072 nt lds
    s_add_u32 m0, s64, 12288
    s_waitcnt vmcnt(30)
    buffer_load_dwordx4 v24, s[44:47], s69 offen offset:0 nt lds
    s_memrealtime s[84:85]
    buffer_load_dwordx4 v25, s[44:47], s69 offen offset:1024 nt lds
    s_waitcnt vmcnt(30)
    s_sub_u32 s7, s60, 16
    v_mov_b32 v19, s7
    ds_max_i32 v16, v19
    buffer_load_dwordx4 v26, s[44:47], s69 offen offset:2048 nt lds
    buffer_load_dwordx4 v27, s[44:47], s69 offen offset:3072 nt lds
    s_add_u32 s69, s69, 8192
WJ_24:
    s_add_u32 s60, s60, 16
    s_waitcnt lgkmcnt(0)
    s_lshl_b32 s7, s84, 5
    s_sub_u32 s7, s7, s77
    s_add_u32 s77, s77, s61
    s_cmp_lt_i32 s7, -640
    s_cbranch_scc1 WS_25
    s_cmp_gt_i32 s7, 2240
    s_cbranch_scc1 WB_26
    s_add_u32 m0, s64, 16384
    s_waitcnt vmcnt(22)
    buffer_load_dwordx4 v10, s[44:47], s70 offen offset:0 nt lds
    buffer_load_dwordx4 v11, s[44:47], s70 offen offset:1024 nt lds
    s_waitcnt vmcnt(22)
    buffer_load_dwordx4 v12, s[44:47], s70 offen offset:2048 nt lds
    buffer_load_dwordx4 v13, s[44:47], s70 offen offset:3072 nt lds
    s_add_u32 m0, s64, 20480
    s_waitcnt vmcnt(22)
    buffer_load_dwordx4 v24, s[44:47], s70 offen offset:0 nt lds
    buffer_load_dwordx4 v25, s[44:47], s70 offen offset:1024 nt lds
    s_waitcnt vmcnt(22)
    s_sub_u32 s7, s60, 16
    v_mov_b32 v19, s7
    ds_max_i32 v16, v19
    buffer_load_dwordx4 v26, s[44:47], s70 offen offset:2048 nt lds
    buffer_load_dwordx4 v27, s[44:47], s70 offen offset:3072 nt lds
    s_add_u32 s70, s70, 8192
    s_add_u32 m0, s64, 24576
    s_waitcnt vmcnt(22)
    buffer_load_dwordx4 v10, s[44:47], s71 offen offset:0 nt lds
    buffer_load_dwordx4 v11, s[44:47], s71 offen offset:1024 nt lds
    s_waitcnt vmcnt(22)
    buffer_load_dwordx4 v12, s[44:47], s71 offen offset:2048 nt lds
    buffer_load_dwordx4 v13, s[44:47], s71 offen offset:3072 nt lds
    s_add_u32 m0, s64, 28672
    s_waitcnt vmcnt(22)
    buffer_load_dwordx4 v24, s[44:47], s71 offen offset:0 nt lds
    s_memrealtime s[84:85]
    ds_read_b32 v18, v17
    buffer_load_dwordx4 v25, s[44:47], s71 offen offset:1024 nt lds
    s_waitcnt vmcnt(22)
    s_sub_u32 s7, s60, 8
    v_mov_b32 v19, s7
    ds_max_i32 v16, v19
    buffer_load_dwordx4 v26, s[44:47], s71 offen offset:2048 nt lds
    buffer_load_dwordx4 v27, s[44:47], s71 offen offset:3072 nt lds
    s_add_u32 s71, s71, 8192
    s_branch WJ_27
WS_25:
    s_add_u32 m0, s64, 16384
    s_waitcnt vmcnt(14)
    buffer_load_dwordx4 v10, s[44:47], s70 offen offset:0 nt lds
    buffer_load_dwordx4 v11, s[44:47], s70 offen offset:1024 nt lds
    s_waitcnt vmcnt(14)
    buffer_load_dwordx4 v12, s[44:47], s70 offen offset:2048 nt lds
    buffer_load_dwordx4 v13, s[44:47], s70 offen offset:3072 nt lds
    s_add_u32 m0, s64, 20480
    s_waitcnt vmcnt(14)
    buffer_load_dwordx4 v24, s[44:47], s70 offen offset:0 nt lds
    buffer_load_dwordx4 v25, s[44:47], s70 offen offset:1024 nt lds
    s_waitcnt vmcnt(14)
    s_sub_u32 s7, s60, 8
    v_mov_b32 v19, s7
    ds_max_i32 v16, v19
    buffer_load_dwordx4 v26, s[44:47], s70 offen offset:2048 nt lds
    buffer_load_dwordx4 v27, s[44:47], s70 offen offset:3072 nt lds
    s_add_u32 s70, s70, 8192
    s_add_u32 m0, s64, 24576
    s_waitcnt vmcnt(14)
    buffer_load_dwordx4 v10, s[44:47], s71 offen offset:0 nt lds
    buffer_load_dwordx4 v11, s[44:47], s71 offen offset:1024 nt lds
    s_waitcnt vmcnt(14)
    buffer_load_dwordx4 v12, s[44:47], s71 offen offset:2048 nt lds
    buffer_load_dwordx4 v13, s[44:47], s71 offen offset:3072 nt lds
    s_add_u32 m0, s64, 28672
    s_waitcnt vmcnt(14)
    buffer_load_dwordx4 v24, s[44:47], s71 offen offset:0 nt lds
    s_memrealtime s[84:85]
    ds_read_b32 v18, v17
    buffer_load_dwordx4 v25, s[44:47], s71 offen offset:1024 nt lds
    s_waitcnt vmcnt(14)
    v_mov_b32 v19, s60
    ds_max_i32 v16, v19
    buffer_load_dwordx4 v26, s[44:47], s71 offen offset:2048 nt lds
    buffer_load_dwordx4 v27, s[44:47], s71 offen offset:3072 nt lds
    s_add_u32 s71, s71, 8192
    s_branch WJ_27
WB_26:
    s_add_u32 m0, s64, 16384
    s_waitcnt vmcnt(30)
    buffer_load_dwordx4 v10, s[44:47], s70 offen offset:0 nt lds
    buffer_load_dwordx4 v11, s[44:47], s70 offen offset:1024 nt lds
    s_waitcnt vmcnt(30)
    buffer_load_dwordx4 v12, s[44:47], s70 offen offset:2048 nt lds
    buffer_load_dwordx4 v13, s[44:47], s70 offen offset:3072 nt lds
    s_add_u32 m0, s64, 20480
    s_waitcnt vmcnt(30)
    buffer_load_dwordx4 v24, s[44:47], s70 offen offset:0 nt lds
    buffer_load_dwordx4 v25, s[44:47], s70 offen offset:1024 nt lds
    s_waitcnt vmcnt(30)
    s_sub_u32 s7, s60, 24
    v_mov_b32 v19, s7
    ds_max_i32 v16, v19
    buffer_load_dwordx4 v26, s[44:47], s70 offen offset:2048 nt lds
    buffer_load_dwordx4 v27, s[44:47], s70 offen offset:3072 nt lds
    s_add_u32 s70, s70, 8192
    s_add_u32 m0, s64, 24576
    s_waitcnt vmcnt(30)
    buffer_load_dwordx4 v10, s[44:47], s71 offen offset:0 nt lds
    buffer_load_dwordx4 v11, s[44:47], s71 offen offset:1024 nt lds
    s_waitcnt vmcnt(30)
    buffer_load_dwordx4 v12, s[44:47], s71 offen offset:2048 nt lds
    buffer_load_dwordx4 v13, s[44:47], s71 offen offset:3072 nt lds
    s_add_u32 m0, s64, 28672
    s_waitcnt vmcnt(30)
    buffer_load_dwordx4 v24, s[44:47], s71 offen offset:0 nt lds
    s_memrealtime s[84:85]
    ds_read_b32 v18, v17
    buffer_load_dwordx4 v25, s[44:47], s71 offen offset:1024 nt lds
    s_waitcnt vmcnt(30)
    s_sub_u32 s7, s60, 16
    v_mov_b32 v19, s7
    ds_max_i32 v16, v19
    buffer_load_dwordx4 v26, s[44:47], s71 offen offset:2048 nt lds
    buffer_load_dwordx4 v27, s[44:47], s71 offen offset:3072 nt lds
    s_add_u32 s71, s71, 8192
WJ_27:
    s_add_u32 s60, s60, 16
    s_add_u32 s62, s62, 1
    s_and_b32 s62, s62, 3
    s_lshl_b32 s64, s62, 15
    s_cmp_eq_u32 s62, 2
    s_cselect_b32 s7, 4, 0
    s_add_u32 s63, s63, s7
    s_sub_u32 s66, s66, 1
    s_cmp_lg_u32 s66, 0
    s_cbranch_scc1 RD_19
    s_mov_b32 s68, s72
    s_mov_b32 s69, s73
    s_mov_b32 s70, s74
    s_mov_b32 s71, s75
    s_mov_b32 s66, s87
    s_mov_b32 s61, s86
RD_28:
    s_waitcnt lgkmcnt(0)
    v_readlane_b32 s79, v18, s62
    s_cmp_lt_u32 s79, s63
    s_cbranch_scc1 ST_30
GO_29:
    s_lshl_b32 s7, s84, 5
    s_sub_u32 s7, s7, s77
    s_add_u32 s77, s77, s61
    s_cmp_lt_i32 s7, -640
    s_cbranch_scc1 WS_31
    s_cmp_gt_i32 s7, 2240
    s_cbranch_scc1 WB_32
    s_add_u32 m0, s64, 0
    s_waitcnt vmcnt(28)
    buffer_load_dwordx4 v14, s[48:51], s68 offen offset:0 nt lds
    buffer_load_dwordx4 v15, s[48:51], s68 offen offset:1024 nt lds
    s_waitcnt vmcnt(28)
    buffer_load_dwordx4 v14, s[48:51], s68 offen offset:2048 nt lds
    buffer_load_dwordx4 v15, s[48:51], s68 offen offset:3072 nt lds
    s_add_u32 m0, s64, 4096
    s_waitcnt vmcnt(28)
    s_sub_u32 s7, s60, 24
    v_mov_b32 v19, s7
    ds_max_i32 v16, v19
    buffer_load_dwordx4 v28, s[48:51], s68 offen offset:0 nt lds
    buffer_load_dwordx4 v29, s[48:51], s68 offen offset:1024 nt lds
    s_waitcnt vmcnt(28)
    buffer_load_dwordx4 v28, s[48:51], s68 offen offset:2048 nt lds
    buffer_load_dwordx4 v29, s[48:51], s68 offen offset:3072 nt lds
    s_add_u32 s68, s68, 8192
    s_add_u32 m0, s64, 8192
    s_waitcnt vmcnt(28)
    buffer_load_dwordx4 v14, s[48:51], s69 offen offset:0 nt lds
    buffer_load_dwordx4 v15, s[48:51], s69 offen offset:1024 nt lds
    s_waitcnt vmcnt(28)
    buffer_load_dwordx4 v14, s[48:51], s69 offen offset:2048 nt lds
    buffer_load_dwordx4 v15, s[48:51], s69 offen offset:3072 nt lds
    s_add_u32 m0, s64, 12288
    s_waitcnt vmcnt(28)
    s_sub_u32 s7, s60, 16
    v_mov_b32 v19, s7
    ds_max_i32 v16, v19
    buffer_load_dwordx4 v28, s[48:51], s69 offen offset:0 nt lds
    s_memrealtime s[84:85]
    buffer_load_dwordx4 v29, s[48:51], s69 offen offset:1024 nt lds
    s_waitcnt vmcnt(28)
    buffer_load_dwordx4 v28, s[48:51], s69 offen offset:2048 nt lds
    buffer_load_dwordx4 v29, s[48:51], s69 offen offset:3072 nt lds
    s_add_u32 s69, s69, 8192
    s_branch WJ_33
WS_31:
    s_add_u32 m0, s64, 0
    s_waitcnt vmcnt(18)
    buffer_load_dwordx4 v14, s[48:51], s68 offen offset:0 nt lds
    buffer_load_dwordx4 v15, s[48:51], s68 offen offset:1024 nt lds
    s_waitcnt vmcnt(18)
    s_sub_u32 s7, s60, 16
    v_mov_b32 v19, s7
    ds_max_i32 v16, v19
    buffer_load_dwordx4 v14, s[48:51], s68 offen offset:2048 nt lds
    buffer_load_dwordx4 v15, s[48:51], s68 offen offset:3072 nt lds
    s_add_u32 m0, s64, 4096
    s_waitcnt vmcnt(18)
    buffer_load_dwordx4 v28, s[48:51], s68 offen offset:0 nt lds
    buffer_load_dwordx4 v29, s[48:51], s68 offen offset:1024 nt lds
    s_waitcnt vmcnt(18)
    buffer_load_dwordx4 v28, s[48:51], s68 offen offset:2048 nt lds
    buffer_load_dwordx4 v29, s[48:51], s68 offen offset:3072 nt lds
    s_add_u32 s68, s68, 8192
    s_add_u32 m0, s64, 8192
    s_waitcnt vmcnt(18)
    buffer_load_dwordx4 v14, s[48:51], s69 offen offset:0 nt lds
    buffer_load_dwordx4 v15, s[48:51], s69 offen offset:1024 nt lds
    s_waitcnt vmcnt(18)
    s_sub_u32 s7, s60, 8
    v_mov_b32 v19, s7
    ds_max_i32 v16, v19
    buffer_load_dwordx4 v14, s[48:51], s69 offen offset:2048 nt lds
    buffer_load_dwordx4 v15, s[48:51], s69 offen offset:3072 nt lds
    s_add_u32 m0, s64, 12288
    s_waitcnt vmcnt(18)
    buffer_load_dwordx4 v28, s[48:51], s69 offen offset:0 nt lds
    s_memrealtime s[84:85]
    buffer_load_dwordx4 v29, s[48:51], s69 offen offset:1024 nt lds
    s_waitcnt vmcnt(18)
    buffer_load_dwordx4 v28, s[48:51], s69 offen offset:2048 nt lds
    buffer_load_dwordx4 v29, s[48:51], s69 offen offset:3072 nt lds
    s_add_u32 s69, s69, 8192
    s_branch WJ_33
WB_32:
    s_add_u32 m0, s64, 0
    s_waitcnt vmcnt(42)
    buffer_load_dwordx4 v14, s[48:51], s68 offen offset:0 nt lds
    buffer_load_dwordx4 v15, s[48:51], s68 offen offset:1024 nt lds
    s_waitcnt vmcnt(42)
    s_sub_u32 s7, s60, 40
    v_mov_b32 v19, s7
    ds_max_i32 v16, v19
    buffer_load_dwordx4 v14, s[48:51], s68 offen offset:2048 nt lds
    buffer_load_dwordx4 v15, s[48:51], s68 offen offset:3072 nt lds
    s_add_u32 m0, s64, 4096
    s_waitcnt vmcnt(42)
    buffer_load_dwordx4 v28, s[48:51], s68 offen offset:0 nt lds
    buffer_load_dwordx4 v29, s[48:51], s68 offen offset:1024 nt lds
    s_waitcnt vmcnt(42)
    buffer_load_dwordx4 v28, s[48:51], s68 offen offset:2048 nt lds
    buffer_load_dwordx4 v29, s[48:51], s68 offen offset:3072 nt lds
    s_add_u32 s68, s68, 8192
    s_add_u32 m0, s64, 8192
    s_waitcnt vmcnt(42)
    buffer_load_dwordx4 v14, s[48:51], s69 offen offset:0 nt lds
    buffer_load_dwordx4 v15, s[48:51], s69 offen offset:1024 nt lds
    s_waitcnt vmcnt(42)
    s_sub_u32 s7, s60, 32
    v_mov_b32 v19, s7
    ds_max_i32 v16, v19
    buffer_load_dwordx4 v14, s[48:51], s69 offen offset:2048 nt lds
    buffer_load_dwordx4 v15, s[48:51], s69 offen offset:3072 nt lds
    s_add_u32 m0, s64, 12288
    s_waitcnt vmcnt(42)
    buffer_load_dwordx4 v28, s[48:51], s69 offen offset:0 nt lds
    s_memrealtime s[84:85]
    buffer_load_dwordx4 v29, s[48:51], s69 offen offset:1024 nt lds
    s_waitcnt vmcnt(42)
    buffer_load_dwordx4 v28, s[48:51], s69 offen offset:2048 nt lds
    buffer_load_dwordx4 v29, s[48:51], s69 offen offset:3072 nt lds
    s_add_u32 s69, s69, 8192
WJ_33:
    s_add_u32 s60, s60, 16
    s_waitcnt lgkmcnt(0)
    s_lshl_b32 s7, s84, 5
    s_sub_u32 s7, s7, s77
    s_add_u32 s77, s77, s61
    s_cmp_lt_i32 s7, -640
    s_cbranch_scc1 WS_34
    s_cmp_gt_i32 s7, 2240
    s_cbranch_scc1 WB_35
    s_add_u32 m0, s64, 16384
    s_waitcnt vmcnt(28)
    buffer_load_dwordx4 v14, s[48:51], s70 offen offset:0 nt lds
    buffer_load_dwordx4 v15, s[48:51], s70 offen offset:1024 nt lds
    s_waitcnt vmcnt(28)
    buffer_load_dwordx4 v14, s[48:51], s70 offen offset:2048 nt lds
    buffer_load_dwordx4 v15, s[48:51], s70 offen offset:3072 nt lds
    s_add_u32 m0, s64, 20480
    s_waitcnt vmcnt(28)
    s_sub_u32 s7, s60, 24
    v_mov_b32 v19, s7
    ds_max_i32 v16, v19
    buffer_load_dwordx4 v28, s[48:51], s70 offen offset:0 nt lds
    buffer_load_dwordx4 v29, s[48:51], s70 offen offset:1024 nt lds
    s_waitcnt vmcnt(28)
    buffer_load_dwordx4 v28, s[48:51], s70 offen offset:2048 nt lds
    buffer_load_dwordx4 v29, s[48:51], s70 offen offset:3072 nt lds
    s_add_u32 s70, s70, 8192
    s_add_u32 m0, s64, 24576
    s_waitcnt vmcnt(28)
    buffer_load_dwordx4 v14, s[48:51], s71 offen offset:0 nt lds
    buffer_load_dwordx4 v15, s[48:51], s71 offen offset:1024 nt lds
    s_waitcnt vmcnt(28)
    buffer_load_dwordx4 v14, s[48:51], s71 offen offset:2048 nt lds
    buffer_load_dwordx4 v15, s[48:51], s71 offen offset:3072 nt lds
    s_add_u32 m0, s64, 28672
    s_waitcnt vmcnt(28)
    s_sub_u32 s7, s60, 16
    v_mov_b32 v19, s7
    ds_max_i32 v16, v19
    buffer_load_dwordx4 v28, s[48:51], s71 offen offset:0 nt lds
    s_memrealtime s[84:85]
    ds_read_b32 v18, v17
    buffer_load_dwordx4 v29, s[48:51], s71 offen offset:1024 nt lds
    s_waitcnt vmcnt(28)
    buffer_load_dwordx4 v28, s[48:51], s71 offen offset:2048 nt lds
    buffer_load_dwordx4 v29, s[48:51], s71 offen offset:3072 nt lds
    s_add_u32 s71, s71, 8192
    s_branch WJ_36
WS_34:
    s_add_u32 m0, s64, 16384
    s_waitcnt vmcnt(18)
    buffer_load_dwordx4 v14, s[48:51], s70 offen offset:0 nt lds
    buffer_load_dwordx4 v15, s[48:51], s70 offen offset:1024 nt lds
    s_waitcnt vmcnt(18)
    s_sub_u32 s7, s60, 16
    v_mov_b32 v19, s7
    ds_max_i32 v16, v19
    buffer_load_dwordx4 v14, s[48:51], s70 offen offset:2048 nt lds
    buffer_load_dwordx4 v15, s[48:51], s70 offen offset:3072 nt lds
    s_add_u32 m0, s64, 20480
    s_waitcnt vmcnt(18)
    buffer_load_dwordx4 v28, s[48:51], s70 offen offset:0 nt lds
    buffer_load_dwordx4 v29, s[48:51], s70 offen offset:1024 nt lds
    s_waitcnt vmcnt(18)
    buffer_load_dwordx4 v28, s[48:51], s70 offen offset:2048 nt lds
    buffer_load_dwordx4 v29, s[48:51], s70 offen offset:3072 nt lds
    s_add_u32 s70, s70, 8192
    s_add_u32 m0, s64, 24576
    s_waitcnt vmcnt(18)
    buffer_load_dwordx4 v14, s[48:51], s71 offen offset:0 nt lds
    buffer_load_dwordx4 v15, s[48:51], s71 offen offset:1024 nt lds
    s_waitcnt vmcnt(18)
    s_sub_u32 s7, s60, 8
    v_mov_b32 v19, s7
    ds_max_i32 v16, v19
    buffer_load_dwordx4 v14, s[48:51], s71 offen offset:2048 nt lds
    buffer_load_dwordx4 v15, s[48:51], s71 offen offset:3072 nt lds
    s_add_u32 m0, s64, 28672
    s_waitcnt vmcnt(18)
    buffer_load_dwordx4 v28, s[48:51], s71 offen offset:0 nt lds
    s_memrealtime s[84:85]
    ds_read_b32 v18, v17
    buffer_load_dwordx4 v29, s[48:51], s71 offen offset:1024 nt lds
    s_waitcnt vmcnt(18)
    buffer_load_dwordx4 v28, s[48:51], s71 offen offset:2048 nt lds
    buffer_load_dwordx4 v29, s[48:51], s71 offen offset:3072 nt lds
    s_add_u32 s71, s71, 8192
    s_branch WJ_36
WB_35:
    s_add_u32 m0, s64, 16384
    s_waitcnt vmcnt(42)
    buffer_load_dwordx4 v14, s[48:51], s70 offen offset:0 nt lds
    buffer_load_dwordx4 v15, s[48:51], s70 offen offset:1024 nt lds
    s_waitcnt vmcnt(42)
    s_sub_u32 s7, s60, 40
    v_mov_b32 v19, s7
    ds_max_i32 v16, v19
    buffer_load_dwordx4 v14, s[48:51], s70 offen offset:2048 nt lds
    buffer_load_dwordx4 v15, s[48:51], s70 offen offset:3072 nt lds
    s_add_u32 m0, s64, 20480
    s_waitcnt vmcnt(42)
    buffer_load_dwordx4 v28, s[48:51], s70 offen offset:0 nt lds
    buffer_load_dwordx4 v29, s[48:51], s70 offen offset:1024 nt lds
    s_waitcnt vmcnt(42)
    buffer_load_dwordx4 v28, s[48:51], s70 offen offset:2048 nt lds
    buffer_load_dwordx4 v29, s[48:51], s70 offen offset:3072 nt lds
    s_add_u32 s70, s70, 8192
    s_add_u32 m0, s64, 24576
    s_waitcnt vmcnt(42)
    buffer_load_dwordx4 v14, s[48:51], s71 offen offset:0 nt lds
    buffer_load_dwordx4 v15, s[48:51], s71 offen offset:1024 nt lds
    s_waitcnt vmcnt(42)
    s_sub_u32 s7, s60, 32
    v_mov_b32 v19, s7
    ds_max_i32 v16, v19
    buffer_load_dwordx4 v14, s[48:51], s71 offen offset:2048 nt lds
    buffer_load_dwordx4 v15, s[48:51], s71 offen offset:3072 nt lds
    s_add_u32 m0, s64, 28672
    s_waitcnt vmcnt(42)
    buffer_load_dwordx4 v28, s[48:51], s71 offen offset:0 nt lds
    s_memrealtime s[84:85]
    ds_read_b32 v18, v17
    buffer_load_dwordx4 v29, s[48:51], s71 offen offset:1024 nt lds
    s_waitcnt vmcnt(42)
    buffer_load_dwordx4 v28, s[48:51], s71 offen offset:2048 nt lds
    buffer_load_dwordx4 v29, s[48:51], s71 offen offset:3072 nt lds
    s_add_u32 s71, s71, 8192
WJ_36:
    s_add_u32 s60, s60, 16
    s_add_u32 s62, s62, 1
    s_and_b32 s62, s62, 3
    s_lshl_b32 s64, s62, 15
    s_cmp_eq_u32 s62, 2
    s_cselect_b32 s7, 4, 0
    s_add_u32 s63, s63, s7
    s_sub_u32 s66, s66, 1
    s_cmp_lg_u32 s66, 0
    s_cbranch_scc1 RD_28
    s_cmp_ge_u32 s5, 4
    s_cbranch_scc1 KE_37
    s_mov_b32 s65, s67
    s_waitcnt lgkmcnt(0)
    v_readlane_b32 s79, v18, s62
    s_cmp_lt_u32 s79, s63
    s_cbranch_scc1 ST_39
GO_38:
    s_mov_b32 s66, 2
LL_40:
    s_waitcnt vmcnt(43)
    s_mov_b32 m0, s64
    s_add_u32 s64, s64, 1024
    buffer_load_dwordx4 v20, s[56:59], s65 offen nt lds
    s_add_u32 s65, s65, 4096
    s_waitcnt vmcnt(43)
    s_mov_b32 m0, s64
    s_add_u32 s64, s64, 1024
    buffer_load_dwordx4 v20, s[56:59], s65 offen nt lds
    s_add_u32 s65, s65, 4096
    s_waitcnt vmcnt(43)
    s_mov_b32 m0, s64
    s_add_u32 s64, s64, 1024
    buffer_load_dwordx4 v20, s[56:59], s65 offen nt lds
    s_add_u32 s65, s65, 4096
    s_waitcnt vmcnt(43)
    s_sub_u32 s7, s60, 40
    v_mov_b32 v19, s7
    ds_max_i32 v16, v19
    s_mov_b32 m0, s64
    s_add_u32 s64, s64, 1024
    buffer_load_dwordx4 v20, s[56:59], s65 offen nt lds
    s_add_u32 s65, s65, 4096
    s_waitcnt vmcnt(43)
    s_mov_b32 m0, s64
    s_add_u32 s64, s64, 1024
    buffer_load_dwordx4 v21, s[56:59], s65 offen nt lds
    s_add_u32 s65, s65, 4096
    s_waitcnt vmcnt(43)
    s_mov_b32 m0, s64
    s_add_u32 s64, s64, 1024
    buffer_load_dwordx4 v21, s[56:59], s65 offen nt lds
    s_add_u32 s65, s65, 4096
    s_waitcnt vmcnt(43)
    s_mov_b32 m0, s64
    s_add_u32 s64, s64, 1024
    buffer_load_dwordx4 v21, s[56:59], s65 offen nt lds
    s_add_u32 s65, s65, 4096
    s_waitcnt vmcnt(43)
    s_mov_b32 m0, s64
    s_add_u32 s64, s64, 1024
    buffer_load_dwordx4 v21, s[56:59], s65 offen nt lds
    s_add_u32 s65, s65, 4096
    s_waitcnt vmcnt(43)
    s_mov_b32 m0, s64
    s_add_u32 s64, s64, 1024
    buffer_load_dwordx4 v22, s[56:59], s65 offen nt lds
    s_add_u32 s65, s65, 4096
    s_waitcnt vmcnt(43)
    s_mov_b32 m0, s64
    s_add_u32 s64, s64, 1024
    buffer_load_dwordx4 v22, s[56:59], s65 offen nt lds
    s_add_u32 s65, s65, 4096
    s_waitcnt vmcnt(43)
    s_mov_b32 m0, s64
    s_add_u32 s64, s64, 1024
    buffer_load_dwordx4 v22, s[56:59], s65 offen nt lds
    s_add_u32 s65, s65, 4096
    s_waitcnt vmcnt(43)
    s_sub_u32 s7, s60, 32
    v_mov_b32 v19, s7
    ds_max_i32 v16, v19
    s_mov_b32 m0, s64
    s_add_u32 s64, s64, 1024
    buffer_load_dwordx4 v22, s[56:59], s65 offen nt lds
    s_add_u32 s65, s65, 4096
    s_waitcnt vmcnt(43)
    s_mov_b32 m0, s64
    s_add_u32 s64, s64, 1024
    buffer_load_dwordx4 v23, s[56:59], s65 offen nt lds
    s_add_u32 s65, s65, 4096
    s_waitcnt vmcnt(43)
    s_mov_b32 m0, s64
    s_add_u32 s64, s64, 1024
    buffer_load_dwordx4 v23, s[56:59], s65 offen nt lds
    s_add_u32 s65, s65, 4096
    s_waitcnt vmcnt(43)
    s_mov_b32 m0, s64
    s_add_u32 s64, s64, 1024
    buffer_load_dwordx4 v23, s[56:59], s65 offen nt lds
    s_add_u32 s65, s65, 4096
    s_waitcnt vmcnt(43)
    s_mov_b32 m0, s64
    s_add_u32 s64, s64, 1024
    buffer_load_dwordx4 v23, s[56:59], s65 offen nt lds
    s_add_u32 s65, s65, 4096
    s_add_u32 s60, s60, 16
    s_sub_u32 s66, s66, 1
    s_cmp_lg_u32 s66, 0
    s_cbranch_scc1 LL_40
KE_37:
    s_waitcnt vmcnt(40)
    s_sub_u32 s7, s60, 40
    v_mov_b32 v19, s7
    ds_max_i32 v16, v19
    s_waitcnt vmcnt(32)
    s_sub_u32 s7, s60, 32
    v_mov_b32 v19, s7
    ds_max_i32 v16, v19
    s_waitcnt vmcnt(24)
    s_sub_u32 s7, s60, 24
    v_mov_b32 v19, s7
    ds_max_i32 v16, v19
    s_waitcnt vmcnt(16)
    s_sub_u32 s7, s60, 16
    v_mov_b32 v19, s7
    ds_max_i32 v16, v19
    s_waitcnt vmcnt(8)
    s_sub_u32 s7, s60, 8
    v_mov_b32 v19, s7
    ds_max_i32 v16, v19
    s_waitcnt vmcnt(0)
    v_mov_b32 v19, s60
    ds_max_i32 v16, v19
    s_endpgm
L_LDE:
    s_setprio 3
    v_xor_b32 v6, v3, v2
    v_lshlrev_b32 v6, 4, v6
    v_lshl_add_u32 v6, v2, 13, v6
    v_xor_b32 v7, 0x40, v6
    v_xor_b32 v8, 0x80, v6
    v_xor_b32 v9, 0xc0, v6
    s_lshl_b32 s65, s5, 21
    s_lshl_b32 s7, s4, 8
    s_add_u32 s65, s65, s7
    s_sub_u32 s65, s65, 0x800000
    s_mov_b32 s64, 0x10000
    s_waitcnt lgkmcnt(0)
    s_mov_b32 s52, s24
    s_and_b32 s53, s25, 0xffff
    s_mov_b32 s54, 0x400000
    s_mov_b32 s55, 0x20000
    s_mov_b32 m0, s64
    s_add_u32 s64, s64, 1024
    buffer_load_dwordx4 v6, s[52:55], s65 offen nt lds
    s_add_u32 s65, s65, 32768
    s_mov_b32 m0, s64
    s_add_u32 s64, s64, 1024
    buffer_load_dwordx4 v7, s[52:55], s65 offen nt lds
    s_add_u32 s65, s65, 32768
    s_mov_b32 m0, s64
    s_add_u32 s64, s64, 1024
    buffer_load_dwordx4 v8, s[52:55], s65 offen nt lds
    s_add_u32 s65, s65, 32768
    s_mov_b32 m0, s64
    s_add_u32 s64, s64, 1024
    buffer_load_dwordx4 v9, s[52:55], s65 offen nt lds
    s_add_u32 s65, s65, 32768
    s_mov_b32 m0, s64
    s_add_u32 s64, s64, 1024
    buffer_load_dwordx4 v6, s[52:55], s65 offen nt lds
    s_add_u32 s65, s65, 32768
    s_mov_b32 m0, s64
    s_add_u32 s64, s64, 1024
    buffer_load_dwordx4 v7, s[52:55], s65 offen nt lds
    s_add_u32 s65, s65, 32768
    s_mov_b32 m0, s64
    s_add_u32 s64, s64, 1024
    buffer_load_dwordx4 v8, s[52:55], s65 offen nt lds
    s_add_u32 s65, s65, 32768
    s_mov_b32 m0, s64
    s_add_u32 s64, s64, 1024
    buffer_load_dwordx4 v9, s[52:55], s65 offen nt lds
    s_add_u32 s65, s65, 32768
    s_mov_b32 m0, s64
    s_add_u32 s64, s64, 1024
    buffer_load_dwordx4 v6, s[52:55], s65 offen nt lds
    s_add_u32 s65, s65, 32768
    s_mov_b32 m0, s64
    s_add_u32 s64, s64, 1024
    buffer_load_dwordx4 v7, s[52:55], s65 offen nt lds
    s_add_u32 s65, s65, 32768
    s_mov_b32 m0, s64
    s_add_u32 s64, s64, 1024
    buffer_load_dwordx4 v8, s[52:55], s65 offen nt lds
    s_add_u32 s65, s65, 32768
    s_mov_b32 m0, s64
    s_add_u32 s64, s64, 1024
    buffer_load_dwordx4 v9, s[52:55], s65 offen nt lds
    s_add_u32 s65, s65, 32768
    s_mov_b32 m0, s64
    s_add_u32 s64, s64, 1024
    buffer_load_dwordx4 v6, s[52:55], s65 offen nt lds
    s_add_u32 s65, s65, 32768
    s_mov_b32 m0, s64
    s_add_u32 s64, s64, 1024
    buffer_load_dwordx4 v7, s[52:55], s65 offen nt lds
    s_add_u32 s65, s65, 32768
    s_mov_b32 m0, s64
    s_add_u32 s64, s64, 1024
    buffer_load_dwordx4 v8, s[52:55], s65 offen nt lds
    s_add_u32 s65, s65, 32768
    s_mov_b32 m0, s64
    s_add_u32 s64, s64, 1024
    buffer_load_dwordx4 v9, s[52:55], s65 offen nt lds
    s_add_u32 s65, s65, 32768
    s_mov_b32 m0, s64
    s_add_u32 s64, s64, 1024
    buffer_load_dwordx4 v6, s[52:55], s65 offen nt lds
    s_add_u32 s65, s65, 32768
    s_mov_b32 m0, s64
    s_add_u32 s64, s64, 1024
    buffer_load_dwordx4 v7, s[52:55], s65 offen nt lds
    s_add_u32 s65, s65, 32768
    s_mov_b32 m0, s64
    s_add_u32 s64, s64, 1024
    buffer_load_dwordx4 v8, s[52:55], s65 offen nt lds
    s_add_u32 s65, s65, 32768
    s_mov_b32 m0, s64
    s_add_u32 s64, s64, 1024
    buffer_load_dwordx4 v9, s[52:55], s65 offen nt lds
    s_add_u32 s65, s65, 32768
    s_mov_b32 m0, s64
    s_add_u32 s64, s64, 1024
    buffer_load_dwordx4 v6, s[52:55], s65 offen nt lds
    s_add_u32 s65, s65, 32768
    s_mov_b32 m0, s64
    s_add_u32 s64, s64, 1024
    buffer_load_dwordx4 v7, s[52:55], s65 offen nt lds
    s_add_u32 s65, s65, 32768
    s_mov_b32 m0, s64
    s_add_u32 s64, s64, 1024
    buffer_load_dwordx4 v8, s[52:55], s65 offen nt lds
    s_add_u32 s65, s65, 32768
    s_mov_b32 m0, s64
    s_add_u32 s64, s64, 1024
    buffer_load_dwordx4 v9, s[52:55], s65 offen nt lds
    s_add_u32 s65, s65, 32768
    s_mov_b32 m0, s64
    s_add_u32 s64, s64, 1024
    buffer_load_dwordx4 v6, s[52:55], s65 offen nt lds
    s_add_u32 s65, s65, 32768
    s_mov_b32 m0, s64
    s_add_u32 s64, s64, 1024
    buffer_load_dwordx4 v7, s[52:55], s65 offen nt lds
    s_add_u32 s65, s65, 32768
    s_mov_b32 m0, s64
    s_add_u32 s64, s64, 1024
    buffer_load_dwordx4 v8, s[52:55], s65 offen nt lds
    s_add_u32 s65, s65, 32768
    s_mov_b32 m0, s64
    s_add_u32 s64, s64, 1024
    buffer_load_dwordx4 v9, s[52:55], s65 offen nt lds
    s_add_u32 s65, s65, 32768
    s_mov_b32 m0, s64
    s_add_u32 s64, s64, 1024
    buffer_load_dwordx4 v6, s[52:55], s65 offen nt lds
    s_add_u32 s65, s65, 32768
    s_mov_b32 m0, s64
    s_add_u32 s64, s64, 1024
    buffer_load_dwordx4 v7, s[52:55], s65 offen nt lds
    s_add_u32 s65, s65, 32768
    s_mov_b32 m0, s64
    s_add_u32 s64, s64, 1024
    buffer_load_dwordx4 v8, s[52:55], s65 offen nt lds
    s_add_u32 s65, s65, 32768
    s_mov_b32 m0, s64
    s_add_u32 s64, s64, 1024
    buffer_load_dwordx4 v9, s[52:55], s65 offen nt lds
    s_add_u32 s65, s65, 32768
    s_barrier
    s_mov_b32 s63, 0
    v_lshlrev_b32 v16, 2, v1
    v_add_u32 v17, 0x24100, v16
    v_add_u32 v16, 0x24000, v16
    v_mov_b32 v18, 0
    s_mov_b32 s60, 32
    s_mov_b32 s36, s34
    s_and_b32 s37, s35, 0xffff
    s_mov_b32 s38, 0x1000000
    s_mov_b32 s39, 0x20000
    s_mov_b32 s56, s26
    s_and_b32 s57, s27, 0xffff
    s_mov_b32 s58, 0x400000
    s_mov_b32 s59, 0x20000
    s_mov_b32 s44, s10
    s_and_b32 s45, s11, 0xffff
    s_mov_b32 s46, 0x8000000
    s_mov_b32 s47, 0x20000
    s_mov_b32 s48, s12
    s_and_b32 s49, s13, 0xffff
    s_mov_b32 s50, 0x8000000
    s_mov_b32 s51, 0x20000
    v_bfe_u32 v20, v1, 1, 2
    v_xor_b32 v20, v20, v2
    v_lshlrev_b32 v20, 5, v20
    v_lshrrev_b32 v40, 3, v1
    v_lshl_add_u32 v20, v40, 13, v20
    v_and_b32 v40, 1, v1
    v_lshl_add_u32 v20, v40, 4, v20
    v_mov_b32 v21, 0
    v_mov_b32 v22, 0
    v_mov_b32 v23, 0
    s_mov_b32 s67, 0
    s_mov_b32 s96, 0x6010600
    s_mov_b32 s97, 0x6030602
    s_cmp_eq_u32 s5, 1
    s_cselect_b32 s96, 0x6190618, s96
    s_cselect_b32 s97, 0x61b061a, s97
    s_cmp_eq_u32 s5, 2
    s_cselect_b32 s96, 0x6310630, s96
    s_cselect_b32 s97, 0x6330632, s97
    s_cmp_eq_u32 s5, 3
    s_cselect_b32 s96, 0x6490648, s96
    s_cselect_b32 s97, 0x64b064a, s97
    s_cmp_eq_u32 s5, 4
    s_cselect_b32 s96, 0x4610460, s96
    s_cselect_b32 s97, 0x4630462, s97
    s_cmp_eq_u32 s5, 5
    s_cselect_b32 s96, 0x4710470, s96
    s_cselect_b32 s97, 0x4730472, s97
    v_xor_b32 v10, v3, v2
    v_lshlrev_b32 v10, 4, v10
    v_lshl_add_u32 v10, v2, 8, v10
    v_xor_b32 v11, 0x40, v10
    v_xor_b32 v12, 0x80, v10
    v_xor_b32 v13, 0xc0, v10
    v_lshrrev_b32 v14, 1, v3
    v_xor_b32 v14, v14, v2
    v_lshlrev_b32 v14, 5, v14
    v_lshl_add_u32 v14, v2, 8, v14
    v_and_b32 v40, 1, v1
    v_lshl_add_u32 v14, v40, 4, v14
    v_xor_b32 v15, 0x80, v14
    v_add_u32 v24, 4096, v10
    v_add_u32 v25, 4096, v11
    v_add_u32 v26, 4096, v12
    v_add_u32 v27, 4096, v13
    v_add_u32 v28, 4096, v14
    v_add_u32 v29, 4096, v15
    s_mov_b32 s76, 0
    s_lshl_b32 s7, s76, 4
    s_lshr_b64 s[90:91], s[96:97], s7
    s_and_b32 s68, s90, 3
    s_bfe_u32 s72, s90, 0x50002
    s_lshl_b32 s68, s68, 5
    s_add_u32 s68, s68, s4
    s_lshl_b32 s68, s68, 20
    s_lshl_b32 s72, s72, 13
    s_add_u32 s72, s72, s68
    s_add_u32 s72, s72, 0xC0000
    s_mov_b32 s68, s72
    s_mov_b32 s76, 1
    s_lshl_b32 s7, s76, 4
    s_lshr_b64 s[90:91], s[96:97], s7
    s_and_b32 s69, s90, 3
    s_bfe_u32 s73, s90, 0x50002
    s_lshl_b32 s69, s69, 5
    s_add_u32 s69, s69, s4
    s_lshl_b32 s69, s69, 20
    s_lshl_b32 s73, s73, 13
    s_add_u32 s73, s73, s69
    s_add_u32 s73, s73, 0xC0000
    s_mov_b32 s69, s73
    s_mov_b32 s76, 2
    s_lshl_b32 s7, s76, 4
    s_lshr_b64 s[90:91], s[96:97], s7
    s_and_b32 s70, s90, 3
    s_bfe_u32 s74, s90, 0x50002
    s_lshl_b32 s70, s70, 5
    s_add_u32 s70, s70, s4
    s_lshl_b32 s70, s70, 20
    s_lshl_b32 s74, s74, 13
    s_add_u32 s74, s74, s70
    s_add_u32 s74, s74, 0xC0000
    s_mov_b32 s70, s74
    s_mov_b32 s76, 3
    s_lshl_b32 s7, s76, 4
    s_lshr_b64 s[90:91], s[96:97], s7
    s_and_b32 s71, s90, 3
    s_bfe_u32 s75, s90, 0x50002
    s_lshl_b32 s71, s71, 5
    s_add_u32 s71, s71, s4
    s_lshl_b32 s71, s71, 20
    s_lshl_b32 s75, s75, 13
    s_add_u32 s75, s75, s71
    s_add_u32 s75, s75, 0xC0000
    s_mov_b32 s71, s75
    s_mov_b32 s66, 4
LL_41:
    s_waitcnt vmcnt(39)
    s_mov_b32 m0, s64
    s_add_u32 s64, s64, 1024
    buffer_load_dwordx4 v6, s[52:55], s65 offen nt lds
    s_add_u32 s65, s65, 32768
    s_waitcnt vmcnt(39)
    s_mov_b32 m0, s64
    s_add_u32 s64, s64, 1024
    buffer_load_dwordx4 v7, s[52:55], s65 offen nt lds
    s_add_u32 s65, s65, 32768
    s_waitcnt vmcnt(39)
    s_mov_b32 m0, s64
    s_add_u32 s64, s64, 1024
    buffer_load_dwordx4 v8, s[52:55], s65 offen nt lds
    s_add_u32 s65, s65, 32768
    s_waitcnt vmcnt(39)
    s_mov_b32 m0, s64
    s_add_u32 s64, s64, 1024
    buffer_load_dwordx4 v9, s[52:55], s65 offen nt lds
    s_add_u32 s65, s65, 32768
    s_waitcnt vmcnt(39)
    s_mov_b32 m0, s64
    s_add_u32 s64, s64, 1024
    buffer_load_dwordx4 v6, s[52:55], s65 offen nt lds
    s_add_u32 s65, s65, 32768
    s_waitcnt vmcnt(39)
    s_mov_b32 m0, s64
    s_add_u32 s64, s64, 1024
    buffer_load_dwordx4 v7, s[52:55], s65 offen nt lds
    s_add_u32 s65, s65, 32768
    s_waitcnt vmcnt(39)
    s_mov_b32 m0, s64
    s_add_u32 s64, s64, 1024
    buffer_load_dwordx4 v8, s[52:55], s65 offen nt lds
    s_add_u32 s65, s65, 32768
    s_waitcnt vmcnt(39)
    s_sub_u32 s7, s60, 32
    v_mov_b32 v19, s7
    ds_max_i32 v16, v19
    s_mov_b32 m0, s64
    s_add_u32 s64, s64, 1024
    buffer_load_dwordx4 v9, s[52:55], s65 offen nt lds
    s_add_u32 s65, s65, 32768
    s_add_u32 s60, s60, 8
    s_sub_u32 s66, s66, 1
    s_cmp_lg_u32 s66, 0
    s_cbranch_scc1 LL_41
    s_waitcnt vmcnt(32)
    s_sub_u32 s7, s60, 32
    v_mov_b32 v19, s7
    ds_max_i32 v16, v19
    s_waitcnt vmcnt(24)
    s_sub_u32 s7, s60, 24
    v_mov_b32 v19, s7
    ds_max_i32 v16, v19
    s_waitcnt vmcnt(16)
    s_sub_u32 s7, s60, 16
    v_mov_b32 v19, s7
    ds_max_i32 v16, v19
    s_waitcnt vmcnt(8)
    s_sub_u32 s7, s60, 8
    v_mov_b32 v19, s7
    ds_max_i32 v16, v19
    s_waitcnt vmcnt(0)
    v_mov_b32 v19, s60
    ds_max_i32 v16, v19
    v_mov_b32 v40, 0x24208
    s_mov_b32 s80, 1600000
LW_42:
    ds_read_b32 v41, v40
    s_waitcnt lgkmcnt(0)
    v_readfirstlane_b32 s79, v41
    s_cmp_ge_u32 s79, 148
    s_cbranch_scc1 LWD_43
    s_sub_u32 s80, s80, 1
    s_cmp_lg_u32 s80, 0
    s_cbranch_scc1 LW_42
LWD_43:
    s_lshl_b32 s65, s4, 8
    s_lshl_b32 s7, s5, 7
    s_add_u32 s65, s65, s7
    s_sub_u32 s65, s65, 512
    s_mov_b32 s64, 0
    s_mov_b32 s66, 8
LL_44:
    s_waitcnt vmcnt(23)
    s_mov_b32 m0, s64
    s_add_u32 s64, s64, 1024
    buffer_load_dwordx4 v20, s[56:59], s65 offen nt lds
    s_add_u32 s65, s65, 65536
    s_waitcnt vmcnt(23)
    s_mov_b32 m0, s64
    s_add_u32 s64, s64, 1024
    buffer_load_dwordx4 v20, s[56:59], s65 offen nt lds
    s_add_u32 s65, s65, 65536
    s_waitcnt vmcnt(23)
    s_mov_b32 m0, s64
    s_add_u32 s64, s64, 1024
    buffer_load_dwordx4 v20, s[56:59], s65 offen nt lds
    s_add_u32 s65, s65, 65536
    s_waitcnt vmcnt(23)
    s_mov_b32 m0, s64
    s_add_u32 s64, s64, 1024
    buffer_load_dwordx4 v20, s[56:59], s65 offen nt lds
    s_add_u32 s65, s65, 65536
    s_waitcnt vmcnt(23)
    s_mov_b32 m0, s64
    s_add_u32 s64, s64, 1024
    buffer_load_dwordx4 v20, s[56:59], s65 offen nt lds
    s_add_u32 s65, s65, 65536
    s_waitcnt vmcnt(23)
    s_mov_b32 m0, s64
    s_add_u32 s64, s64, 1024
    buffer_load_dwordx4 v20, s[56:59], s65 offen nt lds
    s_add_u32 s65, s65, 65536
    ds_read_b32 v18, v17
    s_waitcnt vmcnt(23)
    s_mov_b32 m0, s64
    s_add_u32 s64, s64, 1024
    buffer_load_dwordx4 v20, s[56:59], s65 offen nt lds
    s_add_u32 s65, s65, 65536
    s_waitcnt vmcnt(23)
    s_sub_u32 s7, s60, 16
    v_mov_b32 v19, s7
    ds_max_i32 v16, v19
    s_mov_b32 m0, s64
    s_add_u32 s64, s64, 1024
    buffer_load_dwordx4 v20, s[56:59], s65 offen nt lds
    s_add_u32 s65, s65, 65536
    s_add_u32 s60, s60, 8
    s_sub_u32 s66, s66, 1
    s_cmp_lg_u32 s66, 0
    s_cbranch_scc1 LL_44
    s_mov_b32 s62, 2
    s_mov_b32 s63, 4
    v_mov_b32 v40, 0x24204
    s_mov_b32 s80, 1600000
LW_45:
    ds_read_b32 v41, v40
    s_waitcnt lgkmcnt(0)
    v_readfirstlane_b32 s79, v41
    s_cmp_ge_u32 s79, 1
    s_cbranch_scc1 LWD_46
    s_sleep 1
    s_sub_u32 s80, s80, 1
    s_cmp_lg_u32 s80, 0
    s_cbranch_scc1 LW_45
LWD_46:
    v_mov_b32 v40, 0x24248
    ds_read_b64 v[42:43], v40
    s_waitcnt lgkmcnt(0)
    v_readfirstlane_b32 s92, v42
    v_readfirstlane_b32 s93, v43
    s_add_u32 s77, s92, 18240
    s_mov_b32 s61, 1984
    s_mov_b32 s86, 1728
    s_mov_b32 s66, 4
    s_mov_b32 s87, 4
    s_memrealtime s[84:85]
    s_branch L_KV
L_LDB:
    s_setprio 3
    v_lshlrev_b32 v20, 4, v1
    v_xor_b32 v21, 0x40, v20
    v_xor_b32 v22, 0x80, v20
    v_xor_b32 v23, 0xc0, v20
    v_xor_b32 v24, 0x10, v20
    v_xor_b32 v25, 0x50, v20
    v_xor_b32 v26, 0x90, v20
    v_xor_b32 v27, 0xd0, v20
    v_xor_b32 v28, 0x20, v20
    v_xor_b32 v29, 0x60, v20
    v_xor_b32 v30, 0xa0, v20
    v_xor_b32 v31, 0xe0, v20
    v_xor_b32 v32, 0x30, v20
    v_xor_b32 v33, 0x70, v20
    v_xor_b32 v34, 0xb0, v20
    v_xor_b32 v35, 0xf0, v20
    s_and_b32 s69, s4, 7
    s_lshl_b32 s69, s69, 3
    s_lshr_b32 s7, s4, 3
    s_lshl_b32 s7, s7, 1
    s_add_u32 s69, s69, s7
    s_add_u32 s69, s69, s5
    s_sub_u32 s69, s69, 6
    s_lshl_b32 s68, s69, 18
    s_mov_b32 s64, 0
    s_waitcnt lgkmcnt(0)
    s_mov_b32 s44, s20
    s_and_b32 s45, s21, 0xffff
    s_mov_b32 s46, 0x1000000
    s_mov_b32 s47, 0x20000
    s_add_u32 s7, s64, 0
    s_mov_b32 m0, s7
    s_add_u32 s65, s68, 0
    buffer_load_dwordx4 v20, s[44:47], s65 offen offset:0 nt lds
    buffer_load_dwordx4 v21, s[44:47], s65 offen offset:1024 nt lds
    buffer_load_dwordx4 v22, s[44:47], s65 offen offset:2048 nt lds
    buffer_load_dwordx4 v23, s[44:47], s65 offen offset:3072 nt lds
    s_add_u32 s7, s64, 4096
    s_mov_b32 m0, s7
    s_add_u32 s65, s68, 4096
    buffer_load_dwordx4 v24, s[44:47], s65 offen offset:0 nt lds
    buffer_load_dwordx4 v25, s[44:47], s65 offen offset:1024 nt lds
    buffer_load_dwordx4 v26, s[44:47], s65 offen offset:2048 nt lds
    buffer_load_dwordx4 v27, s[44:47], s65 offen offset:3072 nt lds
    s_add_u32 s7, s64, 8192
    s_mov_b32 m0, s7
    s_add_u32 s65, s68, 8192
    buffer_load_dwordx4 v28, s[44:47], s65 offen offset:0 nt lds
    buffer_load_dwordx4 v29, s[44:47], s65 offen offset:1024 nt lds
    buffer_load_dwordx4 v30, s[44:47], s65 offen offset:2048 nt lds
    buffer_load_dwordx4 v31, s[44:47], s65 offen offset:3072 nt lds
    s_add_u32 s7, s64, 12288
    s_mov_b32 m0, s7
    s_add_u32 s65, s68, 12288
    buffer_load_dwordx4 v32, s[44:47], s65 offen offset:0 nt lds
    buffer_load_dwordx4 v33, s[44:47], s65 offen offset:1024 nt lds
    buffer_load_dwordx4 v34, s[44:47], s65 offen offset:2048 nt lds
    buffer_load_dwordx4 v35, s[44:47], s65 offen offset:3072 nt lds
    s_barrier
    s_mov_b32 s63, 0
    v_lshlrev_b32 v16, 2, v1
    v_add_u32 v17, 0x24100, v16
    v_add_u32 v16, 0x24000, v16
    v_mov_b32 v18, 0
    s_mov_b32 s60, 16
    s_mov_b32 s36, s34
    s_and_b32 s37, s35, 0xffff
    s_mov_b32 s38, 0x1000000
    s_mov_b32 s39, 0x20000
    s_add_u32 s68, s68, 16384
    s_mov_b32 s64, 16384
    s_mov_b32 s48, s28
    s_and_b32 s49, s29, 0xffff
    s_mov_b32 s50, 0x400000
    s_mov_b32 s51, 0x20000
    v_bfe_u32 v10, v1, 1, 2
    v_xor_b32 v10, v10, v2
    v_lshlrev_b32 v10, 5, v10
    v_lshrrev_b32 v40, 3, v1
    v_lshl_add_u32 v10, v40, 10, v10
    v_and_b32 v40, 1, v1
    v_lshl_add_u32 v10, v40, 4, v10
    s_mov_b32 s72, 0x22559911
    s_mov_b32 s73, 0x2
    s_mov_b32 s74, 0x54873210
    s_mov_b32 s75, 0x6
    s_mov_b32 s66, 6
LL_47:
    s_waitcnt vmcnt(27)
    s_add_u32 s7, s64, 0
    s_mov_b32 m0, s7
    s_add_u32 s65, s68, 0
    buffer_load_dwordx4 v20, s[44:47], s65 offen offset:0 nt lds
    s_waitcnt vmcnt(27)
    buffer_load_dwordx4 v21, s[44:47], s65 offen offset:1024 nt lds
    s_waitcnt vmcnt(27)
    buffer_load_dwordx4 v22, s[44:47], s65 offen offset:2048 nt lds
    s_waitcnt vmcnt(27)
    s_sub_u32 s7, s60, 24
    v_mov_b32 v19, s7
    ds_max_i32 v16, v19
    buffer_load_dwordx4 v23, s[44:47], s65 offen offset:3072 nt lds
    s_waitcnt vmcnt(27)
    s_add_u32 s7, s64, 4096
    s_mov_b32 m0, s7
    s_add_u32 s65, s68, 4096
    buffer_load_dwordx4 v24, s[44:47], s65 offen offset:0 nt lds
    s_waitcnt vmcnt(27)
    buffer_load_dwordx4 v25, s[44:47], s65 offen offset:1024 nt lds
    s_waitcnt vmcnt(27)
    buffer_load_dwordx4 v26, s[44:47], s65 offen offset:2048 nt lds
    s_waitcnt vmcnt(27)
    buffer_load_dwordx4 v27, s[44:47], s65 offen offset:3072 nt lds
    s_waitcnt vmcnt(27)
    s_add_u32 s7, s64, 8192
    s_mov_b32 m0, s7
    s_add_u32 s65, s68, 8192
    buffer_load_dwordx4 v28, s[44:47], s65 offen offset:0 nt lds
    s_waitcnt vmcnt(27)
    buffer_load_dwordx4 v29, s[44:47], s65 offen offset:1024 nt lds
    s_waitcnt vmcnt(27)
    buffer_load_dwordx4 v30, s[44:47], s65 offen offset:2048 nt lds
    s_waitcnt vmcnt(27)
    s_sub_u32 s7, s60, 16
    v_mov_b32 v19, s7
    ds_max_i32 v16, v19
    buffer_load_dwordx4 v31, s[44:47], s65 offen offset:3072 nt lds
    s_waitcnt vmcnt(27)
    s_add_u32 s7, s64, 12288
    s_mov_b32 m0, s7
    s_add_u32 s65, s68, 12288
    buffer_load_dwordx4 v32, s[44:47], s65 offen offset:0 nt lds
    s_waitcnt vmcnt(27)
    buffer_load_dwordx4 v33, s[44:47], s65 offen offset:1024 nt lds
    s_waitcnt vmcnt(27)
    buffer_load_dwordx4 v34, s[44:47], s65 offen offset:2048 nt lds
    s_waitcnt vmcnt(27)
    buffer_load_dwordx4 v35, s[44:47], s65 offen offset:3072 nt lds
    s_add_u32 s60, s60, 16
    s_add_u32 s68, s68, 16384
    s_add_u32 s64, s64, 16384
    s_sub_u32 s66, s66, 1
    s_cmp_lg_u32 s66, 0
    s_cbranch_scc1 LL_47
    s_mov_b32 s66, 2
LL_48:
    s_and_b32 s63, s72, 3
    s_lshl_b32 s63, s63, 3
    s_bfe_u32 s62, s72, 0x20002
    s_lshr_b64 s[72:73], s[72:73], 4
    s_and_b32 s64, s74, 15
    s_lshl_b32 s64, s64, 14
    s_lshr_b64 s[74:75], s[74:75], 4
    s_waitcnt lgkmcnt(0)
    v_readlane_b32 s79, v18, s62
    s_cmp_lt_u32 s79, s63
    s_cbranch_scc1 ST_50
GO_49:
    s_waitcnt vmcnt(19)
    s_add_u32 s7, s64, 0
    s_mov_b32 m0, s7
    s_add_u32 s65, s68, 0
    buffer_load_dwordx4 v20, s[44:47], s65 offen offset:0 nt lds
    s_waitcnt vmcnt(19)
    buffer_load_dwordx4 v21, s[44:47], s65 offen offset:1024 nt lds
    s_waitcnt vmcnt(19)
    buffer_load_dwordx4 v22, s[44:47], s65 offen offset:2048 nt lds
    s_waitcnt vmcnt(19)
    s_sub_u32 s7, s60, 16
    v_mov_b32 v19, s7
    ds_max_i32 v16, v19
    buffer_load_dwordx4 v23, s[44:47], s65 offen offset:3072 nt lds
    s_waitcnt vmcnt(19)
    s_add_u32 s7, s64, 4096
    s_mov_b32 m0, s7
    s_add_u32 s65, s68, 4096
    buffer_load_dwordx4 v24, s[44:47], s65 offen offset:0 nt lds
    s_waitcnt vmcnt(19)
    buffer_load_dwordx4 v25, s[44:47], s65 offen offset:1024 nt lds
    s_waitcnt vmcnt(19)
    buffer_load_dwordx4 v26, s[44:47], s65 offen offset:2048 nt lds
    s_waitcnt vmcnt(19)
    buffer_load_dwordx4 v27, s[44:47], s65 offen offset:3072 nt lds
    s_waitcnt vmcnt(19)
    s_add_u32 s7, s64, 8192
    s_mov_b32 m0, s7
    s_add_u32 s65, s68, 8192
    buffer_load_dwordx4 v28, s[44:47], s65 offen offset:0 nt lds
    s_waitcnt vmcnt(19)
    buffer_load_dwordx4 v29, s[44:47], s65 offen offset:1024 nt lds
    s_waitcnt vmcnt(19)
    buffer_load_dwordx4 v30, s[44:47], s65 offen offset:2048 nt lds
    s_waitcnt vmcnt(19)
    s_sub_u32 s7, s60, 8
    v_mov_b32 v19, s7
    ds_max_i32 v16, v19
    buffer_load_dwordx4 v31, s[44:47], s65 offen offset:3072 nt lds
    s_waitcnt vmcnt(19)
    s_add_u32 s7, s64, 12288
    s_mov_b32 m0, s7
    s_add_u32 s65, s68, 12288
    buffer_load_dwordx4 v32, s[44:47], s65 offen offset:0 nt lds
    s_waitcnt vmcnt(19)
    buffer_load_dwordx4 v33, s[44:47], s65 offen offset:1024 nt lds
    ds_read_b32 v18, v17
    s_waitcnt vmcnt(19)
    buffer_load_dwordx4 v34, s[44:47], s65 offen offset:2048 nt lds
    s_waitcnt vmcnt(19)
    buffer_load_dwordx4 v35, s[44:47], s65 offen offset:3072 nt lds
    s_add_u32 s60, s60, 16
    s_add_u32 s68, s68, 16384
    s_sub_u32 s66, s66, 1
    s_cmp_lg_u32 s66, 0
    s_cbranch_scc1 LL_48
    s_mov_b32 s66, 7
LL_51:
    s_and_b32 s63, s72, 3
    s_lshl_b32 s63, s63, 3
    s_bfe_u32 s62, s72, 0x20002
    s_lshr_b64 s[72:73], s[72:73], 4
    s_and_b32 s64, s74, 15
    s_lshl_b32 s64, s64, 14
    s_lshr_b64 s[74:75], s[74:75], 4
    s_waitcnt lgkmcnt(0)
    v_readlane_b32 s79, v18, s62
    s_cmp_lt_u32 s79, s63
    s_cbranch_scc1 ST_53
GO_52:
    s_waitcnt vmcnt(31)
    s_add_u32 s7, s64, 0
    s_mov_b32 m0, s7
    s_add_u32 s65, s68, 0
    buffer_load_dwordx4 v20, s[44:47], s65 offen offset:0 nt lds
    s_waitcnt vmcnt(31)
    buffer_load_dwordx4 v21, s[44:47], s65 offen offset:1024 nt lds
    s_waitcnt vmcnt(31)
    buffer_load_dwordx4 v22, s[44:47], s65 offen offset:2048 nt lds
    s_waitcnt vmcnt(31)
    buffer_load_dwordx4 v23, s[44:47], s65 offen offset:3072 nt lds
    s_waitcnt vmcnt(31)
    s_add_u32 s7, s64, 4096
    s_mov_b32 m0, s7
    s_add_u32 s65, s68, 4096
    buffer_load_dwordx4 v24, s[44:47], s65 offen offset:0 nt lds
    s_waitcnt vmcnt(31)
    buffer_load_dwordx4 v25, s[44:47], s65 offen offset:1024 nt lds
    s_waitcnt vmcnt(31)
    buffer_load_dwordx4 v26, s[44:47], s65 offen offset:2048 nt lds
    s_waitcnt vmcnt(31)
    s_sub_u32 s7, s60, 24
    v_mov_b32 v19, s7
    ds_max_i32 v16, v19
    buffer_load_dwordx4 v27, s[44:47], s65 offen offset:3072 nt lds
    s_waitcnt vmcnt(31)
    s_add_u32 s7, s64, 8192
    s_mov_b32 m0, s7
    s_add_u32 s65, s68, 8192
    buffer_load_dwordx4 v28, s[44:47], s65 offen offset:0 nt lds
    s_waitcnt vmcnt(31)
    buffer_load_dwordx4 v29, s[44:47], s65 offen offset:1024 nt lds
    s_waitcnt vmcnt(31)
    buffer_load_dwordx4 v30, s[44:47], s65 offen offset:2048 nt lds
    s_waitcnt vmcnt(31)
    buffer_load_dwordx4 v31, s[44:47], s65 offen offset:3072 nt lds
    s_waitcnt vmcnt(31)
    s_add_u32 s7, s64, 12288
    s_mov_b32 m0, s7
    s_add_u32 s65, s68, 12288
    buffer_load_dwordx4 v32, s[44:47], s65 offen offset:0 nt lds
    s_waitcnt vmcnt(31)
    buffer_load_dwordx4 v33, s[44:47], s65 offen offset:1024 nt lds
    ds_read_b32 v18, v17
    s_waitcnt vmcnt(31)
    buffer_load_dwordx4 v34, s[44:47], s65 offen offset:2048 nt lds
    s_waitcnt vmcnt(31)
    s_sub_u32 s7, s60, 16
    v_mov_b32 v19, s7
    ds_max_i32 v16, v19
    buffer_load_dwordx4 v35, s[44:47], s65 offen offset:3072 nt lds
    s_add_u32 s60, s60, 16
    s_add_u32 s68, s68, 16384
    s_sub_u32 s66, s66, 1
    s_cmp_lg_u32 s66, 0
    s_cbranch_scc1 LL_51
    s_lshr_b32 s65, s69, 3
    s_lshl_b32 s65, s65, 17
    s_and_b32 s7, s69, 7
    s_lshl_b32 s7, s7, 7
    s_add_u32 s65, s65, s7
    s_mov_b32 s64, 0
    s_mov_b32 s63, 24
    s_waitcnt lgkmcnt(0)
    v_readlane_b32 s79, v18, 0
    s_cmp_lt_u32 s79, s63
    s_cbranch_scc1 ST_55
GO_54:
    s_mov_b32 m0, s64
    s_add_u32 s64, s64, 1024
    buffer_load_dwordx4 v10, s[48:51], s65 offen nt lds
    s_add_u32 s65, s65, 8192
    s_mov_b32 m0, s64
    s_add_u32 s64, s64, 1024
    buffer_load_dwordx4 v10, s[48:51], s65 offen nt lds
    s_add_u32 s65, s65, 8192
    s_mov_b32 m0, s64
    s_add_u32 s64, s64, 1024
    buffer_load_dwordx4 v10, s[48:51], s65 offen nt lds
    s_add_u32 s65, s65, 8192
    s_mov_b32 m0, s64
    s_add_u32 s64, s64, 1024
    buffer_load_dwordx4 v10, s[48:51], s65 offen nt lds
    s_add_u32 s65, s65, 8192
    s_mov_b32 m0, s64
    s_add_u32 s64, s64, 1024
    buffer_load_dwordx4 v10, s[48:51], s65 offen nt lds
    s_add_u32 s65, s65, 8192
    s_mov_b32 m0, s64
    s_add_u32 s64, s64, 1024
    buffer_load_dwordx4 v10, s[48:51], s65 offen nt lds
    s_add_u32 s65, s65, 8192
    s_mov_b32 m0, s64
    s_add_u32 s64, s64, 1024
    buffer_load_dwordx4 v10, s[48:51], s65 offen nt lds
    s_add_u32 s65, s65, 8192
    s_mov_b32 m0, s64
    s_add_u32 s64, s64, 1024
    buffer_load_dwordx4 v10, s[48:51], s65 offen nt lds
    s_add_u32 s65, s65, 8192
    s_mov_b32 m0, s64
    s_add_u32 s64, s64, 1024
    buffer_load_dwordx4 v10, s[48:51], s65 offen nt lds
    s_add_u32 s65, s65, 8192
    s_mov_b32 m0, s64
    s_add_u32 s64, s64, 1024
    buffer_load_dwordx4 v10, s[48:51], s65 offen nt lds
    s_add_u32 s65, s65, 8192
    s_mov_b32 m0, s64
    s_add_u32 s64, s64, 1024
    buffer_load_dwordx4 v10, s[48:51], s65 offen nt lds
    s_add_u32 s65, s65, 8192
    s_mov_b32 m0, s64
    s_add_u32 s64, s64, 1024
    buffer_load_dwordx4 v10, s[48:51], s65 offen nt lds
    s_add_u32 s65, s65, 8192
    s_mov_b32 m0, s64
    s_add_u32 s64, s64, 1024
    buffer_load_dwordx4 v10, s[48:51], s65 offen nt lds
    s_add_u32 s65, s65, 8192
    s_mov_b32 m0, s64
    s_add_u32 s64, s64, 1024
    buffer_load_dwordx4 v10, s[48:51], s65 offen nt lds
    s_add_u32 s65, s65, 8192
    s_mov_b32 m0, s64
    s_add_u32 s64, s64, 1024
    buffer_load_dwordx4 v10, s[48:51], s65 offen nt lds
    s_add_u32 s65, s65, 8192
    s_mov_b32 m0, s64
    s_add_u32 s64, s64, 1024
    buffer_load_dwordx4 v10, s[48:51], s65 offen nt lds
    s_add_u32 s65, s65, 8192
    s_add_u32 s65, s65, 917504
    s_waitcnt vmcnt(40)
    s_sub_u32 s7, s60, 24
    v_mov_b32 v19, s7
    ds_max_i32 v16, v19
    s_waitcnt vmcnt(32)
    s_sub_u32 s7, s60, 16
    v_mov_b32 v19, s7
    ds_max_i32 v16, v19
    s_waitcnt vmcnt(24)
    s_sub_u32 s7, s60, 8
    v_mov_b32 v19, s7
    ds_max_i32 v16, v19
    s_waitcnt vmcnt(16)
    v_mov_b32 v19, s60
    ds_max_i32 v16, v19
    s_add_u32 s60, s60, 16
    s_waitcnt vmcnt(24)
    s_sub_u32 s7, s60, 24
    v_mov_b32 v19, s7
    ds_max_i32 v16, v19
    s_waitcnt vmcnt(16)
    s_sub_u32 s7, s60, 16
    v_mov_b32 v19, s7
    ds_max_i32 v16, v19
    s_waitcnt vmcnt(8)
    s_sub_u32 s7, s60, 8
    v_mov_b32 v19, s7
    ds_max_i32 v16, v19
    s_waitcnt vmcnt(0)
    v_mov_b32 v19, s60
    ds_max_i32 v16, v19
    v_mov_b32 v48, 0x24218
    s_mov_b32 s80, 1600000
LW_56:
    ds_read_b32 v49, v48
    s_waitcnt lgkmcnt(0)
    v_readfirstlane_b32 s79, v49
    s_cmp_ge_u32 s79, 16
    s_cbranch_scc1 LWD_57
    s_sleep 1
    s_sub_u32 s80, s80, 1
    s_cmp_lg_u32 s80, 0
    s_cbranch_scc1 LW_56
LWD_57:
    s_mov_b32 s66, 3
LL_58:
    s_waitcnt vmcnt(31)
    s_mov_b32 m0, s64
    s_add_u32 s64, s64, 1024
    buffer_load_dwordx4 v10, s[48:51], s65 offen nt lds
    s_add_u32 s65, s65, 8192
    s_waitcnt vmcnt(31)
    s_mov_b32 m0, s64
    s_add_u32 s64, s64, 1024
    buffer_load_dwordx4 v10, s[48:51], s65 offen nt lds
    s_add_u32 s65, s65, 8192
    s_waitcnt vmcnt(31)
    s_mov_b32 m0, s64
    s_add_u32 s64, s64, 1024
    buffer_load_dwordx4 v10, s[48:51], s65 offen nt lds
    s_add_u32 s65, s65, 8192
    s_waitcnt vmcnt(31)
    s_mov_b32 m0, s64
    s_add_u32 s64, s64, 1024
    buffer_load_dwordx4 v10, s[48:51], s65 offen nt lds
    s_add_u32 s65, s65, 8192
    s_waitcnt vmcnt(31)
    s_mov_b32 m0, s64
    s_add_u32 s64, s64, 1024
    buffer_load_dwordx4 v10, s[48:51], s65 offen nt lds
    s_add_u32 s65, s65, 8192
    s_waitcnt vmcnt(31)
    s_mov_b32 m0, s64
    s_add_u32 s64, s64, 1024
    buffer_load_dwordx4 v10, s[48:51], s65 offen nt lds
    s_add_u32 s65, s65, 8192
    s_waitcnt vmcnt(31)
    s_mov_b32 m0, s64
    s_add_u32 s64, s64, 1024
    buffer_load_dwordx4 v10, s[48:51], s65 offen nt lds
    s_add_u32 s65, s65, 8192
    s_waitcnt vmcnt(31)
    s_sub_u32 s7, s60, 24
    v_mov_b32 v19, s7
    ds_max_i32 v16, v19
    s_mov_b32 m0, s64
    s_add_u32 s64, s64, 1024
    buffer_load_dwordx4 v10, s[48:51], s65 offen nt lds
    s_add_u32 s65, s65, 8192
    s_waitcnt vmcnt(31)
    s_mov_b32 m0, s64
    s_add_u32 s64, s64, 1024
    buffer_load_dwordx4 v10, s[48:51], s65 offen nt lds
    s_add_u32 s65, s65, 8192
    s_waitcnt vmcnt(31)
    s_mov_b32 m0, s64
    s_add_u32 s64, s64, 1024
    buffer_load_dwordx4 v10, s[48:51], s65 offen nt lds
    s_add_u32 s65, s65, 8192
    s_waitcnt vmcnt(31)
    s_mov_b32 m0, s64
    s_add_u32 s64, s64, 1024
    buffer_load_dwordx4 v10, s[48:51], s65 offen nt lds
    s_add_u32 s65, s65, 8192
    s_waitcnt vmcnt(31)
    s_mov_b32 m0, s64
    s_add_u32 s64, s64, 1024
    buffer_load_dwordx4 v10, s[48:51], s65 offen nt lds
    s_add_u32 s65, s65, 8192
    s_waitcnt vmcnt(31)
    s_mov_b32 m0, s64
    s_add_u32 s64, s64, 1024
    buffer_load_dwordx4 v10, s[48:51], s65 offen nt lds
    s_add_u32 s65, s65, 8192
    s_waitcnt vmcnt(31)
    s_mov_b32 m0, s64
    s_add_u32 s64, s64, 1024
    buffer_load_dwordx4 v10, s[48:51], s65 offen nt lds
    s_add_u32 s65, s65, 8192
    s_waitcnt vmcnt(31)
    s_mov_b32 m0, s64
    s_add_u32 s64, s64, 1024
    buffer_load_dwordx4 v10, s[48:51], s65 offen nt lds
    s_add_u32 s65, s65, 8192
    s_waitcnt vmcnt(31)
    s_sub_u32 s7, s60, 16
    v_mov_b32 v19, s7
    ds_max_i32 v16, v19
    s_mov_b32 m0, s64
    s_add_u32 s64, s64, 1024
    buffer_load_dwordx4 v10, s[48:51], s65 offen nt lds
    s_add_u32 s65, s65, 8192
    s_add_u32 s60, s60, 16
    s_add_u32 s65, s65, 917504
    s_sub_u32 s66, s66, 1
    s_cmp_lg_u32 s66, 0
    s_cbranch_scc1 LL_58
    s_waitcnt vmcnt(24)
    s_sub_u32 s7, s60, 24
    v_mov_b32 v19, s7
    ds_max_i32 v16, v19
    s_waitcnt vmcnt(16)
    s_sub_u32 s7, s60, 16
    v_mov_b32 v19, s7
    ds_max_i32 v16, v19
    s_waitcnt vmcnt(8)
    s_sub_u32 s7, s60, 8
    v_mov_b32 v19, s7
    ds_max_i32 v16, v19
    s_waitcnt vmcnt(0)
    v_mov_b32 v19, s60
    ds_max_i32 v16, v19
    s_endpgm
L_RED:
    s_and_b32 s7, s4, 7
    s_cbranch_scc1 L_END
    s_add_u32 s61, s4, s5
    s_and_b32 s7, s6, 3
    s_cmp_eq_u32 s7, 3
    s_cbranch_scc1 L_END
    s_cmp_eq_u32 s7, 2
    s_cbranch_scc1 L_REDB
    s_lshl_b32 s60, s61, 1
    s_add_u32 s60, s60, s7
    s_mov_b32 s52, s30
    s_and_b32 s53, s31, 0xffff
    s_mov_b32 s54, 0x2000
    s_mov_b32 s55, 0x20000
    s_mov_b32 s84, 0x3f80
    s_mov_b32 s85, 0x3f800000
    s_lshl_b32 s7, s60, 12
    s_add_u32 s7, s7, 0x280000
    v_lshl_add_u32 v36, v1, 4, s7
    s_lshr_b32 s7, s60, 4
    s_lshl_b32 s7, s7, 11
    s_and_b32 s61, s60, 15
    s_lshl_b32 s61, s61, 6
    s_add_u32 s7, s7, s61
    v_lshl_add_u32 v37, v1, 3, s7
    s_mov_b64 exec, -1
    buffer_load_dwordx4 v[48:51], v36, s[36:39], 0 offen offset:0 sc1
    buffer_load_dwordx4 v[52:55], v36, s[36:39], 0 offen offset:1024 sc1
    buffer_load_dwordx4 v[56:59], v36, s[36:39], 0 offen offset:2048 sc1
    buffer_load_dwordx4 v[60:63], v36, s[36:39], 0 offen offset:3072 sc1
    s_mov_b32 s80, 200000
MC_60:
    s_mov_b64 exec, -1
    s_waitcnt vmcnt(0)
    v_cmp_ne_u64 s[62:63], s[92:93], v[50:51]
    v_cmp_ne_u64 s[64:65], s[92:93], v[54:55]
    v_cmp_ne_u64 s[66:67], s[92:93], v[58:59]
    v_cmp_ne_u64 s[68:69], s[92:93], v[62:63]
    s_or_b64 s[90:91], s[62:63], s[64:65]
    s_or_b64 s[90:91], s[90:91], s[66:67]
    s_or_b64 s[90:91], s[90:91], s[68:69]
    s_cbranch_scc1 M_59
MD_61:
    s_mov_b64 exec, -1
    v_dot2_f32_bf16 v44, v48, s84, 0
    v_dot2_f32_bf16 v45, v48, s85, 0
    v_dot2_f32_bf16 v46, v49, s84, 0
    v_dot2_f32_bf16 v47, v49, s85, 0
    v_dot2_f32_bf16 v44, v52, s84, v44
    v_dot2_f32_bf16 v45, v52, s85, v45
    v_dot2_f32_bf16 v46, v53, s84, v46
    v_dot2_f32_bf16 v47, v53, s85, v47
    v_dot2_f32_bf16 v44, v56, s84, v44
    v_dot2_f32_bf16 v45, v56, s85, v45
    v_dot2_f32_bf16 v46, v57, s84, v46
    v_dot2_f32_bf16 v47, v57, s85, v47
    v_dot2_f32_bf16 v44, v60, s84, v44
    v_dot2_f32_bf16 v45, v60, s85, v45
    v_dot2_f32_bf16 v46, v61, s84, v46
    v_dot2_f32_bf16 v47, v61, s85, v47
    v_add_f32_dpp v44, v44, v44 row_ror:8 row_mask:0xf bank_mask:0xf
    v_add_f32_dpp v45, v45, v45 row_ror:8 row_mask:0xf bank_mask:0xf
    v_add_f32_dpp v46, v46, v46 row_ror:8 row_mask:0xf bank_mask:0xf
    v_add_f32_dpp v47, v47, v47 row_ror:8 row_mask:0xf bank_mask:0xf
    s_nop 0
    v_permlane32_swap_b32 v44, v46
    v_permlane32_swap_b32 v45, v47
    v_add_f32 v44, v44, v46
    v_add_f32 v45, v45, v47
    v_mov_b32 v46, v44
    v_mov_b32 v47, v45
    s_nop 0
    v_permlane16_swap_b32 v44, v46
    v_permlane16_swap_b32 v45, v47
    v_add_f32 v44, v44, v46
    v_add_f32 v45, v45, v47
    v_cvt_pk_bf16_f32 v44, v44, v45
    v_mov_b32 v45, v44
    s_nop 1
    v_permlane32_swap_b32 v44, v45
    s_mov_b64 exec, 0xff
    buffer_store_dwordx2 v[44:45], v37, s[52:55], 0 offen
    s_mov_b64 exec, -1
    s_endpgm
L_REDB:
    s_mov_b32 s52, s30
    s_and_b32 s53, s31, 0xffff
    s_mov_b32 s54, 0x2000
    s_mov_b32 s55, 0x20000
    s_mov_b32 s84, 0x3f80
    s_mov_b32 s85, 0x3f800000
    s_lshl_b32 s7, s61, 11
    s_add_u32 s7, s7, 0x2c0000
    v_lshl_add_u32 v36, v1, 4, s7
    s_lshl_b32 s7, s61, 5
    s_add_u32 s7, s7, 1024
    v_and_b32 v38, 3, v1
    v_lshl_add_u32 v37, v38, 3, s7
    v_lshrrev_b32 v38, 2, v3
    v_lshl_add_u32 v37, v38, 11, v37
    s_mov_b64 exec, -1
    buffer_load_dwordx4 v[48:51], v36, s[36:39], 0 offen offset:0 sc1
    buffer_load_dwordx4 v[52:55], v36, s[36:39], 0 offen offset:1024 sc1
    s_mov_b32 s80, 200000
MC_63:
    s_mov_b64 exec, -1
    s_waitcnt vmcnt(0)
    v_cmp_ne_u64 s[62:63], s[92:93], v[50:51]
    v_cmp_ne_u64 s[64:65], s[92:93], v[54:55]
    s_or_b64 s[90:91], s[62:63], s[64:65]
    s_cbranch_scc1 M_62
MD_64:
    s_mov_b64 exec, -1
    v_dot2_f32_bf16 v44, v48, s84, 0
    v_dot2_f32_bf16 v45, v48, s85, 0
    v_dot2_f32_bf16 v46, v49, s84, 0
    v_dot2_f32_bf16 v47, v49, s85, 0
    v_dot2_f32_bf16 v44, v52, s84, v44
    v_dot2_f32_bf16 v45, v52, s85, v45
    v_dot2_f32_bf16 v46, v53, s84, v46
    v_dot2_f32_bf16 v47, v53, s85, v47
    s_nop 1
    v_permlane32_swap_b32 v44, v46
    v_permlane32_swap_b32 v45, v47
    v_add_f32 v44, v44, v46
    v_add_f32 v45, v45, v47
    v_mov_b32 v46, v44
    v_mov_b32 v47, v45
    s_nop 0
    v_permlane16_swap_b32 v44, v46
    v_permlane16_swap_b32 v45, v47
    v_add_f32 v44, v44, v46
    v_add_f32 v45, v45, v47
    v_cvt_pk_bf16_f32 v44, v44, v45
    v_mov_b32 v45, v44
    s_nop 1
    v_permlane32_swap_b32 v44, v45
    s_mov_b64 exec, 0xffff
    buffer_store_dwordx2 v[44:45], v37, s[52:55], 0 offen
    s_mov_b64 exec, -1
    s_endpgm
L_SIDE:
    v_lshlrev_b32 v10, 2, v0
    v_mov_b32 v24, 0
    v_add_u32 v10, 0x23c00, v10
    ds_write_b32 v10, v24
    s_mov_b32 s61, s6
    v_mov_b32 v28, -1
    v_mov_b32 v29, -1
    v_mov_b32 v30, -1
    v_mov_b32 v31, -1
    s_and_b32 s64, s4, 7
    s_lshl_b32 s64, s64, 3
    s_lshr_b32 s7, s4, 3
    s_lshl_b32 s7, s7, 1
    s_add_u32 s64, s64, s7
    s_add_u32 s64, s64, s5
    s_sub_u32 s64, s64, 6
    s_waitcnt lgkmcnt(0)
    s_mov_b32 s40, s32
    s_and_b32 s41, s33, 0xffff
    s_mov_b32 s42, 0x100
    s_mov_b32 s43, 0x20000
    s_or_b32 s7, s6, s2
    s_cbranch_scc1 NC_65
    s_lshl_b64 s[92:93], s[94:95], 5
    s_or_b32 s93, s93, 0x80000000
    v_mov_b32 v12, s92
    v_mov_b32 v13, s93
    s_mov_b64 exec, 1
    buffer_store_dwordx2 v[12:13], v24, s[40:43], 0 offen sc1
    s_mov_b64 exec, -1
NC_65:
    s_mov_b32 s36, s34
    s_and_b32 s37, s35, 0xffff
    s_mov_b32 s38, 0x1000000
    s_mov_b32 s39, 0x20000
    s_cmp_lt_u32 s5, 4
    s_cbranch_scc1 NB_67
    s_cmp_ge_u32 s5, 6
    s_cbranch_scc1 NQ_66
    s_cmp_lg_u32 s6, 2
    s_cbranch_scc1 NB_67
    s_lshl_b32 s7, s4, 1
    s_add_u32 s7, s7, s5
    s_lshl_b32 s7, s7, 9
    s_sub_u32 s7, s7, 2048
    v_lshl_add_u32 v10, v3, 4, s7
    v_lshl_add_u32 v10, v2, 15, v10
    buffer_store_dwordx4 v[28:31], v10, s[36:39], 0 offen sc1
    buffer_store_dwordx4 v[28:31], v10, s[36:39], 0 offen offset:256 sc1
    s_branch NB_67
NQ_66:
    s_lshl_b32 s65, s64, 2
    s_add_u32 s65, s65, s6
    s_and_b32 s7, s65, 31
    s_lshl_b32 s7, s7, 13
    s_lshr_b32 s62, s64, 3
    s_lshl_b32 s62, s62, 10
    s_add_u32 s7, s7, s62
    s_add_u32 s7, s7, 0x200000
    v_lshl_add_u32 v10, v1, 4, s7
    buffer_store_dwordx4 v[28:31], v10, s[36:39], 0 offen sc1
    s_lshl_b32 s7, s65, 10
    s_add_u32 s7, s7, 0x280000
    v_lshl_add_u32 v10, v1, 7, s7
    s_lshl_b32 s62, s65, 8
    s_add_u32 s7, s62, 0x2c0000
    v_writelane_b32 v10, s7, 8
    s_add_u32 s7, s62, 0x2c0080
    v_writelane_b32 v10, s7, 9
    s_add_u32 s7, s62, 0xc0000
    v_writelane_b32 v10, s7, 10
    s_add_u32 s7, s62, 0xc0080
    v_writelane_b32 v10, s7, 11
    s_lshl_b32 s7, s65, 7
    s_add_u32 s7, s7, 0x28000
    v_writelane_b32 v10, s7, 12
    s_add_u32 s7, s7, 0x8000
    v_writelane_b32 v10, s7, 14
    s_lshl_b32 s7, s65, 4
    s_add_u32 s7, s7, 0x23000
    v_writelane_b32 v10, s7, 13
    s_mov_b64 exec, 0x7fff
    buffer_load_dword v15, v10, s[36:39], 0 offen sc1
    s_mov_b64 exec, -1
    s_getpc_b64 s[84:85]
L_PC:
    s_and_b32 s7, s65, 31
    s_mul_i32 s7, s7, 1280
    v_lshl_add_u32 v10, v1, 7, s7
    v_min_u32 v10, L_END-concat_heads__sliding_block_cached__compressed_kv_cla__decode_kernel, v10
    s_sub_u32 s84, s84, L_PC-concat_heads__sliding_block_cached__compressed_kv_cla__decode_kernel
    s_subb_u32 s85, s85, 0
    v_mov_b32 v11, s85
    v_add_co_u32 v10, vcc, s84, v10
    s_nop 1
    v_addc_co_u32 v11, vcc, 0, v11, vcc
    s_mov_b64 exec, 0x3ff
    global_load_dword v15, v[10:11], off
    s_mov_b64 exec, -1
NB_67:
    s_barrier
    s_cmp_lg_u32 s6, 0
    s_cbranch_scc1 NF_69
    s_mov_b32 s80, 800000
    s_sleep 4
NL_71:
    s_mov_b64 exec, 1
    buffer_load_dwordx2 v[12:13], v24, s[40:43], 0 offen sc1
    s_mov_b64 exec, -1
    s_waitcnt vmcnt(0)
    v_readfirstlane_b32 s92, v12
    v_readfirstlane_b32 s93, v13
    s_sub_u32 s80, s80, 1
    s_cbranch_scc1 NH_72
    s_cmp_eq_u32 s93, 0
    s_cbranch_scc1 NL_71
    s_sub_u32 s7, s94, 1500
    s_lshl_b32 s7, s7, 5
    s_sub_u32 s7, s92, s7
    s_cmp_ge_i32 s7, 0
    s_cbranch_scc1 NH_72
    s_cmp_gt_u32 s80, 799960
    s_cbranch_scc1 NL_71
NH_72:
    v_mov_b32 v11, 0x24248
    v_mov_b32 v12, s92
    v_mov_b32 v13, s93
    ds_write_b64 v11, v[12:13]
    v_mov_b32 v11, 0x24204
    v_mov_b32 v14, 1
    s_mov_b64 exec, 1
    ds_add_u32 v11, v14
    s_mov_b64 exec, -1
NF_69:
    s_cmp_lg_u32 s6, 1
    s_cbranch_scc1 NP_68
    s_lshl_b32 s65, s4, 7
    s_add_u32 s65, s65, 0x21000
    s_lshr_b32 s7, s64, 3
    s_lshl_b32 s7, s7, 7
    s_add_u32 s7, s7, 0x22000
    s_and_b32 s62, s64, 7
    s_cmp_lt_u32 s5, 6
    s_cselect_b32 s7, s65, s7
    s_cselect_b32 s62, s5, s62
    v_lshl_add_u32 v11, v1, 3, s7
    s_sleep 12
    s_memrealtime s[88:89]
    s_waitcnt lgkmcnt(0)
    s_or_b32 s89, s89, s78
    v_mov_b32 v12, s88
    v_mov_b32 v13, s89
    s_lshl_b64 exec, 1, s62
    buffer_store_dwordx2 v[12:13], v11, s[36:39], 0 offen
    s_mov_b64 exec, -1
    s_cmp_ge_u32 s5, 6
    s_cbranch_scc1 NP_68
    s_sleep 24
    s_or_b32 s95, s95, s78
    s_add_u32 s88, s94, 0x10000
    s_addc_u32 s89, s95, 0
    s_mov_b32 s101, 16
    s_mov_b64 exec, 0x3f
U_73:
    buffer_load_dwordx2 v[14:15], v11, s[36:39], 0 offen sc1 nt
UU_74:
    s_waitcnt vmcnt(0)
    v_cmp_gt_u64 s[90:91], s[94:95], v[14:15]
    v_cmp_le_u64 vcc, s[88:89], v[14:15]
    s_or_b64 vcc, vcc, s[90:91]
    s_cbranch_scc0 UD_75
    s_sleep 8
    s_sub_u32 s101, s101, 1
    s_cmp_lg_u32 s101, 0
    s_cbranch_scc1 U_73
UD_75:
    s_mov_b64 exec, -1
    s_min_u32 s7, s101, 1
    s_add_u32 s7, s7, 16
    v_mov_b32 v12, 0x24200
    v_mov_b32 v13, s7
    s_mov_b64 exec, 1
    ds_add_u32 v12, v13
    s_mov_b64 exec, -1
NP_68:
    s_cmp_ge_u32 s5, 6
    s_cbranch_scc1 L_BATT
    s_cmp_lt_u32 s5, 4
    s_cbranch_scc1 NG_70
    s_cmp_lg_u32 s6, 2
    s_cbranch_scc1 NG_70
    s_lshl_b32 s7, s4, 4
    s_add_u32 s7, s7, s5
    s_lshl_b32 s7, s7, 3
    s_add_u32 s7, s7, 0x1ffe0
    v_mov_b32 v11, s7
    s_waitcnt vmcnt(0)
    v_mov_b32 v12, 0x24208
    v_mov_b32 v13, 16
    s_mov_b64 exec, 1
    ds_add_u32 v12, v13
    s_mov_b64 exec, -1
    v_mov_b32 v16, 0x24204
    s_mov_b32 s80, 1600000
LW_76:
    ds_read_b32 v17, v16
    s_waitcnt lgkmcnt(0)
    v_readfirstlane_b32 s79, v17
    s_cmp_ge_u32 s79, 1
    s_cbranch_scc1 LWD_77
    s_sleep 1
    s_sub_u32 s80, s80, 1
    s_cmp_lg_u32 s80, 0
    s_cbranch_scc1 LW_76
LWD_77:
    v_mov_b32 v16, 0x24248
    ds_read_b64 v[18:19], v16
    s_waitcnt lgkmcnt(0)
    v_readfirstlane_b32 s92, v18
    v_readfirstlane_b32 s93, v19
    s_mov_b64 exec, 1
    buffer_store_dwordx2 v[18:19], v11, s[36:39], 0 offen sc1
    s_mov_b64 exec, -1
NG_70:
    s_mov_b32 s96, 0x6010600
    s_mov_b32 s97, 0x6030602
    s_cmp_eq_u32 s5, 1
    s_cselect_b32 s96, 0x6190618, s96
    s_cselect_b32 s97, 0x61b061a, s97
    s_cmp_eq_u32 s5, 2
    s_cselect_b32 s96, 0x6310630, s96
    s_cselect_b32 s97, 0x6330632, s97
    s_cmp_eq_u32 s5, 3
    s_cselect_b32 s96, 0x6490648, s96
    s_cselect_b32 s97, 0x64b064a, s97
    s_cmp_eq_u32 s5, 4
    s_cselect_b32 s96, 0x4610460, s96
    s_cselect_b32 s97, 0x4630462, s97
    s_cmp_eq_u32 s5, 5
    s_cselect_b32 s96, 0x4710470, s96
    s_cselect_b32 s97, 0x4730472, s97
    s_lshl_b32 s7, s61, 4
    s_lshr_b64 s[90:91], s[96:97], s7
    s_and_b32 s66, s90, 3
    s_bfe_u32 s67, s90, 0x50002
    s_bfe_u32 s68, s90, 0x40008
    s_lshl_b32 s7, s4, 15
    s_lshl_b32 s63, s66, 9
    s_add_u32 s7, s7, s63
    s_add_u32 s7, s7, 0x100000
    v_and_b32 v20, 31, v1
    v_lshl_add_u32 v7, v20, 4, s7
    v_lshrrev_b32 v21, 5, v1
    v_lshl_add_u32 v7, v21, 11, v7
    v_add_u32 v22, 4096, v7
    s_mul_i32 s7, s66, 320
    s_add_u32 s63, s7, 0x24400
    v_lshl_add_u32 v6, v20, 3, s63
    v_lshl_add_u32 v6, v21, 2, v6
    s_mov_b32 s70, 0x3f80
    s_mov_b32 s71, 0x3f800000
    v_mov_b32 v12, 0x24200
    s_mov_b32 s80, 1600000
LW_78:
    ds_read_b32 v13, v12
    s_waitcnt lgkmcnt(0)
    v_readfirstlane_b32 s79, v13
    s_cmp_ge_u32 s79, 16
    s_cbranch_scc1 LWD_79
    s_sleep 4
    s_sub_u32 s80, s80, 1
    s_cmp_lg_u32 s80, 0
    s_cbranch_scc1 LW_78
LWD_79:
    s_and_b32 s101, s79, 15
    v_mov_b32 v16, 0x24204
    s_mov_b32 s80, 1600000
LW_80:
    ds_read_b32 v17, v16
    s_waitcnt lgkmcnt(0)
    v_readfirstlane_b32 s79, v17
    s_cmp_ge_u32 s79, 1
    s_cbranch_scc1 LWD_81
    s_sleep 1
    s_sub_u32 s80, s80, 1
    s_cmp_lg_u32 s80, 0
    s_cbranch_scc1 LW_80
LWD_81:
    v_mov_b32 v16, 0x24248
    ds_read_b64 v[18:19], v16
    s_waitcnt lgkmcnt(0)
    v_readfirstlane_b32 s92, v18
    v_readfirstlane_b32 s93, v19
    s_cmp_lt_u32 s5, 4
    s_cselect_b32 s65, 16, 148
    s_cselect_b32 s7, 0, 4294967288
    s_add_u32 s7, s7, 0x24210
    v_mov_b32 v12, s7
    s_mov_b32 s80, 1600000
LW_82:
    ds_read_b32 v13, v12
    s_waitcnt lgkmcnt(0)
    v_readfirstlane_b32 s79, v13
    s_cmp_ge_u32 s79, s65
    s_cbranch_scc1 LWD_83
    s_sleep 4
    s_sub_u32 s80, s80, 1
    s_cmp_lg_u32 s80, 0
    s_cbranch_scc1 LW_82
LWD_83:
    s_sleep 16
    s_mov_b64 exec, -1
    buffer_load_dwordx4 v[48:51], v7, s[36:39], 0 offen sc1 nt
    buffer_load_dwordx4 v[52:55], v22, s[36:39], 0 offen sc1 nt
    s_mov_b32 s80, 200000
MC_85:
    s_mov_b64 exec, -1
    s_waitcnt vmcnt(0)
    v_cmp_ne_u64 s[44:45], s[92:93], v[50:51]
    v_cmp_ne_u64 s[46:47], s[92:93], v[54:55]
    s_or_b64 s[90:91], s[44:45], s[46:47]
    s_cbranch_scc1 M_84
MD_86:
    s_mov_b64 exec, -1
    v_dot2_f32_bf16 v24, v48, s70, 0
    v_dot2_f32_bf16 v25, v48, s71, 0
    v_dot2_f32_bf16 v26, v49, s70, 0
    v_dot2_f32_bf16 v27, v49, s71, 0
    v_dot2_f32_bf16 v24, v52, s70, v24
    v_dot2_f32_bf16 v25, v52, s71, v25
    v_dot2_f32_bf16 v26, v53, s70, v26
    v_dot2_f32_bf16 v27, v53, s71, v27
    s_nop 1
    v_permlane32_swap_b32 v24, v26
    v_permlane32_swap_b32 v25, v27
    v_add_f32 v24, v24, v26
    v_add_f32 v25, v25, v27
    v_cvt_pk_bf16_f32 v24, v24, v25
    ds_write_b32 v6, v24
L_AATT:
    v_lshl_add_u32 v8, v2, 4, s63
    s_waitcnt lgkmcnt(0)
    ds_read_b128 v[16:19], v8 offset:0
    ds_read_b128 v[20:23], v8 offset:64
    ds_read_b128 v[24:27], v8 offset:128
    ds_read_b128 v[28:31], v8 offset:192
    v_xor_b32 v4, v3, v2
    v_lshlrev_b32 v4, 4, v4
    v_lshl_add_u32 v4, v3, 8, v4
    v_lshrrev_b32 v9, 2, v1
    v_and_b32 v5, 7, v9
    v_lshlrev_b32 v5, 5, v5
    v_lshl_add_u32 v5, v9, 8, v5
    v_and_b32 v10, 3, v1
    v_lshl_add_u32 v5, v10, 3, v5
    s_lshl_b32 s7, s61, 10
    s_add_u32 s7, s7, 0x24e00
    v_lshl_add_u32 v6, v2, 4, s7
    v_cmp_eq_u32 s[84:85], 0, v3
    s_mov_b32 s72, 0x3e0293ee
    s_cmp_ge_u32 s5, 4
    s_cselect_b32 s73, 8, 8
    s_cselect_b32 s69, 8, 0
    s_cselect_b32 s70, 17, 1
    s_cselect_b32 s74, 16, 24
    s_add_u32 s70, s70, s61
    s_add_u32 s74, s74, s70
    s_lshl_b32 s70, s70, 3
    s_add_u32 s69, s69, s61
    s_cmp_ge_u32 s69, 16
    s_cselect_b32 s7, 16, 0
    s_sub_u32 s69, s69, s7
    s_mov_b32 s71, s68
AK_87:
    s_lshl_b32 s7, s69, 13
    v_add_u32 v104, s7, v4
    v_xor_b32 v105, 0x40, v104
    v_xor_b32 v106, 0x80, v104
    v_xor_b32 v107, 0xc0, v104
    s_and_b32 s62, s69, 12
    s_add_u32 s62, s62, 0x24100
    v_mov_b32 v8, 0x24000
    s_mov_b32 s80, 1600000
LW_88:
    ds_read_b32 v9, v8
    s_waitcnt lgkmcnt(0)
    v_readfirstlane_b32 s79, v9
    s_cmp_ge_u32 s79, s70
    s_cbranch_scc1 LWD_89
    s_sleep 2
    s_sub_u32 s80, s80, 1
    s_cmp_lg_u32 s80, 0
    s_cbranch_scc1 LW_88
LWD_89:
    ds_read_b128 v[32:35], v104 offset:0
    ds_read_b128 v[36:39], v104 offset:4096
    ds_read_b128 v[40:43], v105 offset:0
    ds_read_b128 v[44:47], v105 offset:4096
    ds_read_b128 v[48:51], v106 offset:0
    ds_read_b128 v[52:55], v106 offset:4096
    ds_read_b128 v[56:59], v107 offset:0
    ds_read_b128 v[60:63], v107 offset:4096
    s_waitcnt lgkmcnt(6)
    v_mfma_f32_16x16x32_bf16 v[64:67], v[32:35], v[16:19], 0
    v_mfma_f32_16x16x32_bf16 v[68:71], v[36:39], v[16:19], 0
    s_waitcnt lgkmcnt(4)
    v_mfma_f32_16x16x32_bf16 v[64:67], v[40:43], v[20:23], v[64:67]
    v_mfma_f32_16x16x32_bf16 v[68:71], v[44:47], v[20:23], v[68:71]
    s_waitcnt lgkmcnt(2)
    v_mfma_f32_16x16x32_bf16 v[64:67], v[48:51], v[24:27], v[64:67]
    v_mfma_f32_16x16x32_bf16 v[68:71], v[52:55], v[24:27], v[68:71]
    s_waitcnt lgkmcnt(0)
    v_mfma_f32_16x16x32_bf16 v[64:67], v[56:59], v[28:31], v[64:67]
    v_mfma_f32_16x16x32_bf16 v[68:71], v[60:63], v[28:31], v[68:71]
    v_mov_b32 v8, s62
    v_mov_b32 v9, 1
    s_mov_b64 exec, 1
    ds_add_u32 v8, v9
    s_mov_b64 exec, -1
    s_mov_b64 exec, s[84:85]
    s_nop 0
    ds_write_b128 v6, v[64:67] offset:0
    ds_write_b128 v6, v[68:71] offset:64
    s_mov_b64 exec, -1
    v_add_u32 v6, 128, v6
    s_add_u32 s69, s69, 4
    s_cmp_ge_u32 s69, 16
    s_cselect_b32 s7, 16, 0
    s_sub_u32 s69, s69, s7
    s_add_u32 s70, s70, 32
    s_sub_u32 s71, s71, 1
    s_cmp_lg_u32 s71, 0
    s_cbranch_scc1 AK_87
    v_lshrrev_b32 v8, 2, v1
    v_cmp_gt_u32 s[86:87], s68, v8
    v_and_b32 v8, 7, v8
    v_and_b32 v9, 3, v1
    v_lshlrev_b32 v9, 4, v9
    v_lshl_add_u32 v10, v8, 7, v9
    s_lshl_b32 s7, s61, 10
    s_add_u32 s7, s7, 0x24e00
    v_add_u32 v10, s7, v10
    s_waitcnt lgkmcnt(0)
    ds_read_b128 v[32:35], v10
    ds_read_b128 v[36:39], v10 offset:64
    s_lshl_b32 s7, s61, 9
    s_add_u32 s7, s7, 0x25e00
    v_lshl_add_u32 v10, v8, 6, v9
    v_add_u32 v10, s7, v10
    v_lshl_add_u32 v7, v2, 4, s7
    v_mov_b32 v11, 0xff800000
    s_waitcnt lgkmcnt(0)
    v_cndmask_b32 v32, v11, v32, s[86:87]
    v_cndmask_b32 v33, v11, v33, s[86:87]
    v_cndmask_b32 v34, v11, v34, s[86:87]
    v_cndmask_b32 v35, v11, v35, s[86:87]
    v_cndmask_b32 v36, v11, v36, s[86:87]
    v_cndmask_b32 v37, v11, v37, s[86:87]
    v_cndmask_b32 v38, v11, v38, s[86:87]
    v_cndmask_b32 v39, v11, v39, s[86:87]
    v_max3_f32 v64, v32, v33, v34
    v_max3_f32 v64, v64, v35, v36
    v_max3_f32 v64, v64, v37, v38
    v_max_f32 v64, v64, v39
    s_nop 1
    v_max_f32_dpp v64, v64, v64 row_ror:1 row_mask:0xf bank_mask:0xf
    s_nop 1
    v_max_f32_dpp v64, v64, v64 row_ror:2 row_mask:0xf bank_mask:0xf
    s_nop 1
    v_max_f32_dpp v64, v64, v64 row_ror:4 row_mask:0xf bank_mask:0xf
    s_nop 1
    v_max_f32_dpp v64, v64, v64 row_ror:8 row_mask:0xf bank_mask:0xf
    v_mov_b32 v11, v64
    s_nop 1
    v_permlane32_swap_b32 v64, v11
    v_max_f32 v64, v64, v11
    v_mov_b32 v11, v64
    s_nop 1
    v_permlane16_swap_b32 v64, v11
    v_max_f32 v64, v64, v11
    v_mul_f32 v64, s72, v64
    v_fma_f32 v32, v32, s72, -v64
    v_fma_f32 v33, v33, s72, -v64
    v_fma_f32 v34, v34, s72, -v64
    v_fma_f32 v35, v35, s72, -v64
    v_fma_f32 v36, v36, s72, -v64
    v_fma_f32 v37, v37, s72, -v64
    v_fma_f32 v38, v38, s72, -v64
    v_fma_f32 v39, v39, s72, -v64
    v_exp_f32 v32, v32
    v_exp_f32 v33, v33
    v_exp_f32 v34, v34
    v_exp_f32 v35, v35
    v_exp_f32 v36, v36
    v_exp_f32 v37, v37
    v_exp_f32 v38, v38
    v_exp_f32 v39, v39
    v_cvt_pk_bf16_f32 v112, v32, v33
    v_cvt_pk_bf16_f32 v113, v34, v35
    v_cvt_pk_bf16_f32 v114, v36, v37
    v_cvt_pk_bf16_f32 v115, v38, v39
    s_mov_b64 exec, s[86:87]
    ds_write_b128 v10, v[112:115]
    s_mov_b64 exec, -1
    v_add_f32 v32, v32, v36
    v_add_f32 v33, v33, v37
    v_add_f32 v34, v34, v38
    v_add_f32 v35, v35, v39
    v_add_f32 v32, v32, v34
    v_add_f32 v33, v33, v35
    v_add_f32 v32, v32, v33
    v_mov_b32 v65, v32
    s_nop 1
    v_add_f32_dpp v65, v65, v65 row_ror:1 row_mask:0xf bank_mask:0xf
    s_nop 1
    v_add_f32_dpp v65, v65, v65 row_ror:2 row_mask:0xf bank_mask:0xf
    s_nop 1
    v_add_f32_dpp v65, v65, v65 row_ror:4 row_mask:0xf bank_mask:0xf
    s_nop 1
    v_add_f32_dpp v65, v65, v65 row_ror:8 row_mask:0xf bank_mask:0xf
    v_mov_b32 v11, v65
    s_nop 1
    v_permlane32_swap_b32 v65, v11
    v_add_f32 v65, v65, v11
    v_mov_b32 v11, v65
    s_nop 1
    v_permlane16_swap_b32 v65, v11
    v_add_f32 v65, v65, v11
    v_mov_b32 v8, 0x24204
    s_mov_b32 s80, 1600000
LW_90:
    ds_read_b32 v9, v8
    s_waitcnt lgkmcnt(0)
    v_readfirstlane_b32 s79, v9
    s_cmp_ge_u32 s79, 1
    s_cbranch_scc1 LWD_91
    s_sleep 1
    s_sub_u32 s80, s80, 1
    s_cmp_lg_u32 s80, 0
    s_cbranch_scc1 LW_90
LWD_91:
    v_mov_b32 v8, 0x24248
    ds_read_b64 v[10:11], v8
    s_waitcnt lgkmcnt(0)
    v_readfirstlane_b32 s92, v10
    v_readfirstlane_b32 s93, v11
    s_nop 0
    v_mov_b32 v66, s92
    v_mov_b32 v67, s93
    s_lshl_b32 s7, s4, 2
    s_add_u32 s7, s7, s66
    s_lshl_b32 s7, s7, 3
    s_add_u32 s7, s7, s5
    s_lshl_b32 s7, s7, 4
    s_add_u32 s7, s7, 0x24000
    v_mov_b32 v8, s7
    s_mov_b64 exec, 1
    s_cmp_eq_u32 s101, 0
    s_cbranch_scc1 SU_92
    buffer_store_dwordx4 v[64:67], v8, s[36:39], 0 offen
SV_93:
    s_mov_b64 exec, -1
    s_and_b32 s7, s7, -128
    v_lshl_add_u32 v12, v1, 4, s7
    v_or_b32 v70, 1, v66
    v_mov_b32 v71, v67
    v_mov_b32 v116, 0xff800000
    v_mov_b32 v117, 0
    v_mov_b32 v72, 0
    v_mov_b32 v73, 0
    v_mov_b32 v74, 0
    v_mov_b32 v75, 0
    v_mov_b32 v76, 0
    v_mov_b32 v77, 0
    v_mov_b32 v78, 0
    v_mov_b32 v79, 0
    v_mov_b32 v80, 0
    v_mov_b32 v81, 0
    v_mov_b32 v82, 0
    v_mov_b32 v83, 0
    v_mov_b32 v84, 0
    v_mov_b32 v85, 0
    v_mov_b32 v86, 0
    v_mov_b32 v87, 0
    v_mov_b32 v88, 0
    v_mov_b32 v89, 0
    v_mov_b32 v90, 0
    v_mov_b32 v91, 0
    v_mov_b32 v92, 0
    v_mov_b32 v93, 0
    v_mov_b32 v94, 0
    v_mov_b32 v95, 0
    v_mov_b32 v96, 0
    v_mov_b32 v97, 0
    v_mov_b32 v98, 0
    v_mov_b32 v99, 0
    v_mov_b32 v100, 0
    v_mov_b32 v101, 0
    v_mov_b32 v102, 0
    v_mov_b32 v103, 0
    s_lshl_b32 s7, s4, 4
    s_add_u32 s7, s7, s5
    s_lshl_b32 s7, s7, 2
    s_add_u32 s7, s7, s66
    s_lshl_b32 s7, s7, 9
    s_add_u32 s7, s7, 0x100000
    v_lshl_add_u32 v6, v1, 4, s7
    s_cmp_lt_u32 s5, 4
    s_cbranch_scc1 AE_94
    v_mov_b32 v13, 0
    s_mov_b64 exec, 0x01010101
    buffer_store_dword v13, v6, s[36:39], 0 offen
    buffer_load_dword v13, v6, s[36:39], 0 offen sc1 nt
    s_mov_b64 exec, -1
AE_94:
    s_add_u32 s69, s73, s61
    s_lshl_b32 s70, s74, 3
    s_cmp_ge_u32 s69, 16
    s_cselect_b32 s7, 16, 0
    s_sub_u32 s69, s69, s7
    s_mov_b32 s71, s68
AV_95:
    s_lshl_b32 s7, s69, 13
    v_add_u32 v104, s7, v5
    v_xor_b32 v105, 0x20, v104
    v_xor_b32 v106, 0x40, v104
    v_xor_b32 v107, 0x60, v104
    v_xor_b32 v108, 0x80, v104
    v_xor_b32 v109, 0xa0, v104
    v_xor_b32 v110, 0xc0, v104
    v_xor_b32 v111, 0xe0, v104
    s_and_b32 s62, s69, 12
    s_add_u32 s62, s62, 0x24100
    ds_read_b128 v[112:115], v7
    v_add_u32 v7, 64, v7
    s_cmp_le_u32 s71, 2
    s_cbranch_scc1 AW_96
AWB_97:
    v_mov_b32 v8, 0x24000
    s_mov_b32 s80, 1600000
LW_98:
    ds_read_b32 v9, v8
    s_waitcnt lgkmcnt(0)
    v_readfirstlane_b32 s79, v9
    s_cmp_ge_u32 s79, s70
    s_cbranch_scc1 LWD_99
    s_sleep 1
    s_sub_u32 s80, s80, 1
    s_cmp_lg_u32 s80, 0
    s_cbranch_scc1 LW_98
LWD_99:
    ds_read_b64_tr_b16 v[32:33], v104
    ds_read_b64_tr_b16 v[34:35], v104 offset:4096
    ds_read_b64_tr_b16 v[36:37], v105
    ds_read_b64_tr_b16 v[38:39], v105 offset:4096
    ds_read_b64_tr_b16 v[40:41], v106
    ds_read_b64_tr_b16 v[42:43], v106 offset:4096
    ds_read_b64_tr_b16 v[44:45], v107
    ds_read_b64_tr_b16 v[46:47], v107 offset:4096
    ds_read_b64_tr_b16 v[48:49], v108
    ds_read_b64_tr_b16 v[50:51], v108 offset:4096
    ds_read_b64_tr_b16 v[52:53], v109
    ds_read_b64_tr_b16 v[54:55], v109 offset:4096
    ds_read_b64_tr_b16 v[56:57], v110
    ds_read_b64_tr_b16 v[58:59], v110 offset:4096
    s_waitcnt lgkmcnt(12)
    v_mfma_f32_16x16x32_bf16 v[72:75], v[112:115], v[32:35], v[72:75]
    ds_read_b64_tr_b16 v[60:61], v111
    ds_read_b64_tr_b16 v[62:63], v111 offset:4096
    s_waitcnt lgkmcnt(12)
    v_mfma_f32_16x16x32_bf16 v[76:79], v[112:115], v[36:39], v[76:79]
    s_waitcnt lgkmcnt(10)
    v_mfma_f32_16x16x32_bf16 v[80:83], v[112:115], v[40:43], v[80:83]
    s_waitcnt lgkmcnt(8)
    v_mfma_f32_16x16x32_bf16 v[84:87], v[112:115], v[44:47], v[84:87]
    s_waitcnt lgkmcnt(6)
    v_mfma_f32_16x16x32_bf16 v[88:91], v[112:115], v[48:51], v[88:91]
    s_waitcnt lgkmcnt(4)
    v_mfma_f32_16x16x32_bf16 v[92:95], v[112:115], v[52:55], v[92:95]
    s_waitcnt lgkmcnt(2)
    v_mfma_f32_16x16x32_bf16 v[96:99], v[112:115], v[56:59], v[96:99]
    s_waitcnt lgkmcnt(0)
    v_mfma_f32_16x16x32_bf16 v[100:103], v[112:115], v[60:63], v[100:103]
    v_mov_b32 v8, s62
    v_mov_b32 v9, 1
    s_mov_b64 exec, 1
    ds_add_u32 v8, v9
    s_mov_b64 exec, -1
    s_add_u32 s69, s69, 4
    s_cmp_ge_u32 s69, 16
    s_cselect_b32 s7, 16, 0
    s_sub_u32 s69, s69, s7
    s_add_u32 s70, s70, 32
    s_sub_u32 s71, s71, 1
    s_cmp_lg_u32 s71, 0
    s_cbranch_scc1 AV_95
    v_mov_b32_dpp v72, v88 quad_perm:[0,1,2,3] row_mask:0x2 bank_mask:0xf
    v_mov_b32_dpp v76, v92 quad_perm:[0,1,2,3] row_mask:0x2 bank_mask:0xf
    v_mov_b32_dpp v80, v96 quad_perm:[0,1,2,3] row_mask:0x2 bank_mask:0xf
    v_mov_b32_dpp v84, v100 quad_perm:[0,1,2,3] row_mask:0x2 bank_mask:0xf
    v_mul_f32 v72, s72, v72
    v_mul_f32 v76, s72, v76
    v_mul_f32 v80, s72, v80
    v_mul_f32 v84, s72, v84
    v_cvt_pk_bf16_f32 v68, v72, v76
    v_cvt_pk_bf16_f32 v69, v80, v84
    s_mov_b64 exec, 0xffffffff
    s_cmp_eq_u32 s101, 0
    s_cbranch_scc1 SU_100
    buffer_store_dwordx4 v[68:71], v6, s[36:39], 0 offen
SV_101:
    s_mov_b64 exec, -1
    v_mov_b32 v8, 0x24214
    v_mov_b32 v9, 1
    s_mov_b64 exec, 1
    ds_add_u32 v8, v9
    s_mov_b64 exec, -1
    s_endpgm
L_ASVC:
    v_bfe_u32 v24, v1, 2, 2
    v_lshl_add_u32 v4, v24, 4, v2
    v_lshlrev_b32 v4, 8, v4
    v_and_b32 v25, 1, v2
    v_lshl_or_b32 v24, v24, 1, v25
    s_lshl_b32 s7, s61, 1
    v_xor_b32 v24, s7, v24
    v_lshl_add_u32 v4, v24, 5, v4
    v_and_b32 v24, 3, v1
    v_lshl_add_u32 v4, v24, 3, v4
    v_add_u32 v4, 0x0, v4
    v_xor_b32 v9, 32, v4
    v_lshlrev_b32 v8, 16, v24
    v_and_b32 v26, 4, v1
    v_lshl_add_u32 v8, v26, 4, v8
    v_lshl_add_u32 v8, v2, 4, v8
    s_lshl_b32 s7, s5, 2
    s_add_u32 s7, s7, s61
    s_lshl_b32 s7, s7, 5
    s_add_u32 s7, s7, s4
    s_lshl_b32 s7, s7, 7
    s_add_u32 s7, s7, 0x280000
    v_add_u32 v8, s7, v8
    v_cmp_gt_u32 s[84:85], 8, v3
    s_lshl_b32 s7, s4, 15
    s_lshl_b32 s62, s61, 9
    s_add_u32 s7, s7, s62
    s_add_u32 s7, s7, 0x100000
    v_and_b32 v26, 31, v1
    v_lshl_add_u32 v5, v26, 4, s7
    v_lshrrev_b32 v26, 5, v1
    v_lshl_add_u32 v5, v26, 11, v5
    s_mul_i32 s7, s61, 320
    s_add_u32 s7, s7, 0x26600
    v_lshl_add_u32 v6, v3, 4, s7
    v_lshl_add_u32 v6, v25, 3, v6
    v_lshl_add_u32 v6, v26, 2, v6
    v_mul_u32_u24 v7, 320, v24
    v_lshl_add_u32 v7, v2, 4, v7
    v_add_u32 v7, 0x26600, v7
    s_or_b64 s[94:95], s[92:93], 1
    v_mov_b32 v18, s92
    v_mov_b32 v19, s93
    s_mov_b32 s62, 4096
    s_mov_b32 s63, 8192
    s_mov_b32 s70, 0x3f80
    s_mov_b32 s71, 0x3f800000
    v_mov_b32 v28, 0x24214
    s_mov_b32 s80, 1600000
LW_102:
    ds_read_b32 v29, v28
    s_waitcnt lgkmcnt(0)
    v_readfirstlane_b32 s79, v29
    s_cmp_ge_u32 s79, 4
    s_cbranch_scc1 LWD_103
    s_sleep 2
    s_sub_u32 s80, s80, 1
    s_cmp_lg_u32 s80, 0
    s_cbranch_scc1 LW_102
LWD_103:
    s_setprio 2
    s_mov_b64 exec, -1
    buffer_load_dwordx4 v[112:115], v5, s[36:39], 0 offen sc1 nt
    buffer_load_dwordx4 v[116:119], v5, s[36:39], s62 offen sc1 nt
    buffer_load_dwordx4 v[120:123], v5, s[36:39], s63 offen sc1 nt
    v_mov_b32 v28, 0x24000
    s_mov_b32 s80, 1600000
LW_107:
    ds_read_b32 v29, v28
    s_waitcnt lgkmcnt(0)
    v_readfirstlane_b32 s79, v29
    s_cmp_ge_u32 s79, 416
    s_cbranch_scc1 LWD_108
    s_sub_u32 s80, s80, 1
    s_cmp_lg_u32 s80, 0
    s_cbranch_scc1 LW_107
LWD_108:
    ds_read_b64_tr_b16 v[32:33], v4 offset:0
    ds_read_b64_tr_b16 v[34:35], v4 offset:16384
    ds_read_b64_tr_b16 v[48:49], v9 offset:0
    ds_read_b64_tr_b16 v[50:51], v9 offset:16384
    ds_read_b64_tr_b16 v[36:37], v4 offset:1024
    ds_read_b64_tr_b16 v[38:39], v4 offset:17408
    ds_read_b64_tr_b16 v[52:53], v9 offset:1024
    ds_read_b64_tr_b16 v[54:55], v9 offset:17408
    ds_read_b64_tr_b16 v[40:41], v4 offset:2048
    ds_read_b64_tr_b16 v[42:43], v4 offset:18432
    ds_read_b64_tr_b16 v[56:57], v9 offset:2048
    ds_read_b64_tr_b16 v[58:59], v9 offset:18432
    ds_read_b64_tr_b16 v[44:45], v4 offset:3072
    ds_read_b64_tr_b16 v[46:47], v4 offset:19456
    ds_read_b64_tr_b16 v[60:61], v9 offset:3072
    ds_read_b64_tr_b16 v[62:63], v9 offset:19456
    s_mov_b32 s80, 200000
MC_105:
    s_mov_b64 exec, -1
    s_waitcnt vmcnt(0)
    v_cmp_ne_u64 s[64:65], s[94:95], v[114:115]
    v_cmp_ne_u64 s[66:67], s[94:95], v[118:119]
    v_cmp_ne_u64 s[68:69], s[94:95], v[122:123]
    s_or_b64 s[90:91], s[64:65], s[66:67]
    s_or_b64 s[90:91], s[90:91], s[68:69]
    s_cbranch_scc1 M_104
MD_106:
    s_mov_b64 exec, -1
    v_dot2_f32_bf16 v104, v112, s70, 0
    v_dot2_f32_bf16 v105, v112, s71, 0
    v_dot2_f32_bf16 v106, v113, s70, 0
    v_dot2_f32_bf16 v107, v113, s71, 0
    v_dot2_f32_bf16 v104, v116, s70, v104
    v_dot2_f32_bf16 v105, v116, s71, v105
    v_dot2_f32_bf16 v106, v117, s70, v106
    v_dot2_f32_bf16 v107, v117, s71, v107
    v_dot2_f32_bf16 v104, v120, s70, v104
    v_dot2_f32_bf16 v105, v120, s71, v105
    v_dot2_f32_bf16 v106, v121, s70, v106
    v_dot2_f32_bf16 v107, v121, s71, v107
    s_nop 1
    v_permlane32_swap_b32 v104, v106
    v_permlane32_swap_b32 v105, v107
    v_add_f32 v104, v104, v106
    v_add_f32 v105, v105, v107
    v_cvt_pk_bf16_f32 v104, v104, v105
    ds_write_b32 v6, v104
    s_add_u32 s81, s81, 4
    v_mov_b32 v24, 0x2420c
    v_mov_b32 v25, 1
    s_mov_b64 exec, 1
    ds_add_u32 v24, v25
    s_mov_b64 exec, -1
    v_mov_b32 v24, 0x2420c
    s_mov_b32 s80, 1600000
LW_109:
    ds_read_b32 v25, v24
    s_waitcnt lgkmcnt(0)
    v_readfirstlane_b32 s79, v25
    s_cmp_ge_u32 s79, s81
    s_cbranch_scc1 LWD_110
    s_sub_u32 s80, s80, 1
    s_cmp_lg_u32 s80, 0
    s_cbranch_scc1 LW_109
LWD_110:
    ds_read_b128 v[64:67], v7 offset:0
    ds_read_b128 v[68:71], v7 offset:64
    ds_read_b128 v[72:75], v7 offset:128
    ds_read_b128 v[76:79], v7 offset:192
    s_waitcnt lgkmcnt(3)
    v_mfma_f32_16x16x32_bf16 v[96:99], v[32:35], v[64:67], 0
    v_mfma_f32_16x16x32_bf16 v[100:103], v[48:51], v[64:67], 0
    s_waitcnt lgkmcnt(2)
    v_mfma_f32_16x16x32_bf16 v[96:99], v[36:39], v[68:71], v[96:99]
    v_mfma_f32_16x16x32_bf16 v[100:103], v[52:55], v[68:71], v[100:103]
    s_waitcnt lgkmcnt(1)
    v_mfma_f32_16x16x32_bf16 v[96:99], v[40:43], v[72:75], v[96:99]
    v_mfma_f32_16x16x32_bf16 v[100:103], v[56:59], v[72:75], v[100:103]
    s_waitcnt lgkmcnt(0)
    v_mfma_f32_16x16x32_bf16 v[96:99], v[44:47], v[76:79], v[96:99]
    v_mfma_f32_16x16x32_bf16 v[100:103], v[60:63], v[76:79], v[100:103]
    s_nop 6
    v_cvt_pk_bf16_f32 v16, v96, v97
    v_cvt_pk_bf16_f32 v17, v98, v99
    v_cvt_pk_bf16_f32 v104, v100, v101
    v_cvt_pk_bf16_f32 v105, v102, v103
    s_nop 0
    v_mov_b32_dpp v16, v104 quad_perm:[0,1,2,3] row_mask:0xf bank_mask:0x2
    v_mov_b32_dpp v17, v105 quad_perm:[0,1,2,3] row_mask:0xf bank_mask:0x2
    s_mov_b64 exec, s[84:85]
    buffer_store_dwordx4 v[16:19], v8, s[36:39], 0 offen sc1
    s_mov_b64 exec, -1
    s_branch L_RED
L_QABS:
    s_and_b32 s61, s6, 3
    s_waitcnt lgkmcnt(0)
    s_mov_b32 s36, s34
    s_and_b32 s37, s35, 0xffff
    s_mov_b32 s38, 0x1000000
    s_mov_b32 s39, 0x20000
    s_barrier
    s_cmp_ge_u32 s5, 6
    s_cbranch_scc1 L_BATT
    v_and_b32 v8, 3, v1
    v_lshlrev_b32 v5, 15, v8
    v_lshl_add_u32 v5, v2, 3, v5
    v_lshrrev_b32 v10, 2, v3
    v_lshl_add_u32 v5, v10, 5, v5
    s_lshl_b32 s7, s4, 1
    s_add_u32 s7, s7, s5
    s_lshl_b32 s7, s7, 2
    s_add_u32 s7, s7, s61
    s_lshl_b32 s7, s7, 7
    s_sub_u32 s7, s7, 2048
    v_add_u32 v5, s7, v5
    s_or_b32 s95, s95, s78
    s_add_u32 s72, s94, 0x10000
    s_addc_u32 s73, s95, 0
    s_lshl_b32 s7, s4, 15
    s_lshl_b32 s63, s61, 9
    s_add_u32 s7, s7, s63
    s_add_u32 s7, s7, 0x104000
    v_and_b32 v20, 31, v1
    v_lshl_add_u32 v7, v20, 4, s7
    v_lshrrev_b32 v21, 5, v1
    v_lshl_add_u32 v7, v21, 11, v7
    v_add_u32 v22, 4096, v7
    s_mul_i32 s7, s61, 320
    s_add_u32 s63, s7, 0x24900
    v_lshl_add_u32 v6, v20, 3, s63
    v_lshl_add_u32 v6, v21, 2, v6
    s_mov_b32 s70, 0x3f80
    s_mov_b32 s71, 0x3f800000
    v_xor_b32 v10, v3, v2
    v_lshlrev_b32 v10, 4, v10
    v_lshl_add_u32 v10, v3, 8, v10
    s_lshl_b32 s7, s61, 14
    s_add_u32 s7, s7, 0x10000
    v_add_u32 v10, s7, v10
    s_lshl_b32 s65, s61, 4
    s_add_u32 s65, s65, 16
    s_and_b32 s64, s61, 2
    s_lshl_b32 s64, s64, 1
    s_add_u32 s64, s64, 0x24108
    v_mul_u32_u24 v9, 320, v8
    v_lshl_add_u32 v9, v2, 4, v9
    v_add_u32 v9, 0x24900, v9
    v_mov_b32 v12, 0x24000
    s_mov_b32 s80, 1600000
LW_112:
    ds_read_b32 v13, v12
    s_waitcnt lgkmcnt(0)
    v_readfirstlane_b32 s79, v13
    s_cmp_ge_u32 s79, 40
    s_cbranch_scc1 LWD_113
    s_sleep 1
    s_sub_u32 s80, s80, 1
    s_cmp_lg_u32 s80, 0
    s_cbranch_scc1 LW_112
LWD_113:
    s_mov_b64 exec, -1
    buffer_load_dwordx4 v[48:51], v7, s[36:39], 0 offen sc1 nt
    buffer_load_dwordx4 v[52:55], v22, s[36:39], 0 offen sc1 nt
    s_mov_b32 s80, 200000
MC_115:
    s_mov_b64 exec, -1
    s_waitcnt vmcnt(0)
    v_cmp_gt_u64 s[44:45], s[94:95], v[50:51]
    v_cmp_le_u64 vcc, s[72:73], v[50:51]
    s_or_b64 s[44:45], s[44:45], vcc
    v_cmp_gt_u64 s[46:47], s[94:95], v[54:55]
    v_cmp_le_u64 vcc, s[72:73], v[54:55]
    s_or_b64 s[46:47], s[46:47], vcc
    s_or_b64 s[90:91], s[44:45], s[46:47]
    s_cbranch_scc1 M_114
MD_116:
    s_mov_b64 exec, -1
    v_dot2_f32_bf16 v24, v48, s70, 0
    v_dot2_f32_bf16 v25, v48, s71, 0
    v_dot2_f32_bf16 v26, v49, s70, 0
    v_dot2_f32_bf16 v27, v49, s71, 0
    v_dot2_f32_bf16 v24, v52, s70, v24
    v_dot2_f32_bf16 v25, v52, s71, v25
    v_dot2_f32_bf16 v26, v53, s70, v26
    v_dot2_f32_bf16 v27, v53, s71, v27
    s_nop 1
    v_permlane32_swap_b32 v24, v26
    v_permlane32_swap_b32 v25, v27
    v_add_f32 v24, v24, v26
    v_add_f32 v25, v25, v27
    v_cvt_pk_bf16_f32 v24, v24, v25
    ds_write_b32 v6, v24
    v_mov_b32 v48, 0x24208
    v_mov_b32 v49, 1
    s_mov_b64 exec, 1
    ds_add_u32 v48, v49
    s_mov_b64 exec, -1
    v_mov_b32 v12, 0x24000
    s_mov_b32 s80, 1600000
LW_117:
    ds_read_b32 v13, v12
    s_waitcnt lgkmcnt(0)
    v_readfirstlane_b32 s79, v13
    s_cmp_ge_u32 s79, s65
    s_cbranch_scc1 LWD_118
    s_sub_u32 s80, s80, 1
    s_cmp_lg_u32 s80, 0
    s_cbranch_scc1 LW_117
LWD_118:
    v_xor_b32 v11, 0x0, v10
    ds_read_b128 v[64:67], v11 offset:0
    ds_read_b128 v[80:83], v11 offset:4096
    ds_read_b128 v[96:99], v11 offset:8192
    ds_read_b128 v[112:115], v11 offset:12288
    v_xor_b32 v11, 0x40, v10
    ds_read_b128 v[68:71], v11 offset:0
    ds_read_b128 v[84:87], v11 offset:4096
    ds_read_b128 v[100:103], v11 offset:8192
    ds_read_b128 v[116:119], v11 offset:12288
    v_xor_b32 v11, 0x80, v10
    ds_read_b128 v[72:75], v11 offset:0
    ds_read_b128 v[88:91], v11 offset:4096
    ds_read_b128 v[104:107], v11 offset:8192
    ds_read_b128 v[120:123], v11 offset:12288
    v_xor_b32 v11, 0xc0, v10
    ds_read_b128 v[76:79], v11 offset:0
    ds_read_b128 v[92:95], v11 offset:4096
    ds_read_b128 v[108:111], v11 offset:8192
    ds_read_b128 v[124:127], v11 offset:12288
    v_mov_b32 v12, s64
    v_mov_b32 v13, 2
    s_mov_b64 exec, 1
    ds_add_u32 v12, v13
    s_mov_b64 exec, -1
    v_mov_b32 v12, 0x24208
    s_mov_b32 s80, 1600000
LW_119:
    ds_read_b32 v13, v12
    s_waitcnt lgkmcnt(0)
    v_readfirstlane_b32 s79, v13
    s_cmp_ge_u32 s79, 20
    s_cbranch_scc1 LWD_120
    s_sub_u32 s80, s80, 1
    s_cmp_lg_u32 s80, 0
    s_cbranch_scc1 LW_119
LWD_120:
    ds_read_b128 v[48:51], v9 offset:0
    ds_read_b128 v[52:55], v9 offset:64
    ds_read_b128 v[56:59], v9 offset:128
    ds_read_b128 v[60:63], v9 offset:192
    s_waitcnt lgkmcnt(3)
    v_mfma_f32_16x16x32_bf16 v[128:131], v[64:67], v[48:51], 0
    v_mfma_f32_16x16x32_bf16 v[132:135], v[80:83], v[48:51], 0
    v_mfma_f32_16x16x32_bf16 v[136:139], v[96:99], v[48:51], 0
    v_mfma_f32_16x16x32_bf16 v[140:143], v[112:115], v[48:51], 0
    s_waitcnt lgkmcnt(2)
    v_mfma_f32_16x16x32_bf16 v[128:131], v[68:71], v[52:55], v[128:131]
    v_mfma_f32_16x16x32_bf16 v[132:135], v[84:87], v[52:55], v[132:135]
    v_mfma_f32_16x16x32_bf16 v[136:139], v[100:103], v[52:55], v[136:139]
    v_mfma_f32_16x16x32_bf16 v[140:143], v[116:119], v[52:55], v[140:143]
    s_waitcnt lgkmcnt(1)
    v_mfma_f32_16x16x32_bf16 v[128:131], v[72:75], v[56:59], v[128:131]
    v_mfma_f32_16x16x32_bf16 v[132:135], v[88:91], v[56:59], v[132:135]
    v_mfma_f32_16x16x32_bf16 v[136:139], v[104:107], v[56:59], v[136:139]
    v_mfma_f32_16x16x32_bf16 v[140:143], v[120:123], v[56:59], v[140:143]
    s_waitcnt lgkmcnt(0)
    v_mfma_f32_16x16x32_bf16 v[128:131], v[76:79], v[60:63], v[128:131]
    v_mfma_f32_16x16x32_bf16 v[132:135], v[92:95], v[60:63], v[132:135]
    v_mfma_f32_16x16x32_bf16 v[136:139], v[108:111], v[60:63], v[136:139]
    v_mfma_f32_16x16x32_bf16 v[140:143], v[124:127], v[60:63], v[140:143]
    s_nop 4
    v_cvt_pk_bf16_f32 v24, v128, v129
    v_cvt_pk_bf16_f32 v25, v130, v131
    v_cvt_pk_bf16_f32 v26, v132, v133
    v_cvt_pk_bf16_f32 v27, v134, v135
    v_cvt_pk_bf16_f32 v28, v136, v137
    v_cvt_pk_bf16_f32 v29, v138, v139
    v_cvt_pk_bf16_f32 v30, v140, v141
    v_cvt_pk_bf16_f32 v31, v142, v143
    v_mov_b32_dpp v24, v26 quad_perm:[0,1,2,3] row_mask:0xf bank_mask:0x2
    v_mov_b32_dpp v25, v27 quad_perm:[0,1,2,3] row_mask:0xf bank_mask:0x2
    v_mov_b32_dpp v24, v28 quad_perm:[0,1,2,3] row_mask:0xf bank_mask:0x4
    v_mov_b32_dpp v25, v29 quad_perm:[0,1,2,3] row_mask:0xf bank_mask:0x4
    v_mov_b32_dpp v24, v30 quad_perm:[0,1,2,3] row_mask:0xf bank_mask:0x8
    v_mov_b32_dpp v25, v31 quad_perm:[0,1,2,3] row_mask:0xf bank_mask:0x8
    buffer_store_dwordx2 v[24:25], v5, s[36:39], 0 offen sc1
    v_mov_b32 v48, 0x24208
    v_mov_b32 v49, 32
    s_mov_b64 exec, 1
    ds_add_u32 v48, v49
    s_mov_b64 exec, -1
L_ESVC:
    v_lshrrev_b32 v160, 2, v1
    v_bfe_u32 v161, v1, 3, 2
    v_xor_b32 v161, s61, v161
    v_lshlrev_b32 v161, 5, v161
    v_lshl_add_u32 v161, v160, 7, v161
    v_and_b32 v162, 3, v1
    v_lshl_add_u32 v161, v162, 3, v161
    s_lshl_b32 s7, s61, 8
    s_lshl_b32 s62, s4, 10
    s_add_u32 s7, s7, s62
    s_add_u32 s7, s7, 0x30000
    v_and_b32 v164, 1, v1
    v_lshl_add_u32 v4, v164, 7, s7
    s_lshl_b32 s7, s4, 13
    s_lshl_b32 s62, s61, 11
    s_add_u32 s7, s7, s62
    s_add_u32 s7, s7, 0x200000
    v_lshl_add_u32 v5, v1, 4, s7
    s_mul_i32 s7, s61, 1088
    s_add_u32 s7, s7, 0x26600
    v_lshl_add_u32 v6, v160, 6, s7
    v_lshl_add_u32 v6, v164, 5, v6
    v_and_b32 v164, 2, v1
    v_lshl_add_u32 v6, v164, 2, v6
    v_mul_u32_u24 v7, 1088, v162
    v_lshl_add_u32 v7, v2, 4, v7
    v_add_u32 v7, 0x26600, v7
    v_cmp_gt_u32 s[84:85], 4, v3
    s_and_b32 s62, s4, 7
    s_lshl_b32 s62, s62, 3
    s_lshr_b32 s7, s4, 3
    s_lshl_b32 s7, s7, 1
    s_add_u32 s62, s62, s7
    s_add_u32 s62, s62, s5
    s_sub_u32 s62, s62, 6
    s_add_u32 s62, s62, 2
    s_lshl_b32 s7, s62, 10
    s_lshl_b32 s64, s61, 8
    s_add_u32 s7, s7, s64
    s_add_u32 s7, s7, 0xc0000
    v_lshl_add_u32 v10, v162, 6, s7
    v_lshl_add_u32 v10, v2, 4, v10
    s_lshr_b32 s7, s62, 3
    s_lshl_b32 s7, s7, 7
    s_add_u32 s7, s7, 0x22000
    v_and_b32 v164, 7, v1
    v_lshl_add_u32 v9, v164, 3, s7
    v_mov_b32 v16, 0x24204
    s_mov_b32 s80, 1600000
LW_121:
    ds_read_b32 v17, v16
    s_waitcnt lgkmcnt(0)
    v_readfirstlane_b32 s79, v17
    s_cmp_ge_u32 s79, 1
    s_cbranch_scc1 LWD_122
    s_sleep 1
    s_sub_u32 s80, s80, 1
    s_cmp_lg_u32 s80, 0
    s_cbranch_scc1 LW_121
LWD_122:
    v_mov_b32 v16, 0x24248
    ds_read_b64 v[18:19], v16
    s_waitcnt lgkmcnt(0)
    v_readfirstlane_b32 s92, v18
    v_readfirstlane_b32 s93, v19
    v_mov_b32 v16, 0x24000
    s_mov_b32 s80, 1600000
LW_123:
    ds_read_b32 v17, v16
    s_waitcnt lgkmcnt(0)
    v_readfirstlane_b32 s79, v17
    s_cmp_ge_u32 s79, 96
    s_cbranch_scc1 LWD_124
    s_sleep 4
    s_sub_u32 s80, s80, 1
    s_cmp_lg_u32 s80, 0
    s_cbranch_scc1 LW_123
LWD_124:
    s_or_b32 s95, s95, s78
    s_add_u32 s88, s94, 0x10000
    s_addc_u32 s89, s95, 0
    s_mov_b32 s101, 4
    s_mov_b64 exec, 0xff
U_125:
    buffer_load_dwordx2 v[16:17], v9, s[36:39], 0 offen sc1 nt
UU_126:
    s_waitcnt vmcnt(0)
    v_cmp_gt_u64 s[90:91], s[94:95], v[16:17]
    v_cmp_le_u64 vcc, s[88:89], v[16:17]
    s_or_b64 vcc, vcc, s[90:91]
    s_cbranch_scc0 UD_127
    s_sleep 8
    s_sub_u32 s101, s101, 1
    s_cmp_lg_u32 s101, 0
    s_cbranch_scc1 U_125
UD_127:
    s_mov_b64 exec, -1
    v_mov_b32 v16, 0x24000
    s_mov_b32 s80, 1600000
LW_128:
    ds_read_b32 v17, v16
    s_waitcnt lgkmcnt(0)
    v_readfirstlane_b32 s79, v17
    s_cmp_ge_u32 s79, 128
    s_cbranch_scc1 LWD_129
    s_sleep 4
    s_sub_u32 s80, s80, 1
    s_cmp_lg_u32 s80, 0
    s_cbranch_scc1 LW_128
LWD_129:
    ds_read_b64_tr_b16 v[32:33], v161 offset:0
    ds_read_b64_tr_b16 v[34:35], v161 offset:2048
    ds_read_b64_tr_b16 v[36:37], v161 offset:4096
    ds_read_b64_tr_b16 v[38:39], v161 offset:6144
    ds_read_b64_tr_b16 v[40:41], v161 offset:8192
    ds_read_b64_tr_b16 v[42:43], v161 offset:10240
    ds_read_b64_tr_b16 v[44:45], v161 offset:12288
    ds_read_b64_tr_b16 v[46:47], v161 offset:14336
    s_waitcnt lgkmcnt(4)
    ds_read_b64_tr_b16 v[48:49], v161 offset:16384
    ds_read_b64_tr_b16 v[50:51], v161 offset:18432
    ds_read_b64_tr_b16 v[52:53], v161 offset:20480
    ds_read_b64_tr_b16 v[54:55], v161 offset:22528
    ds_read_b64_tr_b16 v[56:57], v161 offset:24576
    ds_read_b64_tr_b16 v[58:59], v161 offset:26624
    ds_read_b64_tr_b16 v[60:61], v161 offset:28672
    ds_read_b64_tr_b16 v[62:63], v161 offset:30720
    s_waitcnt lgkmcnt(4)
    ds_read_b64_tr_b16 v[64:65], v161 offset:32768
    ds_read_b64_tr_b16 v[66:67], v161 offset:34816
    ds_read_b64_tr_b16 v[68:69], v161 offset:36864
    ds_read_b64_tr_b16 v[70:71], v161 offset:38912
    ds_read_b64_tr_b16 v[72:73], v161 offset:40960
    ds_read_b64_tr_b16 v[74:75], v161 offset:43008
    ds_read_b64_tr_b16 v[76:77], v161 offset:45056
    ds_read_b64_tr_b16 v[78:79], v161 offset:47104
    s_waitcnt lgkmcnt(4)
    ds_read_b64_tr_b16 v[80:81], v161 offset:49152
    ds_read_b64_tr_b16 v[82:83], v161 offset:51200
    ds_read_b64_tr_b16 v[84:85], v161 offset:53248
    ds_read_b64_tr_b16 v[86:87], v161 offset:55296
    ds_read_b64_tr_b16 v[88:89], v161 offset:57344
    ds_read_b64_tr_b16 v[90:91], v161 offset:59392
    ds_read_b64_tr_b16 v[92:93], v161 offset:61440
    ds_read_b64_tr_b16 v[94:95], v161 offset:63488
    s_waitcnt lgkmcnt(4)
    v_lshlrev_b32 v16, 2, v1
    v_add_u32 v16, 0x24100, v16
    v_mov_b32 v17, 1
    s_mov_b64 exec, 3
    ds_add_u32 v16, v17
    s_mov_b64 exec, -1
    s_lshl_b32 s7, s62, 2
    s_add_u32 s7, s7, s61
    s_lshl_b32 s7, s7, 13
    s_add_u32 s7, s7, 0x600000
    v_lshl_add_u32 v8, v1, 7, s7
    buffer_load_dword v8, v8, s[36:39], 0 offen sc1 nt
    s_and_b32 s7, s4, 7
    s_lshl_b32 s7, s7, 12
    s_add_u32 s7, s7, 0x28008
    v_lshl_add_u32 v9, v1, 9, s7
    s_mov_b64 exec, 3
    buffer_load_dwordx2 v[12:13], v4, s[36:39], 0 offen offset:16 sc1
    s_mov_b32 s80, 200000
MC_131:
    s_mov_b64 exec, 3
    s_waitcnt vmcnt(0)
    v_cmp_ne_u64 s[64:65], s[92:93], v[12:13]
    s_cmp_lg_u64 s[64:65], 0
    s_cbranch_scc1 M_130
MD_132:
    s_mov_b64 exec, -1
    s_cmp_eq_u32 s101, 0
    s_cbranch_scc1 EH_133
    s_mov_b64 exec, 0xff
    buffer_load_dwordx2 v[12:13], v9, s[36:39], 0 offen sc1 nt
    s_mov_b32 s80, 200000
MC_135:
    s_mov_b64 exec, 0xff
    s_waitcnt vmcnt(0)
    v_cmp_ne_u64 s[64:65], s[92:93], v[12:13]
    s_cmp_lg_u64 s[64:65], 0
    s_cbranch_scc1 M_134
MD_136:
    s_mov_b64 exec, -1
EH_133:
    s_sleep 25
    s_setprio 2
    s_mov_b64 exec, -1
    buffer_load_dwordx4 v[16:19], v5, s[36:39], 0 offen offset:0 sc1
    buffer_load_dwordx4 v[20:23], v5, s[36:39], 0 offen offset:1024 sc1
    buffer_load_dwordx4 v[12:15], v4, s[36:39], 0 offen sc1
    s_mov_b32 s80, 200000
MC_138:
    s_mov_b64 exec, -1
    s_waitcnt vmcnt(0)
    v_max3_u32 v160, v16, v17, v18
    v_max_u32 v160, v160, v19
    v_cmp_eq_u32 s[64:65], -1, v160
    v_max3_u32 v161, v20, v21, v22
    v_max_u32 v161, v161, v23
    v_cmp_eq_u32 s[66:67], -1, v161
    v_cmp_ne_u64 s[68:69], s[92:93], v[14:15]
    s_or_b64 s[90:91], s[64:65], s[66:67]
    s_or_b64 s[90:91], s[90:91], s[68:69]
    s_cbranch_scc1 M_137
MD_139:
    s_mov_b64 exec, -1
    v_readlane_b32 s74, v12, 0
    v_readlane_b32 s76, v13, 0
    v_readlane_b32 s75, v12, 1
    v_readlane_b32 s77, v13, 1
    v_mov_b32 v160, s74
    v_max_f32 v160, s75, v160
    v_sub_f32 v11, s74, v160
    v_sub_f32 v12, s75, v160
    v_exp_f32 v11, v11
    v_exp_f32 v12, v12
    v_mul_f32 v160, s76, v11
    v_fmac_f32 v160, s77, v12
    v_rcp_f32 v160, v160
    s_nop 0
    v_mul_f32 v11, v11, v160
    v_mul_f32 v12, v12, v160
    v_lshlrev_b32 v96, 16, v16
    v_and_b32 v97, 0xffff0000, v16
    v_lshlrev_b32 v98, 16, v17
    v_and_b32 v99, 0xffff0000, v17
    v_lshlrev_b32 v100, 16, v18
    v_and_b32 v101, 0xffff0000, v18
    v_lshlrev_b32 v102, 16, v19
    v_and_b32 v103, 0xffff0000, v19
    v_lshlrev_b32 v104, 16, v20
    v_and_b32 v105, 0xffff0000, v20
    v_lshlrev_b32 v106, 16, v21
    v_and_b32 v107, 0xffff0000, v21
    v_lshlrev_b32 v108, 16, v22
    v_and_b32 v109, 0xffff0000, v22
    v_lshlrev_b32 v110, 16, v23
    v_and_b32 v111, 0xffff0000, v23
    v_mul_f32 v96, v96, v11
    v_mul_f32 v97, v97, v11
    v_mul_f32 v98, v98, v11
    v_mul_f32 v99, v99, v11
    v_mul_f32 v100, v100, v11
    v_mul_f32 v101, v101, v11
    v_mul_f32 v102, v102, v11
    v_mul_f32 v103, v103, v11
    v_fmac_f32 v96, v104, v12
    v_fmac_f32 v97, v105, v12
    v_fmac_f32 v98, v106, v12
    v_fmac_f32 v99, v107, v12
    v_fmac_f32 v100, v108, v12
    v_fmac_f32 v101, v109, v12
    v_fmac_f32 v102, v110, v12
    v_fmac_f32 v103, v111, v12
    v_cvt_pk_bf16_f32 v24, v96, v97
    v_cvt_pk_bf16_f32 v25, v98, v99
    v_cvt_pk_bf16_f32 v26, v100, v101
    v_cvt_pk_bf16_f32 v27, v102, v103
    ds_write_b64 v6, v[24:25]
    ds_write_b64 v6, v[26:27] offset:16
    s_add_u32 s81, s81, 4
    v_mov_b32 v160, 0x2420c
    v_mov_b32 v161, 1
    s_mov_b64 exec, 1
    ds_add_u32 v160, v161
    s_mov_b64 exec, -1
    v_mov_b32 v160, 0x2420c
    s_mov_b32 s80, 1600000
LW_140:
    ds_read_b32 v161, v160
    s_waitcnt lgkmcnt(0)
    v_readfirstlane_b32 s79, v161
    s_cmp_ge_u32 s79, s81
    s_cbranch_scc1 LWD_141
    s_sub_u32 s80, s80, 1
    s_cmp_lg_u32 s80, 0
    s_cbranch_scc1 LW_140
LWD_141:
    ds_read_b128 v[96:99], v7 offset:0
    ds_read_b128 v[100:103], v7 offset:64
    ds_read_b128 v[104:107], v7 offset:128
    ds_read_b128 v[108:111], v7 offset:192
    ds_read_b128 v[112:115], v7 offset:256
    ds_read_b128 v[116:119], v7 offset:320
    ds_read_b128 v[120:123], v7 offset:384
    ds_read_b128 v[124:127], v7 offset:448
    ds_read_b128 v[128:131], v7 offset:512
    ds_read_b128 v[132:135], v7 offset:576
    ds_read_b128 v[136:139], v7 offset:640
    ds_read_b128 v[140:143], v7 offset:704
    v_mov_b32 v18, s92
    v_mov_b32 v19, s93
    s_waitcnt lgkmcnt(8)
    ds_read_b128 v[144:147], v7 offset:768
    ds_read_b128 v[148:151], v7 offset:832
    ds_read_b128 v[152:155], v7 offset:896
    ds_read_b128 v[156:159], v7 offset:960
    v_mfma_f32_16x16x32_bf16 v[12:15], v[32:35], v[96:99], 0
    v_mfma_f32_16x16x32_bf16 v[12:15], v[36:39], v[100:103], v[12:15]
    v_mfma_f32_16x16x32_bf16 v[12:15], v[40:43], v[104:107], v[12:15]
    v_mfma_f32_16x16x32_bf16 v[12:15], v[44:47], v[108:111], v[12:15]
    s_waitcnt lgkmcnt(11)
    v_mfma_f32_16x16x32_bf16 v[12:15], v[48:51], v[112:115], v[12:15]
    s_waitcnt lgkmcnt(10)
    v_mfma_f32_16x16x32_bf16 v[12:15], v[52:55], v[116:119], v[12:15]
    s_waitcnt lgkmcnt(9)
    v_mfma_f32_16x16x32_bf16 v[12:15], v[56:59], v[120:123], v[12:15]
    s_waitcnt lgkmcnt(8)
    v_mfma_f32_16x16x32_bf16 v[12:15], v[60:63], v[124:127], v[12:15]
    s_waitcnt lgkmcnt(7)
    v_mfma_f32_16x16x32_bf16 v[12:15], v[64:67], v[128:131], v[12:15]
    s_waitcnt lgkmcnt(6)
    v_mfma_f32_16x16x32_bf16 v[12:15], v[68:71], v[132:135], v[12:15]
    s_waitcnt lgkmcnt(5)
    v_mfma_f32_16x16x32_bf16 v[12:15], v[72:75], v[136:139], v[12:15]
    s_waitcnt lgkmcnt(4)
    v_mfma_f32_16x16x32_bf16 v[12:15], v[76:79], v[140:143], v[12:15]
    s_waitcnt lgkmcnt(3)
    v_mfma_f32_16x16x32_bf16 v[12:15], v[80:83], v[144:147], v[12:15]
    s_waitcnt lgkmcnt(2)
    v_mfma_f32_16x16x32_bf16 v[12:15], v[84:87], v[148:151], v[12:15]
    s_waitcnt lgkmcnt(1)
    v_mfma_f32_16x16x32_bf16 v[12:15], v[88:91], v[152:155], v[12:15]
    s_waitcnt lgkmcnt(0)
    v_mfma_f32_16x16x32_bf16 v[12:15], v[92:95], v[156:159], v[12:15]
    s_nop 7
    v_cvt_pk_bf16_f32 v16, v12, v13
    v_cvt_pk_bf16_f32 v17, v14, v15
    s_mov_b64 exec, s[84:85]
    s_cmp_eq_u32 s101, 0
    s_cbranch_scc1 SU_142
    buffer_store_dwordx4 v[16:19], v10, s[36:39], 0 offen
SV_143:
    s_mov_b64 exec, -1
    s_branch L_RED
L_BATT:
    s_and_b32 s60, s4, 7
    s_lshl_b32 s60, s60, 3
    s_lshr_b32 s7, s4, 3
    s_lshl_b32 s7, s7, 1
    s_add_u32 s60, s60, s7
    s_add_u32 s60, s60, s5
    s_sub_u32 s60, s60, 6
    s_lshr_b32 s61, s6, 1
    s_and_b32 s62, s6, 1
    s_mov_b32 s64, 0x3e0293ee
    v_lshlrev_b32 v4, 10, v3
    v_lshl_add_u32 v4, v2, 8, v4
    v_lshl_add_u32 v0, v3, 4, v4
    s_lshl_b32 s7, s62, 14
    s_add_u32 s7, s7, 0x1c000
    v_add_u32 v0, s7, v0
    v_and_b32 v162, 3, v1
    v_lshl_add_u32 v4, v162, 6, v4
    v_bfe_u32 v162, v1, 2, 2
    v_lshl_add_u32 v4, v162, 4, v4
    s_lshl_b32 s7, s6, 7
    s_add_u32 s7, s7, 0x24400
    v_lshl_add_u32 v5, v3, 3, s7
    s_lshl_b32 s7, s61, 10
    s_lshl_b32 s63, s62, 8
    s_add_u32 s7, s7, s63
    s_add_u32 s7, s7, 0x26000
    v_lshl_add_u32 v6, v3, 4, s7
    v_lshrrev_b32 v163, 5, v1
    v_lshl_add_u32 v6, v163, 9, v6
    v_and_b32 v162, 1, v2
    v_lshl_add_u32 v6, v162, 3, v6
    v_lshlrev_b32 v7, 4, v1
    v_add_u32 v7, 0x26000, v7
    v_and_b32 v162, 31, v1
    v_lshlrev_b32 v8, 3, v162
    v_add_u32 v8, 0x24400, v8
    v_bfe_u32 v162, v1, 2, 2
    v_lshl_add_u32 v164, v163, 3, v162
    v_lshlrev_b32 v164, 10, v164
    v_and_b32 v165, 1, v1
    v_lshl_add_u32 v164, v165, 3, v164
    s_lshl_b32 s7, s61, 8
    v_add_u32 v164, s7, v164
    v_bfe_u32 v165, v1, 4, 1
    v_lshlrev_b32 v165, 1, v165
    v_bfe_u32 v160, v1, 1, 1
    v_or_b32 v165, v165, v160
    s_lshl_b32 s7, s62, 3
    v_or_b32 v165, s7, v165
    v_lshlrev_b32 v162, 2, v162
    v_xor_b32 v165, v165, v162
    v_lshlrev_b32 v163, 1, v163
    v_xor_b32 v165, v165, v163
    v_xor_b32 v160, 0, v165
    v_lshl_add_u32 v9, v160, 4, v164
    v_xor_b32 v160, 4, v165
    v_lshl_add_u32 v10, v160, 4, v164
    v_xor_b32 v160, 1, v165
    v_lshl_add_u32 v11, v160, 4, v164
    v_add_u32 v11, 0x1000, v11
    v_xor_b32 v160, 5, v165
    v_lshl_add_u32 v12, v160, 4, v164
    v_add_u32 v12, 0x1000, v12
    v_mov_b32 v13, 0xff800000
    s_mov_b64 s[84:85], 0xffff
    s_lshl_b32 s7, s60, 15
    s_lshl_b32 s63, s6, 12
    s_add_u32 s7, s7, s63
    s_add_u32 s7, s7, 0x600000
    v_lshl_add_u32 v152, v1, 4, s7
    buffer_store_dwordx4 v[0:3], v152, s[36:39], 0 offen offset:0
    buffer_store_dwordx4 v[0:3], v152, s[36:39], 0 offen offset:1024
    buffer_store_dwordx4 v[0:3], v152, s[36:39], 0 offen offset:2048
    buffer_store_dwordx4 v[0:3], v152, s[36:39], 0 offen offset:3072
    s_lshl_b32 s7, s6, 9
    s_add_u32 s7, s7, 0x20000
    v_and_b32 v144, 1, v1
    v_lshl_add_u32 v144, v144, 3, s7
    v_lshrrev_b32 v145, 1, v1
    v_lshl_add_u32 v144, v145, 7, v144
    s_lshr_b32 s7, s60, 4
    s_lshl_b32 s7, s7, 15
    s_add_u32 s7, s7, s63
    v_lshl_add_u32 v145, v1, 4, s7
    s_and_b32 s7, s6, 3
    s_lshl_b32 s7, s7, 6
    v_lshlrev_b32 v146, 4, v1
    v_xor_b32 v146, s7, v146
    s_add_u32 s7, s63, 0x1c000
    v_add_u32 v146, s7, v146
    v_xor_b32 v147, 0x10, v146
    v_xor_b32 v148, 0x20, v146
    v_xor_b32 v149, 0x30, v146
    s_lshl_b32 s66, s61, 4
    s_add_u32 s66, s66, 16
    s_mov_b32 s70, 64
    s_mov_b32 s71, 0x800080
    s_lshl_b32 s67, s61, 2
    s_or_b32 s67, s67, 0x40000
    s_mov_b32 s72, 0x6543210
    s_mov_b32 s73, 0x65487321
    s_mov_b32 s69, 4
    s_lshr_b32 s7, s60, 3
    s_lshl_b32 s7, s7, 7
    s_add_u32 s7, s7, 0x22000
    v_lshl_add_u32 v153, v1, 3, s7
    v_mov_b32 v160, 0x24000
    s_mov_b32 s80, 1600000
LW_144:
    ds_read_b32 v161, v160
    s_waitcnt lgkmcnt(0)
    v_readfirstlane_b32 s79, v161
    s_cmp_ge_u32 s79, 48
    s_cbranch_scc1 LWD_145
    s_sleep 2
    s_sub_u32 s80, s80, 1
    s_cmp_lg_u32 s80, 0
    s_cbranch_scc1 LW_144
LWD_145:
    s_mov_b64 exec, 0xff
    buffer_load_dwordx2 v[16:17], v144, s[36:39], 0 offen sc1
    buffer_load_dwordx2 v[18:19], v153, s[36:39], 0 offen sc1 nt
    s_mov_b64 exec, -1
    s_lshl_b32 s7, s61, 14
    v_add_u32 v14, s7, v4
    v_mov_b32 v160, 0x24000
    s_mov_b32 s80, 1600000
LW_149:
    ds_read_b32 v161, v160
    s_waitcnt lgkmcnt(0)
    v_readfirstlane_b32 s79, v161
    s_cmp_ge_u32 s79, 64
    s_cbranch_scc1 LWD_150
    s_sleep 2
    s_sub_u32 s80, s80, 1
    s_cmp_lg_u32 s80, 0
    s_cbranch_scc1 LW_149
LWD_150:
    v_xor_b32 v160, 0x0, v14
    ds_read_b128 v[32:35], v160
    v_xor_b32 v161, 0x10, v14
    ds_read_b128 v[36:39], v161
    v_xor_b32 v160, 0x20, v14
    ds_read_b128 v[40:43], v160
    v_xor_b32 v161, 0x30, v14
    ds_read_b128 v[44:47], v161
    v_xor_b32 v160, 0x40, v14
    ds_read_b128 v[48:51], v160
    v_xor_b32 v161, 0x50, v14
    ds_read_b128 v[52:55], v161
    v_xor_b32 v160, 0x60, v14
    ds_read_b128 v[56:59], v160
    v_xor_b32 v161, 0x70, v14
    ds_read_b128 v[60:63], v161
    v_xor_b32 v160, 0x80, v14
    ds_read_b128 v[64:67], v160
    v_xor_b32 v161, 0x90, v14
    ds_read_b128 v[68:71], v161
    v_xor_b32 v160, 0xa0, v14
    ds_read_b128 v[72:75], v160
    v_xor_b32 v161, 0xb0, v14
    ds_read_b128 v[76:79], v161
    v_xor_b32 v160, 0xc0, v14
    ds_read_b128 v[80:83], v160
    v_xor_b32 v161, 0xd0, v14
    ds_read_b128 v[84:87], v161
    v_xor_b32 v160, 0xe0, v14
    ds_read_b128 v[88:91], v160
    v_xor_b32 v161, 0xf0, v14
    ds_read_b128 v[92:95], v161
    s_bfe_u32 s7, s72, 0x40000
    s_lshl_b32 s7, s7, 14
    v_add_u32 v20, s7, v9
    v_add_u32 v21, s7, v10
    v_add_u32 v22, s7, v11
    v_add_u32 v23, s7, v12
    ds_read_b64_tr_b16 v[96:97], v20
    ds_read_b64_tr_b16 v[98:99], v22
    ds_read_b64_tr_b16 v[100:101], v21
    ds_read_b64_tr_b16 v[102:103], v23
    s_bfe_u32 s7, s72, 0x40004
    s_lshl_b32 s7, s7, 14
    v_add_u32 v24, s7, v9
    v_add_u32 v25, s7, v10
    v_add_u32 v26, s7, v11
    v_add_u32 v27, s7, v12
    ds_read_b64_tr_b16 v[104:105], v24
    ds_read_b64_tr_b16 v[106:107], v26
    ds_read_b64_tr_b16 v[108:109], v25
    ds_read_b64_tr_b16 v[110:111], v27
    s_bfe_u32 s7, s72, 0x40008
    s_lshl_b32 s7, s7, 14
    v_add_u32 v28, s7, v9
    v_add_u32 v29, s7, v10
    v_add_u32 v30, s7, v11
    v_add_u32 v31, s7, v12
    ds_read_b64_tr_b16 v[112:113], v28
    ds_read_b64_tr_b16 v[114:115], v30
    ds_read_b64_tr_b16 v[116:117], v29
    ds_read_b64_tr_b16 v[118:119], v31
    s_bfe_u32 s7, s72, 0x4000c
    s_lshl_b32 s7, s7, 14
    v_add_u32 v20, s7, v9
    v_add_u32 v21, s7, v10
    v_add_u32 v22, s7, v11
    v_add_u32 v23, s7, v12
    ds_read_b64_tr_b16 v[120:121], v20
    ds_read_b64_tr_b16 v[122:123], v22
    ds_read_b64_tr_b16 v[124:125], v21
    ds_read_b64_tr_b16 v[126:127], v23
    v_mov_b32 v162, 0x24100
    v_mov_b32 v163, 1
    s_mov_b64 exec, 1
    ds_add_u32 v162, v163
    s_mov_b64 exec, -1
    v_mov_b32 v160, 0x24204
    s_mov_b32 s80, 1600000
LW_151:
    ds_read_b32 v161, v160
    s_waitcnt lgkmcnt(0)
    v_readfirstlane_b32 s79, v161
    s_cmp_ge_u32 s79, 1
    s_cbranch_scc1 LWD_152
    s_sleep 1
    s_sub_u32 s80, s80, 1
    s_cmp_lg_u32 s80, 0
    s_cbranch_scc1 LW_151
LWD_152:
    v_mov_b32 v160, 0x24248
    ds_read_b64 v[162:163], v160
    s_waitcnt lgkmcnt(0)
    v_readfirstlane_b32 s92, v162
    v_readfirstlane_b32 s93, v163
    s_mov_b32 s80, 200000
MC_147:
    s_mov_b64 exec, 0xff
    s_waitcnt vmcnt(0)
    v_cmp_ne_u64 s[44:45], s[92:93], v[16:17]
    s_cmp_lg_u64 s[44:45], 0
    s_cbranch_scc1 M_146
MD_148:
    s_mov_b64 exec, -1
    s_or_b32 s95, s95, s78
    s_add_u32 s88, s94, 0x10000
    s_addc_u32 s89, s95, 0
    s_mov_b32 s101, 4
    s_mov_b64 exec, 0xff
    s_branch UU_154
U_153:
    buffer_load_dwordx2 v[18:19], v153, s[36:39], 0 offen sc1 nt
UU_154:
    s_waitcnt vmcnt(0)
    v_cmp_gt_u64 s[90:91], s[94:95], v[18:19]
    v_cmp_le_u64 vcc, s[88:89], v[18:19]
    s_or_b64 vcc, vcc, s[90:91]
    s_cbranch_scc0 UD_155
    s_sleep 8
    s_sub_u32 s101, s101, 1
    s_cmp_lg_u32 s101, 0
    s_cbranch_scc1 U_153
UD_155:
    s_mov_b64 exec, -1
    s_cmp_ge_u32 s6, 4
    s_cbranch_scc1 XC_156
    s_and_b32 s7, s60, 7
    s_lshl_b32 s7, s7, 2
    s_add_u32 s7, s7, s6
    s_lshl_b32 s7, s7, 3
    s_lshr_b32 s65, s60, 3
    s_add_u32 s7, s7, s65
    s_lshl_b32 s7, s7, 7
    s_add_u32 s7, s7, 0x30010
    v_mov_b32 v160, s7
    s_waitcnt vmcnt(0)
    s_mov_b64 exec, 1
    buffer_store_dwordx2 v[162:163], v160, s[36:39], 0 offen sc1
    s_mov_b64 exec, -1
XC_156:
    v_mov_b32 v160, 0x24000
    s_mov_b32 s80, 1600000
LW_157:
    ds_read_b32 v161, v160
    s_waitcnt lgkmcnt(0)
    v_readfirstlane_b32 s79, v161
    s_cmp_ge_u32 s79, 120
    s_cbranch_scc1 LWD_158
    s_sleep 1
    s_sub_u32 s80, s80, 1
    s_cmp_lg_u32 s80, 0
    s_cbranch_scc1 LW_157
LWD_158:
    s_mov_b64 exec, -1
    buffer_load_dwordx4 v[128:131], v145, s[36:39], 0 offen offset:0 sc1
    buffer_load_dwordx4 v[132:135], v145, s[36:39], 0 offen offset:1024 sc1
    buffer_load_dwordx4 v[136:139], v145, s[36:39], 0 offen offset:2048 sc1
    buffer_load_dwordx4 v[140:143], v145, s[36:39], 0 offen offset:3072 sc1
    s_mov_b32 s80, 200000
MC_160:
    s_mov_b64 exec, -1
    s_waitcnt vmcnt(0)
    v_max3_u32 v160, v128, v129, v130
    v_max_u32 v160, v160, v131
    v_cmp_eq_u32 s[44:45], -1, v160
    v_max3_u32 v161, v132, v133, v134
    v_max_u32 v161, v161, v135
    v_cmp_eq_u32 s[46:47], -1, v161
    v_max3_u32 v162, v136, v137, v138
    v_max_u32 v162, v162, v139
    v_cmp_eq_u32 s[48:49], -1, v162
    v_max3_u32 v163, v140, v141, v142
    v_max_u32 v163, v163, v143
    v_cmp_eq_u32 s[50:51], -1, v163
    s_or_b64 s[90:91], s[44:45], s[46:47]
    s_or_b64 s[90:91], s[90:91], s[48:49]
    s_or_b64 s[90:91], s[90:91], s[50:51]
    s_cbranch_scc1 M_159
MD_161:
    s_mov_b64 exec, -1
    v_mov_b32 v160, 0x24108
    v_mov_b32 v161, 1
    s_mov_b64 exec, 1
    ds_add_u32 v160, v161
    s_mov_b64 exec, -1
    ds_write_b128 v146, v[128:131] offset:0
    ds_write_b128 v147, v[132:135] offset:1024
    ds_write_b128 v148, v[136:139] offset:2048
    ds_write_b128 v149, v[140:143] offset:3072
    v_xor_b32 v20, 0x0, v0
    v_xor_b32 v21, 0x10, v0
    v_xor_b32 v22, 0x20, v0
    v_xor_b32 v23, 0x30, v0
    v_xor_b32 v24, 0x40, v0
    v_xor_b32 v25, 0x50, v0
    v_xor_b32 v26, 0x60, v0
    v_xor_b32 v27, 0x70, v0
    v_mov_b32 v0, 0x24000
    s_add_u32 s81, s81, 8
    v_mov_b32 v162, 0x2420c
    v_mov_b32 v163, 1
    s_mov_b64 exec, 1
    ds_add_u32 v162, v163
    s_mov_b64 exec, -1
    v_mov_b32 v162, 0x2420c
    s_mov_b32 s80, 1600000
LW_162:
    ds_read_b32 v163, v162
    s_waitcnt lgkmcnt(0)
    v_readfirstlane_b32 s79, v163
    s_cmp_ge_u32 s79, s81
    s_cbranch_scc1 LWD_163
    s_sub_u32 s80, s80, 1
    s_cmp_lg_u32 s80, 0
    s_cbranch_scc1 LW_162
LWD_163:
    ds_read_b128 v[128:131], v20
    ds_read_b128 v[132:135], v21
    ds_read_b128 v[136:139], v22
    ds_read_b128 v[140:143], v23
    ds_read_b128 v[144:147], v24
    ds_read_b128 v[148:151], v25
    ds_read_b128 v[152:155], v26
    ds_read_b128 v[156:159], v27
    v_xor_b32 v20, 0x80, v20
    v_xor_b32 v21, 0x80, v21
    v_xor_b32 v22, 0x80, v22
    v_xor_b32 v23, 0x80, v23
    v_xor_b32 v24, 0x80, v24
    v_xor_b32 v25, 0x80, v25
    v_xor_b32 v26, 0x80, v26
    v_xor_b32 v27, 0x80, v27
    s_waitcnt lgkmcnt(7)
    v_mfma_f32_16x16x32_bf16 v[16:19], v[32:35], v[128:131], 0
    v_pk_mov_b32 v[32:33], v[128:129], v[128:129] op_sel:[0,1]
    v_pk_mov_b32 v[34:35], v[130:131], v[130:131] op_sel:[0,1]
    ds_read_b128 v[128:131], v20
    s_waitcnt lgkmcnt(7)
    v_mfma_f32_16x16x32_bf16 v[16:19], v[36:39], v[132:135], v[16:19]
    v_pk_mov_b32 v[36:37], v[132:133], v[132:133] op_sel:[0,1]
    v_pk_mov_b32 v[38:39], v[134:135], v[134:135] op_sel:[0,1]
    ds_read_b128 v[132:135], v21
    s_waitcnt lgkmcnt(7)
    v_mfma_f32_16x16x32_bf16 v[16:19], v[40:43], v[136:139], v[16:19]
    v_pk_mov_b32 v[40:41], v[136:137], v[136:137] op_sel:[0,1]
    v_pk_mov_b32 v[42:43], v[138:139], v[138:139] op_sel:[0,1]
    ds_read_b128 v[136:139], v22
    s_waitcnt lgkmcnt(7)
    v_mfma_f32_16x16x32_bf16 v[16:19], v[44:47], v[140:143], v[16:19]
    v_pk_mov_b32 v[44:45], v[140:141], v[140:141] op_sel:[0,1]
    v_pk_mov_b32 v[46:47], v[142:143], v[142:143] op_sel:[0,1]
    ds_read_b128 v[140:143], v23
    s_waitcnt lgkmcnt(7)
    v_mfma_f32_16x16x32_bf16 v[16:19], v[48:51], v[144:147], v[16:19]
    v_pk_mov_b32 v[48:49], v[144:145], v[144:145] op_sel:[0,1]
    v_pk_mov_b32 v[50:51], v[146:147], v[146:147] op_sel:[0,1]
    ds_read_b128 v[144:147], v24
    s_waitcnt lgkmcnt(7)
    v_mfma_f32_16x16x32_bf16 v[16:19], v[52:55], v[148:151], v[16:19]
    v_pk_mov_b32 v[52:53], v[148:149], v[148:149] op_sel:[0,1]
    v_pk_mov_b32 v[54:55], v[150:151], v[150:151] op_sel:[0,1]
    ds_read_b128 v[148:151], v25
    s_waitcnt lgkmcnt(7)
    v_mfma_f32_16x16x32_bf16 v[16:19], v[56:59], v[152:155], v[16:19]
    v_pk_mov_b32 v[56:57], v[152:153], v[152:153] op_sel:[0,1]
    v_pk_mov_b32 v[58:59], v[154:155], v[154:155] op_sel:[0,1]
    ds_read_b128 v[152:155], v26
    s_waitcnt lgkmcnt(7)
    v_mfma_f32_16x16x32_bf16 v[16:19], v[60:63], v[156:159], v[16:19]
    v_pk_mov_b32 v[60:61], v[156:157], v[156:157] op_sel:[0,1]
    v_pk_mov_b32 v[62:63], v[158:159], v[158:159] op_sel:[0,1]
    ds_read_b128 v[156:159], v27
    s_waitcnt lgkmcnt(7)
    v_mfma_f32_16x16x32_bf16 v[16:19], v[64:67], v[128:131], v[16:19]
    v_pk_mov_b32 v[64:65], v[128:129], v[128:129] op_sel:[0,1]
    v_pk_mov_b32 v[66:67], v[130:131], v[130:131] op_sel:[0,1]
    v_pk_mov_b32 v[128:129], 0, 0
    v_pk_mov_b32 v[130:131], 0, 0
    s_waitcnt lgkmcnt(6)
    v_mfma_f32_16x16x32_bf16 v[16:19], v[68:71], v[132:135], v[16:19]
    v_pk_mov_b32 v[68:69], v[132:133], v[132:133] op_sel:[0,1]
    v_pk_mov_b32 v[70:71], v[134:135], v[134:135] op_sel:[0,1]
    v_pk_mov_b32 v[132:133], 0, 0
    v_pk_mov_b32 v[134:135], 0, 0
    s_waitcnt lgkmcnt(5)
    v_mfma_f32_16x16x32_bf16 v[16:19], v[72:75], v[136:139], v[16:19]
    v_pk_mov_b32 v[72:73], v[136:137], v[136:137] op_sel:[0,1]
    v_pk_mov_b32 v[74:75], v[138:139], v[138:139] op_sel:[0,1]
    v_pk_mov_b32 v[136:137], 0, 0
    v_pk_mov_b32 v[138:139], 0, 0
    s_waitcnt lgkmcnt(4)
    v_mfma_f32_16x16x32_bf16 v[16:19], v[76:79], v[140:143], v[16:19]
    v_pk_mov_b32 v[76:77], v[140:141], v[140:141] op_sel:[0,1]
    v_pk_mov_b32 v[78:79], v[142:143], v[142:143] op_sel:[0,1]
    v_pk_mov_b32 v[140:141], 0, 0
    v_pk_mov_b32 v[142:143], 0, 0
    s_waitcnt lgkmcnt(3)
    v_mfma_f32_16x16x32_bf16 v[16:19], v[80:83], v[144:147], v[16:19]
    v_pk_mov_b32 v[80:81], v[144:145], v[144:145] op_sel:[0,1]
    v_pk_mov_b32 v[82:83], v[146:147], v[146:147] op_sel:[0,1]
    v_pk_mov_b32 v[144:145], 0, 0
    v_pk_mov_b32 v[146:147], 0, 0
    s_waitcnt lgkmcnt(2)
    v_mfma_f32_16x16x32_bf16 v[16:19], v[84:87], v[148:151], v[16:19]
    v_pk_mov_b32 v[84:85], v[148:149], v[148:149] op_sel:[0,1]
    v_pk_mov_b32 v[86:87], v[150:151], v[150:151] op_sel:[0,1]
    v_pk_mov_b32 v[148:149], 0, 0
    v_pk_mov_b32 v[150:151], 0, 0
    s_waitcnt lgkmcnt(1)
    v_mfma_f32_16x16x32_bf16 v[16:19], v[88:91], v[152:155], v[16:19]
    v_pk_mov_b32 v[88:89], v[152:153], v[152:153] op_sel:[0,1]
    v_pk_mov_b32 v[90:91], v[154:155], v[154:155] op_sel:[0,1]
    v_pk_mov_b32 v[152:153], 0, 0
    v_pk_mov_b32 v[154:155], 0, 0
    s_waitcnt lgkmcnt(0)
    v_mfma_f32_16x16x32_bf16 v[16:19], v[92:95], v[156:159], v[16:19]
    v_pk_mov_b32 v[92:93], v[156:157], v[156:157] op_sel:[0,1]
    v_pk_mov_b32 v[94:95], v[158:159], v[158:159] op_sel:[0,1]
    v_pk_mov_b32 v[156:157], 0, 0
    v_pk_mov_b32 v[158:159], 0, 0
    v_mov_b32 v162, 0x24104
    v_mov_b32 v163, 1
    s_mov_b64 exec, 1
    ds_add_u32 v162, v163
    s_mov_b64 exec, -1
    s_branch BM_164
BS_165:
    s_bfe_u32 s7, s72, s67
    s_lshl_b32 s7, s7, 14
    v_add_u32 v20, s7, v4
    v_xor_b32 v21, 0x10, v20
    v_xor_b32 v22, 0x20, v20
    v_xor_b32 v23, 0x30, v20
    v_xor_b32 v24, 0x40, v20
    v_xor_b32 v25, 0x50, v20
    v_xor_b32 v26, 0x60, v20
    v_xor_b32 v27, 0x70, v20
    v_readfirstlane_b32 s79, v15
    s_cmp_ge_u32 s79, s66
    s_cbranch_scc1 BK_166
    v_mov_b32 v162, 0x24000
    s_mov_b32 s80, 1600000
LW_167:
    ds_read_b32 v163, v162
    s_waitcnt lgkmcnt(0)
    v_readfirstlane_b32 s79, v163
    s_cmp_ge_u32 s79, s66
    s_cbranch_scc1 LWD_168
    s_sleep 1
    s_sub_u32 s80, s80, 1
    s_cmp_lg_u32 s80, 0
    s_cbranch_scc1 LW_167
LWD_168:
BK_166:
    ds_read_b128 v[96:99], v20
    ds_read_b128 v[100:103], v21
    ds_read_b128 v[104:107], v22
    ds_read_b128 v[108:111], v23
    ds_read_b128 v[112:115], v24
    ds_read_b128 v[116:119], v25
    ds_read_b128 v[120:123], v26
    ds_read_b128 v[124:127], v27
    v_xor_b32 v20, 0x80, v20
    v_xor_b32 v21, 0x80, v21
    v_xor_b32 v22, 0x80, v22
    v_xor_b32 v23, 0x80, v23
    v_xor_b32 v24, 0x80, v24
    v_xor_b32 v25, 0x80, v25
    v_xor_b32 v26, 0x80, v26
    v_xor_b32 v27, 0x80, v27
    s_waitcnt lgkmcnt(7)
    v_mfma_f32_16x16x32_bf16 v[16:19], v[96:99], v[32:35], 0
    ds_read_b128 v[96:99], v20
    s_waitcnt lgkmcnt(7)
    v_mfma_f32_16x16x32_bf16 v[16:19], v[100:103], v[36:39], v[16:19]
    ds_read_b128 v[100:103], v21
    s_waitcnt lgkmcnt(7)
    v_mfma_f32_16x16x32_bf16 v[16:19], v[104:107], v[40:43], v[16:19]
    ds_read_b128 v[104:107], v22
    s_waitcnt lgkmcnt(7)
    v_mfma_f32_16x16x32_bf16 v[16:19], v[108:111], v[44:47], v[16:19]
    ds_read_b128 v[108:111], v23
    s_waitcnt lgkmcnt(7)
    v_mfma_f32_16x16x32_bf16 v[16:19], v[112:115], v[48:51], v[16:19]
    ds_read_b128 v[112:115], v24
    s_waitcnt lgkmcnt(7)
    v_mfma_f32_16x16x32_bf16 v[16:19], v[116:119], v[52:55], v[16:19]
    ds_read_b128 v[116:119], v25
    s_waitcnt lgkmcnt(7)
    v_mfma_f32_16x16x32_bf16 v[16:19], v[120:123], v[56:59], v[16:19]
    ds_read_b128 v[120:123], v26
    s_waitcnt lgkmcnt(7)
    v_mfma_f32_16x16x32_bf16 v[16:19], v[124:127], v[60:63], v[16:19]
    ds_read_b128 v[124:127], v27
    s_waitcnt lgkmcnt(7)
    v_mfma_f32_16x16x32_bf16 v[16:19], v[96:99], v[64:67], v[16:19]
    s_waitcnt lgkmcnt(6)
    v_mfma_f32_16x16x32_bf16 v[16:19], v[100:103], v[68:71], v[16:19]
    s_bfe_u32 s7, s72, 0x40000
    s_lshl_b32 s7, s7, 14
    v_add_u32 v20, s7, v9
    v_add_u32 v21, s7, v10
    v_add_u32 v22, s7, v11
    v_add_u32 v23, s7, v12
    s_waitcnt lgkmcnt(5)
    v_mfma_f32_16x16x32_bf16 v[16:19], v[104:107], v[72:75], v[16:19]
    s_waitcnt lgkmcnt(4)
    v_mfma_f32_16x16x32_bf16 v[16:19], v[108:111], v[76:79], v[16:19]
    s_bfe_u32 s7, s72, 0x40004
    s_lshl_b32 s7, s7, 14
    v_add_u32 v24, s7, v9
    v_add_u32 v25, s7, v10
    v_add_u32 v26, s7, v11
    v_add_u32 v27, s7, v12
    s_waitcnt lgkmcnt(3)
    v_mfma_f32_16x16x32_bf16 v[16:19], v[112:115], v[80:83], v[16:19]
    s_waitcnt lgkmcnt(2)
    v_mfma_f32_16x16x32_bf16 v[16:19], v[116:119], v[84:87], v[16:19]
    s_bfe_u32 s7, s72, 0x40008
    s_lshl_b32 s7, s7, 14
    v_add_u32 v28, s7, v9
    v_add_u32 v29, s7, v10
    v_add_u32 v30, s7, v11
    v_add_u32 v31, s7, v12
    s_waitcnt lgkmcnt(1)
    v_mfma_f32_16x16x32_bf16 v[16:19], v[120:123], v[88:91], v[16:19]
    s_waitcnt lgkmcnt(0)
    v_mfma_f32_16x16x32_bf16 v[16:19], v[124:127], v[92:95], v[16:19]
    s_cmp_ge_u32 s79, s70
    s_cbranch_scc1 BA_169
    v_mov_b32 v162, 0x24000
    s_mov_b32 s80, 1600000
LW_170:
    ds_read_b32 v163, v162
    s_waitcnt lgkmcnt(0)
    v_readfirstlane_b32 s79, v163
    s_cmp_ge_u32 s79, s70
    s_cbranch_scc1 LWD_171
    s_sleep 1
    s_sub_u32 s80, s80, 1
    s_cmp_lg_u32 s80, 0
    s_cbranch_scc1 LW_170
LWD_171:
BA_169:
    ds_read_b64_tr_b16 v[96:97], v20
    ds_read_b64_tr_b16 v[98:99], v22
    ds_read_b64_tr_b16 v[100:101], v21
    ds_read_b64_tr_b16 v[102:103], v23
    ds_read_b64_tr_b16 v[104:105], v24
    ds_read_b64_tr_b16 v[106:107], v26
    ds_read_b64_tr_b16 v[108:109], v25
    ds_read_b64_tr_b16 v[110:111], v27
    ds_read_b64_tr_b16 v[112:113], v28
    ds_read_b64_tr_b16 v[114:115], v30
    ds_read_b64_tr_b16 v[116:117], v29
    ds_read_b64_tr_b16 v[118:119], v31
    s_bfe_u32 s7, s72, 0x4000c
    s_lshl_b32 s7, s7, 14
    v_add_u32 v20, s7, v9
    v_add_u32 v21, s7, v10
    v_add_u32 v22, s7, v11
    v_add_u32 v23, s7, v12
    ds_read_b64_tr_b16 v[120:121], v20
    ds_read_b64_tr_b16 v[122:123], v22
    ds_read_b64_tr_b16 v[124:125], v21
    ds_read_b64_tr_b16 v[126:127], v23
    v_mov_b32 v162, 0x24100
    v_mov_b32 v163, 1
    s_mov_b64 exec, 1
    ds_add_u32 v162, v163
    s_mov_b64 exec, -1
BM_164:
    v_max3_f32 v160, v16, v17, v18
    v_max_f32 v160, v160, v19
    v_mov_b32 v161, v160
    s_nop 1
    v_permlane32_swap_b32 v160, v161
    v_max_f32 v160, v160, v161
    v_mov_b32 v161, v160
    s_nop 1
    v_permlane16_swap_b32 v160, v161
    v_max_f32 v160, v160, v161
    v_mul_f32 v160, s64, v160
    v_ceil_f32 v160, v160
    v_fma_f32 v16, v16, s64, -v160
    v_fma_f32 v17, v17, s64, -v160
    v_fma_f32 v18, v18, s64, -v160
    v_fma_f32 v19, v19, s64, -v160
    v_exp_f32 v16, v16
    v_exp_f32 v17, v17
    v_exp_f32 v18, v18
    v_exp_f32 v19, v19
    v_cvt_pk_bf16_f32 v162, v16, v17
    v_cvt_pk_bf16_f32 v163, v18, v19
    ds_write_b64 v6, v[162:163]
    s_mov_b64 exec, s[84:85]
    ds_write_b32 v5, v160
    s_add_u32 s81, s81, 8
    v_mov_b32 v164, 0x2420c
    v_mov_b32 v165, 1
    s_mov_b64 exec, 1
    ds_add_u32 v164, v165
    s_mov_b64 exec, -1
    v_add_f32 v16, v16, v17
    v_add_f32 v18, v18, v19
    v_add_f32 v161, v16, v18
    v_mov_b32 v16, v161
    s_nop 1
    v_permlane32_swap_b32 v161, v16
    v_add_f32 v161, v161, v16
    v_mov_b32 v16, v161
    s_nop 1
    v_permlane16_swap_b32 v161, v16
    v_add_f32 v161, v161, v16
    s_mov_b64 exec, s[84:85]
    ds_write_b32 v5, v161 offset:4
    s_mov_b64 exec, 1
    ds_add_u32 v164, v165 offset:4
    s_mov_b64 exec, -1
    v_mov_b32 v164, 0x2420c
    s_mov_b32 s80, 1600000
LW_172:
    ds_read_b32 v165, v164
    s_waitcnt lgkmcnt(0)
    v_readfirstlane_b32 s79, v165
    s_cmp_ge_u32 s79, s81
    s_cbranch_scc1 LWD_173
    s_sub_u32 s80, s80, 1
    s_cmp_lg_u32 s80, 0
    s_cbranch_scc1 LW_172
LWD_173:
    ds_read_b32 v160, v8 offset:0
    ds_read_b32 v161, v8 offset:256
    ds_read_b32 v162, v8 offset:512
    ds_read_b32 v163, v8 offset:768
    ds_read_b32 v15, v0
    ds_read_b128 v[16:19], v7 offset:0
    ds_read_b128 v[20:23], v7 offset:1024
    ds_read_b128 v[24:27], v7 offset:2048
    ds_read_b128 v[28:31], v7 offset:3072
    v_xor_b32 v6, 0x1000, v6
    v_xor_b32 v7, 0x1000, v7
    v_add_u32 v5, 1024, v5
    v_add_u32 v8, 1024, v8
    s_waitcnt lgkmcnt(5)
    v_max3_f32 v14, v13, v160, v161
    v_max3_f32 v14, v14, v162, v163
    v_cmp_neq_f32 vcc, v14, v13
    v_sub_f32 v160, v14, v160
    v_sub_f32 v161, v14, v161
    v_sub_f32 v162, v14, v162
    v_sub_f32 v163, v14, v163
    v_cvt_u32_f32 v160, v160
    v_cvt_u32_f32 v161, v161
    v_cvt_u32_f32 v162, v162
    v_cvt_u32_f32 v163, v163
    v_min_u32 v160, 0xff, v160
    v_min_u32 v161, 0xff, v161
    v_min_u32 v162, 0xff, v162
    v_min_u32 v163, 0xff, v163
    v_mul_u32_u24 v160, s71, v160
    v_mul_u32_u24 v161, s71, v161
    v_mul_u32_u24 v162, s71, v162
    v_mul_u32_u24 v163, s71, v163
    s_cbranch_vccz BR_174
    v_sub_f32 v164, v13, v14
    v_exp_f32 v164, v164
    v_mov_b32 v13, v14
    v_pk_mul_f32 v[128:129], v[128:129], v[164:165] op_sel_hi:[1,0]
    v_pk_mul_f32 v[130:131], v[130:131], v[164:165] op_sel_hi:[1,0]
    v_pk_mul_f32 v[132:133], v[132:133], v[164:165] op_sel_hi:[1,0]
    v_pk_mul_f32 v[134:135], v[134:135], v[164:165] op_sel_hi:[1,0]
    v_pk_mul_f32 v[136:137], v[136:137], v[164:165] op_sel_hi:[1,0]
    v_pk_mul_f32 v[138:139], v[138:139], v[164:165] op_sel_hi:[1,0]
    v_pk_mul_f32 v[140:141], v[140:141], v[164:165] op_sel_hi:[1,0]
    v_pk_mul_f32 v[142:143], v[142:143], v[164:165] op_sel_hi:[1,0]
    v_pk_mul_f32 v[144:145], v[144:145], v[164:165] op_sel_hi:[1,0]
    v_pk_mul_f32 v[146:147], v[146:147], v[164:165] op_sel_hi:[1,0]
    v_pk_mul_f32 v[148:149], v[148:149], v[164:165] op_sel_hi:[1,0]
    v_pk_mul_f32 v[150:151], v[150:151], v[164:165] op_sel_hi:[1,0]
    v_pk_mul_f32 v[152:153], v[152:153], v[164:165] op_sel_hi:[1,0]
    v_pk_mul_f32 v[154:155], v[154:155], v[164:165] op_sel_hi:[1,0]
    v_pk_mul_f32 v[156:157], v[156:157], v[164:165] op_sel_hi:[1,0]
    v_pk_mul_f32 v[158:159], v[158:159], v[164:165] op_sel_hi:[1,0]
BR_174:
    s_waitcnt lgkmcnt(3)
    v_pk_sub_u16 v16, v16, v160 clamp
    v_pk_sub_u16 v17, v17, v160 clamp
    v_pk_sub_u16 v18, v18, v160 clamp
    v_pk_sub_u16 v19, v19, v160 clamp
    s_nop 1
    v_mfma_f32_32x32x16_bf16 v[128:143], v[96:99], v[16:19], v[128:143]
    v_mfma_f32_32x32x16_bf16 v[144:159], v[100:103], v[16:19], v[144:159]
    s_waitcnt lgkmcnt(2)
    v_pk_sub_u16 v20, v20, v161 clamp
    v_pk_sub_u16 v21, v21, v161 clamp
    v_pk_sub_u16 v22, v22, v161 clamp
    v_pk_sub_u16 v23, v23, v161 clamp
    s_nop 1
    v_mfma_f32_32x32x16_bf16 v[128:143], v[104:107], v[20:23], v[128:143]
    v_mfma_f32_32x32x16_bf16 v[144:159], v[108:111], v[20:23], v[144:159]
    s_waitcnt lgkmcnt(1)
    v_pk_sub_u16 v24, v24, v162 clamp
    v_pk_sub_u16 v25, v25, v162 clamp
    v_pk_sub_u16 v26, v26, v162 clamp
    v_pk_sub_u16 v27, v27, v162 clamp
    s_nop 1
    v_mfma_f32_32x32x16_bf16 v[128:143], v[112:115], v[24:27], v[128:143]
    v_mfma_f32_32x32x16_bf16 v[144:159], v[116:119], v[24:27], v[144:159]
    s_waitcnt lgkmcnt(0)
    v_pk_sub_u16 v28, v28, v163 clamp
    v_pk_sub_u16 v29, v29, v163 clamp
    v_pk_sub_u16 v30, v30, v163 clamp
    v_pk_sub_u16 v31, v31, v163 clamp
    s_nop 1
    v_mfma_f32_32x32x16_bf16 v[128:143], v[120:123], v[28:31], v[128:143]
    v_mfma_f32_32x32x16_bf16 v[144:159], v[124:127], v[28:31], v[144:159]
    s_lshr_b64 s[72:73], s[72:73], 16
    s_add_u32 s66, s66, 64
    s_add_u32 s70, s70, 64
    s_sub_u32 s69, s69, 1
    s_cmp_lg_u32 s69, 0
    s_cbranch_scc1 BS_165
    s_lshr_b32 s67, s60, 3
    s_and_b32 s68, s60, 7
    s_lshl_b32 s7, s60, 15
    s_lshl_b32 s63, s6, 12
    s_add_u32 s7, s7, s63
    s_add_u32 s7, s7, 0x600000
    v_lshl_add_u32 v5, v1, 4, s7
    v_mov_b32 v38, s92
    v_mov_b32 v39, s93
    s_cmp_lg_u32 s6, 7
    s_cbranch_scc1 B7_175
    v_lshrrev_b32 v45, 5, v1
    v_lshl_add_u32 v45, v45, 11, v8
    v_add_u32 v45, -4096, v45
    v_mov_b32 v46, 0x24210
    s_mov_b32 s80, 1600000
LW_176:
    ds_read_b32 v47, v46
    s_waitcnt lgkmcnt(0)
    v_readfirstlane_b32 s79, v47
    s_cmp_ge_u32 s79, 32
    s_cbranch_scc1 LWD_177
    s_sub_u32 s80, s80, 1
    s_cmp_lg_u32 s80, 0
    s_cbranch_scc1 LW_176
LWD_177:
    ds_read_b64 v[48:49], v45 offset:0
    ds_read_b64 v[50:51], v45 offset:256
    ds_read_b64 v[52:53], v45 offset:512
    ds_read_b64 v[54:55], v45 offset:768
    ds_read_b64 v[56:57], v45 offset:1024
    ds_read_b64 v[58:59], v45 offset:1280
    ds_read_b64 v[60:61], v45 offset:1536
    ds_read_b64 v[62:63], v45 offset:1792
    s_lshl_b32 s7, s60, 9
    s_add_u32 s7, s7, 0x28000
    v_lshl_add_u32 v44, v1, 4, s7
    v_mov_b32 v36, v13
    s_waitcnt lgkmcnt(0)
    v_sub_f32 v48, v48, v36
    v_sub_f32 v50, v50, v36
    v_sub_f32 v52, v52, v36
    v_sub_f32 v54, v54, v36
    v_sub_f32 v56, v56, v36
    v_sub_f32 v58, v58, v36
    v_sub_f32 v60, v60, v36
    v_sub_f32 v62, v62, v36
    v_exp_f32 v48, v48
    v_exp_f32 v50, v50
    v_exp_f32 v52, v52
    v_exp_f32 v54, v54
    v_exp_f32 v56, v56
    v_exp_f32 v58, v58
    v_exp_f32 v60, v60
    v_exp_f32 v62, v62
    v_mul_f32 v37, v48, v49
    v_fmac_f32 v37, v50, v51
    v_fmac_f32 v37, v52, v53
    v_fmac_f32 v37, v54, v55
    v_fmac_f32 v37, v56, v57
    v_fmac_f32 v37, v58, v59
    v_fmac_f32 v37, v60, v61
    v_fmac_f32 v37, v62, v63
    v_mov_b32 v48, v37
    s_nop 1
    v_permlane32_swap_b32 v37, v48
    v_add_f32 v37, v37, v48
    s_mov_b64 exec, 0xffffffff
    s_cmp_eq_u32 s101, 0
    s_cbranch_scc1 SU_178
    buffer_store_dwordx4 v[36:39], v44, s[36:39], 0 offen
SV_179:
    s_mov_b64 exec, -1
B7_175:
    v_permlane32_swap_b32 v128, v132
    v_permlane32_swap_b32 v129, v133
    v_permlane32_swap_b32 v130, v134
    v_permlane32_swap_b32 v131, v135
    v_cvt_pk_bf16_f32 v16, v128, v129
    v_cvt_pk_bf16_f32 v17, v130, v131
    v_cvt_pk_bf16_f32 v18, v132, v133
    v_cvt_pk_bf16_f32 v19, v134, v135
    v_permlane32_swap_b32 v136, v140
    v_permlane32_swap_b32 v137, v141
    v_permlane32_swap_b32 v138, v142
    v_permlane32_swap_b32 v139, v143
    v_cvt_pk_bf16_f32 v20, v136, v137
    v_cvt_pk_bf16_f32 v21, v138, v139
    v_cvt_pk_bf16_f32 v22, v140, v141
    v_cvt_pk_bf16_f32 v23, v142, v143
    v_permlane32_swap_b32 v144, v148
    v_permlane32_swap_b32 v145, v149
    v_permlane32_swap_b32 v146, v150
    v_permlane32_swap_b32 v147, v151
    v_cvt_pk_bf16_f32 v24, v144, v145
    v_cvt_pk_bf16_f32 v25, v146, v147
    v_cvt_pk_bf16_f32 v26, v148, v149
    v_cvt_pk_bf16_f32 v27, v150, v151
    v_permlane32_swap_b32 v152, v156
    v_permlane32_swap_b32 v153, v157
    v_permlane32_swap_b32 v154, v158
    v_permlane32_swap_b32 v155, v159
    v_cvt_pk_bf16_f32 v28, v152, v153
    v_cvt_pk_bf16_f32 v29, v154, v155
    v_cvt_pk_bf16_f32 v30, v156, v157
    v_cvt_pk_bf16_f32 v31, v158, v159
    s_lshl_b32 s7, s67, 9
    s_lshl_b32 s65, s6, 6
    s_add_u32 s7, s7, s65
    s_add_u32 s7, s7, 0x23000
    v_and_b32 v160, 7, v1
    v_lshl_add_u32 v7, v160, 3, s7
    s_lshl_b64 s[88:89], 1, s68
    s_cmp_eq_u32 s101, 0
    s_cbranch_scc1 SU_180
    buffer_store_dwordx4 v[16:19], v5, s[36:39], 0 offen offset:0
    buffer_store_dwordx4 v[20:23], v5, s[36:39], 0 offen offset:1024
    buffer_store_dwordx4 v[24:27], v5, s[36:39], 0 offen offset:2048
    buffer_store_dwordx4 v[28:31], v5, s[36:39], 0 offen offset:3072
    s_waitcnt vmcnt(0)
    s_mov_b64 exec, s[88:89]
    buffer_store_dwordx2 v[38:39], v7, s[36:39], 0 offen
    s_mov_b64 exec, -1
SV_181:
    s_lshl_b32 s7, s67, 18
    s_add_u32 s7, s7, s63
    s_lshl_b32 s65, s68, 6
    s_add_u32 s7, s7, s65
    s_add_u32 s7, s7, 0x600000
    v_and_b32 v160, 3, v1
    v_lshl_add_u32 v5, v160, 4, s7
    v_bfe_u32 v161, v1, 2, 3
    v_lshl_add_u32 v5, v161, 9, v5
    v_lshrrev_b32 v162, 5, v1
    v_lshl_add_u32 v5, v162, 15, v5
    s_lshl_b32 s7, s67, 12
    s_add_u32 s7, s7, s65
    s_add_u32 s7, s7, 0x28000
    v_lshl_add_u32 v6, v160, 4, s7
    v_lshl_add_u32 v6, v162, 9, v6
    s_lshl_b32 s7, s68, 15
    s_lshl_b32 s63, s67, 10
    s_add_u32 s7, s7, s63
    s_lshl_b32 s63, s6, 7
    s_add_u32 s7, s7, s63
    s_add_u32 s7, s7, 0x200000
    v_lshl_add_u32 v8, v160, 13, s7
    v_lshl_add_u32 v8, v161, 4, v8
    v_lshl_add_u32 v8, v162, 3, v8
    s_lshl_b32 s7, s67, 7
    s_lshl_b32 s63, s68, 12
    s_add_u32 s7, s7, s63
    s_add_u32 s7, s7, 0x30000
    v_lshl_add_u32 v9, v160, 10, s7
    s_mov_b64 exec, 0xff
    buffer_load_dwordx2 v[40:41], v7, s[36:39], 0 offen sc1 nt
    s_mov_b32 s80, 200000
MC_183:
    s_mov_b64 exec, 0xff
    s_waitcnt vmcnt(0)
    v_cmp_ne_u64 s[86:87], s[92:93], v[40:41]
    s_cmp_lg_u64 s[86:87], 0
    s_cbranch_scc1 M_182
MD_184:
    s_mov_b64 exec, -1
    buffer_load_dwordx4 v[64:67], v6, s[36:39], 0 offen offset:0 sc1 nt
    buffer_load_dwordx4 v[68:71], v6, s[36:39], 0 offen offset:1024 sc1 nt
    buffer_load_dwordx4 v[72:75], v6, s[36:39], 0 offen offset:2048 sc1 nt
    buffer_load_dwordx4 v[76:79], v6, s[36:39], 0 offen offset:3072 sc1 nt
    s_mov_b32 s63, 0
    buffer_load_dwordx4 v[48:51], v5, s[36:39], s63 offen sc1 nt
    s_add_u32 s63, s63, 65536
    buffer_load_dwordx4 v[52:55], v5, s[36:39], s63 offen sc1 nt
    s_add_u32 s63, s63, 65536
    buffer_load_dwordx4 v[56:59], v5, s[36:39], s63 offen sc1 nt
    s_add_u32 s63, s63, 65536
    buffer_load_dwordx4 v[60:63], v5, s[36:39], s63 offen sc1 nt
    s_add_u32 s63, s63, 65536
    s_waitcnt vmcnt(4)
    v_cmp_ne_u64 s[90:91], s[92:93], v[66:67]
    v_cmp_ne_u64 vcc, s[92:93], v[70:71]
    s_or_b64 s[90:91], s[90:91], vcc
    v_cmp_ne_u64 vcc, s[92:93], v[74:75]
    s_or_b64 s[90:91], s[90:91], vcc
    v_cmp_ne_u64 vcc, s[92:93], v[78:79]
    s_or_b64 s[90:91], s[90:91], vcc
    s_cmp_lg_u64 s[90:91], 0
    s_cbranch_scc1 BL_185
BLD_186:
    v_max3_f32 v36, v64, v68, v72
    v_max_f32 v36, v36, v76
    v_mov_b32 v37, v36
    s_nop 1
    v_permlane32_swap_b32 v36, v37
    v_max_f32 v36, v36, v37
    v_sub_f32 v80, v64, v36
    v_sub_f32 v81, v68, v36
    v_sub_f32 v82, v72, v36
    v_sub_f32 v83, v76, v36
    v_exp_f32 v80, v80
    v_exp_f32 v81, v81
    v_exp_f32 v82, v82
    v_exp_f32 v83, v83
    v_mul_f32 v37, v80, v65
    v_fmac_f32 v37, v81, v69
    v_fmac_f32 v37, v82, v73
    v_fmac_f32 v37, v83, v77
    v_mov_b32 v40, v37
    s_nop 1
    v_permlane32_swap_b32 v37, v40
    v_add_f32 v37, v37, v40
    s_waitcnt vmcnt(3)
    v_lshlrev_b32 v88, 16, v48
    v_and_b32 v89, 0xffff0000, v48
    v_lshlrev_b32 v90, 16, v49
    v_and_b32 v91, 0xffff0000, v49
    v_lshlrev_b32 v92, 16, v50
    v_and_b32 v93, 0xffff0000, v50
    v_lshlrev_b32 v94, 16, v51
    v_and_b32 v95, 0xffff0000, v51
    v_mul_f32 v16, v88, v80
    v_mul_f32 v17, v89, v80
    v_mul_f32 v18, v90, v80
    v_mul_f32 v19, v91, v80
    v_mul_f32 v20, v92, v80
    v_mul_f32 v21, v93, v80
    v_mul_f32 v22, v94, v80
    v_mul_f32 v23, v95, v80
    s_waitcnt vmcnt(2)
    v_lshlrev_b32 v88, 16, v52
    v_and_b32 v89, 0xffff0000, v52
    v_lshlrev_b32 v90, 16, v53
    v_and_b32 v91, 0xffff0000, v53
    v_lshlrev_b32 v92, 16, v54
    v_and_b32 v93, 0xffff0000, v54
    v_lshlrev_b32 v94, 16, v55
    v_and_b32 v95, 0xffff0000, v55
    v_fmac_f32 v16, v88, v81
    v_fmac_f32 v17, v89, v81
    v_fmac_f32 v18, v90, v81
    v_fmac_f32 v19, v91, v81
    v_fmac_f32 v20, v92, v81
    v_fmac_f32 v21, v93, v81
    v_fmac_f32 v22, v94, v81
    v_fmac_f32 v23, v95, v81
    s_waitcnt vmcnt(1)
    v_lshlrev_b32 v88, 16, v56
    v_and_b32 v89, 0xffff0000, v56
    v_lshlrev_b32 v90, 16, v57
    v_and_b32 v91, 0xffff0000, v57
    v_lshlrev_b32 v92, 16, v58
    v_and_b32 v93, 0xffff0000, v58
    v_lshlrev_b32 v94, 16, v59
    v_and_b32 v95, 0xffff0000, v59
    v_fmac_f32 v16, v88, v82
    v_fmac_f32 v17, v89, v82
    v_fmac_f32 v18, v90, v82
    v_fmac_f32 v19, v91, v82
    v_fmac_f32 v20, v92, v82
    v_fmac_f32 v21, v93, v82
    v_fmac_f32 v22, v94, v82
    v_fmac_f32 v23, v95, v82
    s_waitcnt vmcnt(0)
    v_mov_b32 v160, 0x24218
    v_mov_b32 v161, 1
    s_mov_b64 exec, 1
    ds_add_u32 v160, v161
    s_mov_b64 exec, -1
    v_lshlrev_b32 v88, 16, v60
    v_and_b32 v89, 0xffff0000, v60
    v_lshlrev_b32 v90, 16, v61
    v_and_b32 v91, 0xffff0000, v61
    v_lshlrev_b32 v92, 16, v62
    v_and_b32 v93, 0xffff0000, v62
    v_lshlrev_b32 v94, 16, v63
    v_and_b32 v95, 0xffff0000, v63
    v_fmac_f32 v16, v88, v83
    v_fmac_f32 v17, v89, v83
    v_fmac_f32 v18, v90, v83
    v_fmac_f32 v19, v91, v83
    v_fmac_f32 v20, v92, v83
    v_fmac_f32 v21, v93, v83
    v_fmac_f32 v22, v94, v83
    v_fmac_f32 v23, v95, v83
    v_permlane32_swap_b32 v16, v20
    v_permlane32_swap_b32 v17, v21
    v_permlane32_swap_b32 v18, v22
    v_permlane32_swap_b32 v19, v23
    v_add_f32 v16, v16, v20
    v_add_f32 v17, v17, v21
    v_add_f32 v18, v18, v22
    v_add_f32 v19, v19, v23
    v_cvt_pk_bf16_f32 v44, v16, v17
    v_cvt_pk_bf16_f32 v45, v18, v19
    v_mov_b32 v160, 0x24218
    s_mov_b32 s80, 1600000
LW_187:
    ds_read_b32 v161, v160
    s_waitcnt lgkmcnt(0)
    v_readfirstlane_b32 s79, v161
    s_cmp_ge_u32 s79, 8
    s_cbranch_scc1 LWD_188
    s_sub_u32 s80, s80, 1
    s_cmp_lg_u32 s80, 0
    s_cbranch_scc1 LW_187
LWD_188:
    buffer_store_dwordx2 v[44:45], v8, s[36:39], 0 offen sc1
    s_cmp_lg_u32 s6, 0
    s_cbranch_scc1 BM2_189
    s_mov_b64 exec, 15
    buffer_store_dwordx4 v[36:39], v9, s[36:39], 0 offen sc1
    s_mov_b64 exec, -1
BM2_189:
    v_mov_b32 v160, 0x24218
    v_mov_b32 v161, 1
    s_mov_b64 exec, 1
    ds_add_u32 v160, v161
    s_mov_b64 exec, -1
    s_lshl_b32 s7, s67, 13
    s_lshl_b32 s63, s6, 10
    s_add_u32 s7, s7, s63
    s_add_u32 s7, s7, 0xc0000
    v_lshl_add_u32 v4, v1, 4, s7
    v_lshrrev_b32 v160, 2, v3
    v_mul_u32_u24 v5, 1088, v160
    v_and_b32 v160, 3, v1
    v_lshl_add_u32 v5, v160, 4, v5
    v_lshrrev_b32 v161, 5, v1
    v_lshl_add_u32 v5, v161, 6, v5
    v_and_b32 v161, 1, v2
    v_lshl_add_u32 v5, v161, 3, v5
    s_lshl_b32 s7, s6, 7
    s_add_u32 s7, s7, 0x26000
    v_add_u32 v5, s7, v5
    v_mul_u32_u24 v6, 1088, v160
    v_lshl_add_u32 v6, v2, 4, v6
    v_add_u32 v6, 0x26000, v6
    s_lshl_b32 s7, s68, 2
    s_add_u32 s7, s7, s6
    s_lshl_b32 s7, s7, 3
    s_add_u32 s7, s7, s67
    s_lshl_b32 s7, s7, 8
    s_add_u32 s7, s7, 0x2c0000
    v_lshl_add_u32 v7, v160, 6, s7
    v_lshl_add_u32 v7, v2, 4, v7
    v_cmp_gt_u32 s[84:85], 4, v3
    v_bfe_u32 v8, v1, 3, 2
    v_xor_b32 v8, s6, v8
    v_lshlrev_b32 v8, 5, v8
    v_lshrrev_b32 v161, 2, v1
    v_lshl_add_u32 v8, v161, 7, v8
    v_lshl_add_u32 v8, v160, 3, v8
    s_cmp_ge_u32 s6, 4
    s_cbranch_scc1 W4_190
    v_mov_b32 v162, 0x24000
    s_mov_b32 s80, 1600000
LW_191:
    ds_read_b32 v163, v162
    s_waitcnt lgkmcnt(0)
    v_readfirstlane_b32 s79, v163
    s_cmp_ge_u32 s79, 288
    s_cbranch_scc1 LWD_192
    s_sleep 1
    s_sub_u32 s80, s80, 1
    s_cmp_lg_u32 s80, 0
    s_cbranch_scc1 LW_191
LWD_192:
    ds_read_b64_tr_b16 v[48:49], v8 offset:0
    ds_read_b64_tr_b16 v[50:51], v8 offset:2048
    ds_read_b64_tr_b16 v[52:53], v8 offset:4096
    ds_read_b64_tr_b16 v[54:55], v8 offset:6144
    ds_read_b64_tr_b16 v[56:57], v8 offset:8192
    ds_read_b64_tr_b16 v[58:59], v8 offset:10240
    ds_read_b64_tr_b16 v[60:61], v8 offset:12288
    ds_read_b64_tr_b16 v[62:63], v8 offset:14336
    s_waitcnt lgkmcnt(4)
    ds_read_b64_tr_b16 v[64:65], v8 offset:16384
    ds_read_b64_tr_b16 v[66:67], v8 offset:18432
    ds_read_b64_tr_b16 v[68:69], v8 offset:20480
    ds_read_b64_tr_b16 v[70:71], v8 offset:22528
    ds_read_b64_tr_b16 v[72:73], v8 offset:24576
    ds_read_b64_tr_b16 v[74:75], v8 offset:26624
    ds_read_b64_tr_b16 v[76:77], v8 offset:28672
    ds_read_b64_tr_b16 v[78:79], v8 offset:30720
    s_waitcnt lgkmcnt(4)
    v_mov_b32 v162, 0x24000
    s_mov_b32 s80, 1600000
LW_193:
    ds_read_b32 v163, v162
    s_waitcnt lgkmcnt(0)
    v_readfirstlane_b32 s79, v163
    s_cmp_ge_u32 s79, 320
    s_cbranch_scc1 LWD_194
    s_sleep 1
    s_sub_u32 s80, s80, 1
    s_cmp_lg_u32 s80, 0
    s_cbranch_scc1 LW_193
LWD_194:
    ds_read_b64_tr_b16 v[80:81], v8 offset:32768
    ds_read_b64_tr_b16 v[82:83], v8 offset:34816
    ds_read_b64_tr_b16 v[84:85], v8 offset:36864
    ds_read_b64_tr_b16 v[86:87], v8 offset:38912
    ds_read_b64_tr_b16 v[88:89], v8 offset:40960
    ds_read_b64_tr_b16 v[90:91], v8 offset:43008
    ds_read_b64_tr_b16 v[92:93], v8 offset:45056
    ds_read_b64_tr_b16 v[94:95], v8 offset:47104
    s_waitcnt lgkmcnt(4)
    ds_read_b64_tr_b16 v[96:97], v8 offset:49152
    ds_read_b64_tr_b16 v[98:99], v8 offset:51200
    ds_read_b64_tr_b16 v[100:101], v8 offset:53248
    ds_read_b64_tr_b16 v[102:103], v8 offset:55296
    ds_read_b64_tr_b16 v[104:105], v8 offset:57344
    ds_read_b64_tr_b16 v[106:107], v8 offset:59392
    ds_read_b64_tr_b16 v[108:109], v8 offset:61440
    ds_read_b64_tr_b16 v[110:111], v8 offset:63488
    s_waitcnt lgkmcnt(4)
W4_190:
    s_mov_b64 exec, -1
    buffer_load_dwordx4 v[16:19], v4, s[36:39], 0 offen sc1 nt
    s_mov_b32 s80, 200000
MC_196:
    s_mov_b64 exec, -1
    s_waitcnt vmcnt(0)
    v_cmp_ne_u64 s[86:87], s[92:93], v[18:19]
    s_cmp_lg_u64 s[86:87], 0
    s_cbranch_scc1 M_195
MD_197:
    s_mov_b64 exec, -1
    ds_write_b64 v5, v[16:17]
    s_add_u32 s81, s81, 8
    v_mov_b32 v160, 0x2420c
    v_mov_b32 v161, 1
    s_mov_b64 exec, 1
    ds_add_u32 v160, v161
    s_mov_b64 exec, -1
    s_cmp_ge_u32 s6, 4
    s_cbranch_scc1 L_END
    v_mov_b32 v160, 0x2420c
    s_mov_b32 s80, 1600000
LW_198:
    ds_read_b32 v161, v160
    s_waitcnt lgkmcnt(0)
    v_readfirstlane_b32 s79, v161
    s_cmp_ge_u32 s79, s81
    s_cbranch_scc1 LWD_199
    s_sub_u32 s80, s80, 1
    s_cmp_lg_u32 s80, 0
    s_cbranch_scc1 LW_198
LWD_199:
    ds_read_b128 v[112:115], v6 offset:0
    ds_read_b128 v[116:119], v6 offset:64
    ds_read_b128 v[120:123], v6 offset:128
    ds_read_b128 v[124:127], v6 offset:192
    ds_read_b128 v[128:131], v6 offset:256
    ds_read_b128 v[132:135], v6 offset:320
    ds_read_b128 v[136:139], v6 offset:384
    ds_read_b128 v[140:143], v6 offset:448
    ds_read_b128 v[144:147], v6 offset:512
    ds_read_b128 v[148:151], v6 offset:576
    ds_read_b128 v[152:155], v6 offset:640
    ds_read_b128 v[156:159], v6 offset:704
    s_waitcnt lgkmcnt(8)
    ds_read_b128 v[20:23], v6 offset:768
    ds_read_b128 v[24:27], v6 offset:832
    ds_read_b128 v[28:31], v6 offset:896
    ds_read_b128 v[32:35], v6 offset:960
    v_mfma_f32_16x16x32_bf16 v[12:15], v[48:51], v[112:115], 0
    v_mfma_f32_16x16x32_bf16 v[12:15], v[52:55], v[116:119], v[12:15]
    v_mfma_f32_16x16x32_bf16 v[12:15], v[56:59], v[120:123], v[12:15]
    v_mfma_f32_16x16x32_bf16 v[12:15], v[60:63], v[124:127], v[12:15]
    s_waitcnt lgkmcnt(11)
    v_mfma_f32_16x16x32_bf16 v[12:15], v[64:67], v[128:131], v[12:15]
    s_waitcnt lgkmcnt(10)
    v_mfma_f32_16x16x32_bf16 v[12:15], v[68:71], v[132:135], v[12:15]
    s_waitcnt lgkmcnt(9)
    v_mfma_f32_16x16x32_bf16 v[12:15], v[72:75], v[136:139], v[12:15]
    s_waitcnt lgkmcnt(8)
    v_mfma_f32_16x16x32_bf16 v[12:15], v[76:79], v[140:143], v[12:15]
    s_waitcnt lgkmcnt(7)
    v_mfma_f32_16x16x32_bf16 v[12:15], v[80:83], v[144:147], v[12:15]
    s_waitcnt lgkmcnt(6)
    v_mfma_f32_16x16x32_bf16 v[12:15], v[84:87], v[148:151], v[12:15]
    s_waitcnt lgkmcnt(5)
    v_mfma_f32_16x16x32_bf16 v[12:15], v[88:91], v[152:155], v[12:15]
    s_waitcnt lgkmcnt(4)
    v_mfma_f32_16x16x32_bf16 v[12:15], v[92:95], v[156:159], v[12:15]
    s_waitcnt lgkmcnt(3)
    v_mfma_f32_16x16x32_bf16 v[12:15], v[96:99], v[20:23], v[12:15]
    s_waitcnt lgkmcnt(2)
    v_mfma_f32_16x16x32_bf16 v[12:15], v[100:103], v[24:27], v[12:15]
    s_waitcnt lgkmcnt(1)
    v_mfma_f32_16x16x32_bf16 v[12:15], v[104:107], v[28:31], v[12:15]
    s_waitcnt lgkmcnt(0)
    v_mfma_f32_16x16x32_bf16 v[12:15], v[108:111], v[32:35], v[12:15]
    s_nop 7
    v_cvt_pk_bf16_f32 v16, v12, v13
    v_cvt_pk_bf16_f32 v17, v14, v15
    s_mov_b64 exec, s[84:85]
    buffer_store_dwordx4 v[16:19], v7, s[36:39], 0 offen sc1
    s_mov_b64 exec, -1
    v_mov_b32 v160, 0x24214
    v_mov_b32 v161, 1
    s_mov_b64 exec, 1
    ds_add_u32 v160, v161
    s_mov_b64 exec, -1
    s_branch L_RED
SU_9:
    s_nop 3
    buffer_store_dwordx4 v[72:75], v4, s[36:39], 0 offen sc1
    s_branch SV_10
SU_13:
    s_nop 3
    buffer_store_dwordx4 v[64:67], v5, s[36:39], 0 offen sc1
    s_branch SV_14
ST_21:
    ds_read_b32 v18, v17
    s_waitcnt lgkmcnt(0)
    v_readlane_b32 s79, v18, s62
    s_cmp_ge_u32 s79, s63
    s_cbranch_scc1 GO_20
    s_waitcnt vmcnt(24)
    s_sub_u32 s7, s60, 24
    v_mov_b32 v19, s7
    ds_max_i32 v16, v19
    ds_read_b32 v18, v17
    s_waitcnt lgkmcnt(0)
    v_readlane_b32 s79, v18, s62
    s_cmp_ge_u32 s79, s63
    s_cbranch_scc1 GO_20
    s_waitcnt vmcnt(16)
    s_sub_u32 s7, s60, 16
    v_mov_b32 v19, s7
    ds_max_i32 v16, v19
    ds_read_b32 v18, v17
    s_waitcnt lgkmcnt(0)
    v_readlane_b32 s79, v18, s62
    s_cmp_ge_u32 s79, s63
    s_cbranch_scc1 GO_20
    s_waitcnt vmcnt(8)
    s_sub_u32 s7, s60, 8
    v_mov_b32 v19, s7
    ds_max_i32 v16, v19
    ds_read_b32 v18, v17
    s_waitcnt lgkmcnt(0)
    v_readlane_b32 s79, v18, s62
    s_cmp_ge_u32 s79, s63
    s_cbranch_scc1 GO_20
    s_waitcnt vmcnt(0)
    v_mov_b32 v19, s60
    ds_max_i32 v16, v19
    ds_read_b32 v18, v17
    s_waitcnt lgkmcnt(0)
    v_readlane_b32 s79, v18, s62
    s_cmp_ge_u32 s79, s63
    s_cbranch_scc1 GO_20
    s_mov_b32 s80, 1600000
SP_200:
    ds_read_b32 v18, v17
    s_waitcnt lgkmcnt(0)
    v_readlane_b32 s79, v18, s62
    s_cmp_ge_u32 s79, s63
    s_cbranch_scc1 GO_20
    s_sub_u32 s80, s80, 1
    s_cmp_lg_u32 s80, 0
    s_cbranch_scc1 SP_200
    s_branch GO_20
ST_30:
    ds_read_b32 v18, v17
    s_waitcnt lgkmcnt(0)
    v_readlane_b32 s79, v18, s62
    s_cmp_ge_u32 s79, s63
    s_cbranch_scc1 GO_29
    s_waitcnt vmcnt(40)
    s_sub_u32 s7, s60, 40
    v_mov_b32 v19, s7
    ds_max_i32 v16, v19
    ds_read_b32 v18, v17
    s_waitcnt lgkmcnt(0)
    v_readlane_b32 s79, v18, s62
    s_cmp_ge_u32 s79, s63
    s_cbranch_scc1 GO_29
    s_waitcnt vmcnt(32)
    s_sub_u32 s7, s60, 32
    v_mov_b32 v19, s7
    ds_max_i32 v16, v19
    ds_read_b32 v18, v17
    s_waitcnt lgkmcnt(0)
    v_readlane_b32 s79, v18, s62
    s_cmp_ge_u32 s79, s63
    s_cbranch_scc1 GO_29
    s_waitcnt vmcnt(24)
    s_sub_u32 s7, s60, 24
    v_mov_b32 v19, s7
    ds_max_i32 v16, v19
    ds_read_b32 v18, v17
    s_waitcnt lgkmcnt(0)
    v_readlane_b32 s79, v18, s62
    s_cmp_ge_u32 s79, s63
    s_cbranch_scc1 GO_29
    s_waitcnt vmcnt(16)
    s_sub_u32 s7, s60, 16
    v_mov_b32 v19, s7
    ds_max_i32 v16, v19
    ds_read_b32 v18, v17
    s_waitcnt lgkmcnt(0)
    v_readlane_b32 s79, v18, s62
    s_cmp_ge_u32 s79, s63
    s_cbranch_scc1 GO_29
    s_waitcnt vmcnt(8)
    s_sub_u32 s7, s60, 8
    v_mov_b32 v19, s7
    ds_max_i32 v16, v19
    ds_read_b32 v18, v17
    s_waitcnt lgkmcnt(0)
    v_readlane_b32 s79, v18, s62
    s_cmp_ge_u32 s79, s63
    s_cbranch_scc1 GO_29
    s_waitcnt vmcnt(0)
    v_mov_b32 v19, s60
    ds_max_i32 v16, v19
    ds_read_b32 v18, v17
    s_waitcnt lgkmcnt(0)
    v_readlane_b32 s79, v18, s62
    s_cmp_ge_u32 s79, s63
    s_cbranch_scc1 GO_29
    s_mov_b32 s80, 1600000
SP_201:
    ds_read_b32 v18, v17
    s_waitcnt lgkmcnt(0)
    v_readlane_b32 s79, v18, s62
    s_cmp_ge_u32 s79, s63
    s_cbranch_scc1 GO_29
    s_sub_u32 s80, s80, 1
    s_cmp_lg_u32 s80, 0
    s_cbranch_scc1 SP_201
    s_branch GO_29
ST_39:
    ds_read_b32 v18, v17
    s_waitcnt lgkmcnt(0)
    v_readlane_b32 s79, v18, s62
    s_cmp_ge_u32 s79, s63
    s_cbranch_scc1 GO_38
    s_waitcnt vmcnt(40)
    s_sub_u32 s7, s60, 40
    v_mov_b32 v19, s7
    ds_max_i32 v16, v19
    ds_read_b32 v18, v17
    s_waitcnt lgkmcnt(0)
    v_readlane_b32 s79, v18, s62
    s_cmp_ge_u32 s79, s63
    s_cbranch_scc1 GO_38
    s_waitcnt vmcnt(32)
    s_sub_u32 s7, s60, 32
    v_mov_b32 v19, s7
    ds_max_i32 v16, v19
    ds_read_b32 v18, v17
    s_waitcnt lgkmcnt(0)
    v_readlane_b32 s79, v18, s62
    s_cmp_ge_u32 s79, s63
    s_cbranch_scc1 GO_38
    s_waitcnt vmcnt(24)
    s_sub_u32 s7, s60, 24
    v_mov_b32 v19, s7
    ds_max_i32 v16, v19
    ds_read_b32 v18, v17
    s_waitcnt lgkmcnt(0)
    v_readlane_b32 s79, v18, s62
    s_cmp_ge_u32 s79, s63
    s_cbranch_scc1 GO_38
    s_waitcnt vmcnt(16)
    s_sub_u32 s7, s60, 16
    v_mov_b32 v19, s7
    ds_max_i32 v16, v19
    ds_read_b32 v18, v17
    s_waitcnt lgkmcnt(0)
    v_readlane_b32 s79, v18, s62
    s_cmp_ge_u32 s79, s63
    s_cbranch_scc1 GO_38
    s_waitcnt vmcnt(8)
    s_sub_u32 s7, s60, 8
    v_mov_b32 v19, s7
    ds_max_i32 v16, v19
    ds_read_b32 v18, v17
    s_waitcnt lgkmcnt(0)
    v_readlane_b32 s79, v18, s62
    s_cmp_ge_u32 s79, s63
    s_cbranch_scc1 GO_38
    s_waitcnt vmcnt(0)
    v_mov_b32 v19, s60
    ds_max_i32 v16, v19
    ds_read_b32 v18, v17
    s_waitcnt lgkmcnt(0)
    v_readlane_b32 s79, v18, s62
    s_cmp_ge_u32 s79, s63
    s_cbranch_scc1 GO_38
    s_mov_b32 s80, 1600000
SP_202:
    ds_read_b32 v18, v17
    s_waitcnt lgkmcnt(0)
    v_readlane_b32 s79, v18, s62
    s_cmp_ge_u32 s79, s63
    s_cbranch_scc1 GO_38
    s_sub_u32 s80, s80, 1
    s_cmp_lg_u32 s80, 0
    s_cbranch_scc1 SP_202
    s_branch GO_38
ST_50:
    ds_read_b32 v18, v17
    s_waitcnt lgkmcnt(0)
    v_readlane_b32 s79, v18, s62
    s_cmp_ge_u32 s79, s63
    s_cbranch_scc1 GO_49
    s_waitcnt vmcnt(16)
    s_sub_u32 s7, s60, 16
    v_mov_b32 v19, s7
    ds_max_i32 v16, v19
    ds_read_b32 v18, v17
    s_waitcnt lgkmcnt(0)
    v_readlane_b32 s79, v18, s62
    s_cmp_ge_u32 s79, s63
    s_cbranch_scc1 GO_49
    s_waitcnt vmcnt(8)
    s_sub_u32 s7, s60, 8
    v_mov_b32 v19, s7
    ds_max_i32 v16, v19
    ds_read_b32 v18, v17
    s_waitcnt lgkmcnt(0)
    v_readlane_b32 s79, v18, s62
    s_cmp_ge_u32 s79, s63
    s_cbranch_scc1 GO_49
    s_waitcnt vmcnt(0)
    v_mov_b32 v19, s60
    ds_max_i32 v16, v19
    ds_read_b32 v18, v17
    s_waitcnt lgkmcnt(0)
    v_readlane_b32 s79, v18, s62
    s_cmp_ge_u32 s79, s63
    s_cbranch_scc1 GO_49
    s_mov_b32 s80, 1600000
SP_203:
    ds_read_b32 v18, v17
    s_waitcnt lgkmcnt(0)
    v_readlane_b32 s79, v18, s62
    s_cmp_ge_u32 s79, s63
    s_cbranch_scc1 GO_49
    s_sub_u32 s80, s80, 1
    s_cmp_lg_u32 s80, 0
    s_cbranch_scc1 SP_203
    s_branch GO_49
ST_53:
    ds_read_b32 v18, v17
    s_waitcnt lgkmcnt(0)
    v_readlane_b32 s79, v18, s62
    s_cmp_ge_u32 s79, s63
    s_cbranch_scc1 GO_52
    s_waitcnt vmcnt(24)
    s_sub_u32 s7, s60, 24
    v_mov_b32 v19, s7
    ds_max_i32 v16, v19
    ds_read_b32 v18, v17
    s_waitcnt lgkmcnt(0)
    v_readlane_b32 s79, v18, s62
    s_cmp_ge_u32 s79, s63
    s_cbranch_scc1 GO_52
    s_waitcnt vmcnt(16)
    s_sub_u32 s7, s60, 16
    v_mov_b32 v19, s7
    ds_max_i32 v16, v19
    ds_read_b32 v18, v17
    s_waitcnt lgkmcnt(0)
    v_readlane_b32 s79, v18, s62
    s_cmp_ge_u32 s79, s63
    s_cbranch_scc1 GO_52
    s_waitcnt vmcnt(8)
    s_sub_u32 s7, s60, 8
    v_mov_b32 v19, s7
    ds_max_i32 v16, v19
    ds_read_b32 v18, v17
    s_waitcnt lgkmcnt(0)
    v_readlane_b32 s79, v18, s62
    s_cmp_ge_u32 s79, s63
    s_cbranch_scc1 GO_52
    s_waitcnt vmcnt(0)
    v_mov_b32 v19, s60
    ds_max_i32 v16, v19
    ds_read_b32 v18, v17
    s_waitcnt lgkmcnt(0)
    v_readlane_b32 s79, v18, s62
    s_cmp_ge_u32 s79, s63
    s_cbranch_scc1 GO_52
    s_mov_b32 s80, 1600000
SP_204:
    ds_read_b32 v18, v17
    s_waitcnt lgkmcnt(0)
    v_readlane_b32 s79, v18, s62
    s_cmp_ge_u32 s79, s63
    s_cbranch_scc1 GO_52
    s_sub_u32 s80, s80, 1
    s_cmp_lg_u32 s80, 0
    s_cbranch_scc1 SP_204
    s_branch GO_52
ST_55:
    ds_read_b32 v18, v17
    s_waitcnt lgkmcnt(0)
    v_readlane_b32 s79, v18, 0
    s_cmp_ge_u32 s79, s63
    s_cbranch_scc1 GO_54
    s_waitcnt vmcnt(24)
    s_sub_u32 s7, s60, 24
    v_mov_b32 v19, s7
    ds_max_i32 v16, v19
    ds_read_b32 v18, v17
    s_waitcnt lgkmcnt(0)
    v_readlane_b32 s79, v18, 0
    s_cmp_ge_u32 s79, s63
    s_cbranch_scc1 GO_54
    s_waitcnt vmcnt(16)
    s_sub_u32 s7, s60, 16
    v_mov_b32 v19, s7
    ds_max_i32 v16, v19
    ds_read_b32 v18, v17
    s_waitcnt lgkmcnt(0)
    v_readlane_b32 s79, v18, 0
    s_cmp_ge_u32 s79, s63
    s_cbranch_scc1 GO_54
    s_waitcnt vmcnt(8)
    s_sub_u32 s7, s60, 8
    v_mov_b32 v19, s7
    ds_max_i32 v16, v19
    ds_read_b32 v18, v17
    s_waitcnt lgkmcnt(0)
    v_readlane_b32 s79, v18, 0
    s_cmp_ge_u32 s79, s63
    s_cbranch_scc1 GO_54
    s_waitcnt vmcnt(0)
    v_mov_b32 v19, s60
    ds_max_i32 v16, v19
    ds_read_b32 v18, v17
    s_waitcnt lgkmcnt(0)
    v_readlane_b32 s79, v18, 0
    s_cmp_ge_u32 s79, s63
    s_cbranch_scc1 GO_54
    s_mov_b32 s80, 1600000
SP_205:
    ds_read_b32 v18, v17
    s_waitcnt lgkmcnt(0)
    v_readlane_b32 s79, v18, 0
    s_cmp_ge_u32 s79, s63
    s_cbranch_scc1 GO_54
    s_sub_u32 s80, s80, 1
    s_cmp_lg_u32 s80, 0
    s_cbranch_scc1 SP_205
    s_branch GO_54
M_59:
    s_sub_u32 s80, s80, 1
    s_cmp_le_u32 s80, 0
    s_cbranch_scc1 MD_61
    s_mov_b64 exec, s[62:63]
    s_cbranch_execz RS_206
    buffer_load_dwordx4 v[48:51], v36, s[36:39], 0 offen offset:0 sc1
RS_206:
    s_mov_b64 exec, s[64:65]
    s_cbranch_execz RS_207
    buffer_load_dwordx4 v[52:55], v36, s[36:39], 0 offen offset:1024 sc1
RS_207:
    s_mov_b64 exec, s[66:67]
    s_cbranch_execz RS_208
    buffer_load_dwordx4 v[56:59], v36, s[36:39], 0 offen offset:2048 sc1
RS_208:
    s_mov_b64 exec, s[68:69]
    s_cbranch_execz RS_209
    buffer_load_dwordx4 v[60:63], v36, s[36:39], 0 offen offset:3072 sc1
RS_209:
    s_branch MC_60
M_62:
    s_sub_u32 s80, s80, 1
    s_cmp_le_u32 s80, 0
    s_cbranch_scc1 MD_64
    s_mov_b64 exec, s[62:63]
    s_cbranch_execz RS_210
    buffer_load_dwordx4 v[48:51], v36, s[36:39], 0 offen offset:0 sc1
RS_210:
    s_mov_b64 exec, s[64:65]
    s_cbranch_execz RS_211
    buffer_load_dwordx4 v[52:55], v36, s[36:39], 0 offen offset:1024 sc1
RS_211:
    s_branch MC_63
M_84:
    s_sleep 4
    s_sub_u32 s80, s80, 1
    s_cmp_le_u32 s80, 0
    s_cbranch_scc1 MD_86
    s_mov_b64 exec, s[44:45]
    s_cbranch_execz RS_212
    buffer_load_dwordx4 v[48:51], v7, s[36:39], 0 offen sc1 nt
RS_212:
    s_mov_b64 exec, s[46:47]
    s_cbranch_execz RS_213
    buffer_load_dwordx4 v[52:55], v22, s[36:39], 0 offen sc1 nt
RS_213:
    s_branch MC_85
SU_92:
    s_nop 3
    buffer_store_dwordx4 v[64:67], v8, s[36:39], 0 offen sc1
    s_branch SV_93
AW_96:
    s_mov_b64 exec, 0x3f
    s_cmp_eq_u32 s71, 1
    s_cbranch_scc1 AX_214
    buffer_load_dwordx4 v[116:119], v12, s[36:39], 0 offen sc1 nt
    s_mov_b64 exec, -1
    s_branch AWB_97
AX_214:
    s_mov_b32 s80, 200000
    s_branch PP_216
P_215:
    buffer_load_dwordx4 v[116:119], v12, s[36:39], 0 offen sc1 nt
PP_216:
    s_waitcnt vmcnt(0)
    v_cmp_ne_u64 s[90:91], s[92:93], v[118:119]
    s_cmp_lg_u64 s[90:91], 0
    s_cbranch_scc0 PD_217
    s_sleep 2
    s_sub_u32 s80, s80, 1
    s_cmp_lg_u32 s80, 0
    s_cbranch_scc1 P_215
PD_217:
    s_mov_b64 exec, -1
    v_mov_b32 v118, v116
    s_nop 1
    v_max_f32_dpp v118, v118, v118 row_ror:1 row_mask:0xf bank_mask:0xf
    s_nop 1
    v_max_f32_dpp v118, v118, v118 row_ror:2 row_mask:0xf bank_mask:0xf
    s_nop 1
    v_max_f32_dpp v118, v118, v118 row_ror:4 row_mask:0xf bank_mask:0xf
    s_nop 1
    v_max_f32_dpp v118, v118, v118 row_ror:8 row_mask:0xf bank_mask:0xf
    v_sub_f32 v116, v116, v118
    v_sub_f32 v119, v64, v118
    v_exp_f32 v116, v116
    v_exp_f32 v119, v119
    v_mul_f32 v116, v116, v117
    s_nop 1
    v_add_f32_dpp v116, v116, v116 row_ror:1 row_mask:0xf bank_mask:0xf
    s_nop 1
    v_add_f32_dpp v116, v116, v116 row_ror:2 row_mask:0xf bank_mask:0xf
    s_nop 1
    v_add_f32_dpp v116, v116, v116 row_ror:4 row_mask:0xf bank_mask:0xf
    s_nop 1
    v_add_f32_dpp v116, v116, v116 row_ror:8 row_mask:0xf bank_mask:0xf
    v_rcp_f32 v116, v116
    s_nop 0
    v_mul_f32 v116, v116, v119
    s_nop 0
    v_readfirstlane_b32 s72, v116
    s_branch AWB_97
SU_100:
    s_nop 3
    buffer_store_dwordx4 v[68:71], v6, s[36:39], 0 offen sc1
    s_branch SV_101
M_104:
    s_sub_u32 s80, s80, 1
    s_cmp_le_u32 s80, 0
    s_cbranch_scc1 MD_106
    s_mov_b64 exec, s[64:65]
    s_cbranch_execz RS_218
    buffer_load_dwordx4 v[112:115], v5, s[36:39], 0 offen sc1 nt
RS_218:
    s_mov_b64 exec, s[66:67]
    s_cbranch_execz RS_219
    buffer_load_dwordx4 v[116:119], v5, s[36:39], s62 offen sc1 nt
RS_219:
    s_mov_b64 exec, s[68:69]
    s_cbranch_execz RS_220
    buffer_load_dwordx4 v[120:123], v5, s[36:39], s63 offen sc1 nt
RS_220:
    s_branch MC_105
M_114:
    s_sub_u32 s80, s80, 1
    s_cmp_le_u32 s80, 199994
    s_cbranch_scc1 G2_111
    s_mov_b64 exec, s[44:45]
    s_cbranch_execz RS_221
    buffer_load_dwordx4 v[48:51], v7, s[36:39], 0 offen sc1 nt
RS_221:
    s_mov_b64 exec, s[46:47]
    s_cbranch_execz RS_222
    buffer_load_dwordx4 v[52:55], v22, s[36:39], 0 offen sc1 nt
RS_222:
    s_branch MC_115
G2_111:
    s_mov_b64 exec, -1
    v_mov_b32 v12, 0x24204
    s_mov_b32 s80, 1600000
LW_223:
    ds_read_b32 v13, v12
    s_waitcnt lgkmcnt(0)
    v_readfirstlane_b32 s79, v13
    s_cmp_ge_u32 s79, 1
    s_cbranch_scc1 LWD_224
    s_sleep 1
    s_sub_u32 s80, s80, 1
    s_cmp_lg_u32 s80, 0
    s_cbranch_scc1 LW_223
LWD_224:
    v_mov_b32 v12, 0x24248
    ds_read_b64 v[14:15], v12
    s_waitcnt lgkmcnt(0)
    v_readfirstlane_b32 s92, v14
    v_readfirstlane_b32 s93, v15
    s_mov_b32 s80, 200000
P_225:
    buffer_load_dwordx4 v[48:51], v7, s[36:39], 0 offen sc1 nt
    buffer_load_dwordx4 v[52:55], v22, s[36:39], 0 offen sc1 nt
PP_226:
    s_waitcnt vmcnt(0)
    s_mov_b64 s[90:91], 0
    v_cmp_gt_u64 s[88:89], s[94:95], v[50:51]
    v_cmp_le_u64 vcc, s[72:73], v[50:51]
    s_or_b64 s[88:89], s[88:89], vcc
    v_cmp_ne_u64 vcc, s[92:93], v[50:51]
    s_and_b64 vcc, vcc, s[88:89]
    s_or_b64 s[90:91], s[90:91], vcc
    v_cmp_gt_u64 s[88:89], s[94:95], v[54:55]
    v_cmp_le_u64 vcc, s[72:73], v[54:55]
    s_or_b64 s[88:89], s[88:89], vcc
    v_cmp_ne_u64 vcc, s[92:93], v[54:55]
    s_and_b64 vcc, vcc, s[88:89]
    s_or_b64 s[90:91], s[90:91], vcc
    s_cbranch_scc0 PD_227
    s_sleep 1
    s_sub_u32 s80, s80, 1
    s_cmp_lg_u32 s80, 0
    s_cbranch_scc1 P_225
PD_227:
    s_branch MD_116
M_130:
    s_sleep 8
    s_sub_u32 s80, s80, 1
    s_cmp_le_u32 s80, 0
    s_cbranch_scc1 MD_132
    s_mov_b64 exec, s[64:65]
    s_cbranch_execz RS_228
    buffer_load_dwordx2 v[12:13], v4, s[36:39], 0 offen offset:16 sc1
RS_228:
    s_branch MC_131
M_134:
    s_sleep 6
    s_sub_u32 s80, s80, 1
    s_cmp_le_u32 s80, 0
    s_cbranch_scc1 MD_136
    s_mov_b64 exec, s[64:65]
    s_cbranch_execz RS_229
    buffer_load_dwordx2 v[12:13], v9, s[36:39], 0 offen sc1 nt
RS_229:
    s_branch MC_135
M_137:
    s_sub_u32 s80, s80, 1
    s_cmp_le_u32 s80, 0
    s_cbranch_scc1 MD_139
    s_mov_b64 exec, s[64:65]
    s_cbranch_execz RS_230
    buffer_load_dwordx4 v[16:19], v5, s[36:39], 0 offen offset:0 sc1
RS_230:
    s_mov_b64 exec, s[66:67]
    s_cbranch_execz RS_231
    buffer_load_dwordx4 v[20:23], v5, s[36:39], 0 offen offset:1024 sc1
RS_231:
    s_mov_b64 exec, s[68:69]
    s_cbranch_execz RS_232
    buffer_load_dwordx4 v[12:15], v4, s[36:39], 0 offen sc1
RS_232:
    s_branch MC_138
SU_142:
    s_nop 3
    buffer_store_dwordx4 v[16:19], v10, s[36:39], 0 offen sc1
    s_branch SV_143
M_146:
    s_sleep 2
    s_sub_u32 s80, s80, 1
    s_cmp_le_u32 s80, 0
    s_cbranch_scc1 MD_148
    s_mov_b64 exec, s[44:45]
    s_cbranch_execz RS_233
    buffer_load_dwordx2 v[16:17], v144, s[36:39], 0 offen sc1
RS_233:
    s_branch MC_147
M_159:
    s_sleep 1
    s_sub_u32 s80, s80, 1
    s_cmp_le_u32 s80, 0
    s_cbranch_scc1 MD_161
    s_mov_b64 exec, s[44:45]
    s_cbranch_execz RS_234
    buffer_load_dwordx4 v[128:131], v145, s[36:39], 0 offen offset:0 sc1
RS_234:
    s_mov_b64 exec, s[46:47]
    s_cbranch_execz RS_235
    buffer_load_dwordx4 v[132:135], v145, s[36:39], 0 offen offset:1024 sc1
RS_235:
    s_mov_b64 exec, s[48:49]
    s_cbranch_execz RS_236
    buffer_load_dwordx4 v[136:139], v145, s[36:39], 0 offen offset:2048 sc1
RS_236:
    s_mov_b64 exec, s[50:51]
    s_cbranch_execz RS_237
    buffer_load_dwordx4 v[140:143], v145, s[36:39], 0 offen offset:3072 sc1
RS_237:
    s_branch MC_160
SU_178:
    s_nop 3
    buffer_store_dwordx4 v[36:39], v44, s[36:39], 0 offen sc1
    s_branch SV_179
SU_180:
    s_nop 3
    buffer_store_dwordx4 v[16:19], v5, s[36:39], 0 offen offset:0 sc1
    buffer_store_dwordx4 v[20:23], v5, s[36:39], 0 offen offset:1024 sc1
    buffer_store_dwordx4 v[24:27], v5, s[36:39], 0 offen offset:2048 sc1
    buffer_store_dwordx4 v[28:31], v5, s[36:39], 0 offen offset:3072 sc1
    s_waitcnt vmcnt(0)
    s_mov_b64 exec, s[88:89]
    buffer_store_dwordx2 v[38:39], v7, s[36:39], 0 offen sc1
    s_mov_b64 exec, -1
    s_branch SV_181
M_182:
    s_sub_u32 s80, s80, 1
    s_cmp_le_u32 s80, 0
    s_cbranch_scc1 MD_184
    s_mov_b64 exec, s[86:87]
    s_cbranch_execz RS_238
    buffer_load_dwordx2 v[40:41], v7, s[36:39], 0 offen sc1 nt
RS_238:
    s_branch MC_183
BL_185:
    s_mov_b32 s80, 200000
P_239:
    buffer_load_dwordx4 v[64:67], v6, s[36:39], 0 offen offset:0 sc1 nt
    buffer_load_dwordx4 v[68:71], v6, s[36:39], 0 offen offset:1024 sc1 nt
    buffer_load_dwordx4 v[72:75], v6, s[36:39], 0 offen offset:2048 sc1 nt
    buffer_load_dwordx4 v[76:79], v6, s[36:39], 0 offen offset:3072 sc1 nt
PP_240:
    s_waitcnt vmcnt(0)
    v_cmp_ne_u64 s[90:91], s[92:93], v[66:67]
    v_cmp_ne_u64 vcc, s[92:93], v[70:71]
    s_or_b64 s[90:91], s[90:91], vcc
    v_cmp_ne_u64 vcc, s[92:93], v[74:75]
    s_or_b64 s[90:91], s[90:91], vcc
    v_cmp_ne_u64 vcc, s[92:93], v[78:79]
    s_or_b64 s[90:91], s[90:91], vcc
    s_cmp_lg_u64 s[90:91], 0
    s_cbranch_scc0 PD_241
    s_sub_u32 s80, s80, 1
    s_cmp_lg_u32 s80, 0
    s_cbranch_scc1 P_239
PD_241:
    s_branch BLD_186
M_195:
    s_sleep 1
    s_sub_u32 s80, s80, 1
    s_cmp_le_u32 s80, 0
    s_cbranch_scc1 MD_197
    s_mov_b64 exec, s[86:87]
    s_cbranch_execz RS_242
    buffer_load_dwordx4 v[16:19], v4, s[36:39], 0 offen sc1 nt
RS_242:
    s_branch MC_196
L_END:
    s_endpgm
.section .rodata,"a"
.p2align 6
.amdhsa_kernel concat_heads__sliding_block_cached__compressed_kv_cla__decode_kernel
  .amdhsa_next_free_vgpr 168
  .amdhsa_next_free_sgpr 102
  .amdhsa_accum_offset 168
  .amdhsa_group_segment_fixed_size 0
  .amdhsa_kernarg_size 112
  .amdhsa_user_sgpr_count 2
  .amdhsa_user_sgpr_kernarg_segment_ptr 1
  .amdhsa_system_sgpr_workgroup_id_x 1
  .amdhsa_float_denorm_mode_32 3
.end_amdhsa_kernel
```

```asm
; @launch grid=(256,1,1) block=(576,1,1) lds=163840
.amdgcn_target "amdgcn-amd-amdhsa--gfx950"
.text
.globl concat_heads__sliding_block_cached__compressed_kv_cla__decode_kernel
.p2align 8
.type concat_heads__sliding_block_cached__compressed_kv_cla__decode_kernel,@function
concat_heads__sliding_block_cached__compressed_kv_cla__decode_kernel:
    s_cmp_ge_u32 s2, 256
    s_cbranch_scc1 L_END
    s_load_dwordx16 s[8:23], s[0:1], 0
    s_load_dwordx8 s[24:31], s[0:1], 64
    s_load_dwordx4 s[32:35], s[0:1], 96
    s_memrealtime s[94:95]
    v_lshrrev_b32 v1, 6, v0
    s_nop 0
    v_readfirstlane_b32 s3, v1
    v_and_b32 v1, 63, v0
    v_lshrrev_b32 v2, 4, v1
    v_and_b32 v3, 15, v1
    s_and_b32 s4, s2, 7
    s_lshr_b32 s7, s2, 6
    s_lshl_b32 s7, s7, 3
    s_or_b32 s4, s4, s7
    s_bfe_u32 s5, s2, 0x30003
    s_getreg_b32 s78, hwreg(HW_REG_XCC_ID, 0, 4)
    s_lshl_b32 s78, s78, 26
    s_xor_b32 s6, s3, 4
    s_cmp_eq_u32 s3, 8
    s_cselect_b32 s7, 8, 0
    s_add_u32 s7, s7, s5
    s_cmp_ge_u32 s7, 14
    s_cbranch_scc1 L_LDB
    s_cmp_ge_u32 s7, 12
    s_cbranch_scc1 L_LDE
    s_cmp_ge_u32 s7, 8
    s_cbranch_scc1 L_LDA
    s_mov_b32 s81, 0
    s_cmp_lt_u32 s6, 4
    s_cbranch_scc1 L_SIDE
    s_cmp_ge_u32 s7, 4
    s_cbranch_scc1 L_QABS
    s_and_b32 s61, s6, 3
    v_lshrrev_b32 v10, 1, v3
    v_xor_b32 v10, v10, v2
    v_lshlrev_b32 v10, 5, v10
    v_lshl_add_u32 v10, v2, 13, v10
    v_and_b32 v40, 1, v1
    v_lshl_add_u32 v10, v40, 4, v10
    v_xor_b32 v11, 0x80, v10
    s_lshl_b32 s65, s5, 20
    s_lshl_b32 s7, s4, 8
    s_add_u32 s65, s65, s7
    s_lshl_b32 s7, s61, 18
    s_add_u32 s65, s65, s7
    s_lshl_b32 s64, s61, 13
    s_add_u32 s64, s64, 0x18000
    v_and_b32 v8, 3, v1
    v_lshlrev_b32 v9, 10, v8
    v_lshl_add_u32 v9, v2, 4, v9
    s_lshl_b32 s62, s5, 8
    s_waitcnt lgkmcnt(0)
    s_mov_b32 s48, s22
    s_and_b32 s49, s23, 0xffff
    s_mov_b32 s50, 0x400000
    s_mov_b32 s51, 0x20000
    s_mov_b32 s63, s65
    s_mov_b32 m0, s64
    s_add_u32 s64, s64, 1024
    buffer_load_dwordx4 v10, s[48:51], s63 offen nt lds
    s_add_u32 s63, s63, 32768
    s_mov_b32 m0, s64
    s_add_u32 s64, s64, 1024
    buffer_load_dwordx4 v11, s[48:51], s63 offen nt lds
    s_add_u32 s63, s63, 32768
    s_mov_b32 m0, s64
    s_add_u32 s64, s64, 1024
    buffer_load_dwordx4 v10, s[48:51], s63 offen nt lds
    s_add_u32 s63, s63, 32768
    s_mov_b32 m0, s64
    s_add_u32 s64, s64, 1024
    buffer_load_dwordx4 v11, s[48:51], s63 offen nt lds
    s_add_u32 s63, s63, 32768
    s_mov_b32 m0, s64
    s_add_u32 s64, s64, 1024
    buffer_load_dwordx4 v10, s[48:51], s63 offen nt lds
    s_add_u32 s63, s63, 32768
    s_mov_b32 m0, s64
    s_add_u32 s64, s64, 1024
    buffer_load_dwordx4 v11, s[48:51], s63 offen nt lds
    s_add_u32 s63, s63, 32768
    s_mov_b32 m0, s64
    s_add_u32 s64, s64, 1024
    buffer_load_dwordx4 v10, s[48:51], s63 offen nt lds
    s_add_u32 s63, s63, 32768
    s_mov_b32 m0, s64
    s_add_u32 s64, s64, 1024
    buffer_load_dwordx4 v11, s[48:51], s63 offen nt lds
    s_add_u32 s63, s63, 32768
    s_mov_b32 s44, s18
    s_and_b32 s45, s19, 0xffff
    s_mov_b32 s46, 0x1000
    s_mov_b32 s47, 0x20000
    buffer_load_dwordx4 v[128:131], v9, s[44:47], s62 offen offset:0
    buffer_load_dwordx4 v[132:135], v9, s[44:47], s62 offen offset:64
    buffer_load_dwordx4 v[136:139], v9, s[44:47], s62 offen offset:128
    buffer_load_dwordx4 v[140:143], v9, s[44:47], s62 offen offset:192
    s_barrier
    s_mov_b32 s36, s34
    s_and_b32 s37, s35, 0xffff
    s_mov_b32 s38, 0x1000000
    s_mov_b32 s39, 0x20000
    s_lshl_b32 s7, s4, 4
    s_add_u32 s7, s7, s5
    s_lshl_b32 s7, s7, 4
    s_add_u32 s7, s7, s61
    s_lshl_b32 s7, s7, 7
    s_add_u32 s7, s7, 0x100000
    v_lshl_add_u32 v4, v8, 9, s7
    v_lshl_add_u32 v4, v2, 4, v4
    v_and_b32 v12, 4, v1
    v_lshl_add_u32 v4, v12, 4, v4
    v_add_u32 v5, 16384, v4
    v_mov_b32 v16, 0
    s_mov_b64 exec, 15
    buffer_store_dword v16, v5, s[36:39], 0 offen
    buffer_load_dword v16, v5, s[36:39], 0 offen sc1 nt
    s_mov_b64 exec, -1
    s_sub_u32 s64, s64, 40960
    s_mov_b32 s48, s14
    s_and_b32 s49, s15, 0xffff
    s_mov_b32 s50, 0x400000
    s_mov_b32 s51, 0x20000
    s_mov_b32 s63, s65
    s_mov_b32 s44, s8
    s_and_b32 s45, s9, 0xffff
    s_mov_b32 s46, 0x1000
    s_mov_b32 s47, 0x20000
    buffer_load_dwordx4 v[144:147], v9, s[44:47], s62 offen offset:0
    buffer_load_dwordx4 v[148:151], v9, s[44:47], s62 offen offset:64
    buffer_load_dwordx4 v[152:155], v9, s[44:47], s62 offen offset:128
    buffer_load_dwordx4 v[156:159], v9, s[44:47], s62 offen offset:192
    s_mov_b32 m0, s64
    s_add_u32 s64, s64, 1024
    buffer_load_dwordx4 v10, s[48:51], s63 offen nt lds
    s_add_u32 s63, s63, 32768
    s_mov_b32 m0, s64
    s_add_u32 s64, s64, 1024
    buffer_load_dwordx4 v11, s[48:51], s63 offen nt lds
    s_add_u32 s63, s63, 32768
    v_cmp_gt_u32 s[84:85], 8, v3
    v_bfe_u32 v21, v1, 2, 2
    v_lshl_add_u32 v20, v2, 3, v21
    s_lshl_b32 s7, s61, 1
    v_xor_b32 v21, s7, v21
    v_lshlrev_b32 v20, 8, v20
    v_lshl_add_u32 v20, v21, 5, v20
    v_lshl_add_u32 v20, v8, 3, v20
    v_add_u32 v20, 0x10000, v20
    v_xor_b32 v21, 32, v20
    v_xor_b32 v22, 0x480, v20
    v_xor_b32 v23, 0x4a0, v20
    s_waitcnt vmcnt(8)
    v_mov_b32 v14, 0x24210
    v_mov_b32 v15, 1
    s_mov_b64 exec, 1
    ds_add_u32 v14, v15
    s_mov_b64 exec, -1
    v_mov_b32 v14, 0x24210
    s_mov_b32 s80, 1600000
LW_1:
    ds_read_b32 v15, v14
    s_waitcnt lgkmcnt(0)
    v_readfirstlane_b32 s79, v15
    s_cmp_ge_u32 s79, 4
    s_cbranch_scc1 LWD_2
    s_sub_u32 s80, s80, 1
    s_cmp_lg_u32 s80, 0
    s_cbranch_scc1 LW_1
LWD_2:
    ds_read_b64_tr_b16 v[32:33], v20 offset:32768
    ds_read_b64_tr_b16 v[34:35], v22 offset:32768
    ds_read_b64_tr_b16 v[36:37], v21 offset:32768
    ds_read_b64_tr_b16 v[38:39], v23 offset:32768
    ds_read_b64_tr_b16 v[40:41], v20 offset:40960
    ds_read_b64_tr_b16 v[42:43], v22 offset:40960
    ds_read_b64_tr_b16 v[44:45], v21 offset:40960
    ds_read_b64_tr_b16 v[46:47], v23 offset:40960
    ds_read_b64_tr_b16 v[48:49], v20 offset:49152
    ds_read_b64_tr_b16 v[50:51], v22 offset:49152
    ds_read_b64_tr_b16 v[52:53], v21 offset:49152
    ds_read_b64_tr_b16 v[54:55], v23 offset:49152
    s_waitcnt lgkmcnt(8)
    ds_read_b64_tr_b16 v[56:57], v20 offset:57344
    ds_read_b64_tr_b16 v[58:59], v22 offset:57344
    ds_read_b64_tr_b16 v[60:61], v21 offset:57344
    ds_read_b64_tr_b16 v[62:63], v23 offset:57344
    s_waitcnt lgkmcnt(12)
    v_mfma_f32_16x16x32_bf16 v[24:27], v[32:35], v[128:131], 0
    v_mfma_f32_16x16x32_bf16 v[28:31], v[36:39], v[128:131], 0
    s_waitcnt lgkmcnt(8)
    v_mfma_f32_16x16x32_bf16 v[24:27], v[40:43], v[132:135], v[24:27]
    v_mfma_f32_16x16x32_bf16 v[28:31], v[44:47], v[132:135], v[28:31]
    s_waitcnt lgkmcnt(4)
    v_mfma_f32_16x16x32_bf16 v[24:27], v[48:51], v[136:139], v[24:27]
    v_mfma_f32_16x16x32_bf16 v[28:31], v[52:55], v[136:139], v[28:31]
    s_waitcnt lgkmcnt(0)
    v_mfma_f32_16x16x32_bf16 v[24:27], v[56:59], v[140:143], v[24:27]
    v_mfma_f32_16x16x32_bf16 v[28:31], v[60:63], v[140:143], v[28:31]
    s_memrealtime s[88:89]
    v_mov_b32 v14, 0x2410c
    v_mov_b32 v15, 1
    s_mov_b64 exec, 1
    ds_add_u32 v14, v15
    s_mov_b64 exec, -1
    s_nop 0
    v_cvt_pk_bf16_f32 v64, v24, v25
    v_cvt_pk_bf16_f32 v65, v26, v27
    v_cvt_pk_bf16_f32 v68, v28, v29
    v_cvt_pk_bf16_f32 v69, v30, v31
    s_nop 0
    v_mov_b32_dpp v64, v68 quad_perm:[0,1,2,3] row_mask:0xf bank_mask:0x2
    v_mov_b32_dpp v65, v69 quad_perm:[0,1,2,3] row_mask:0xf bank_mask:0x2
    s_waitcnt lgkmcnt(0)
    s_or_b32 s89, s89, s78
    v_mov_b32 v66, s88
    v_mov_b32 v67, s89
    s_mov_b64 exec, s[84:85]
    buffer_store_dwordx4 v[64:67], v5, s[36:39], 0 offen
    s_mov_b64 exec, -1
    s_mov_b32 m0, s64
    s_add_u32 s64, s64, 1024
    buffer_load_dwordx4 v10, s[48:51], s63 offen nt lds
    s_add_u32 s63, s63, 32768
    s_mov_b32 m0, s64
    s_add_u32 s64, s64, 1024
    buffer_load_dwordx4 v11, s[48:51], s63 offen nt lds
    s_add_u32 s63, s63, 32768
    s_mov_b32 m0, s64
    s_add_u32 s64, s64, 1024
    buffer_load_dwordx4 v10, s[48:51], s63 offen nt lds
    s_add_u32 s63, s63, 32768
    s_mov_b32 m0, s64
    s_add_u32 s64, s64, 1024
    buffer_load_dwordx4 v11, s[48:51], s63 offen nt lds
    s_add_u32 s63, s63, 32768
    s_mov_b32 m0, s64
    s_add_u32 s64, s64, 1024
    buffer_load_dwordx4 v10, s[48:51], s63 offen nt lds
    s_add_u32 s63, s63, 32768
    s_mov_b32 m0, s64
    s_add_u32 s64, s64, 1024
    buffer_load_dwordx4 v11, s[48:51], s63 offen nt lds
    s_add_u32 s63, s63, 32768
    v_mov_b32 v14, 0x24210
    v_mov_b32 v15, 1
    s_mov_b64 exec, 1
    ds_add_u32 v14, v15
    s_mov_b64 exec, -1
    s_waitcnt vmcnt(0)
    v_mov_b32 v14, 0x24210
    v_mov_b32 v15, 1
    s_mov_b64 exec, 1
    ds_add_u32 v14, v15
    s_mov_b64 exec, -1
    v_mov_b32 v14, 0x24210
    s_mov_b32 s80, 1600000
LW_3:
    ds_read_b32 v15, v14
    s_waitcnt lgkmcnt(0)
    v_readfirstlane_b32 s79, v15
    s_cmp_ge_u32 s79, 12
    s_cbranch_scc1 LWD_4
    s_sub_u32 s80, s80, 1
    s_cmp_lg_u32 s80, 0
    s_cbranch_scc1 LW_3
LWD_4:
    ds_read_b64_tr_b16 v[32:33], v20 offset:0
    ds_read_b64_tr_b16 v[34:35], v22 offset:0
    ds_read_b64_tr_b16 v[36:37], v21 offset:0
    ds_read_b64_tr_b16 v[38:39], v23 offset:0
    ds_read_b64_tr_b16 v[40:41], v20 offset:8192
    ds_read_b64_tr_b16 v[42:43], v22 offset:8192
    ds_read_b64_tr_b16 v[44:45], v21 offset:8192
    ds_read_b64_tr_b16 v[46:47], v23 offset:8192
    ds_read_b64_tr_b16 v[48:49], v20 offset:16384
    ds_read_b64_tr_b16 v[50:51], v22 offset:16384
    ds_read_b64_tr_b16 v[52:53], v21 offset:16384
    ds_read_b64_tr_b16 v[54:55], v23 offset:16384
    s_waitcnt lgkmcnt(8)
    ds_read_b64_tr_b16 v[56:57], v20 offset:24576
    ds_read_b64_tr_b16 v[58:59], v22 offset:24576
    ds_read_b64_tr_b16 v[60:61], v21 offset:24576
    ds_read_b64_tr_b16 v[62:63], v23 offset:24576
    s_waitcnt lgkmcnt(12)
    v_mfma_f32_16x16x32_bf16 v[24:27], v[32:35], v[144:147], 0
    v_mfma_f32_16x16x32_bf16 v[28:31], v[36:39], v[144:147], 0
    s_waitcnt lgkmcnt(8)
    v_mfma_f32_16x16x32_bf16 v[24:27], v[40:43], v[148:151], v[24:27]
    v_mfma_f32_16x16x32_bf16 v[28:31], v[44:47], v[148:151], v[28:31]
    s_waitcnt lgkmcnt(4)
    v_mfma_f32_16x16x32_bf16 v[24:27], v[48:51], v[152:155], v[24:27]
    v_mfma_f32_16x16x32_bf16 v[28:31], v[52:55], v[152:155], v[28:31]
    s_waitcnt lgkmcnt(0)
    v_mfma_f32_16x16x32_bf16 v[24:27], v[56:59], v[156:159], v[24:27]
    v_mfma_f32_16x16x32_bf16 v[28:31], v[60:63], v[156:159], v[28:31]
    v_mov_b32 v14, 0x24108
    v_mov_b32 v15, 1
    s_mov_b64 exec, 1
    ds_add_u32 v14, v15
    s_mov_b64 exec, -1
    s_nop 1
    v_cvt_pk_bf16_f32 v72, v24, v25
    v_cvt_pk_bf16_f32 v73, v26, v27
    v_cvt_pk_bf16_f32 v76, v28, v29
    v_cvt_pk_bf16_f32 v77, v30, v31
    s_nop 0
    v_mov_b32_dpp v72, v76 quad_perm:[0,1,2,3] row_mask:0xf bank_mask:0x2
    v_mov_b32_dpp v73, v77 quad_perm:[0,1,2,3] row_mask:0xf bank_mask:0x2
    v_mov_b32 v10, 0x24200
    s_mov_b32 s80, 1600000
LW_5:
    ds_read_b32 v11, v10
    s_waitcnt lgkmcnt(0)
    v_readfirstlane_b32 s79, v11
    s_cmp_ge_u32 s79, 16
    s_cbranch_scc1 LWD_6
    s_sleep 1
    s_sub_u32 s80, s80, 1
    s_cmp_lg_u32 s80, 0
    s_cbranch_scc1 LW_5
LWD_6:
    s_and_b32 s101, s79, 15
    v_mov_b32 v12, 0x24204
    s_mov_b32 s80, 1600000
LW_7:
    ds_read_b32 v13, v12
    s_waitcnt lgkmcnt(0)
    v_readfirstlane_b32 s79, v13
    s_cmp_ge_u32 s79, 1
    s_cbranch_scc1 LWD_8
    s_sleep 1
    s_sub_u32 s80, s80, 1
    s_cmp_lg_u32 s80, 0
    s_cbranch_scc1 LW_7
LWD_8:
    v_mov_b32 v12, 0x24248
    ds_read_b64 v[14:15], v12
    s_waitcnt lgkmcnt(0)
    v_readfirstlane_b32 s92, v14
    v_readfirstlane_b32 s93, v15
    s_nop 0
    v_mov_b32 v66, s92
    v_mov_b32 v67, s93
    v_mov_b32 v74, s92
    v_mov_b32 v75, s93
    s_mov_b64 exec, s[84:85]
    s_cmp_eq_u32 s101, 0
    s_cbranch_scc1 SU_9
    buffer_store_dwordx4 v[72:75], v4, s[36:39], 0 offen
SV_10:
    s_mov_b64 exec, -1
    v_mov_b32 v14, 0x24210
    v_mov_b32 v15, 1
    s_mov_b64 exec, 1
    ds_add_u32 v14, v15
    s_mov_b64 exec, -1
    v_mov_b32 v14, 0x24000
    s_mov_b32 s80, 1600000
LW_11:
    ds_read_b32 v15, v14
    s_waitcnt lgkmcnt(0)
    v_readfirstlane_b32 s79, v15
    s_cmp_ge_u32 s79, 96
    s_cbranch_scc1 LWD_12
    s_sleep 16
    s_sub_u32 s80, s80, 1
    s_cmp_lg_u32 s80, 0
    s_cbranch_scc1 LW_11
LWD_12:
    s_mov_b64 exec, s[84:85]
    s_cmp_eq_u32 s101, 0
    s_cbranch_scc1 SU_13
    buffer_store_dwordx4 v[64:67], v5, s[36:39], 0 offen
SV_14:
    s_mov_b64 exec, -1
    s_branch L_ASVC
L_LDA:
    s_setprio 3
    v_lshrrev_b32 v20, 1, v3
    v_and_b32 v40, 1, v2
    v_xor_b32 v20, v20, v40
    v_lshlrev_b32 v20, 5, v20
    v_lshl_add_u32 v20, v2, 10, v20
    v_and_b32 v40, 1, v1
    v_lshl_add_u32 v20, v40, 4, v20
    v_xor_b32 v21, 0x40, v20
    v_xor_b32 v22, 0x80, v20
    v_xor_b32 v23, 0xc0, v20
    s_lshl_b32 s65, s4, 17
    s_lshl_b32 s7, s5, 8
    s_add_u32 s65, s65, s7
    s_mov_b32 s67, s65
    s_mov_b32 s64, 0
    s_mov_b32 s96, 0x6010600
    s_mov_b32 s97, 0x6030602
    s_cmp_eq_u32 s5, 1
    s_cselect_b32 s96, 0x6190618, s96
    s_cselect_b32 s97, 0x61b061a, s97
    s_cmp_eq_u32 s5, 2
    s_cselect_b32 s96, 0x6310630, s96
    s_cselect_b32 s97, 0x6330632, s97
    s_cmp_eq_u32 s5, 3
    s_cselect_b32 s96, 0x6490648, s96
    s_cselect_b32 s97, 0x64b064a, s97
    s_cmp_eq_u32 s5, 4
    s_cselect_b32 s96, 0x4610460, s96
    s_cselect_b32 s97, 0x4630462, s97
    s_cmp_eq_u32 s5, 5
    s_cselect_b32 s96, 0x4710470, s96
    s_cselect_b32 s97, 0x4730472, s97
    v_xor_b32 v10, v3, v2
    v_lshlrev_b32 v10, 4, v10
    v_lshl_add_u32 v10, v2, 8, v10
    v_xor_b32 v11, 0x40, v10
    v_xor_b32 v12, 0x80, v10
    v_xor_b32 v13, 0xc0, v10
    v_lshrrev_b32 v14, 1, v3
    v_xor_b32 v14, v14, v2
    v_lshlrev_b32 v14, 5, v14
    v_lshl_add_u32 v14, v2, 8, v14
    v_and_b32 v40, 1, v1
    v_lshl_add_u32 v14, v40, 4, v14
    v_xor_b32 v15, 0x80, v14
    v_add_u32 v24, 4096, v10
    v_add_u32 v25, 4096, v11
    v_add_u32 v26, 4096, v12
    v_add_u32 v27, 4096, v13
    v_add_u32 v28, 4096, v14
    v_add_u32 v29, 4096, v15
    s_mov_b32 s76, 0
    s_lshl_b32 s7, s76, 4
    s_lshr_b64 s[90:91], s[96:97], s7
    s_and_b32 s68, s90, 3
    s_bfe_u32 s72, s90, 0x50002
    s_lshl_b32 s68, s68, 5
    s_add_u32 s68, s68, s4
    s_lshl_b32 s68, s68, 20
    s_lshl_b32 s72, s72, 13
    s_add_u32 s72, s72, s68
    s_add_u32 s72, s72, 0xC0000
    s_mov_b32 s68, s72
    s_mov_b32 s76, 1
    s_lshl_b32 s7, s76, 4
    s_lshr_b64 s[90:91], s[96:97], s7
    s_and_b32 s69, s90, 3
    s_bfe_u32 s73, s90, 0x50002
    s_lshl_b32 s69, s69, 5
    s_add_u32 s69, s69, s4
    s_lshl_b32 s69, s69, 20
    s_lshl_b32 s73, s73, 13
    s_add_u32 s73, s73, s69
    s_add_u32 s73, s73, 0xC0000
    s_mov_b32 s69, s73
    s_mov_b32 s76, 2
    s_lshl_b32 s7, s76, 4
    s_lshr_b64 s[90:91], s[96:97], s7
    s_and_b32 s70, s90, 3
    s_bfe_u32 s74, s90, 0x50002
    s_lshl_b32 s70, s70, 5
    s_add_u32 s70, s70, s4
    s_lshl_b32 s70, s70, 20
    s_lshl_b32 s74, s74, 13
    s_add_u32 s74, s74, s70
    s_add_u32 s74, s74, 0xC0000
    s_mov_b32 s70, s74
    s_mov_b32 s76, 3
    s_lshl_b32 s7, s76, 4
    s_lshr_b64 s[90:91], s[96:97], s7
    s_and_b32 s71, s90, 3
    s_bfe_u32 s75, s90, 0x50002
    s_lshl_b32 s71, s71, 5
    s_add_u32 s71, s71, s4
    s_lshl_b32 s71, s71, 20
    s_lshl_b32 s75, s75, 13
    s_add_u32 s75, s75, s71
    s_add_u32 s75, s75, 0xC0000
    s_mov_b32 s71, s75
    s_waitcnt lgkmcnt(0)
    s_mov_b32 s56, s16
    s_and_b32 s57, s17, 0xffff
    s_mov_b32 s58, 0x400000
    s_mov_b32 s59, 0x20000
    s_mov_b32 s44, s10
    s_and_b32 s45, s11, 0xffff
    s_mov_b32 s46, 0x8000000
    s_mov_b32 s47, 0x20000
    s_mov_b32 s48, s12
    s_and_b32 s49, s13, 0xffff
    s_mov_b32 s50, 0x8000000
    s_mov_b32 s51, 0x20000
    s_barrier
    s_mov_b32 s63, 0
    v_lshlrev_b32 v16, 2, v1
    v_add_u32 v17, 0x24100, v16
    v_add_u32 v16, 0x24000, v16
    v_mov_b32 v18, 0
    s_mov_b32 s60, 0
    s_mov_b32 s36, s34
    s_and_b32 s37, s35, 0xffff
    s_mov_b32 s38, 0x1000000
    s_mov_b32 s39, 0x20000
    s_mov_b32 s52, s30
    s_and_b32 s53, s31, 0xffff
    s_mov_b32 s54, 0x2000
    s_mov_b32 s55, 0x20000
    s_lshl_b32 s7, s4, 8
    s_mov_b64 exec, 1
    buffer_load_dword v100, v10, s[44:47], s68 offen nt
    buffer_load_dword v100, v10, s[44:47], s69 offen nt
    buffer_load_dword v100, v10, s[44:47], s70 offen nt
    buffer_load_dword v100, v10, s[44:47], s71 offen nt
    buffer_load_dword v100, v10, s[48:51], s68 offen nt
    buffer_load_dword v100, v10, s[48:51], s69 offen nt
    buffer_load_dword v100, v10, s[48:51], s70 offen nt
    buffer_load_dword v100, v10, s[48:51], s71 offen nt
    buffer_load_dword v100, v10, s[56:59], s67 offen nt
    buffer_load_dword v100, v10, s[52:55], s7 offen nt
    s_mov_b64 exec, -1
    s_lshl_b32 s7, s2, 14
    s_mov_b32 s52, s26
    s_and_b32 s53, s27, 0xffff
    s_mov_b32 s54, 0x400000
    s_mov_b32 s55, 0x20000
    s_mov_b64 exec, 1
    buffer_load_dword v100, v10, s[52:55], s7 offen nt
    s_mov_b64 exec, -1
    s_mov_b32 s52, s28
    s_and_b32 s53, s29, 0xffff
    s_mov_b32 s54, 0x400000
    s_mov_b32 s55, 0x20000
    s_mov_b64 exec, 1
    buffer_load_dword v100, v10, s[52:55], s7 offen nt
    s_mov_b64 exec, -1
    v_mov_b32 v40, 0x24210
    s_mov_b32 s80, 1600000
LW_15:
    ds_read_b32 v41, v40
    s_waitcnt lgkmcnt(0)
    v_readfirstlane_b32 s79, v41
    s_cmp_ge_u32 s79, 8
    s_cbranch_scc1 LWD_16
    s_sub_u32 s80, s80, 1
    s_cmp_lg_u32 s80, 0
    s_cbranch_scc1 LW_15
LWD_16:
    s_mov_b32 s62, 0
    s_add_u32 m0, s64, 0
    s_waitcnt vmcnt(26)
    buffer_load_dwordx4 v10, s[44:47], s68 offen offset:0 nt lds
    buffer_load_dwordx4 v11, s[44:47], s68 offen offset:1024 nt lds
    s_waitcnt vmcnt(26)
    s_sub_u32 s7, s60, 24
    v_mov_b32 v19, s7
    ds_max_i32 v16, v19
    buffer_load_dwordx4 v12, s[44:47], s68 offen offset:2048 nt lds
    buffer_load_dwordx4 v13, s[44:47], s68 offen offset:3072 nt lds
    s_add_u32 m0, s64, 4096
    s_waitcnt vmcnt(26)
    buffer_load_dwordx4 v24, s[44:47], s68 offen offset:0 nt lds
    buffer_load_dwordx4 v25, s[44:47], s68 offen offset:1024 nt lds
    s_waitcnt vmcnt(26)
    buffer_load_dwordx4 v26, s[44:47], s68 offen offset:2048 nt lds
    buffer_load_dwordx4 v27, s[44:47], s68 offen offset:3072 nt lds
    s_add_u32 s68, s68, 8192
    s_add_u32 m0, s64, 8192
    s_waitcnt vmcnt(26)
    buffer_load_dwordx4 v10, s[44:47], s69 offen offset:0 nt lds
    buffer_load_dwordx4 v11, s[44:47], s69 offen offset:1024 nt lds
    s_waitcnt vmcnt(26)
    s_sub_u32 s7, s60, 16
    v_mov_b32 v19, s7
    ds_max_i32 v16, v19
    buffer_load_dwordx4 v12, s[44:47], s69 offen offset:2048 nt lds
    buffer_load_dwordx4 v13, s[44:47], s69 offen offset:3072 nt lds
    s_add_u32 m0, s64, 12288
    s_waitcnt vmcnt(26)
    buffer_load_dwordx4 v24, s[44:47], s69 offen offset:0 nt lds
    s_memrealtime s[84:85]
    buffer_load_dwordx4 v25, s[44:47], s69 offen offset:1024 nt lds
    s_waitcnt vmcnt(26)
    buffer_load_dwordx4 v26, s[44:47], s69 offen offset:2048 nt lds
    buffer_load_dwordx4 v27, s[44:47], s69 offen offset:3072 nt lds
    s_add_u32 s69, s69, 8192
    s_add_u32 s60, s60, 16
    s_add_u32 m0, s64, 16384
    s_waitcnt vmcnt(26)
    buffer_load_dwordx4 v10, s[44:47], s70 offen offset:0 nt lds
    buffer_load_dwordx4 v11, s[44:47], s70 offen offset:1024 nt lds
    s_waitcnt vmcnt(26)
    s_sub_u32 s7, s60, 24
    v_mov_b32 v19, s7
    ds_max_i32 v16, v19
    buffer_load_dwordx4 v12, s[44:47], s70 offen offset:2048 nt lds
    buffer_load_dwordx4 v13, s[44:47], s70 offen offset:3072 nt lds
    s_add_u32 m0, s64, 20480
    s_waitcnt vmcnt(26)
    buffer_load_dwordx4 v24, s[44:47], s70 offen offset:0 nt lds
    buffer_load_dwordx4 v25, s[44:47], s70 offen offset:1024 nt lds
    s_waitcnt vmcnt(26)
    buffer_load_dwordx4 v26, s[44:47], s70 offen offset:2048 nt lds
    buffer_load_dwordx4 v27, s[44:47], s70 offen offset:3072 nt lds
    s_add_u32 s70, s70, 8192
    s_add_u32 m0, s64, 24576
    s_waitcnt vmcnt(26)
    buffer_load_dwordx4 v10, s[44:47], s71 offen offset:0 nt lds
    buffer_load_dwordx4 v11, s[44:47], s71 offen offset:1024 nt lds
    s_waitcnt vmcnt(26)
    s_sub_u32 s7, s60, 16
    v_mov_b32 v19, s7
    ds_max_i32 v16, v19
    buffer_load_dwordx4 v12, s[44:47], s71 offen offset:2048 nt lds
    buffer_load_dwordx4 v13, s[44:47], s71 offen offset:3072 nt lds
    s_add_u32 m0, s64, 28672
    s_waitcnt vmcnt(26)
    buffer_load_dwordx4 v24, s[44:47], s71 offen offset:0 nt lds
    s_memrealtime s[84:85]
    ds_read_b32 v18, v17
    buffer_load_dwordx4 v25, s[44:47], s71 offen offset:1024 nt lds
    s_waitcnt vmcnt(26)
    buffer_load_dwordx4 v26, s[44:47], s71 offen offset:2048 nt lds
    buffer_load_dwordx4 v27, s[44:47], s71 offen offset:3072 nt lds
    s_add_u32 s71, s71, 8192
    s_add_u32 s60, s60, 16
    s_add_u32 s62, s62, 1
    s_and_b32 s62, s62, 3
    s_lshl_b32 s64, s62, 15
    s_cmp_eq_u32 s62, 2
    s_cselect_b32 s7, 4, 0
    s_add_u32 s63, s63, s7
    v_mov_b32 v40, 0x24204
    s_mov_b32 s80, 1600000
LW_17:
    ds_read_b32 v41, v40
    s_waitcnt lgkmcnt(0)
    v_readfirstlane_b32 s79, v41
    s_cmp_ge_u32 s79, 1
    s_cbranch_scc1 LWD_18
    s_sleep 1
    s_sub_u32 s80, s80, 1
    s_cmp_lg_u32 s80, 0
    s_cbranch_scc1 LW_17
LWD_18:
    v_mov_b32 v40, 0x24248
    ds_read_b64 v[42:43], v40
    s_waitcnt lgkmcnt(0)
    v_readfirstlane_b32 s92, v42
    v_readfirstlane_b32 s93, v43
    s_add_u32 s77, s92, 11136
    s_mov_b32 s61, 2048
    s_mov_b32 s86, 1536
    s_mov_b32 s66, 5
    s_mov_b32 s87, 6
    s_memrealtime s[84:85]
L_KV:
RD_19:
    s_waitcnt lgkmcnt(0)
    v_readlane_b32 s79, v18, s62
    s_cmp_lt_u32 s79, s63
    s_cbranch_scc1 ST_21
GO_20:
    s_lshl_b32 s7, s84, 5
    s_sub_u32 s7, s7, s77
    s_add_u32 s77, s77, s61
    s_cmp_lt_i32 s7, -640
    s_cbranch_scc1 WS_22
    s_cmp_gt_i32 s7, 2240
    s_cbranch_scc1 WB_23
    s_add_u32 m0, s64, 0
    s_waitcnt vmcnt(22)
    buffer_load_dwordx4 v10, s[44:47], s68 offen offset:0 nt lds
    buffer_load_dwordx4 v11, s[44:47], s68 offen offset:1024 nt lds
    s_waitcnt vmcnt(22)
    buffer_load_dwordx4 v12, s[44:47], s68 offen offset:2048 nt lds
    buffer_load_dwordx4 v13, s[44:47], s68 offen offset:3072 nt lds
    s_add_u32 m0, s64, 4096
    s_waitcnt vmcnt(22)
    buffer_load_dwordx4 v24, s[44:47], s68 offen offset:0 nt lds
    buffer_load_dwordx4 v25, s[44:47], s68 offen offset:1024 nt lds
    s_waitcnt vmcnt(22)
    s_sub_u32 s7, s60, 16
    v_mov_b32 v19, s7
    ds_max_i32 v16, v19
    buffer_load_dwordx4 v26, s[44:47], s68 offen offset:2048 nt lds
    buffer_load_dwordx4 v27, s[44:47], s68 offen offset:3072 nt lds
    s_add_u32 s68, s68, 8192
    s_add_u32 m0, s64, 8192
    s_waitcnt vmcnt(22)
    buffer_load_dwordx4 v10, s[44:47], s69 offen offset:0 nt lds
    buffer_load_dwordx4 v11, s[44:47], s69 offen offset:1024 nt lds
    s_waitcnt vmcnt(22)
    buffer_load_dwordx4 v12, s[44:47], s69 offen offset:2048 nt lds
    buffer_load_dwordx4 v13, s[44:47], s69 offen offset:3072 nt lds
    s_add_u32 m0, s64, 12288
    s_waitcnt vmcnt(22)
    buffer_load_dwordx4 v24, s[44:47], s69 offen offset:0 nt lds
    s_memrealtime s[84:85]
    buffer_load_dwordx4 v25, s[44:47], s69 offen offset:1024 nt lds
    s_waitcnt vmcnt(22)
    s_sub_u32 s7, s60, 8
    v_mov_b32 v19, s7
    ds_max_i32 v16, v19
    buffer_load_dwordx4 v26, s[44:47], s69 offen offset:2048 nt lds
    buffer_load_dwordx4 v27, s[44:47], s69 offen offset:3072 nt lds
    s_add_u32 s69, s69, 8192
    s_branch WJ_24
WS_22:
    s_add_u32 m0, s64, 0
    s_waitcnt vmcnt(14)
    buffer_load_dwordx4 v10, s[44:47], s68 offen offset:0 nt lds
    buffer_load_dwordx4 v11, s[44:47], s68 offen offset:1024 nt lds
    s_waitcnt vmcnt(14)
    buffer_load_dwordx4 v12, s[44:47], s68 offen offset:2048 nt lds
    buffer_load_dwordx4 v13, s[44:47], s68 offen offset:3072 nt lds
    s_add_u32 m0, s64, 4096
    s_waitcnt vmcnt(14)
    buffer_load_dwordx4 v24, s[44:47], s68 offen offset:0 nt lds
    buffer_load_dwordx4 v25, s[44:47], s68 offen offset:1024 nt lds
    s_waitcnt vmcnt(14)
    s_sub_u32 s7, s60, 8
    v_mov_b32 v19, s7
    ds_max_i32 v16, v19
    buffer_load_dwordx4 v26, s[44:47], s68 offen offset:2048 nt lds
    buffer_load_dwordx4 v27, s[44:47], s68 offen offset:3072 nt lds
    s_add_u32 s68, s68, 8192
    s_add_u32 m0, s64, 8192
    s_waitcnt vmcnt(14)
    buffer_load_dwordx4 v10, s[44:47], s69 offen offset:0 nt lds
    buffer_load_dwordx4 v11, s[44:47], s69 offen offset:1024 nt lds
    s_waitcnt vmcnt(14)
    buffer_load_dwordx4 v12, s[44:47], s69 offen offset:2048 nt lds
    buffer_load_dwordx4 v13, s[44:47], s69 offen offset:3072 nt lds
    s_add_u32 m0, s64, 12288
    s_waitcnt vmcnt(14)
    buffer_load_dwordx4 v24, s[44:47], s69 offen offset:0 nt lds
    s_memrealtime s[84:85]
    buffer_load_dwordx4 v25, s[44:47], s69 offen offset:1024 nt lds
    s_waitcnt vmcnt(14)
    v_mov_b32 v19, s60
    ds_max_i32 v16, v19
    buffer_load_dwordx4 v26, s[44:47], s69 offen offset:2048 nt lds
    buffer_load_dwordx4 v27, s[44:47], s69 offen offset:3072 nt lds
    s_add_u32 s69, s69, 8192
    s_branch WJ_24
WB_23:
    s_add_u32 m0, s64, 0
    s_waitcnt vmcnt(30)
    buffer_load_dwordx4 v10, s[44:47], s68 offen offset:0 nt lds
    buffer_load_dwordx4 v11, s[44:47], s68 offen offset:1024 nt lds
    s_waitcnt vmcnt(30)
    buffer_load_dwordx4 v12, s[44:47], s68 offen offset:2048 nt lds
    buffer_load_dwordx4 v13, s[44:47], s68 offen offset:3072 nt lds
    s_add_u32 m0, s64, 4096
    s_waitcnt vmcnt(30)
    buffer_load_dwordx4 v24, s[44:47], s68 offen offset:0 nt lds
    buffer_load_dwordx4 v25, s[44:47], s68 offen offset:1024 nt lds
    s_waitcnt vmcnt(30)
    s_sub_u32 s7, s60, 24
    v_mov_b32 v19, s7
    ds_max_i32 v16, v19
    buffer_load_dwordx4 v26, s[44:47], s68 offen offset:2048 nt lds
    buffer_load_dwordx4 v27, s[44:47], s68 offen offset:3072 nt lds
    s_add_u32 s68, s68, 8192
    s_add_u32 m0, s64, 8192
    s_waitcnt vmcnt(30)
    buffer_load_dwordx4 v10, s[44:47], s69 offen offset:0 nt lds
    buffer_load_dwordx4 v11, s[44:47], s69 offen offset:1024 nt lds
    s_waitcnt vmcnt(30)
    buffer_load_dwordx4 v12, s[44:47], s69 offen offset:2048 nt lds
    buffer_load_dwordx4 v13, s[44:47], s69 offen offset:3072 nt lds
    s_add_u32 m0, s64, 12288
    s_waitcnt vmcnt(30)
    buffer_load_dwordx4 v24, s[44:47], s69 offen offset:0 nt lds
    s_memrealtime s[84:85]
    buffer_load_dwordx4 v25, s[44:47], s69 offen offset:1024 nt lds
    s_waitcnt vmcnt(30)
    s_sub_u32 s7, s60, 16
    v_mov_b32 v19, s7
    ds_max_i32 v16, v19
    buffer_load_dwordx4 v26, s[44:47], s69 offen offset:2048 nt lds
    buffer_load_dwordx4 v27, s[44:47], s69 offen offset:3072 nt lds
    s_add_u32 s69, s69, 8192
WJ_24:
    s_add_u32 s60, s60, 16
    s_waitcnt lgkmcnt(0)
    s_lshl_b32 s7, s84, 5
    s_sub_u32 s7, s7, s77
    s_add_u32 s77, s77, s61
    s_cmp_lt_i32 s7, -640
    s_cbranch_scc1 WS_25
    s_cmp_gt_i32 s7, 2240
    s_cbranch_scc1 WB_26
    s_add_u32 m0, s64, 16384
    s_waitcnt vmcnt(22)
    buffer_load_dwordx4 v10, s[44:47], s70 offen offset:0 nt lds
    buffer_load_dwordx4 v11, s[44:47], s70 offen offset:1024 nt lds
    s_waitcnt vmcnt(22)
    buffer_load_dwordx4 v12, s[44:47], s70 offen offset:2048 nt lds
    buffer_load_dwordx4 v13, s[44:47], s70 offen offset:3072 nt lds
    s_add_u32 m0, s64, 20480
    s_waitcnt vmcnt(22)
    buffer_load_dwordx4 v24, s[44:47], s70 offen offset:0 nt lds
    buffer_load_dwordx4 v25, s[44:47], s70 offen offset:1024 nt lds
    s_waitcnt vmcnt(22)
    s_sub_u32 s7, s60, 16
    v_mov_b32 v19, s7
    ds_max_i32 v16, v19
    buffer_load_dwordx4 v26, s[44:47], s70 offen offset:2048 nt lds
    buffer_load_dwordx4 v27, s[44:47], s70 offen offset:3072 nt lds
    s_add_u32 s70, s70, 8192
    s_add_u32 m0, s64, 24576
    s_waitcnt vmcnt(22)
    buffer_load_dwordx4 v10, s[44:47], s71 offen offset:0 nt lds
    buffer_load_dwordx4 v11, s[44:47], s71 offen offset:1024 nt lds
    s_waitcnt vmcnt(22)
    buffer_load_dwordx4 v12, s[44:47], s71 offen offset:2048 nt lds
    buffer_load_dwordx4 v13, s[44:47], s71 offen offset:3072 nt lds
    s_add_u32 m0, s64, 28672
    s_waitcnt vmcnt(22)
    buffer_load_dwordx4 v24, s[44:47], s71 offen offset:0 nt lds
    s_memrealtime s[84:85]
    ds_read_b32 v18, v17
    buffer_load_dwordx4 v25, s[44:47], s71 offen offset:1024 nt lds
    s_waitcnt vmcnt(22)
    s_sub_u32 s7, s60, 8
    v_mov_b32 v19, s7
    ds_max_i32 v16, v19
    buffer_load_dwordx4 v26, s[44:47], s71 offen offset:2048 nt lds
    buffer_load_dwordx4 v27, s[44:47], s71 offen offset:3072 nt lds
    s_add_u32 s71, s71, 8192
    s_branch WJ_27
WS_25:
    s_add_u32 m0, s64, 16384
    s_waitcnt vmcnt(14)
    buffer_load_dwordx4 v10, s[44:47], s70 offen offset:0 nt lds
    buffer_load_dwordx4 v11, s[44:47], s70 offen offset:1024 nt lds
    s_waitcnt vmcnt(14)
    buffer_load_dwordx4 v12, s[44:47], s70 offen offset:2048 nt lds
    buffer_load_dwordx4 v13, s[44:47], s70 offen offset:3072 nt lds
    s_add_u32 m0, s64, 20480
    s_waitcnt vmcnt(14)
    buffer_load_dwordx4 v24, s[44:47], s70 offen offset:0 nt lds
    buffer_load_dwordx4 v25, s[44:47], s70 offen offset:1024 nt lds
    s_waitcnt vmcnt(14)
    s_sub_u32 s7, s60, 8
    v_mov_b32 v19, s7
    ds_max_i32 v16, v19
    buffer_load_dwordx4 v26, s[44:47], s70 offen offset:2048 nt lds
    buffer_load_dwordx4 v27, s[44:47], s70 offen offset:3072 nt lds
    s_add_u32 s70, s70, 8192
    s_add_u32 m0, s64, 24576
    s_waitcnt vmcnt(14)
    buffer_load_dwordx4 v10, s[44:47], s71 offen offset:0 nt lds
    buffer_load_dwordx4 v11, s[44:47], s71 offen offset:1024 nt lds
    s_waitcnt vmcnt(14)
    buffer_load_dwordx4 v12, s[44:47], s71 offen offset:2048 nt lds
    buffer_load_dwordx4 v13, s[44:47], s71 offen offset:3072 nt lds
    s_add_u32 m0, s64, 28672
    s_waitcnt vmcnt(14)
    buffer_load_dwordx4 v24, s[44:47], s71 offen offset:0 nt lds
    s_memrealtime s[84:85]
    ds_read_b32 v18, v17
    buffer_load_dwordx4 v25, s[44:47], s71 offen offset:1024 nt lds
    s_waitcnt vmcnt(14)
    v_mov_b32 v19, s60
    ds_max_i32 v16, v19
    buffer_load_dwordx4 v26, s[44:47], s71 offen offset:2048 nt lds
    buffer_load_dwordx4 v27, s[44:47], s71 offen offset:3072 nt lds
    s_add_u32 s71, s71, 8192
    s_branch WJ_27
WB_26:
    s_add_u32 m0, s64, 16384
    s_waitcnt vmcnt(30)
    buffer_load_dwordx4 v10, s[44:47], s70 offen offset:0 nt lds
    buffer_load_dwordx4 v11, s[44:47], s70 offen offset:1024 nt lds
    s_waitcnt vmcnt(30)
    buffer_load_dwordx4 v12, s[44:47], s70 offen offset:2048 nt lds
    buffer_load_dwordx4 v13, s[44:47], s70 offen offset:3072 nt lds
    s_add_u32 m0, s64, 20480
    s_waitcnt vmcnt(30)
    buffer_load_dwordx4 v24, s[44:47], s70 offen offset:0 nt lds
    buffer_load_dwordx4 v25, s[44:47], s70 offen offset:1024 nt lds
    s_waitcnt vmcnt(30)
    s_sub_u32 s7, s60, 24
    v_mov_b32 v19, s7
    ds_max_i32 v16, v19
    buffer_load_dwordx4 v26, s[44:47], s70 offen offset:2048 nt lds
    buffer_load_dwordx4 v27, s[44:47], s70 offen offset:3072 nt lds
    s_add_u32 s70, s70, 8192
    s_add_u32 m0, s64, 24576
    s_waitcnt vmcnt(30)
    buffer_load_dwordx4 v10, s[44:47], s71 offen offset:0 nt lds
    buffer_load_dwordx4 v11, s[44:47], s71 offen offset:1024 nt lds
    s_waitcnt vmcnt(30)
    buffer_load_dwordx4 v12, s[44:47], s71 offen offset:2048 nt lds
    buffer_load_dwordx4 v13, s[44:47], s71 offen offset:3072 nt lds
    s_add_u32 m0, s64, 28672
    s_waitcnt vmcnt(30)
    buffer_load_dwordx4 v24, s[44:47], s71 offen offset:0 nt lds
    s_memrealtime s[84:85]
    ds_read_b32 v18, v17
    buffer_load_dwordx4 v25, s[44:47], s71 offen offset:1024 nt lds
    s_waitcnt vmcnt(30)
    s_sub_u32 s7, s60, 16
    v_mov_b32 v19, s7
    ds_max_i32 v16, v19
    buffer_load_dwordx4 v26, s[44:47], s71 offen offset:2048 nt lds
    buffer_load_dwordx4 v27, s[44:47], s71 offen offset:3072 nt lds
    s_add_u32 s71, s71, 8192
WJ_27:
    s_add_u32 s60, s60, 16
    s_add_u32 s62, s62, 1
    s_and_b32 s62, s62, 3
    s_lshl_b32 s64, s62, 15
    s_cmp_eq_u32 s62, 2
    s_cselect_b32 s7, 4, 0
    s_add_u32 s63, s63, s7
    s_sub_u32 s66, s66, 1
    s_cmp_lg_u32 s66, 0
    s_cbranch_scc1 RD_19
    s_mov_b32 s68, s72
    s_mov_b32 s69, s73
    s_mov_b32 s70, s74
    s_mov_b32 s71, s75
    s_mov_b32 s66, s87
    s_mov_b32 s61, s86
RD_28:
    s_waitcnt lgkmcnt(0)
    v_readlane_b32 s79, v18, s62
    s_cmp_lt_u32 s79, s63
    s_cbranch_scc1 ST_30
GO_29:
    s_lshl_b32 s7, s84, 5
    s_sub_u32 s7, s7, s77
    s_add_u32 s77, s77, s61
    s_cmp_lt_i32 s7, -640
    s_cbranch_scc1 WS_31
    s_cmp_gt_i32 s7, 2240
    s_cbranch_scc1 WB_32
    s_add_u32 m0, s64, 0
    s_waitcnt vmcnt(28)
    buffer_load_dwordx4 v14, s[48:51], s68 offen offset:0 nt lds
    buffer_load_dwordx4 v15, s[48:51], s68 offen offset:1024 nt lds
    s_waitcnt vmcnt(28)
    buffer_load_dwordx4 v14, s[48:51], s68 offen offset:2048 nt lds
    buffer_load_dwordx4 v15, s[48:51], s68 offen offset:3072 nt lds
    s_add_u32 m0, s64, 4096
    s_waitcnt vmcnt(28)
    s_sub_u32 s7, s60, 24
    v_mov_b32 v19, s7
    ds_max_i32 v16, v19
    buffer_load_dwordx4 v28, s[48:51], s68 offen offset:0 nt lds
    buffer_load_dwordx4 v29, s[48:51], s68 offen offset:1024 nt lds
    s_waitcnt vmcnt(28)
    buffer_load_dwordx4 v28, s[48:51], s68 offen offset:2048 nt lds
    buffer_load_dwordx4 v29, s[48:51], s68 offen offset:3072 nt lds
    s_add_u32 s68, s68, 8192
    s_add_u32 m0, s64, 8192
    s_waitcnt vmcnt(28)
    buffer_load_dwordx4 v14, s[48:51], s69 offen offset:0 nt lds
    buffer_load_dwordx4 v15, s[48:51], s69 offen offset:1024 nt lds
    s_waitcnt vmcnt(28)
    buffer_load_dwordx4 v14, s[48:51], s69 offen offset:2048 nt lds
    buffer_load_dwordx4 v15, s[48:51], s69 offen offset:3072 nt lds
    s_add_u32 m0, s64, 12288
    s_waitcnt vmcnt(28)
    s_sub_u32 s7, s60, 16
    v_mov_b32 v19, s7
    ds_max_i32 v16, v19
    buffer_load_dwordx4 v28, s[48:51], s69 offen offset:0 nt lds
    s_memrealtime s[84:85]
    buffer_load_dwordx4 v29, s[48:51], s69 offen offset:1024 nt lds
    s_waitcnt vmcnt(28)
    buffer_load_dwordx4 v28, s[48:51], s69 offen offset:2048 nt lds
    buffer_load_dwordx4 v29, s[48:51], s69 offen offset:3072 nt lds
    s_add_u32 s69, s69, 8192
    s_branch WJ_33
WS_31:
    s_add_u32 m0, s64, 0
    s_waitcnt vmcnt(18)
    buffer_load_dwordx4 v14, s[48:51], s68 offen offset:0 nt lds
    buffer_load_dwordx4 v15, s[48:51], s68 offen offset:1024 nt lds
    s_waitcnt vmcnt(18)
    s_sub_u32 s7, s60, 16
    v_mov_b32 v19, s7
    ds_max_i32 v16, v19
    buffer_load_dwordx4 v14, s[48:51], s68 offen offset:2048 nt lds
    buffer_load_dwordx4 v15, s[48:51], s68 offen offset:3072 nt lds
    s_add_u32 m0, s64, 4096
    s_waitcnt vmcnt(18)
    buffer_load_dwordx4 v28, s[48:51], s68 offen offset:0 nt lds
    buffer_load_dwordx4 v29, s[48:51], s68 offen offset:1024 nt lds
    s_waitcnt vmcnt(18)
    buffer_load_dwordx4 v28, s[48:51], s68 offen offset:2048 nt lds
    buffer_load_dwordx4 v29, s[48:51], s68 offen offset:3072 nt lds
    s_add_u32 s68, s68, 8192
    s_add_u32 m0, s64, 8192
    s_waitcnt vmcnt(18)
    buffer_load_dwordx4 v14, s[48:51], s69 offen offset:0 nt lds
    buffer_load_dwordx4 v15, s[48:51], s69 offen offset:1024 nt lds
    s_waitcnt vmcnt(18)
    s_sub_u32 s7, s60, 8
    v_mov_b32 v19, s7
    ds_max_i32 v16, v19
    buffer_load_dwordx4 v14, s[48:51], s69 offen offset:2048 nt lds
    buffer_load_dwordx4 v15, s[48:51], s69 offen offset:3072 nt lds
    s_add_u32 m0, s64, 12288
    s_waitcnt vmcnt(18)
    buffer_load_dwordx4 v28, s[48:51], s69 offen offset:0 nt lds
    s_memrealtime s[84:85]
    buffer_load_dwordx4 v29, s[48:51], s69 offen offset:1024 nt lds
    s_waitcnt vmcnt(18)
    buffer_load_dwordx4 v28, s[48:51], s69 offen offset:2048 nt lds
    buffer_load_dwordx4 v29, s[48:51], s69 offen offset:3072 nt lds
    s_add_u32 s69, s69, 8192
    s_branch WJ_33
WB_32:
    s_add_u32 m0, s64, 0
    s_waitcnt vmcnt(42)
    buffer_load_dwordx4 v14, s[48:51], s68 offen offset:0 nt lds
    buffer_load_dwordx4 v15, s[48:51], s68 offen offset:1024 nt lds
    s_waitcnt vmcnt(42)
    s_sub_u32 s7, s60, 40
    v_mov_b32 v19, s7
    ds_max_i32 v16, v19
    buffer_load_dwordx4 v14, s[48:51], s68 offen offset:2048 nt lds
    buffer_load_dwordx4 v15, s[48:51], s68 offen offset:3072 nt lds
    s_add_u32 m0, s64, 4096
    s_waitcnt vmcnt(42)
    buffer_load_dwordx4 v28, s[48:51], s68 offen offset:0 nt lds
    buffer_load_dwordx4 v29, s[48:51], s68 offen offset:1024 nt lds
    s_waitcnt vmcnt(42)
    buffer_load_dwordx4 v28, s[48:51], s68 offen offset:2048 nt lds
    buffer_load_dwordx4 v29, s[48:51], s68 offen offset:3072 nt lds
    s_add_u32 s68, s68, 8192
    s_add_u32 m0, s64, 8192
    s_waitcnt vmcnt(42)
    buffer_load_dwordx4 v14, s[48:51], s69 offen offset:0 nt lds
    buffer_load_dwordx4 v15, s[48:51], s69 offen offset:1024 nt lds
    s_waitcnt vmcnt(42)
    s_sub_u32 s7, s60, 32
    v_mov_b32 v19, s7
    ds_max_i32 v16, v19
    buffer_load_dwordx4 v14, s[48:51], s69 offen offset:2048 nt lds
    buffer_load_dwordx4 v15, s[48:51], s69 offen offset:3072 nt lds
    s_add_u32 m0, s64, 12288
    s_waitcnt vmcnt(42)
    buffer_load_dwordx4 v28, s[48:51], s69 offen offset:0 nt lds
    s_memrealtime s[84:85]
    buffer_load_dwordx4 v29, s[48:51], s69 offen offset:1024 nt lds
    s_waitcnt vmcnt(42)
    buffer_load_dwordx4 v28, s[48:51], s69 offen offset:2048 nt lds
    buffer_load_dwordx4 v29, s[48:51], s69 offen offset:3072 nt lds
    s_add_u32 s69, s69, 8192
WJ_33:
    s_add_u32 s60, s60, 16
    s_waitcnt lgkmcnt(0)
    s_lshl_b32 s7, s84, 5
    s_sub_u32 s7, s7, s77
    s_add_u32 s77, s77, s61
    s_cmp_lt_i32 s7, -640
    s_cbranch_scc1 WS_34
    s_cmp_gt_i32 s7, 2240
    s_cbranch_scc1 WB_35
    s_add_u32 m0, s64, 16384
    s_waitcnt vmcnt(28)
    buffer_load_dwordx4 v14, s[48:51], s70 offen offset:0 nt lds
    buffer_load_dwordx4 v15, s[48:51], s70 offen offset:1024 nt lds
    s_waitcnt vmcnt(28)
    buffer_load_dwordx4 v14, s[48:51], s70 offen offset:2048 nt lds
    buffer_load_dwordx4 v15, s[48:51], s70 offen offset:3072 nt lds
    s_add_u32 m0, s64, 20480
    s_waitcnt vmcnt(28)
    s_sub_u32 s7, s60, 24
    v_mov_b32 v19, s7
    ds_max_i32 v16, v19
    buffer_load_dwordx4 v28, s[48:51], s70 offen offset:0 nt lds
    buffer_load_dwordx4 v29, s[48:51], s70 offen offset:1024 nt lds
    s_waitcnt vmcnt(28)
    buffer_load_dwordx4 v28, s[48:51], s70 offen offset:2048 nt lds
    buffer_load_dwordx4 v29, s[48:51], s70 offen offset:3072 nt lds
    s_add_u32 s70, s70, 8192
    s_add_u32 m0, s64, 24576
    s_waitcnt vmcnt(28)
    buffer_load_dwordx4 v14, s[48:51], s71 offen offset:0 nt lds
    buffer_load_dwordx4 v15, s[48:51], s71 offen offset:1024 nt lds
    s_waitcnt vmcnt(28)
    buffer_load_dwordx4 v14, s[48:51], s71 offen offset:2048 nt lds
    buffer_load_dwordx4 v15, s[48:51], s71 offen offset:3072 nt lds
    s_add_u32 m0, s64, 28672
    s_waitcnt vmcnt(28)
    s_sub_u32 s7, s60, 16
    v_mov_b32 v19, s7
    ds_max_i32 v16, v19
    buffer_load_dwordx4 v28, s[48:51], s71 offen offset:0 nt lds
    s_memrealtime s[84:85]
    ds_read_b32 v18, v17
    buffer_load_dwordx4 v29, s[48:51], s71 offen offset:1024 nt lds
    s_waitcnt vmcnt(28)
    buffer_load_dwordx4 v28, s[48:51], s71 offen offset:2048 nt lds
    buffer_load_dwordx4 v29, s[48:51], s71 offen offset:3072 nt lds
    s_add_u32 s71, s71, 8192
    s_branch WJ_36
WS_34:
    s_add_u32 m0, s64, 16384
    s_waitcnt vmcnt(18)
    buffer_load_dwordx4 v14, s[48:51], s70 offen offset:0 nt lds
    buffer_load_dwordx4 v15, s[48:51], s70 offen offset:1024 nt lds
    s_waitcnt vmcnt(18)
    s_sub_u32 s7, s60, 16
    v_mov_b32 v19, s7
    ds_max_i32 v16, v19
    buffer_load_dwordx4 v14, s[48:51], s70 offen offset:2048 nt lds
    buffer_load_dwordx4 v15, s[48:51], s70 offen offset:3072 nt lds
    s_add_u32 m0, s64, 20480
    s_waitcnt vmcnt(18)
    buffer_load_dwordx4 v28, s[48:51], s70 offen offset:0 nt lds
    buffer_load_dwordx4 v29, s[48:51], s70 offen offset:1024 nt lds
    s_waitcnt vmcnt(18)
    buffer_load_dwordx4 v28, s[48:51], s70 offen offset:2048 nt lds
    buffer_load_dwordx4 v29, s[48:51], s70 offen offset:3072 nt lds
    s_add_u32 s70, s70, 8192
    s_add_u32 m0, s64, 24576
    s_waitcnt vmcnt(18)
    buffer_load_dwordx4 v14, s[48:51], s71 offen offset:0 nt lds
    buffer_load_dwordx4 v15, s[48:51], s71 offen offset:1024 nt lds
    s_waitcnt vmcnt(18)
    s_sub_u32 s7, s60, 8
    v_mov_b32 v19, s7
    ds_max_i32 v16, v19
    buffer_load_dwordx4 v14, s[48:51], s71 offen offset:2048 nt lds
    buffer_load_dwordx4 v15, s[48:51], s71 offen offset:3072 nt lds
    s_add_u32 m0, s64, 28672
    s_waitcnt vmcnt(18)
    buffer_load_dwordx4 v28, s[48:51], s71 offen offset:0 nt lds
    s_memrealtime s[84:85]
    ds_read_b32 v18, v17
    buffer_load_dwordx4 v29, s[48:51], s71 offen offset:1024 nt lds
    s_waitcnt vmcnt(18)
    buffer_load_dwordx4 v28, s[48:51], s71 offen offset:2048 nt lds
    buffer_load_dwordx4 v29, s[48:51], s71 offen offset:3072 nt lds
    s_add_u32 s71, s71, 8192
    s_branch WJ_36
WB_35:
    s_add_u32 m0, s64, 16384
    s_waitcnt vmcnt(42)
    buffer_load_dwordx4 v14, s[48:51], s70 offen offset:0 nt lds
    buffer_load_dwordx4 v15, s[48:51], s70 offen offset:1024 nt lds
    s_waitcnt vmcnt(42)
    s_sub_u32 s7, s60, 40
    v_mov_b32 v19, s7
    ds_max_i32 v16, v19
    buffer_load_dwordx4 v14, s[48:51], s70 offen offset:2048 nt lds
    buffer_load_dwordx4 v15, s[48:51], s70 offen offset:3072 nt lds
    s_add_u32 m0, s64, 20480
    s_waitcnt vmcnt(42)
    buffer_load_dwordx4 v28, s[48:51], s70 offen offset:0 nt lds
    buffer_load_dwordx4 v29, s[48:51], s70 offen offset:1024 nt lds
    s_waitcnt vmcnt(42)
    buffer_load_dwordx4 v28, s[48:51], s70 offen offset:2048 nt lds
    buffer_load_dwordx4 v29, s[48:51], s70 offen offset:3072 nt lds
    s_add_u32 s70, s70, 8192
    s_add_u32 m0, s64, 24576
    s_waitcnt vmcnt(42)
    buffer_load_dwordx4 v14, s[48:51], s71 offen offset:0 nt lds
    buffer_load_dwordx4 v15, s[48:51], s71 offen offset:1024 nt lds
    s_waitcnt vmcnt(42)
    s_sub_u32 s7, s60, 32
    v_mov_b32 v19, s7
    ds_max_i32 v16, v19
    buffer_load_dwordx4 v14, s[48:51], s71 offen offset:2048 nt lds
    buffer_load_dwordx4 v15, s[48:51], s71 offen offset:3072 nt lds
    s_add_u32 m0, s64, 28672
    s_waitcnt vmcnt(42)
    buffer_load_dwordx4 v28, s[48:51], s71 offen offset:0 nt lds
    s_memrealtime s[84:85]
    ds_read_b32 v18, v17
    buffer_load_dwordx4 v29, s[48:51], s71 offen offset:1024 nt lds
    s_waitcnt vmcnt(42)
    buffer_load_dwordx4 v28, s[48:51], s71 offen offset:2048 nt lds
    buffer_load_dwordx4 v29, s[48:51], s71 offen offset:3072 nt lds
    s_add_u32 s71, s71, 8192
WJ_36:
    s_add_u32 s60, s60, 16
    s_add_u32 s62, s62, 1
    s_and_b32 s62, s62, 3
    s_lshl_b32 s64, s62, 15
    s_cmp_eq_u32 s62, 2
    s_cselect_b32 s7, 4, 0
    s_add_u32 s63, s63, s7
    s_sub_u32 s66, s66, 1
    s_cmp_lg_u32 s66, 0
    s_cbranch_scc1 RD_28
    s_cmp_ge_u32 s5, 4
    s_cbranch_scc1 KE_37
    s_mov_b32 s65, s67
    s_waitcnt lgkmcnt(0)
    v_readlane_b32 s79, v18, s62
    s_cmp_lt_u32 s79, s63
    s_cbranch_scc1 ST_39
GO_38:
    s_mov_b32 s66, 2
LL_40:
    s_waitcnt vmcnt(43)
    s_mov_b32 m0, s64
    s_add_u32 s64, s64, 1024
    buffer_load_dwordx4 v20, s[56:59], s65 offen nt lds
    s_add_u32 s65, s65, 4096
    s_waitcnt vmcnt(43)
    s_mov_b32 m0, s64
    s_add_u32 s64, s64, 1024
    buffer_load_dwordx4 v20, s[56:59], s65 offen nt lds
    s_add_u32 s65, s65, 4096
    s_waitcnt vmcnt(43)
    s_mov_b32 m0, s64
    s_add_u32 s64, s64, 1024
    buffer_load_dwordx4 v20, s[56:59], s65 offen nt lds
    s_add_u32 s65, s65, 4096
    s_waitcnt vmcnt(43)
    s_sub_u32 s7, s60, 40
    v_mov_b32 v19, s7
    ds_max_i32 v16, v19
    s_mov_b32 m0, s64
    s_add_u32 s64, s64, 1024
    buffer_load_dwordx4 v20, s[56:59], s65 offen nt lds
    s_add_u32 s65, s65, 4096
    s_waitcnt vmcnt(43)
    s_mov_b32 m0, s64
    s_add_u32 s64, s64, 1024
    buffer_load_dwordx4 v21, s[56:59], s65 offen nt lds
    s_add_u32 s65, s65, 4096
    s_waitcnt vmcnt(43)
    s_mov_b32 m0, s64
    s_add_u32 s64, s64, 1024
    buffer_load_dwordx4 v21, s[56:59], s65 offen nt lds
    s_add_u32 s65, s65, 4096
    s_waitcnt vmcnt(43)
    s_mov_b32 m0, s64
    s_add_u32 s64, s64, 1024
    buffer_load_dwordx4 v21, s[56:59], s65 offen nt lds
    s_add_u32 s65, s65, 4096
    s_waitcnt vmcnt(43)
    s_mov_b32 m0, s64
    s_add_u32 s64, s64, 1024
    buffer_load_dwordx4 v21, s[56:59], s65 offen nt lds
    s_add_u32 s65, s65, 4096
    s_waitcnt vmcnt(43)
    s_mov_b32 m0, s64
    s_add_u32 s64, s64, 1024
    buffer_load_dwordx4 v22, s[56:59], s65 offen nt lds
    s_add_u32 s65, s65, 4096
    s_waitcnt vmcnt(43)
    s_mov_b32 m0, s64
    s_add_u32 s64, s64, 1024
    buffer_load_dwordx4 v22, s[56:59], s65 offen nt lds
    s_add_u32 s65, s65, 4096
    s_waitcnt vmcnt(43)
    s_mov_b32 m0, s64
    s_add_u32 s64, s64, 1024
    buffer_load_dwordx4 v22, s[56:59], s65 offen nt lds
    s_add_u32 s65, s65, 4096
    s_waitcnt vmcnt(43)
    s_sub_u32 s7, s60, 32
    v_mov_b32 v19, s7
    ds_max_i32 v16, v19
    s_mov_b32 m0, s64
    s_add_u32 s64, s64, 1024
    buffer_load_dwordx4 v22, s[56:59], s65 offen nt lds
    s_add_u32 s65, s65, 4096
    s_waitcnt vmcnt(43)
    s_mov_b32 m0, s64
    s_add_u32 s64, s64, 1024
    buffer_load_dwordx4 v23, s[56:59], s65 offen nt lds
    s_add_u32 s65, s65, 4096
    s_waitcnt vmcnt(43)
    s_mov_b32 m0, s64
    s_add_u32 s64, s64, 1024
    buffer_load_dwordx4 v23, s[56:59], s65 offen nt lds
    s_add_u32 s65, s65, 4096
    s_waitcnt vmcnt(43)
    s_mov_b32 m0, s64
    s_add_u32 s64, s64, 1024
    buffer_load_dwordx4 v23, s[56:59], s65 offen nt lds
    s_add_u32 s65, s65, 4096
    s_waitcnt vmcnt(43)
    s_mov_b32 m0, s64
    s_add_u32 s64, s64, 1024
    buffer_load_dwordx4 v23, s[56:59], s65 offen nt lds
    s_add_u32 s65, s65, 4096
    s_add_u32 s60, s60, 16
    s_sub_u32 s66, s66, 1
    s_cmp_lg_u32 s66, 0
    s_cbranch_scc1 LL_40
KE_37:
    s_waitcnt vmcnt(40)
    s_sub_u32 s7, s60, 40
    v_mov_b32 v19, s7
    ds_max_i32 v16, v19
    s_waitcnt vmcnt(32)
    s_sub_u32 s7, s60, 32
    v_mov_b32 v19, s7
    ds_max_i32 v16, v19
    s_waitcnt vmcnt(24)
    s_sub_u32 s7, s60, 24
    v_mov_b32 v19, s7
    ds_max_i32 v16, v19
    s_waitcnt vmcnt(16)
    s_sub_u32 s7, s60, 16
    v_mov_b32 v19, s7
    ds_max_i32 v16, v19
    s_waitcnt vmcnt(8)
    s_sub_u32 s7, s60, 8
    v_mov_b32 v19, s7
    ds_max_i32 v16, v19
    s_waitcnt vmcnt(0)
    v_mov_b32 v19, s60
    ds_max_i32 v16, v19
    s_endpgm
L_LDE:
    s_setprio 3
    v_xor_b32 v6, v3, v2
    v_lshlrev_b32 v6, 4, v6
    v_lshl_add_u32 v6, v2, 13, v6
    v_xor_b32 v7, 0x40, v6
    v_xor_b32 v8, 0x80, v6
    v_xor_b32 v9, 0xc0, v6
    s_lshl_b32 s65, s5, 21
    s_lshl_b32 s7, s4, 8
    s_add_u32 s65, s65, s7
    s_sub_u32 s65, s65, 0x800000
    s_mov_b32 s64, 0x10000
    s_waitcnt lgkmcnt(0)
    s_mov_b32 s52, s24
    s_and_b32 s53, s25, 0xffff
    s_mov_b32 s54, 0x400000
    s_mov_b32 s55, 0x20000
    s_mov_b32 m0, s64
    s_add_u32 s64, s64, 1024
    buffer_load_dwordx4 v6, s[52:55], s65 offen nt lds
    s_add_u32 s65, s65, 32768
    s_mov_b32 m0, s64
    s_add_u32 s64, s64, 1024
    buffer_load_dwordx4 v7, s[52:55], s65 offen nt lds
    s_add_u32 s65, s65, 32768
    s_mov_b32 m0, s64
    s_add_u32 s64, s64, 1024
    buffer_load_dwordx4 v8, s[52:55], s65 offen nt lds
    s_add_u32 s65, s65, 32768
    s_mov_b32 m0, s64
    s_add_u32 s64, s64, 1024
    buffer_load_dwordx4 v9, s[52:55], s65 offen nt lds
    s_add_u32 s65, s65, 32768
    s_mov_b32 m0, s64
    s_add_u32 s64, s64, 1024
    buffer_load_dwordx4 v6, s[52:55], s65 offen nt lds
    s_add_u32 s65, s65, 32768
    s_mov_b32 m0, s64
    s_add_u32 s64, s64, 1024
    buffer_load_dwordx4 v7, s[52:55], s65 offen nt lds
    s_add_u32 s65, s65, 32768
    s_mov_b32 m0, s64
    s_add_u32 s64, s64, 1024
    buffer_load_dwordx4 v8, s[52:55], s65 offen nt lds
    s_add_u32 s65, s65, 32768
    s_mov_b32 m0, s64
    s_add_u32 s64, s64, 1024
    buffer_load_dwordx4 v9, s[52:55], s65 offen nt lds
    s_add_u32 s65, s65, 32768
    s_mov_b32 m0, s64
    s_add_u32 s64, s64, 1024
    buffer_load_dwordx4 v6, s[52:55], s65 offen nt lds
    s_add_u32 s65, s65, 32768
    s_mov_b32 m0, s64
    s_add_u32 s64, s64, 1024
    buffer_load_dwordx4 v7, s[52:55], s65 offen nt lds
    s_add_u32 s65, s65, 32768
    s_mov_b32 m0, s64
    s_add_u32 s64, s64, 1024
    buffer_load_dwordx4 v8, s[52:55], s65 offen nt lds
    s_add_u32 s65, s65, 32768
    s_mov_b32 m0, s64
    s_add_u32 s64, s64, 1024
    buffer_load_dwordx4 v9, s[52:55], s65 offen nt lds
    s_add_u32 s65, s65, 32768
    s_mov_b32 m0, s64
    s_add_u32 s64, s64, 1024
    buffer_load_dwordx4 v6, s[52:55], s65 offen nt lds
    s_add_u32 s65, s65, 32768
    s_mov_b32 m0, s64
    s_add_u32 s64, s64, 1024
    buffer_load_dwordx4 v7, s[52:55], s65 offen nt lds
    s_add_u32 s65, s65, 32768
    s_mov_b32 m0, s64
    s_add_u32 s64, s64, 1024
    buffer_load_dwordx4 v8, s[52:55], s65 offen nt lds
    s_add_u32 s65, s65, 32768
    s_mov_b32 m0, s64
    s_add_u32 s64, s64, 1024
    buffer_load_dwordx4 v9, s[52:55], s65 offen nt lds
    s_add_u32 s65, s65, 32768
    s_mov_b32 m0, s64
    s_add_u32 s64, s64, 1024
    buffer_load_dwordx4 v6, s[52:55], s65 offen nt lds
    s_add_u32 s65, s65, 32768
    s_mov_b32 m0, s64
    s_add_u32 s64, s64, 1024
    buffer_load_dwordx4 v7, s[52:55], s65 offen nt lds
    s_add_u32 s65, s65, 32768
    s_mov_b32 m0, s64
    s_add_u32 s64, s64, 1024
    buffer_load_dwordx4 v8, s[52:55], s65 offen nt lds
    s_add_u32 s65, s65, 32768
    s_mov_b32 m0, s64
    s_add_u32 s64, s64, 1024
    buffer_load_dwordx4 v9, s[52:55], s65 offen nt lds
    s_add_u32 s65, s65, 32768
    s_mov_b32 m0, s64
    s_add_u32 s64, s64, 1024
    buffer_load_dwordx4 v6, s[52:55], s65 offen nt lds
    s_add_u32 s65, s65, 32768
    s_mov_b32 m0, s64
    s_add_u32 s64, s64, 1024
    buffer_load_dwordx4 v7, s[52:55], s65 offen nt lds
    s_add_u32 s65, s65, 32768
    s_mov_b32 m0, s64
    s_add_u32 s64, s64, 1024
    buffer_load_dwordx4 v8, s[52:55], s65 offen nt lds
    s_add_u32 s65, s65, 32768
    s_mov_b32 m0, s64
    s_add_u32 s64, s64, 1024
    buffer_load_dwordx4 v9, s[52:55], s65 offen nt lds
    s_add_u32 s65, s65, 32768
    s_mov_b32 m0, s64
    s_add_u32 s64, s64, 1024
    buffer_load_dwordx4 v6, s[52:55], s65 offen nt lds
    s_add_u32 s65, s65, 32768
    s_mov_b32 m0, s64
    s_add_u32 s64, s64, 1024
    buffer_load_dwordx4 v7, s[52:55], s65 offen nt lds
    s_add_u32 s65, s65, 32768
    s_mov_b32 m0, s64
    s_add_u32 s64, s64, 1024
    buffer_load_dwordx4 v8, s[52:55], s65 offen nt lds
    s_add_u32 s65, s65, 32768
    s_mov_b32 m0, s64
    s_add_u32 s64, s64, 1024
    buffer_load_dwordx4 v9, s[52:55], s65 offen nt lds
    s_add_u32 s65, s65, 32768
    s_mov_b32 m0, s64
    s_add_u32 s64, s64, 1024
    buffer_load_dwordx4 v6, s[52:55], s65 offen nt lds
    s_add_u32 s65, s65, 32768
    s_mov_b32 m0, s64
    s_add_u32 s64, s64, 1024
    buffer_load_dwordx4 v7, s[52:55], s65 offen nt lds
    s_add_u32 s65, s65, 32768
    s_mov_b32 m0, s64
    s_add_u32 s64, s64, 1024
    buffer_load_dwordx4 v8, s[52:55], s65 offen nt lds
    s_add_u32 s65, s65, 32768
    s_mov_b32 m0, s64
    s_add_u32 s64, s64, 1024
    buffer_load_dwordx4 v9, s[52:55], s65 offen nt lds
    s_add_u32 s65, s65, 32768
    s_barrier
    s_mov_b32 s63, 0
    v_lshlrev_b32 v16, 2, v1
    v_add_u32 v17, 0x24100, v16
    v_add_u32 v16, 0x24000, v16
    v_mov_b32 v18, 0
    s_mov_b32 s60, 32
    s_mov_b32 s36, s34
    s_and_b32 s37, s35, 0xffff
    s_mov_b32 s38, 0x1000000
    s_mov_b32 s39, 0x20000
    s_mov_b32 s56, s26
    s_and_b32 s57, s27, 0xffff
    s_mov_b32 s58, 0x400000
    s_mov_b32 s59, 0x20000
    s_mov_b32 s44, s10
    s_and_b32 s45, s11, 0xffff
    s_mov_b32 s46, 0x8000000
    s_mov_b32 s47, 0x20000
    s_mov_b32 s48, s12
    s_and_b32 s49, s13, 0xffff
    s_mov_b32 s50, 0x8000000
    s_mov_b32 s51, 0x20000
    v_bfe_u32 v20, v1, 1, 2
    v_xor_b32 v20, v20, v2
    v_lshlrev_b32 v20, 5, v20
    v_lshrrev_b32 v40, 3, v1
    v_lshl_add_u32 v20, v40, 13, v20
    v_and_b32 v40, 1, v1
    v_lshl_add_u32 v20, v40, 4, v20
    v_mov_b32 v21, 0
    v_mov_b32 v22, 0
    v_mov_b32 v23, 0
    s_mov_b32 s67, 0
    s_mov_b32 s96, 0x6010600
    s_mov_b32 s97, 0x6030602
    s_cmp_eq_u32 s5, 1
    s_cselect_b32 s96, 0x6190618, s96
    s_cselect_b32 s97, 0x61b061a, s97
    s_cmp_eq_u32 s5, 2
    s_cselect_b32 s96, 0x6310630, s96
    s_cselect_b32 s97, 0x6330632, s97
    s_cmp_eq_u32 s5, 3
    s_cselect_b32 s96, 0x6490648, s96
    s_cselect_b32 s97, 0x64b064a, s97
    s_cmp_eq_u32 s5, 4
    s_cselect_b32 s96, 0x4610460, s96
    s_cselect_b32 s97, 0x4630462, s97
    s_cmp_eq_u32 s5, 5
    s_cselect_b32 s96, 0x4710470, s96
    s_cselect_b32 s97, 0x4730472, s97
    v_xor_b32 v10, v3, v2
    v_lshlrev_b32 v10, 4, v10
    v_lshl_add_u32 v10, v2, 8, v10
    v_xor_b32 v11, 0x40, v10
    v_xor_b32 v12, 0x80, v10
    v_xor_b32 v13, 0xc0, v10
    v_lshrrev_b32 v14, 1, v3
    v_xor_b32 v14, v14, v2
    v_lshlrev_b32 v14, 5, v14
    v_lshl_add_u32 v14, v2, 8, v14
    v_and_b32 v40, 1, v1
    v_lshl_add_u32 v14, v40, 4, v14
    v_xor_b32 v15, 0x80, v14
    v_add_u32 v24, 4096, v10
    v_add_u32 v25, 4096, v11
    v_add_u32 v26, 4096, v12
    v_add_u32 v27, 4096, v13
    v_add_u32 v28, 4096, v14
    v_add_u32 v29, 4096, v15
    s_mov_b32 s76, 0
    s_lshl_b32 s7, s76, 4
    s_lshr_b64 s[90:91], s[96:97], s7
    s_and_b32 s68, s90, 3
    s_bfe_u32 s72, s90, 0x50002
    s_lshl_b32 s68, s68, 5
    s_add_u32 s68, s68, s4
    s_lshl_b32 s68, s68, 20
    s_lshl_b32 s72, s72, 13
    s_add_u32 s72, s72, s68
    s_add_u32 s72, s72, 0xC0000
    s_mov_b32 s68, s72
    s_mov_b32 s76, 1
    s_lshl_b32 s7, s76, 4
    s_lshr_b64 s[90:91], s[96:97], s7
    s_and_b32 s69, s90, 3
    s_bfe_u32 s73, s90, 0x50002
    s_lshl_b32 s69, s69, 5
    s_add_u32 s69, s69, s4
    s_lshl_b32 s69, s69, 20
    s_lshl_b32 s73, s73, 13
    s_add_u32 s73, s73, s69
    s_add_u32 s73, s73, 0xC0000
    s_mov_b32 s69, s73
    s_mov_b32 s76, 2
    s_lshl_b32 s7, s76, 4
    s_lshr_b64 s[90:91], s[96:97], s7
    s_and_b32 s70, s90, 3
    s_bfe_u32 s74, s90, 0x50002
    s_lshl_b32 s70, s70, 5
    s_add_u32 s70, s70, s4
    s_lshl_b32 s70, s70, 20
    s_lshl_b32 s74, s74, 13
    s_add_u32 s74, s74, s70
    s_add_u32 s74, s74, 0xC0000
    s_mov_b32 s70, s74
    s_mov_b32 s76, 3
    s_lshl_b32 s7, s76, 4
    s_lshr_b64 s[90:91], s[96:97], s7
    s_and_b32 s71, s90, 3
    s_bfe_u32 s75, s90, 0x50002
    s_lshl_b32 s71, s71, 5
    s_add_u32 s71, s71, s4
    s_lshl_b32 s71, s71, 20
    s_lshl_b32 s75, s75, 13
    s_add_u32 s75, s75, s71
    s_add_u32 s75, s75, 0xC0000
    s_mov_b32 s71, s75
    s_mov_b32 s66, 4
LL_41:
    s_waitcnt vmcnt(39)
    s_mov_b32 m0, s64
    s_add_u32 s64, s64, 1024
    buffer_load_dwordx4 v6, s[52:55], s65 offen nt lds
    s_add_u32 s65, s65, 32768
    s_waitcnt vmcnt(39)
    s_mov_b32 m0, s64
    s_add_u32 s64, s64, 1024
    buffer_load_dwordx4 v7, s[52:55], s65 offen nt lds
    s_add_u32 s65, s65, 32768
    s_waitcnt vmcnt(39)
    s_mov_b32 m0, s64
    s_add_u32 s64, s64, 1024
    buffer_load_dwordx4 v8, s[52:55], s65 offen nt lds
    s_add_u32 s65, s65, 32768
    s_waitcnt vmcnt(39)
    s_mov_b32 m0, s64
    s_add_u32 s64, s64, 1024
    buffer_load_dwordx4 v9, s[52:55], s65 offen nt lds
    s_add_u32 s65, s65, 32768
    s_waitcnt vmcnt(39)
    s_mov_b32 m0, s64
    s_add_u32 s64, s64, 1024
    buffer_load_dwordx4 v6, s[52:55], s65 offen nt lds
    s_add_u32 s65, s65, 32768
    s_waitcnt vmcnt(39)
    s_mov_b32 m0, s64
    s_add_u32 s64, s64, 1024
    buffer_load_dwordx4 v7, s[52:55], s65 offen nt lds
    s_add_u32 s65, s65, 32768
    s_waitcnt vmcnt(39)
    s_mov_b32 m0, s64
    s_add_u32 s64, s64, 1024
    buffer_load_dwordx4 v8, s[52:55], s65 offen nt lds
    s_add_u32 s65, s65, 32768
    s_waitcnt vmcnt(39)
    s_sub_u32 s7, s60, 32
    v_mov_b32 v19, s7
    ds_max_i32 v16, v19
    s_mov_b32 m0, s64
    s_add_u32 s64, s64, 1024
    buffer_load_dwordx4 v9, s[52:55], s65 offen nt lds
    s_add_u32 s65, s65, 32768
    s_add_u32 s60, s60, 8
    s_sub_u32 s66, s66, 1
    s_cmp_lg_u32 s66, 0
    s_cbranch_scc1 LL_41
    s_waitcnt vmcnt(32)
    s_sub_u32 s7, s60, 32
    v_mov_b32 v19, s7
    ds_max_i32 v16, v19
    s_waitcnt vmcnt(24)
    s_sub_u32 s7, s60, 24
    v_mov_b32 v19, s7
    ds_max_i32 v16, v19
    s_waitcnt vmcnt(16)
    s_sub_u32 s7, s60, 16
    v_mov_b32 v19, s7
    ds_max_i32 v16, v19
    s_waitcnt vmcnt(8)
    s_sub_u32 s7, s60, 8
    v_mov_b32 v19, s7
    ds_max_i32 v16, v19
    s_waitcnt vmcnt(0)
    v_mov_b32 v19, s60
    ds_max_i32 v16, v19
    v_mov_b32 v40, 0x24208
    s_mov_b32 s80, 1600000
LW_42:
    ds_read_b32 v41, v40
    s_waitcnt lgkmcnt(0)
    v_readfirstlane_b32 s79, v41
    s_cmp_ge_u32 s79, 148
    s_cbranch_scc1 LWD_43
    s_sub_u32 s80, s80, 1
    s_cmp_lg_u32 s80, 0
    s_cbranch_scc1 LW_42
LWD_43:
    s_lshl_b32 s65, s4, 8
    s_lshl_b32 s7, s5, 7
    s_add_u32 s65, s65, s7
    s_sub_u32 s65, s65, 512
    s_mov_b32 s64, 0
    s_mov_b32 s66, 8
LL_44:
    s_waitcnt vmcnt(23)
    s_mov_b32 m0, s64
    s_add_u32 s64, s64, 1024
    buffer_load_dwordx4 v20, s[56:59], s65 offen nt lds
    s_add_u32 s65, s65, 65536
    s_waitcnt vmcnt(23)
    s_mov_b32 m0, s64
    s_add_u32 s64, s64, 1024
    buffer_load_dwordx4 v20, s[56:59], s65 offen nt lds
    s_add_u32 s65, s65, 65536
    s_waitcnt vmcnt(23)
    s_mov_b32 m0, s64
    s_add_u32 s64, s64, 1024
    buffer_load_dwordx4 v20, s[56:59], s65 offen nt lds
    s_add_u32 s65, s65, 65536
    s_waitcnt vmcnt(23)
    s_mov_b32 m0, s64
    s_add_u32 s64, s64, 1024
    buffer_load_dwordx4 v20, s[56:59], s65 offen nt lds
    s_add_u32 s65, s65, 65536
    s_waitcnt vmcnt(23)
    s_mov_b32 m0, s64
    s_add_u32 s64, s64, 1024
    buffer_load_dwordx4 v20, s[56:59], s65 offen nt lds
    s_add_u32 s65, s65, 65536
    s_waitcnt vmcnt(23)
    s_mov_b32 m0, s64
    s_add_u32 s64, s64, 1024
    buffer_load_dwordx4 v20, s[56:59], s65 offen nt lds
    s_add_u32 s65, s65, 65536
    ds_read_b32 v18, v17
    s_waitcnt vmcnt(23)
    s_mov_b32 m0, s64
    s_add_u32 s64, s64, 1024
    buffer_load_dwordx4 v20, s[56:59], s65 offen nt lds
    s_add_u32 s65, s65, 65536
    s_waitcnt vmcnt(23)
    s_sub_u32 s7, s60, 16
    v_mov_b32 v19, s7
    ds_max_i32 v16, v19
    s_mov_b32 m0, s64
    s_add_u32 s64, s64, 1024
    buffer_load_dwordx4 v20, s[56:59], s65 offen nt lds
    s_add_u32 s65, s65, 65536
    s_add_u32 s60, s60, 8
    s_sub_u32 s66, s66, 1
    s_cmp_lg_u32 s66, 0
    s_cbranch_scc1 LL_44
    s_mov_b32 s62, 2
    s_mov_b32 s63, 4
    v_mov_b32 v40, 0x24204
    s_mov_b32 s80, 1600000
LW_45:
    ds_read_b32 v41, v40
    s_waitcnt lgkmcnt(0)
    v_readfirstlane_b32 s79, v41
    s_cmp_ge_u32 s79, 1
    s_cbranch_scc1 LWD_46
    s_sleep 1
    s_sub_u32 s80, s80, 1
    s_cmp_lg_u32 s80, 0
    s_cbranch_scc1 LW_45
LWD_46:
    v_mov_b32 v40, 0x24248
    ds_read_b64 v[42:43], v40
    s_waitcnt lgkmcnt(0)
    v_readfirstlane_b32 s92, v42
    v_readfirstlane_b32 s93, v43
    s_add_u32 s77, s92, 18240
    s_mov_b32 s61, 1984
    s_mov_b32 s86, 1728
    s_mov_b32 s66, 4
    s_mov_b32 s87, 4
    s_memrealtime s[84:85]
    s_branch L_KV
L_LDB:
    s_setprio 3
    v_lshlrev_b32 v20, 4, v1
    v_xor_b32 v21, 0x40, v20
    v_xor_b32 v22, 0x80, v20
    v_xor_b32 v23, 0xc0, v20
    v_xor_b32 v24, 0x10, v20
    v_xor_b32 v25, 0x50, v20
    v_xor_b32 v26, 0x90, v20
    v_xor_b32 v27, 0xd0, v20
    v_xor_b32 v28, 0x20, v20
    v_xor_b32 v29, 0x60, v20
    v_xor_b32 v30, 0xa0, v20
    v_xor_b32 v31, 0xe0, v20
    v_xor_b32 v32, 0x30, v20
    v_xor_b32 v33, 0x70, v20
    v_xor_b32 v34, 0xb0, v20
    v_xor_b32 v35, 0xf0, v20
    s_and_b32 s69, s4, 7
    s_lshl_b32 s69, s69, 3
    s_lshr_b32 s7, s4, 3
    s_lshl_b32 s7, s7, 1
    s_add_u32 s69, s69, s7
    s_add_u32 s69, s69, s5
    s_sub_u32 s69, s69, 6
    s_lshr_b32 s68, s69, 3
    s_lshl_b32 s68, s68, 21
    s_and_b32 s7, s69, 7
    s_lshl_b32 s7, s7, 14
    s_add_u32 s68, s68, s7
    s_mov_b32 s64, 0
    s_waitcnt lgkmcnt(0)
    s_mov_b32 s44, s20
    s_and_b32 s45, s21, 0xffff
    s_mov_b32 s46, 0x1000000
    s_mov_b32 s47, 0x20000
    s_add_u32 s7, s64, 0
    s_mov_b32 m0, s7
    s_add_u32 s65, s68, 0
    buffer_load_dwordx4 v20, s[44:47], s65 offen offset:0 nt lds
    buffer_load_dwordx4 v21, s[44:47], s65 offen offset:1024 nt lds
    buffer_load_dwordx4 v22, s[44:47], s65 offen offset:2048 nt lds
    buffer_load_dwordx4 v23, s[44:47], s65 offen offset:3072 nt lds
    s_add_u32 s7, s64, 4096
    s_mov_b32 m0, s7
    s_add_u32 s65, s68, 4096
    buffer_load_dwordx4 v24, s[44:47], s65 offen offset:0 nt lds
    buffer_load_dwordx4 v25, s[44:47], s65 offen offset:1024 nt lds
    buffer_load_dwordx4 v26, s[44:47], s65 offen offset:2048 nt lds
    buffer_load_dwordx4 v27, s[44:47], s65 offen offset:3072 nt lds
    s_add_u32 s7, s64, 8192
    s_mov_b32 m0, s7
    s_add_u32 s65, s68, 8192
    buffer_load_dwordx4 v28, s[44:47], s65 offen offset:0 nt lds
    buffer_load_dwordx4 v29, s[44:47], s65 offen offset:1024 nt lds
    buffer_load_dwordx4 v30, s[44:47], s65 offen offset:2048 nt lds
    buffer_load_dwordx4 v31, s[44:47], s65 offen offset:3072 nt lds
    s_add_u32 s7, s64, 12288
    s_mov_b32 m0, s7
    s_add_u32 s65, s68, 12288
    buffer_load_dwordx4 v32, s[44:47], s65 offen offset:0 nt lds
    buffer_load_dwordx4 v33, s[44:47], s65 offen offset:1024 nt lds
    buffer_load_dwordx4 v34, s[44:47], s65 offen offset:2048 nt lds
    buffer_load_dwordx4 v35, s[44:47], s65 offen offset:3072 nt lds
    s_barrier
    s_mov_b32 s63, 0
    v_lshlrev_b32 v16, 2, v1
    v_add_u32 v17, 0x24100, v16
    v_add_u32 v16, 0x24000, v16
    v_mov_b32 v18, 0
    s_mov_b32 s60, 16
    s_mov_b32 s36, s34
    s_and_b32 s37, s35, 0xffff
    s_mov_b32 s38, 0x1000000
    s_mov_b32 s39, 0x20000
    s_add_u32 s68, s68, 131072
    s_mov_b32 s64, 16384
    s_mov_b32 s48, s28
    s_and_b32 s49, s29, 0xffff
    s_mov_b32 s50, 0x400000
    s_mov_b32 s51, 0x20000
    v_bfe_u32 v10, v1, 1, 2
    v_xor_b32 v10, v10, v2
    v_lshlrev_b32 v10, 5, v10
    v_lshrrev_b32 v40, 3, v1
    v_lshl_add_u32 v10, v40, 10, v10
    v_and_b32 v40, 1, v1
    v_lshl_add_u32 v10, v40, 4, v10
    s_mov_b32 s72, 0x22559911
    s_mov_b32 s73, 0x2
    s_mov_b32 s74, 0x54873210
    s_mov_b32 s75, 0x6
    s_mov_b32 s66, 6
LL_47:
    s_waitcnt vmcnt(27)
    s_add_u32 s7, s64, 0
    s_mov_b32 m0, s7
    s_add_u32 s65, s68, 0
    buffer_load_dwordx4 v20, s[44:47], s65 offen offset:0 nt lds
    s_waitcnt vmcnt(27)
    buffer_load_dwordx4 v21, s[44:47], s65 offen offset:1024 nt lds
    s_waitcnt vmcnt(27)
    buffer_load_dwordx4 v22, s[44:47], s65 offen offset:2048 nt lds
    s_waitcnt vmcnt(27)
    s_sub_u32 s7, s60, 24
    v_mov_b32 v19, s7
    ds_max_i32 v16, v19
    buffer_load_dwordx4 v23, s[44:47], s65 offen offset:3072 nt lds
    s_waitcnt vmcnt(27)
    s_add_u32 s7, s64, 4096
    s_mov_b32 m0, s7
    s_add_u32 s65, s68, 4096
    buffer_load_dwordx4 v24, s[44:47], s65 offen offset:0 nt lds
    s_waitcnt vmcnt(27)
    buffer_load_dwordx4 v25, s[44:47], s65 offen offset:1024 nt lds
    s_waitcnt vmcnt(27)
    buffer_load_dwordx4 v26, s[44:47], s65 offen offset:2048 nt lds
    s_waitcnt vmcnt(27)
    buffer_load_dwordx4 v27, s[44:47], s65 offen offset:3072 nt lds
    s_waitcnt vmcnt(27)
    s_add_u32 s7, s64, 8192
    s_mov_b32 m0, s7
    s_add_u32 s65, s68, 8192
    buffer_load_dwordx4 v28, s[44:47], s65 offen offset:0 nt lds
    s_waitcnt vmcnt(27)
    buffer_load_dwordx4 v29, s[44:47], s65 offen offset:1024 nt lds
    s_waitcnt vmcnt(27)
    buffer_load_dwordx4 v30, s[44:47], s65 offen offset:2048 nt lds
    s_waitcnt vmcnt(27)
    s_sub_u32 s7, s60, 16
    v_mov_b32 v19, s7
    ds_max_i32 v16, v19
    buffer_load_dwordx4 v31, s[44:47], s65 offen offset:3072 nt lds
    s_waitcnt vmcnt(27)
    s_add_u32 s7, s64, 12288
    s_mov_b32 m0, s7
    s_add_u32 s65, s68, 12288
    buffer_load_dwordx4 v32, s[44:47], s65 offen offset:0 nt lds
    s_waitcnt vmcnt(27)
    buffer_load_dwordx4 v33, s[44:47], s65 offen offset:1024 nt lds
    s_waitcnt vmcnt(27)
    buffer_load_dwordx4 v34, s[44:47], s65 offen offset:2048 nt lds
    s_waitcnt vmcnt(27)
    buffer_load_dwordx4 v35, s[44:47], s65 offen offset:3072 nt lds
    s_add_u32 s60, s60, 16
    s_add_u32 s68, s68, 131072
    s_add_u32 s64, s64, 16384
    s_sub_u32 s66, s66, 1
    s_cmp_lg_u32 s66, 0
    s_cbranch_scc1 LL_47
    s_mov_b32 s66, 2
LL_48:
    s_and_b32 s63, s72, 3
    s_lshl_b32 s63, s63, 3
    s_bfe_u32 s62, s72, 0x20002
    s_lshr_b64 s[72:73], s[72:73], 4
    s_and_b32 s64, s74, 15
    s_lshl_b32 s64, s64, 14
    s_lshr_b64 s[74:75], s[74:75], 4
    s_waitcnt lgkmcnt(0)
    v_readlane_b32 s79, v18, s62
    s_cmp_lt_u32 s79, s63
    s_cbranch_scc1 ST_50
GO_49:
    s_waitcnt vmcnt(19)
    s_add_u32 s7, s64, 0
    s_mov_b32 m0, s7
    s_add_u32 s65, s68, 0
    buffer_load_dwordx4 v20, s[44:47], s65 offen offset:0 nt lds
    s_waitcnt vmcnt(19)
    buffer_load_dwordx4 v21, s[44:47], s65 offen offset:1024 nt lds
    s_waitcnt vmcnt(19)
    buffer_load_dwordx4 v22, s[44:47], s65 offen offset:2048 nt lds
    s_waitcnt vmcnt(19)
    s_sub_u32 s7, s60, 16
    v_mov_b32 v19, s7
    ds_max_i32 v16, v19
    buffer_load_dwordx4 v23, s[44:47], s65 offen offset:3072 nt lds
    s_waitcnt vmcnt(19)
    s_add_u32 s7, s64, 4096
    s_mov_b32 m0, s7
    s_add_u32 s65, s68, 4096
    buffer_load_dwordx4 v24, s[44:47], s65 offen offset:0 nt lds
    s_waitcnt vmcnt(19)
    buffer_load_dwordx4 v25, s[44:47], s65 offen offset:1024 nt lds
    s_waitcnt vmcnt(19)
    buffer_load_dwordx4 v26, s[44:47], s65 offen offset:2048 nt lds
    s_waitcnt vmcnt(19)
    buffer_load_dwordx4 v27, s[44:47], s65 offen offset:3072 nt lds
    s_waitcnt vmcnt(19)
    s_add_u32 s7, s64, 8192
    s_mov_b32 m0, s7
    s_add_u32 s65, s68, 8192
    buffer_load_dwordx4 v28, s[44:47], s65 offen offset:0 nt lds
    s_waitcnt vmcnt(19)
    buffer_load_dwordx4 v29, s[44:47], s65 offen offset:1024 nt lds
    s_waitcnt vmcnt(19)
    buffer_load_dwordx4 v30, s[44:47], s65 offen offset:2048 nt lds
    s_waitcnt vmcnt(19)
    s_sub_u32 s7, s60, 8
    v_mov_b32 v19, s7
    ds_max_i32 v16, v19
    buffer_load_dwordx4 v31, s[44:47], s65 offen offset:3072 nt lds
    s_waitcnt vmcnt(19)
    s_add_u32 s7, s64, 12288
    s_mov_b32 m0, s7
    s_add_u32 s65, s68, 12288
    buffer_load_dwordx4 v32, s[44:47], s65 offen offset:0 nt lds
    s_waitcnt vmcnt(19)
    buffer_load_dwordx4 v33, s[44:47], s65 offen offset:1024 nt lds
    ds_read_b32 v18, v17
    s_waitcnt vmcnt(19)
    buffer_load_dwordx4 v34, s[44:47], s65 offen offset:2048 nt lds
    s_waitcnt vmcnt(19)
    buffer_load_dwordx4 v35, s[44:47], s65 offen offset:3072 nt lds
    s_add_u32 s60, s60, 16
    s_add_u32 s68, s68, 131072
    s_sub_u32 s66, s66, 1
    s_cmp_lg_u32 s66, 0
    s_cbranch_scc1 LL_48
    s_mov_b32 s66, 7
LL_51:
    s_and_b32 s63, s72, 3
    s_lshl_b32 s63, s63, 3
    s_bfe_u32 s62, s72, 0x20002
    s_lshr_b64 s[72:73], s[72:73], 4
    s_and_b32 s64, s74, 15
    s_lshl_b32 s64, s64, 14
    s_lshr_b64 s[74:75], s[74:75], 4
    s_waitcnt lgkmcnt(0)
    v_readlane_b32 s79, v18, s62
    s_cmp_lt_u32 s79, s63
    s_cbranch_scc1 ST_53
GO_52:
    s_waitcnt vmcnt(31)
    s_add_u32 s7, s64, 0
    s_mov_b32 m0, s7
    s_add_u32 s65, s68, 0
    buffer_load_dwordx4 v20, s[44:47], s65 offen offset:0 nt lds
    s_waitcnt vmcnt(31)
    buffer_load_dwordx4 v21, s[44:47], s65 offen offset:1024 nt lds
    s_waitcnt vmcnt(31)
    buffer_load_dwordx4 v22, s[44:47], s65 offen offset:2048 nt lds
    s_waitcnt vmcnt(31)
    buffer_load_dwordx4 v23, s[44:47], s65 offen offset:3072 nt lds
    s_waitcnt vmcnt(31)
    s_add_u32 s7, s64, 4096
    s_mov_b32 m0, s7
    s_add_u32 s65, s68, 4096
    buffer_load_dwordx4 v24, s[44:47], s65 offen offset:0 nt lds
    s_waitcnt vmcnt(31)
    buffer_load_dwordx4 v25, s[44:47], s65 offen offset:1024 nt lds
    s_waitcnt vmcnt(31)
    buffer_load_dwordx4 v26, s[44:47], s65 offen offset:2048 nt lds
    s_waitcnt vmcnt(31)
    s_sub_u32 s7, s60, 24
    v_mov_b32 v19, s7
    ds_max_i32 v16, v19
    buffer_load_dwordx4 v27, s[44:47], s65 offen offset:3072 nt lds
    s_waitcnt vmcnt(31)
    s_add_u32 s7, s64, 8192
    s_mov_b32 m0, s7
    s_add_u32 s65, s68, 8192
    buffer_load_dwordx4 v28, s[44:47], s65 offen offset:0 nt lds
    s_waitcnt vmcnt(31)
    buffer_load_dwordx4 v29, s[44:47], s65 offen offset:1024 nt lds
    s_waitcnt vmcnt(31)
    buffer_load_dwordx4 v30, s[44:47], s65 offen offset:2048 nt lds
    s_waitcnt vmcnt(31)
    buffer_load_dwordx4 v31, s[44:47], s65 offen offset:3072 nt lds
    s_waitcnt vmcnt(31)
    s_add_u32 s7, s64, 12288
    s_mov_b32 m0, s7
    s_add_u32 s65, s68, 12288
    buffer_load_dwordx4 v32, s[44:47], s65 offen offset:0 nt lds
    s_waitcnt vmcnt(31)
    buffer_load_dwordx4 v33, s[44:47], s65 offen offset:1024 nt lds
    ds_read_b32 v18, v17
    s_waitcnt vmcnt(31)
    buffer_load_dwordx4 v34, s[44:47], s65 offen offset:2048 nt lds
    s_waitcnt vmcnt(31)
    s_sub_u32 s7, s60, 16
    v_mov_b32 v19, s7
    ds_max_i32 v16, v19
    buffer_load_dwordx4 v35, s[44:47], s65 offen offset:3072 nt lds
    s_add_u32 s60, s60, 16
    s_add_u32 s68, s68, 131072
    s_sub_u32 s66, s66, 1
    s_cmp_lg_u32 s66, 0
    s_cbranch_scc1 LL_51
    s_lshr_b32 s65, s69, 3
    s_lshl_b32 s65, s65, 17
    s_and_b32 s7, s69, 7
    s_lshl_b32 s7, s7, 7
    s_add_u32 s65, s65, s7
    s_mov_b32 s64, 0
    s_mov_b32 s63, 24
    s_waitcnt lgkmcnt(0)
    v_readlane_b32 s79, v18, 0
    s_cmp_lt_u32 s79, s63
    s_cbranch_scc1 ST_55
GO_54:
    s_mov_b32 m0, s64
    s_add_u32 s64, s64, 1024
    buffer_load_dwordx4 v10, s[48:51], s65 offen nt lds
    s_add_u32 s65, s65, 8192
    s_mov_b32 m0, s64
    s_add_u32 s64, s64, 1024
    buffer_load_dwordx4 v10, s[48:51], s65 offen nt lds
    s_add_u32 s65, s65, 8192
    s_mov_b32 m0, s64
    s_add_u32 s64, s64, 1024
    buffer_load_dwordx4 v10, s[48:51], s65 offen nt lds
    s_add_u32 s65, s65, 8192
    s_mov_b32 m0, s64
    s_add_u32 s64, s64, 1024
    buffer_load_dwordx4 v10, s[48:51], s65 offen nt lds
    s_add_u32 s65, s65, 8192
    s_mov_b32 m0, s64
    s_add_u32 s64, s64, 1024
    buffer_load_dwordx4 v10, s[48:51], s65 offen nt lds
    s_add_u32 s65, s65, 8192
    s_mov_b32 m0, s64
    s_add_u32 s64, s64, 1024
    buffer_load_dwordx4 v10, s[48:51], s65 offen nt lds
    s_add_u32 s65, s65, 8192
    s_mov_b32 m0, s64
    s_add_u32 s64, s64, 1024
    buffer_load_dwordx4 v10, s[48:51], s65 offen nt lds
    s_add_u32 s65, s65, 8192
    s_mov_b32 m0, s64
    s_add_u32 s64, s64, 1024
    buffer_load_dwordx4 v10, s[48:51], s65 offen nt lds
    s_add_u32 s65, s65, 8192
    s_mov_b32 m0, s64
    s_add_u32 s64, s64, 1024
    buffer_load_dwordx4 v10, s[48:51], s65 offen nt lds
    s_add_u32 s65, s65, 8192
    s_mov_b32 m0, s64
    s_add_u32 s64, s64, 1024
    buffer_load_dwordx4 v10, s[48:51], s65 offen nt lds
    s_add_u32 s65, s65, 8192
    s_mov_b32 m0, s64
    s_add_u32 s64, s64, 1024
    buffer_load_dwordx4 v10, s[48:51], s65 offen nt lds
    s_add_u32 s65, s65, 8192
    s_mov_b32 m0, s64
    s_add_u32 s64, s64, 1024
    buffer_load_dwordx4 v10, s[48:51], s65 offen nt lds
    s_add_u32 s65, s65, 8192
    s_mov_b32 m0, s64
    s_add_u32 s64, s64, 1024
    buffer_load_dwordx4 v10, s[48:51], s65 offen nt lds
    s_add_u32 s65, s65, 8192
    s_mov_b32 m0, s64
    s_add_u32 s64, s64, 1024
    buffer_load_dwordx4 v10, s[48:51], s65 offen nt lds
    s_add_u32 s65, s65, 8192
    s_mov_b32 m0, s64
    s_add_u32 s64, s64, 1024
    buffer_load_dwordx4 v10, s[48:51], s65 offen nt lds
    s_add_u32 s65, s65, 8192
    s_mov_b32 m0, s64
    s_add_u32 s64, s64, 1024
    buffer_load_dwordx4 v10, s[48:51], s65 offen nt lds
    s_add_u32 s65, s65, 8192
    s_add_u32 s65, s65, 917504
    s_waitcnt vmcnt(40)
    s_sub_u32 s7, s60, 24
    v_mov_b32 v19, s7
    ds_max_i32 v16, v19
    s_waitcnt vmcnt(32)
    s_sub_u32 s7, s60, 16
    v_mov_b32 v19, s7
    ds_max_i32 v16, v19
    s_waitcnt vmcnt(24)
    s_sub_u32 s7, s60, 8
    v_mov_b32 v19, s7
    ds_max_i32 v16, v19
    s_waitcnt vmcnt(16)
    v_mov_b32 v19, s60
    ds_max_i32 v16, v19
    s_add_u32 s60, s60, 16
    s_waitcnt vmcnt(24)
    s_sub_u32 s7, s60, 24
    v_mov_b32 v19, s7
    ds_max_i32 v16, v19
    s_waitcnt vmcnt(16)
    s_sub_u32 s7, s60, 16
    v_mov_b32 v19, s7
    ds_max_i32 v16, v19
    s_waitcnt vmcnt(8)
    s_sub_u32 s7, s60, 8
    v_mov_b32 v19, s7
    ds_max_i32 v16, v19
    s_waitcnt vmcnt(0)
    v_mov_b32 v19, s60
    ds_max_i32 v16, v19
    v_mov_b32 v48, 0x24218
    s_mov_b32 s80, 1600000
LW_56:
    ds_read_b32 v49, v48
    s_waitcnt lgkmcnt(0)
    v_readfirstlane_b32 s79, v49
    s_cmp_ge_u32 s79, 16
    s_cbranch_scc1 LWD_57
    s_sleep 1
    s_sub_u32 s80, s80, 1
    s_cmp_lg_u32 s80, 0
    s_cbranch_scc1 LW_56
LWD_57:
    s_mov_b32 s66, 3
LL_58:
    s_waitcnt vmcnt(31)
    s_mov_b32 m0, s64
    s_add_u32 s64, s64, 1024
    buffer_load_dwordx4 v10, s[48:51], s65 offen nt lds
    s_add_u32 s65, s65, 8192
    s_waitcnt vmcnt(31)
    s_mov_b32 m0, s64
    s_add_u32 s64, s64, 1024
    buffer_load_dwordx4 v10, s[48:51], s65 offen nt lds
    s_add_u32 s65, s65, 8192
    s_waitcnt vmcnt(31)
    s_mov_b32 m0, s64
    s_add_u32 s64, s64, 1024
    buffer_load_dwordx4 v10, s[48:51], s65 offen nt lds
    s_add_u32 s65, s65, 8192
    s_waitcnt vmcnt(31)
    s_mov_b32 m0, s64
    s_add_u32 s64, s64, 1024
    buffer_load_dwordx4 v10, s[48:51], s65 offen nt lds
    s_add_u32 s65, s65, 8192
    s_waitcnt vmcnt(31)
    s_mov_b32 m0, s64
    s_add_u32 s64, s64, 1024
    buffer_load_dwordx4 v10, s[48:51], s65 offen nt lds
    s_add_u32 s65, s65, 8192
    s_waitcnt vmcnt(31)
    s_mov_b32 m0, s64
    s_add_u32 s64, s64, 1024
    buffer_load_dwordx4 v10, s[48:51], s65 offen nt lds
    s_add_u32 s65, s65, 8192
    s_waitcnt vmcnt(31)
    s_mov_b32 m0, s64
    s_add_u32 s64, s64, 1024
    buffer_load_dwordx4 v10, s[48:51], s65 offen nt lds
    s_add_u32 s65, s65, 8192
    s_waitcnt vmcnt(31)
    s_sub_u32 s7, s60, 24
    v_mov_b32 v19, s7
    ds_max_i32 v16, v19
    s_mov_b32 m0, s64
    s_add_u32 s64, s64, 1024
    buffer_load_dwordx4 v10, s[48:51], s65 offen nt lds
    s_add_u32 s65, s65, 8192
    s_waitcnt vmcnt(31)
    s_mov_b32 m0, s64
    s_add_u32 s64, s64, 1024
    buffer_load_dwordx4 v10, s[48:51], s65 offen nt lds
    s_add_u32 s65, s65, 8192
    s_waitcnt vmcnt(31)
    s_mov_b32 m0, s64
    s_add_u32 s64, s64, 1024
    buffer_load_dwordx4 v10, s[48:51], s65 offen nt lds
    s_add_u32 s65, s65, 8192
    s_waitcnt vmcnt(31)
    s_mov_b32 m0, s64
    s_add_u32 s64, s64, 1024
    buffer_load_dwordx4 v10, s[48:51], s65 offen nt lds
    s_add_u32 s65, s65, 8192
    s_waitcnt vmcnt(31)
    s_mov_b32 m0, s64
    s_add_u32 s64, s64, 1024
    buffer_load_dwordx4 v10, s[48:51], s65 offen nt lds
    s_add_u32 s65, s65, 8192
    s_waitcnt vmcnt(31)
    s_mov_b32 m0, s64
    s_add_u32 s64, s64, 1024
    buffer_load_dwordx4 v10, s[48:51], s65 offen nt lds
    s_add_u32 s65, s65, 8192
    s_waitcnt vmcnt(31)
    s_mov_b32 m0, s64
    s_add_u32 s64, s64, 1024
    buffer_load_dwordx4 v10, s[48:51], s65 offen nt lds
    s_add_u32 s65, s65, 8192
    s_waitcnt vmcnt(31)
    s_mov_b32 m0, s64
    s_add_u32 s64, s64, 1024
    buffer_load_dwordx4 v10, s[48:51], s65 offen nt lds
    s_add_u32 s65, s65, 8192
    s_waitcnt vmcnt(31)
    s_sub_u32 s7, s60, 16
    v_mov_b32 v19, s7
    ds_max_i32 v16, v19
    s_mov_b32 m0, s64
    s_add_u32 s64, s64, 1024
    buffer_load_dwordx4 v10, s[48:51], s65 offen nt lds
    s_add_u32 s65, s65, 8192
    s_add_u32 s60, s60, 16
    s_add_u32 s65, s65, 917504
    s_sub_u32 s66, s66, 1
    s_cmp_lg_u32 s66, 0
    s_cbranch_scc1 LL_58
    s_waitcnt vmcnt(24)
    s_sub_u32 s7, s60, 24
    v_mov_b32 v19, s7
    ds_max_i32 v16, v19
    s_waitcnt vmcnt(16)
    s_sub_u32 s7, s60, 16
    v_mov_b32 v19, s7
    ds_max_i32 v16, v19
    s_waitcnt vmcnt(8)
    s_sub_u32 s7, s60, 8
    v_mov_b32 v19, s7
    ds_max_i32 v16, v19
    s_waitcnt vmcnt(0)
    v_mov_b32 v19, s60
    ds_max_i32 v16, v19
    s_endpgm
L_RED:
    s_and_b32 s7, s4, 7
    s_cbranch_scc1 L_END
    s_add_u32 s61, s4, s5
    s_and_b32 s7, s6, 3
    s_cmp_eq_u32 s7, 3
    s_cbranch_scc1 L_END
    s_cmp_eq_u32 s7, 2
    s_cbranch_scc1 L_REDB
    s_lshl_b32 s60, s61, 1
    s_add_u32 s60, s60, s7
    s_mov_b32 s52, s30
    s_and_b32 s53, s31, 0xffff
    s_mov_b32 s54, 0x2000
    s_mov_b32 s55, 0x20000
    s_mov_b32 s84, 0x3f80
    s_mov_b32 s85, 0x3f800000
    s_lshl_b32 s7, s60, 12
    s_add_u32 s7, s7, 0x280000
    v_lshl_add_u32 v36, v1, 4, s7
    s_lshr_b32 s7, s60, 4
    s_lshl_b32 s7, s7, 11
    s_and_b32 s61, s60, 15
    s_lshl_b32 s61, s61, 6
    s_add_u32 s7, s7, s61
    v_lshl_add_u32 v37, v1, 3, s7
    s_mov_b64 exec, -1
    buffer_load_dwordx4 v[48:51], v36, s[36:39], 0 offen offset:0 sc1
    buffer_load_dwordx4 v[52:55], v36, s[36:39], 0 offen offset:1024 sc1
    buffer_load_dwordx4 v[56:59], v36, s[36:39], 0 offen offset:2048 sc1
    buffer_load_dwordx4 v[60:63], v36, s[36:39], 0 offen offset:3072 sc1
    s_mov_b32 s80, 200000
MC_60:
    s_mov_b64 exec, -1
    s_waitcnt vmcnt(0)
    v_cmp_ne_u64 s[62:63], s[92:93], v[50:51]
    v_cmp_ne_u64 s[64:65], s[92:93], v[54:55]
    v_cmp_ne_u64 s[66:67], s[92:93], v[58:59]
    v_cmp_ne_u64 s[68:69], s[92:93], v[62:63]
    s_or_b64 s[90:91], s[62:63], s[64:65]
    s_or_b64 s[90:91], s[90:91], s[66:67]
    s_or_b64 s[90:91], s[90:91], s[68:69]
    s_cbranch_scc1 M_59
MD_61:
    s_mov_b64 exec, -1
    v_dot2_f32_bf16 v44, v48, s84, 0
    v_dot2_f32_bf16 v45, v48, s85, 0
    v_dot2_f32_bf16 v46, v49, s84, 0
    v_dot2_f32_bf16 v47, v49, s85, 0
    v_dot2_f32_bf16 v44, v52, s84, v44
    v_dot2_f32_bf16 v45, v52, s85, v45
    v_dot2_f32_bf16 v46, v53, s84, v46
    v_dot2_f32_bf16 v47, v53, s85, v47
    v_dot2_f32_bf16 v44, v56, s84, v44
    v_dot2_f32_bf16 v45, v56, s85, v45
    v_dot2_f32_bf16 v46, v57, s84, v46
    v_dot2_f32_bf16 v47, v57, s85, v47
    v_dot2_f32_bf16 v44, v60, s84, v44
    v_dot2_f32_bf16 v45, v60, s85, v45
    v_dot2_f32_bf16 v46, v61, s84, v46
    v_dot2_f32_bf16 v47, v61, s85, v47
    v_add_f32_dpp v44, v44, v44 row_ror:8 row_mask:0xf bank_mask:0xf
    v_add_f32_dpp v45, v45, v45 row_ror:8 row_mask:0xf bank_mask:0xf
    v_add_f32_dpp v46, v46, v46 row_ror:8 row_mask:0xf bank_mask:0xf
    v_add_f32_dpp v47, v47, v47 row_ror:8 row_mask:0xf bank_mask:0xf
    s_nop 0
    v_permlane32_swap_b32 v44, v46
    v_permlane32_swap_b32 v45, v47
    v_add_f32 v44, v44, v46
    v_add_f32 v45, v45, v47
    v_mov_b32 v46, v44
    v_mov_b32 v47, v45
    s_nop 0
    v_permlane16_swap_b32 v44, v46
    v_permlane16_swap_b32 v45, v47
    v_add_f32 v44, v44, v46
    v_add_f32 v45, v45, v47
    v_cvt_pk_bf16_f32 v44, v44, v45
    v_mov_b32 v45, v44
    s_nop 1
    v_permlane32_swap_b32 v44, v45
    s_mov_b64 exec, 0xff
    buffer_store_dwordx2 v[44:45], v37, s[52:55], 0 offen
    s_mov_b64 exec, -1
    s_endpgm
L_REDB:
    s_mov_b32 s52, s30
    s_and_b32 s53, s31, 0xffff
    s_mov_b32 s54, 0x2000
    s_mov_b32 s55, 0x20000
    s_mov_b32 s84, 0x3f80
    s_mov_b32 s85, 0x3f800000
    s_lshl_b32 s7, s61, 11
    s_add_u32 s7, s7, 0x2c0000
    v_lshl_add_u32 v36, v1, 4, s7
    s_lshl_b32 s7, s61, 5
    s_add_u32 s7, s7, 1024
    v_and_b32 v38, 3, v1
    v_lshl_add_u32 v37, v38, 3, s7
    v_lshrrev_b32 v38, 2, v3
    v_lshl_add_u32 v37, v38, 11, v37
    s_mov_b64 exec, -1
    buffer_load_dwordx4 v[48:51], v36, s[36:39], 0 offen offset:0 sc1
    buffer_load_dwordx4 v[52:55], v36, s[36:39], 0 offen offset:1024 sc1
    s_mov_b32 s80, 200000
MC_63:
    s_mov_b64 exec, -1
    s_waitcnt vmcnt(0)
    v_cmp_ne_u64 s[62:63], s[92:93], v[50:51]
    v_cmp_ne_u64 s[64:65], s[92:93], v[54:55]
    s_or_b64 s[90:91], s[62:63], s[64:65]
    s_cbranch_scc1 M_62
MD_64:
    s_mov_b64 exec, -1
    v_dot2_f32_bf16 v44, v48, s84, 0
    v_dot2_f32_bf16 v45, v48, s85, 0
    v_dot2_f32_bf16 v46, v49, s84, 0
    v_dot2_f32_bf16 v47, v49, s85, 0
    v_dot2_f32_bf16 v44, v52, s84, v44
    v_dot2_f32_bf16 v45, v52, s85, v45
    v_dot2_f32_bf16 v46, v53, s84, v46
    v_dot2_f32_bf16 v47, v53, s85, v47
    s_nop 1
    v_permlane32_swap_b32 v44, v46
    v_permlane32_swap_b32 v45, v47
    v_add_f32 v44, v44, v46
    v_add_f32 v45, v45, v47
    v_mov_b32 v46, v44
    v_mov_b32 v47, v45
    s_nop 0
    v_permlane16_swap_b32 v44, v46
    v_permlane16_swap_b32 v45, v47
    v_add_f32 v44, v44, v46
    v_add_f32 v45, v45, v47
    v_cvt_pk_bf16_f32 v44, v44, v45
    v_mov_b32 v45, v44
    s_nop 1
    v_permlane32_swap_b32 v44, v45
    s_mov_b64 exec, 0xffff
    buffer_store_dwordx2 v[44:45], v37, s[52:55], 0 offen
    s_mov_b64 exec, -1
    s_endpgm
L_SIDE:
    v_lshlrev_b32 v10, 2, v0
    v_mov_b32 v24, 0
    v_add_u32 v10, 0x23c00, v10
    ds_write_b32 v10, v24
    s_mov_b32 s61, s6
    v_mov_b32 v28, -1
    v_mov_b32 v29, -1
    v_mov_b32 v30, -1
    v_mov_b32 v31, -1
    s_and_b32 s64, s4, 7
    s_lshl_b32 s64, s64, 3
    s_lshr_b32 s7, s4, 3
    s_lshl_b32 s7, s7, 1
    s_add_u32 s64, s64, s7
    s_add_u32 s64, s64, s5
    s_sub_u32 s64, s64, 6
    s_waitcnt lgkmcnt(0)
    s_mov_b32 s40, s32
    s_and_b32 s41, s33, 0xffff
    s_mov_b32 s42, 0x100
    s_mov_b32 s43, 0x20000
    s_or_b32 s7, s6, s2
    s_cbranch_scc1 NC_65
    s_lshl_b64 s[92:93], s[94:95], 5
    s_or_b32 s93, s93, 0x80000000
    v_mov_b32 v12, s92
    v_mov_b32 v13, s93
    s_mov_b64 exec, 1
    buffer_store_dwordx2 v[12:13], v24, s[40:43], 0 offen sc1
    s_mov_b64 exec, -1
NC_65:
    s_mov_b32 s36, s34
    s_and_b32 s37, s35, 0xffff
    s_mov_b32 s38, 0x1000000
    s_mov_b32 s39, 0x20000
    s_cmp_lt_u32 s5, 4
    s_cbranch_scc1 NB_67
    s_cmp_ge_u32 s5, 6
    s_cbranch_scc1 NQ_66
    s_cmp_lg_u32 s6, 2
    s_cbranch_scc1 NB_67
    s_lshl_b32 s7, s4, 1
    s_add_u32 s7, s7, s5
    s_lshl_b32 s7, s7, 9
    s_sub_u32 s7, s7, 2048
    v_lshl_add_u32 v10, v3, 4, s7
    v_lshl_add_u32 v10, v2, 15, v10
    buffer_store_dwordx4 v[28:31], v10, s[36:39], 0 offen sc1
    buffer_store_dwordx4 v[28:31], v10, s[36:39], 0 offen offset:256 sc1
    s_branch NB_67
NQ_66:
    s_lshl_b32 s65, s64, 2
    s_add_u32 s65, s65, s6
    s_and_b32 s7, s65, 31
    s_lshl_b32 s7, s7, 13
    s_lshr_b32 s62, s64, 3
    s_lshl_b32 s62, s62, 10
    s_add_u32 s7, s7, s62
    s_add_u32 s7, s7, 0x200000
    v_lshl_add_u32 v10, v1, 4, s7
    buffer_store_dwordx4 v[28:31], v10, s[36:39], 0 offen sc1
    s_lshl_b32 s7, s65, 10
    s_add_u32 s7, s7, 0x280000
    v_lshl_add_u32 v10, v1, 7, s7
    s_lshl_b32 s62, s65, 8
    s_add_u32 s7, s62, 0x2c0000
    v_writelane_b32 v10, s7, 8
    s_add_u32 s7, s62, 0x2c0080
    v_writelane_b32 v10, s7, 9
    s_add_u32 s7, s62, 0xc0000
    v_writelane_b32 v10, s7, 10
    s_add_u32 s7, s62, 0xc0080
    v_writelane_b32 v10, s7, 11
    s_lshl_b32 s7, s65, 7
    s_add_u32 s7, s7, 0x28000
    v_writelane_b32 v10, s7, 12
    s_add_u32 s7, s7, 0x8000
    v_writelane_b32 v10, s7, 14
    s_lshl_b32 s7, s65, 4
    s_add_u32 s7, s7, 0x23000
    v_writelane_b32 v10, s7, 13
    s_mov_b64 exec, 0x7fff
    buffer_load_dword v15, v10, s[36:39], 0 offen sc1
    s_mov_b64 exec, -1
    s_getpc_b64 s[84:85]
L_PC:
    s_and_b32 s7, s65, 31
    s_mul_i32 s7, s7, 1280
    v_lshl_add_u32 v10, v1, 7, s7
    v_min_u32 v10, L_END-concat_heads__sliding_block_cached__compressed_kv_cla__decode_kernel, v10
    s_sub_u32 s84, s84, L_PC-concat_heads__sliding_block_cached__compressed_kv_cla__decode_kernel
    s_subb_u32 s85, s85, 0
    v_mov_b32 v11, s85
    v_add_co_u32 v10, vcc, s84, v10
    s_nop 1
    v_addc_co_u32 v11, vcc, 0, v11, vcc
    s_mov_b64 exec, 0x3ff
    global_load_dword v15, v[10:11], off
    s_mov_b64 exec, -1
NB_67:
    s_barrier
    s_cmp_lg_u32 s6, 0
    s_cbranch_scc1 NF_69
    s_mov_b32 s80, 800000
    s_sleep 4
NL_71:
    s_mov_b64 exec, 1
    buffer_load_dwordx2 v[12:13], v24, s[40:43], 0 offen sc1
    s_mov_b64 exec, -1
    s_waitcnt vmcnt(0)
    v_readfirstlane_b32 s92, v12
    v_readfirstlane_b32 s93, v13
    s_sub_u32 s80, s80, 1
    s_cbranch_scc1 NH_72
    s_cmp_eq_u32 s93, 0
    s_cbranch_scc1 NL_71
    s_sub_u32 s7, s94, 1500
    s_lshl_b32 s7, s7, 5
    s_sub_u32 s7, s92, s7
    s_cmp_ge_i32 s7, 0
    s_cbranch_scc1 NH_72
    s_cmp_gt_u32 s80, 799960
    s_cbranch_scc1 NL_71
NH_72:
    v_mov_b32 v11, 0x24248
    v_mov_b32 v12, s92
    v_mov_b32 v13, s93
    ds_write_b64 v11, v[12:13]
    v_mov_b32 v11, 0x24204
    v_mov_b32 v14, 1
    s_mov_b64 exec, 1
    ds_add_u32 v11, v14
    s_mov_b64 exec, -1
NF_69:
    s_cmp_lg_u32 s6, 1
    s_cbranch_scc1 NP_68
    s_lshl_b32 s65, s4, 7
    s_add_u32 s65, s65, 0x21000
    s_lshr_b32 s7, s64, 3
    s_lshl_b32 s7, s7, 7
    s_add_u32 s7, s7, 0x22000
    s_and_b32 s62, s64, 7
    s_cmp_lt_u32 s5, 6
    s_cselect_b32 s7, s65, s7
    s_cselect_b32 s62, s5, s62
    v_lshl_add_u32 v11, v1, 3, s7
    s_sleep 12
    s_memrealtime s[88:89]
    s_waitcnt lgkmcnt(0)
    s_or_b32 s89, s89, s78
    v_mov_b32 v12, s88
    v_mov_b32 v13, s89
    s_lshl_b64 exec, 1, s62
    buffer_store_dwordx2 v[12:13], v11, s[36:39], 0 offen
    s_mov_b64 exec, -1
    s_cmp_ge_u32 s5, 6
    s_cbranch_scc1 NP_68
    s_sleep 24
    s_or_b32 s95, s95, s78
    s_add_u32 s88, s94, 0x10000
    s_addc_u32 s89, s95, 0
    s_mov_b32 s101, 16
    s_mov_b64 exec, 0x3f
U_73:
    buffer_load_dwordx2 v[14:15], v11, s[36:39], 0 offen sc1 nt
UU_74:
    s_waitcnt vmcnt(0)
    v_cmp_gt_u64 s[90:91], s[94:95], v[14:15]
    v_cmp_le_u64 vcc, s[88:89], v[14:15]
    s_or_b64 vcc, vcc, s[90:91]
    s_cbranch_scc0 UD_75
    s_sleep 8
    s_sub_u32 s101, s101, 1
    s_cmp_lg_u32 s101, 0
    s_cbranch_scc1 U_73
UD_75:
    s_mov_b64 exec, -1
    s_min_u32 s7, s101, 1
    s_add_u32 s7, s7, 16
    v_mov_b32 v12, 0x24200
    v_mov_b32 v13, s7
    s_mov_b64 exec, 1
    ds_add_u32 v12, v13
    s_mov_b64 exec, -1
NP_68:
    s_cmp_ge_u32 s5, 6
    s_cbranch_scc1 L_BATT
    s_cmp_lt_u32 s5, 4
    s_cbranch_scc1 NG_70
    s_cmp_lg_u32 s6, 2
    s_cbranch_scc1 NG_70
    s_lshl_b32 s7, s4, 4
    s_add_u32 s7, s7, s5
    s_lshl_b32 s7, s7, 3
    s_add_u32 s7, s7, 0x1ffe0
    v_mov_b32 v11, s7
    s_waitcnt vmcnt(0)
    v_mov_b32 v12, 0x24208
    v_mov_b32 v13, 16
    s_mov_b64 exec, 1
    ds_add_u32 v12, v13
    s_mov_b64 exec, -1
    v_mov_b32 v16, 0x24204
    s_mov_b32 s80, 1600000
LW_76:
    ds_read_b32 v17, v16
    s_waitcnt lgkmcnt(0)
    v_readfirstlane_b32 s79, v17
    s_cmp_ge_u32 s79, 1
    s_cbranch_scc1 LWD_77
    s_sleep 1
    s_sub_u32 s80, s80, 1
    s_cmp_lg_u32 s80, 0
    s_cbranch_scc1 LW_76
LWD_77:
    v_mov_b32 v16, 0x24248
    ds_read_b64 v[18:19], v16
    s_waitcnt lgkmcnt(0)
    v_readfirstlane_b32 s92, v18
    v_readfirstlane_b32 s93, v19
    s_mov_b64 exec, 1
    buffer_store_dwordx2 v[18:19], v11, s[36:39], 0 offen sc1
    s_mov_b64 exec, -1
NG_70:
    s_mov_b32 s96, 0x6010600
    s_mov_b32 s97, 0x6030602
    s_cmp_eq_u32 s5, 1
    s_cselect_b32 s96, 0x6190618, s96
    s_cselect_b32 s97, 0x61b061a, s97
    s_cmp_eq_u32 s5, 2
    s_cselect_b32 s96, 0x6310630, s96
    s_cselect_b32 s97, 0x6330632, s97
    s_cmp_eq_u32 s5, 3
    s_cselect_b32 s96, 0x6490648, s96
    s_cselect_b32 s97, 0x64b064a, s97
    s_cmp_eq_u32 s5, 4
    s_cselect_b32 s96, 0x4610460, s96
    s_cselect_b32 s97, 0x4630462, s97
    s_cmp_eq_u32 s5, 5
    s_cselect_b32 s96, 0x4710470, s96
    s_cselect_b32 s97, 0x4730472, s97
    s_lshl_b32 s7, s61, 4
    s_lshr_b64 s[90:91], s[96:97], s7
    s_and_b32 s66, s90, 3
    s_bfe_u32 s67, s90, 0x50002
    s_bfe_u32 s68, s90, 0x40008
    s_lshl_b32 s7, s4, 15
    s_lshl_b32 s63, s66, 9
    s_add_u32 s7, s7, s63
    s_add_u32 s7, s7, 0x100000
    v_and_b32 v20, 31, v1
    v_lshl_add_u32 v7, v20, 4, s7
    v_lshrrev_b32 v21, 5, v1
    v_lshl_add_u32 v7, v21, 11, v7
    v_add_u32 v22, 4096, v7
    s_mul_i32 s7, s66, 320
    s_add_u32 s63, s7, 0x24400
    v_lshl_add_u32 v6, v20, 3, s63
    v_lshl_add_u32 v6, v21, 2, v6
    s_mov_b32 s70, 0x3f80
    s_mov_b32 s71, 0x3f800000
    v_mov_b32 v12, 0x24200
    s_mov_b32 s80, 1600000
LW_78:
    ds_read_b32 v13, v12
    s_waitcnt lgkmcnt(0)
    v_readfirstlane_b32 s79, v13
    s_cmp_ge_u32 s79, 16
    s_cbranch_scc1 LWD_79
    s_sleep 4
    s_sub_u32 s80, s80, 1
    s_cmp_lg_u32 s80, 0
    s_cbranch_scc1 LW_78
LWD_79:
    s_and_b32 s101, s79, 15
    v_mov_b32 v16, 0x24204
    s_mov_b32 s80, 1600000
LW_80:
    ds_read_b32 v17, v16
    s_waitcnt lgkmcnt(0)
    v_readfirstlane_b32 s79, v17
    s_cmp_ge_u32 s79, 1
    s_cbranch_scc1 LWD_81
    s_sleep 1
    s_sub_u32 s80, s80, 1
    s_cmp_lg_u32 s80, 0
    s_cbranch_scc1 LW_80
LWD_81:
    v_mov_b32 v16, 0x24248
    ds_read_b64 v[18:19], v16
    s_waitcnt lgkmcnt(0)
    v_readfirstlane_b32 s92, v18
    v_readfirstlane_b32 s93, v19
    s_cmp_lt_u32 s5, 4
    s_cselect_b32 s65, 16, 148
    s_cselect_b32 s7, 0, 4294967288
    s_add_u32 s7, s7, 0x24210
    v_mov_b32 v12, s7
    s_mov_b32 s80, 1600000
LW_82:
    ds_read_b32 v13, v12
    s_waitcnt lgkmcnt(0)
    v_readfirstlane_b32 s79, v13
    s_cmp_ge_u32 s79, s65
    s_cbranch_scc1 LWD_83
    s_sleep 4
    s_sub_u32 s80, s80, 1
    s_cmp_lg_u32 s80, 0
    s_cbranch_scc1 LW_82
LWD_83:
    s_sleep 6
    s_mov_b64 exec, -1
    buffer_load_dwordx4 v[48:51], v7, s[36:39], 0 offen sc1 nt
    buffer_load_dwordx4 v[52:55], v22, s[36:39], 0 offen sc1 nt
    s_mov_b32 s80, 200000
MC_85:
    s_mov_b64 exec, -1
    s_waitcnt vmcnt(0)
    v_cmp_ne_u64 s[44:45], s[92:93], v[50:51]
    v_cmp_ne_u64 s[46:47], s[92:93], v[54:55]
    s_or_b64 s[90:91], s[44:45], s[46:47]
    s_cbranch_scc1 M_84
MD_86:
    s_mov_b64 exec, -1
    v_dot2_f32_bf16 v24, v48, s70, 0
    v_dot2_f32_bf16 v25, v48, s71, 0
    v_dot2_f32_bf16 v26, v49, s70, 0
    v_dot2_f32_bf16 v27, v49, s71, 0
    v_dot2_f32_bf16 v24, v52, s70, v24
    v_dot2_f32_bf16 v25, v52, s71, v25
    v_dot2_f32_bf16 v26, v53, s70, v26
    v_dot2_f32_bf16 v27, v53, s71, v27
    s_nop 1
    v_permlane32_swap_b32 v24, v26
    v_permlane32_swap_b32 v25, v27
    v_add_f32 v24, v24, v26
    v_add_f32 v25, v25, v27
    v_cvt_pk_bf16_f32 v24, v24, v25
    ds_write_b32 v6, v24
L_AATT:
    v_lshl_add_u32 v8, v2, 4, s63
    s_waitcnt lgkmcnt(0)
    ds_read_b128 v[16:19], v8 offset:0
    ds_read_b128 v[20:23], v8 offset:64
    ds_read_b128 v[24:27], v8 offset:128
    ds_read_b128 v[28:31], v8 offset:192
    v_xor_b32 v4, v3, v2
    v_lshlrev_b32 v4, 4, v4
    v_lshl_add_u32 v4, v3, 8, v4
    v_lshrrev_b32 v9, 2, v1
    v_and_b32 v5, 7, v9
    v_lshlrev_b32 v5, 5, v5
    v_lshl_add_u32 v5, v9, 8, v5
    v_and_b32 v10, 3, v1
    v_lshl_add_u32 v5, v10, 3, v5
    s_lshl_b32 s7, s61, 10
    s_add_u32 s7, s7, 0x24e00
    v_lshl_add_u32 v6, v2, 4, s7
    v_cmp_eq_u32 s[84:85], 0, v3
    s_mov_b32 s72, 0x3e0293ee
    s_cmp_ge_u32 s5, 4
    s_cselect_b32 s73, 8, 8
    s_cselect_b32 s69, 8, 0
    s_cselect_b32 s70, 17, 1
    s_cselect_b32 s74, 16, 24
    s_add_u32 s70, s70, s61
    s_add_u32 s74, s74, s70
    s_lshl_b32 s70, s70, 3
    s_add_u32 s69, s69, s61
    s_cmp_ge_u32 s69, 16
    s_cselect_b32 s7, 16, 0
    s_sub_u32 s69, s69, s7
    s_mov_b32 s71, s68
AK_87:
    s_lshl_b32 s7, s69, 13
    v_add_u32 v104, s7, v4
    v_xor_b32 v105, 0x40, v104
    v_xor_b32 v106, 0x80, v104
    v_xor_b32 v107, 0xc0, v104
    s_and_b32 s62, s69, 12
    s_add_u32 s62, s62, 0x24100
    v_mov_b32 v8, 0x24000
    s_mov_b32 s80, 1600000
LW_88:
    ds_read_b32 v9, v8
    s_waitcnt lgkmcnt(0)
    v_readfirstlane_b32 s79, v9
    s_cmp_ge_u32 s79, s70
    s_cbranch_scc1 LWD_89
    s_sleep 2
    s_sub_u32 s80, s80, 1
    s_cmp_lg_u32 s80, 0
    s_cbranch_scc1 LW_88
LWD_89:
    ds_read_b128 v[32:35], v104 offset:0
    ds_read_b128 v[36:39], v104 offset:4096
    ds_read_b128 v[40:43], v105 offset:0
    ds_read_b128 v[44:47], v105 offset:4096
    ds_read_b128 v[48:51], v106 offset:0
    ds_read_b128 v[52:55], v106 offset:4096
    ds_read_b128 v[56:59], v107 offset:0
    ds_read_b128 v[60:63], v107 offset:4096
    s_waitcnt lgkmcnt(6)
    v_mfma_f32_16x16x32_bf16 v[64:67], v[32:35], v[16:19], 0
    v_mfma_f32_16x16x32_bf16 v[68:71], v[36:39], v[16:19], 0
    s_waitcnt lgkmcnt(4)
    v_mfma_f32_16x16x32_bf16 v[64:67], v[40:43], v[20:23], v[64:67]
    v_mfma_f32_16x16x32_bf16 v[68:71], v[44:47], v[20:23], v[68:71]
    s_waitcnt lgkmcnt(2)
    v_mfma_f32_16x16x32_bf16 v[64:67], v[48:51], v[24:27], v[64:67]
    v_mfma_f32_16x16x32_bf16 v[68:71], v[52:55], v[24:27], v[68:71]
    s_waitcnt lgkmcnt(0)
    v_mfma_f32_16x16x32_bf16 v[64:67], v[56:59], v[28:31], v[64:67]
    v_mfma_f32_16x16x32_bf16 v[68:71], v[60:63], v[28:31], v[68:71]
    v_mov_b32 v8, s62
    v_mov_b32 v9, 1
    s_mov_b64 exec, 1
    ds_add_u32 v8, v9
    s_mov_b64 exec, -1
    s_mov_b64 exec, s[84:85]
    s_nop 0
    ds_write_b128 v6, v[64:67] offset:0
    ds_write_b128 v6, v[68:71] offset:64
    s_mov_b64 exec, -1
    v_add_u32 v6, 128, v6
    s_add_u32 s69, s69, 4
    s_cmp_ge_u32 s69, 16
    s_cselect_b32 s7, 16, 0
    s_sub_u32 s69, s69, s7
    s_add_u32 s70, s70, 32
    s_sub_u32 s71, s71, 1
    s_cmp_lg_u32 s71, 0
    s_cbranch_scc1 AK_87
    v_lshrrev_b32 v8, 2, v1
    v_cmp_gt_u32 s[86:87], s68, v8
    v_and_b32 v8, 7, v8
    v_and_b32 v9, 3, v1
    v_lshlrev_b32 v9, 4, v9
    v_lshl_add_u32 v10, v8, 7, v9
    s_lshl_b32 s7, s61, 10
    s_add_u32 s7, s7, 0x24e00
    v_add_u32 v10, s7, v10
    s_waitcnt lgkmcnt(0)
    ds_read_b128 v[32:35], v10
    ds_read_b128 v[36:39], v10 offset:64
    s_lshl_b32 s7, s61, 9
    s_add_u32 s7, s7, 0x25e00
    v_lshl_add_u32 v10, v8, 6, v9
    v_add_u32 v10, s7, v10
    v_lshl_add_u32 v7, v2, 4, s7
    v_mov_b32 v11, 0xff800000
    s_waitcnt lgkmcnt(0)
    v_cndmask_b32 v32, v11, v32, s[86:87]
    v_cndmask_b32 v33, v11, v33, s[86:87]
    v_cndmask_b32 v34, v11, v34, s[86:87]
    v_cndmask_b32 v35, v11, v35, s[86:87]
    v_cndmask_b32 v36, v11, v36, s[86:87]
    v_cndmask_b32 v37, v11, v37, s[86:87]
    v_cndmask_b32 v38, v11, v38, s[86:87]
    v_cndmask_b32 v39, v11, v39, s[86:87]
    v_max3_f32 v64, v32, v33, v34
    v_max3_f32 v64, v64, v35, v36
    v_max3_f32 v64, v64, v37, v38
    v_max_f32 v64, v64, v39
    s_nop 1
    v_max_f32_dpp v64, v64, v64 row_ror:1 row_mask:0xf bank_mask:0xf
    s_nop 1
    v_max_f32_dpp v64, v64, v64 row_ror:2 row_mask:0xf bank_mask:0xf
    s_nop 1
    v_max_f32_dpp v64, v64, v64 row_ror:4 row_mask:0xf bank_mask:0xf
    s_nop 1
    v_max_f32_dpp v64, v64, v64 row_ror:8 row_mask:0xf bank_mask:0xf
    v_mov_b32 v11, v64
    s_nop 1
    v_permlane32_swap_b32 v64, v11
    v_max_f32 v64, v64, v11
    v_mov_b32 v11, v64
    s_nop 1
    v_permlane16_swap_b32 v64, v11
    v_max_f32 v64, v64, v11
    v_mul_f32 v64, s72, v64
    v_fma_f32 v32, v32, s72, -v64
    v_fma_f32 v33, v33, s72, -v64
    v_fma_f32 v34, v34, s72, -v64
    v_fma_f32 v35, v35, s72, -v64
    v_fma_f32 v36, v36, s72, -v64
    v_fma_f32 v37, v37, s72, -v64
    v_fma_f32 v38, v38, s72, -v64
    v_fma_f32 v39, v39, s72, -v64
    v_exp_f32 v32, v32
    v_exp_f32 v33, v33
    v_exp_f32 v34, v34
    v_exp_f32 v35, v35
    v_exp_f32 v36, v36
    v_exp_f32 v37, v37
    v_exp_f32 v38, v38
    v_exp_f32 v39, v39
    v_cvt_pk_bf16_f32 v112, v32, v33
    v_cvt_pk_bf16_f32 v113, v34, v35
    v_cvt_pk_bf16_f32 v114, v36, v37
    v_cvt_pk_bf16_f32 v115, v38, v39
    s_mov_b64 exec, s[86:87]
    ds_write_b128 v10, v[112:115]
    s_mov_b64 exec, -1
    v_add_f32 v32, v32, v36
    v_add_f32 v33, v33, v37
    v_add_f32 v34, v34, v38
    v_add_f32 v35, v35, v39
    v_add_f32 v32, v32, v34
    v_add_f32 v33, v33, v35
    v_add_f32 v32, v32, v33
    v_mov_b32 v65, v32
    s_nop 1
    v_add_f32_dpp v65, v65, v65 row_ror:1 row_mask:0xf bank_mask:0xf
    s_nop 1
    v_add_f32_dpp v65, v65, v65 row_ror:2 row_mask:0xf bank_mask:0xf
    s_nop 1
    v_add_f32_dpp v65, v65, v65 row_ror:4 row_mask:0xf bank_mask:0xf
    s_nop 1
    v_add_f32_dpp v65, v65, v65 row_ror:8 row_mask:0xf bank_mask:0xf
    v_mov_b32 v11, v65
    s_nop 1
    v_permlane32_swap_b32 v65, v11
    v_add_f32 v65, v65, v11
    v_mov_b32 v11, v65
    s_nop 1
    v_permlane16_swap_b32 v65, v11
    v_add_f32 v65, v65, v11
    v_mov_b32 v8, 0x24204
    s_mov_b32 s80, 1600000
LW_90:
    ds_read_b32 v9, v8
    s_waitcnt lgkmcnt(0)
    v_readfirstlane_b32 s79, v9
    s_cmp_ge_u32 s79, 1
    s_cbranch_scc1 LWD_91
    s_sleep 1
    s_sub_u32 s80, s80, 1
    s_cmp_lg_u32 s80, 0
    s_cbranch_scc1 LW_90
LWD_91:
    v_mov_b32 v8, 0x24248
    ds_read_b64 v[10:11], v8
    s_waitcnt lgkmcnt(0)
    v_readfirstlane_b32 s92, v10
    v_readfirstlane_b32 s93, v11
    s_nop 0
    v_mov_b32 v66, s92
    v_mov_b32 v67, s93
    s_lshl_b32 s7, s4, 2
    s_add_u32 s7, s7, s66
    s_lshl_b32 s7, s7, 3
    s_add_u32 s7, s7, s5
    s_lshl_b32 s7, s7, 4
    s_add_u32 s7, s7, 0x24000
    v_mov_b32 v8, s7
    s_mov_b64 exec, 1
    s_cmp_eq_u32 s101, 0
    s_cbranch_scc1 SU_92
    buffer_store_dwordx4 v[64:67], v8, s[36:39], 0 offen
SV_93:
    s_mov_b64 exec, -1
    s_and_b32 s7, s7, -128
    v_lshl_add_u32 v12, v1, 4, s7
    v_or_b32 v70, 1, v66
    v_mov_b32 v71, v67
    v_mov_b32 v116, 0xff800000
    v_mov_b32 v117, 0
    v_mov_b32 v72, 0
    v_mov_b32 v73, 0
    v_mov_b32 v74, 0
    v_mov_b32 v75, 0
    v_mov_b32 v76, 0
    v_mov_b32 v77, 0
    v_mov_b32 v78, 0
    v_mov_b32 v79, 0
    v_mov_b32 v80, 0
    v_mov_b32 v81, 0
    v_mov_b32 v82, 0
    v_mov_b32 v83, 0
    v_mov_b32 v84, 0
    v_mov_b32 v85, 0
    v_mov_b32 v86, 0
    v_mov_b32 v87, 0
    v_mov_b32 v88, 0
    v_mov_b32 v89, 0
    v_mov_b32 v90, 0
    v_mov_b32 v91, 0
    v_mov_b32 v92, 0
    v_mov_b32 v93, 0
    v_mov_b32 v94, 0
    v_mov_b32 v95, 0
    v_mov_b32 v96, 0
    v_mov_b32 v97, 0
    v_mov_b32 v98, 0
    v_mov_b32 v99, 0
    v_mov_b32 v100, 0
    v_mov_b32 v101, 0
    v_mov_b32 v102, 0
    v_mov_b32 v103, 0
    s_lshl_b32 s7, s4, 4
    s_add_u32 s7, s7, s5
    s_lshl_b32 s7, s7, 2
    s_add_u32 s7, s7, s66
    s_lshl_b32 s7, s7, 9
    s_add_u32 s7, s7, 0x100000
    v_lshl_add_u32 v6, v1, 4, s7
    s_cmp_lt_u32 s5, 4
    s_cbranch_scc1 AE_94
    v_mov_b32 v13, 0
    s_mov_b64 exec, 0x01010101
    buffer_store_dword v13, v6, s[36:39], 0 offen
    buffer_load_dword v13, v6, s[36:39], 0 offen sc1 nt
    s_mov_b64 exec, -1
AE_94:
    s_add_u32 s69, s73, s61
    s_lshl_b32 s70, s74, 3
    s_cmp_ge_u32 s69, 16
    s_cselect_b32 s7, 16, 0
    s_sub_u32 s69, s69, s7
    s_mov_b32 s71, s68
AV_95:
    s_lshl_b32 s7, s69, 13
    v_add_u32 v104, s7, v5
    v_xor_b32 v105, 0x20, v104
    v_xor_b32 v106, 0x40, v104
    v_xor_b32 v107, 0x60, v104
    v_xor_b32 v108, 0x80, v104
    v_xor_b32 v109, 0xa0, v104
    v_xor_b32 v110, 0xc0, v104
    v_xor_b32 v111, 0xe0, v104
    s_and_b32 s62, s69, 12
    s_add_u32 s62, s62, 0x24100
    ds_read_b128 v[112:115], v7
    v_add_u32 v7, 64, v7
    s_cmp_le_u32 s71, 2
    s_cbranch_scc1 AW_96
AWB_97:
    v_mov_b32 v8, 0x24000
    s_mov_b32 s80, 1600000
LW_98:
    ds_read_b32 v9, v8
    s_waitcnt lgkmcnt(0)
    v_readfirstlane_b32 s79, v9
    s_cmp_ge_u32 s79, s70
    s_cbranch_scc1 LWD_99
    s_sleep 1
    s_sub_u32 s80, s80, 1
    s_cmp_lg_u32 s80, 0
    s_cbranch_scc1 LW_98
LWD_99:
    ds_read_b64_tr_b16 v[32:33], v104
    ds_read_b64_tr_b16 v[34:35], v104 offset:4096
    ds_read_b64_tr_b16 v[36:37], v105
    ds_read_b64_tr_b16 v[38:39], v105 offset:4096
    ds_read_b64_tr_b16 v[40:41], v106
    ds_read_b64_tr_b16 v[42:43], v106 offset:4096
    ds_read_b64_tr_b16 v[44:45], v107
    ds_read_b64_tr_b16 v[46:47], v107 offset:4096
    ds_read_b64_tr_b16 v[48:49], v108
    ds_read_b64_tr_b16 v[50:51], v108 offset:4096
    ds_read_b64_tr_b16 v[52:53], v109
    ds_read_b64_tr_b16 v[54:55], v109 offset:4096
    ds_read_b64_tr_b16 v[56:57], v110
    ds_read_b64_tr_b16 v[58:59], v110 offset:4096
    s_waitcnt lgkmcnt(12)
    v_mfma_f32_16x16x32_bf16 v[72:75], v[112:115], v[32:35], v[72:75]
    ds_read_b64_tr_b16 v[60:61], v111
    ds_read_b64_tr_b16 v[62:63], v111 offset:4096
    s_waitcnt lgkmcnt(12)
    v_mfma_f32_16x16x32_bf16 v[76:79], v[112:115], v[36:39], v[76:79]
    s_waitcnt lgkmcnt(10)
    v_mfma_f32_16x16x32_bf16 v[80:83], v[112:115], v[40:43], v[80:83]
    s_waitcnt lgkmcnt(8)
    v_mfma_f32_16x16x32_bf16 v[84:87], v[112:115], v[44:47], v[84:87]
    s_waitcnt lgkmcnt(6)
    v_mfma_f32_16x16x32_bf16 v[88:91], v[112:115], v[48:51], v[88:91]
    s_waitcnt lgkmcnt(4)
    v_mfma_f32_16x16x32_bf16 v[92:95], v[112:115], v[52:55], v[92:95]
    s_waitcnt lgkmcnt(2)
    v_mfma_f32_16x16x32_bf16 v[96:99], v[112:115], v[56:59], v[96:99]
    s_waitcnt lgkmcnt(0)
    v_mfma_f32_16x16x32_bf16 v[100:103], v[112:115], v[60:63], v[100:103]
    v_mov_b32 v8, s62
    v_mov_b32 v9, 1
    s_mov_b64 exec, 1
    ds_add_u32 v8, v9
    s_mov_b64 exec, -1
    s_add_u32 s69, s69, 4
    s_cmp_ge_u32 s69, 16
    s_cselect_b32 s7, 16, 0
    s_sub_u32 s69, s69, s7
    s_add_u32 s70, s70, 32
    s_sub_u32 s71, s71, 1
    s_cmp_lg_u32 s71, 0
    s_cbranch_scc1 AV_95
    v_mov_b32_dpp v72, v88 quad_perm:[0,1,2,3] row_mask:0x2 bank_mask:0xf
    v_mov_b32_dpp v76, v92 quad_perm:[0,1,2,3] row_mask:0x2 bank_mask:0xf
    v_mov_b32_dpp v80, v96 quad_perm:[0,1,2,3] row_mask:0x2 bank_mask:0xf
    v_mov_b32_dpp v84, v100 quad_perm:[0,1,2,3] row_mask:0x2 bank_mask:0xf
    v_mul_f32 v72, s72, v72
    v_mul_f32 v76, s72, v76
    v_mul_f32 v80, s72, v80
    v_mul_f32 v84, s72, v84
    v_cvt_pk_bf16_f32 v68, v72, v76
    v_cvt_pk_bf16_f32 v69, v80, v84
    s_mov_b64 exec, 0xffffffff
    s_cmp_eq_u32 s101, 0
    s_cbranch_scc1 SU_100
    buffer_store_dwordx4 v[68:71], v6, s[36:39], 0 offen
SV_101:
    s_mov_b64 exec, -1
    v_mov_b32 v8, 0x24214
    v_mov_b32 v9, 1
    s_mov_b64 exec, 1
    ds_add_u32 v8, v9
    s_mov_b64 exec, -1
    s_endpgm
L_ASVC:
    v_bfe_u32 v24, v1, 2, 2
    v_lshl_add_u32 v4, v24, 4, v2
    v_lshlrev_b32 v4, 8, v4
    v_and_b32 v25, 1, v2
    v_lshl_or_b32 v24, v24, 1, v25
    s_lshl_b32 s7, s61, 1
    v_xor_b32 v24, s7, v24
    v_lshl_add_u32 v4, v24, 5, v4
    v_and_b32 v24, 3, v1
    v_lshl_add_u32 v4, v24, 3, v4
    v_add_u32 v4, 0x0, v4
    v_xor_b32 v9, 32, v4
    v_lshlrev_b32 v8, 16, v24
    v_and_b32 v26, 4, v1
    v_lshl_add_u32 v8, v26, 4, v8
    v_lshl_add_u32 v8, v2, 4, v8
    s_lshl_b32 s7, s5, 2
    s_add_u32 s7, s7, s61
    s_lshl_b32 s7, s7, 5
    s_add_u32 s7, s7, s4
    s_lshl_b32 s7, s7, 7
    s_add_u32 s7, s7, 0x280000
    v_add_u32 v8, s7, v8
    v_cmp_gt_u32 s[84:85], 8, v3
    s_lshl_b32 s7, s4, 15
    s_lshl_b32 s62, s61, 9
    s_add_u32 s7, s7, s62
    s_add_u32 s7, s7, 0x100000
    v_and_b32 v26, 31, v1
    v_lshl_add_u32 v5, v26, 4, s7
    v_lshrrev_b32 v26, 5, v1
    v_lshl_add_u32 v5, v26, 11, v5
    s_mul_i32 s7, s61, 320
    s_add_u32 s7, s7, 0x26600
    v_lshl_add_u32 v6, v3, 4, s7
    v_lshl_add_u32 v6, v25, 3, v6
    v_lshl_add_u32 v6, v26, 2, v6
    v_mul_u32_u24 v7, 320, v24
    v_lshl_add_u32 v7, v2, 4, v7
    v_add_u32 v7, 0x26600, v7
    s_or_b64 s[94:95], s[92:93], 1
    v_mov_b32 v18, s92
    v_mov_b32 v19, s93
    s_mov_b32 s62, 4096
    s_mov_b32 s63, 8192
    s_mov_b32 s70, 0x3f80
    s_mov_b32 s71, 0x3f800000
    v_mov_b32 v28, 0x24214
    s_mov_b32 s80, 1600000
LW_102:
    ds_read_b32 v29, v28
    s_waitcnt lgkmcnt(0)
    v_readfirstlane_b32 s79, v29
    s_cmp_ge_u32 s79, 4
    s_cbranch_scc1 LWD_103
    s_sleep 2
    s_sub_u32 s80, s80, 1
    s_cmp_lg_u32 s80, 0
    s_cbranch_scc1 LW_102
LWD_103:
    s_setprio 2
    s_mov_b64 exec, -1
    buffer_load_dwordx4 v[112:115], v5, s[36:39], 0 offen sc1 nt
    buffer_load_dwordx4 v[116:119], v5, s[36:39], s62 offen sc1 nt
    buffer_load_dwordx4 v[120:123], v5, s[36:39], s63 offen sc1 nt
    v_mov_b32 v28, 0x24000
    s_mov_b32 s80, 1600000
LW_107:
    ds_read_b32 v29, v28
    s_waitcnt lgkmcnt(0)
    v_readfirstlane_b32 s79, v29
    s_cmp_ge_u32 s79, 416
    s_cbranch_scc1 LWD_108
    s_sub_u32 s80, s80, 1
    s_cmp_lg_u32 s80, 0
    s_cbranch_scc1 LW_107
LWD_108:
    ds_read_b64_tr_b16 v[32:33], v4 offset:0
    ds_read_b64_tr_b16 v[34:35], v4 offset:16384
    ds_read_b64_tr_b16 v[48:49], v9 offset:0
    ds_read_b64_tr_b16 v[50:51], v9 offset:16384
    ds_read_b64_tr_b16 v[36:37], v4 offset:1024
    ds_read_b64_tr_b16 v[38:39], v4 offset:17408
    ds_read_b64_tr_b16 v[52:53], v9 offset:1024
    ds_read_b64_tr_b16 v[54:55], v9 offset:17408
    ds_read_b64_tr_b16 v[40:41], v4 offset:2048
    ds_read_b64_tr_b16 v[42:43], v4 offset:18432
    ds_read_b64_tr_b16 v[56:57], v9 offset:2048
    ds_read_b64_tr_b16 v[58:59], v9 offset:18432
    ds_read_b64_tr_b16 v[44:45], v4 offset:3072
    ds_read_b64_tr_b16 v[46:47], v4 offset:19456
    ds_read_b64_tr_b16 v[60:61], v9 offset:3072
    ds_read_b64_tr_b16 v[62:63], v9 offset:19456
    s_mov_b32 s80, 200000
MC_105:
    s_mov_b64 exec, -1
    s_waitcnt vmcnt(0)
    v_cmp_ne_u64 s[64:65], s[94:95], v[114:115]
    v_cmp_ne_u64 s[66:67], s[94:95], v[118:119]
    v_cmp_ne_u64 s[68:69], s[94:95], v[122:123]
    s_or_b64 s[90:91], s[64:65], s[66:67]
    s_or_b64 s[90:91], s[90:91], s[68:69]
    s_cbranch_scc1 M_104
MD_106:
    s_mov_b64 exec, -1
    v_dot2_f32_bf16 v104, v112, s70, 0
    v_dot2_f32_bf16 v105, v112, s71, 0
    v_dot2_f32_bf16 v106, v113, s70, 0
    v_dot2_f32_bf16 v107, v113, s71, 0
    v_dot2_f32_bf16 v104, v116, s70, v104
    v_dot2_f32_bf16 v105, v116, s71, v105
    v_dot2_f32_bf16 v106, v117, s70, v106
    v_dot2_f32_bf16 v107, v117, s71, v107
    v_dot2_f32_bf16 v104, v120, s70, v104
    v_dot2_f32_bf16 v105, v120, s71, v105
    v_dot2_f32_bf16 v106, v121, s70, v106
    v_dot2_f32_bf16 v107, v121, s71, v107
    s_nop 1
    v_permlane32_swap_b32 v104, v106
    v_permlane32_swap_b32 v105, v107
    v_add_f32 v104, v104, v106
    v_add_f32 v105, v105, v107
    v_cvt_pk_bf16_f32 v104, v104, v105
    ds_write_b32 v6, v104
    s_add_u32 s81, s81, 4
    v_mov_b32 v24, 0x2420c
    v_mov_b32 v25, 1
    s_mov_b64 exec, 1
    ds_add_u32 v24, v25
    s_mov_b64 exec, -1
    v_mov_b32 v24, 0x2420c
    s_mov_b32 s80, 1600000
LW_109:
    ds_read_b32 v25, v24
    s_waitcnt lgkmcnt(0)
    v_readfirstlane_b32 s79, v25
    s_cmp_ge_u32 s79, s81
    s_cbranch_scc1 LWD_110
    s_sub_u32 s80, s80, 1
    s_cmp_lg_u32 s80, 0
    s_cbranch_scc1 LW_109
LWD_110:
    ds_read_b128 v[64:67], v7 offset:0
    ds_read_b128 v[68:71], v7 offset:64
    ds_read_b128 v[72:75], v7 offset:128
    ds_read_b128 v[76:79], v7 offset:192
    s_waitcnt lgkmcnt(3)
    v_mfma_f32_16x16x32_bf16 v[96:99], v[32:35], v[64:67], 0
    v_mfma_f32_16x16x32_bf16 v[100:103], v[48:51], v[64:67], 0
    s_waitcnt lgkmcnt(2)
    v_mfma_f32_16x16x32_bf16 v[96:99], v[36:39], v[68:71], v[96:99]
    v_mfma_f32_16x16x32_bf16 v[100:103], v[52:55], v[68:71], v[100:103]
    s_waitcnt lgkmcnt(1)
    v_mfma_f32_16x16x32_bf16 v[96:99], v[40:43], v[72:75], v[96:99]
    v_mfma_f32_16x16x32_bf16 v[100:103], v[56:59], v[72:75], v[100:103]
    s_waitcnt lgkmcnt(0)
    v_mfma_f32_16x16x32_bf16 v[96:99], v[44:47], v[76:79], v[96:99]
    v_mfma_f32_16x16x32_bf16 v[100:103], v[60:63], v[76:79], v[100:103]
    s_nop 6
    v_cvt_pk_bf16_f32 v16, v96, v97
    v_cvt_pk_bf16_f32 v17, v98, v99
    v_cvt_pk_bf16_f32 v104, v100, v101
    v_cvt_pk_bf16_f32 v105, v102, v103
    s_nop 0
    v_mov_b32_dpp v16, v104 quad_perm:[0,1,2,3] row_mask:0xf bank_mask:0x2
    v_mov_b32_dpp v17, v105 quad_perm:[0,1,2,3] row_mask:0xf bank_mask:0x2
    s_mov_b64 exec, s[84:85]
    buffer_store_dwordx4 v[16:19], v8, s[36:39], 0 offen sc1
    s_mov_b64 exec, -1
    s_branch L_RED
L_QABS:
    s_and_b32 s61, s6, 3
    s_waitcnt lgkmcnt(0)
    s_mov_b32 s36, s34
    s_and_b32 s37, s35, 0xffff
    s_mov_b32 s38, 0x1000000
    s_mov_b32 s39, 0x20000
    s_barrier
    s_cmp_ge_u32 s5, 6
    s_cbranch_scc1 L_BATT
    v_and_b32 v8, 3, v1
    v_lshlrev_b32 v5, 15, v8
    v_lshl_add_u32 v5, v2, 3, v5
    v_lshrrev_b32 v10, 2, v3
    v_lshl_add_u32 v5, v10, 5, v5
    s_lshl_b32 s7, s4, 1
    s_add_u32 s7, s7, s5
    s_lshl_b32 s7, s7, 2
    s_add_u32 s7, s7, s61
    s_lshl_b32 s7, s7, 7
    s_sub_u32 s7, s7, 2048
    v_add_u32 v5, s7, v5
    s_or_b32 s95, s95, s78
    s_add_u32 s72, s94, 0x10000
    s_addc_u32 s73, s95, 0
    s_lshl_b32 s7, s4, 15
    s_lshl_b32 s63, s61, 9
    s_add_u32 s7, s7, s63
    s_add_u32 s7, s7, 0x104000
    v_and_b32 v20, 31, v1
    v_lshl_add_u32 v7, v20, 4, s7
    v_lshrrev_b32 v21, 5, v1
    v_lshl_add_u32 v7, v21, 11, v7
    v_add_u32 v22, 4096, v7
    s_mul_i32 s7, s61, 320
    s_add_u32 s63, s7, 0x24900
    v_lshl_add_u32 v6, v20, 3, s63
    v_lshl_add_u32 v6, v21, 2, v6
    s_mov_b32 s70, 0x3f80
    s_mov_b32 s71, 0x3f800000
    v_xor_b32 v10, v3, v2
    v_lshlrev_b32 v10, 4, v10
    v_lshl_add_u32 v10, v3, 8, v10
    s_lshl_b32 s7, s61, 14
    s_add_u32 s7, s7, 0x10000
    v_add_u32 v10, s7, v10
    s_lshl_b32 s65, s61, 4
    s_add_u32 s65, s65, 16
    s_and_b32 s64, s61, 2
    s_lshl_b32 s64, s64, 1
    s_add_u32 s64, s64, 0x24108
    v_mul_u32_u24 v9, 320, v8
    v_lshl_add_u32 v9, v2, 4, v9
    v_add_u32 v9, 0x24900, v9
    v_mov_b32 v12, 0x24000
    s_mov_b32 s80, 1600000
LW_112:
    ds_read_b32 v13, v12
    s_waitcnt lgkmcnt(0)
    v_readfirstlane_b32 s79, v13
    s_cmp_ge_u32 s79, 40
    s_cbranch_scc1 LWD_113
    s_sleep 1
    s_sub_u32 s80, s80, 1
    s_cmp_lg_u32 s80, 0
    s_cbranch_scc1 LW_112
LWD_113:
    s_mov_b64 exec, -1
    buffer_load_dwordx4 v[48:51], v7, s[36:39], 0 offen sc1 nt
    buffer_load_dwordx4 v[52:55], v22, s[36:39], 0 offen sc1 nt
    s_mov_b32 s80, 200000
MC_115:
    s_mov_b64 exec, -1
    s_waitcnt vmcnt(0)
    v_cmp_gt_u64 s[44:45], s[94:95], v[50:51]
    v_cmp_le_u64 vcc, s[72:73], v[50:51]
    s_or_b64 s[44:45], s[44:45], vcc
    v_cmp_gt_u64 s[46:47], s[94:95], v[54:55]
    v_cmp_le_u64 vcc, s[72:73], v[54:55]
    s_or_b64 s[46:47], s[46:47], vcc
    s_or_b64 s[90:91], s[44:45], s[46:47]
    s_cbranch_scc1 M_114
MD_116:
    s_mov_b64 exec, -1
    v_dot2_f32_bf16 v24, v48, s70, 0
    v_dot2_f32_bf16 v25, v48, s71, 0
    v_dot2_f32_bf16 v26, v49, s70, 0
    v_dot2_f32_bf16 v27, v49, s71, 0
    v_dot2_f32_bf16 v24, v52, s70, v24
    v_dot2_f32_bf16 v25, v52, s71, v25
    v_dot2_f32_bf16 v26, v53, s70, v26
    v_dot2_f32_bf16 v27, v53, s71, v27
    s_nop 1
    v_permlane32_swap_b32 v24, v26
    v_permlane32_swap_b32 v25, v27
    v_add_f32 v24, v24, v26
    v_add_f32 v25, v25, v27
    v_cvt_pk_bf16_f32 v24, v24, v25
    ds_write_b32 v6, v24
    v_mov_b32 v48, 0x24208
    v_mov_b32 v49, 1
    s_mov_b64 exec, 1
    ds_add_u32 v48, v49
    s_mov_b64 exec, -1
    v_mov_b32 v12, 0x24000
    s_mov_b32 s80, 1600000
LW_117:
    ds_read_b32 v13, v12
    s_waitcnt lgkmcnt(0)
    v_readfirstlane_b32 s79, v13
    s_cmp_ge_u32 s79, s65
    s_cbranch_scc1 LWD_118
    s_sub_u32 s80, s80, 1
    s_cmp_lg_u32 s80, 0
    s_cbranch_scc1 LW_117
LWD_118:
    v_xor_b32 v11, 0x0, v10
    ds_read_b128 v[64:67], v11 offset:0
    ds_read_b128 v[80:83], v11 offset:4096
    ds_read_b128 v[96:99], v11 offset:8192
    ds_read_b128 v[112:115], v11 offset:12288
    v_xor_b32 v11, 0x40, v10
    ds_read_b128 v[68:71], v11 offset:0
    ds_read_b128 v[84:87], v11 offset:4096
    ds_read_b128 v[100:103], v11 offset:8192
    ds_read_b128 v[116:119], v11 offset:12288
    v_xor_b32 v11, 0x80, v10
    ds_read_b128 v[72:75], v11 offset:0
    ds_read_b128 v[88:91], v11 offset:4096
    ds_read_b128 v[104:107], v11 offset:8192
    ds_read_b128 v[120:123], v11 offset:12288
    v_xor_b32 v11, 0xc0, v10
    ds_read_b128 v[76:79], v11 offset:0
    ds_read_b128 v[92:95], v11 offset:4096
    ds_read_b128 v[108:111], v11 offset:8192
    ds_read_b128 v[124:127], v11 offset:12288
    v_mov_b32 v12, s64
    v_mov_b32 v13, 2
    s_mov_b64 exec, 1
    ds_add_u32 v12, v13
    s_mov_b64 exec, -1
    v_mov_b32 v12, 0x24208
    s_mov_b32 s80, 1600000
LW_119:
    ds_read_b32 v13, v12
    s_waitcnt lgkmcnt(0)
    v_readfirstlane_b32 s79, v13
    s_cmp_ge_u32 s79, 20
    s_cbranch_scc1 LWD_120
    s_sub_u32 s80, s80, 1
    s_cmp_lg_u32 s80, 0
    s_cbranch_scc1 LW_119
LWD_120:
    ds_read_b128 v[48:51], v9 offset:0
    ds_read_b128 v[52:55], v9 offset:64
    ds_read_b128 v[56:59], v9 offset:128
    ds_read_b128 v[60:63], v9 offset:192
    s_waitcnt lgkmcnt(3)
    v_mfma_f32_16x16x32_bf16 v[128:131], v[64:67], v[48:51], 0
    v_mfma_f32_16x16x32_bf16 v[132:135], v[80:83], v[48:51], 0
    v_mfma_f32_16x16x32_bf16 v[136:139], v[96:99], v[48:51], 0
    v_mfma_f32_16x16x32_bf16 v[140:143], v[112:115], v[48:51], 0
    s_waitcnt lgkmcnt(2)
    v_mfma_f32_16x16x32_bf16 v[128:131], v[68:71], v[52:55], v[128:131]
    v_mfma_f32_16x16x32_bf16 v[132:135], v[84:87], v[52:55], v[132:135]
    v_mfma_f32_16x16x32_bf16 v[136:139], v[100:103], v[52:55], v[136:139]
    v_mfma_f32_16x16x32_bf16 v[140:143], v[116:119], v[52:55], v[140:143]
    s_waitcnt lgkmcnt(1)
    v_mfma_f32_16x16x32_bf16 v[128:131], v[72:75], v[56:59], v[128:131]
    v_mfma_f32_16x16x32_bf16 v[132:135], v[88:91], v[56:59], v[132:135]
    v_mfma_f32_16x16x32_bf16 v[136:139], v[104:107], v[56:59], v[136:139]
    v_mfma_f32_16x16x32_bf16 v[140:143], v[120:123], v[56:59], v[140:143]
    s_waitcnt lgkmcnt(0)
    v_mfma_f32_16x16x32_bf16 v[128:131], v[76:79], v[60:63], v[128:131]
    v_mfma_f32_16x16x32_bf16 v[132:135], v[92:95], v[60:63], v[132:135]
    v_mfma_f32_16x16x32_bf16 v[136:139], v[108:111], v[60:63], v[136:139]
    v_mfma_f32_16x16x32_bf16 v[140:143], v[124:127], v[60:63], v[140:143]
    s_nop 4
    v_cvt_pk_bf16_f32 v24, v128, v129
    v_cvt_pk_bf16_f32 v25, v130, v131
    v_cvt_pk_bf16_f32 v26, v132, v133
    v_cvt_pk_bf16_f32 v27, v134, v135
    v_cvt_pk_bf16_f32 v28, v136, v137
    v_cvt_pk_bf16_f32 v29, v138, v139
    v_cvt_pk_bf16_f32 v30, v140, v141
    v_cvt_pk_bf16_f32 v31, v142, v143
    v_mov_b32_dpp v24, v26 quad_perm:[0,1,2,3] row_mask:0xf bank_mask:0x2
    v_mov_b32_dpp v25, v27 quad_perm:[0,1,2,3] row_mask:0xf bank_mask:0x2
    v_mov_b32_dpp v24, v28 quad_perm:[0,1,2,3] row_mask:0xf bank_mask:0x4
    v_mov_b32_dpp v25, v29 quad_perm:[0,1,2,3] row_mask:0xf bank_mask:0x4
    v_mov_b32_dpp v24, v30 quad_perm:[0,1,2,3] row_mask:0xf bank_mask:0x8
    v_mov_b32_dpp v25, v31 quad_perm:[0,1,2,3] row_mask:0xf bank_mask:0x8
    buffer_store_dwordx2 v[24:25], v5, s[36:39], 0 offen sc1
    v_mov_b32 v48, 0x24208
    v_mov_b32 v49, 32
    s_mov_b64 exec, 1
    ds_add_u32 v48, v49
    s_mov_b64 exec, -1
L_ESVC:
    v_lshrrev_b32 v160, 2, v1
    v_bfe_u32 v161, v1, 3, 2
    v_xor_b32 v161, s61, v161
    v_lshlrev_b32 v161, 5, v161
    v_lshl_add_u32 v161, v160, 7, v161
    v_and_b32 v162, 3, v1
    v_lshl_add_u32 v161, v162, 3, v161
    s_lshl_b32 s7, s61, 8
    s_lshl_b32 s62, s4, 10
    s_add_u32 s7, s7, s62
    s_add_u32 s7, s7, 0x30000
    v_and_b32 v164, 1, v1
    v_lshl_add_u32 v4, v164, 7, s7
    s_lshl_b32 s7, s4, 13
    s_lshl_b32 s62, s61, 11
    s_add_u32 s7, s7, s62
    s_add_u32 s7, s7, 0x200000
    v_lshl_add_u32 v5, v1, 4, s7
    s_mul_i32 s7, s61, 1088
    s_add_u32 s7, s7, 0x26600
    v_lshl_add_u32 v6, v160, 6, s7
    v_lshl_add_u32 v6, v164, 5, v6
    v_and_b32 v164, 2, v1
    v_lshl_add_u32 v6, v164, 2, v6
    v_mul_u32_u24 v7, 1088, v162
    v_lshl_add_u32 v7, v2, 4, v7
    v_add_u32 v7, 0x26600, v7
    v_cmp_gt_u32 s[84:85], 4, v3
    s_and_b32 s62, s4, 7
    s_lshl_b32 s62, s62, 3
    s_lshr_b32 s7, s4, 3
    s_lshl_b32 s7, s7, 1
    s_add_u32 s62, s62, s7
    s_add_u32 s62, s62, s5
    s_sub_u32 s62, s62, 6
    s_add_u32 s62, s62, 2
    s_lshl_b32 s7, s62, 10
    s_lshl_b32 s64, s61, 8
    s_add_u32 s7, s7, s64
    s_add_u32 s7, s7, 0xc0000
    v_lshl_add_u32 v10, v162, 6, s7
    v_lshl_add_u32 v10, v2, 4, v10
    s_lshr_b32 s7, s62, 3
    s_lshl_b32 s7, s7, 7
    s_add_u32 s7, s7, 0x22000
    v_and_b32 v164, 7, v1
    v_lshl_add_u32 v9, v164, 3, s7
    v_mov_b32 v16, 0x24204
    s_mov_b32 s80, 1600000
LW_121:
    ds_read_b32 v17, v16
    s_waitcnt lgkmcnt(0)
    v_readfirstlane_b32 s79, v17
    s_cmp_ge_u32 s79, 1
    s_cbranch_scc1 LWD_122
    s_sleep 1
    s_sub_u32 s80, s80, 1
    s_cmp_lg_u32 s80, 0
    s_cbranch_scc1 LW_121
LWD_122:
    v_mov_b32 v16, 0x24248
    ds_read_b64 v[18:19], v16
    s_waitcnt lgkmcnt(0)
    v_readfirstlane_b32 s92, v18
    v_readfirstlane_b32 s93, v19
    v_mov_b32 v16, 0x24000
    s_mov_b32 s80, 1600000
LW_123:
    ds_read_b32 v17, v16
    s_waitcnt lgkmcnt(0)
    v_readfirstlane_b32 s79, v17
    s_cmp_ge_u32 s79, 96
    s_cbranch_scc1 LWD_124
    s_sleep 4
    s_sub_u32 s80, s80, 1
    s_cmp_lg_u32 s80, 0
    s_cbranch_scc1 LW_123
LWD_124:
    s_or_b32 s95, s95, s78
    s_add_u32 s88, s94, 0x10000
    s_addc_u32 s89, s95, 0
    s_mov_b32 s101, 4
    s_mov_b64 exec, 0xff
U_125:
    buffer_load_dwordx2 v[16:17], v9, s[36:39], 0 offen sc1 nt
UU_126:
    s_waitcnt vmcnt(0)
    v_cmp_gt_u64 s[90:91], s[94:95], v[16:17]
    v_cmp_le_u64 vcc, s[88:89], v[16:17]
    s_or_b64 vcc, vcc, s[90:91]
    s_cbranch_scc0 UD_127
    s_sleep 8
    s_sub_u32 s101, s101, 1
    s_cmp_lg_u32 s101, 0
    s_cbranch_scc1 U_125
UD_127:
    s_mov_b64 exec, -1
    v_mov_b32 v16, 0x24000
    s_mov_b32 s80, 1600000
LW_128:
    ds_read_b32 v17, v16
    s_waitcnt lgkmcnt(0)
    v_readfirstlane_b32 s79, v17
    s_cmp_ge_u32 s79, 128
    s_cbranch_scc1 LWD_129
    s_sleep 4
    s_sub_u32 s80, s80, 1
    s_cmp_lg_u32 s80, 0
    s_cbranch_scc1 LW_128
LWD_129:
    ds_read_b64_tr_b16 v[32:33], v161 offset:0
    ds_read_b64_tr_b16 v[34:35], v161 offset:2048
    ds_read_b64_tr_b16 v[36:37], v161 offset:4096
    ds_read_b64_tr_b16 v[38:39], v161 offset:6144
    ds_read_b64_tr_b16 v[40:41], v161 offset:8192
    ds_read_b64_tr_b16 v[42:43], v161 offset:10240
    ds_read_b64_tr_b16 v[44:45], v161 offset:12288
    ds_read_b64_tr_b16 v[46:47], v161 offset:14336
    s_waitcnt lgkmcnt(4)
    ds_read_b64_tr_b16 v[48:49], v161 offset:16384
    ds_read_b64_tr_b16 v[50:51], v161 offset:18432
    ds_read_b64_tr_b16 v[52:53], v161 offset:20480
    ds_read_b64_tr_b16 v[54:55], v161 offset:22528
    ds_read_b64_tr_b16 v[56:57], v161 offset:24576
    ds_read_b64_tr_b16 v[58:59], v161 offset:26624
    ds_read_b64_tr_b16 v[60:61], v161 offset:28672
    ds_read_b64_tr_b16 v[62:63], v161 offset:30720
    s_waitcnt lgkmcnt(4)
    ds_read_b64_tr_b16 v[64:65], v161 offset:32768
    ds_read_b64_tr_b16 v[66:67], v161 offset:34816
    ds_read_b64_tr_b16 v[68:69], v161 offset:36864
    ds_read_b64_tr_b16 v[70:71], v161 offset:38912
    ds_read_b64_tr_b16 v[72:73], v161 offset:40960
    ds_read_b64_tr_b16 v[74:75], v161 offset:43008
    ds_read_b64_tr_b16 v[76:77], v161 offset:45056
    ds_read_b64_tr_b16 v[78:79], v161 offset:47104
    s_waitcnt lgkmcnt(4)
    ds_read_b64_tr_b16 v[80:81], v161 offset:49152
    ds_read_b64_tr_b16 v[82:83], v161 offset:51200
    ds_read_b64_tr_b16 v[84:85], v161 offset:53248
    ds_read_b64_tr_b16 v[86:87], v161 offset:55296
    ds_read_b64_tr_b16 v[88:89], v161 offset:57344
    ds_read_b64_tr_b16 v[90:91], v161 offset:59392
    ds_read_b64_tr_b16 v[92:93], v161 offset:61440
    ds_read_b64_tr_b16 v[94:95], v161 offset:63488
    s_waitcnt lgkmcnt(4)
    v_lshlrev_b32 v16, 2, v1
    v_add_u32 v16, 0x24100, v16
    v_mov_b32 v17, 1
    s_mov_b64 exec, 3
    ds_add_u32 v16, v17
    s_mov_b64 exec, -1
    s_lshl_b32 s7, s62, 2
    s_add_u32 s7, s7, s61
    s_lshl_b32 s7, s7, 13
    s_add_u32 s7, s7, 0x600000
    v_lshl_add_u32 v8, v1, 7, s7
    buffer_load_dword v8, v8, s[36:39], 0 offen sc1 nt
    s_and_b32 s7, s4, 7
    s_lshl_b32 s7, s7, 12
    s_add_u32 s7, s7, 0x28008
    v_lshl_add_u32 v9, v1, 9, s7
    s_mov_b64 exec, 3
    buffer_load_dwordx2 v[12:13], v4, s[36:39], 0 offen offset:16 sc1
    s_mov_b32 s80, 200000
MC_131:
    s_mov_b64 exec, 3
    s_waitcnt vmcnt(0)
    v_cmp_ne_u64 s[64:65], s[92:93], v[12:13]
    s_cmp_lg_u64 s[64:65], 0
    s_cbranch_scc1 M_130
MD_132:
    s_mov_b64 exec, -1
    s_cmp_eq_u32 s101, 0
    s_cbranch_scc1 EH_133
    s_mov_b64 exec, 0xff
    buffer_load_dwordx2 v[12:13], v9, s[36:39], 0 offen sc1 nt
    s_mov_b32 s80, 200000
MC_135:
    s_mov_b64 exec, 0xff
    s_waitcnt vmcnt(0)
    v_cmp_ne_u64 s[64:65], s[92:93], v[12:13]
    s_cmp_lg_u64 s[64:65], 0
    s_cbranch_scc1 M_134
MD_136:
    s_mov_b64 exec, -1
EH_133:
    s_sleep 25
    s_setprio 2
    s_mov_b64 exec, -1
    buffer_load_dwordx4 v[16:19], v5, s[36:39], 0 offen offset:0 sc1
    buffer_load_dwordx4 v[20:23], v5, s[36:39], 0 offen offset:1024 sc1
    buffer_load_dwordx4 v[12:15], v4, s[36:39], 0 offen sc1
    s_mov_b32 s80, 200000
MC_138:
    s_mov_b64 exec, -1
    s_waitcnt vmcnt(0)
    v_max3_u32 v160, v16, v17, v18
    v_max_u32 v160, v160, v19
    v_cmp_eq_u32 s[64:65], -1, v160
    v_max3_u32 v161, v20, v21, v22
    v_max_u32 v161, v161, v23
    v_cmp_eq_u32 s[66:67], -1, v161
    v_cmp_ne_u64 s[68:69], s[92:93], v[14:15]
    s_or_b64 s[90:91], s[64:65], s[66:67]
    s_or_b64 s[90:91], s[90:91], s[68:69]
    s_cbranch_scc1 M_137
MD_139:
    s_mov_b64 exec, -1
    v_readlane_b32 s74, v12, 0
    v_readlane_b32 s76, v13, 0
    v_readlane_b32 s75, v12, 1
    v_readlane_b32 s77, v13, 1
    v_mov_b32 v160, s74
    v_max_f32 v160, s75, v160
    v_sub_f32 v11, s74, v160
    v_sub_f32 v12, s75, v160
    v_exp_f32 v11, v11
    v_exp_f32 v12, v12
    v_mul_f32 v160, s76, v11
    v_fmac_f32 v160, s77, v12
    v_rcp_f32 v160, v160
    s_nop 0
    v_mul_f32 v11, v11, v160
    v_mul_f32 v12, v12, v160
    v_lshlrev_b32 v96, 16, v16
    v_and_b32 v97, 0xffff0000, v16
    v_lshlrev_b32 v98, 16, v17
    v_and_b32 v99, 0xffff0000, v17
    v_lshlrev_b32 v100, 16, v18
    v_and_b32 v101, 0xffff0000, v18
    v_lshlrev_b32 v102, 16, v19
    v_and_b32 v103, 0xffff0000, v19
    v_lshlrev_b32 v104, 16, v20
    v_and_b32 v105, 0xffff0000, v20
    v_lshlrev_b32 v106, 16, v21
    v_and_b32 v107, 0xffff0000, v21
    v_lshlrev_b32 v108, 16, v22
    v_and_b32 v109, 0xffff0000, v22
    v_lshlrev_b32 v110, 16, v23
    v_and_b32 v111, 0xffff0000, v23
    v_mul_f32 v96, v96, v11
    v_mul_f32 v97, v97, v11
    v_mul_f32 v98, v98, v11
    v_mul_f32 v99, v99, v11
    v_mul_f32 v100, v100, v11
    v_mul_f32 v101, v101, v11
    v_mul_f32 v102, v102, v11
    v_mul_f32 v103, v103, v11
    v_fmac_f32 v96, v104, v12
    v_fmac_f32 v97, v105, v12
    v_fmac_f32 v98, v106, v12
    v_fmac_f32 v99, v107, v12
    v_fmac_f32 v100, v108, v12
    v_fmac_f32 v101, v109, v12
    v_fmac_f32 v102, v110, v12
    v_fmac_f32 v103, v111, v12
    v_cvt_pk_bf16_f32 v24, v96, v97
    v_cvt_pk_bf16_f32 v25, v98, v99
    v_cvt_pk_bf16_f32 v26, v100, v101
    v_cvt_pk_bf16_f32 v27, v102, v103
    ds_write_b64 v6, v[24:25]
    ds_write_b64 v6, v[26:27] offset:16
    s_add_u32 s81, s81, 4
    v_mov_b32 v160, 0x2420c
    v_mov_b32 v161, 1
    s_mov_b64 exec, 1
    ds_add_u32 v160, v161
    s_mov_b64 exec, -1
    v_mov_b32 v160, 0x2420c
    s_mov_b32 s80, 1600000
LW_140:
    ds_read_b32 v161, v160
    s_waitcnt lgkmcnt(0)
    v_readfirstlane_b32 s79, v161
    s_cmp_ge_u32 s79, s81
    s_cbranch_scc1 LWD_141
    s_sub_u32 s80, s80, 1
    s_cmp_lg_u32 s80, 0
    s_cbranch_scc1 LW_140
LWD_141:
    ds_read_b128 v[96:99], v7 offset:0
    ds_read_b128 v[100:103], v7 offset:64
    ds_read_b128 v[104:107], v7 offset:128
    ds_read_b128 v[108:111], v7 offset:192
    ds_read_b128 v[112:115], v7 offset:256
    ds_read_b128 v[116:119], v7 offset:320
    ds_read_b128 v[120:123], v7 offset:384
    ds_read_b128 v[124:127], v7 offset:448
    ds_read_b128 v[128:131], v7 offset:512
    ds_read_b128 v[132:135], v7 offset:576
    ds_read_b128 v[136:139], v7 offset:640
    ds_read_b128 v[140:143], v7 offset:704
    v_mov_b32 v18, s92
    v_mov_b32 v19, s93
    s_waitcnt lgkmcnt(8)
    ds_read_b128 v[144:147], v7 offset:768
    ds_read_b128 v[148:151], v7 offset:832
    ds_read_b128 v[152:155], v7 offset:896
    ds_read_b128 v[156:159], v7 offset:960
    v_mfma_f32_16x16x32_bf16 v[12:15], v[32:35], v[96:99], 0
    v_mfma_f32_16x16x32_bf16 v[12:15], v[36:39], v[100:103], v[12:15]
    v_mfma_f32_16x16x32_bf16 v[12:15], v[40:43], v[104:107], v[12:15]
    v_mfma_f32_16x16x32_bf16 v[12:15], v[44:47], v[108:111], v[12:15]
    s_waitcnt lgkmcnt(11)
    v_mfma_f32_16x16x32_bf16 v[12:15], v[48:51], v[112:115], v[12:15]
    s_waitcnt lgkmcnt(10)
    v_mfma_f32_16x16x32_bf16 v[12:15], v[52:55], v[116:119], v[12:15]
    s_waitcnt lgkmcnt(9)
    v_mfma_f32_16x16x32_bf16 v[12:15], v[56:59], v[120:123], v[12:15]
    s_waitcnt lgkmcnt(8)
    v_mfma_f32_16x16x32_bf16 v[12:15], v[60:63], v[124:127], v[12:15]
    s_waitcnt lgkmcnt(7)
    v_mfma_f32_16x16x32_bf16 v[12:15], v[64:67], v[128:131], v[12:15]
    s_waitcnt lgkmcnt(6)
    v_mfma_f32_16x16x32_bf16 v[12:15], v[68:71], v[132:135], v[12:15]
    s_waitcnt lgkmcnt(5)
    v_mfma_f32_16x16x32_bf16 v[12:15], v[72:75], v[136:139], v[12:15]
    s_waitcnt lgkmcnt(4)
    v_mfma_f32_16x16x32_bf16 v[12:15], v[76:79], v[140:143], v[12:15]
    s_waitcnt lgkmcnt(3)
    v_mfma_f32_16x16x32_bf16 v[12:15], v[80:83], v[144:147], v[12:15]
    s_waitcnt lgkmcnt(2)
    v_mfma_f32_16x16x32_bf16 v[12:15], v[84:87], v[148:151], v[12:15]
    s_waitcnt lgkmcnt(1)
    v_mfma_f32_16x16x32_bf16 v[12:15], v[88:91], v[152:155], v[12:15]
    s_waitcnt lgkmcnt(0)
    v_mfma_f32_16x16x32_bf16 v[12:15], v[92:95], v[156:159], v[12:15]
    s_nop 7
    v_cvt_pk_bf16_f32 v16, v12, v13
    v_cvt_pk_bf16_f32 v17, v14, v15
    s_mov_b64 exec, s[84:85]
    s_cmp_eq_u32 s101, 0
    s_cbranch_scc1 SU_142
    buffer_store_dwordx4 v[16:19], v10, s[36:39], 0 offen
SV_143:
    s_mov_b64 exec, -1
    s_branch L_RED
L_BATT:
    s_and_b32 s60, s4, 7
    s_lshl_b32 s60, s60, 3
    s_lshr_b32 s7, s4, 3
    s_lshl_b32 s7, s7, 1
    s_add_u32 s60, s60, s7
    s_add_u32 s60, s60, s5
    s_sub_u32 s60, s60, 6
    s_lshr_b32 s61, s6, 1
    s_and_b32 s62, s6, 1
    s_mov_b32 s64, 0x3e0293ee
    v_lshlrev_b32 v4, 10, v3
    v_lshl_add_u32 v4, v2, 8, v4
    v_lshl_add_u32 v0, v3, 4, v4
    s_lshl_b32 s7, s62, 14
    s_add_u32 s7, s7, 0x1c000
    v_add_u32 v0, s7, v0
    v_and_b32 v162, 3, v1
    v_lshl_add_u32 v4, v162, 6, v4
    v_bfe_u32 v162, v1, 2, 2
    v_lshl_add_u32 v4, v162, 4, v4
    s_lshl_b32 s7, s6, 7
    s_add_u32 s7, s7, 0x24400
    v_lshl_add_u32 v5, v3, 3, s7
    s_lshl_b32 s7, s61, 10
    s_lshl_b32 s63, s62, 8
    s_add_u32 s7, s7, s63
    s_add_u32 s7, s7, 0x26000
    v_lshl_add_u32 v6, v3, 4, s7
    v_lshrrev_b32 v163, 5, v1
    v_lshl_add_u32 v6, v163, 9, v6
    v_and_b32 v162, 1, v2
    v_lshl_add_u32 v6, v162, 3, v6
    v_lshlrev_b32 v7, 4, v1
    v_add_u32 v7, 0x26000, v7
    v_and_b32 v162, 31, v1
    v_lshlrev_b32 v8, 3, v162
    v_add_u32 v8, 0x24400, v8
    v_bfe_u32 v162, v1, 2, 2
    v_lshl_add_u32 v164, v163, 3, v162
    v_lshlrev_b32 v164, 10, v164
    v_and_b32 v165, 1, v1
    v_lshl_add_u32 v164, v165, 3, v164
    s_lshl_b32 s7, s61, 8
    v_add_u32 v164, s7, v164
    v_bfe_u32 v165, v1, 4, 1
    v_lshlrev_b32 v165, 1, v165
    v_bfe_u32 v160, v1, 1, 1
    v_or_b32 v165, v165, v160
    s_lshl_b32 s7, s62, 3
    v_or_b32 v165, s7, v165
    v_lshlrev_b32 v162, 2, v162
    v_xor_b32 v165, v165, v162
    v_lshlrev_b32 v163, 1, v163
    v_xor_b32 v165, v165, v163
    v_xor_b32 v160, 0, v165
    v_lshl_add_u32 v9, v160, 4, v164
    v_xor_b32 v160, 4, v165
    v_lshl_add_u32 v10, v160, 4, v164
    v_xor_b32 v160, 1, v165
    v_lshl_add_u32 v11, v160, 4, v164
    v_add_u32 v11, 0x1000, v11
    v_xor_b32 v160, 5, v165
    v_lshl_add_u32 v12, v160, 4, v164
    v_add_u32 v12, 0x1000, v12
    v_mov_b32 v13, 0xff800000
    s_mov_b64 s[84:85], 0xffff
    s_lshl_b32 s7, s60, 15
    s_lshl_b32 s63, s6, 12
    s_add_u32 s7, s7, s63
    s_add_u32 s7, s7, 0x600000
    v_lshl_add_u32 v152, v1, 4, s7
    buffer_store_dwordx4 v[0:3], v152, s[36:39], 0 offen offset:0
    buffer_store_dwordx4 v[0:3], v152, s[36:39], 0 offen offset:1024
    buffer_store_dwordx4 v[0:3], v152, s[36:39], 0 offen offset:2048
    buffer_store_dwordx4 v[0:3], v152, s[36:39], 0 offen offset:3072
    s_lshl_b32 s7, s6, 9
    s_add_u32 s7, s7, 0x20000
    v_and_b32 v144, 1, v1
    v_lshl_add_u32 v144, v144, 3, s7
    v_lshrrev_b32 v145, 1, v1
    v_lshl_add_u32 v144, v145, 7, v144
    s_lshr_b32 s7, s60, 4
    s_lshl_b32 s7, s7, 15
    s_add_u32 s7, s7, s63
    v_lshl_add_u32 v145, v1, 4, s7
    s_and_b32 s7, s6, 3
    s_lshl_b32 s7, s7, 6
    v_lshlrev_b32 v146, 4, v1
    v_xor_b32 v146, s7, v146
    s_add_u32 s7, s63, 0x1c000
    v_add_u32 v146, s7, v146
    v_xor_b32 v147, 0x10, v146
    v_xor_b32 v148, 0x20, v146
    v_xor_b32 v149, 0x30, v146
    s_lshl_b32 s66, s61, 4
    s_add_u32 s66, s66, 16
    s_mov_b32 s70, 64
    s_mov_b32 s71, 0x800080
    s_lshl_b32 s67, s61, 2
    s_or_b32 s67, s67, 0x40000
    s_mov_b32 s72, 0x6543210
    s_mov_b32 s73, 0x65487321
    s_mov_b32 s69, 4
    s_lshr_b32 s7, s60, 3
    s_lshl_b32 s7, s7, 7
    s_add_u32 s7, s7, 0x22000
    v_lshl_add_u32 v153, v1, 3, s7
    v_mov_b32 v160, 0x24000
    s_mov_b32 s80, 1600000
LW_144:
    ds_read_b32 v161, v160
    s_waitcnt lgkmcnt(0)
    v_readfirstlane_b32 s79, v161
    s_cmp_ge_u32 s79, 48
    s_cbranch_scc1 LWD_145
    s_sleep 2
    s_sub_u32 s80, s80, 1
    s_cmp_lg_u32 s80, 0
    s_cbranch_scc1 LW_144
LWD_145:
    s_mov_b64 exec, 0xff
    buffer_load_dwordx2 v[16:17], v144, s[36:39], 0 offen sc1
    buffer_load_dwordx2 v[18:19], v153, s[36:39], 0 offen sc1 nt
    s_mov_b64 exec, -1
    s_lshl_b32 s7, s61, 14
    v_add_u32 v14, s7, v4
    v_mov_b32 v160, 0x24000
    s_mov_b32 s80, 1600000
LW_149:
    ds_read_b32 v161, v160
    s_waitcnt lgkmcnt(0)
    v_readfirstlane_b32 s79, v161
    s_cmp_ge_u32 s79, 64
    s_cbranch_scc1 LWD_150
    s_sleep 2
    s_sub_u32 s80, s80, 1
    s_cmp_lg_u32 s80, 0
    s_cbranch_scc1 LW_149
LWD_150:
    v_xor_b32 v160, 0x0, v14
    ds_read_b128 v[32:35], v160
    v_xor_b32 v161, 0x10, v14
    ds_read_b128 v[36:39], v161
    v_xor_b32 v160, 0x20, v14
    ds_read_b128 v[40:43], v160
    v_xor_b32 v161, 0x30, v14
    ds_read_b128 v[44:47], v161
    v_xor_b32 v160, 0x40, v14
    ds_read_b128 v[48:51], v160
    v_xor_b32 v161, 0x50, v14
    ds_read_b128 v[52:55], v161
    v_xor_b32 v160, 0x60, v14
    ds_read_b128 v[56:59], v160
    v_xor_b32 v161, 0x70, v14
    ds_read_b128 v[60:63], v161
    v_xor_b32 v160, 0x80, v14
    ds_read_b128 v[64:67], v160
    v_xor_b32 v161, 0x90, v14
    ds_read_b128 v[68:71], v161
    v_xor_b32 v160, 0xa0, v14
    ds_read_b128 v[72:75], v160
    v_xor_b32 v161, 0xb0, v14
    ds_read_b128 v[76:79], v161
    v_xor_b32 v160, 0xc0, v14
    ds_read_b128 v[80:83], v160
    v_xor_b32 v161, 0xd0, v14
    ds_read_b128 v[84:87], v161
    v_xor_b32 v160, 0xe0, v14
    ds_read_b128 v[88:91], v160
    v_xor_b32 v161, 0xf0, v14
    ds_read_b128 v[92:95], v161
    s_bfe_u32 s7, s72, 0x40000
    s_lshl_b32 s7, s7, 14
    v_add_u32 v20, s7, v9
    v_add_u32 v21, s7, v10
    v_add_u32 v22, s7, v11
    v_add_u32 v23, s7, v12
    ds_read_b64_tr_b16 v[96:97], v20
    ds_read_b64_tr_b16 v[98:99], v22
    ds_read_b64_tr_b16 v[100:101], v21
    ds_read_b64_tr_b16 v[102:103], v23
    s_bfe_u32 s7, s72, 0x40004
    s_lshl_b32 s7, s7, 14
    v_add_u32 v24, s7, v9
    v_add_u32 v25, s7, v10
    v_add_u32 v26, s7, v11
    v_add_u32 v27, s7, v12
    ds_read_b64_tr_b16 v[104:105], v24
    ds_read_b64_tr_b16 v[106:107], v26
    ds_read_b64_tr_b16 v[108:109], v25
    ds_read_b64_tr_b16 v[110:111], v27
    s_bfe_u32 s7, s72, 0x40008
    s_lshl_b32 s7, s7, 14
    v_add_u32 v28, s7, v9
    v_add_u32 v29, s7, v10
    v_add_u32 v30, s7, v11
    v_add_u32 v31, s7, v12
    ds_read_b64_tr_b16 v[112:113], v28
    ds_read_b64_tr_b16 v[114:115], v30
    ds_read_b64_tr_b16 v[116:117], v29
    ds_read_b64_tr_b16 v[118:119], v31
    s_bfe_u32 s7, s72, 0x4000c
    s_lshl_b32 s7, s7, 14
    v_add_u32 v20, s7, v9
    v_add_u32 v21, s7, v10
    v_add_u32 v22, s7, v11
    v_add_u32 v23, s7, v12
    ds_read_b64_tr_b16 v[120:121], v20
    ds_read_b64_tr_b16 v[122:123], v22
    ds_read_b64_tr_b16 v[124:125], v21
    ds_read_b64_tr_b16 v[126:127], v23
    v_mov_b32 v162, 0x24100
    v_mov_b32 v163, 1
    s_mov_b64 exec, 1
    ds_add_u32 v162, v163
    s_mov_b64 exec, -1
    v_mov_b32 v160, 0x24204
    s_mov_b32 s80, 1600000
LW_151:
    ds_read_b32 v161, v160
    s_waitcnt lgkmcnt(0)
    v_readfirstlane_b32 s79, v161
    s_cmp_ge_u32 s79, 1
    s_cbranch_scc1 LWD_152
    s_sleep 1
    s_sub_u32 s80, s80, 1
    s_cmp_lg_u32 s80, 0
    s_cbranch_scc1 LW_151
LWD_152:
    v_mov_b32 v160, 0x24248
    ds_read_b64 v[162:163], v160
    s_waitcnt lgkmcnt(0)
    v_readfirstlane_b32 s92, v162
    v_readfirstlane_b32 s93, v163
    s_mov_b32 s80, 200000
MC_147:
    s_mov_b64 exec, 0xff
    s_waitcnt vmcnt(0)
    v_cmp_ne_u64 s[44:45], s[92:93], v[16:17]
    s_cmp_lg_u64 s[44:45], 0
    s_cbranch_scc1 M_146
MD_148:
    s_mov_b64 exec, -1
    s_or_b32 s95, s95, s78
    s_add_u32 s88, s94, 0x10000
    s_addc_u32 s89, s95, 0
    s_mov_b32 s101, 4
    s_mov_b64 exec, 0xff
    s_branch UU_154
U_153:
    buffer_load_dwordx2 v[18:19], v153, s[36:39], 0 offen sc1 nt
UU_154:
    s_waitcnt vmcnt(0)
    v_cmp_gt_u64 s[90:91], s[94:95], v[18:19]
    v_cmp_le_u64 vcc, s[88:89], v[18:19]
    s_or_b64 vcc, vcc, s[90:91]
    s_cbranch_scc0 UD_155
    s_sleep 8
    s_sub_u32 s101, s101, 1
    s_cmp_lg_u32 s101, 0
    s_cbranch_scc1 U_153
UD_155:
    s_mov_b64 exec, -1
    s_cmp_ge_u32 s6, 4
    s_cbranch_scc1 XC_156
    s_and_b32 s7, s60, 7
    s_lshl_b32 s7, s7, 2
    s_add_u32 s7, s7, s6
    s_lshl_b32 s7, s7, 3
    s_lshr_b32 s65, s60, 3
    s_add_u32 s7, s7, s65
    s_lshl_b32 s7, s7, 7
    s_add_u32 s7, s7, 0x30010
    v_mov_b32 v160, s7
    s_waitcnt vmcnt(0)
    s_mov_b64 exec, 1
    buffer_store_dwordx2 v[162:163], v160, s[36:39], 0 offen sc1
    s_mov_b64 exec, -1
XC_156:
    v_mov_b32 v160, 0x24000
    s_mov_b32 s80, 1600000
LW_157:
    ds_read_b32 v161, v160
    s_waitcnt lgkmcnt(0)
    v_readfirstlane_b32 s79, v161
    s_cmp_ge_u32 s79, 120
    s_cbranch_scc1 LWD_158
    s_sleep 1
    s_sub_u32 s80, s80, 1
    s_cmp_lg_u32 s80, 0
    s_cbranch_scc1 LW_157
LWD_158:
    s_mov_b64 exec, -1
    buffer_load_dwordx4 v[128:131], v145, s[36:39], 0 offen offset:0 sc1
    buffer_load_dwordx4 v[132:135], v145, s[36:39], 0 offen offset:1024 sc1
    buffer_load_dwordx4 v[136:139], v145, s[36:39], 0 offen offset:2048 sc1
    buffer_load_dwordx4 v[140:143], v145, s[36:39], 0 offen offset:3072 sc1
    s_mov_b32 s80, 200000
MC_160:
    s_mov_b64 exec, -1
    s_waitcnt vmcnt(0)
    v_max3_u32 v160, v128, v129, v130
    v_max_u32 v160, v160, v131
    v_cmp_eq_u32 s[44:45], -1, v160
    v_max3_u32 v161, v132, v133, v134
    v_max_u32 v161, v161, v135
    v_cmp_eq_u32 s[46:47], -1, v161
    v_max3_u32 v162, v136, v137, v138
    v_max_u32 v162, v162, v139
    v_cmp_eq_u32 s[48:49], -1, v162
    v_max3_u32 v163, v140, v141, v142
    v_max_u32 v163, v163, v143
    v_cmp_eq_u32 s[50:51], -1, v163
    s_or_b64 s[90:91], s[44:45], s[46:47]
    s_or_b64 s[90:91], s[90:91], s[48:49]
    s_or_b64 s[90:91], s[90:91], s[50:51]
    s_cbranch_scc1 M_159
MD_161:
    s_mov_b64 exec, -1
    v_mov_b32 v160, 0x24108
    v_mov_b32 v161, 1
    s_mov_b64 exec, 1
    ds_add_u32 v160, v161
    s_mov_b64 exec, -1
    ds_write_b128 v146, v[128:131] offset:0
    ds_write_b128 v147, v[132:135] offset:1024
    ds_write_b128 v148, v[136:139] offset:2048
    ds_write_b128 v149, v[140:143] offset:3072
    v_xor_b32 v20, 0x0, v0
    v_xor_b32 v21, 0x10, v0
    v_xor_b32 v22, 0x20, v0
    v_xor_b32 v23, 0x30, v0
    v_xor_b32 v24, 0x40, v0
    v_xor_b32 v25, 0x50, v0
    v_xor_b32 v26, 0x60, v0
    v_xor_b32 v27, 0x70, v0
    v_mov_b32 v0, 0x24000
    s_add_u32 s81, s81, 8
    v_mov_b32 v162, 0x2420c
    v_mov_b32 v163, 1
    s_mov_b64 exec, 1
    ds_add_u32 v162, v163
    s_mov_b64 exec, -1
    v_mov_b32 v162, 0x2420c
    s_mov_b32 s80, 1600000
LW_162:
    ds_read_b32 v163, v162
    s_waitcnt lgkmcnt(0)
    v_readfirstlane_b32 s79, v163
    s_cmp_ge_u32 s79, s81
    s_cbranch_scc1 LWD_163
    s_sub_u32 s80, s80, 1
    s_cmp_lg_u32 s80, 0
    s_cbranch_scc1 LW_162
LWD_163:
    ds_read_b128 v[128:131], v20
    ds_read_b128 v[132:135], v21
    ds_read_b128 v[136:139], v22
    ds_read_b128 v[140:143], v23
    ds_read_b128 v[144:147], v24
    ds_read_b128 v[148:151], v25
    ds_read_b128 v[152:155], v26
    ds_read_b128 v[156:159], v27
    v_xor_b32 v20, 0x80, v20
    v_xor_b32 v21, 0x80, v21
    v_xor_b32 v22, 0x80, v22
    v_xor_b32 v23, 0x80, v23
    v_xor_b32 v24, 0x80, v24
    v_xor_b32 v25, 0x80, v25
    v_xor_b32 v26, 0x80, v26
    v_xor_b32 v27, 0x80, v27
    s_waitcnt lgkmcnt(7)
    v_mfma_f32_16x16x32_bf16 v[16:19], v[32:35], v[128:131], 0
    v_pk_mov_b32 v[32:33], v[128:129], v[128:129] op_sel:[0,1]
    v_pk_mov_b32 v[34:35], v[130:131], v[130:131] op_sel:[0,1]
    ds_read_b128 v[128:131], v20
    s_waitcnt lgkmcnt(7)
    v_mfma_f32_16x16x32_bf16 v[16:19], v[36:39], v[132:135], v[16:19]
    v_pk_mov_b32 v[36:37], v[132:133], v[132:133] op_sel:[0,1]
    v_pk_mov_b32 v[38:39], v[134:135], v[134:135] op_sel:[0,1]
    ds_read_b128 v[132:135], v21
    s_waitcnt lgkmcnt(7)
    v_mfma_f32_16x16x32_bf16 v[16:19], v[40:43], v[136:139], v[16:19]
    v_pk_mov_b32 v[40:41], v[136:137], v[136:137] op_sel:[0,1]
    v_pk_mov_b32 v[42:43], v[138:139], v[138:139] op_sel:[0,1]
    ds_read_b128 v[136:139], v22
    s_waitcnt lgkmcnt(7)
    v_mfma_f32_16x16x32_bf16 v[16:19], v[44:47], v[140:143], v[16:19]
    v_pk_mov_b32 v[44:45], v[140:141], v[140:141] op_sel:[0,1]
    v_pk_mov_b32 v[46:47], v[142:143], v[142:143] op_sel:[0,1]
    ds_read_b128 v[140:143], v23
    s_waitcnt lgkmcnt(7)
    v_mfma_f32_16x16x32_bf16 v[16:19], v[48:51], v[144:147], v[16:19]
    v_pk_mov_b32 v[48:49], v[144:145], v[144:145] op_sel:[0,1]
    v_pk_mov_b32 v[50:51], v[146:147], v[146:147] op_sel:[0,1]
    ds_read_b128 v[144:147], v24
    s_waitcnt lgkmcnt(7)
    v_mfma_f32_16x16x32_bf16 v[16:19], v[52:55], v[148:151], v[16:19]
    v_pk_mov_b32 v[52:53], v[148:149], v[148:149] op_sel:[0,1]
    v_pk_mov_b32 v[54:55], v[150:151], v[150:151] op_sel:[0,1]
    ds_read_b128 v[148:151], v25
    s_waitcnt lgkmcnt(7)
    v_mfma_f32_16x16x32_bf16 v[16:19], v[56:59], v[152:155], v[16:19]
    v_pk_mov_b32 v[56:57], v[152:153], v[152:153] op_sel:[0,1]
    v_pk_mov_b32 v[58:59], v[154:155], v[154:155] op_sel:[0,1]
    ds_read_b128 v[152:155], v26
    s_waitcnt lgkmcnt(7)
    v_mfma_f32_16x16x32_bf16 v[16:19], v[60:63], v[156:159], v[16:19]
    v_pk_mov_b32 v[60:61], v[156:157], v[156:157] op_sel:[0,1]
    v_pk_mov_b32 v[62:63], v[158:159], v[158:159] op_sel:[0,1]
    ds_read_b128 v[156:159], v27
    s_waitcnt lgkmcnt(7)
    v_mfma_f32_16x16x32_bf16 v[16:19], v[64:67], v[128:131], v[16:19]
    v_pk_mov_b32 v[64:65], v[128:129], v[128:129] op_sel:[0,1]
    v_pk_mov_b32 v[66:67], v[130:131], v[130:131] op_sel:[0,1]
    v_pk_mov_b32 v[128:129], 0, 0
    v_pk_mov_b32 v[130:131], 0, 0
    s_waitcnt lgkmcnt(6)
    v_mfma_f32_16x16x32_bf16 v[16:19], v[68:71], v[132:135], v[16:19]
    v_pk_mov_b32 v[68:69], v[132:133], v[132:133] op_sel:[0,1]
    v_pk_mov_b32 v[70:71], v[134:135], v[134:135] op_sel:[0,1]
    v_pk_mov_b32 v[132:133], 0, 0
    v_pk_mov_b32 v[134:135], 0, 0
    s_waitcnt lgkmcnt(5)
    v_mfma_f32_16x16x32_bf16 v[16:19], v[72:75], v[136:139], v[16:19]
    v_pk_mov_b32 v[72:73], v[136:137], v[136:137] op_sel:[0,1]
    v_pk_mov_b32 v[74:75], v[138:139], v[138:139] op_sel:[0,1]
    v_pk_mov_b32 v[136:137], 0, 0
    v_pk_mov_b32 v[138:139], 0, 0
    s_waitcnt lgkmcnt(4)
    v_mfma_f32_16x16x32_bf16 v[16:19], v[76:79], v[140:143], v[16:19]
    v_pk_mov_b32 v[76:77], v[140:141], v[140:141] op_sel:[0,1]
    v_pk_mov_b32 v[78:79], v[142:143], v[142:143] op_sel:[0,1]
    v_pk_mov_b32 v[140:141], 0, 0
    v_pk_mov_b32 v[142:143], 0, 0
    s_waitcnt lgkmcnt(3)
    v_mfma_f32_16x16x32_bf16 v[16:19], v[80:83], v[144:147], v[16:19]
    v_pk_mov_b32 v[80:81], v[144:145], v[144:145] op_sel:[0,1]
    v_pk_mov_b32 v[82:83], v[146:147], v[146:147] op_sel:[0,1]
    v_pk_mov_b32 v[144:145], 0, 0
    v_pk_mov_b32 v[146:147], 0, 0
    s_waitcnt lgkmcnt(2)
    v_mfma_f32_16x16x32_bf16 v[16:19], v[84:87], v[148:151], v[16:19]
    v_pk_mov_b32 v[84:85], v[148:149], v[148:149] op_sel:[0,1]
    v_pk_mov_b32 v[86:87], v[150:151], v[150:151] op_sel:[0,1]
    v_pk_mov_b32 v[148:149], 0, 0
    v_pk_mov_b32 v[150:151], 0, 0
    s_waitcnt lgkmcnt(1)
    v_mfma_f32_16x16x32_bf16 v[16:19], v[88:91], v[152:155], v[16:19]
    v_pk_mov_b32 v[88:89], v[152:153], v[152:153] op_sel:[0,1]
    v_pk_mov_b32 v[90:91], v[154:155], v[154:155] op_sel:[0,1]
    v_pk_mov_b32 v[152:153], 0, 0
    v_pk_mov_b32 v[154:155], 0, 0
    s_waitcnt lgkmcnt(0)
    v_mfma_f32_16x16x32_bf16 v[16:19], v[92:95], v[156:159], v[16:19]
    v_pk_mov_b32 v[92:93], v[156:157], v[156:157] op_sel:[0,1]
    v_pk_mov_b32 v[94:95], v[158:159], v[158:159] op_sel:[0,1]
    v_pk_mov_b32 v[156:157], 0, 0
    v_pk_mov_b32 v[158:159], 0, 0
    v_mov_b32 v162, 0x24104
    v_mov_b32 v163, 1
    s_mov_b64 exec, 1
    ds_add_u32 v162, v163
    s_mov_b64 exec, -1
    s_branch BM_164
BS_165:
    s_bfe_u32 s7, s72, s67
    s_lshl_b32 s7, s7, 14
    v_add_u32 v20, s7, v4
    v_xor_b32 v21, 0x10, v20
    v_xor_b32 v22, 0x20, v20
    v_xor_b32 v23, 0x30, v20
    v_xor_b32 v24, 0x40, v20
    v_xor_b32 v25, 0x50, v20
    v_xor_b32 v26, 0x60, v20
    v_xor_b32 v27, 0x70, v20
    v_readfirstlane_b32 s79, v15
    s_cmp_ge_u32 s79, s66
    s_cbranch_scc1 BK_166
    v_mov_b32 v162, 0x24000
    s_mov_b32 s80, 1600000
LW_167:
    ds_read_b32 v163, v162
    s_waitcnt lgkmcnt(0)
    v_readfirstlane_b32 s79, v163
    s_cmp_ge_u32 s79, s66
    s_cbranch_scc1 LWD_168
    s_sleep 1
    s_sub_u32 s80, s80, 1
    s_cmp_lg_u32 s80, 0
    s_cbranch_scc1 LW_167
LWD_168:
BK_166:
    ds_read_b128 v[96:99], v20
    ds_read_b128 v[100:103], v21
    ds_read_b128 v[104:107], v22
    ds_read_b128 v[108:111], v23
    ds_read_b128 v[112:115], v24
    ds_read_b128 v[116:119], v25
    ds_read_b128 v[120:123], v26
    ds_read_b128 v[124:127], v27
    v_xor_b32 v20, 0x80, v20
    v_xor_b32 v21, 0x80, v21
    v_xor_b32 v22, 0x80, v22
    v_xor_b32 v23, 0x80, v23
    v_xor_b32 v24, 0x80, v24
    v_xor_b32 v25, 0x80, v25
    v_xor_b32 v26, 0x80, v26
    v_xor_b32 v27, 0x80, v27
    s_waitcnt lgkmcnt(7)
    v_mfma_f32_16x16x32_bf16 v[16:19], v[96:99], v[32:35], 0
    ds_read_b128 v[96:99], v20
    s_waitcnt lgkmcnt(7)
    v_mfma_f32_16x16x32_bf16 v[16:19], v[100:103], v[36:39], v[16:19]
    ds_read_b128 v[100:103], v21
    s_waitcnt lgkmcnt(7)
    v_mfma_f32_16x16x32_bf16 v[16:19], v[104:107], v[40:43], v[16:19]
    ds_read_b128 v[104:107], v22
    s_waitcnt lgkmcnt(7)
    v_mfma_f32_16x16x32_bf16 v[16:19], v[108:111], v[44:47], v[16:19]
    ds_read_b128 v[108:111], v23
    s_waitcnt lgkmcnt(7)
    v_mfma_f32_16x16x32_bf16 v[16:19], v[112:115], v[48:51], v[16:19]
    ds_read_b128 v[112:115], v24
    s_waitcnt lgkmcnt(7)
    v_mfma_f32_16x16x32_bf16 v[16:19], v[116:119], v[52:55], v[16:19]
    ds_read_b128 v[116:119], v25
    s_waitcnt lgkmcnt(7)
    v_mfma_f32_16x16x32_bf16 v[16:19], v[120:123], v[56:59], v[16:19]
    ds_read_b128 v[120:123], v26
    s_waitcnt lgkmcnt(7)
    v_mfma_f32_16x16x32_bf16 v[16:19], v[124:127], v[60:63], v[16:19]
    ds_read_b128 v[124:127], v27
    s_waitcnt lgkmcnt(7)
    v_mfma_f32_16x16x32_bf16 v[16:19], v[96:99], v[64:67], v[16:19]
    s_waitcnt lgkmcnt(6)
    v_mfma_f32_16x16x32_bf16 v[16:19], v[100:103], v[68:71], v[16:19]
    s_bfe_u32 s7, s72, 0x40000
    s_lshl_b32 s7, s7, 14
    v_add_u32 v20, s7, v9
    v_add_u32 v21, s7, v10
    v_add_u32 v22, s7, v11
    v_add_u32 v23, s7, v12
    s_waitcnt lgkmcnt(5)
    v_mfma_f32_16x16x32_bf16 v[16:19], v[104:107], v[72:75], v[16:19]
    s_waitcnt lgkmcnt(4)
    v_mfma_f32_16x16x32_bf16 v[16:19], v[108:111], v[76:79], v[16:19]
    s_bfe_u32 s7, s72, 0x40004
    s_lshl_b32 s7, s7, 14
    v_add_u32 v24, s7, v9
    v_add_u32 v25, s7, v10
    v_add_u32 v26, s7, v11
    v_add_u32 v27, s7, v12
    s_waitcnt lgkmcnt(3)
    v_mfma_f32_16x16x32_bf16 v[16:19], v[112:115], v[80:83], v[16:19]
    s_waitcnt lgkmcnt(2)
    v_mfma_f32_16x16x32_bf16 v[16:19], v[116:119], v[84:87], v[16:19]
    s_bfe_u32 s7, s72, 0x40008
    s_lshl_b32 s7, s7, 14
    v_add_u32 v28, s7, v9
    v_add_u32 v29, s7, v10
    v_add_u32 v30, s7, v11
    v_add_u32 v31, s7, v12
    s_waitcnt lgkmcnt(1)
    v_mfma_f32_16x16x32_bf16 v[16:19], v[120:123], v[88:91], v[16:19]
    s_waitcnt lgkmcnt(0)
    v_mfma_f32_16x16x32_bf16 v[16:19], v[124:127], v[92:95], v[16:19]
    s_cmp_ge_u32 s79, s70
    s_cbranch_scc1 BA_169
    v_mov_b32 v162, 0x24000
    s_mov_b32 s80, 1600000
LW_170:
    ds_read_b32 v163, v162
    s_waitcnt lgkmcnt(0)
    v_readfirstlane_b32 s79, v163
    s_cmp_ge_u32 s79, s70
    s_cbranch_scc1 LWD_171
    s_sleep 1
    s_sub_u32 s80, s80, 1
    s_cmp_lg_u32 s80, 0
    s_cbranch_scc1 LW_170
LWD_171:
BA_169:
    ds_read_b64_tr_b16 v[96:97], v20
    ds_read_b64_tr_b16 v[98:99], v22
    ds_read_b64_tr_b16 v[100:101], v21
    ds_read_b64_tr_b16 v[102:103], v23
    ds_read_b64_tr_b16 v[104:105], v24
    ds_read_b64_tr_b16 v[106:107], v26
    ds_read_b64_tr_b16 v[108:109], v25
    ds_read_b64_tr_b16 v[110:111], v27
    ds_read_b64_tr_b16 v[112:113], v28
    ds_read_b64_tr_b16 v[114:115], v30
    ds_read_b64_tr_b16 v[116:117], v29
    ds_read_b64_tr_b16 v[118:119], v31
    s_bfe_u32 s7, s72, 0x4000c
    s_lshl_b32 s7, s7, 14
    v_add_u32 v20, s7, v9
    v_add_u32 v21, s7, v10
    v_add_u32 v22, s7, v11
    v_add_u32 v23, s7, v12
    ds_read_b64_tr_b16 v[120:121], v20
    ds_read_b64_tr_b16 v[122:123], v22
    ds_read_b64_tr_b16 v[124:125], v21
    ds_read_b64_tr_b16 v[126:127], v23
    v_mov_b32 v162, 0x24100
    v_mov_b32 v163, 1
    s_mov_b64 exec, 1
    ds_add_u32 v162, v163
    s_mov_b64 exec, -1
BM_164:
    v_max3_f32 v160, v16, v17, v18
    v_max_f32 v160, v160, v19
    v_mov_b32 v161, v160
    s_nop 1
    v_permlane32_swap_b32 v160, v161
    v_max_f32 v160, v160, v161
    v_mov_b32 v161, v160
    s_nop 1
    v_permlane16_swap_b32 v160, v161
    v_max_f32 v160, v160, v161
    v_mul_f32 v160, s64, v160
    v_ceil_f32 v160, v160
    v_fma_f32 v16, v16, s64, -v160
    v_fma_f32 v17, v17, s64, -v160
    v_fma_f32 v18, v18, s64, -v160
    v_fma_f32 v19, v19, s64, -v160
    v_exp_f32 v16, v16
    v_exp_f32 v17, v17
    v_exp_f32 v18, v18
    v_exp_f32 v19, v19
    v_cvt_pk_bf16_f32 v162, v16, v17
    v_cvt_pk_bf16_f32 v163, v18, v19
    ds_write_b64 v6, v[162:163]
    s_mov_b64 exec, s[84:85]
    ds_write_b32 v5, v160
    s_add_u32 s81, s81, 8
    v_mov_b32 v164, 0x2420c
    v_mov_b32 v165, 1
    s_mov_b64 exec, 1
    ds_add_u32 v164, v165
    s_mov_b64 exec, -1
    v_add_f32 v16, v16, v17
    v_add_f32 v18, v18, v19
    v_add_f32 v161, v16, v18
    v_mov_b32 v16, v161
    s_nop 1
    v_permlane32_swap_b32 v161, v16
    v_add_f32 v161, v161, v16
    v_mov_b32 v16, v161
    s_nop 1
    v_permlane16_swap_b32 v161, v16
    v_add_f32 v161, v161, v16
    s_mov_b64 exec, s[84:85]
    ds_write_b32 v5, v161 offset:4
    s_mov_b64 exec, 1
    ds_add_u32 v164, v165 offset:4
    s_mov_b64 exec, -1
    v_mov_b32 v164, 0x2420c
    s_mov_b32 s80, 1600000
LW_172:
    ds_read_b32 v165, v164
    s_waitcnt lgkmcnt(0)
    v_readfirstlane_b32 s79, v165
    s_cmp_ge_u32 s79, s81
    s_cbranch_scc1 LWD_173
    s_sub_u32 s80, s80, 1
    s_cmp_lg_u32 s80, 0
    s_cbranch_scc1 LW_172
LWD_173:
    ds_read_b32 v160, v8 offset:0
    ds_read_b32 v161, v8 offset:256
    ds_read_b32 v162, v8 offset:512
    ds_read_b32 v163, v8 offset:768
    ds_read_b32 v15, v0
    ds_read_b128 v[16:19], v7 offset:0
    ds_read_b128 v[20:23], v7 offset:1024
    ds_read_b128 v[24:27], v7 offset:2048
    ds_read_b128 v[28:31], v7 offset:3072
    v_xor_b32 v6, 0x1000, v6
    v_xor_b32 v7, 0x1000, v7
    v_add_u32 v5, 1024, v5
    v_add_u32 v8, 1024, v8
    s_waitcnt lgkmcnt(5)
    v_max3_f32 v14, v13, v160, v161
    v_max3_f32 v14, v14, v162, v163
    v_cmp_neq_f32 vcc, v14, v13
    v_sub_f32 v160, v14, v160
    v_sub_f32 v161, v14, v161
    v_sub_f32 v162, v14, v162
    v_sub_f32 v163, v14, v163
    v_cvt_u32_f32 v160, v160
    v_cvt_u32_f32 v161, v161
    v_cvt_u32_f32 v162, v162
    v_cvt_u32_f32 v163, v163
    v_min_u32 v160, 0xff, v160
    v_min_u32 v161, 0xff, v161
    v_min_u32 v162, 0xff, v162
    v_min_u32 v163, 0xff, v163
    v_mul_u32_u24 v160, s71, v160
    v_mul_u32_u24 v161, s71, v161
    v_mul_u32_u24 v162, s71, v162
    v_mul_u32_u24 v163, s71, v163
    s_cbranch_vccz BR_174
    v_sub_f32 v164, v13, v14
    v_exp_f32 v164, v164
    v_mov_b32 v13, v14
    v_pk_mul_f32 v[128:129], v[128:129], v[164:165] op_sel_hi:[1,0]
    v_pk_mul_f32 v[130:131], v[130:131], v[164:165] op_sel_hi:[1,0]
    v_pk_mul_f32 v[132:133], v[132:133], v[164:165] op_sel_hi:[1,0]
    v_pk_mul_f32 v[134:135], v[134:135], v[164:165] op_sel_hi:[1,0]
    v_pk_mul_f32 v[136:137], v[136:137], v[164:165] op_sel_hi:[1,0]
    v_pk_mul_f32 v[138:139], v[138:139], v[164:165] op_sel_hi:[1,0]
    v_pk_mul_f32 v[140:141], v[140:141], v[164:165] op_sel_hi:[1,0]
    v_pk_mul_f32 v[142:143], v[142:143], v[164:165] op_sel_hi:[1,0]
    v_pk_mul_f32 v[144:145], v[144:145], v[164:165] op_sel_hi:[1,0]
    v_pk_mul_f32 v[146:147], v[146:147], v[164:165] op_sel_hi:[1,0]
    v_pk_mul_f32 v[148:149], v[148:149], v[164:165] op_sel_hi:[1,0]
    v_pk_mul_f32 v[150:151], v[150:151], v[164:165] op_sel_hi:[1,0]
    v_pk_mul_f32 v[152:153], v[152:153], v[164:165] op_sel_hi:[1,0]
    v_pk_mul_f32 v[154:155], v[154:155], v[164:165] op_sel_hi:[1,0]
    v_pk_mul_f32 v[156:157], v[156:157], v[164:165] op_sel_hi:[1,0]
    v_pk_mul_f32 v[158:159], v[158:159], v[164:165] op_sel_hi:[1,0]
BR_174:
    s_waitcnt lgkmcnt(3)
    v_pk_sub_u16 v16, v16, v160 clamp
    v_pk_sub_u16 v17, v17, v160 clamp
    v_pk_sub_u16 v18, v18, v160 clamp
    v_pk_sub_u16 v19, v19, v160 clamp
    s_nop 1
    v_mfma_f32_32x32x16_bf16 v[128:143], v[96:99], v[16:19], v[128:143]
    v_mfma_f32_32x32x16_bf16 v[144:159], v[100:103], v[16:19], v[144:159]
    s_waitcnt lgkmcnt(2)
    v_pk_sub_u16 v20, v20, v161 clamp
    v_pk_sub_u16 v21, v21, v161 clamp
    v_pk_sub_u16 v22, v22, v161 clamp
    v_pk_sub_u16 v23, v23, v161 clamp
    s_nop 1
    v_mfma_f32_32x32x16_bf16 v[128:143], v[104:107], v[20:23], v[128:143]
    v_mfma_f32_32x32x16_bf16 v[144:159], v[108:111], v[20:23], v[144:159]
    s_waitcnt lgkmcnt(1)
    v_pk_sub_u16 v24, v24, v162 clamp
    v_pk_sub_u16 v25, v25, v162 clamp
    v_pk_sub_u16 v26, v26, v162 clamp
    v_pk_sub_u16 v27, v27, v162 clamp
    s_nop 1
    v_mfma_f32_32x32x16_bf16 v[128:143], v[112:115], v[24:27], v[128:143]
    v_mfma_f32_32x32x16_bf16 v[144:159], v[116:119], v[24:27], v[144:159]
    s_waitcnt lgkmcnt(0)
    v_pk_sub_u16 v28, v28, v163 clamp
    v_pk_sub_u16 v29, v29, v163 clamp
    v_pk_sub_u16 v30, v30, v163 clamp
    v_pk_sub_u16 v31, v31, v163 clamp
    s_nop 1
    v_mfma_f32_32x32x16_bf16 v[128:143], v[120:123], v[28:31], v[128:143]
    v_mfma_f32_32x32x16_bf16 v[144:159], v[124:127], v[28:31], v[144:159]
    s_lshr_b64 s[72:73], s[72:73], 16
    s_add_u32 s66, s66, 64
    s_add_u32 s70, s70, 64
    s_sub_u32 s69, s69, 1
    s_cmp_lg_u32 s69, 0
    s_cbranch_scc1 BS_165
    s_lshr_b32 s67, s60, 3
    s_and_b32 s68, s60, 7
    s_lshl_b32 s7, s60, 15
    s_lshl_b32 s63, s6, 12
    s_add_u32 s7, s7, s63
    s_add_u32 s7, s7, 0x600000
    v_lshl_add_u32 v5, v1, 4, s7
    v_mov_b32 v38, s92
    v_mov_b32 v39, s93
    s_cmp_lg_u32 s6, 7
    s_cbranch_scc1 B7_175
    v_lshrrev_b32 v45, 5, v1
    v_lshl_add_u32 v45, v45, 11, v8
    v_add_u32 v45, -4096, v45
    v_mov_b32 v46, 0x24210
    s_mov_b32 s80, 1600000
LW_176:
    ds_read_b32 v47, v46
    s_waitcnt lgkmcnt(0)
    v_readfirstlane_b32 s79, v47
    s_cmp_ge_u32 s79, 32
    s_cbranch_scc1 LWD_177
    s_sub_u32 s80, s80, 1
    s_cmp_lg_u32 s80, 0
    s_cbranch_scc1 LW_176
LWD_177:
    ds_read_b64 v[48:49], v45 offset:0
    ds_read_b64 v[50:51], v45 offset:256
    ds_read_b64 v[52:53], v45 offset:512
    ds_read_b64 v[54:55], v45 offset:768
    ds_read_b64 v[56:57], v45 offset:1024
    ds_read_b64 v[58:59], v45 offset:1280
    ds_read_b64 v[60:61], v45 offset:1536
    ds_read_b64 v[62:63], v45 offset:1792
    s_lshl_b32 s7, s60, 9
    s_add_u32 s7, s7, 0x28000
    v_lshl_add_u32 v44, v1, 4, s7
    v_mov_b32 v36, v13
    s_waitcnt lgkmcnt(0)
    v_sub_f32 v48, v48, v36
    v_sub_f32 v50, v50, v36
    v_sub_f32 v52, v52, v36
    v_sub_f32 v54, v54, v36
    v_sub_f32 v56, v56, v36
    v_sub_f32 v58, v58, v36
    v_sub_f32 v60, v60, v36
    v_sub_f32 v62, v62, v36
    v_exp_f32 v48, v48
    v_exp_f32 v50, v50
    v_exp_f32 v52, v52
    v_exp_f32 v54, v54
    v_exp_f32 v56, v56
    v_exp_f32 v58, v58
    v_exp_f32 v60, v60
    v_exp_f32 v62, v62
    v_mul_f32 v37, v48, v49
    v_fmac_f32 v37, v50, v51
    v_fmac_f32 v37, v52, v53
    v_fmac_f32 v37, v54, v55
    v_fmac_f32 v37, v56, v57
    v_fmac_f32 v37, v58, v59
    v_fmac_f32 v37, v60, v61
    v_fmac_f32 v37, v62, v63
    v_mov_b32 v48, v37
    s_nop 1
    v_permlane32_swap_b32 v37, v48
    v_add_f32 v37, v37, v48
    s_mov_b64 exec, 0xffffffff
    s_cmp_eq_u32 s101, 0
    s_cbranch_scc1 SU_178
    buffer_store_dwordx4 v[36:39], v44, s[36:39], 0 offen
SV_179:
    s_mov_b64 exec, -1
B7_175:
    v_permlane32_swap_b32 v128, v132
    v_permlane32_swap_b32 v129, v133
    v_permlane32_swap_b32 v130, v134
    v_permlane32_swap_b32 v131, v135
    v_cvt_pk_bf16_f32 v16, v128, v129
    v_cvt_pk_bf16_f32 v17, v130, v131
    v_cvt_pk_bf16_f32 v18, v132, v133
    v_cvt_pk_bf16_f32 v19, v134, v135
    v_permlane32_swap_b32 v136, v140
    v_permlane32_swap_b32 v137, v141
    v_permlane32_swap_b32 v138, v142
    v_permlane32_swap_b32 v139, v143
    v_cvt_pk_bf16_f32 v20, v136, v137
    v_cvt_pk_bf16_f32 v21, v138, v139
    v_cvt_pk_bf16_f32 v22, v140, v141
    v_cvt_pk_bf16_f32 v23, v142, v143
    v_permlane32_swap_b32 v144, v148
    v_permlane32_swap_b32 v145, v149
    v_permlane32_swap_b32 v146, v150
    v_permlane32_swap_b32 v147, v151
    v_cvt_pk_bf16_f32 v24, v144, v145
    v_cvt_pk_bf16_f32 v25, v146, v147
    v_cvt_pk_bf16_f32 v26, v148, v149
    v_cvt_pk_bf16_f32 v27, v150, v151
    v_permlane32_swap_b32 v152, v156
    v_permlane32_swap_b32 v153, v157
    v_permlane32_swap_b32 v154, v158
    v_permlane32_swap_b32 v155, v159
    v_cvt_pk_bf16_f32 v28, v152, v153
    v_cvt_pk_bf16_f32 v29, v154, v155
    v_cvt_pk_bf16_f32 v30, v156, v157
    v_cvt_pk_bf16_f32 v31, v158, v159
    s_lshl_b32 s7, s67, 9
    s_lshl_b32 s65, s6, 6
    s_add_u32 s7, s7, s65
    s_add_u32 s7, s7, 0x23000
    v_and_b32 v160, 7, v1
    v_lshl_add_u32 v7, v160, 3, s7
    s_lshl_b64 s[88:89], 1, s68
    s_cmp_eq_u32 s101, 0
    s_cbranch_scc1 SU_180
    buffer_store_dwordx4 v[16:19], v5, s[36:39], 0 offen offset:0
    buffer_store_dwordx4 v[20:23], v5, s[36:39], 0 offen offset:1024
    buffer_store_dwordx4 v[24:27], v5, s[36:39], 0 offen offset:2048
    buffer_store_dwordx4 v[28:31], v5, s[36:39], 0 offen offset:3072
    s_waitcnt vmcnt(0)
    s_mov_b64 exec, s[88:89]
    buffer_store_dwordx2 v[38:39], v7, s[36:39], 0 offen
    s_mov_b64 exec, -1
SV_181:
    s_lshl_b32 s7, s67, 18
    s_add_u32 s7, s7, s63
    s_lshl_b32 s65, s68, 6
    s_add_u32 s7, s7, s65
    s_add_u32 s7, s7, 0x600000
    v_and_b32 v160, 3, v1
    v_lshl_add_u32 v5, v160, 4, s7
    v_bfe_u32 v161, v1, 2, 3
    v_lshl_add_u32 v5, v161, 9, v5
    v_lshrrev_b32 v162, 5, v1
    v_lshl_add_u32 v5, v162, 15, v5
    s_lshl_b32 s7, s67, 12
    s_add_u32 s7, s7, s65
    s_add_u32 s7, s7, 0x28000
    v_lshl_add_u32 v6, v160, 4, s7
    v_lshl_add_u32 v6, v162, 9, v6
    s_lshl_b32 s7, s68, 15
    s_lshl_b32 s63, s67, 10
    s_add_u32 s7, s7, s63
    s_lshl_b32 s63, s6, 7
    s_add_u32 s7, s7, s63
    s_add_u32 s7, s7, 0x200000
    v_lshl_add_u32 v8, v160, 13, s7
    v_lshl_add_u32 v8, v161, 4, v8
    v_lshl_add_u32 v8, v162, 3, v8
    s_lshl_b32 s7, s67, 7
    s_lshl_b32 s63, s68, 12
    s_add_u32 s7, s7, s63
    s_add_u32 s7, s7, 0x30000
    v_lshl_add_u32 v9, v160, 10, s7
    s_mov_b64 exec, 0xff
    buffer_load_dwordx2 v[40:41], v7, s[36:39], 0 offen sc1 nt
    s_mov_b32 s80, 200000
MC_183:
    s_mov_b64 exec, 0xff
    s_waitcnt vmcnt(0)
    v_cmp_ne_u64 s[86:87], s[92:93], v[40:41]
    s_cmp_lg_u64 s[86:87], 0
    s_cbranch_scc1 M_182
MD_184:
    s_mov_b64 exec, -1
    buffer_load_dwordx4 v[64:67], v6, s[36:39], 0 offen offset:0 sc1 nt
    buffer_load_dwordx4 v[68:71], v6, s[36:39], 0 offen offset:1024 sc1 nt
    buffer_load_dwordx4 v[72:75], v6, s[36:39], 0 offen offset:2048 sc1 nt
    buffer_load_dwordx4 v[76:79], v6, s[36:39], 0 offen offset:3072 sc1 nt
    s_mov_b32 s63, 0
    buffer_load_dwordx4 v[48:51], v5, s[36:39], s63 offen sc1 nt
    s_add_u32 s63, s63, 65536
    buffer_load_dwordx4 v[52:55], v5, s[36:39], s63 offen sc1 nt
    s_add_u32 s63, s63, 65536
    buffer_load_dwordx4 v[56:59], v5, s[36:39], s63 offen sc1 nt
    s_add_u32 s63, s63, 65536
    buffer_load_dwordx4 v[60:63], v5, s[36:39], s63 offen sc1 nt
    s_add_u32 s63, s63, 65536
    s_waitcnt vmcnt(4)
    v_cmp_ne_u64 s[90:91], s[92:93], v[66:67]
    v_cmp_ne_u64 vcc, s[92:93], v[70:71]
    s_or_b64 s[90:91], s[90:91], vcc
    v_cmp_ne_u64 vcc, s[92:93], v[74:75]
    s_or_b64 s[90:91], s[90:91], vcc
    v_cmp_ne_u64 vcc, s[92:93], v[78:79]
    s_or_b64 s[90:91], s[90:91], vcc
    s_cmp_lg_u64 s[90:91], 0
    s_cbranch_scc1 BL_185
BLD_186:
    v_max3_f32 v36, v64, v68, v72
    v_max_f32 v36, v36, v76
    v_mov_b32 v37, v36
    s_nop 1
    v_permlane32_swap_b32 v36, v37
    v_max_f32 v36, v36, v37
    v_sub_f32 v80, v64, v36
    v_sub_f32 v81, v68, v36
    v_sub_f32 v82, v72, v36
    v_sub_f32 v83, v76, v36
    v_exp_f32 v80, v80
    v_exp_f32 v81, v81
    v_exp_f32 v82, v82
    v_exp_f32 v83, v83
    v_mul_f32 v37, v80, v65
    v_fmac_f32 v37, v81, v69
    v_fmac_f32 v37, v82, v73
    v_fmac_f32 v37, v83, v77
    v_mov_b32 v40, v37
    s_nop 1
    v_permlane32_swap_b32 v37, v40
    v_add_f32 v37, v37, v40
    s_waitcnt vmcnt(3)
    v_lshlrev_b32 v88, 16, v48
    v_and_b32 v89, 0xffff0000, v48
    v_lshlrev_b32 v90, 16, v49
    v_and_b32 v91, 0xffff0000, v49
    v_lshlrev_b32 v92, 16, v50
    v_and_b32 v93, 0xffff0000, v50
    v_lshlrev_b32 v94, 16, v51
    v_and_b32 v95, 0xffff0000, v51
    v_mul_f32 v16, v88, v80
    v_mul_f32 v17, v89, v80
    v_mul_f32 v18, v90, v80
    v_mul_f32 v19, v91, v80
    v_mul_f32 v20, v92, v80
    v_mul_f32 v21, v93, v80
    v_mul_f32 v22, v94, v80
    v_mul_f32 v23, v95, v80
    s_waitcnt vmcnt(2)
    v_lshlrev_b32 v88, 16, v52
    v_and_b32 v89, 0xffff0000, v52
    v_lshlrev_b32 v90, 16, v53
    v_and_b32 v91, 0xffff0000, v53
    v_lshlrev_b32 v92, 16, v54
    v_and_b32 v93, 0xffff0000, v54
    v_lshlrev_b32 v94, 16, v55
    v_and_b32 v95, 0xffff0000, v55
    v_fmac_f32 v16, v88, v81
    v_fmac_f32 v17, v89, v81
    v_fmac_f32 v18, v90, v81
    v_fmac_f32 v19, v91, v81
    v_fmac_f32 v20, v92, v81
    v_fmac_f32 v21, v93, v81
    v_fmac_f32 v22, v94, v81
    v_fmac_f32 v23, v95, v81
    s_waitcnt vmcnt(1)
    v_lshlrev_b32 v88, 16, v56
    v_and_b32 v89, 0xffff0000, v56
    v_lshlrev_b32 v90, 16, v57
    v_and_b32 v91, 0xffff0000, v57
    v_lshlrev_b32 v92, 16, v58
    v_and_b32 v93, 0xffff0000, v58
    v_lshlrev_b32 v94, 16, v59
    v_and_b32 v95, 0xffff0000, v59
    v_fmac_f32 v16, v88, v82
    v_fmac_f32 v17, v89, v82
    v_fmac_f32 v18, v90, v82
    v_fmac_f32 v19, v91, v82
    v_fmac_f32 v20, v92, v82
    v_fmac_f32 v21, v93, v82
    v_fmac_f32 v22, v94, v82
    v_fmac_f32 v23, v95, v82
    s_waitcnt vmcnt(0)
    v_mov_b32 v160, 0x24218
    v_mov_b32 v161, 1
    s_mov_b64 exec, 1
    ds_add_u32 v160, v161
    s_mov_b64 exec, -1
    v_lshlrev_b32 v88, 16, v60
    v_and_b32 v89, 0xffff0000, v60
    v_lshlrev_b32 v90, 16, v61
    v_and_b32 v91, 0xffff0000, v61
    v_lshlrev_b32 v92, 16, v62
    v_and_b32 v93, 0xffff0000, v62
    v_lshlrev_b32 v94, 16, v63
    v_and_b32 v95, 0xffff0000, v63
    v_fmac_f32 v16, v88, v83
    v_fmac_f32 v17, v89, v83
    v_fmac_f32 v18, v90, v83
    v_fmac_f32 v19, v91, v83
    v_fmac_f32 v20, v92, v83
    v_fmac_f32 v21, v93, v83
    v_fmac_f32 v22, v94, v83
    v_fmac_f32 v23, v95, v83
    v_permlane32_swap_b32 v16, v20
    v_permlane32_swap_b32 v17, v21
    v_permlane32_swap_b32 v18, v22
    v_permlane32_swap_b32 v19, v23
    v_add_f32 v16, v16, v20
    v_add_f32 v17, v17, v21
    v_add_f32 v18, v18, v22
    v_add_f32 v19, v19, v23
    v_cvt_pk_bf16_f32 v44, v16, v17
    v_cvt_pk_bf16_f32 v45, v18, v19
    v_mov_b32 v160, 0x24218
    s_mov_b32 s80, 1600000
LW_187:
    ds_read_b32 v161, v160
    s_waitcnt lgkmcnt(0)
    v_readfirstlane_b32 s79, v161
    s_cmp_ge_u32 s79, 8
    s_cbranch_scc1 LWD_188
    s_sub_u32 s80, s80, 1
    s_cmp_lg_u32 s80, 0
    s_cbranch_scc1 LW_187
LWD_188:
    buffer_store_dwordx2 v[44:45], v8, s[36:39], 0 offen sc1
    s_cmp_lg_u32 s6, 0
    s_cbranch_scc1 BM2_189
    s_mov_b64 exec, 15
    buffer_store_dwordx4 v[36:39], v9, s[36:39], 0 offen sc1
    s_mov_b64 exec, -1
BM2_189:
    v_mov_b32 v160, 0x24218
    v_mov_b32 v161, 1
    s_mov_b64 exec, 1
    ds_add_u32 v160, v161
    s_mov_b64 exec, -1
    s_lshl_b32 s7, s67, 13
    s_lshl_b32 s63, s6, 10
    s_add_u32 s7, s7, s63
    s_add_u32 s7, s7, 0xc0000
    v_lshl_add_u32 v4, v1, 4, s7
    v_lshrrev_b32 v160, 2, v3
    v_mul_u32_u24 v5, 1088, v160
    v_and_b32 v160, 3, v1
    v_lshl_add_u32 v5, v160, 4, v5
    v_lshrrev_b32 v161, 5, v1
    v_lshl_add_u32 v5, v161, 6, v5
    v_and_b32 v161, 1, v2
    v_lshl_add_u32 v5, v161, 3, v5
    s_lshl_b32 s7, s6, 7
    s_add_u32 s7, s7, 0x26000
    v_add_u32 v5, s7, v5
    v_mul_u32_u24 v6, 1088, v160
    v_lshl_add_u32 v6, v2, 4, v6
    v_add_u32 v6, 0x26000, v6
    s_lshl_b32 s7, s68, 2
    s_add_u32 s7, s7, s6
    s_lshl_b32 s7, s7, 3
    s_add_u32 s7, s7, s67
    s_lshl_b32 s7, s7, 8
    s_add_u32 s7, s7, 0x2c0000
    v_lshl_add_u32 v7, v160, 6, s7
    v_lshl_add_u32 v7, v2, 4, v7
    v_cmp_gt_u32 s[84:85], 4, v3
    v_bfe_u32 v8, v1, 3, 2
    v_xor_b32 v8, s6, v8
    v_lshlrev_b32 v8, 5, v8
    v_lshrrev_b32 v161, 2, v1
    v_lshl_add_u32 v8, v161, 7, v8
    v_lshl_add_u32 v8, v160, 3, v8
    s_cmp_ge_u32 s6, 4
    s_cbranch_scc1 W4_190
    v_mov_b32 v162, 0x24000
    s_mov_b32 s80, 1600000
LW_191:
    ds_read_b32 v163, v162
    s_waitcnt lgkmcnt(0)
    v_readfirstlane_b32 s79, v163
    s_cmp_ge_u32 s79, 288
    s_cbranch_scc1 LWD_192
    s_sleep 1
    s_sub_u32 s80, s80, 1
    s_cmp_lg_u32 s80, 0
    s_cbranch_scc1 LW_191
LWD_192:
    ds_read_b64_tr_b16 v[48:49], v8 offset:0
    ds_read_b64_tr_b16 v[50:51], v8 offset:2048
    ds_read_b64_tr_b16 v[52:53], v8 offset:4096
    ds_read_b64_tr_b16 v[54:55], v8 offset:6144
    ds_read_b64_tr_b16 v[56:57], v8 offset:8192
    ds_read_b64_tr_b16 v[58:59], v8 offset:10240
    ds_read_b64_tr_b16 v[60:61], v8 offset:12288
    ds_read_b64_tr_b16 v[62:63], v8 offset:14336
    s_waitcnt lgkmcnt(4)
    ds_read_b64_tr_b16 v[64:65], v8 offset:16384
    ds_read_b64_tr_b16 v[66:67], v8 offset:18432
    ds_read_b64_tr_b16 v[68:69], v8 offset:20480
    ds_read_b64_tr_b16 v[70:71], v8 offset:22528
    ds_read_b64_tr_b16 v[72:73], v8 offset:24576
    ds_read_b64_tr_b16 v[74:75], v8 offset:26624
    ds_read_b64_tr_b16 v[76:77], v8 offset:28672
    ds_read_b64_tr_b16 v[78:79], v8 offset:30720
    s_waitcnt lgkmcnt(4)
    v_mov_b32 v162, 0x24000
    s_mov_b32 s80, 1600000
LW_193:
    ds_read_b32 v163, v162
    s_waitcnt lgkmcnt(0)
    v_readfirstlane_b32 s79, v163
    s_cmp_ge_u32 s79, 320
    s_cbranch_scc1 LWD_194
    s_sleep 1
    s_sub_u32 s80, s80, 1
    s_cmp_lg_u32 s80, 0
    s_cbranch_scc1 LW_193
LWD_194:
    ds_read_b64_tr_b16 v[80:81], v8 offset:32768
    ds_read_b64_tr_b16 v[82:83], v8 offset:34816
    ds_read_b64_tr_b16 v[84:85], v8 offset:36864
    ds_read_b64_tr_b16 v[86:87], v8 offset:38912
    ds_read_b64_tr_b16 v[88:89], v8 offset:40960
    ds_read_b64_tr_b16 v[90:91], v8 offset:43008
    ds_read_b64_tr_b16 v[92:93], v8 offset:45056
    ds_read_b64_tr_b16 v[94:95], v8 offset:47104
    s_waitcnt lgkmcnt(4)
    ds_read_b64_tr_b16 v[96:97], v8 offset:49152
    ds_read_b64_tr_b16 v[98:99], v8 offset:51200
    ds_read_b64_tr_b16 v[100:101], v8 offset:53248
    ds_read_b64_tr_b16 v[102:103], v8 offset:55296
    ds_read_b64_tr_b16 v[104:105], v8 offset:57344
    ds_read_b64_tr_b16 v[106:107], v8 offset:59392
    ds_read_b64_tr_b16 v[108:109], v8 offset:61440
    ds_read_b64_tr_b16 v[110:111], v8 offset:63488
    s_waitcnt lgkmcnt(4)
W4_190:
    s_mov_b64 exec, -1
    buffer_load_dwordx4 v[16:19], v4, s[36:39], 0 offen sc1 nt
    s_mov_b32 s80, 200000
MC_196:
    s_mov_b64 exec, -1
    s_waitcnt vmcnt(0)
    v_cmp_ne_u64 s[86:87], s[92:93], v[18:19]
    s_cmp_lg_u64 s[86:87], 0
    s_cbranch_scc1 M_195
MD_197:
    s_mov_b64 exec, -1
    ds_write_b64 v5, v[16:17]
    s_add_u32 s81, s81, 8
    v_mov_b32 v160, 0x2420c
    v_mov_b32 v161, 1
    s_mov_b64 exec, 1
    ds_add_u32 v160, v161
    s_mov_b64 exec, -1
    s_cmp_ge_u32 s6, 4
    s_cbranch_scc1 L_END
    v_mov_b32 v160, 0x2420c
    s_mov_b32 s80, 1600000
LW_198:
    ds_read_b32 v161, v160
    s_waitcnt lgkmcnt(0)
    v_readfirstlane_b32 s79, v161
    s_cmp_ge_u32 s79, s81
    s_cbranch_scc1 LWD_199
    s_sub_u32 s80, s80, 1
    s_cmp_lg_u32 s80, 0
    s_cbranch_scc1 LW_198
LWD_199:
    ds_read_b128 v[112:115], v6 offset:0
    ds_read_b128 v[116:119], v6 offset:64
    ds_read_b128 v[120:123], v6 offset:128
    ds_read_b128 v[124:127], v6 offset:192
    ds_read_b128 v[128:131], v6 offset:256
    ds_read_b128 v[132:135], v6 offset:320
    ds_read_b128 v[136:139], v6 offset:384
    ds_read_b128 v[140:143], v6 offset:448
    ds_read_b128 v[144:147], v6 offset:512
    ds_read_b128 v[148:151], v6 offset:576
    ds_read_b128 v[152:155], v6 offset:640
    ds_read_b128 v[156:159], v6 offset:704
    s_waitcnt lgkmcnt(8)
    ds_read_b128 v[20:23], v6 offset:768
    ds_read_b128 v[24:27], v6 offset:832
    ds_read_b128 v[28:31], v6 offset:896
    ds_read_b128 v[32:35], v6 offset:960
    v_mfma_f32_16x16x32_bf16 v[12:15], v[48:51], v[112:115], 0
    v_mfma_f32_16x16x32_bf16 v[12:15], v[52:55], v[116:119], v[12:15]
    v_mfma_f32_16x16x32_bf16 v[12:15], v[56:59], v[120:123], v[12:15]
    v_mfma_f32_16x16x32_bf16 v[12:15], v[60:63], v[124:127], v[12:15]
    s_waitcnt lgkmcnt(11)
    v_mfma_f32_16x16x32_bf16 v[12:15], v[64:67], v[128:131], v[12:15]
    s_waitcnt lgkmcnt(10)
    v_mfma_f32_16x16x32_bf16 v[12:15], v[68:71], v[132:135], v[12:15]
    s_waitcnt lgkmcnt(9)
    v_mfma_f32_16x16x32_bf16 v[12:15], v[72:75], v[136:139], v[12:15]
    s_waitcnt lgkmcnt(8)
    v_mfma_f32_16x16x32_bf16 v[12:15], v[76:79], v[140:143], v[12:15]
    s_waitcnt lgkmcnt(7)
    v_mfma_f32_16x16x32_bf16 v[12:15], v[80:83], v[144:147], v[12:15]
    s_waitcnt lgkmcnt(6)
    v_mfma_f32_16x16x32_bf16 v[12:15], v[84:87], v[148:151], v[12:15]
    s_waitcnt lgkmcnt(5)
    v_mfma_f32_16x16x32_bf16 v[12:15], v[88:91], v[152:155], v[12:15]
    s_waitcnt lgkmcnt(4)
    v_mfma_f32_16x16x32_bf16 v[12:15], v[92:95], v[156:159], v[12:15]
    s_waitcnt lgkmcnt(3)
    v_mfma_f32_16x16x32_bf16 v[12:15], v[96:99], v[20:23], v[12:15]
    s_waitcnt lgkmcnt(2)
    v_mfma_f32_16x16x32_bf16 v[12:15], v[100:103], v[24:27], v[12:15]
    s_waitcnt lgkmcnt(1)
    v_mfma_f32_16x16x32_bf16 v[12:15], v[104:107], v[28:31], v[12:15]
    s_waitcnt lgkmcnt(0)
    v_mfma_f32_16x16x32_bf16 v[12:15], v[108:111], v[32:35], v[12:15]
    s_nop 7
    v_cvt_pk_bf16_f32 v16, v12, v13
    v_cvt_pk_bf16_f32 v17, v14, v15
    s_mov_b64 exec, s[84:85]
    buffer_store_dwordx4 v[16:19], v7, s[36:39], 0 offen sc1
    s_mov_b64 exec, -1
    v_mov_b32 v160, 0x24214
    v_mov_b32 v161, 1
    s_mov_b64 exec, 1
    ds_add_u32 v160, v161
    s_mov_b64 exec, -1
    s_branch L_RED
SU_9:
    s_nop 3
    buffer_store_dwordx4 v[72:75], v4, s[36:39], 0 offen sc1
    s_branch SV_10
SU_13:
    s_nop 3
    buffer_store_dwordx4 v[64:67], v5, s[36:39], 0 offen sc1
    s_branch SV_14
ST_21:
    ds_read_b32 v18, v17
    s_waitcnt lgkmcnt(0)
    v_readlane_b32 s79, v18, s62
    s_cmp_ge_u32 s79, s63
    s_cbranch_scc1 GO_20
    s_waitcnt vmcnt(24)
    s_sub_u32 s7, s60, 24
    v_mov_b32 v19, s7
    ds_max_i32 v16, v19
    ds_read_b32 v18, v17
    s_waitcnt lgkmcnt(0)
    v_readlane_b32 s79, v18, s62
    s_cmp_ge_u32 s79, s63
    s_cbranch_scc1 GO_20
    s_waitcnt vmcnt(16)
    s_sub_u32 s7, s60, 16
    v_mov_b32 v19, s7
    ds_max_i32 v16, v19
    ds_read_b32 v18, v17
    s_waitcnt lgkmcnt(0)
    v_readlane_b32 s79, v18, s62
    s_cmp_ge_u32 s79, s63
    s_cbranch_scc1 GO_20
    s_waitcnt vmcnt(8)
    s_sub_u32 s7, s60, 8
    v_mov_b32 v19, s7
    ds_max_i32 v16, v19
    ds_read_b32 v18, v17
    s_waitcnt lgkmcnt(0)
    v_readlane_b32 s79, v18, s62
    s_cmp_ge_u32 s79, s63
    s_cbranch_scc1 GO_20
    s_waitcnt vmcnt(0)
    v_mov_b32 v19, s60
    ds_max_i32 v16, v19
    ds_read_b32 v18, v17
    s_waitcnt lgkmcnt(0)
    v_readlane_b32 s79, v18, s62
    s_cmp_ge_u32 s79, s63
    s_cbranch_scc1 GO_20
    s_mov_b32 s80, 1600000
SP_200:
    ds_read_b32 v18, v17
    s_waitcnt lgkmcnt(0)
    v_readlane_b32 s79, v18, s62
    s_cmp_ge_u32 s79, s63
    s_cbranch_scc1 GO_20
    s_sub_u32 s80, s80, 1
    s_cmp_lg_u32 s80, 0
    s_cbranch_scc1 SP_200
    s_branch GO_20
ST_30:
    ds_read_b32 v18, v17
    s_waitcnt lgkmcnt(0)
    v_readlane_b32 s79, v18, s62
    s_cmp_ge_u32 s79, s63
    s_cbranch_scc1 GO_29
    s_waitcnt vmcnt(40)
    s_sub_u32 s7, s60, 40
    v_mov_b32 v19, s7
    ds_max_i32 v16, v19
    ds_read_b32 v18, v17
    s_waitcnt lgkmcnt(0)
    v_readlane_b32 s79, v18, s62
    s_cmp_ge_u32 s79, s63
    s_cbranch_scc1 GO_29
    s_waitcnt vmcnt(32)
    s_sub_u32 s7, s60, 32
    v_mov_b32 v19, s7
    ds_max_i32 v16, v19
    ds_read_b32 v18, v17
    s_waitcnt lgkmcnt(0)
    v_readlane_b32 s79, v18, s62
    s_cmp_ge_u32 s79, s63
    s_cbranch_scc1 GO_29
    s_waitcnt vmcnt(24)
    s_sub_u32 s7, s60, 24
    v_mov_b32 v19, s7
    ds_max_i32 v16, v19
    ds_read_b32 v18, v17
    s_waitcnt lgkmcnt(0)
    v_readlane_b32 s79, v18, s62
    s_cmp_ge_u32 s79, s63
    s_cbranch_scc1 GO_29
    s_waitcnt vmcnt(16)
    s_sub_u32 s7, s60, 16
    v_mov_b32 v19, s7
    ds_max_i32 v16, v19
    ds_read_b32 v18, v17
    s_waitcnt lgkmcnt(0)
    v_readlane_b32 s79, v18, s62
    s_cmp_ge_u32 s79, s63
    s_cbranch_scc1 GO_29
    s_waitcnt vmcnt(8)
    s_sub_u32 s7, s60, 8
    v_mov_b32 v19, s7
    ds_max_i32 v16, v19
    ds_read_b32 v18, v17
    s_waitcnt lgkmcnt(0)
    v_readlane_b32 s79, v18, s62
    s_cmp_ge_u32 s79, s63
    s_cbranch_scc1 GO_29
    s_waitcnt vmcnt(0)
    v_mov_b32 v19, s60
    ds_max_i32 v16, v19
    ds_read_b32 v18, v17
    s_waitcnt lgkmcnt(0)
    v_readlane_b32 s79, v18, s62
    s_cmp_ge_u32 s79, s63
    s_cbranch_scc1 GO_29
    s_mov_b32 s80, 1600000
SP_201:
    ds_read_b32 v18, v17
    s_waitcnt lgkmcnt(0)
    v_readlane_b32 s79, v18, s62
    s_cmp_ge_u32 s79, s63
    s_cbranch_scc1 GO_29
    s_sub_u32 s80, s80, 1
    s_cmp_lg_u32 s80, 0
    s_cbranch_scc1 SP_201
    s_branch GO_29
ST_39:
    ds_read_b32 v18, v17
    s_waitcnt lgkmcnt(0)
    v_readlane_b32 s79, v18, s62
    s_cmp_ge_u32 s79, s63
    s_cbranch_scc1 GO_38
    s_waitcnt vmcnt(40)
    s_sub_u32 s7, s60, 40
    v_mov_b32 v19, s7
    ds_max_i32 v16, v19
    ds_read_b32 v18, v17
    s_waitcnt lgkmcnt(0)
    v_readlane_b32 s79, v18, s62
    s_cmp_ge_u32 s79, s63
    s_cbranch_scc1 GO_38
    s_waitcnt vmcnt(32)
    s_sub_u32 s7, s60, 32
    v_mov_b32 v19, s7
    ds_max_i32 v16, v19
    ds_read_b32 v18, v17
    s_waitcnt lgkmcnt(0)
    v_readlane_b32 s79, v18, s62
    s_cmp_ge_u32 s79, s63
    s_cbranch_scc1 GO_38
    s_waitcnt vmcnt(24)
    s_sub_u32 s7, s60, 24
    v_mov_b32 v19, s7
    ds_max_i32 v16, v19
    ds_read_b32 v18, v17
    s_waitcnt lgkmcnt(0)
    v_readlane_b32 s79, v18, s62
    s_cmp_ge_u32 s79, s63
    s_cbranch_scc1 GO_38
    s_waitcnt vmcnt(16)
    s_sub_u32 s7, s60, 16
    v_mov_b32 v19, s7
    ds_max_i32 v16, v19
    ds_read_b32 v18, v17
    s_waitcnt lgkmcnt(0)
    v_readlane_b32 s79, v18, s62
    s_cmp_ge_u32 s79, s63
    s_cbranch_scc1 GO_38
    s_waitcnt vmcnt(8)
    s_sub_u32 s7, s60, 8
    v_mov_b32 v19, s7
    ds_max_i32 v16, v19
    ds_read_b32 v18, v17
    s_waitcnt lgkmcnt(0)
    v_readlane_b32 s79, v18, s62
    s_cmp_ge_u32 s79, s63
    s_cbranch_scc1 GO_38
    s_waitcnt vmcnt(0)
    v_mov_b32 v19, s60
    ds_max_i32 v16, v19
    ds_read_b32 v18, v17
    s_waitcnt lgkmcnt(0)
    v_readlane_b32 s79, v18, s62
    s_cmp_ge_u32 s79, s63
    s_cbranch_scc1 GO_38
    s_mov_b32 s80, 1600000
SP_202:
    ds_read_b32 v18, v17
    s_waitcnt lgkmcnt(0)
    v_readlane_b32 s79, v18, s62
    s_cmp_ge_u32 s79, s63
    s_cbranch_scc1 GO_38
    s_sub_u32 s80, s80, 1
    s_cmp_lg_u32 s80, 0
    s_cbranch_scc1 SP_202
    s_branch GO_38
ST_50:
    ds_read_b32 v18, v17
    s_waitcnt lgkmcnt(0)
    v_readlane_b32 s79, v18, s62
    s_cmp_ge_u32 s79, s63
    s_cbranch_scc1 GO_49
    s_waitcnt vmcnt(16)
    s_sub_u32 s7, s60, 16
    v_mov_b32 v19, s7
    ds_max_i32 v16, v19
    ds_read_b32 v18, v17
    s_waitcnt lgkmcnt(0)
    v_readlane_b32 s79, v18, s62
    s_cmp_ge_u32 s79, s63
    s_cbranch_scc1 GO_49
    s_waitcnt vmcnt(8)
    s_sub_u32 s7, s60, 8
    v_mov_b32 v19, s7
    ds_max_i32 v16, v19
    ds_read_b32 v18, v17
    s_waitcnt lgkmcnt(0)
    v_readlane_b32 s79, v18, s62
    s_cmp_ge_u32 s79, s63
    s_cbranch_scc1 GO_49
    s_waitcnt vmcnt(0)
    v_mov_b32 v19, s60
    ds_max_i32 v16, v19
    ds_read_b32 v18, v17
    s_waitcnt lgkmcnt(0)
    v_readlane_b32 s79, v18, s62
    s_cmp_ge_u32 s79, s63
    s_cbranch_scc1 GO_49
    s_mov_b32 s80, 1600000
SP_203:
    ds_read_b32 v18, v17
    s_waitcnt lgkmcnt(0)
    v_readlane_b32 s79, v18, s62
    s_cmp_ge_u32 s79, s63
    s_cbranch_scc1 GO_49
    s_sub_u32 s80, s80, 1
    s_cmp_lg_u32 s80, 0
    s_cbranch_scc1 SP_203
    s_branch GO_49
ST_53:
    ds_read_b32 v18, v17
    s_waitcnt lgkmcnt(0)
    v_readlane_b32 s79, v18, s62
    s_cmp_ge_u32 s79, s63
    s_cbranch_scc1 GO_52
    s_waitcnt vmcnt(24)
    s_sub_u32 s7, s60, 24
    v_mov_b32 v19, s7
    ds_max_i32 v16, v19
    ds_read_b32 v18, v17
    s_waitcnt lgkmcnt(0)
    v_readlane_b32 s79, v18, s62
    s_cmp_ge_u32 s79, s63
    s_cbranch_scc1 GO_52
    s_waitcnt vmcnt(16)
    s_sub_u32 s7, s60, 16
    v_mov_b32 v19, s7
    ds_max_i32 v16, v19
    ds_read_b32 v18, v17
    s_waitcnt lgkmcnt(0)
    v_readlane_b32 s79, v18, s62
    s_cmp_ge_u32 s79, s63
    s_cbranch_scc1 GO_52
    s_waitcnt vmcnt(8)
    s_sub_u32 s7, s60, 8
    v_mov_b32 v19, s7
    ds_max_i32 v16, v19
    ds_read_b32 v18, v17
    s_waitcnt lgkmcnt(0)
    v_readlane_b32 s79, v18, s62
    s_cmp_ge_u32 s79, s63
    s_cbranch_scc1 GO_52
    s_waitcnt vmcnt(0)
    v_mov_b32 v19, s60
    ds_max_i32 v16, v19
    ds_read_b32 v18, v17
    s_waitcnt lgkmcnt(0)
    v_readlane_b32 s79, v18, s62
    s_cmp_ge_u32 s79, s63
    s_cbranch_scc1 GO_52
    s_mov_b32 s80, 1600000
SP_204:
    ds_read_b32 v18, v17
    s_waitcnt lgkmcnt(0)
    v_readlane_b32 s79, v18, s62
    s_cmp_ge_u32 s79, s63
    s_cbranch_scc1 GO_52
    s_sub_u32 s80, s80, 1
    s_cmp_lg_u32 s80, 0
    s_cbranch_scc1 SP_204
    s_branch GO_52
ST_55:
    ds_read_b32 v18, v17
    s_waitcnt lgkmcnt(0)
    v_readlane_b32 s79, v18, 0
    s_cmp_ge_u32 s79, s63
    s_cbranch_scc1 GO_54
    s_waitcnt vmcnt(24)
    s_sub_u32 s7, s60, 24
    v_mov_b32 v19, s7
    ds_max_i32 v16, v19
    ds_read_b32 v18, v17
    s_waitcnt lgkmcnt(0)
    v_readlane_b32 s79, v18, 0
    s_cmp_ge_u32 s79, s63
    s_cbranch_scc1 GO_54
    s_waitcnt vmcnt(16)
    s_sub_u32 s7, s60, 16
    v_mov_b32 v19, s7
    ds_max_i32 v16, v19
    ds_read_b32 v18, v17
    s_waitcnt lgkmcnt(0)
    v_readlane_b32 s79, v18, 0
    s_cmp_ge_u32 s79, s63
    s_cbranch_scc1 GO_54
    s_waitcnt vmcnt(8)
    s_sub_u32 s7, s60, 8
    v_mov_b32 v19, s7
    ds_max_i32 v16, v19
    ds_read_b32 v18, v17
    s_waitcnt lgkmcnt(0)
    v_readlane_b32 s79, v18, 0
    s_cmp_ge_u32 s79, s63
    s_cbranch_scc1 GO_54
    s_waitcnt vmcnt(0)
    v_mov_b32 v19, s60
    ds_max_i32 v16, v19
    ds_read_b32 v18, v17
    s_waitcnt lgkmcnt(0)
    v_readlane_b32 s79, v18, 0
    s_cmp_ge_u32 s79, s63
    s_cbranch_scc1 GO_54
    s_mov_b32 s80, 1600000
SP_205:
    ds_read_b32 v18, v17
    s_waitcnt lgkmcnt(0)
    v_readlane_b32 s79, v18, 0
    s_cmp_ge_u32 s79, s63
    s_cbranch_scc1 GO_54
    s_sub_u32 s80, s80, 1
    s_cmp_lg_u32 s80, 0
    s_cbranch_scc1 SP_205
    s_branch GO_54
M_59:
    s_sub_u32 s80, s80, 1
    s_cmp_le_u32 s80, 0
    s_cbranch_scc1 MD_61
    s_mov_b64 exec, s[62:63]
    s_cbranch_execz RS_206
    buffer_load_dwordx4 v[48:51], v36, s[36:39], 0 offen offset:0 sc1
RS_206:
    s_mov_b64 exec, s[64:65]
    s_cbranch_execz RS_207
    buffer_load_dwordx4 v[52:55], v36, s[36:39], 0 offen offset:1024 sc1
RS_207:
    s_mov_b64 exec, s[66:67]
    s_cbranch_execz RS_208
    buffer_load_dwordx4 v[56:59], v36, s[36:39], 0 offen offset:2048 sc1
RS_208:
    s_mov_b64 exec, s[68:69]
    s_cbranch_execz RS_209
    buffer_load_dwordx4 v[60:63], v36, s[36:39], 0 offen offset:3072 sc1
RS_209:
    s_branch MC_60
M_62:
    s_sub_u32 s80, s80, 1
    s_cmp_le_u32 s80, 0
    s_cbranch_scc1 MD_64
    s_mov_b64 exec, s[62:63]
    s_cbranch_execz RS_210
    buffer_load_dwordx4 v[48:51], v36, s[36:39], 0 offen offset:0 sc1
RS_210:
    s_mov_b64 exec, s[64:65]
    s_cbranch_execz RS_211
    buffer_load_dwordx4 v[52:55], v36, s[36:39], 0 offen offset:1024 sc1
RS_211:
    s_branch MC_63
M_84:
    s_sleep 4
    s_sub_u32 s80, s80, 1
    s_cmp_le_u32 s80, 0
    s_cbranch_scc1 MD_86
    s_mov_b64 exec, s[44:45]
    s_cbranch_execz RS_212
    buffer_load_dwordx4 v[48:51], v7, s[36:39], 0 offen sc1 nt
RS_212:
    s_mov_b64 exec, s[46:47]
    s_cbranch_execz RS_213
    buffer_load_dwordx4 v[52:55], v22, s[36:39], 0 offen sc1 nt
RS_213:
    s_branch MC_85
SU_92:
    s_nop 3
    buffer_store_dwordx4 v[64:67], v8, s[36:39], 0 offen sc1
    s_branch SV_93
AW_96:
    s_mov_b64 exec, 0x3f
    s_cmp_eq_u32 s71, 1
    s_cbranch_scc1 AX_214
    buffer_load_dwordx4 v[116:119], v12, s[36:39], 0 offen sc1 nt
    s_mov_b64 exec, -1
    s_branch AWB_97
AX_214:
    s_mov_b32 s80, 200000
    s_branch PP_216
P_215:
    buffer_load_dwordx4 v[116:119], v12, s[36:39], 0 offen sc1 nt
PP_216:
    s_waitcnt vmcnt(0)
    v_cmp_ne_u64 s[90:91], s[92:93], v[118:119]
    s_cmp_lg_u64 s[90:91], 0
    s_cbranch_scc0 PD_217
    s_sleep 2
    s_sub_u32 s80, s80, 1
    s_cmp_lg_u32 s80, 0
    s_cbranch_scc1 P_215
PD_217:
    s_mov_b64 exec, -1
    v_mov_b32 v118, v116
    s_nop 1
    v_max_f32_dpp v118, v118, v118 row_ror:1 row_mask:0xf bank_mask:0xf
    s_nop 1
    v_max_f32_dpp v118, v118, v118 row_ror:2 row_mask:0xf bank_mask:0xf
    s_nop 1
    v_max_f32_dpp v118, v118, v118 row_ror:4 row_mask:0xf bank_mask:0xf
    s_nop 1
    v_max_f32_dpp v118, v118, v118 row_ror:8 row_mask:0xf bank_mask:0xf
    v_sub_f32 v116, v116, v118
    v_sub_f32 v119, v64, v118
    v_exp_f32 v116, v116
    v_exp_f32 v119, v119
    v_mul_f32 v116, v116, v117
    s_nop 1
    v_add_f32_dpp v116, v116, v116 row_ror:1 row_mask:0xf bank_mask:0xf
    s_nop 1
    v_add_f32_dpp v116, v116, v116 row_ror:2 row_mask:0xf bank_mask:0xf
    s_nop 1
    v_add_f32_dpp v116, v116, v116 row_ror:4 row_mask:0xf bank_mask:0xf
    s_nop 1
    v_add_f32_dpp v116, v116, v116 row_ror:8 row_mask:0xf bank_mask:0xf
    v_rcp_f32 v116, v116
    s_nop 0
    v_mul_f32 v116, v116, v119
    s_nop 0
    v_readfirstlane_b32 s72, v116
    s_branch AWB_97
SU_100:
    s_nop 3
    buffer_store_dwordx4 v[68:71], v6, s[36:39], 0 offen sc1
    s_branch SV_101
M_104:
    s_sub_u32 s80, s80, 1
    s_cmp_le_u32 s80, 0
    s_cbranch_scc1 MD_106
    s_mov_b64 exec, s[64:65]
    s_cbranch_execz RS_218
    buffer_load_dwordx4 v[112:115], v5, s[36:39], 0 offen sc1 nt
RS_218:
    s_mov_b64 exec, s[66:67]
    s_cbranch_execz RS_219
    buffer_load_dwordx4 v[116:119], v5, s[36:39], s62 offen sc1 nt
RS_219:
    s_mov_b64 exec, s[68:69]
    s_cbranch_execz RS_220
    buffer_load_dwordx4 v[120:123], v5, s[36:39], s63 offen sc1 nt
RS_220:
    s_branch MC_105
M_114:
    s_sub_u32 s80, s80, 1
    s_cmp_le_u32 s80, 199994
    s_cbranch_scc1 G2_111
    s_mov_b64 exec, s[44:45]
    s_cbranch_execz RS_221
    buffer_load_dwordx4 v[48:51], v7, s[36:39], 0 offen sc1 nt
RS_221:
    s_mov_b64 exec, s[46:47]
    s_cbranch_execz RS_222
    buffer_load_dwordx4 v[52:55], v22, s[36:39], 0 offen sc1 nt
RS_222:
    s_branch MC_115
G2_111:
    s_mov_b64 exec, -1
    v_mov_b32 v12, 0x24204
    s_mov_b32 s80, 1600000
LW_223:
    ds_read_b32 v13, v12
    s_waitcnt lgkmcnt(0)
    v_readfirstlane_b32 s79, v13
    s_cmp_ge_u32 s79, 1
    s_cbranch_scc1 LWD_224
    s_sleep 1
    s_sub_u32 s80, s80, 1
    s_cmp_lg_u32 s80, 0
    s_cbranch_scc1 LW_223
LWD_224:
    v_mov_b32 v12, 0x24248
    ds_read_b64 v[14:15], v12
    s_waitcnt lgkmcnt(0)
    v_readfirstlane_b32 s92, v14
    v_readfirstlane_b32 s93, v15
    s_mov_b32 s80, 200000
P_225:
    buffer_load_dwordx4 v[48:51], v7, s[36:39], 0 offen sc1 nt
    buffer_load_dwordx4 v[52:55], v22, s[36:39], 0 offen sc1 nt
PP_226:
    s_waitcnt vmcnt(0)
    s_mov_b64 s[90:91], 0
    v_cmp_gt_u64 s[88:89], s[94:95], v[50:51]
    v_cmp_le_u64 vcc, s[72:73], v[50:51]
    s_or_b64 s[88:89], s[88:89], vcc
    v_cmp_ne_u64 vcc, s[92:93], v[50:51]
    s_and_b64 vcc, vcc, s[88:89]
    s_or_b64 s[90:91], s[90:91], vcc
    v_cmp_gt_u64 s[88:89], s[94:95], v[54:55]
    v_cmp_le_u64 vcc, s[72:73], v[54:55]
    s_or_b64 s[88:89], s[88:89], vcc
    v_cmp_ne_u64 vcc, s[92:93], v[54:55]
    s_and_b64 vcc, vcc, s[88:89]
    s_or_b64 s[90:91], s[90:91], vcc
    s_cbranch_scc0 PD_227
    s_sleep 1
    s_sub_u32 s80, s80, 1
    s_cmp_lg_u32 s80, 0
    s_cbranch_scc1 P_225
PD_227:
    s_branch MD_116
M_130:
    s_sleep 8
    s_sub_u32 s80, s80, 1
    s_cmp_le_u32 s80, 0
    s_cbranch_scc1 MD_132
    s_mov_b64 exec, s[64:65]
    s_cbranch_execz RS_228
    buffer_load_dwordx2 v[12:13], v4, s[36:39], 0 offen offset:16 sc1
RS_228:
    s_branch MC_131
M_134:
    s_sleep 6
    s_sub_u32 s80, s80, 1
    s_cmp_le_u32 s80, 0
    s_cbranch_scc1 MD_136
    s_mov_b64 exec, s[64:65]
    s_cbranch_execz RS_229
    buffer_load_dwordx2 v[12:13], v9, s[36:39], 0 offen sc1 nt
RS_229:
    s_branch MC_135
M_137:
    s_sub_u32 s80, s80, 1
    s_cmp_le_u32 s80, 0
    s_cbranch_scc1 MD_139
    s_mov_b64 exec, s[64:65]
    s_cbranch_execz RS_230
    buffer_load_dwordx4 v[16:19], v5, s[36:39], 0 offen offset:0 sc1
RS_230:
    s_mov_b64 exec, s[66:67]
    s_cbranch_execz RS_231
    buffer_load_dwordx4 v[20:23], v5, s[36:39], 0 offen offset:1024 sc1
RS_231:
    s_mov_b64 exec, s[68:69]
    s_cbranch_execz RS_232
    buffer_load_dwordx4 v[12:15], v4, s[36:39], 0 offen sc1
RS_232:
    s_branch MC_138
SU_142:
    s_nop 3
    buffer_store_dwordx4 v[16:19], v10, s[36:39], 0 offen sc1
    s_branch SV_143
M_146:
    s_sleep 2
    s_sub_u32 s80, s80, 1
    s_cmp_le_u32 s80, 0
    s_cbranch_scc1 MD_148
    s_mov_b64 exec, s[44:45]
    s_cbranch_execz RS_233
    buffer_load_dwordx2 v[16:17], v144, s[36:39], 0 offen sc1
RS_233:
    s_branch MC_147
M_159:
    s_sleep 1
    s_sub_u32 s80, s80, 1
    s_cmp_le_u32 s80, 0
    s_cbranch_scc1 MD_161
    s_mov_b64 exec, s[44:45]
    s_cbranch_execz RS_234
    buffer_load_dwordx4 v[128:131], v145, s[36:39], 0 offen offset:0 sc1
RS_234:
    s_mov_b64 exec, s[46:47]
    s_cbranch_execz RS_235
    buffer_load_dwordx4 v[132:135], v145, s[36:39], 0 offen offset:1024 sc1
RS_235:
    s_mov_b64 exec, s[48:49]
    s_cbranch_execz RS_236
    buffer_load_dwordx4 v[136:139], v145, s[36:39], 0 offen offset:2048 sc1
RS_236:
    s_mov_b64 exec, s[50:51]
    s_cbranch_execz RS_237
    buffer_load_dwordx4 v[140:143], v145, s[36:39], 0 offen offset:3072 sc1
RS_237:
    s_branch MC_160
SU_178:
    s_nop 3
    buffer_store_dwordx4 v[36:39], v44, s[36:39], 0 offen sc1
    s_branch SV_179
SU_180:
    s_nop 3
    buffer_store_dwordx4 v[16:19], v5, s[36:39], 0 offen offset:0 sc1
    buffer_store_dwordx4 v[20:23], v5, s[36:39], 0 offen offset:1024 sc1
    buffer_store_dwordx4 v[24:27], v5, s[36:39], 0 offen offset:2048 sc1
    buffer_store_dwordx4 v[28:31], v5, s[36:39], 0 offen offset:3072 sc1
    s_waitcnt vmcnt(0)
    s_mov_b64 exec, s[88:89]
    buffer_store_dwordx2 v[38:39], v7, s[36:39], 0 offen sc1
    s_mov_b64 exec, -1
    s_branch SV_181
M_182:
    s_sub_u32 s80, s80, 1
    s_cmp_le_u32 s80, 0
    s_cbranch_scc1 MD_184
    s_mov_b64 exec, s[86:87]
    s_cbranch_execz RS_238
    buffer_load_dwordx2 v[40:41], v7, s[36:39], 0 offen sc1 nt
RS_238:
    s_branch MC_183
BL_185:
    s_mov_b32 s80, 200000
P_239:
    buffer_load_dwordx4 v[64:67], v6, s[36:39], 0 offen offset:0 sc1 nt
    buffer_load_dwordx4 v[68:71], v6, s[36:39], 0 offen offset:1024 sc1 nt
    buffer_load_dwordx4 v[72:75], v6, s[36:39], 0 offen offset:2048 sc1 nt
    buffer_load_dwordx4 v[76:79], v6, s[36:39], 0 offen offset:3072 sc1 nt
PP_240:
    s_waitcnt vmcnt(0)
    v_cmp_ne_u64 s[90:91], s[92:93], v[66:67]
    v_cmp_ne_u64 vcc, s[92:93], v[70:71]
    s_or_b64 s[90:91], s[90:91], vcc
    v_cmp_ne_u64 vcc, s[92:93], v[74:75]
    s_or_b64 s[90:91], s[90:91], vcc
    v_cmp_ne_u64 vcc, s[92:93], v[78:79]
    s_or_b64 s[90:91], s[90:91], vcc
    s_cmp_lg_u64 s[90:91], 0
    s_cbranch_scc0 PD_241
    s_sub_u32 s80, s80, 1
    s_cmp_lg_u32 s80, 0
    s_cbranch_scc1 P_239
PD_241:
    s_branch BLD_186
M_195:
    s_sleep 1
    s_sub_u32 s80, s80, 1
    s_cmp_le_u32 s80, 0
    s_cbranch_scc1 MD_197
    s_mov_b64 exec, s[86:87]
    s_cbranch_execz RS_242
    buffer_load_dwordx4 v[16:19], v4, s[36:39], 0 offen sc1 nt
RS_242:
    s_branch MC_196
L_END:
    s_endpgm
.section .rodata,"a"
.p2align 6
.amdhsa_kernel concat_heads__sliding_block_cached__compressed_kv_cla__decode_kernel
  .amdhsa_next_free_vgpr 168
  .amdhsa_next_free_sgpr 102
  .amdhsa_accum_offset 168
  .amdhsa_group_segment_fixed_size 0
  .amdhsa_kernarg_size 112
  .amdhsa_user_sgpr_count 2
  .amdhsa_user_sgpr_kernarg_segment_ptr 1
  .amdhsa_system_sgpr_workgroup_id_x 1
  .amdhsa_float_denorm_mode_32 3
.end_amdhsa_kernel
```

```asm
; @launch grid=(256,1,1) block=(576,1,1) lds=163840
.amdgcn_target "amdgcn-amd-amdhsa--gfx950"
.text
.globl concat_heads__sliding_block_cached__compressed_kv_cla__decode_kernel
.p2align 8
.type concat_heads__sliding_block_cached__compressed_kv_cla__decode_kernel,@function
concat_heads__sliding_block_cached__compressed_kv_cla__decode_kernel:
    s_cmp_ge_u32 s2, 256
    s_cbranch_scc1 L_END
    s_load_dwordx16 s[8:23], s[0:1], 0
    s_load_dwordx8 s[24:31], s[0:1], 64
    s_load_dwordx4 s[32:35], s[0:1], 96
    s_memrealtime s[94:95]
    v_lshrrev_b32 v1, 6, v0
    s_nop 0
    v_readfirstlane_b32 s3, v1
    v_and_b32 v1, 63, v0
    v_lshrrev_b32 v2, 4, v1
    v_and_b32 v3, 15, v1
    s_and_b32 s4, s2, 7
    s_lshr_b32 s7, s2, 6
    s_lshl_b32 s7, s7, 3
    s_or_b32 s4, s4, s7
    s_bfe_u32 s5, s2, 0x30003
    s_getreg_b32 s78, hwreg(HW_REG_XCC_ID, 0, 4)
    s_lshl_b32 s78, s78, 26
    s_xor_b32 s6, s3, 4
    s_cmp_eq_u32 s3, 8
    s_cselect_b32 s7, 8, 0
    s_add_u32 s7, s7, s5
    s_cmp_ge_u32 s7, 14
    s_cbranch_scc1 L_LDB
    s_cmp_ge_u32 s7, 12
    s_cbranch_scc1 L_LDE
    s_cmp_ge_u32 s7, 8
    s_cbranch_scc1 L_LDA
    s_mov_b32 s81, 0
    s_cmp_lt_u32 s6, 4
    s_cbranch_scc1 L_SIDE
    s_cmp_ge_u32 s7, 4
    s_cbranch_scc1 L_QABS
    s_and_b32 s61, s6, 3
    v_lshrrev_b32 v10, 1, v3
    v_xor_b32 v10, v10, v2
    v_lshlrev_b32 v10, 5, v10
    v_lshl_add_u32 v10, v2, 13, v10
    v_and_b32 v40, 1, v1
    v_lshl_add_u32 v10, v40, 4, v10
    v_xor_b32 v11, 0x80, v10
    s_lshl_b32 s65, s5, 20
    s_lshl_b32 s7, s4, 8
    s_add_u32 s65, s65, s7
    s_lshl_b32 s7, s61, 18
    s_add_u32 s65, s65, s7
    s_lshl_b32 s64, s61, 13
    s_add_u32 s64, s64, 0x18000
    v_and_b32 v8, 3, v1
    v_lshlrev_b32 v9, 10, v8
    v_lshl_add_u32 v9, v2, 4, v9
    s_lshl_b32 s62, s5, 8
    s_waitcnt lgkmcnt(0)
    s_mov_b32 s48, s22
    s_and_b32 s49, s23, 0xffff
    s_mov_b32 s50, 0x400000
    s_mov_b32 s51, 0x20000
    s_mov_b32 s63, s65
    s_mov_b32 m0, s64
    s_add_u32 s64, s64, 1024
    buffer_load_dwordx4 v10, s[48:51], s63 offen nt lds
    s_add_u32 s63, s63, 32768
    s_mov_b32 m0, s64
    s_add_u32 s64, s64, 1024
    buffer_load_dwordx4 v11, s[48:51], s63 offen nt lds
    s_add_u32 s63, s63, 32768
    s_mov_b32 m0, s64
    s_add_u32 s64, s64, 1024
    buffer_load_dwordx4 v10, s[48:51], s63 offen nt lds
    s_add_u32 s63, s63, 32768
    s_mov_b32 m0, s64
    s_add_u32 s64, s64, 1024
    buffer_load_dwordx4 v11, s[48:51], s63 offen nt lds
    s_add_u32 s63, s63, 32768
    s_mov_b32 m0, s64
    s_add_u32 s64, s64, 1024
    buffer_load_dwordx4 v10, s[48:51], s63 offen nt lds
    s_add_u32 s63, s63, 32768
    s_mov_b32 m0, s64
    s_add_u32 s64, s64, 1024
    buffer_load_dwordx4 v11, s[48:51], s63 offen nt lds
    s_add_u32 s63, s63, 32768
    s_mov_b32 m0, s64
    s_add_u32 s64, s64, 1024
    buffer_load_dwordx4 v10, s[48:51], s63 offen nt lds
    s_add_u32 s63, s63, 32768
    s_mov_b32 m0, s64
    s_add_u32 s64, s64, 1024
    buffer_load_dwordx4 v11, s[48:51], s63 offen nt lds
    s_add_u32 s63, s63, 32768
    s_mov_b32 s44, s18
    s_and_b32 s45, s19, 0xffff
    s_mov_b32 s46, 0x1000
    s_mov_b32 s47, 0x20000
    buffer_load_dwordx4 v[128:131], v9, s[44:47], s62 offen offset:0
    buffer_load_dwordx4 v[132:135], v9, s[44:47], s62 offen offset:64
    buffer_load_dwordx4 v[136:139], v9, s[44:47], s62 offen offset:128
    buffer_load_dwordx4 v[140:143], v9, s[44:47], s62 offen offset:192
    s_barrier
    s_mov_b32 s36, s34
    s_and_b32 s37, s35, 0xffff
    s_mov_b32 s38, 0x1000000
    s_mov_b32 s39, 0x20000
    s_lshl_b32 s7, s4, 4
    s_add_u32 s7, s7, s5
    s_lshl_b32 s7, s7, 4
    s_add_u32 s7, s7, s61
    s_lshl_b32 s7, s7, 7
    s_add_u32 s7, s7, 0x100000
    v_lshl_add_u32 v4, v8, 9, s7
    v_lshl_add_u32 v4, v2, 4, v4
    v_and_b32 v12, 4, v1
    v_lshl_add_u32 v4, v12, 4, v4
    v_add_u32 v5, 16384, v4
    v_mov_b32 v16, 0
    s_mov_b64 exec, 15
    buffer_store_dword v16, v5, s[36:39], 0 offen
    buffer_load_dword v16, v5, s[36:39], 0 offen sc1 nt
    s_mov_b64 exec, -1
    s_sub_u32 s64, s64, 40960
    s_mov_b32 s48, s14
    s_and_b32 s49, s15, 0xffff
    s_mov_b32 s50, 0x400000
    s_mov_b32 s51, 0x20000
    s_mov_b32 s63, s65
    s_mov_b32 s44, s8
    s_and_b32 s45, s9, 0xffff
    s_mov_b32 s46, 0x1000
    s_mov_b32 s47, 0x20000
    buffer_load_dwordx4 v[144:147], v9, s[44:47], s62 offen offset:0
    buffer_load_dwordx4 v[148:151], v9, s[44:47], s62 offen offset:64
    buffer_load_dwordx4 v[152:155], v9, s[44:47], s62 offen offset:128
    buffer_load_dwordx4 v[156:159], v9, s[44:47], s62 offen offset:192
    s_mov_b32 m0, s64
    s_add_u32 s64, s64, 1024
    buffer_load_dwordx4 v10, s[48:51], s63 offen nt lds
    s_add_u32 s63, s63, 32768
    s_mov_b32 m0, s64
    s_add_u32 s64, s64, 1024
    buffer_load_dwordx4 v11, s[48:51], s63 offen nt lds
    s_add_u32 s63, s63, 32768
    v_cmp_gt_u32 s[84:85], 8, v3
    v_bfe_u32 v21, v1, 2, 2
    v_lshl_add_u32 v20, v2, 3, v21
    s_lshl_b32 s7, s61, 1
    v_xor_b32 v21, s7, v21
    v_lshlrev_b32 v20, 8, v20
    v_lshl_add_u32 v20, v21, 5, v20
    v_lshl_add_u32 v20, v8, 3, v20
    v_add_u32 v20, 0x10000, v20
    v_xor_b32 v21, 32, v20
    v_xor_b32 v22, 0x480, v20
    v_xor_b32 v23, 0x4a0, v20
    s_waitcnt vmcnt(8)
    v_mov_b32 v14, 0x24210
    v_mov_b32 v15, 1
    s_mov_b64 exec, 1
    ds_add_u32 v14, v15
    s_mov_b64 exec, -1
    v_mov_b32 v14, 0x24210
    s_mov_b32 s80, 1600000
LW_1:
    ds_read_b32 v15, v14
    s_waitcnt lgkmcnt(0)
    v_readfirstlane_b32 s79, v15
    s_cmp_ge_u32 s79, 4
    s_cbranch_scc1 LWD_2
    s_sub_u32 s80, s80, 1
    s_cmp_lg_u32 s80, 0
    s_cbranch_scc1 LW_1
LWD_2:
    ds_read_b64_tr_b16 v[32:33], v20 offset:32768
    ds_read_b64_tr_b16 v[34:35], v22 offset:32768
    ds_read_b64_tr_b16 v[36:37], v21 offset:32768
    ds_read_b64_tr_b16 v[38:39], v23 offset:32768
    ds_read_b64_tr_b16 v[40:41], v20 offset:40960
    ds_read_b64_tr_b16 v[42:43], v22 offset:40960
    ds_read_b64_tr_b16 v[44:45], v21 offset:40960
    ds_read_b64_tr_b16 v[46:47], v23 offset:40960
    ds_read_b64_tr_b16 v[48:49], v20 offset:49152
    ds_read_b64_tr_b16 v[50:51], v22 offset:49152
    ds_read_b64_tr_b16 v[52:53], v21 offset:49152
    ds_read_b64_tr_b16 v[54:55], v23 offset:49152
    s_waitcnt lgkmcnt(8)
    ds_read_b64_tr_b16 v[56:57], v20 offset:57344
    ds_read_b64_tr_b16 v[58:59], v22 offset:57344
    ds_read_b64_tr_b16 v[60:61], v21 offset:57344
    ds_read_b64_tr_b16 v[62:63], v23 offset:57344
    s_waitcnt lgkmcnt(12)
    v_mfma_f32_16x16x32_bf16 v[24:27], v[32:35], v[128:131], 0
    v_mfma_f32_16x16x32_bf16 v[28:31], v[36:39], v[128:131], 0
    s_waitcnt lgkmcnt(8)
    v_mfma_f32_16x16x32_bf16 v[24:27], v[40:43], v[132:135], v[24:27]
    v_mfma_f32_16x16x32_bf16 v[28:31], v[44:47], v[132:135], v[28:31]
    s_waitcnt lgkmcnt(4)
    v_mfma_f32_16x16x32_bf16 v[24:27], v[48:51], v[136:139], v[24:27]
    v_mfma_f32_16x16x32_bf16 v[28:31], v[52:55], v[136:139], v[28:31]
    s_waitcnt lgkmcnt(0)
    v_mfma_f32_16x16x32_bf16 v[24:27], v[56:59], v[140:143], v[24:27]
    v_mfma_f32_16x16x32_bf16 v[28:31], v[60:63], v[140:143], v[28:31]
    s_memrealtime s[88:89]
    v_mov_b32 v14, 0x2410c
    v_mov_b32 v15, 1
    s_mov_b64 exec, 1
    ds_add_u32 v14, v15
    s_mov_b64 exec, -1
    s_nop 0
    v_cvt_pk_bf16_f32 v64, v24, v25
    v_cvt_pk_bf16_f32 v65, v26, v27
    v_cvt_pk_bf16_f32 v68, v28, v29
    v_cvt_pk_bf16_f32 v69, v30, v31
    s_nop 0
    v_mov_b32_dpp v64, v68 quad_perm:[0,1,2,3] row_mask:0xf bank_mask:0x2
    v_mov_b32_dpp v65, v69 quad_perm:[0,1,2,3] row_mask:0xf bank_mask:0x2
    s_waitcnt lgkmcnt(0)
    s_or_b32 s89, s89, s78
    v_mov_b32 v66, s88
    v_mov_b32 v67, s89
    s_mov_b64 exec, s[84:85]
    buffer_store_dwordx4 v[64:67], v5, s[36:39], 0 offen
    s_mov_b64 exec, -1
    s_mov_b32 m0, s64
    s_add_u32 s64, s64, 1024
    buffer_load_dwordx4 v10, s[48:51], s63 offen nt lds
    s_add_u32 s63, s63, 32768
    s_mov_b32 m0, s64
    s_add_u32 s64, s64, 1024
    buffer_load_dwordx4 v11, s[48:51], s63 offen nt lds
    s_add_u32 s63, s63, 32768
    s_mov_b32 m0, s64
    s_add_u32 s64, s64, 1024
    buffer_load_dwordx4 v10, s[48:51], s63 offen nt lds
    s_add_u32 s63, s63, 32768
    s_mov_b32 m0, s64
    s_add_u32 s64, s64, 1024
    buffer_load_dwordx4 v11, s[48:51], s63 offen nt lds
    s_add_u32 s63, s63, 32768
    s_mov_b32 m0, s64
    s_add_u32 s64, s64, 1024
    buffer_load_dwordx4 v10, s[48:51], s63 offen nt lds
    s_add_u32 s63, s63, 32768
    s_mov_b32 m0, s64
    s_add_u32 s64, s64, 1024
    buffer_load_dwordx4 v11, s[48:51], s63 offen nt lds
    s_add_u32 s63, s63, 32768
    v_mov_b32 v14, 0x24210
    v_mov_b32 v15, 1
    s_mov_b64 exec, 1
    ds_add_u32 v14, v15
    s_mov_b64 exec, -1
    s_waitcnt vmcnt(0)
    v_mov_b32 v14, 0x24210
    v_mov_b32 v15, 1
    s_mov_b64 exec, 1
    ds_add_u32 v14, v15
    s_mov_b64 exec, -1
    v_mov_b32 v14, 0x24210
    s_mov_b32 s80, 1600000
LW_3:
    ds_read_b32 v15, v14
    s_waitcnt lgkmcnt(0)
    v_readfirstlane_b32 s79, v15
    s_cmp_ge_u32 s79, 12
    s_cbranch_scc1 LWD_4
    s_sub_u32 s80, s80, 1
    s_cmp_lg_u32 s80, 0
    s_cbranch_scc1 LW_3
LWD_4:
    ds_read_b64_tr_b16 v[32:33], v20 offset:0
    ds_read_b64_tr_b16 v[34:35], v22 offset:0
    ds_read_b64_tr_b16 v[36:37], v21 offset:0
    ds_read_b64_tr_b16 v[38:39], v23 offset:0
    ds_read_b64_tr_b16 v[40:41], v20 offset:8192
    ds_read_b64_tr_b16 v[42:43], v22 offset:8192
    ds_read_b64_tr_b16 v[44:45], v21 offset:8192
    ds_read_b64_tr_b16 v[46:47], v23 offset:8192
    ds_read_b64_tr_b16 v[48:49], v20 offset:16384
    ds_read_b64_tr_b16 v[50:51], v22 offset:16384
    ds_read_b64_tr_b16 v[52:53], v21 offset:16384
    ds_read_b64_tr_b16 v[54:55], v23 offset:16384
    s_waitcnt lgkmcnt(8)
    ds_read_b64_tr_b16 v[56:57], v20 offset:24576
    ds_read_b64_tr_b16 v[58:59], v22 offset:24576
    ds_read_b64_tr_b16 v[60:61], v21 offset:24576
    ds_read_b64_tr_b16 v[62:63], v23 offset:24576
    s_waitcnt lgkmcnt(12)
    v_mfma_f32_16x16x32_bf16 v[24:27], v[32:35], v[144:147], 0
    v_mfma_f32_16x16x32_bf16 v[28:31], v[36:39], v[144:147], 0
    s_waitcnt lgkmcnt(8)
    v_mfma_f32_16x16x32_bf16 v[24:27], v[40:43], v[148:151], v[24:27]
    v_mfma_f32_16x16x32_bf16 v[28:31], v[44:47], v[148:151], v[28:31]
    s_waitcnt lgkmcnt(4)
    v_mfma_f32_16x16x32_bf16 v[24:27], v[48:51], v[152:155], v[24:27]
    v_mfma_f32_16x16x32_bf16 v[28:31], v[52:55], v[152:155], v[28:31]
    s_waitcnt lgkmcnt(0)
    v_mfma_f32_16x16x32_bf16 v[24:27], v[56:59], v[156:159], v[24:27]
    v_mfma_f32_16x16x32_bf16 v[28:31], v[60:63], v[156:159], v[28:31]
    v_mov_b32 v14, 0x24108
    v_mov_b32 v15, 1
    s_mov_b64 exec, 1
    ds_add_u32 v14, v15
    s_mov_b64 exec, -1
    s_nop 1
    v_cvt_pk_bf16_f32 v72, v24, v25
    v_cvt_pk_bf16_f32 v73, v26, v27
    v_cvt_pk_bf16_f32 v76, v28, v29
    v_cvt_pk_bf16_f32 v77, v30, v31
    s_nop 0
    v_mov_b32_dpp v72, v76 quad_perm:[0,1,2,3] row_mask:0xf bank_mask:0x2
    v_mov_b32_dpp v73, v77 quad_perm:[0,1,2,3] row_mask:0xf bank_mask:0x2
    v_mov_b32 v74, v66
    v_mov_b32 v75, v67
    s_mov_b64 exec, s[84:85]
    buffer_store_dwordx4 v[72:75], v4, s[36:39], 0 offen
    s_mov_b64 exec, -1
    v_mov_b32 v14, 0x24210
    v_mov_b32 v15, 1
    s_mov_b64 exec, 1
    ds_add_u32 v14, v15
    s_mov_b64 exec, -1
    s_lshl_b32 s7, s4, 7
    s_add_u32 s7, s7, 0x21000
    v_lshl_add_u32 v10, v1, 3, s7
    s_or_b32 s95, s95, s78
    s_add_u32 s88, s94, 0x10000
    s_addc_u32 s89, s95, 0
    s_mov_b32 s101, 6
    s_mov_b64 exec, 0x3f
U_5:
    buffer_load_dwordx2 v[12:13], v10, s[36:39], 0 offen sc1 nt
UU_6:
    s_waitcnt vmcnt(0)
    v_cmp_gt_u64 s[90:91], s[94:95], v[12:13]
    v_cmp_le_u64 vcc, s[88:89], v[12:13]
    s_or_b64 vcc, vcc, s[90:91]
    s_cbranch_scc0 UD_7
    s_sleep 8
    s_sub_u32 s101, s101, 1
    s_cmp_lg_u32 s101, 0
    s_cbranch_scc1 U_5
UD_7:
    s_mov_b64 exec, -1
    s_min_u32 s7, s101, 1
    s_add_u32 s7, s7, 16
    v_mov_b32 v10, 0x24200
    v_mov_b32 v11, s7
    s_mov_b64 exec, 1
    ds_add_u32 v10, v11
    s_mov_b64 exec, -1
    v_mov_b32 v12, 0x24204
    s_mov_b32 s80, 1600000
LW_8:
    ds_read_b32 v13, v12
    s_waitcnt lgkmcnt(0)
    v_readfirstlane_b32 s79, v13
    s_cmp_ge_u32 s79, 1
    s_cbranch_scc1 LWD_9
    s_sleep 1
    s_sub_u32 s80, s80, 1
    s_cmp_lg_u32 s80, 0
    s_cbranch_scc1 LW_8
LWD_9:
    v_mov_b32 v12, 0x24248
    ds_read_b64 v[14:15], v12
    s_waitcnt lgkmcnt(0)
    v_readfirstlane_b32 s92, v14
    v_readfirstlane_b32 s93, v15
    v_mov_b32 v14, 0x24000
    s_mov_b32 s80, 1600000
LW_10:
    ds_read_b32 v15, v14
    s_waitcnt lgkmcnt(0)
    v_readfirstlane_b32 s79, v15
    s_cmp_ge_u32 s79, 96
    s_cbranch_scc1 LWD_11
    s_sleep 16
    s_sub_u32 s80, s80, 1
    s_cmp_lg_u32 s80, 0
    s_cbranch_scc1 LW_10
LWD_11:
    v_mov_b32 v66, s92
    v_mov_b32 v67, s93
    v_mov_b32 v74, s92
    v_mov_b32 v75, s93
    s_mov_b64 exec, s[84:85]
    s_cmp_eq_u32 s101, 0
    s_cbranch_scc1 SU_12
    buffer_store_dwordx4 v[64:67], v5, s[36:39], 0 offen
    buffer_store_dwordx4 v[72:75], v4, s[36:39], 0 offen
SV_13:
    s_mov_b64 exec, -1
    s_waitcnt vmcnt(0)
    v_mov_b32 v14, 0x24210
    v_mov_b32 v15, 1
    s_mov_b64 exec, 1
    ds_add_u32 v14, v15
    s_mov_b64 exec, -1
    s_branch L_ASVC
L_LDA:
    s_setprio 3
    v_lshrrev_b32 v20, 1, v3
    v_and_b32 v40, 1, v2
    v_xor_b32 v20, v20, v40
    v_lshlrev_b32 v20, 5, v20
    v_lshl_add_u32 v20, v2, 10, v20
    v_and_b32 v40, 1, v1
    v_lshl_add_u32 v20, v40, 4, v20
    v_xor_b32 v21, 0x40, v20
    v_xor_b32 v22, 0x80, v20
    v_xor_b32 v23, 0xc0, v20
    s_lshl_b32 s65, s4, 17
    s_lshl_b32 s7, s5, 8
    s_add_u32 s65, s65, s7
    s_mov_b32 s67, s65
    s_mov_b32 s64, 0
    s_mov_b32 s96, 0x6010600
    s_mov_b32 s97, 0x6030602
    s_cmp_eq_u32 s5, 1
    s_cselect_b32 s96, 0x6190618, s96
    s_cselect_b32 s97, 0x61b061a, s97
    s_cmp_eq_u32 s5, 2
    s_cselect_b32 s96, 0x6310630, s96
    s_cselect_b32 s97, 0x6330632, s97
    s_cmp_eq_u32 s5, 3
    s_cselect_b32 s96, 0x6490648, s96
    s_cselect_b32 s97, 0x64b064a, s97
    s_cmp_eq_u32 s5, 4
    s_cselect_b32 s96, 0x4610460, s96
    s_cselect_b32 s97, 0x4630462, s97
    s_cmp_eq_u32 s5, 5
    s_cselect_b32 s96, 0x4710470, s96
    s_cselect_b32 s97, 0x4730472, s97
    v_xor_b32 v10, v3, v2
    v_lshlrev_b32 v10, 4, v10
    v_lshl_add_u32 v10, v2, 8, v10
    v_xor_b32 v11, 0x40, v10
    v_xor_b32 v12, 0x80, v10
    v_xor_b32 v13, 0xc0, v10
    v_lshrrev_b32 v14, 1, v3
    v_xor_b32 v14, v14, v2
    v_lshlrev_b32 v14, 5, v14
    v_lshl_add_u32 v14, v2, 8, v14
    v_and_b32 v40, 1, v1
    v_lshl_add_u32 v14, v40, 4, v14
    v_xor_b32 v15, 0x80, v14
    v_add_u32 v24, 4096, v10
    v_add_u32 v25, 4096, v11
    v_add_u32 v26, 4096, v12
    v_add_u32 v27, 4096, v13
    v_add_u32 v28, 4096, v14
    v_add_u32 v29, 4096, v15
    s_mov_b32 s76, 0
    s_lshl_b32 s7, s76, 4
    s_lshr_b64 s[90:91], s[96:97], s7
    s_and_b32 s68, s90, 3
    s_bfe_u32 s72, s90, 0x50002
    s_lshl_b32 s68, s68, 5
    s_add_u32 s68, s68, s4
    s_lshl_b32 s68, s68, 20
    s_lshl_b32 s72, s72, 13
    s_add_u32 s72, s72, s68
    s_add_u32 s72, s72, 0xC0000
    s_mov_b32 s68, s72
    s_mov_b32 s76, 1
    s_lshl_b32 s7, s76, 4
    s_lshr_b64 s[90:91], s[96:97], s7
    s_and_b32 s69, s90, 3
    s_bfe_u32 s73, s90, 0x50002
    s_lshl_b32 s69, s69, 5
    s_add_u32 s69, s69, s4
    s_lshl_b32 s69, s69, 20
    s_lshl_b32 s73, s73, 13
    s_add_u32 s73, s73, s69
    s_add_u32 s73, s73, 0xC0000
    s_mov_b32 s69, s73
    s_mov_b32 s76, 2
    s_lshl_b32 s7, s76, 4
    s_lshr_b64 s[90:91], s[96:97], s7
    s_and_b32 s70, s90, 3
    s_bfe_u32 s74, s90, 0x50002
    s_lshl_b32 s70, s70, 5
    s_add_u32 s70, s70, s4
    s_lshl_b32 s70, s70, 20
    s_lshl_b32 s74, s74, 13
    s_add_u32 s74, s74, s70
    s_add_u32 s74, s74, 0xC0000
    s_mov_b32 s70, s74
    s_mov_b32 s76, 3
    s_lshl_b32 s7, s76, 4
    s_lshr_b64 s[90:91], s[96:97], s7
    s_and_b32 s71, s90, 3
    s_bfe_u32 s75, s90, 0x50002
    s_lshl_b32 s71, s71, 5
    s_add_u32 s71, s71, s4
    s_lshl_b32 s71, s71, 20
    s_lshl_b32 s75, s75, 13
    s_add_u32 s75, s75, s71
    s_add_u32 s75, s75, 0xC0000
    s_mov_b32 s71, s75
    s_waitcnt lgkmcnt(0)
    s_mov_b32 s56, s16
    s_and_b32 s57, s17, 0xffff
    s_mov_b32 s58, 0x400000
    s_mov_b32 s59, 0x20000
    s_mov_b32 s44, s10
    s_and_b32 s45, s11, 0xffff
    s_mov_b32 s46, 0x8000000
    s_mov_b32 s47, 0x20000
    s_mov_b32 s48, s12
    s_and_b32 s49, s13, 0xffff
    s_mov_b32 s50, 0x8000000
    s_mov_b32 s51, 0x20000
    s_barrier
    s_mov_b32 s63, 0
    v_lshlrev_b32 v16, 2, v1
    v_add_u32 v17, 0x24100, v16
    v_add_u32 v16, 0x24000, v16
    v_mov_b32 v18, 0
    s_mov_b32 s60, 0
    s_mov_b32 s36, s34
    s_and_b32 s37, s35, 0xffff
    s_mov_b32 s38, 0x1000000
    s_mov_b32 s39, 0x20000
    s_mov_b32 s52, s30
    s_and_b32 s53, s31, 0xffff
    s_mov_b32 s54, 0x2000
    s_mov_b32 s55, 0x20000
    s_lshl_b32 s7, s4, 8
    s_mov_b64 exec, 1
    buffer_load_dword v100, v10, s[44:47], s68 offen nt
    buffer_load_dword v100, v10, s[44:47], s69 offen nt
    buffer_load_dword v100, v10, s[44:47], s70 offen nt
    buffer_load_dword v100, v10, s[44:47], s71 offen nt
    buffer_load_dword v100, v10, s[48:51], s68 offen nt
    buffer_load_dword v100, v10, s[48:51], s69 offen nt
    buffer_load_dword v100, v10, s[48:51], s70 offen nt
    buffer_load_dword v100, v10, s[48:51], s71 offen nt
    buffer_load_dword v100, v10, s[56:59], s67 offen nt
    buffer_load_dword v100, v10, s[52:55], s7 offen nt
    s_mov_b64 exec, -1
    s_lshl_b32 s7, s2, 14
    s_mov_b32 s52, s26
    s_and_b32 s53, s27, 0xffff
    s_mov_b32 s54, 0x400000
    s_mov_b32 s55, 0x20000
    s_mov_b64 exec, 1
    buffer_load_dword v100, v10, s[52:55], s7 offen nt
    s_mov_b64 exec, -1
    s_mov_b32 s52, s28
    s_and_b32 s53, s29, 0xffff
    s_mov_b32 s54, 0x400000
    s_mov_b32 s55, 0x20000
    s_mov_b64 exec, 1
    buffer_load_dword v100, v10, s[52:55], s7 offen nt
    s_mov_b64 exec, -1
    s_mov_b32 s62, 0
    v_mov_b32 v40, 0x24210
    s_mov_b32 s80, 1600000
LW_14:
    ds_read_b32 v41, v40
    s_waitcnt lgkmcnt(0)
    v_readfirstlane_b32 s79, v41
    s_cmp_ge_u32 s79, 8
    s_cbranch_scc1 LWD_15
    s_sub_u32 s80, s80, 1
    s_cmp_lg_u32 s80, 0
    s_cbranch_scc1 LW_14
LWD_15:
    s_add_u32 m0, s64, 0
    s_waitcnt vmcnt(26)
    buffer_load_dwordx4 v10, s[44:47], s68 offen offset:0 nt lds
    buffer_load_dwordx4 v11, s[44:47], s68 offen offset:1024 nt lds
    s_waitcnt vmcnt(26)
    s_sub_u32 s7, s60, 24
    v_mov_b32 v19, s7
    ds_max_i32 v16, v19
    buffer_load_dwordx4 v12, s[44:47], s68 offen offset:2048 nt lds
    buffer_load_dwordx4 v13, s[44:47], s68 offen offset:3072 nt lds
    s_add_u32 m0, s64, 4096
    s_waitcnt vmcnt(26)
    buffer_load_dwordx4 v24, s[44:47], s68 offen offset:0 nt lds
    buffer_load_dwordx4 v25, s[44:47], s68 offen offset:1024 nt lds
    s_waitcnt vmcnt(26)
    buffer_load_dwordx4 v26, s[44:47], s68 offen offset:2048 nt lds
    buffer_load_dwordx4 v27, s[44:47], s68 offen offset:3072 nt lds
    s_add_u32 s68, s68, 8192
    s_add_u32 m0, s64, 8192
    s_waitcnt vmcnt(26)
    buffer_load_dwordx4 v10, s[44:47], s69 offen offset:0 nt lds
    buffer_load_dwordx4 v11, s[44:47], s69 offen offset:1024 nt lds
    s_waitcnt vmcnt(26)
    s_sub_u32 s7, s60, 16
    v_mov_b32 v19, s7
    ds_max_i32 v16, v19
    buffer_load_dwordx4 v12, s[44:47], s69 offen offset:2048 nt lds
    buffer_load_dwordx4 v13, s[44:47], s69 offen offset:3072 nt lds
    s_add_u32 m0, s64, 12288
    s_waitcnt vmcnt(26)
    buffer_load_dwordx4 v24, s[44:47], s69 offen offset:0 nt lds
    s_memrealtime s[84:85]
    buffer_load_dwordx4 v25, s[44:47], s69 offen offset:1024 nt lds
    s_waitcnt vmcnt(26)
    buffer_load_dwordx4 v26, s[44:47], s69 offen offset:2048 nt lds
    buffer_load_dwordx4 v27, s[44:47], s69 offen offset:3072 nt lds
    s_add_u32 s69, s69, 8192
    s_add_u32 s60, s60, 16
    s_add_u32 m0, s64, 16384
    s_waitcnt vmcnt(26)
    buffer_load_dwordx4 v10, s[44:47], s70 offen offset:0 nt lds
    buffer_load_dwordx4 v11, s[44:47], s70 offen offset:1024 nt lds
    s_waitcnt vmcnt(26)
    s_sub_u32 s7, s60, 24
    v_mov_b32 v19, s7
    ds_max_i32 v16, v19
    buffer_load_dwordx4 v12, s[44:47], s70 offen offset:2048 nt lds
    buffer_load_dwordx4 v13, s[44:47], s70 offen offset:3072 nt lds
    s_add_u32 m0, s64, 20480
    s_waitcnt vmcnt(26)
    buffer_load_dwordx4 v24, s[44:47], s70 offen offset:0 nt lds
    buffer_load_dwordx4 v25, s[44:47], s70 offen offset:1024 nt lds
    s_waitcnt vmcnt(26)
    buffer_load_dwordx4 v26, s[44:47], s70 offen offset:2048 nt lds
    buffer_load_dwordx4 v27, s[44:47], s70 offen offset:3072 nt lds
    s_add_u32 s70, s70, 8192
    s_add_u32 m0, s64, 24576
    s_waitcnt vmcnt(26)
    buffer_load_dwordx4 v10, s[44:47], s71 offen offset:0 nt lds
    buffer_load_dwordx4 v11, s[44:47], s71 offen offset:1024 nt lds
    s_waitcnt vmcnt(26)
    s_sub_u32 s7, s60, 16
    v_mov_b32 v19, s7
    ds_max_i32 v16, v19
    buffer_load_dwordx4 v12, s[44:47], s71 offen offset:2048 nt lds
    buffer_load_dwordx4 v13, s[44:47], s71 offen offset:3072 nt lds
    s_add_u32 m0, s64, 28672
    s_waitcnt vmcnt(26)
    buffer_load_dwordx4 v24, s[44:47], s71 offen offset:0 nt lds
    s_memrealtime s[84:85]
    ds_read_b32 v18, v17
    buffer_load_dwordx4 v25, s[44:47], s71 offen offset:1024 nt lds
    s_waitcnt vmcnt(26)
    buffer_load_dwordx4 v26, s[44:47], s71 offen offset:2048 nt lds
    buffer_load_dwordx4 v27, s[44:47], s71 offen offset:3072 nt lds
    s_add_u32 s71, s71, 8192
    s_add_u32 s60, s60, 16
    s_add_u32 s62, s62, 1
    s_and_b32 s62, s62, 3
    s_lshl_b32 s64, s62, 15
    s_cmp_eq_u32 s62, 2
    s_cselect_b32 s7, 4, 0
    s_add_u32 s63, s63, s7
    v_mov_b32 v40, 0x24204
    s_mov_b32 s80, 1600000
LW_16:
    ds_read_b32 v41, v40
    s_waitcnt lgkmcnt(0)
    v_readfirstlane_b32 s79, v41
    s_cmp_ge_u32 s79, 1
    s_cbranch_scc1 LWD_17
    s_sleep 1
    s_sub_u32 s80, s80, 1
    s_cmp_lg_u32 s80, 0
    s_cbranch_scc1 LW_16
LWD_17:
    v_mov_b32 v40, 0x24248
    ds_read_b64 v[42:43], v40
    s_waitcnt lgkmcnt(0)
    v_readfirstlane_b32 s92, v42
    v_readfirstlane_b32 s93, v43
    s_add_u32 s77, s92, 11136
    s_mov_b32 s86, 0x20202020
    s_mov_b32 s87, 0x20
    s_mov_b32 s88, 0x18181818
    s_mov_b32 s89, 0x1818
    s_mov_b32 s81, 2240
    s_mov_b32 s66, 5
    s_mov_b32 s76, 6
    s_memrealtime s[84:85]
L_KV:
RD_18:
    s_and_b32 s61, s86, 0xff
    s_lshl_b32 s61, s61, 6
    s_lshr_b64 s[86:87], s[86:87], 8
    s_waitcnt lgkmcnt(0)
    v_readlane_b32 s79, v18, s62
    s_cmp_lt_u32 s79, s63
    s_cbranch_scc1 ST_20
GO_19:
    s_lshl_b32 s7, s84, 5
    s_sub_u32 s7, s7, s77
    s_add_u32 s77, s77, s61
    s_cmp_lt_i32 s7, -640
    s_cbranch_scc1 WS_21
    s_cmp_gt_i32 s7, s81
    s_cbranch_scc1 WB_22
    s_add_u32 m0, s64, 0
    s_waitcnt vmcnt(22)
    buffer_load_dwordx4 v10, s[44:47], s68 offen offset:0 nt lds
    buffer_load_dwordx4 v11, s[44:47], s68 offen offset:1024 nt lds
    s_waitcnt vmcnt(22)
    buffer_load_dwordx4 v12, s[44:47], s68 offen offset:2048 nt lds
    buffer_load_dwordx4 v13, s[44:47], s68 offen offset:3072 nt lds
    s_add_u32 m0, s64, 4096
    s_waitcnt vmcnt(22)
    buffer_load_dwordx4 v24, s[44:47], s68 offen offset:0 nt lds
    buffer_load_dwordx4 v25, s[44:47], s68 offen offset:1024 nt lds
    s_waitcnt vmcnt(22)
    s_sub_u32 s7, s60, 16
    v_mov_b32 v19, s7
    ds_max_i32 v16, v19
    buffer_load_dwordx4 v26, s[44:47], s68 offen offset:2048 nt lds
    buffer_load_dwordx4 v27, s[44:47], s68 offen offset:3072 nt lds
    s_add_u32 s68, s68, 8192
    s_add_u32 m0, s64, 8192
    s_waitcnt vmcnt(22)
    buffer_load_dwordx4 v10, s[44:47], s69 offen offset:0 nt lds
    buffer_load_dwordx4 v11, s[44:47], s69 offen offset:1024 nt lds
    s_waitcnt vmcnt(22)
    buffer_load_dwordx4 v12, s[44:47], s69 offen offset:2048 nt lds
    buffer_load_dwordx4 v13, s[44:47], s69 offen offset:3072 nt lds
    s_add_u32 m0, s64, 12288
    s_waitcnt vmcnt(22)
    buffer_load_dwordx4 v24, s[44:47], s69 offen offset:0 nt lds
    s_memrealtime s[84:85]
    buffer_load_dwordx4 v25, s[44:47], s69 offen offset:1024 nt lds
    s_waitcnt vmcnt(22)
    s_sub_u32 s7, s60, 8
    v_mov_b32 v19, s7
    ds_max_i32 v16, v19
    buffer_load_dwordx4 v26, s[44:47], s69 offen offset:2048 nt lds
    buffer_load_dwordx4 v27, s[44:47], s69 offen offset:3072 nt lds
    s_add_u32 s69, s69, 8192
    s_branch WJ_23
WS_21:
    s_add_u32 m0, s64, 0
    s_waitcnt vmcnt(14)
    buffer_load_dwordx4 v10, s[44:47], s68 offen offset:0 nt lds
    buffer_load_dwordx4 v11, s[44:47], s68 offen offset:1024 nt lds
    s_waitcnt vmcnt(14)
    buffer_load_dwordx4 v12, s[44:47], s68 offen offset:2048 nt lds
    buffer_load_dwordx4 v13, s[44:47], s68 offen offset:3072 nt lds
    s_add_u32 m0, s64, 4096
    s_waitcnt vmcnt(14)
    buffer_load_dwordx4 v24, s[44:47], s68 offen offset:0 nt lds
    buffer_load_dwordx4 v25, s[44:47], s68 offen offset:1024 nt lds
    s_waitcnt vmcnt(14)
    s_sub_u32 s7, s60, 8
    v_mov_b32 v19, s7
    ds_max_i32 v16, v19
    buffer_load_dwordx4 v26, s[44:47], s68 offen offset:2048 nt lds
    buffer_load_dwordx4 v27, s[44:47], s68 offen offset:3072 nt lds
    s_add_u32 s68, s68, 8192
    s_add_u32 m0, s64, 8192
    s_waitcnt vmcnt(14)
    buffer_load_dwordx4 v10, s[44:47], s69 offen offset:0 nt lds
    buffer_load_dwordx4 v11, s[44:47], s69 offen offset:1024 nt lds
    s_waitcnt vmcnt(14)
    buffer_load_dwordx4 v12, s[44:47], s69 offen offset:2048 nt lds
    buffer_load_dwordx4 v13, s[44:47], s69 offen offset:3072 nt lds
    s_add_u32 m0, s64, 12288
    s_waitcnt vmcnt(14)
    buffer_load_dwordx4 v24, s[44:47], s69 offen offset:0 nt lds
    s_memrealtime s[84:85]
    buffer_load_dwordx4 v25, s[44:47], s69 offen offset:1024 nt lds
    s_waitcnt vmcnt(14)
    v_mov_b32 v19, s60
    ds_max_i32 v16, v19
    buffer_load_dwordx4 v26, s[44:47], s69 offen offset:2048 nt lds
    buffer_load_dwordx4 v27, s[44:47], s69 offen offset:3072 nt lds
    s_add_u32 s69, s69, 8192
    s_branch WJ_23
WB_22:
    s_add_u32 m0, s64, 0
    s_waitcnt vmcnt(30)
    buffer_load_dwordx4 v10, s[44:47], s68 offen offset:0 nt lds
    buffer_load_dwordx4 v11, s[44:47], s68 offen offset:1024 nt lds
    s_waitcnt vmcnt(30)
    buffer_load_dwordx4 v12, s[44:47], s68 offen offset:2048 nt lds
    buffer_load_dwordx4 v13, s[44:47], s68 offen offset:3072 nt lds
    s_add_u32 m0, s64, 4096
    s_waitcnt vmcnt(30)
    buffer_load_dwordx4 v24, s[44:47], s68 offen offset:0 nt lds
    buffer_load_dwordx4 v25, s[44:47], s68 offen offset:1024 nt lds
    s_waitcnt vmcnt(30)
    s_sub_u32 s7, s60, 24
    v_mov_b32 v19, s7
    ds_max_i32 v16, v19
    buffer_load_dwordx4 v26, s[44:47], s68 offen offset:2048 nt lds
    buffer_load_dwordx4 v27, s[44:47], s68 offen offset:3072 nt lds
    s_add_u32 s68, s68, 8192
    s_add_u32 m0, s64, 8192
    s_waitcnt vmcnt(30)
    buffer_load_dwordx4 v10, s[44:47], s69 offen offset:0 nt lds
    buffer_load_dwordx4 v11, s[44:47], s69 offen offset:1024 nt lds
    s_waitcnt vmcnt(30)
    buffer_load_dwordx4 v12, s[44:47], s69 offen offset:2048 nt lds
    buffer_load_dwordx4 v13, s[44:47], s69 offen offset:3072 nt lds
    s_add_u32 m0, s64, 12288
    s_waitcnt vmcnt(30)
    buffer_load_dwordx4 v24, s[44:47], s69 offen offset:0 nt lds
    s_memrealtime s[84:85]
    buffer_load_dwordx4 v25, s[44:47], s69 offen offset:1024 nt lds
    s_waitcnt vmcnt(30)
    s_sub_u32 s7, s60, 16
    v_mov_b32 v19, s7
    ds_max_i32 v16, v19
    buffer_load_dwordx4 v26, s[44:47], s69 offen offset:2048 nt lds
    buffer_load_dwordx4 v27, s[44:47], s69 offen offset:3072 nt lds
    s_add_u32 s69, s69, 8192
WJ_23:
    s_add_u32 s60, s60, 16
    s_waitcnt lgkmcnt(0)
    s_lshl_b32 s7, s84, 5
    s_sub_u32 s7, s7, s77
    s_add_u32 s77, s77, s61
    s_cmp_lt_i32 s7, -640
    s_cbranch_scc1 WS_24
    s_cmp_gt_i32 s7, s81
    s_cbranch_scc1 WB_25
    s_add_u32 m0, s64, 16384
    s_waitcnt vmcnt(22)
    buffer_load_dwordx4 v10, s[44:47], s70 offen offset:0 nt lds
    buffer_load_dwordx4 v11, s[44:47], s70 offen offset:1024 nt lds
    s_waitcnt vmcnt(22)
    buffer_load_dwordx4 v12, s[44:47], s70 offen offset:2048 nt lds
    buffer_load_dwordx4 v13, s[44:47], s70 offen offset:3072 nt lds
    s_add_u32 m0, s64, 20480
    s_waitcnt vmcnt(22)
    buffer_load_dwordx4 v24, s[44:47], s70 offen offset:0 nt lds
    buffer_load_dwordx4 v25, s[44:47], s70 offen offset:1024 nt lds
    s_waitcnt vmcnt(22)
    s_sub_u32 s7, s60, 16
    v_mov_b32 v19, s7
    ds_max_i32 v16, v19
    buffer_load_dwordx4 v26, s[44:47], s70 offen offset:2048 nt lds
    buffer_load_dwordx4 v27, s[44:47], s70 offen offset:3072 nt lds
    s_add_u32 s70, s70, 8192
    s_add_u32 m0, s64, 24576
    s_waitcnt vmcnt(22)
    buffer_load_dwordx4 v10, s[44:47], s71 offen offset:0 nt lds
    buffer_load_dwordx4 v11, s[44:47], s71 offen offset:1024 nt lds
    s_waitcnt vmcnt(22)
    buffer_load_dwordx4 v12, s[44:47], s71 offen offset:2048 nt lds
    buffer_load_dwordx4 v13, s[44:47], s71 offen offset:3072 nt lds
    s_add_u32 m0, s64, 28672
    s_waitcnt vmcnt(22)
    buffer_load_dwordx4 v24, s[44:47], s71 offen offset:0 nt lds
    s_memrealtime s[84:85]
    ds_read_b32 v18, v17
    buffer_load_dwordx4 v25, s[44:47], s71 offen offset:1024 nt lds
    s_waitcnt vmcnt(22)
    s_sub_u32 s7, s60, 8
    v_mov_b32 v19, s7
    ds_max_i32 v16, v19
    buffer_load_dwordx4 v26, s[44:47], s71 offen offset:2048 nt lds
    buffer_load_dwordx4 v27, s[44:47], s71 offen offset:3072 nt lds
    s_add_u32 s71, s71, 8192
    s_branch WJ_26
WS_24:
    s_add_u32 m0, s64, 16384
    s_waitcnt vmcnt(14)
    buffer_load_dwordx4 v10, s[44:47], s70 offen offset:0 nt lds
    buffer_load_dwordx4 v11, s[44:47], s70 offen offset:1024 nt lds
    s_waitcnt vmcnt(14)
    buffer_load_dwordx4 v12, s[44:47], s70 offen offset:2048 nt lds
    buffer_load_dwordx4 v13, s[44:47], s70 offen offset:3072 nt lds
    s_add_u32 m0, s64, 20480
    s_waitcnt vmcnt(14)
    buffer_load_dwordx4 v24, s[44:47], s70 offen offset:0 nt lds
    buffer_load_dwordx4 v25, s[44:47], s70 offen offset:1024 nt lds
    s_waitcnt vmcnt(14)
    s_sub_u32 s7, s60, 8
    v_mov_b32 v19, s7
    ds_max_i32 v16, v19
    buffer_load_dwordx4 v26, s[44:47], s70 offen offset:2048 nt lds
    buffer_load_dwordx4 v27, s[44:47], s70 offen offset:3072 nt lds
    s_add_u32 s70, s70, 8192
    s_add_u32 m0, s64, 24576
    s_waitcnt vmcnt(14)
    buffer_load_dwordx4 v10, s[44:47], s71 offen offset:0 nt lds
    buffer_load_dwordx4 v11, s[44:47], s71 offen offset:1024 nt lds
    s_waitcnt vmcnt(14)
    buffer_load_dwordx4 v12, s[44:47], s71 offen offset:2048 nt lds
    buffer_load_dwordx4 v13, s[44:47], s71 offen offset:3072 nt lds
    s_add_u32 m0, s64, 28672
    s_waitcnt vmcnt(14)
    buffer_load_dwordx4 v24, s[44:47], s71 offen offset:0 nt lds
    s_memrealtime s[84:85]
    ds_read_b32 v18, v17
    buffer_load_dwordx4 v25, s[44:47], s71 offen offset:1024 nt lds
    s_waitcnt vmcnt(14)
    v_mov_b32 v19, s60
    ds_max_i32 v16, v19
    buffer_load_dwordx4 v26, s[44:47], s71 offen offset:2048 nt lds
    buffer_load_dwordx4 v27, s[44:47], s71 offen offset:3072 nt lds
    s_add_u32 s71, s71, 8192
    s_branch WJ_26
WB_25:
    s_add_u32 m0, s64, 16384
    s_waitcnt vmcnt(30)
    buffer_load_dwordx4 v10, s[44:47], s70 offen offset:0 nt lds
    buffer_load_dwordx4 v11, s[44:47], s70 offen offset:1024 nt lds
    s_waitcnt vmcnt(30)
    buffer_load_dwordx4 v12, s[44:47], s70 offen offset:2048 nt lds
    buffer_load_dwordx4 v13, s[44:47], s70 offen offset:3072 nt lds
    s_add_u32 m0, s64, 20480
    s_waitcnt vmcnt(30)
    buffer_load_dwordx4 v24, s[44:47], s70 offen offset:0 nt lds
    buffer_load_dwordx4 v25, s[44:47], s70 offen offset:1024 nt lds
    s_waitcnt vmcnt(30)
    s_sub_u32 s7, s60, 24
    v_mov_b32 v19, s7
    ds_max_i32 v16, v19
    buffer_load_dwordx4 v26, s[44:47], s70 offen offset:2048 nt lds
    buffer_load_dwordx4 v27, s[44:47], s70 offen offset:3072 nt lds
    s_add_u32 s70, s70, 8192
    s_add_u32 m0, s64, 24576
    s_waitcnt vmcnt(30)
    buffer_load_dwordx4 v10, s[44:47], s71 offen offset:0 nt lds
    buffer_load_dwordx4 v11, s[44:47], s71 offen offset:1024 nt lds
    s_waitcnt vmcnt(30)
    buffer_load_dwordx4 v12, s[44:47], s71 offen offset:2048 nt lds
    buffer_load_dwordx4 v13, s[44:47], s71 offen offset:3072 nt lds
    s_add_u32 m0, s64, 28672
    s_waitcnt vmcnt(30)
    buffer_load_dwordx4 v24, s[44:47], s71 offen offset:0 nt lds
    s_memrealtime s[84:85]
    ds_read_b32 v18, v17
    buffer_load_dwordx4 v25, s[44:47], s71 offen offset:1024 nt lds
    s_waitcnt vmcnt(30)
    s_sub_u32 s7, s60, 16
    v_mov_b32 v19, s7
    ds_max_i32 v16, v19
    buffer_load_dwordx4 v26, s[44:47], s71 offen offset:2048 nt lds
    buffer_load_dwordx4 v27, s[44:47], s71 offen offset:3072 nt lds
    s_add_u32 s71, s71, 8192
WJ_26:
    s_add_u32 s60, s60, 16
    s_add_u32 s62, s62, 1
    s_and_b32 s62, s62, 3
    s_lshl_b32 s64, s62, 15
    s_cmp_eq_u32 s62, 2
    s_cselect_b32 s7, 4, 0
    s_add_u32 s63, s63, s7
    s_sub_u32 s66, s66, 1
    s_cmp_lg_u32 s66, 0
    s_cbranch_scc1 RD_18
    s_mov_b32 s68, s72
    s_mov_b32 s69, s73
    s_mov_b32 s70, s74
    s_mov_b32 s71, s75
    s_mov_b32 s66, s76
    s_mov_b64 s[86:87], s[88:89]
    s_cmp_ge_u32 s5, 4
    s_cselect_b32 s81, 2240, s81
RD_27:
    s_and_b32 s61, s86, 0xff
    s_lshl_b32 s61, s61, 6
    s_lshr_b64 s[86:87], s[86:87], 8
    s_waitcnt lgkmcnt(0)
    v_readlane_b32 s79, v18, s62
    s_cmp_lt_u32 s79, s63
    s_cbranch_scc1 ST_29
GO_28:
    s_lshl_b32 s7, s84, 5
    s_sub_u32 s7, s7, s77
    s_add_u32 s77, s77, s61
    s_cmp_lt_i32 s7, -640
    s_cbranch_scc1 WS_30
    s_cmp_gt_i32 s7, s81
    s_cbranch_scc1 WB_31
    s_add_u32 m0, s64, 0
    s_waitcnt vmcnt(28)
    buffer_load_dwordx4 v14, s[48:51], s68 offen offset:0 nt lds
    buffer_load_dwordx4 v15, s[48:51], s68 offen offset:1024 nt lds
    s_waitcnt vmcnt(28)
    buffer_load_dwordx4 v14, s[48:51], s68 offen offset:2048 nt lds
    buffer_load_dwordx4 v15, s[48:51], s68 offen offset:3072 nt lds
    s_add_u32 m0, s64, 4096
    s_waitcnt vmcnt(28)
    s_sub_u32 s7, s60, 24
    v_mov_b32 v19, s7
    ds_max_i32 v16, v19
    buffer_load_dwordx4 v28, s[48:51], s68 offen offset:0 nt lds
    buffer_load_dwordx4 v29, s[48:51], s68 offen offset:1024 nt lds
    s_waitcnt vmcnt(28)
    buffer_load_dwordx4 v28, s[48:51], s68 offen offset:2048 nt lds
    buffer_load_dwordx4 v29, s[48:51], s68 offen offset:3072 nt lds
    s_add_u32 s68, s68, 8192
    s_add_u32 m0, s64, 8192
    s_waitcnt vmcnt(28)
    buffer_load_dwordx4 v14, s[48:51], s69 offen offset:0 nt lds
    buffer_load_dwordx4 v15, s[48:51], s69 offen offset:1024 nt lds
    s_waitcnt vmcnt(28)
    buffer_load_dwordx4 v14, s[48:51], s69 offen offset:2048 nt lds
    buffer_load_dwordx4 v15, s[48:51], s69 offen offset:3072 nt lds
    s_add_u32 m0, s64, 12288
    s_waitcnt vmcnt(28)
    s_sub_u32 s7, s60, 16
    v_mov_b32 v19, s7
    ds_max_i32 v16, v19
    buffer_load_dwordx4 v28, s[48:51], s69 offen offset:0 nt lds
    s_memrealtime s[84:85]
    buffer_load_dwordx4 v29, s[48:51], s69 offen offset:1024 nt lds
    s_waitcnt vmcnt(28)
    buffer_load_dwordx4 v28, s[48:51], s69 offen offset:2048 nt lds
    buffer_load_dwordx4 v29, s[48:51], s69 offen offset:3072 nt lds
    s_add_u32 s69, s69, 8192
    s_branch WJ_32
WS_30:
    s_add_u32 m0, s64, 0
    s_waitcnt vmcnt(18)
    buffer_load_dwordx4 v14, s[48:51], s68 offen offset:0 nt lds
    buffer_load_dwordx4 v15, s[48:51], s68 offen offset:1024 nt lds
    s_waitcnt vmcnt(18)
    s_sub_u32 s7, s60, 16
    v_mov_b32 v19, s7
    ds_max_i32 v16, v19
    buffer_load_dwordx4 v14, s[48:51], s68 offen offset:2048 nt lds
    buffer_load_dwordx4 v15, s[48:51], s68 offen offset:3072 nt lds
    s_add_u32 m0, s64, 4096
    s_waitcnt vmcnt(18)
    buffer_load_dwordx4 v28, s[48:51], s68 offen offset:0 nt lds
    buffer_load_dwordx4 v29, s[48:51], s68 offen offset:1024 nt lds
    s_waitcnt vmcnt(18)
    buffer_load_dwordx4 v28, s[48:51], s68 offen offset:2048 nt lds
    buffer_load_dwordx4 v29, s[48:51], s68 offen offset:3072 nt lds
    s_add_u32 s68, s68, 8192
    s_add_u32 m0, s64, 8192
    s_waitcnt vmcnt(18)
    buffer_load_dwordx4 v14, s[48:51], s69 offen offset:0 nt lds
    buffer_load_dwordx4 v15, s[48:51], s69 offen offset:1024 nt lds
    s_waitcnt vmcnt(18)
    s_sub_u32 s7, s60, 8
    v_mov_b32 v19, s7
    ds_max_i32 v16, v19
    buffer_load_dwordx4 v14, s[48:51], s69 offen offset:2048 nt lds
    buffer_load_dwordx4 v15, s[48:51], s69 offen offset:3072 nt lds
    s_add_u32 m0, s64, 12288
    s_waitcnt vmcnt(18)
    buffer_load_dwordx4 v28, s[48:51], s69 offen offset:0 nt lds
    s_memrealtime s[84:85]
    buffer_load_dwordx4 v29, s[48:51], s69 offen offset:1024 nt lds
    s_waitcnt vmcnt(18)
    buffer_load_dwordx4 v28, s[48:51], s69 offen offset:2048 nt lds
    buffer_load_dwordx4 v29, s[48:51], s69 offen offset:3072 nt lds
    s_add_u32 s69, s69, 8192
    s_branch WJ_32
WB_31:
    s_add_u32 m0, s64, 0
    s_waitcnt vmcnt(42)
    buffer_load_dwordx4 v14, s[48:51], s68 offen offset:0 nt lds
    buffer_load_dwordx4 v15, s[48:51], s68 offen offset:1024 nt lds
    s_waitcnt vmcnt(42)
    s_sub_u32 s7, s60, 40
    v_mov_b32 v19, s7
    ds_max_i32 v16, v19
    buffer_load_dwordx4 v14, s[48:51], s68 offen offset:2048 nt lds
    buffer_load_dwordx4 v15, s[48:51], s68 offen offset:3072 nt lds
    s_add_u32 m0, s64, 4096
    s_waitcnt vmcnt(42)
    buffer_load_dwordx4 v28, s[48:51], s68 offen offset:0 nt lds
    buffer_load_dwordx4 v29, s[48:51], s68 offen offset:1024 nt lds
    s_waitcnt vmcnt(42)
    buffer_load_dwordx4 v28, s[48:51], s68 offen offset:2048 nt lds
    buffer_load_dwordx4 v29, s[48:51], s68 offen offset:3072 nt lds
    s_add_u32 s68, s68, 8192
    s_add_u32 m0, s64, 8192
    s_waitcnt vmcnt(42)
    buffer_load_dwordx4 v14, s[48:51], s69 offen offset:0 nt lds
    buffer_load_dwordx4 v15, s[48:51], s69 offen offset:1024 nt lds
    s_waitcnt vmcnt(42)
    s_sub_u32 s7, s60, 32
    v_mov_b32 v19, s7
    ds_max_i32 v16, v19
    buffer_load_dwordx4 v14, s[48:51], s69 offen offset:2048 nt lds
    buffer_load_dwordx4 v15, s[48:51], s69 offen offset:3072 nt lds
    s_add_u32 m0, s64, 12288
    s_waitcnt vmcnt(42)
    buffer_load_dwordx4 v28, s[48:51], s69 offen offset:0 nt lds
    s_memrealtime s[84:85]
    buffer_load_dwordx4 v29, s[48:51], s69 offen offset:1024 nt lds
    s_waitcnt vmcnt(42)
    buffer_load_dwordx4 v28, s[48:51], s69 offen offset:2048 nt lds
    buffer_load_dwordx4 v29, s[48:51], s69 offen offset:3072 nt lds
    s_add_u32 s69, s69, 8192
WJ_32:
    s_add_u32 s60, s60, 16
    s_waitcnt lgkmcnt(0)
    s_lshl_b32 s7, s84, 5
    s_sub_u32 s7, s7, s77
    s_add_u32 s77, s77, s61
    s_cmp_lt_i32 s7, -640
    s_cbranch_scc1 WS_33
    s_cmp_gt_i32 s7, s81
    s_cbranch_scc1 WB_34
    s_add_u32 m0, s64, 16384
    s_waitcnt vmcnt(28)
    buffer_load_dwordx4 v14, s[48:51], s70 offen offset:0 nt lds
    buffer_load_dwordx4 v15, s[48:51], s70 offen offset:1024 nt lds
    s_waitcnt vmcnt(28)
    buffer_load_dwordx4 v14, s[48:51], s70 offen offset:2048 nt lds
    buffer_load_dwordx4 v15, s[48:51], s70 offen offset:3072 nt lds
    s_add_u32 m0, s64, 20480
    s_waitcnt vmcnt(28)
    s_sub_u32 s7, s60, 24
    v_mov_b32 v19, s7
    ds_max_i32 v16, v19
    buffer_load_dwordx4 v28, s[48:51], s70 offen offset:0 nt lds
    buffer_load_dwordx4 v29, s[48:51], s70 offen offset:1024 nt lds
    s_waitcnt vmcnt(28)
    buffer_load_dwordx4 v28, s[48:51], s70 offen offset:2048 nt lds
    buffer_load_dwordx4 v29, s[48:51], s70 offen offset:3072 nt lds
    s_add_u32 s70, s70, 8192
    s_add_u32 m0, s64, 24576
    s_waitcnt vmcnt(28)
    buffer_load_dwordx4 v14, s[48:51], s71 offen offset:0 nt lds
    buffer_load_dwordx4 v15, s[48:51], s71 offen offset:1024 nt lds
    s_waitcnt vmcnt(28)
    buffer_load_dwordx4 v14, s[48:51], s71 offen offset:2048 nt lds
    buffer_load_dwordx4 v15, s[48:51], s71 offen offset:3072 nt lds
    s_add_u32 m0, s64, 28672
    s_waitcnt vmcnt(28)
    s_sub_u32 s7, s60, 16
    v_mov_b32 v19, s7
    ds_max_i32 v16, v19
    buffer_load_dwordx4 v28, s[48:51], s71 offen offset:0 nt lds
    s_memrealtime s[84:85]
    ds_read_b32 v18, v17
    buffer_load_dwordx4 v29, s[48:51], s71 offen offset:1024 nt lds
    s_waitcnt vmcnt(28)
    buffer_load_dwordx4 v28, s[48:51], s71 offen offset:2048 nt lds
    buffer_load_dwordx4 v29, s[48:51], s71 offen offset:3072 nt lds
    s_add_u32 s71, s71, 8192
    s_branch WJ_35
WS_33:
    s_add_u32 m0, s64, 16384
    s_waitcnt vmcnt(18)
    buffer_load_dwordx4 v14, s[48:51], s70 offen offset:0 nt lds
    buffer_load_dwordx4 v15, s[48:51], s70 offen offset:1024 nt lds
    s_waitcnt vmcnt(18)
    s_sub_u32 s7, s60, 16
    v_mov_b32 v19, s7
    ds_max_i32 v16, v19
    buffer_load_dwordx4 v14, s[48:51], s70 offen offset:2048 nt lds
    buffer_load_dwordx4 v15, s[48:51], s70 offen offset:3072 nt lds
    s_add_u32 m0, s64, 20480
    s_waitcnt vmcnt(18)
    buffer_load_dwordx4 v28, s[48:51], s70 offen offset:0 nt lds
    buffer_load_dwordx4 v29, s[48:51], s70 offen offset:1024 nt lds
    s_waitcnt vmcnt(18)
    buffer_load_dwordx4 v28, s[48:51], s70 offen offset:2048 nt lds
    buffer_load_dwordx4 v29, s[48:51], s70 offen offset:3072 nt lds
    s_add_u32 s70, s70, 8192
    s_add_u32 m0, s64, 24576
    s_waitcnt vmcnt(18)
    buffer_load_dwordx4 v14, s[48:51], s71 offen offset:0 nt lds
    buffer_load_dwordx4 v15, s[48:51], s71 offen offset:1024 nt lds
    s_waitcnt vmcnt(18)
    s_sub_u32 s7, s60, 8
    v_mov_b32 v19, s7
    ds_max_i32 v16, v19
    buffer_load_dwordx4 v14, s[48:51], s71 offen offset:2048 nt lds
    buffer_load_dwordx4 v15, s[48:51], s71 offen offset:3072 nt lds
    s_add_u32 m0, s64, 28672
    s_waitcnt vmcnt(18)
    buffer_load_dwordx4 v28, s[48:51], s71 offen offset:0 nt lds
    s_memrealtime s[84:85]
    ds_read_b32 v18, v17
    buffer_load_dwordx4 v29, s[48:51], s71 offen offset:1024 nt lds
    s_waitcnt vmcnt(18)
    buffer_load_dwordx4 v28, s[48:51], s71 offen offset:2048 nt lds
    buffer_load_dwordx4 v29, s[48:51], s71 offen offset:3072 nt lds
    s_add_u32 s71, s71, 8192
    s_branch WJ_35
WB_34:
    s_add_u32 m0, s64, 16384
    s_waitcnt vmcnt(42)
    buffer_load_dwordx4 v14, s[48:51], s70 offen offset:0 nt lds
    buffer_load_dwordx4 v15, s[48:51], s70 offen offset:1024 nt lds
    s_waitcnt vmcnt(42)
    s_sub_u32 s7, s60, 40
    v_mov_b32 v19, s7
    ds_max_i32 v16, v19
    buffer_load_dwordx4 v14, s[48:51], s70 offen offset:2048 nt lds
    buffer_load_dwordx4 v15, s[48:51], s70 offen offset:3072 nt lds
    s_add_u32 m0, s64, 20480
    s_waitcnt vmcnt(42)
    buffer_load_dwordx4 v28, s[48:51], s70 offen offset:0 nt lds
    buffer_load_dwordx4 v29, s[48:51], s70 offen offset:1024 nt lds
    s_waitcnt vmcnt(42)
    buffer_load_dwordx4 v28, s[48:51], s70 offen offset:2048 nt lds
    buffer_load_dwordx4 v29, s[48:51], s70 offen offset:3072 nt lds
    s_add_u32 s70, s70, 8192
    s_add_u32 m0, s64, 24576
    s_waitcnt vmcnt(42)
    buffer_load_dwordx4 v14, s[48:51], s71 offen offset:0 nt lds
    buffer_load_dwordx4 v15, s[48:51], s71 offen offset:1024 nt lds
    s_waitcnt vmcnt(42)
    s_sub_u32 s7, s60, 32
    v_mov_b32 v19, s7
    ds_max_i32 v16, v19
    buffer_load_dwordx4 v14, s[48:51], s71 offen offset:2048 nt lds
    buffer_load_dwordx4 v15, s[48:51], s71 offen offset:3072 nt lds
    s_add_u32 m0, s64, 28672
    s_waitcnt vmcnt(42)
    buffer_load_dwordx4 v28, s[48:51], s71 offen offset:0 nt lds
    s_memrealtime s[84:85]
    ds_read_b32 v18, v17
    buffer_load_dwordx4 v29, s[48:51], s71 offen offset:1024 nt lds
    s_waitcnt vmcnt(42)
    buffer_load_dwordx4 v28, s[48:51], s71 offen offset:2048 nt lds
    buffer_load_dwordx4 v29, s[48:51], s71 offen offset:3072 nt lds
    s_add_u32 s71, s71, 8192
WJ_35:
    s_add_u32 s60, s60, 16
    s_add_u32 s62, s62, 1
    s_and_b32 s62, s62, 3
    s_lshl_b32 s64, s62, 15
    s_cmp_eq_u32 s62, 2
    s_cselect_b32 s7, 4, 0
    s_add_u32 s63, s63, s7
    s_sub_u32 s66, s66, 1
    s_cmp_lg_u32 s66, 0
    s_cbranch_scc1 RD_27
    s_cmp_ge_u32 s5, 4
    s_cbranch_scc1 KE_36
    s_mov_b32 s65, s67
    s_waitcnt lgkmcnt(0)
    v_readlane_b32 s79, v18, s62
    s_cmp_lt_u32 s79, s63
    s_cbranch_scc1 ST_38
GO_37:
    s_mov_b32 s66, 2
LL_39:
    s_waitcnt vmcnt(43)
    s_mov_b32 m0, s64
    s_add_u32 s64, s64, 1024
    buffer_load_dwordx4 v20, s[56:59], s65 offen nt lds
    s_add_u32 s65, s65, 4096
    s_waitcnt vmcnt(43)
    s_mov_b32 m0, s64
    s_add_u32 s64, s64, 1024
    buffer_load_dwordx4 v20, s[56:59], s65 offen nt lds
    s_add_u32 s65, s65, 4096
    s_waitcnt vmcnt(43)
    s_mov_b32 m0, s64
    s_add_u32 s64, s64, 1024
    buffer_load_dwordx4 v20, s[56:59], s65 offen nt lds
    s_add_u32 s65, s65, 4096
    s_waitcnt vmcnt(43)
    s_sub_u32 s7, s60, 40
    v_mov_b32 v19, s7
    ds_max_i32 v16, v19
    s_mov_b32 m0, s64
    s_add_u32 s64, s64, 1024
    buffer_load_dwordx4 v20, s[56:59], s65 offen nt lds
    s_add_u32 s65, s65, 4096
    s_waitcnt vmcnt(43)
    s_mov_b32 m0, s64
    s_add_u32 s64, s64, 1024
    buffer_load_dwordx4 v21, s[56:59], s65 offen nt lds
    s_add_u32 s65, s65, 4096
    s_waitcnt vmcnt(43)
    s_mov_b32 m0, s64
    s_add_u32 s64, s64, 1024
    buffer_load_dwordx4 v21, s[56:59], s65 offen nt lds
    s_add_u32 s65, s65, 4096
    s_waitcnt vmcnt(43)
    s_mov_b32 m0, s64
    s_add_u32 s64, s64, 1024
    buffer_load_dwordx4 v21, s[56:59], s65 offen nt lds
    s_add_u32 s65, s65, 4096
    s_waitcnt vmcnt(43)
    s_mov_b32 m0, s64
    s_add_u32 s64, s64, 1024
    buffer_load_dwordx4 v21, s[56:59], s65 offen nt lds
    s_add_u32 s65, s65, 4096
    s_waitcnt vmcnt(43)
    s_mov_b32 m0, s64
    s_add_u32 s64, s64, 1024
    buffer_load_dwordx4 v22, s[56:59], s65 offen nt lds
    s_add_u32 s65, s65, 4096
    s_waitcnt vmcnt(43)
    s_mov_b32 m0, s64
    s_add_u32 s64, s64, 1024
    buffer_load_dwordx4 v22, s[56:59], s65 offen nt lds
    s_add_u32 s65, s65, 4096
    s_waitcnt vmcnt(43)
    s_mov_b32 m0, s64
    s_add_u32 s64, s64, 1024
    buffer_load_dwordx4 v22, s[56:59], s65 offen nt lds
    s_add_u32 s65, s65, 4096
    s_waitcnt vmcnt(43)
    s_sub_u32 s7, s60, 32
    v_mov_b32 v19, s7
    ds_max_i32 v16, v19
    s_mov_b32 m0, s64
    s_add_u32 s64, s64, 1024
    buffer_load_dwordx4 v22, s[56:59], s65 offen nt lds
    s_add_u32 s65, s65, 4096
    s_waitcnt vmcnt(43)
    s_mov_b32 m0, s64
    s_add_u32 s64, s64, 1024
    buffer_load_dwordx4 v23, s[56:59], s65 offen nt lds
    s_add_u32 s65, s65, 4096
    s_waitcnt vmcnt(43)
    s_mov_b32 m0, s64
    s_add_u32 s64, s64, 1024
    buffer_load_dwordx4 v23, s[56:59], s65 offen nt lds
    s_add_u32 s65, s65, 4096
    s_waitcnt vmcnt(43)
    s_mov_b32 m0, s64
    s_add_u32 s64, s64, 1024
    buffer_load_dwordx4 v23, s[56:59], s65 offen nt lds
    s_add_u32 s65, s65, 4096
    s_waitcnt vmcnt(43)
    s_mov_b32 m0, s64
    s_add_u32 s64, s64, 1024
    buffer_load_dwordx4 v23, s[56:59], s65 offen nt lds
    s_add_u32 s65, s65, 4096
    s_add_u32 s60, s60, 16
    s_sub_u32 s66, s66, 1
    s_cmp_lg_u32 s66, 0
    s_cbranch_scc1 LL_39
KE_36:
    s_waitcnt vmcnt(40)
    s_sub_u32 s7, s60, 40
    v_mov_b32 v19, s7
    ds_max_i32 v16, v19
    s_waitcnt vmcnt(32)
    s_sub_u32 s7, s60, 32
    v_mov_b32 v19, s7
    ds_max_i32 v16, v19
    s_waitcnt vmcnt(24)
    s_sub_u32 s7, s60, 24
    v_mov_b32 v19, s7
    ds_max_i32 v16, v19
    s_waitcnt vmcnt(16)
    s_sub_u32 s7, s60, 16
    v_mov_b32 v19, s7
    ds_max_i32 v16, v19
    s_waitcnt vmcnt(8)
    s_sub_u32 s7, s60, 8
    v_mov_b32 v19, s7
    ds_max_i32 v16, v19
    s_waitcnt vmcnt(0)
    v_mov_b32 v19, s60
    ds_max_i32 v16, v19
    s_endpgm
L_LDE:
    s_setprio 3
    v_xor_b32 v6, v3, v2
    v_lshlrev_b32 v6, 4, v6
    v_lshl_add_u32 v6, v2, 13, v6
    v_xor_b32 v7, 0x40, v6
    v_xor_b32 v8, 0x80, v6
    v_xor_b32 v9, 0xc0, v6
    s_lshl_b32 s65, s5, 21
    s_lshl_b32 s7, s4, 8
    s_add_u32 s65, s65, s7
    s_sub_u32 s65, s65, 0x800000
    s_mov_b32 s64, 0x10000
    s_waitcnt lgkmcnt(0)
    s_mov_b32 s52, s24
    s_and_b32 s53, s25, 0xffff
    s_mov_b32 s54, 0x400000
    s_mov_b32 s55, 0x20000
    s_mov_b32 m0, s64
    s_add_u32 s64, s64, 1024
    buffer_load_dwordx4 v6, s[52:55], s65 offen nt lds
    s_add_u32 s65, s65, 32768
    s_mov_b32 m0, s64
    s_add_u32 s64, s64, 1024
    buffer_load_dwordx4 v7, s[52:55], s65 offen nt lds
    s_add_u32 s65, s65, 32768
    s_mov_b32 m0, s64
    s_add_u32 s64, s64, 1024
    buffer_load_dwordx4 v8, s[52:55], s65 offen nt lds
    s_add_u32 s65, s65, 32768
    s_mov_b32 m0, s64
    s_add_u32 s64, s64, 1024
    buffer_load_dwordx4 v9, s[52:55], s65 offen nt lds
    s_add_u32 s65, s65, 32768
    s_mov_b32 m0, s64
    s_add_u32 s64, s64, 1024
    buffer_load_dwordx4 v6, s[52:55], s65 offen nt lds
    s_add_u32 s65, s65, 32768
    s_mov_b32 m0, s64
    s_add_u32 s64, s64, 1024
    buffer_load_dwordx4 v7, s[52:55], s65 offen nt lds
    s_add_u32 s65, s65, 32768
    s_mov_b32 m0, s64
    s_add_u32 s64, s64, 1024
    buffer_load_dwordx4 v8, s[52:55], s65 offen nt lds
    s_add_u32 s65, s65, 32768
    s_mov_b32 m0, s64
    s_add_u32 s64, s64, 1024
    buffer_load_dwordx4 v9, s[52:55], s65 offen nt lds
    s_add_u32 s65, s65, 32768
    s_mov_b32 m0, s64
    s_add_u32 s64, s64, 1024
    buffer_load_dwordx4 v6, s[52:55], s65 offen nt lds
    s_add_u32 s65, s65, 32768
    s_mov_b32 m0, s64
    s_add_u32 s64, s64, 1024
    buffer_load_dwordx4 v7, s[52:55], s65 offen nt lds
    s_add_u32 s65, s65, 32768
    s_mov_b32 m0, s64
    s_add_u32 s64, s64, 1024
    buffer_load_dwordx4 v8, s[52:55], s65 offen nt lds
    s_add_u32 s65, s65, 32768
    s_mov_b32 m0, s64
    s_add_u32 s64, s64, 1024
    buffer_load_dwordx4 v9, s[52:55], s65 offen nt lds
    s_add_u32 s65, s65, 32768
    s_mov_b32 m0, s64
    s_add_u32 s64, s64, 1024
    buffer_load_dwordx4 v6, s[52:55], s65 offen nt lds
    s_add_u32 s65, s65, 32768
    s_mov_b32 m0, s64
    s_add_u32 s64, s64, 1024
    buffer_load_dwordx4 v7, s[52:55], s65 offen nt lds
    s_add_u32 s65, s65, 32768
    s_mov_b32 m0, s64
    s_add_u32 s64, s64, 1024
    buffer_load_dwordx4 v8, s[52:55], s65 offen nt lds
    s_add_u32 s65, s65, 32768
    s_mov_b32 m0, s64
    s_add_u32 s64, s64, 1024
    buffer_load_dwordx4 v9, s[52:55], s65 offen nt lds
    s_add_u32 s65, s65, 32768
    s_mov_b32 m0, s64
    s_add_u32 s64, s64, 1024
    buffer_load_dwordx4 v6, s[52:55], s65 offen nt lds
    s_add_u32 s65, s65, 32768
    s_mov_b32 m0, s64
    s_add_u32 s64, s64, 1024
    buffer_load_dwordx4 v7, s[52:55], s65 offen nt lds
    s_add_u32 s65, s65, 32768
    s_mov_b32 m0, s64
    s_add_u32 s64, s64, 1024
    buffer_load_dwordx4 v8, s[52:55], s65 offen nt lds
    s_add_u32 s65, s65, 32768
    s_mov_b32 m0, s64
    s_add_u32 s64, s64, 1024
    buffer_load_dwordx4 v9, s[52:55], s65 offen nt lds
    s_add_u32 s65, s65, 32768
    s_mov_b32 m0, s64
    s_add_u32 s64, s64, 1024
    buffer_load_dwordx4 v6, s[52:55], s65 offen nt lds
    s_add_u32 s65, s65, 32768
    s_mov_b32 m0, s64
    s_add_u32 s64, s64, 1024
    buffer_load_dwordx4 v7, s[52:55], s65 offen nt lds
    s_add_u32 s65, s65, 32768
    s_mov_b32 m0, s64
    s_add_u32 s64, s64, 1024
    buffer_load_dwordx4 v8, s[52:55], s65 offen nt lds
    s_add_u32 s65, s65, 32768
    s_mov_b32 m0, s64
    s_add_u32 s64, s64, 1024
    buffer_load_dwordx4 v9, s[52:55], s65 offen nt lds
    s_add_u32 s65, s65, 32768
    s_mov_b32 m0, s64
    s_add_u32 s64, s64, 1024
    buffer_load_dwordx4 v6, s[52:55], s65 offen nt lds
    s_add_u32 s65, s65, 32768
    s_mov_b32 m0, s64
    s_add_u32 s64, s64, 1024
    buffer_load_dwordx4 v7, s[52:55], s65 offen nt lds
    s_add_u32 s65, s65, 32768
    s_mov_b32 m0, s64
    s_add_u32 s64, s64, 1024
    buffer_load_dwordx4 v8, s[52:55], s65 offen nt lds
    s_add_u32 s65, s65, 32768
    s_mov_b32 m0, s64
    s_add_u32 s64, s64, 1024
    buffer_load_dwordx4 v9, s[52:55], s65 offen nt lds
    s_add_u32 s65, s65, 32768
    s_mov_b32 m0, s64
    s_add_u32 s64, s64, 1024
    buffer_load_dwordx4 v6, s[52:55], s65 offen nt lds
    s_add_u32 s65, s65, 32768
    s_mov_b32 m0, s64
    s_add_u32 s64, s64, 1024
    buffer_load_dwordx4 v7, s[52:55], s65 offen nt lds
    s_add_u32 s65, s65, 32768
    s_mov_b32 m0, s64
    s_add_u32 s64, s64, 1024
    buffer_load_dwordx4 v8, s[52:55], s65 offen nt lds
    s_add_u32 s65, s65, 32768
    s_mov_b32 m0, s64
    s_add_u32 s64, s64, 1024
    buffer_load_dwordx4 v9, s[52:55], s65 offen nt lds
    s_add_u32 s65, s65, 32768
    s_barrier
    s_mov_b32 s63, 0
    v_lshlrev_b32 v16, 2, v1
    v_add_u32 v17, 0x24100, v16
    v_add_u32 v16, 0x24000, v16
    v_mov_b32 v18, 0
    s_mov_b32 s60, 32
    s_mov_b32 s36, s34
    s_and_b32 s37, s35, 0xffff
    s_mov_b32 s38, 0x1000000
    s_mov_b32 s39, 0x20000
    s_mov_b32 s56, s26
    s_and_b32 s57, s27, 0xffff
    s_mov_b32 s58, 0x400000
    s_mov_b32 s59, 0x20000
    s_mov_b32 s44, s10
    s_and_b32 s45, s11, 0xffff
    s_mov_b32 s46, 0x8000000
    s_mov_b32 s47, 0x20000
    s_mov_b32 s48, s12
    s_and_b32 s49, s13, 0xffff
    s_mov_b32 s50, 0x8000000
    s_mov_b32 s51, 0x20000
    v_lshrrev_b32 v20, 1, v3
    v_xor_b32 v20, v20, v2
    v_lshlrev_b32 v20, 5, v20
    v_lshl_add_u32 v20, v2, 13, v20
    v_and_b32 v40, 1, v1
    v_lshl_add_u32 v20, v40, 4, v20
    v_xor_b32 v21, 0x80, v20
    v_mov_b32 v22, 0
    v_mov_b32 v23, 0
    s_mov_b32 s67, 0
    s_mov_b32 s96, 0x6010600
    s_mov_b32 s97, 0x6030602
    s_cmp_eq_u32 s5, 1
    s_cselect_b32 s96, 0x6190618, s96
    s_cselect_b32 s97, 0x61b061a, s97
    s_cmp_eq_u32 s5, 2
    s_cselect_b32 s96, 0x6310630, s96
    s_cselect_b32 s97, 0x6330632, s97
    s_cmp_eq_u32 s5, 3
    s_cselect_b32 s96, 0x6490648, s96
    s_cselect_b32 s97, 0x64b064a, s97
    s_cmp_eq_u32 s5, 4
    s_cselect_b32 s96, 0x4610460, s96
    s_cselect_b32 s97, 0x4630462, s97
    s_cmp_eq_u32 s5, 5
    s_cselect_b32 s96, 0x4710470, s96
    s_cselect_b32 s97, 0x4730472, s97
    v_xor_b32 v10, v3, v2
    v_lshlrev_b32 v10, 4, v10
    v_lshl_add_u32 v10, v2, 8, v10
    v_xor_b32 v11, 0x40, v10
    v_xor_b32 v12, 0x80, v10
    v_xor_b32 v13, 0xc0, v10
    v_lshrrev_b32 v14, 1, v3
    v_xor_b32 v14, v14, v2
    v_lshlrev_b32 v14, 5, v14
    v_lshl_add_u32 v14, v2, 8, v14
    v_and_b32 v40, 1, v1
    v_lshl_add_u32 v14, v40, 4, v14
    v_xor_b32 v15, 0x80, v14
    v_add_u32 v24, 4096, v10
    v_add_u32 v25, 4096, v11
    v_add_u32 v26, 4096, v12
    v_add_u32 v27, 4096, v13
    v_add_u32 v28, 4096, v14
    v_add_u32 v29, 4096, v15
    s_mov_b32 s76, 0
    s_lshl_b32 s7, s76, 4
    s_lshr_b64 s[90:91], s[96:97], s7
    s_and_b32 s68, s90, 3
    s_bfe_u32 s72, s90, 0x50002
    s_lshl_b32 s68, s68, 5
    s_add_u32 s68, s68, s4
    s_lshl_b32 s68, s68, 20
    s_lshl_b32 s72, s72, 13
    s_add_u32 s72, s72, s68
    s_add_u32 s72, s72, 0xC0000
    s_mov_b32 s68, s72
    s_mov_b32 s76, 1
    s_lshl_b32 s7, s76, 4
    s_lshr_b64 s[90:91], s[96:97], s7
    s_and_b32 s69, s90, 3
    s_bfe_u32 s73, s90, 0x50002
    s_lshl_b32 s69, s69, 5
    s_add_u32 s69, s69, s4
    s_lshl_b32 s69, s69, 20
    s_lshl_b32 s73, s73, 13
    s_add_u32 s73, s73, s69
    s_add_u32 s73, s73, 0xC0000
    s_mov_b32 s69, s73
    s_mov_b32 s76, 2
    s_lshl_b32 s7, s76, 4
    s_lshr_b64 s[90:91], s[96:97], s7
    s_and_b32 s70, s90, 3
    s_bfe_u32 s74, s90, 0x50002
    s_lshl_b32 s70, s70, 5
    s_add_u32 s70, s70, s4
    s_lshl_b32 s70, s70, 20
    s_lshl_b32 s74, s74, 13
    s_add_u32 s74, s74, s70
    s_add_u32 s74, s74, 0xC0000
    s_mov_b32 s70, s74
    s_mov_b32 s76, 3
    s_lshl_b32 s7, s76, 4
    s_lshr_b64 s[90:91], s[96:97], s7
    s_and_b32 s71, s90, 3
    s_bfe_u32 s75, s90, 0x50002
    s_lshl_b32 s71, s71, 5
    s_add_u32 s71, s71, s4
    s_lshl_b32 s71, s71, 20
    s_lshl_b32 s75, s75, 13
    s_add_u32 s75, s75, s71
    s_add_u32 s75, s75, 0xC0000
    s_mov_b32 s71, s75
    s_mov_b32 s66, 4
LL_40:
    s_waitcnt vmcnt(39)
    s_mov_b32 m0, s64
    s_add_u32 s64, s64, 1024
    buffer_load_dwordx4 v6, s[52:55], s65 offen nt lds
    s_add_u32 s65, s65, 32768
    s_waitcnt vmcnt(39)
    s_mov_b32 m0, s64
    s_add_u32 s64, s64, 1024
    buffer_load_dwordx4 v7, s[52:55], s65 offen nt lds
    s_add_u32 s65, s65, 32768
    s_waitcnt vmcnt(39)
    s_mov_b32 m0, s64
    s_add_u32 s64, s64, 1024
    buffer_load_dwordx4 v8, s[52:55], s65 offen nt lds
    s_add_u32 s65, s65, 32768
    s_waitcnt vmcnt(39)
    s_mov_b32 m0, s64
    s_add_u32 s64, s64, 1024
    buffer_load_dwordx4 v9, s[52:55], s65 offen nt lds
    s_add_u32 s65, s65, 32768
    s_waitcnt vmcnt(39)
    s_mov_b32 m0, s64
    s_add_u32 s64, s64, 1024
    buffer_load_dwordx4 v6, s[52:55], s65 offen nt lds
    s_add_u32 s65, s65, 32768
    s_waitcnt vmcnt(39)
    s_mov_b32 m0, s64
    s_add_u32 s64, s64, 1024
    buffer_load_dwordx4 v7, s[52:55], s65 offen nt lds
    s_add_u32 s65, s65, 32768
    s_waitcnt vmcnt(39)
    s_mov_b32 m0, s64
    s_add_u32 s64, s64, 1024
    buffer_load_dwordx4 v8, s[52:55], s65 offen nt lds
    s_add_u32 s65, s65, 32768
    s_waitcnt vmcnt(39)
    s_sub_u32 s7, s60, 32
    v_mov_b32 v19, s7
    ds_max_i32 v16, v19
    s_mov_b32 m0, s64
    s_add_u32 s64, s64, 1024
    buffer_load_dwordx4 v9, s[52:55], s65 offen nt lds
    s_add_u32 s65, s65, 32768
    s_add_u32 s60, s60, 8
    s_sub_u32 s66, s66, 1
    s_cmp_lg_u32 s66, 0
    s_cbranch_scc1 LL_40
    s_waitcnt vmcnt(32)
    s_sub_u32 s7, s60, 32
    v_mov_b32 v19, s7
    ds_max_i32 v16, v19
    s_waitcnt vmcnt(24)
    s_sub_u32 s7, s60, 24
    v_mov_b32 v19, s7
    ds_max_i32 v16, v19
    s_waitcnt vmcnt(16)
    s_sub_u32 s7, s60, 16
    v_mov_b32 v19, s7
    ds_max_i32 v16, v19
    s_waitcnt vmcnt(8)
    s_sub_u32 s7, s60, 8
    v_mov_b32 v19, s7
    ds_max_i32 v16, v19
    s_waitcnt vmcnt(0)
    v_mov_b32 v19, s60
    ds_max_i32 v16, v19
    v_mov_b32 v40, 0x24208
    s_mov_b32 s80, 1600000
LW_41:
    ds_read_b32 v41, v40
    s_waitcnt lgkmcnt(0)
    v_readfirstlane_b32 s79, v41
    s_cmp_ge_u32 s79, 148
    s_cbranch_scc1 LWD_42
    s_sub_u32 s80, s80, 1
    s_cmp_lg_u32 s80, 0
    s_cbranch_scc1 LW_41
LWD_42:
    s_lshl_b32 s65, s4, 8
    s_lshl_b32 s7, s5, 21
    s_add_u32 s65, s65, s7
    s_sub_u32 s65, s65, 0x800000
    s_mov_b32 s64, 0
    s_mov_b32 s66, 8
LL_43:
    s_waitcnt vmcnt(23)
    s_mov_b32 m0, s64
    s_add_u32 s64, s64, 1024
    buffer_load_dwordx4 v20, s[56:59], s65 offen nt lds
    s_add_u32 s65, s65, 32768
    s_waitcnt vmcnt(23)
    s_mov_b32 m0, s64
    s_add_u32 s64, s64, 1024
    buffer_load_dwordx4 v21, s[56:59], s65 offen nt lds
    s_add_u32 s65, s65, 32768
    s_waitcnt vmcnt(23)
    s_mov_b32 m0, s64
    s_add_u32 s64, s64, 1024
    buffer_load_dwordx4 v20, s[56:59], s65 offen nt lds
    s_add_u32 s65, s65, 32768
    s_waitcnt vmcnt(23)
    s_mov_b32 m0, s64
    s_add_u32 s64, s64, 1024
    buffer_load_dwordx4 v21, s[56:59], s65 offen nt lds
    s_add_u32 s65, s65, 32768
    s_waitcnt vmcnt(23)
    s_mov_b32 m0, s64
    s_add_u32 s64, s64, 1024
    buffer_load_dwordx4 v20, s[56:59], s65 offen nt lds
    s_add_u32 s65, s65, 32768
    s_waitcnt vmcnt(23)
    s_mov_b32 m0, s64
    s_add_u32 s64, s64, 1024
    buffer_load_dwordx4 v21, s[56:59], s65 offen nt lds
    s_add_u32 s65, s65, 32768
    ds_read_b32 v18, v17
    s_waitcnt vmcnt(23)
    s_mov_b32 m0, s64
    s_add_u32 s64, s64, 1024
    buffer_load_dwordx4 v20, s[56:59], s65 offen nt lds
    s_add_u32 s65, s65, 32768
    s_waitcnt vmcnt(23)
    s_sub_u32 s7, s60, 16
    v_mov_b32 v19, s7
    ds_max_i32 v16, v19
    s_mov_b32 m0, s64
    s_add_u32 s64, s64, 1024
    buffer_load_dwordx4 v21, s[56:59], s65 offen nt lds
    s_add_u32 s65, s65, 32768
    s_add_u32 s60, s60, 8
    s_sub_u32 s66, s66, 1
    s_cmp_lg_u32 s66, 0
    s_cbranch_scc1 LL_43
    s_mov_b32 s62, 2
    s_mov_b32 s63, 4
    v_mov_b32 v40, 0x24204
    s_mov_b32 s80, 1600000
LW_44:
    ds_read_b32 v41, v40
    s_waitcnt lgkmcnt(0)
    v_readfirstlane_b32 s79, v41
    s_cmp_ge_u32 s79, 1
    s_cbranch_scc1 LWD_45
    s_sleep 1
    s_sub_u32 s80, s80, 1
    s_cmp_lg_u32 s80, 0
    s_cbranch_scc1 LW_44
LWD_45:
    v_mov_b32 v40, 0x24248
    ds_read_b64 v[42:43], v40
    s_waitcnt lgkmcnt(0)
    v_readfirstlane_b32 s92, v42
    v_readfirstlane_b32 s93, v43
    s_add_u32 s77, s92, 18240
    s_mov_b32 s86, 0x1f1f1f1f
    s_mov_b32 s87, 0x0
    s_mov_b32 s88, 0x1b1b1b1b
    s_mov_b32 s89, 0x0
    s_mov_b32 s81, 2240
    s_mov_b32 s66, 4
    s_mov_b32 s76, 4
    s_memrealtime s[84:85]
    s_branch L_KV
L_LDB:
    s_setprio 3
    v_lshlrev_b32 v20, 4, v1
    v_xor_b32 v21, 0x40, v20
    v_xor_b32 v22, 0x80, v20
    v_xor_b32 v23, 0xc0, v20
    v_xor_b32 v24, 0x10, v20
    v_xor_b32 v25, 0x50, v20
    v_xor_b32 v26, 0x90, v20
    v_xor_b32 v27, 0xd0, v20
    v_xor_b32 v28, 0x20, v20
    v_xor_b32 v29, 0x60, v20
    v_xor_b32 v30, 0xa0, v20
    v_xor_b32 v31, 0xe0, v20
    v_xor_b32 v32, 0x30, v20
    v_xor_b32 v33, 0x70, v20
    v_xor_b32 v34, 0xb0, v20
    v_xor_b32 v35, 0xf0, v20
    s_and_b32 s69, s4, 7
    s_lshl_b32 s69, s69, 3
    s_lshr_b32 s7, s4, 3
    s_lshl_b32 s7, s7, 1
    s_add_u32 s69, s69, s7
    s_add_u32 s69, s69, s5
    s_sub_u32 s69, s69, 6
    s_lshr_b32 s68, s69, 3
    s_lshl_b32 s68, s68, 21
    s_and_b32 s7, s69, 7
    s_lshl_b32 s7, s7, 14
    s_add_u32 s68, s68, s7
    s_mov_b32 s64, 0
    s_waitcnt lgkmcnt(0)
    s_mov_b32 s44, s20
    s_and_b32 s45, s21, 0xffff
    s_mov_b32 s46, 0x1000000
    s_mov_b32 s47, 0x20000
    s_add_u32 s7, s64, 0
    s_mov_b32 m0, s7
    s_add_u32 s65, s68, 0
    buffer_load_dwordx4 v20, s[44:47], s65 offen offset:0 nt lds
    buffer_load_dwordx4 v21, s[44:47], s65 offen offset:1024 nt lds
    buffer_load_dwordx4 v22, s[44:47], s65 offen offset:2048 nt lds
    buffer_load_dwordx4 v23, s[44:47], s65 offen offset:3072 nt lds
    s_add_u32 s7, s64, 4096
    s_mov_b32 m0, s7
    s_add_u32 s65, s68, 4096
    buffer_load_dwordx4 v24, s[44:47], s65 offen offset:0 nt lds
    buffer_load_dwordx4 v25, s[44:47], s65 offen offset:1024 nt lds
    buffer_load_dwordx4 v26, s[44:47], s65 offen offset:2048 nt lds
    buffer_load_dwordx4 v27, s[44:47], s65 offen offset:3072 nt lds
    s_add_u32 s7, s64, 8192
    s_mov_b32 m0, s7
    s_add_u32 s65, s68, 8192
    buffer_load_dwordx4 v28, s[44:47], s65 offen offset:0 nt lds
    buffer_load_dwordx4 v29, s[44:47], s65 offen offset:1024 nt lds
    buffer_load_dwordx4 v30, s[44:47], s65 offen offset:2048 nt lds
    buffer_load_dwordx4 v31, s[44:47], s65 offen offset:3072 nt lds
    s_add_u32 s7, s64, 12288
    s_mov_b32 m0, s7
    s_add_u32 s65, s68, 12288
    buffer_load_dwordx4 v32, s[44:47], s65 offen offset:0 nt lds
    buffer_load_dwordx4 v33, s[44:47], s65 offen offset:1024 nt lds
    buffer_load_dwordx4 v34, s[44:47], s65 offen offset:2048 nt lds
    buffer_load_dwordx4 v35, s[44:47], s65 offen offset:3072 nt lds
    s_add_u32 s68, s68, 131072
    s_add_u32 s64, s64, 16384
    s_barrier
    s_mov_b32 s63, 0
    v_lshlrev_b32 v16, 2, v1
    v_add_u32 v17, 0x24100, v16
    v_add_u32 v16, 0x24000, v16
    v_mov_b32 v18, 0
    s_mov_b32 s60, 16
    s_mov_b32 s36, s34
    s_and_b32 s37, s35, 0xffff
    s_mov_b32 s38, 0x1000000
    s_mov_b32 s39, 0x20000
    s_mov_b32 s48, s28
    s_and_b32 s49, s29, 0xffff
    s_mov_b32 s50, 0x400000
    s_mov_b32 s51, 0x20000
    v_lshrrev_b32 v10, 1, v3
    v_xor_b32 v10, v10, v2
    v_lshlrev_b32 v10, 5, v10
    v_lshl_add_u32 v10, v2, 10, v10
    v_and_b32 v40, 1, v1
    v_lshl_add_u32 v10, v40, 4, v10
    v_xor_b32 v11, 0x80, v10
    s_mov_b32 s72, 0x22559911
    s_mov_b32 s73, 0x2
    s_mov_b32 s74, 0x54873210
    s_mov_b32 s75, 0x6
    s_mov_b32 s66, 6
LL_46:
    s_waitcnt vmcnt(27)
    s_add_u32 s7, s64, 0
    s_mov_b32 m0, s7
    s_add_u32 s65, s68, 0
    buffer_load_dwordx4 v20, s[44:47], s65 offen offset:0 nt lds
    s_waitcnt vmcnt(27)
    buffer_load_dwordx4 v21, s[44:47], s65 offen offset:1024 nt lds
    s_waitcnt vmcnt(27)
    buffer_load_dwordx4 v22, s[44:47], s65 offen offset:2048 nt lds
    s_waitcnt vmcnt(27)
    s_sub_u32 s7, s60, 24
    v_mov_b32 v19, s7
    ds_max_i32 v16, v19
    buffer_load_dwordx4 v23, s[44:47], s65 offen offset:3072 nt lds
    s_waitcnt vmcnt(27)
    s_add_u32 s7, s64, 4096
    s_mov_b32 m0, s7
    s_add_u32 s65, s68, 4096
    buffer_load_dwordx4 v24, s[44:47], s65 offen offset:0 nt lds
    s_waitcnt vmcnt(27)
    buffer_load_dwordx4 v25, s[44:47], s65 offen offset:1024 nt lds
    s_waitcnt vmcnt(27)
    buffer_load_dwordx4 v26, s[44:47], s65 offen offset:2048 nt lds
    s_waitcnt vmcnt(27)
    buffer_load_dwordx4 v27, s[44:47], s65 offen offset:3072 nt lds
    s_waitcnt vmcnt(27)
    s_add_u32 s7, s64, 8192
    s_mov_b32 m0, s7
    s_add_u32 s65, s68, 8192
    buffer_load_dwordx4 v28, s[44:47], s65 offen offset:0 nt lds
    s_waitcnt vmcnt(27)
    buffer_load_dwordx4 v29, s[44:47], s65 offen offset:1024 nt lds
    s_waitcnt vmcnt(27)
    buffer_load_dwordx4 v30, s[44:47], s65 offen offset:2048 nt lds
    s_waitcnt vmcnt(27)
    s_sub_u32 s7, s60, 16
    v_mov_b32 v19, s7
    ds_max_i32 v16, v19
    buffer_load_dwordx4 v31, s[44:47], s65 offen offset:3072 nt lds
    s_waitcnt vmcnt(27)
    s_add_u32 s7, s64, 12288
    s_mov_b32 m0, s7
    s_add_u32 s65, s68, 12288
    buffer_load_dwordx4 v32, s[44:47], s65 offen offset:0 nt lds
    s_waitcnt vmcnt(27)
    buffer_load_dwordx4 v33, s[44:47], s65 offen offset:1024 nt lds
    s_waitcnt vmcnt(27)
    buffer_load_dwordx4 v34, s[44:47], s65 offen offset:2048 nt lds
    s_waitcnt vmcnt(27)
    buffer_load_dwordx4 v35, s[44:47], s65 offen offset:3072 nt lds
    s_add_u32 s60, s60, 16
    s_add_u32 s68, s68, 131072
    s_add_u32 s64, s64, 16384
    s_sub_u32 s66, s66, 1
    s_cmp_lg_u32 s66, 0
    s_cbranch_scc1 LL_46
    s_mov_b32 s66, 2
LL_47:
    s_and_b32 s63, s72, 3
    s_lshl_b32 s63, s63, 3
    s_bfe_u32 s62, s72, 0x20002
    s_lshr_b64 s[72:73], s[72:73], 4
    s_and_b32 s64, s74, 15
    s_lshl_b32 s64, s64, 14
    s_lshr_b64 s[74:75], s[74:75], 4
    s_waitcnt lgkmcnt(0)
    v_readlane_b32 s79, v18, s62
    s_cmp_lt_u32 s79, s63
    s_cbranch_scc1 ST_49
GO_48:
    s_waitcnt vmcnt(19)
    s_add_u32 s7, s64, 0
    s_mov_b32 m0, s7
    s_add_u32 s65, s68, 0
    buffer_load_dwordx4 v20, s[44:47], s65 offen offset:0 nt lds
    s_waitcnt vmcnt(19)
    buffer_load_dwordx4 v21, s[44:47], s65 offen offset:1024 nt lds
    s_waitcnt vmcnt(19)
    buffer_load_dwordx4 v22, s[44:47], s65 offen offset:2048 nt lds
    s_waitcnt vmcnt(19)
    s_sub_u32 s7, s60, 16
    v_mov_b32 v19, s7
    ds_max_i32 v16, v19
    buffer_load_dwordx4 v23, s[44:47], s65 offen offset:3072 nt lds
    s_waitcnt vmcnt(19)
    s_add_u32 s7, s64, 4096
    s_mov_b32 m0, s7
    s_add_u32 s65, s68, 4096
    buffer_load_dwordx4 v24, s[44:47], s65 offen offset:0 nt lds
    s_waitcnt vmcnt(19)
    buffer_load_dwordx4 v25, s[44:47], s65 offen offset:1024 nt lds
    s_waitcnt vmcnt(19)
    buffer_load_dwordx4 v26, s[44:47], s65 offen offset:2048 nt lds
    s_waitcnt vmcnt(19)
    buffer_load_dwordx4 v27, s[44:47], s65 offen offset:3072 nt lds
    s_waitcnt vmcnt(19)
    s_add_u32 s7, s64, 8192
    s_mov_b32 m0, s7
    s_add_u32 s65, s68, 8192
    buffer_load_dwordx4 v28, s[44:47], s65 offen offset:0 nt lds
    s_waitcnt vmcnt(19)
    buffer_load_dwordx4 v29, s[44:47], s65 offen offset:1024 nt lds
    s_waitcnt vmcnt(19)
    buffer_load_dwordx4 v30, s[44:47], s65 offen offset:2048 nt lds
    s_waitcnt vmcnt(19)
    s_sub_u32 s7, s60, 8
    v_mov_b32 v19, s7
    ds_max_i32 v16, v19
    buffer_load_dwordx4 v31, s[44:47], s65 offen offset:3072 nt lds
    s_waitcnt vmcnt(19)
    s_add_u32 s7, s64, 12288
    s_mov_b32 m0, s7
    s_add_u32 s65, s68, 12288
    buffer_load_dwordx4 v32, s[44:47], s65 offen offset:0 nt lds
    s_waitcnt vmcnt(19)
    buffer_load_dwordx4 v33, s[44:47], s65 offen offset:1024 nt lds
    ds_read_b32 v18, v17
    s_waitcnt vmcnt(19)
    buffer_load_dwordx4 v34, s[44:47], s65 offen offset:2048 nt lds
    s_waitcnt vmcnt(19)
    buffer_load_dwordx4 v35, s[44:47], s65 offen offset:3072 nt lds
    s_add_u32 s60, s60, 16
    s_add_u32 s68, s68, 131072
    s_sub_u32 s66, s66, 1
    s_cmp_lg_u32 s66, 0
    s_cbranch_scc1 LL_47
    s_mov_b32 s66, 7
LL_50:
    s_and_b32 s63, s72, 3
    s_lshl_b32 s63, s63, 3
    s_bfe_u32 s62, s72, 0x20002
    s_lshr_b64 s[72:73], s[72:73], 4
    s_and_b32 s64, s74, 15
    s_lshl_b32 s64, s64, 14
    s_lshr_b64 s[74:75], s[74:75], 4
    s_waitcnt lgkmcnt(0)
    v_readlane_b32 s79, v18, s62
    s_cmp_lt_u32 s79, s63
    s_cbranch_scc1 ST_52
GO_51:
    s_waitcnt vmcnt(31)
    s_add_u32 s7, s64, 0
    s_mov_b32 m0, s7
    s_add_u32 s65, s68, 0
    buffer_load_dwordx4 v20, s[44:47], s65 offen offset:0 nt lds
    s_waitcnt vmcnt(31)
    buffer_load_dwordx4 v21, s[44:47], s65 offen offset:1024 nt lds
    s_waitcnt vmcnt(31)
    buffer_load_dwordx4 v22, s[44:47], s65 offen offset:2048 nt lds
    s_waitcnt vmcnt(31)
    buffer_load_dwordx4 v23, s[44:47], s65 offen offset:3072 nt lds
    s_waitcnt vmcnt(31)
    s_add_u32 s7, s64, 4096
    s_mov_b32 m0, s7
    s_add_u32 s65, s68, 4096
    buffer_load_dwordx4 v24, s[44:47], s65 offen offset:0 nt lds
    s_waitcnt vmcnt(31)
    buffer_load_dwordx4 v25, s[44:47], s65 offen offset:1024 nt lds
    s_waitcnt vmcnt(31)
    buffer_load_dwordx4 v26, s[44:47], s65 offen offset:2048 nt lds
    s_waitcnt vmcnt(31)
    s_sub_u32 s7, s60, 24
    v_mov_b32 v19, s7
    ds_max_i32 v16, v19
    buffer_load_dwordx4 v27, s[44:47], s65 offen offset:3072 nt lds
    s_waitcnt vmcnt(31)
    s_add_u32 s7, s64, 8192
    s_mov_b32 m0, s7
    s_add_u32 s65, s68, 8192
    buffer_load_dwordx4 v28, s[44:47], s65 offen offset:0 nt lds
    s_waitcnt vmcnt(31)
    buffer_load_dwordx4 v29, s[44:47], s65 offen offset:1024 nt lds
    s_waitcnt vmcnt(31)
    buffer_load_dwordx4 v30, s[44:47], s65 offen offset:2048 nt lds
    s_waitcnt vmcnt(31)
    buffer_load_dwordx4 v31, s[44:47], s65 offen offset:3072 nt lds
    s_waitcnt vmcnt(31)
    s_add_u32 s7, s64, 12288
    s_mov_b32 m0, s7
    s_add_u32 s65, s68, 12288
    buffer_load_dwordx4 v32, s[44:47], s65 offen offset:0 nt lds
    s_waitcnt vmcnt(31)
    buffer_load_dwordx4 v33, s[44:47], s65 offen offset:1024 nt lds
    ds_read_b32 v18, v17
    s_waitcnt vmcnt(31)
    buffer_load_dwordx4 v34, s[44:47], s65 offen offset:2048 nt lds
    s_waitcnt vmcnt(31)
    s_sub_u32 s7, s60, 16
    v_mov_b32 v19, s7
    ds_max_i32 v16, v19
    buffer_load_dwordx4 v35, s[44:47], s65 offen offset:3072 nt lds
    s_add_u32 s60, s60, 16
    s_add_u32 s68, s68, 131072
    s_sub_u32 s66, s66, 1
    s_cmp_lg_u32 s66, 0
    s_cbranch_scc1 LL_50
    s_lshr_b32 s65, s69, 3
    s_lshl_b32 s65, s65, 17
    s_and_b32 s7, s69, 3
    s_lshl_b32 s7, s7, 8
    s_add_u32 s65, s65, s7
    s_and_b32 s7, s69, 4
    s_lshl_b32 s7, s7, 19
    s_add_u32 s65, s65, s7
    s_mov_b32 s64, 0
    s_mov_b32 s63, 24
    s_waitcnt lgkmcnt(0)
    v_readlane_b32 s79, v18, 0
    s_cmp_lt_u32 s79, s63
    s_cbranch_scc1 ST_54
GO_53:
    s_mov_b32 m0, s64
    s_add_u32 s64, s64, 1024
    buffer_load_dwordx4 v10, s[48:51], s65 offen nt lds
    s_add_u32 s65, s65, 4096
    s_mov_b32 m0, s64
    s_add_u32 s64, s64, 1024
    buffer_load_dwordx4 v11, s[48:51], s65 offen nt lds
    s_add_u32 s65, s65, 4096
    s_mov_b32 m0, s64
    s_add_u32 s64, s64, 1024
    buffer_load_dwordx4 v10, s[48:51], s65 offen nt lds
    s_add_u32 s65, s65, 4096
    s_mov_b32 m0, s64
    s_add_u32 s64, s64, 1024
    buffer_load_dwordx4 v11, s[48:51], s65 offen nt lds
    s_add_u32 s65, s65, 4096
    s_mov_b32 m0, s64
    s_add_u32 s64, s64, 1024
    buffer_load_dwordx4 v10, s[48:51], s65 offen nt lds
    s_add_u32 s65, s65, 4096
    s_mov_b32 m0, s64
    s_add_u32 s64, s64, 1024
    buffer_load_dwordx4 v11, s[48:51], s65 offen nt lds
    s_add_u32 s65, s65, 4096
    s_mov_b32 m0, s64
    s_add_u32 s64, s64, 1024
    buffer_load_dwordx4 v10, s[48:51], s65 offen nt lds
    s_add_u32 s65, s65, 4096
    s_mov_b32 m0, s64
    s_add_u32 s64, s64, 1024
    buffer_load_dwordx4 v11, s[48:51], s65 offen nt lds
    s_add_u32 s65, s65, 4096
    s_mov_b32 m0, s64
    s_add_u32 s64, s64, 1024
    buffer_load_dwordx4 v10, s[48:51], s65 offen nt lds
    s_add_u32 s65, s65, 4096
    s_mov_b32 m0, s64
    s_add_u32 s64, s64, 1024
    buffer_load_dwordx4 v11, s[48:51], s65 offen nt lds
    s_add_u32 s65, s65, 4096
    s_mov_b32 m0, s64
    s_add_u32 s64, s64, 1024
    buffer_load_dwordx4 v10, s[48:51], s65 offen nt lds
    s_add_u32 s65, s65, 4096
    s_mov_b32 m0, s64
    s_add_u32 s64, s64, 1024
    buffer_load_dwordx4 v11, s[48:51], s65 offen nt lds
    s_add_u32 s65, s65, 4096
    s_mov_b32 m0, s64
    s_add_u32 s64, s64, 1024
    buffer_load_dwordx4 v10, s[48:51], s65 offen nt lds
    s_add_u32 s65, s65, 4096
    s_mov_b32 m0, s64
    s_add_u32 s64, s64, 1024
    buffer_load_dwordx4 v11, s[48:51], s65 offen nt lds
    s_add_u32 s65, s65, 4096
    s_mov_b32 m0, s64
    s_add_u32 s64, s64, 1024
    buffer_load_dwordx4 v10, s[48:51], s65 offen nt lds
    s_add_u32 s65, s65, 4096
    s_mov_b32 m0, s64
    s_add_u32 s64, s64, 1024
    buffer_load_dwordx4 v11, s[48:51], s65 offen nt lds
    s_add_u32 s65, s65, 4096
    s_waitcnt vmcnt(40)
    s_sub_u32 s7, s60, 24
    v_mov_b32 v19, s7
    ds_max_i32 v16, v19
    s_waitcnt vmcnt(32)
    s_sub_u32 s7, s60, 16
    v_mov_b32 v19, s7
    ds_max_i32 v16, v19
    s_waitcnt vmcnt(24)
    s_sub_u32 s7, s60, 8
    v_mov_b32 v19, s7
    ds_max_i32 v16, v19
    s_waitcnt vmcnt(16)
    v_mov_b32 v19, s60
    ds_max_i32 v16, v19
    s_add_u32 s60, s60, 16
    s_waitcnt vmcnt(24)
    s_sub_u32 s7, s60, 24
    v_mov_b32 v19, s7
    ds_max_i32 v16, v19
    s_waitcnt vmcnt(16)
    s_sub_u32 s7, s60, 16
    v_mov_b32 v19, s7
    ds_max_i32 v16, v19
    s_waitcnt vmcnt(8)
    s_sub_u32 s7, s60, 8
    v_mov_b32 v19, s7
    ds_max_i32 v16, v19
    s_waitcnt vmcnt(0)
    v_mov_b32 v19, s60
    ds_max_i32 v16, v19
    v_mov_b32 v48, 0x24218
    s_mov_b32 s80, 1600000
LW_55:
    ds_read_b32 v49, v48
    s_waitcnt lgkmcnt(0)
    v_readfirstlane_b32 s79, v49
    s_cmp_ge_u32 s79, 16
    s_cbranch_scc1 LWD_56
    s_sleep 1
    s_sub_u32 s80, s80, 1
    s_cmp_lg_u32 s80, 0
    s_cbranch_scc1 LW_55
LWD_56:
    s_mov_b32 s66, 3
LL_57:
    s_waitcnt vmcnt(31)
    s_mov_b32 m0, s64
    s_add_u32 s64, s64, 1024
    buffer_load_dwordx4 v10, s[48:51], s65 offen nt lds
    s_add_u32 s65, s65, 4096
    s_waitcnt vmcnt(31)
    s_mov_b32 m0, s64
    s_add_u32 s64, s64, 1024
    buffer_load_dwordx4 v11, s[48:51], s65 offen nt lds
    s_add_u32 s65, s65, 4096
    s_waitcnt vmcnt(31)
    s_mov_b32 m0, s64
    s_add_u32 s64, s64, 1024
    buffer_load_dwordx4 v10, s[48:51], s65 offen nt lds
    s_add_u32 s65, s65, 4096
    s_waitcnt vmcnt(31)
    s_mov_b32 m0, s64
    s_add_u32 s64, s64, 1024
    buffer_load_dwordx4 v11, s[48:51], s65 offen nt lds
    s_add_u32 s65, s65, 4096
    s_waitcnt vmcnt(31)
    s_mov_b32 m0, s64
    s_add_u32 s64, s64, 1024
    buffer_load_dwordx4 v10, s[48:51], s65 offen nt lds
    s_add_u32 s65, s65, 4096
    s_waitcnt vmcnt(31)
    s_mov_b32 m0, s64
    s_add_u32 s64, s64, 1024
    buffer_load_dwordx4 v11, s[48:51], s65 offen nt lds
    s_add_u32 s65, s65, 4096
    s_waitcnt vmcnt(31)
    s_mov_b32 m0, s64
    s_add_u32 s64, s64, 1024
    buffer_load_dwordx4 v10, s[48:51], s65 offen nt lds
    s_add_u32 s65, s65, 4096
    s_waitcnt vmcnt(31)
    s_sub_u32 s7, s60, 24
    v_mov_b32 v19, s7
    ds_max_i32 v16, v19
    s_mov_b32 m0, s64
    s_add_u32 s64, s64, 1024
    buffer_load_dwordx4 v11, s[48:51], s65 offen nt lds
    s_add_u32 s65, s65, 4096
    s_waitcnt vmcnt(31)
    s_mov_b32 m0, s64
    s_add_u32 s64, s64, 1024
    buffer_load_dwordx4 v10, s[48:51], s65 offen nt lds
    s_add_u32 s65, s65, 4096
    s_waitcnt vmcnt(31)
    s_mov_b32 m0, s64
    s_add_u32 s64, s64, 1024
    buffer_load_dwordx4 v11, s[48:51], s65 offen nt lds
    s_add_u32 s65, s65, 4096
    s_waitcnt vmcnt(31)
    s_mov_b32 m0, s64
    s_add_u32 s64, s64, 1024
    buffer_load_dwordx4 v10, s[48:51], s65 offen nt lds
    s_add_u32 s65, s65, 4096
    s_waitcnt vmcnt(31)
    s_mov_b32 m0, s64
    s_add_u32 s64, s64, 1024
    buffer_load_dwordx4 v11, s[48:51], s65 offen nt lds
    s_add_u32 s65, s65, 4096
    s_waitcnt vmcnt(31)
    s_mov_b32 m0, s64
    s_add_u32 s64, s64, 1024
    buffer_load_dwordx4 v10, s[48:51], s65 offen nt lds
    s_add_u32 s65, s65, 4096
    s_waitcnt vmcnt(31)
    s_mov_b32 m0, s64
    s_add_u32 s64, s64, 1024
    buffer_load_dwordx4 v11, s[48:51], s65 offen nt lds
    s_add_u32 s65, s65, 4096
    s_waitcnt vmcnt(31)
    s_mov_b32 m0, s64
    s_add_u32 s64, s64, 1024
    buffer_load_dwordx4 v10, s[48:51], s65 offen nt lds
    s_add_u32 s65, s65, 4096
    s_waitcnt vmcnt(31)
    s_sub_u32 s7, s60, 16
    v_mov_b32 v19, s7
    ds_max_i32 v16, v19
    s_mov_b32 m0, s64
    s_add_u32 s64, s64, 1024
    buffer_load_dwordx4 v11, s[48:51], s65 offen nt lds
    s_add_u32 s65, s65, 4096
    s_add_u32 s60, s60, 16
    s_bitcmp0_b32 s64, 14
    s_cselect_b32 s7, 917504, 0
    s_add_u32 s65, s65, s7
    s_sub_u32 s66, s66, 1
    s_cmp_lg_u32 s66, 0
    s_cbranch_scc1 LL_57
    s_waitcnt vmcnt(24)
    s_sub_u32 s7, s60, 24
    v_mov_b32 v19, s7
    ds_max_i32 v16, v19
    s_waitcnt vmcnt(16)
    s_sub_u32 s7, s60, 16
    v_mov_b32 v19, s7
    ds_max_i32 v16, v19
    s_waitcnt vmcnt(8)
    s_sub_u32 s7, s60, 8
    v_mov_b32 v19, s7
    ds_max_i32 v16, v19
    s_waitcnt vmcnt(0)
    v_mov_b32 v19, s60
    ds_max_i32 v16, v19
    s_endpgm
L_RED:
    s_and_b32 s7, s4, 7
    s_cbranch_scc1 L_END
    s_add_u32 s61, s4, s5
    s_and_b32 s7, s6, 3
    s_cmp_eq_u32 s7, 3
    s_cbranch_scc1 L_END
    s_cmp_eq_u32 s7, 2
    s_cbranch_scc1 L_REDB
    s_lshl_b32 s60, s61, 1
    s_add_u32 s60, s60, s7
    s_mov_b32 s52, s30
    s_and_b32 s53, s31, 0xffff
    s_mov_b32 s54, 0x2000
    s_mov_b32 s55, 0x20000
    s_mov_b32 s84, 0x3f80
    s_mov_b32 s85, 0x3f800000
    s_lshl_b32 s7, s60, 12
    s_add_u32 s7, s7, 0x280000
    v_lshl_add_u32 v36, v1, 4, s7
    s_lshr_b32 s7, s60, 4
    s_lshl_b32 s7, s7, 11
    s_and_b32 s61, s60, 15
    s_lshl_b32 s61, s61, 6
    s_add_u32 s7, s7, s61
    v_lshl_add_u32 v37, v1, 3, s7
    s_mov_b64 exec, -1
    buffer_load_dwordx4 v[48:51], v36, s[36:39], 0 offen offset:0 sc1
    buffer_load_dwordx4 v[52:55], v36, s[36:39], 0 offen offset:1024 sc1
    buffer_load_dwordx4 v[56:59], v36, s[36:39], 0 offen offset:2048 sc1
    buffer_load_dwordx4 v[60:63], v36, s[36:39], 0 offen offset:3072 sc1
    s_mov_b32 s80, 200000
MC_59:
    s_mov_b64 exec, -1
    s_waitcnt vmcnt(0)
    v_cmp_ne_u64 s[62:63], s[92:93], v[50:51]
    v_cmp_ne_u64 s[64:65], s[92:93], v[54:55]
    v_cmp_ne_u64 s[66:67], s[92:93], v[58:59]
    v_cmp_ne_u64 s[68:69], s[92:93], v[62:63]
    s_or_b64 s[90:91], s[62:63], s[64:65]
    s_or_b64 s[90:91], s[90:91], s[66:67]
    s_or_b64 s[90:91], s[90:91], s[68:69]
    s_cbranch_scc1 M_58
MD_60:
    s_mov_b64 exec, -1
    v_dot2_f32_bf16 v44, v48, s84, 0
    v_dot2_f32_bf16 v45, v48, s85, 0
    v_dot2_f32_bf16 v46, v49, s84, 0
    v_dot2_f32_bf16 v47, v49, s85, 0
    v_dot2_f32_bf16 v44, v52, s84, v44
    v_dot2_f32_bf16 v45, v52, s85, v45
    v_dot2_f32_bf16 v46, v53, s84, v46
    v_dot2_f32_bf16 v47, v53, s85, v47
    v_dot2_f32_bf16 v44, v56, s84, v44
    v_dot2_f32_bf16 v45, v56, s85, v45
    v_dot2_f32_bf16 v46, v57, s84, v46
    v_dot2_f32_bf16 v47, v57, s85, v47
    v_dot2_f32_bf16 v44, v60, s84, v44
    v_dot2_f32_bf16 v45, v60, s85, v45
    v_dot2_f32_bf16 v46, v61, s84, v46
    v_dot2_f32_bf16 v47, v61, s85, v47
    v_add_f32_dpp v44, v44, v44 row_ror:8 row_mask:0xf bank_mask:0xf
    v_add_f32_dpp v45, v45, v45 row_ror:8 row_mask:0xf bank_mask:0xf
    v_add_f32_dpp v46, v46, v46 row_ror:8 row_mask:0xf bank_mask:0xf
    v_add_f32_dpp v47, v47, v47 row_ror:8 row_mask:0xf bank_mask:0xf
    s_nop 0
    v_permlane32_swap_b32 v44, v46
    v_permlane32_swap_b32 v45, v47
    v_add_f32 v44, v44, v46
    v_add_f32 v45, v45, v47
    v_mov_b32 v46, v44
    v_mov_b32 v47, v45
    s_nop 0
    v_permlane16_swap_b32 v44, v46
    v_permlane16_swap_b32 v45, v47
    v_add_f32 v44, v44, v46
    v_add_f32 v45, v45, v47
    v_cvt_pk_bf16_f32 v44, v44, v45
    v_mov_b32 v45, v44
    s_nop 1
    v_permlane32_swap_b32 v44, v45
    s_mov_b64 exec, 0xff
    buffer_store_dwordx2 v[44:45], v37, s[52:55], 0 offen
    s_mov_b64 exec, -1
    s_endpgm
L_REDB:
    s_mov_b32 s52, s30
    s_and_b32 s53, s31, 0xffff
    s_mov_b32 s54, 0x2000
    s_mov_b32 s55, 0x20000
    s_mov_b32 s84, 0x3f80
    s_mov_b32 s85, 0x3f800000
    s_lshl_b32 s7, s61, 12
    s_add_u32 s7, s7, 0x2c0000
    v_lshl_add_u32 v36, v1, 4, s7
    s_lshl_b32 s7, s61, 5
    s_add_u32 s7, s7, 1024
    v_and_b32 v38, 3, v1
    v_lshl_add_u32 v37, v38, 3, s7
    v_lshrrev_b32 v38, 2, v3
    v_lshl_add_u32 v37, v38, 11, v37
    s_mov_b64 exec, -1
    buffer_load_dwordx4 v[48:51], v36, s[36:39], 0 offen offset:0 sc1
    buffer_load_dwordx4 v[52:55], v36, s[36:39], 0 offen offset:1024 sc1
    buffer_load_dwordx4 v[56:59], v36, s[36:39], 0 offen offset:2048 sc1
    buffer_load_dwordx4 v[60:63], v36, s[36:39], 0 offen offset:3072 sc1
    s_mov_b32 s80, 200000
MC_62:
    s_mov_b64 exec, -1
    s_waitcnt vmcnt(0)
    v_cmp_ne_u64 s[62:63], s[92:93], v[50:51]
    v_cmp_ne_u64 s[64:65], s[92:93], v[54:55]
    v_cmp_ne_u64 s[66:67], s[92:93], v[58:59]
    v_cmp_ne_u64 s[68:69], s[92:93], v[62:63]
    s_or_b64 s[90:91], s[62:63], s[64:65]
    s_or_b64 s[90:91], s[90:91], s[66:67]
    s_or_b64 s[90:91], s[90:91], s[68:69]
    s_cbranch_scc1 M_61
MD_63:
    s_mov_b64 exec, -1
    v_dot2_f32_bf16 v44, v48, s84, 0
    v_dot2_f32_bf16 v45, v48, s85, 0
    v_dot2_f32_bf16 v46, v49, s84, 0
    v_dot2_f32_bf16 v47, v49, s85, 0
    v_dot2_f32_bf16 v44, v52, s84, v44
    v_dot2_f32_bf16 v45, v52, s85, v45
    v_dot2_f32_bf16 v46, v53, s84, v46
    v_dot2_f32_bf16 v47, v53, s85, v47
    v_dot2_f32_bf16 v44, v56, s84, v44
    v_dot2_f32_bf16 v45, v56, s85, v45
    v_dot2_f32_bf16 v46, v57, s84, v46
    v_dot2_f32_bf16 v47, v57, s85, v47
    v_dot2_f32_bf16 v44, v60, s84, v44
    v_dot2_f32_bf16 v45, v60, s85, v45
    v_dot2_f32_bf16 v46, v61, s84, v46
    v_dot2_f32_bf16 v47, v61, s85, v47
    s_nop 1
    v_permlane32_swap_b32 v44, v46
    v_permlane32_swap_b32 v45, v47
    v_add_f32 v44, v44, v46
    v_add_f32 v45, v45, v47
    v_mov_b32 v46, v44
    v_mov_b32 v47, v45
    s_nop 0
    v_permlane16_swap_b32 v44, v46
    v_permlane16_swap_b32 v45, v47
    v_add_f32 v44, v44, v46
    v_add_f32 v45, v45, v47
    v_cvt_pk_bf16_f32 v44, v44, v45
    v_mov_b32 v45, v44
    s_nop 1
    v_permlane32_swap_b32 v44, v45
    s_mov_b64 exec, 0xffff
    buffer_store_dwordx2 v[44:45], v37, s[52:55], 0 offen
    s_mov_b64 exec, -1
    s_endpgm
L_SIDE:
    v_lshlrev_b32 v10, 2, v0
    v_mov_b32 v24, 0
    v_add_u32 v10, 0x23c00, v10
    ds_write_b32 v10, v24
    s_mov_b32 s61, s6
    v_mov_b32 v28, -1
    v_mov_b32 v29, -1
    v_mov_b32 v30, -1
    v_mov_b32 v31, -1
    s_and_b32 s64, s4, 7
    s_lshl_b32 s64, s64, 3
    s_lshr_b32 s7, s4, 3
    s_lshl_b32 s7, s7, 1
    s_add_u32 s64, s64, s7
    s_add_u32 s64, s64, s5
    s_sub_u32 s64, s64, 6
    s_waitcnt lgkmcnt(0)
    s_mov_b32 s40, s32
    s_and_b32 s41, s33, 0xffff
    s_mov_b32 s42, 0x100
    s_mov_b32 s43, 0x20000
    s_or_b32 s7, s6, s2
    s_cbranch_scc1 NC_64
    s_lshl_b64 s[92:93], s[94:95], 5
    s_or_b32 s93, s93, 0x80000000
    v_mov_b32 v12, s92
    v_mov_b32 v13, s93
    s_mov_b64 exec, 1
    buffer_store_dwordx2 v[12:13], v24, s[40:43], 0 offen sc1
    s_mov_b64 exec, -1
NC_64:
    s_mov_b32 s36, s34
    s_and_b32 s37, s35, 0xffff
    s_mov_b32 s38, 0x1000000
    s_mov_b32 s39, 0x20000
    s_cmp_lt_u32 s5, 4
    s_cbranch_scc1 NB_66
    s_cmp_ge_u32 s5, 6
    s_cbranch_scc1 NQ_65
    s_cmp_lg_u32 s6, 2
    s_cbranch_scc1 NB_66
    s_lshl_b32 s7, s4, 1
    s_add_u32 s7, s7, s5
    s_lshl_b32 s7, s7, 9
    s_sub_u32 s7, s7, 2048
    v_lshl_add_u32 v10, v3, 4, s7
    v_lshl_add_u32 v10, v2, 15, v10
    buffer_store_dwordx4 v[28:31], v10, s[36:39], 0 offen sc1
    buffer_store_dwordx4 v[28:31], v10, s[36:39], 0 offen offset:256 sc1
    s_branch NB_66
NQ_65:
    s_lshl_b32 s65, s64, 2
    s_add_u32 s65, s65, s6
    s_and_b32 s7, s65, 31
    s_lshl_b32 s7, s7, 13
    s_lshr_b32 s62, s64, 3
    s_lshl_b32 s62, s62, 10
    s_add_u32 s7, s7, s62
    s_add_u32 s7, s7, 0x200000
    v_lshl_add_u32 v10, v1, 4, s7
    buffer_store_dwordx4 v[28:31], v10, s[36:39], 0 offen sc1
    s_lshl_b32 s7, s65, 10
    s_add_u32 s7, s7, 0x280000
    v_lshl_add_u32 v10, v1, 7, s7
    s_lshl_b32 s62, s65, 9
    s_add_u32 s7, s62, 0x2c0000
    v_writelane_b32 v10, s7, 8
    s_add_u32 s7, s62, 0x2c0080
    v_writelane_b32 v10, s7, 9
    s_add_u32 s7, s62, 0x2c0100
    v_writelane_b32 v10, s7, 10
    s_add_u32 s7, s62, 0x2c0180
    v_writelane_b32 v10, s7, 11
    s_add_u32 s7, s62, 0xc0000
    v_writelane_b32 v10, s7, 15
    s_add_u32 s7, s62, 0xc0080
    v_writelane_b32 v10, s7, 16
    s_add_u32 s7, s62, 0xc0100
    v_writelane_b32 v10, s7, 17
    s_add_u32 s7, s62, 0xc0180
    v_writelane_b32 v10, s7, 18
    s_lshl_b32 s7, s65, 7
    s_add_u32 s7, s7, 0x28000
    v_writelane_b32 v10, s7, 12
    s_add_u32 s7, s7, 0x8000
    v_writelane_b32 v10, s7, 14
    s_lshl_b32 s7, s65, 4
    s_add_u32 s7, s7, 0x23000
    v_writelane_b32 v10, s7, 13
    s_mov_b64 exec, 0x7ffff
    buffer_load_dword v15, v10, s[36:39], 0 offen sc1
    s_mov_b64 exec, -1
    s_getpc_b64 s[84:85]
L_PC:
    s_and_b32 s7, s65, 31
    s_mul_i32 s7, s7, 1280
    v_lshl_add_u32 v10, v1, 7, s7
    v_min_u32 v10, L_END-concat_heads__sliding_block_cached__compressed_kv_cla__decode_kernel, v10
    s_sub_u32 s84, s84, L_PC-concat_heads__sliding_block_cached__compressed_kv_cla__decode_kernel
    s_subb_u32 s85, s85, 0
    v_mov_b32 v11, s85
    v_add_co_u32 v10, vcc, s84, v10
    s_nop 1
    v_addc_co_u32 v11, vcc, 0, v11, vcc
    s_mov_b64 exec, 0x3ff
    global_load_dword v15, v[10:11], off
    s_mov_b64 exec, -1
NB_66:
    s_barrier
    s_cmp_lg_u32 s6, 0
    s_cbranch_scc1 NF_68
    s_mov_b32 s80, 800000
    s_sleep 12
NL_70:
    s_mov_b64 exec, 1
    buffer_load_dwordx2 v[12:13], v24, s[40:43], 0 offen sc1
    s_mov_b64 exec, -1
    s_waitcnt vmcnt(0)
    v_readfirstlane_b32 s92, v12
    v_readfirstlane_b32 s93, v13
    s_sub_u32 s80, s80, 1
    s_cbranch_scc1 NH_71
    s_cmp_eq_u32 s93, 0
    s_cbranch_scc1 NL_70
    s_sub_u32 s7, s94, 1500
    s_lshl_b32 s7, s7, 5
    s_sub_u32 s7, s92, s7
    s_cmp_ge_i32 s7, 0
    s_cbranch_scc1 NH_71
    s_cmp_gt_u32 s80, 799960
    s_cbranch_scc1 NL_70
NH_71:
    v_mov_b32 v11, 0x24248
    v_mov_b32 v12, s92
    v_mov_b32 v13, s93
    ds_write_b64 v11, v[12:13]
    v_mov_b32 v11, 0x24204
    v_mov_b32 v14, 1
    s_mov_b64 exec, 1
    ds_add_u32 v11, v14
    s_mov_b64 exec, -1
NF_68:
    s_cmp_lg_u32 s6, 1
    s_cbranch_scc1 NP_67
    s_lshl_b32 s65, s4, 7
    s_add_u32 s65, s65, 0x21000
    s_lshr_b32 s7, s64, 3
    s_lshl_b32 s7, s7, 7
    s_add_u32 s7, s7, 0x22000
    s_and_b32 s62, s64, 7
    s_cmp_lt_u32 s5, 6
    s_cselect_b32 s7, s65, s7
    s_cselect_b32 s62, s5, s62
    v_lshl_add_u32 v11, v1, 3, s7
    s_sleep 12
    s_memrealtime s[88:89]
    s_waitcnt lgkmcnt(0)
    s_or_b32 s89, s89, s78
    v_mov_b32 v12, s88
    v_mov_b32 v13, s89
    s_lshl_b64 exec, 1, s62
    buffer_store_dwordx2 v[12:13], v11, s[36:39], 0 offen
    s_mov_b64 exec, -1
NP_67:
    s_cmp_ge_u32 s5, 6
    s_cbranch_scc1 L_BATT
    s_cmp_lt_u32 s5, 4
    s_cbranch_scc1 NG_69
    s_cmp_lg_u32 s6, 2
    s_cbranch_scc1 NG_69
    s_lshl_b32 s7, s4, 4
    s_add_u32 s7, s7, s5
    s_lshl_b32 s7, s7, 3
    s_add_u32 s7, s7, 0x1ffe0
    v_mov_b32 v11, s7
    s_waitcnt vmcnt(0)
    v_mov_b32 v12, 0x24208
    v_mov_b32 v13, 16
    s_mov_b64 exec, 1
    ds_add_u32 v12, v13
    s_mov_b64 exec, -1
    v_mov_b32 v16, 0x24204
    s_mov_b32 s80, 1600000
LW_72:
    ds_read_b32 v17, v16
    s_waitcnt lgkmcnt(0)
    v_readfirstlane_b32 s79, v17
    s_cmp_ge_u32 s79, 1
    s_cbranch_scc1 LWD_73
    s_sleep 1
    s_sub_u32 s80, s80, 1
    s_cmp_lg_u32 s80, 0
    s_cbranch_scc1 LW_72
LWD_73:
    v_mov_b32 v16, 0x24248
    ds_read_b64 v[18:19], v16
    s_waitcnt lgkmcnt(0)
    v_readfirstlane_b32 s92, v18
    v_readfirstlane_b32 s93, v19
    s_mov_b64 exec, 1
    buffer_store_dwordx2 v[18:19], v11, s[36:39], 0 offen sc1
    s_mov_b64 exec, -1
NG_69:
    s_mov_b32 s96, 0x6010600
    s_mov_b32 s97, 0x6030602
    s_cmp_eq_u32 s5, 1
    s_cselect_b32 s96, 0x6190618, s96
    s_cselect_b32 s97, 0x61b061a, s97
    s_cmp_eq_u32 s5, 2
    s_cselect_b32 s96, 0x6310630, s96
    s_cselect_b32 s97, 0x6330632, s97
    s_cmp_eq_u32 s5, 3
    s_cselect_b32 s96, 0x6490648, s96
    s_cselect_b32 s97, 0x64b064a, s97
    s_cmp_eq_u32 s5, 4
    s_cselect_b32 s96, 0x4610460, s96
    s_cselect_b32 s97, 0x4630462, s97
    s_cmp_eq_u32 s5, 5
    s_cselect_b32 s96, 0x4710470, s96
    s_cselect_b32 s97, 0x4730472, s97
    s_lshl_b32 s7, s61, 4
    s_lshr_b64 s[90:91], s[96:97], s7
    s_and_b32 s66, s90, 3
    s_bfe_u32 s67, s90, 0x50002
    s_bfe_u32 s68, s90, 0x40008
    s_or_b32 s95, s95, s78
    s_add_u32 s72, s94, 0x10000
    s_addc_u32 s73, s95, 0
    s_lshl_b32 s7, s4, 15
    s_lshl_b32 s63, s66, 9
    s_add_u32 s7, s7, s63
    s_add_u32 s7, s7, 0x100000
    v_and_b32 v20, 31, v1
    v_lshl_add_u32 v7, v20, 4, s7
    v_lshrrev_b32 v21, 5, v1
    v_lshl_add_u32 v7, v21, 11, v7
    v_add_u32 v22, 4096, v7
    s_mul_i32 s7, s66, 320
    s_add_u32 s63, s7, 0x24400
    v_lshl_add_u32 v6, v20, 3, s63
    v_lshl_add_u32 v6, v21, 2, v6
    s_mov_b32 s70, 0x3f80
    s_mov_b32 s71, 0x3f800000
    v_mov_b32 v16, 0x24204
    s_mov_b32 s80, 1600000
LW_74:
    ds_read_b32 v17, v16
    s_waitcnt lgkmcnt(0)
    v_readfirstlane_b32 s79, v17
    s_cmp_ge_u32 s79, 1
    s_cbranch_scc1 LWD_75
    s_sleep 1
    s_sub_u32 s80, s80, 1
    s_cmp_lg_u32 s80, 0
    s_cbranch_scc1 LW_74
LWD_75:
    v_mov_b32 v16, 0x24248
    ds_read_b64 v[18:19], v16
    s_waitcnt lgkmcnt(0)
    v_readfirstlane_b32 s92, v18
    v_readfirstlane_b32 s93, v19
    s_cmp_lt_u32 s5, 4
    s_cselect_b32 s65, 16, 148
    s_cselect_b32 s7, 0, 4294967288
    s_add_u32 s7, s7, 0x24210
    v_mov_b32 v12, s7
    s_mov_b32 s80, 1600000
LW_76:
    ds_read_b32 v13, v12
    s_waitcnt lgkmcnt(0)
    v_readfirstlane_b32 s79, v13
    s_cmp_ge_u32 s79, s65
    s_cbranch_scc1 LWD_77
    s_sleep 4
    s_sub_u32 s80, s80, 1
    s_cmp_lg_u32 s80, 0
    s_cbranch_scc1 LW_76
LWD_77:
    s_sleep 10
    s_mov_b64 exec, -1
    buffer_load_dwordx4 v[48:51], v7, s[36:39], 0 offen sc1 nt
    buffer_load_dwordx4 v[52:55], v22, s[36:39], 0 offen sc1 nt
    s_mov_b32 s80, 200000
MC_79:
    s_mov_b64 exec, -1
    s_waitcnt vmcnt(0)
    v_cmp_gt_u64 s[44:45], s[94:95], v[50:51]
    v_cmp_le_u64 vcc, s[72:73], v[50:51]
    s_or_b64 s[44:45], s[44:45], vcc
    v_cmp_ne_u64 vcc, s[92:93], v[50:51]
    s_and_b64 s[44:45], s[44:45], vcc
    v_cmp_gt_u64 s[46:47], s[94:95], v[54:55]
    v_cmp_le_u64 vcc, s[72:73], v[54:55]
    s_or_b64 s[46:47], s[46:47], vcc
    v_cmp_ne_u64 vcc, s[92:93], v[54:55]
    s_and_b64 s[46:47], s[46:47], vcc
    s_or_b64 s[90:91], s[44:45], s[46:47]
    s_cbranch_scc1 M_78
MD_80:
    s_mov_b64 exec, -1
    v_dot2_f32_bf16 v24, v48, s70, 0
    v_dot2_f32_bf16 v25, v48, s71, 0
    v_dot2_f32_bf16 v26, v49, s70, 0
    v_dot2_f32_bf16 v27, v49, s71, 0
    v_dot2_f32_bf16 v24, v52, s70, v24
    v_dot2_f32_bf16 v25, v52, s71, v25
    v_dot2_f32_bf16 v26, v53, s70, v26
    v_dot2_f32_bf16 v27, v53, s71, v27
    s_nop 1
    v_permlane32_swap_b32 v24, v26
    v_permlane32_swap_b32 v25, v27
    v_add_f32 v24, v24, v26
    v_add_f32 v25, v25, v27
    v_cvt_pk_bf16_f32 v24, v24, v25
    ds_write_b32 v6, v24
L_AATT:
    v_lshl_add_u32 v8, v2, 4, s63
    s_waitcnt lgkmcnt(0)
    ds_read_b128 v[16:19], v8 offset:0
    ds_read_b128 v[20:23], v8 offset:64
    ds_read_b128 v[24:27], v8 offset:128
    ds_read_b128 v[28:31], v8 offset:192
    v_xor_b32 v4, v3, v2
    v_lshlrev_b32 v4, 4, v4
    v_lshl_add_u32 v4, v3, 8, v4
    v_lshrrev_b32 v9, 2, v1
    v_and_b32 v5, 7, v9
    v_lshlrev_b32 v5, 5, v5
    v_lshl_add_u32 v5, v9, 8, v5
    v_and_b32 v10, 3, v1
    v_lshl_add_u32 v5, v10, 3, v5
    s_lshl_b32 s7, s61, 10
    s_add_u32 s7, s7, 0x24e00
    v_lshl_add_u32 v6, v2, 4, s7
    v_cmp_eq_u32 s[84:85], 0, v3
    s_mov_b32 s72, 0x3e0293ee
    s_cmp_ge_u32 s5, 4
    s_cselect_b32 s73, 8, 8
    s_cselect_b32 s69, 8, 0
    s_cselect_b32 s70, 17, 1
    s_cselect_b32 s74, 16, 24
    s_add_u32 s70, s70, s61
    s_add_u32 s74, s74, s70
    s_lshl_b32 s70, s70, 3
    s_add_u32 s69, s69, s61
    s_cmp_ge_u32 s69, 16
    s_cselect_b32 s7, 16, 0
    s_sub_u32 s69, s69, s7
    s_mov_b32 s71, s68
AK_81:
    s_lshl_b32 s7, s69, 13
    v_add_u32 v104, s7, v4
    v_xor_b32 v105, 0x40, v104
    v_xor_b32 v106, 0x80, v104
    v_xor_b32 v107, 0xc0, v104
    s_and_b32 s62, s69, 12
    s_add_u32 s62, s62, 0x24100
    v_mov_b32 v8, 0x24000
    s_mov_b32 s80, 1600000
LW_82:
    ds_read_b32 v9, v8
    s_waitcnt lgkmcnt(0)
    v_readfirstlane_b32 s79, v9
    s_cmp_ge_u32 s79, s70
    s_cbranch_scc1 LWD_83
    s_sleep 2
    s_sub_u32 s80, s80, 1
    s_cmp_lg_u32 s80, 0
    s_cbranch_scc1 LW_82
LWD_83:
    ds_read_b128 v[32:35], v104 offset:0
    ds_read_b128 v[36:39], v104 offset:4096
    ds_read_b128 v[40:43], v105 offset:0
    ds_read_b128 v[44:47], v105 offset:4096
    ds_read_b128 v[48:51], v106 offset:0
    ds_read_b128 v[52:55], v106 offset:4096
    ds_read_b128 v[56:59], v107 offset:0
    ds_read_b128 v[60:63], v107 offset:4096
    s_waitcnt lgkmcnt(6)
    v_mfma_f32_16x16x32_bf16 v[64:67], v[32:35], v[16:19], 0
    v_mfma_f32_16x16x32_bf16 v[68:71], v[36:39], v[16:19], 0
    s_waitcnt lgkmcnt(4)
    v_mfma_f32_16x16x32_bf16 v[64:67], v[40:43], v[20:23], v[64:67]
    v_mfma_f32_16x16x32_bf16 v[68:71], v[44:47], v[20:23], v[68:71]
    s_waitcnt lgkmcnt(2)
    v_mfma_f32_16x16x32_bf16 v[64:67], v[48:51], v[24:27], v[64:67]
    v_mfma_f32_16x16x32_bf16 v[68:71], v[52:55], v[24:27], v[68:71]
    s_waitcnt lgkmcnt(0)
    v_mfma_f32_16x16x32_bf16 v[64:67], v[56:59], v[28:31], v[64:67]
    v_mfma_f32_16x16x32_bf16 v[68:71], v[60:63], v[28:31], v[68:71]
    v_mov_b32 v8, s62
    v_mov_b32 v9, 1
    s_mov_b64 exec, 1
    ds_add_u32 v8, v9
    s_mov_b64 exec, -1
    s_mov_b64 exec, s[84:85]
    s_nop 0
    ds_write_b128 v6, v[64:67] offset:0
    ds_write_b128 v6, v[68:71] offset:64
    s_mov_b64 exec, -1
    v_add_u32 v6, 128, v6
    s_add_u32 s69, s69, 4
    s_cmp_ge_u32 s69, 16
    s_cselect_b32 s7, 16, 0
    s_sub_u32 s69, s69, s7
    s_add_u32 s70, s70, 32
    s_sub_u32 s71, s71, 1
    s_cmp_lg_u32 s71, 0
    s_cbranch_scc1 AK_81
    v_lshrrev_b32 v8, 2, v1
    v_cmp_gt_u32 s[86:87], s68, v8
    v_and_b32 v8, 7, v8
    v_and_b32 v9, 3, v1
    v_lshlrev_b32 v9, 4, v9
    v_lshl_add_u32 v10, v8, 7, v9
    s_lshl_b32 s7, s61, 10
    s_add_u32 s7, s7, 0x24e00
    v_add_u32 v10, s7, v10
    s_waitcnt lgkmcnt(0)
    ds_read_b128 v[32:35], v10
    ds_read_b128 v[36:39], v10 offset:64
    s_lshl_b32 s7, s61, 9
    s_add_u32 s7, s7, 0x25e00
    v_lshl_add_u32 v10, v8, 6, v9
    v_add_u32 v10, s7, v10
    v_lshl_add_u32 v7, v2, 4, s7
    v_mov_b32 v11, 0xff800000
    s_waitcnt lgkmcnt(0)
    v_cndmask_b32 v32, v11, v32, s[86:87]
    v_cndmask_b32 v33, v11, v33, s[86:87]
    v_cndmask_b32 v34, v11, v34, s[86:87]
    v_cndmask_b32 v35, v11, v35, s[86:87]
    v_cndmask_b32 v36, v11, v36, s[86:87]
    v_cndmask_b32 v37, v11, v37, s[86:87]
    v_cndmask_b32 v38, v11, v38, s[86:87]
    v_cndmask_b32 v39, v11, v39, s[86:87]
    v_max3_f32 v64, v32, v33, v34
    v_max3_f32 v64, v64, v35, v36
    v_max3_f32 v64, v64, v37, v38
    v_max_f32 v64, v64, v39
    s_nop 1
    v_max_f32_dpp v64, v64, v64 row_ror:1 row_mask:0xf bank_mask:0xf
    s_nop 1
    v_max_f32_dpp v64, v64, v64 row_ror:2 row_mask:0xf bank_mask:0xf
    s_nop 1
    v_max_f32_dpp v64, v64, v64 row_ror:4 row_mask:0xf bank_mask:0xf
    s_nop 1
    v_max_f32_dpp v64, v64, v64 row_ror:8 row_mask:0xf bank_mask:0xf
    v_mov_b32 v11, v64
    s_nop 1
    v_permlane32_swap_b32 v64, v11
    v_max_f32 v64, v64, v11
    v_mov_b32 v11, v64
    s_nop 1
    v_permlane16_swap_b32 v64, v11
    v_max_f32 v64, v64, v11
    v_mul_f32 v64, s72, v64
    v_fma_f32 v32, v32, s72, -v64
    v_fma_f32 v33, v33, s72, -v64
    v_fma_f32 v34, v34, s72, -v64
    v_fma_f32 v35, v35, s72, -v64
    v_fma_f32 v36, v36, s72, -v64
    v_fma_f32 v37, v37, s72, -v64
    v_fma_f32 v38, v38, s72, -v64
    v_fma_f32 v39, v39, s72, -v64
    v_exp_f32 v32, v32
    v_exp_f32 v33, v33
    v_exp_f32 v34, v34
    v_exp_f32 v35, v35
    v_exp_f32 v36, v36
    v_exp_f32 v37, v37
    v_exp_f32 v38, v38
    v_exp_f32 v39, v39
    v_cvt_pk_bf16_f32 v112, v32, v33
    v_cvt_pk_bf16_f32 v113, v34, v35
    v_cvt_pk_bf16_f32 v114, v36, v37
    v_cvt_pk_bf16_f32 v115, v38, v39
    s_mov_b64 exec, s[86:87]
    ds_write_b128 v10, v[112:115]
    s_mov_b64 exec, -1
    v_add_f32 v32, v32, v36
    v_add_f32 v33, v33, v37
    v_add_f32 v34, v34, v38
    v_add_f32 v35, v35, v39
    v_add_f32 v32, v32, v34
    v_add_f32 v33, v33, v35
    v_add_f32 v32, v32, v33
    v_mov_b32 v65, v32
    s_nop 1
    v_add_f32_dpp v65, v65, v65 row_ror:1 row_mask:0xf bank_mask:0xf
    s_nop 1
    v_add_f32_dpp v65, v65, v65 row_ror:2 row_mask:0xf bank_mask:0xf
    s_nop 1
    v_add_f32_dpp v65, v65, v65 row_ror:4 row_mask:0xf bank_mask:0xf
    s_nop 1
    v_add_f32_dpp v65, v65, v65 row_ror:8 row_mask:0xf bank_mask:0xf
    v_mov_b32 v11, v65
    s_nop 1
    v_permlane32_swap_b32 v65, v11
    v_add_f32 v65, v65, v11
    v_mov_b32 v11, v65
    s_nop 1
    v_permlane16_swap_b32 v65, v11
    v_add_f32 v65, v65, v11
    v_mov_b32 v8, 0x24200
    s_mov_b32 s80, 1600000
LW_84:
    ds_read_b32 v9, v8
    s_waitcnt lgkmcnt(0)
    v_readfirstlane_b32 s79, v9
    s_cmp_ge_u32 s79, 16
    s_cbranch_scc1 LWD_85
    s_sleep 1
    s_sub_u32 s80, s80, 1
    s_cmp_lg_u32 s80, 0
    s_cbranch_scc1 LW_84
LWD_85:
    s_and_b32 s101, s79, 15
    v_mov_b32 v66, s92
    v_mov_b32 v67, s93
    s_lshl_b32 s7, s4, 2
    s_add_u32 s7, s7, s66
    s_lshl_b32 s7, s7, 3
    s_add_u32 s7, s7, s5
    s_lshl_b32 s7, s7, 4
    s_add_u32 s7, s7, 0x24000
    v_mov_b32 v8, s7
    s_mov_b64 exec, 1
    s_cmp_eq_u32 s101, 0
    s_cbranch_scc1 SU_86
    buffer_store_dwordx4 v[64:67], v8, s[36:39], 0 offen
SV_87:
    s_mov_b64 exec, -1
    s_and_b32 s7, s7, -128
    v_lshl_add_u32 v12, v1, 4, s7
    v_or_b32 v70, 1, v66
    v_mov_b32 v71, v67
    v_mov_b32 v116, 0xff800000
    v_mov_b32 v117, 0
    v_mov_b32 v72, 0
    v_mov_b32 v73, 0
    v_mov_b32 v74, 0
    v_mov_b32 v75, 0
    v_mov_b32 v76, 0
    v_mov_b32 v77, 0
    v_mov_b32 v78, 0
    v_mov_b32 v79, 0
    v_mov_b32 v80, 0
    v_mov_b32 v81, 0
    v_mov_b32 v82, 0
    v_mov_b32 v83, 0
    v_mov_b32 v84, 0
    v_mov_b32 v85, 0
    v_mov_b32 v86, 0
    v_mov_b32 v87, 0
    v_mov_b32 v88, 0
    v_mov_b32 v89, 0
    v_mov_b32 v90, 0
    v_mov_b32 v91, 0
    v_mov_b32 v92, 0
    v_mov_b32 v93, 0
    v_mov_b32 v94, 0
    v_mov_b32 v95, 0
    v_mov_b32 v96, 0
    v_mov_b32 v97, 0
    v_mov_b32 v98, 0
    v_mov_b32 v99, 0
    v_mov_b32 v100, 0
    v_mov_b32 v101, 0
    v_mov_b32 v102, 0
    v_mov_b32 v103, 0
    s_lshl_b32 s7, s4, 4
    s_add_u32 s7, s7, s5
    s_lshl_b32 s7, s7, 2
    s_add_u32 s7, s7, s66
    s_lshl_b32 s7, s7, 9
    s_add_u32 s7, s7, 0x100000
    v_lshl_add_u32 v6, v1, 4, s7
    s_cmp_lt_u32 s5, 4
    s_cbranch_scc1 AE_88
    v_mov_b32 v13, 0
    s_mov_b64 exec, 0x01010101
    buffer_store_dword v13, v6, s[36:39], 0 offen
    buffer_load_dword v13, v6, s[36:39], 0 offen sc1 nt
    s_mov_b64 exec, -1
AE_88:
    s_add_u32 s69, s73, s61
    s_lshl_b32 s70, s74, 3
    s_cmp_ge_u32 s69, 16
    s_cselect_b32 s7, 16, 0
    s_sub_u32 s69, s69, s7
    s_mov_b32 s71, s68
AV_89:
    s_lshl_b32 s7, s69, 13
    v_add_u32 v104, s7, v5
    v_xor_b32 v105, 0x20, v104
    v_xor_b32 v106, 0x40, v104
    v_xor_b32 v107, 0x60, v104
    v_xor_b32 v108, 0x80, v104
    v_xor_b32 v109, 0xa0, v104
    v_xor_b32 v110, 0xc0, v104
    v_xor_b32 v111, 0xe0, v104
    s_and_b32 s62, s69, 12
    s_add_u32 s62, s62, 0x24100
    ds_read_b128 v[112:115], v7
    v_add_u32 v7, 64, v7
    s_cmp_le_u32 s71, 2
    s_cbranch_scc1 AW_90
AWB_91:
    v_mov_b32 v8, 0x24000
    s_mov_b32 s80, 1600000
LW_92:
    ds_read_b32 v9, v8
    s_waitcnt lgkmcnt(0)
    v_readfirstlane_b32 s79, v9
    s_cmp_ge_u32 s79, s70
    s_cbranch_scc1 LWD_93
    s_sleep 1
    s_sub_u32 s80, s80, 1
    s_cmp_lg_u32 s80, 0
    s_cbranch_scc1 LW_92
LWD_93:
    ds_read_b64_tr_b16 v[32:33], v104
    ds_read_b64_tr_b16 v[34:35], v104 offset:4096
    ds_read_b64_tr_b16 v[36:37], v105
    ds_read_b64_tr_b16 v[38:39], v105 offset:4096
    ds_read_b64_tr_b16 v[40:41], v106
    ds_read_b64_tr_b16 v[42:43], v106 offset:4096
    ds_read_b64_tr_b16 v[44:45], v107
    ds_read_b64_tr_b16 v[46:47], v107 offset:4096
    ds_read_b64_tr_b16 v[48:49], v108
    ds_read_b64_tr_b16 v[50:51], v108 offset:4096
    ds_read_b64_tr_b16 v[52:53], v109
    ds_read_b64_tr_b16 v[54:55], v109 offset:4096
    ds_read_b64_tr_b16 v[56:57], v110
    ds_read_b64_tr_b16 v[58:59], v110 offset:4096
    s_waitcnt lgkmcnt(12)
    v_mfma_f32_16x16x32_bf16 v[72:75], v[112:115], v[32:35], v[72:75]
    ds_read_b64_tr_b16 v[60:61], v111
    ds_read_b64_tr_b16 v[62:63], v111 offset:4096
    s_waitcnt lgkmcnt(12)
    v_mfma_f32_16x16x32_bf16 v[76:79], v[112:115], v[36:39], v[76:79]
    s_waitcnt lgkmcnt(10)
    v_mfma_f32_16x16x32_bf16 v[80:83], v[112:115], v[40:43], v[80:83]
    s_waitcnt lgkmcnt(8)
    v_mfma_f32_16x16x32_bf16 v[84:87], v[112:115], v[44:47], v[84:87]
    s_waitcnt lgkmcnt(6)
    v_mfma_f32_16x16x32_bf16 v[88:91], v[112:115], v[48:51], v[88:91]
    s_waitcnt lgkmcnt(4)
    v_mfma_f32_16x16x32_bf16 v[92:95], v[112:115], v[52:55], v[92:95]
    s_waitcnt lgkmcnt(2)
    v_mfma_f32_16x16x32_bf16 v[96:99], v[112:115], v[56:59], v[96:99]
    s_waitcnt lgkmcnt(0)
    v_mfma_f32_16x16x32_bf16 v[100:103], v[112:115], v[60:63], v[100:103]
    v_mov_b32 v8, s62
    v_mov_b32 v9, 1
    s_mov_b64 exec, 1
    ds_add_u32 v8, v9
    s_mov_b64 exec, -1
    s_add_u32 s69, s69, 4
    s_cmp_ge_u32 s69, 16
    s_cselect_b32 s7, 16, 0
    s_sub_u32 s69, s69, s7
    s_add_u32 s70, s70, 32
    s_sub_u32 s71, s71, 1
    s_cmp_lg_u32 s71, 0
    s_cbranch_scc1 AV_89
    v_mov_b32_dpp v72, v88 quad_perm:[0,1,2,3] row_mask:0x2 bank_mask:0xf
    v_mov_b32_dpp v76, v92 quad_perm:[0,1,2,3] row_mask:0x2 bank_mask:0xf
    v_mov_b32_dpp v80, v96 quad_perm:[0,1,2,3] row_mask:0x2 bank_mask:0xf
    v_mov_b32_dpp v84, v100 quad_perm:[0,1,2,3] row_mask:0x2 bank_mask:0xf
    v_mul_f32 v72, s72, v72
    v_mul_f32 v76, s72, v76
    v_mul_f32 v80, s72, v80
    v_mul_f32 v84, s72, v84
    v_cvt_pk_bf16_f32 v68, v72, v76
    v_cvt_pk_bf16_f32 v69, v80, v84
    s_mov_b64 exec, 0xffffffff
    s_cmp_eq_u32 s101, 0
    s_cbranch_scc1 SU_94
    buffer_store_dwordx4 v[68:71], v6, s[36:39], 0 offen
SV_95:
    s_mov_b64 exec, -1
    v_mov_b32 v8, 0x24214
    v_mov_b32 v9, 1
    s_mov_b64 exec, 1
    ds_add_u32 v8, v9
    s_mov_b64 exec, -1
    s_endpgm
L_ASVC:
    v_bfe_u32 v24, v1, 2, 2
    v_lshl_add_u32 v4, v24, 4, v2
    v_lshlrev_b32 v4, 8, v4
    v_and_b32 v25, 1, v2
    v_lshl_or_b32 v24, v24, 1, v25
    s_lshl_b32 s7, s61, 1
    v_xor_b32 v24, s7, v24
    v_lshl_add_u32 v4, v24, 5, v4
    v_and_b32 v24, 3, v1
    v_lshl_add_u32 v4, v24, 3, v4
    v_add_u32 v4, 0x0, v4
    v_xor_b32 v9, 32, v4
    v_lshlrev_b32 v8, 16, v24
    v_and_b32 v26, 4, v1
    v_lshl_add_u32 v8, v26, 4, v8
    v_lshl_add_u32 v8, v2, 4, v8
    s_lshl_b32 s7, s5, 2
    s_add_u32 s7, s7, s61
    s_lshl_b32 s7, s7, 5
    s_add_u32 s7, s7, s4
    s_lshl_b32 s7, s7, 7
    s_add_u32 s7, s7, 0x280000
    v_add_u32 v8, s7, v8
    v_cmp_gt_u32 s[84:85], 8, v3
    s_lshl_b32 s7, s4, 15
    s_lshl_b32 s62, s61, 9
    s_add_u32 s7, s7, s62
    s_add_u32 s7, s7, 0x100000
    v_and_b32 v26, 31, v1
    v_lshl_add_u32 v5, v26, 4, s7
    v_lshrrev_b32 v26, 5, v1
    v_lshl_add_u32 v5, v26, 11, v5
    s_mul_i32 s7, s61, 320
    s_add_u32 s7, s7, 0x26600
    v_lshl_add_u32 v6, v3, 4, s7
    v_lshl_add_u32 v6, v25, 3, v6
    v_lshl_add_u32 v6, v26, 2, v6
    v_mul_u32_u24 v7, 320, v24
    v_lshl_add_u32 v7, v2, 4, v7
    v_add_u32 v7, 0x26600, v7
    s_or_b64 s[94:95], s[92:93], 1
    v_mov_b32 v18, s92
    v_mov_b32 v19, s93
    s_mov_b32 s62, 4096
    s_mov_b32 s63, 8192
    s_mov_b32 s70, 0x3f80
    s_mov_b32 s71, 0x3f800000
    v_mov_b32 v28, 0x24214
    s_mov_b32 s80, 1600000
LW_96:
    ds_read_b32 v29, v28
    s_waitcnt lgkmcnt(0)
    v_readfirstlane_b32 s79, v29
    s_cmp_ge_u32 s79, 4
    s_cbranch_scc1 LWD_97
    s_sleep 2
    s_sub_u32 s80, s80, 1
    s_cmp_lg_u32 s80, 0
    s_cbranch_scc1 LW_96
LWD_97:
    s_setprio 2
    s_mov_b64 exec, -1
    buffer_load_dwordx4 v[112:115], v5, s[36:39], 0 offen sc1 nt
    buffer_load_dwordx4 v[116:119], v5, s[36:39], s62 offen sc1 nt
    buffer_load_dwordx4 v[120:123], v5, s[36:39], s63 offen sc1 nt
    v_mov_b32 v28, 0x24000
    s_mov_b32 s80, 1600000
LW_101:
    ds_read_b32 v29, v28
    s_waitcnt lgkmcnt(0)
    v_readfirstlane_b32 s79, v29
    s_cmp_ge_u32 s79, 416
    s_cbranch_scc1 LWD_102
    s_sub_u32 s80, s80, 1
    s_cmp_lg_u32 s80, 0
    s_cbranch_scc1 LW_101
LWD_102:
    ds_read_b64_tr_b16 v[32:33], v4 offset:0
    ds_read_b64_tr_b16 v[34:35], v4 offset:16384
    ds_read_b64_tr_b16 v[48:49], v9 offset:0
    ds_read_b64_tr_b16 v[50:51], v9 offset:16384
    ds_read_b64_tr_b16 v[36:37], v4 offset:1024
    ds_read_b64_tr_b16 v[38:39], v4 offset:17408
    ds_read_b64_tr_b16 v[52:53], v9 offset:1024
    ds_read_b64_tr_b16 v[54:55], v9 offset:17408
    ds_read_b64_tr_b16 v[40:41], v4 offset:2048
    ds_read_b64_tr_b16 v[42:43], v4 offset:18432
    ds_read_b64_tr_b16 v[56:57], v9 offset:2048
    ds_read_b64_tr_b16 v[58:59], v9 offset:18432
    ds_read_b64_tr_b16 v[44:45], v4 offset:3072
    ds_read_b64_tr_b16 v[46:47], v4 offset:19456
    ds_read_b64_tr_b16 v[60:61], v9 offset:3072
    ds_read_b64_tr_b16 v[62:63], v9 offset:19456
    s_mov_b32 s80, 200000
MC_99:
    s_mov_b64 exec, -1
    s_waitcnt vmcnt(0)
    v_cmp_ne_u64 s[64:65], s[94:95], v[114:115]
    v_cmp_ne_u64 s[66:67], s[94:95], v[118:119]
    v_cmp_ne_u64 s[68:69], s[94:95], v[122:123]
    s_or_b64 s[90:91], s[64:65], s[66:67]
    s_or_b64 s[90:91], s[90:91], s[68:69]
    s_cbranch_scc1 M_98
MD_100:
    s_mov_b64 exec, -1
    v_dot2_f32_bf16 v104, v112, s70, 0
    v_dot2_f32_bf16 v105, v112, s71, 0
    v_dot2_f32_bf16 v106, v113, s70, 0
    v_dot2_f32_bf16 v107, v113, s71, 0
    v_dot2_f32_bf16 v104, v116, s70, v104
    v_dot2_f32_bf16 v105, v116, s71, v105
    v_dot2_f32_bf16 v106, v117, s70, v106
    v_dot2_f32_bf16 v107, v117, s71, v107
    v_dot2_f32_bf16 v104, v120, s70, v104
    v_dot2_f32_bf16 v105, v120, s71, v105
    v_dot2_f32_bf16 v106, v121, s70, v106
    v_dot2_f32_bf16 v107, v121, s71, v107
    s_nop 1
    v_permlane32_swap_b32 v104, v106
    v_permlane32_swap_b32 v105, v107
    v_add_f32 v104, v104, v106
    v_add_f32 v105, v105, v107
    v_cvt_pk_bf16_f32 v104, v104, v105
    ds_write_b32 v6, v104
    s_add_u32 s81, s81, 4
    v_mov_b32 v24, 0x2420c
    v_mov_b32 v25, 1
    s_mov_b64 exec, 1
    ds_add_u32 v24, v25
    s_mov_b64 exec, -1
    v_mov_b32 v24, 0x2420c
    s_mov_b32 s80, 1600000
LW_103:
    ds_read_b32 v25, v24
    s_waitcnt lgkmcnt(0)
    v_readfirstlane_b32 s79, v25
    s_cmp_ge_u32 s79, s81
    s_cbranch_scc1 LWD_104
    s_sub_u32 s80, s80, 1
    s_cmp_lg_u32 s80, 0
    s_cbranch_scc1 LW_103
LWD_104:
    ds_read_b128 v[64:67], v7 offset:0
    ds_read_b128 v[68:71], v7 offset:64
    ds_read_b128 v[72:75], v7 offset:128
    ds_read_b128 v[76:79], v7 offset:192
    s_waitcnt lgkmcnt(3)
    v_mfma_f32_16x16x32_bf16 v[96:99], v[32:35], v[64:67], 0
    v_mfma_f32_16x16x32_bf16 v[100:103], v[48:51], v[64:67], 0
    s_waitcnt lgkmcnt(2)
    v_mfma_f32_16x16x32_bf16 v[96:99], v[36:39], v[68:71], v[96:99]
    v_mfma_f32_16x16x32_bf16 v[100:103], v[52:55], v[68:71], v[100:103]
    s_waitcnt lgkmcnt(1)
    v_mfma_f32_16x16x32_bf16 v[96:99], v[40:43], v[72:75], v[96:99]
    v_mfma_f32_16x16x32_bf16 v[100:103], v[56:59], v[72:75], v[100:103]
    s_waitcnt lgkmcnt(0)
    v_mfma_f32_16x16x32_bf16 v[96:99], v[44:47], v[76:79], v[96:99]
    v_mfma_f32_16x16x32_bf16 v[100:103], v[60:63], v[76:79], v[100:103]
    s_nop 6
    v_cvt_pk_bf16_f32 v16, v96, v97
    v_cvt_pk_bf16_f32 v17, v98, v99
    v_cvt_pk_bf16_f32 v104, v100, v101
    v_cvt_pk_bf16_f32 v105, v102, v103
    s_nop 0
    v_mov_b32_dpp v16, v104 quad_perm:[0,1,2,3] row_mask:0xf bank_mask:0x2
    v_mov_b32_dpp v17, v105 quad_perm:[0,1,2,3] row_mask:0xf bank_mask:0x2
    s_mov_b64 exec, s[84:85]
    buffer_store_dwordx4 v[16:19], v8, s[36:39], 0 offen sc1
    s_mov_b64 exec, -1
    s_branch L_RED
L_QABS:
    s_and_b32 s61, s6, 3
    s_waitcnt lgkmcnt(0)
    s_mov_b32 s36, s34
    s_and_b32 s37, s35, 0xffff
    s_mov_b32 s38, 0x1000000
    s_mov_b32 s39, 0x20000
    s_barrier
    s_cmp_ge_u32 s5, 6
    s_cbranch_scc1 L_BATT
    v_and_b32 v8, 3, v1
    v_lshlrev_b32 v5, 15, v8
    v_lshl_add_u32 v5, v2, 3, v5
    v_lshrrev_b32 v10, 2, v3
    v_lshl_add_u32 v5, v10, 5, v5
    s_lshl_b32 s7, s4, 1
    s_add_u32 s7, s7, s5
    s_lshl_b32 s7, s7, 2
    s_add_u32 s7, s7, s61
    s_lshl_b32 s7, s7, 7
    s_sub_u32 s7, s7, 2048
    v_add_u32 v5, s7, v5
    s_or_b32 s95, s95, s78
    s_add_u32 s72, s94, 0x10000
    s_addc_u32 s73, s95, 0
    s_lshl_b32 s7, s4, 15
    s_lshl_b32 s63, s61, 9
    s_add_u32 s7, s7, s63
    s_add_u32 s7, s7, 0x104000
    v_and_b32 v20, 31, v1
    v_lshl_add_u32 v7, v20, 4, s7
    v_lshrrev_b32 v21, 5, v1
    v_lshl_add_u32 v7, v21, 11, v7
    v_add_u32 v22, 4096, v7
    s_mul_i32 s7, s61, 320
    s_add_u32 s63, s7, 0x24900
    v_lshl_add_u32 v6, v20, 3, s63
    v_lshl_add_u32 v6, v21, 2, v6
    s_mov_b32 s70, 0x3f80
    s_mov_b32 s71, 0x3f800000
    v_xor_b32 v10, v3, v2
    v_lshlrev_b32 v10, 4, v10
    v_lshl_add_u32 v10, v3, 8, v10
    s_lshl_b32 s7, s61, 14
    s_add_u32 s7, s7, 0x10000
    v_add_u32 v10, s7, v10
    s_lshl_b32 s65, s61, 4
    s_add_u32 s65, s65, 16
    s_and_b32 s64, s61, 2
    s_lshl_b32 s64, s64, 1
    s_add_u32 s64, s64, 0x24108
    v_mul_u32_u24 v9, 320, v8
    v_lshl_add_u32 v9, v2, 4, v9
    v_add_u32 v9, 0x24900, v9
    v_mov_b32 v12, 0x24000
    s_mov_b32 s80, 1600000
LW_106:
    ds_read_b32 v13, v12
    s_waitcnt lgkmcnt(0)
    v_readfirstlane_b32 s79, v13
    s_cmp_ge_u32 s79, 40
    s_cbranch_scc1 LWD_107
    s_sleep 1
    s_sub_u32 s80, s80, 1
    s_cmp_lg_u32 s80, 0
    s_cbranch_scc1 LW_106
LWD_107:
    s_mov_b64 exec, -1
    buffer_load_dwordx4 v[48:51], v7, s[36:39], 0 offen sc1 nt
    buffer_load_dwordx4 v[52:55], v22, s[36:39], 0 offen sc1 nt
    s_mov_b32 s80, 200000
MC_109:
    s_mov_b64 exec, -1
    s_waitcnt vmcnt(0)
    v_cmp_gt_u64 s[44:45], s[94:95], v[50:51]
    v_cmp_le_u64 vcc, s[72:73], v[50:51]
    s_or_b64 s[44:45], s[44:45], vcc
    v_cmp_gt_u64 s[46:47], s[94:95], v[54:55]
    v_cmp_le_u64 vcc, s[72:73], v[54:55]
    s_or_b64 s[46:47], s[46:47], vcc
    s_or_b64 s[90:91], s[44:45], s[46:47]
    s_cbranch_scc1 M_108
MD_110:
    s_mov_b64 exec, -1
    v_dot2_f32_bf16 v24, v48, s70, 0
    v_dot2_f32_bf16 v25, v48, s71, 0
    v_dot2_f32_bf16 v26, v49, s70, 0
    v_dot2_f32_bf16 v27, v49, s71, 0
    v_dot2_f32_bf16 v24, v52, s70, v24
    v_dot2_f32_bf16 v25, v52, s71, v25
    v_dot2_f32_bf16 v26, v53, s70, v26
    v_dot2_f32_bf16 v27, v53, s71, v27
    s_nop 1
    v_permlane32_swap_b32 v24, v26
    v_permlane32_swap_b32 v25, v27
    v_add_f32 v24, v24, v26
    v_add_f32 v25, v25, v27
    v_cvt_pk_bf16_f32 v24, v24, v25
    ds_write_b32 v6, v24
    v_mov_b32 v48, 0x24208
    v_mov_b32 v49, 1
    s_mov_b64 exec, 1
    ds_add_u32 v48, v49
    s_mov_b64 exec, -1
    v_mov_b32 v12, 0x24000
    s_mov_b32 s80, 1600000
LW_111:
    ds_read_b32 v13, v12
    s_waitcnt lgkmcnt(0)
    v_readfirstlane_b32 s79, v13
    s_cmp_ge_u32 s79, s65
    s_cbranch_scc1 LWD_112
    s_sub_u32 s80, s80, 1
    s_cmp_lg_u32 s80, 0
    s_cbranch_scc1 LW_111
LWD_112:
    v_xor_b32 v11, 0x0, v10
    ds_read_b128 v[64:67], v11 offset:0
    ds_read_b128 v[80:83], v11 offset:4096
    ds_read_b128 v[96:99], v11 offset:8192
    ds_read_b128 v[112:115], v11 offset:12288
    v_xor_b32 v11, 0x40, v10
    ds_read_b128 v[68:71], v11 offset:0
    ds_read_b128 v[84:87], v11 offset:4096
    ds_read_b128 v[100:103], v11 offset:8192
    ds_read_b128 v[116:119], v11 offset:12288
    v_xor_b32 v11, 0x80, v10
    ds_read_b128 v[72:75], v11 offset:0
    ds_read_b128 v[88:91], v11 offset:4096
    ds_read_b128 v[104:107], v11 offset:8192
    ds_read_b128 v[120:123], v11 offset:12288
    v_xor_b32 v11, 0xc0, v10
    ds_read_b128 v[76:79], v11 offset:0
    ds_read_b128 v[92:95], v11 offset:4096
    ds_read_b128 v[108:111], v11 offset:8192
    ds_read_b128 v[124:127], v11 offset:12288
    v_mov_b32 v12, s64
    v_mov_b32 v13, 2
    s_mov_b64 exec, 1
    ds_add_u32 v12, v13
    s_mov_b64 exec, -1
    v_mov_b32 v12, 0x24208
    s_mov_b32 s80, 1600000
LW_113:
    ds_read_b32 v13, v12
    s_waitcnt lgkmcnt(0)
    v_readfirstlane_b32 s79, v13
    s_cmp_ge_u32 s79, 20
    s_cbranch_scc1 LWD_114
    s_sub_u32 s80, s80, 1
    s_cmp_lg_u32 s80, 0
    s_cbranch_scc1 LW_113
LWD_114:
    ds_read_b128 v[48:51], v9 offset:0
    ds_read_b128 v[52:55], v9 offset:64
    ds_read_b128 v[56:59], v9 offset:128
    ds_read_b128 v[60:63], v9 offset:192
    s_waitcnt lgkmcnt(3)
    v_mfma_f32_16x16x32_bf16 v[128:131], v[64:67], v[48:51], 0
    v_mfma_f32_16x16x32_bf16 v[132:135], v[80:83], v[48:51], 0
    v_mfma_f32_16x16x32_bf16 v[136:139], v[96:99], v[48:51], 0
    v_mfma_f32_16x16x32_bf16 v[140:143], v[112:115], v[48:51], 0
    s_waitcnt lgkmcnt(2)
    v_mfma_f32_16x16x32_bf16 v[128:131], v[68:71], v[52:55], v[128:131]
    v_mfma_f32_16x16x32_bf16 v[132:135], v[84:87], v[52:55], v[132:135]
    v_mfma_f32_16x16x32_bf16 v[136:139], v[100:103], v[52:55], v[136:139]
    v_mfma_f32_16x16x32_bf16 v[140:143], v[116:119], v[52:55], v[140:143]
    s_waitcnt lgkmcnt(1)
    v_mfma_f32_16x16x32_bf16 v[128:131], v[72:75], v[56:59], v[128:131]
    v_mfma_f32_16x16x32_bf16 v[132:135], v[88:91], v[56:59], v[132:135]
    v_mfma_f32_16x16x32_bf16 v[136:139], v[104:107], v[56:59], v[136:139]
    v_mfma_f32_16x16x32_bf16 v[140:143], v[120:123], v[56:59], v[140:143]
    s_waitcnt lgkmcnt(0)
    v_mfma_f32_16x16x32_bf16 v[128:131], v[76:79], v[60:63], v[128:131]
    v_mfma_f32_16x16x32_bf16 v[132:135], v[92:95], v[60:63], v[132:135]
    v_mfma_f32_16x16x32_bf16 v[136:139], v[108:111], v[60:63], v[136:139]
    v_mfma_f32_16x16x32_bf16 v[140:143], v[124:127], v[60:63], v[140:143]
    s_nop 4
    v_cvt_pk_bf16_f32 v24, v128, v129
    v_cvt_pk_bf16_f32 v25, v130, v131
    v_cvt_pk_bf16_f32 v26, v132, v133
    v_cvt_pk_bf16_f32 v27, v134, v135
    v_cvt_pk_bf16_f32 v28, v136, v137
    v_cvt_pk_bf16_f32 v29, v138, v139
    v_cvt_pk_bf16_f32 v30, v140, v141
    v_cvt_pk_bf16_f32 v31, v142, v143
    v_mov_b32_dpp v24, v26 quad_perm:[0,1,2,3] row_mask:0xf bank_mask:0x2
    v_mov_b32_dpp v25, v27 quad_perm:[0,1,2,3] row_mask:0xf bank_mask:0x2
    v_mov_b32_dpp v24, v28 quad_perm:[0,1,2,3] row_mask:0xf bank_mask:0x4
    v_mov_b32_dpp v25, v29 quad_perm:[0,1,2,3] row_mask:0xf bank_mask:0x4
    v_mov_b32_dpp v24, v30 quad_perm:[0,1,2,3] row_mask:0xf bank_mask:0x8
    v_mov_b32_dpp v25, v31 quad_perm:[0,1,2,3] row_mask:0xf bank_mask:0x8
    buffer_store_dwordx2 v[24:25], v5, s[36:39], 0 offen sc1
    v_mov_b32 v48, 0x24208
    v_mov_b32 v49, 32
    s_mov_b64 exec, 1
    ds_add_u32 v48, v49
    s_mov_b64 exec, -1
L_ESVC:
    v_lshrrev_b32 v160, 2, v1
    v_and_b32 v161, 7, v160
    s_lshl_b32 s7, s61, 1
    v_xor_b32 v161, s7, v161
    v_lshlrev_b32 v161, 5, v161
    v_lshl_add_u32 v161, v160, 8, v161
    v_and_b32 v162, 3, v1
    v_lshl_add_u32 v161, v162, 3, v161
    v_lshrrev_b32 v163, 5, v1
    s_lshl_b32 s7, s61, 8
    s_lshl_b32 s62, s4, 10
    s_add_u32 s7, s7, s62
    s_add_u32 s62, s7, 0x30000
    v_lshl_add_u32 v4, v163, 7, s62
    s_lshl_b32 s7, s7, 3
    s_lshl_b32 s62, s5, 9
    s_add_u32 s7, s7, s62
    s_add_u32 s7, s7, 0x1ff800
    v_and_b32 v164, 31, v1
    v_lshl_add_u32 v5, v164, 4, s7
    v_lshl_add_u32 v5, v163, 10, v5
    s_mul_i32 s7, s61, 576
    s_add_u32 s7, s7, 0x26600
    v_lshrrev_b32 v164, 2, v164
    v_lshl_add_u32 v6, v164, 6, s7
    v_lshl_add_u32 v6, v163, 4, v6
    v_and_b32 v164, 1, v1
    v_lshl_add_u32 v6, v164, 5, v6
    v_and_b32 v164, 2, v1
    v_lshl_add_u32 v6, v164, 2, v6
    v_mul_u32_u24 v7, 576, v162
    v_lshl_add_u32 v7, v2, 4, v7
    v_add_u32 v7, 0x26600, v7
    v_cmp_gt_u32 s[84:85], 8, v3
    s_and_b32 s62, s4, 7
    s_lshl_b32 s62, s62, 3
    s_lshr_b32 s7, s4, 3
    s_lshl_b32 s7, s7, 1
    s_add_u32 s62, s62, s7
    s_add_u32 s62, s62, s5
    s_sub_u32 s62, s62, 6
    s_add_u32 s62, s62, 2
    s_lshl_b32 s7, s62, 11
    s_lshl_b32 s64, s61, 9
    s_add_u32 s7, s7, s64
    s_add_u32 s7, s7, 0xc0000
    v_lshl_add_u32 v10, v3, 6, s7
    v_lshl_add_u32 v10, v2, 4, v10
    s_lshr_b32 s7, s62, 3
    s_lshl_b32 s7, s7, 7
    s_add_u32 s7, s7, 0x22000
    v_and_b32 v164, 7, v1
    v_lshl_add_u32 v9, v164, 3, s7
    v_mov_b32 v16, 0x24204
    s_mov_b32 s80, 1600000
LW_115:
    ds_read_b32 v17, v16
    s_waitcnt lgkmcnt(0)
    v_readfirstlane_b32 s79, v17
    s_cmp_ge_u32 s79, 1
    s_cbranch_scc1 LWD_116
    s_sleep 1
    s_sub_u32 s80, s80, 1
    s_cmp_lg_u32 s80, 0
    s_cbranch_scc1 LW_115
LWD_116:
    v_mov_b32 v16, 0x24248
    ds_read_b64 v[18:19], v16
    s_waitcnt lgkmcnt(0)
    v_readfirstlane_b32 s92, v18
    v_readfirstlane_b32 s93, v19
    v_mov_b32 v16, 0x24000
    s_mov_b32 s80, 1600000
LW_117:
    ds_read_b32 v17, v16
    s_waitcnt lgkmcnt(0)
    v_readfirstlane_b32 s79, v17
    s_cmp_ge_u32 s79, 128
    s_cbranch_scc1 LWD_118
    s_sleep 4
    s_sub_u32 s80, s80, 1
    s_cmp_lg_u32 s80, 0
    s_cbranch_scc1 LW_117
LWD_118:
    v_xor_b32 v162, 32, v161
    ds_read_b64_tr_b16 v[32:33], v161 offset:0
    ds_read_b64_tr_b16 v[34:35], v161 offset:4096
    ds_read_b64_tr_b16 v[36:37], v162 offset:0
    ds_read_b64_tr_b16 v[38:39], v162 offset:4096
    ds_read_b64_tr_b16 v[40:41], v161 offset:8192
    ds_read_b64_tr_b16 v[42:43], v161 offset:12288
    ds_read_b64_tr_b16 v[44:45], v162 offset:8192
    ds_read_b64_tr_b16 v[46:47], v162 offset:12288
    s_waitcnt lgkmcnt(4)
    ds_read_b64_tr_b16 v[48:49], v161 offset:16384
    ds_read_b64_tr_b16 v[50:51], v161 offset:20480
    ds_read_b64_tr_b16 v[52:53], v162 offset:16384
    ds_read_b64_tr_b16 v[54:55], v162 offset:20480
    ds_read_b64_tr_b16 v[56:57], v161 offset:24576
    ds_read_b64_tr_b16 v[58:59], v161 offset:28672
    ds_read_b64_tr_b16 v[60:61], v162 offset:24576
    ds_read_b64_tr_b16 v[62:63], v162 offset:28672
    s_waitcnt lgkmcnt(4)
    ds_read_b64_tr_b16 v[64:65], v161 offset:32768
    ds_read_b64_tr_b16 v[66:67], v161 offset:36864
    ds_read_b64_tr_b16 v[68:69], v162 offset:32768
    ds_read_b64_tr_b16 v[70:71], v162 offset:36864
    ds_read_b64_tr_b16 v[72:73], v161 offset:40960
    ds_read_b64_tr_b16 v[74:75], v161 offset:45056
    ds_read_b64_tr_b16 v[76:77], v162 offset:40960
    ds_read_b64_tr_b16 v[78:79], v162 offset:45056
    s_waitcnt lgkmcnt(4)
    ds_read_b64_tr_b16 v[80:81], v161 offset:49152
    ds_read_b64_tr_b16 v[82:83], v161 offset:53248
    ds_read_b64_tr_b16 v[84:85], v162 offset:49152
    ds_read_b64_tr_b16 v[86:87], v162 offset:53248
    ds_read_b64_tr_b16 v[88:89], v161 offset:57344
    ds_read_b64_tr_b16 v[90:91], v161 offset:61440
    ds_read_b64_tr_b16 v[92:93], v162 offset:57344
    ds_read_b64_tr_b16 v[94:95], v162 offset:61440
    s_waitcnt lgkmcnt(4)
    v_lshlrev_b32 v16, 2, v1
    v_add_u32 v16, 0x24100, v16
    v_mov_b32 v17, 1
    s_mov_b64 exec, 3
    ds_add_u32 v16, v17
    s_mov_b64 exec, -1
    s_lshl_b32 s7, s62, 2
    s_add_u32 s7, s7, s61
    s_lshl_b32 s7, s7, 13
    s_add_u32 s7, s7, 0x600000
    v_lshl_add_u32 v8, v1, 7, s7
    buffer_load_dword v8, v8, s[36:39], 0 offen sc1 nt
    s_lshl_b32 s7, s4, 7
    s_add_u32 s7, s7, 0x21000
    v_lshl_add_u32 v16, v1, 3, s7
    s_or_b32 s95, s95, s78
    s_add_u32 s88, s94, 0x10000
    s_addc_u32 s89, s95, 0
    s_mov_b32 s101, 6
    s_mov_b64 exec, 0x3f
U_119:
    buffer_load_dwordx2 v[18:19], v16, s[36:39], 0 offen sc1 nt
UU_120:
    s_waitcnt vmcnt(0)
    v_cmp_gt_u64 s[90:91], s[94:95], v[18:19]
    v_cmp_le_u64 vcc, s[88:89], v[18:19]
    s_or_b64 vcc, vcc, s[90:91]
    s_cbranch_scc0 UD_121
    s_sleep 8
    s_sub_u32 s101, s101, 1
    s_cmp_lg_u32 s101, 0
    s_cbranch_scc1 U_119
UD_121:
    s_mov_b64 exec, -1
    s_min_u32 s7, s101, 1
    s_add_u32 s7, s7, 16
    v_mov_b32 v16, 0x24200
    v_mov_b32 v17, s7
    s_mov_b64 exec, 1
    ds_add_u32 v16, v17
    s_mov_b64 exec, -1
    s_or_b32 s95, s95, s78
    s_add_u32 s88, s94, 0x10000
    s_addc_u32 s89, s95, 0
    s_mov_b32 s101, 4
    s_mov_b64 exec, 0xff
U_122:
    buffer_load_dwordx2 v[16:17], v9, s[36:39], 0 offen sc1 nt
UU_123:
    s_waitcnt vmcnt(0)
    v_cmp_gt_u64 s[90:91], s[94:95], v[16:17]
    v_cmp_le_u64 vcc, s[88:89], v[16:17]
    s_or_b64 vcc, vcc, s[90:91]
    s_cbranch_scc0 UD_124
    s_sleep 8
    s_sub_u32 s101, s101, 1
    s_cmp_lg_u32 s101, 0
    s_cbranch_scc1 U_122
UD_124:
    s_mov_b64 exec, -1
    s_and_b32 s7, s4, 7
    s_lshl_b32 s7, s7, 12
    s_add_u32 s7, s7, 0x28008
    v_lshl_add_u32 v9, v1, 9, s7
    s_mov_b32 s86, 1
    s_mov_b32 s87, 1
    s_mov_b64 exec, s[86:87]
    buffer_load_dwordx2 v[12:13], v4, s[36:39], 0 offen offset:16 sc1
    s_mov_b32 s80, 200000
MC_126:
    s_mov_b64 exec, s[86:87]
    s_waitcnt vmcnt(0)
    v_cmp_ne_u64 s[64:65], s[92:93], v[12:13]
    s_cmp_lg_u64 s[64:65], 0
    s_cbranch_scc1 M_125
MD_127:
    s_mov_b64 exec, -1
    s_cmp_eq_u32 s101, 0
    s_cbranch_scc1 EH_128
    s_mov_b64 exec, 0xff
    buffer_load_dwordx2 v[12:13], v9, s[36:39], 0 offen sc1 nt
    s_mov_b32 s80, 200000
MC_130:
    s_mov_b64 exec, 0xff
    s_waitcnt vmcnt(0)
    v_cmp_ne_u64 s[64:65], s[92:93], v[12:13]
    s_cmp_lg_u64 s[64:65], 0
    s_cbranch_scc1 M_129
MD_131:
    s_mov_b64 exec, -1
EH_128:
    s_sleep 25
    s_setprio 2
    s_mov_b64 exec, -1
    buffer_load_dwordx4 v[16:19], v5, s[36:39], 0 offen sc1
    buffer_load_dwordx4 v[12:15], v4, s[36:39], 0 offen sc1
    s_mov_b32 s80, 200000
MC_133:
    s_mov_b64 exec, -1
    s_waitcnt vmcnt(0)
    v_max3_u32 v160, v16, v17, v18
    v_max_u32 v160, v160, v19
    v_cmp_eq_u32 s[64:65], -1, v160
    v_cmp_ne_u64 s[66:67], s[92:93], v[14:15]
    s_or_b64 s[90:91], s[64:65], s[66:67]
    s_cbranch_scc1 M_132
MD_134:
    s_mov_b64 exec, -1
    v_mov_b32 v160, v12
    v_mov_b32 v161, v12
    v_lshlrev_b32 v20, 16, v16
    v_lshlrev_b32 v22, 16, v17
    v_lshlrev_b32 v24, 16, v18
    v_lshlrev_b32 v26, 16, v19
    v_permlane32_swap_b32 v160, v161
    v_max_f32 v160, v160, v161
    v_sub_f32 v11, v12, v160
    v_exp_f32 v11, v11
    v_and_b32 v21, 0xffff0000, v16
    v_and_b32 v23, 0xffff0000, v17
    v_and_b32 v25, 0xffff0000, v18
    v_and_b32 v27, 0xffff0000, v19
    v_mul_f32 v160, v11, v13
    v_mov_b32 v161, v160
    s_nop 1
    v_permlane32_swap_b32 v160, v161
    v_add_f32 v160, v160, v161
    v_rcp_f32 v160, v160
    s_nop 0
    v_mul_f32 v11, v11, v160
    v_mul_f32 v20, v20, v11
    v_mul_f32 v21, v21, v11
    v_mul_f32 v22, v22, v11
    v_mul_f32 v23, v23, v11
    v_mul_f32 v24, v24, v11
    v_mul_f32 v25, v25, v11
    v_mul_f32 v26, v26, v11
    v_mul_f32 v27, v27, v11
    v_permlane32_swap_b32 v20, v24
    v_permlane32_swap_b32 v21, v25
    v_permlane32_swap_b32 v22, v26
    v_permlane32_swap_b32 v23, v27
    v_add_f32 v20, v20, v24
    v_add_f32 v21, v21, v25
    v_add_f32 v22, v22, v26
    v_add_f32 v23, v23, v27
    v_cvt_pk_bf16_f32 v20, v20, v21
    v_cvt_pk_bf16_f32 v21, v22, v23
    ds_write_b64 v6, v[20:21]
    s_add_u32 s81, s81, 4
    v_mov_b32 v160, 0x2420c
    v_mov_b32 v161, 1
    s_mov_b64 exec, 1
    ds_add_u32 v160, v161
    s_mov_b64 exec, -1
    v_mov_b32 v160, 0x2420c
    s_mov_b32 s80, 1600000
LW_135:
    ds_read_b32 v161, v160
    s_waitcnt lgkmcnt(0)
    v_readfirstlane_b32 s79, v161
    s_cmp_ge_u32 s79, s81
    s_cbranch_scc1 LWD_136
    s_sub_u32 s80, s80, 1
    s_cmp_lg_u32 s80, 0
    s_cbranch_scc1 LW_135
LWD_136:
    ds_read_b128 v[96:99], v7 offset:0
    ds_read_b128 v[100:103], v7 offset:64
    ds_read_b128 v[104:107], v7 offset:128
    ds_read_b128 v[108:111], v7 offset:192
    ds_read_b128 v[112:115], v7 offset:256
    ds_read_b128 v[116:119], v7 offset:320
    ds_read_b128 v[120:123], v7 offset:384
    ds_read_b128 v[124:127], v7 offset:448
    v_mov_b32 v18, s92
    v_mov_b32 v19, s93
    s_waitcnt lgkmcnt(7)
    v_mfma_f32_16x16x32_bf16 v[24:27], v[32:35], v[96:99], 0
    v_mfma_f32_16x16x32_bf16 v[28:31], v[36:39], v[96:99], 0
    s_waitcnt lgkmcnt(6)
    v_mfma_f32_16x16x32_bf16 v[24:27], v[40:43], v[100:103], v[24:27]
    v_mfma_f32_16x16x32_bf16 v[28:31], v[44:47], v[100:103], v[28:31]
    s_waitcnt lgkmcnt(5)
    v_mfma_f32_16x16x32_bf16 v[24:27], v[48:51], v[104:107], v[24:27]
    v_mfma_f32_16x16x32_bf16 v[28:31], v[52:55], v[104:107], v[28:31]
    s_waitcnt lgkmcnt(4)
    v_mfma_f32_16x16x32_bf16 v[24:27], v[56:59], v[108:111], v[24:27]
    v_mfma_f32_16x16x32_bf16 v[28:31], v[60:63], v[108:111], v[28:31]
    s_waitcnt lgkmcnt(3)
    v_mfma_f32_16x16x32_bf16 v[24:27], v[64:67], v[112:115], v[24:27]
    v_mfma_f32_16x16x32_bf16 v[28:31], v[68:71], v[112:115], v[28:31]
    s_waitcnt lgkmcnt(2)
    v_mfma_f32_16x16x32_bf16 v[24:27], v[72:75], v[116:119], v[24:27]
    v_mfma_f32_16x16x32_bf16 v[28:31], v[76:79], v[116:119], v[28:31]
    s_waitcnt lgkmcnt(1)
    v_mfma_f32_16x16x32_bf16 v[24:27], v[80:83], v[120:123], v[24:27]
    v_mfma_f32_16x16x32_bf16 v[28:31], v[84:87], v[120:123], v[28:31]
    s_waitcnt lgkmcnt(0)
    v_mfma_f32_16x16x32_bf16 v[24:27], v[88:91], v[124:127], v[24:27]
    v_mfma_f32_16x16x32_bf16 v[28:31], v[92:95], v[124:127], v[28:31]
    s_nop 6
    v_cvt_pk_bf16_f32 v16, v24, v25
    v_cvt_pk_bf16_f32 v17, v26, v27
    v_cvt_pk_bf16_f32 v20, v28, v29
    v_cvt_pk_bf16_f32 v21, v30, v31
    s_nop 0
    v_mov_b32_dpp v16, v20 quad_perm:[0,1,2,3] row_mask:0xf bank_mask:0x2
    v_mov_b32_dpp v17, v21 quad_perm:[0,1,2,3] row_mask:0xf bank_mask:0x2
    s_mov_b64 exec, s[84:85]
    s_cmp_eq_u32 s101, 0
    s_cbranch_scc1 SU_137
    buffer_store_dwordx4 v[16:19], v10, s[36:39], 0 offen
SV_138:
    s_mov_b64 exec, -1
    s_branch L_RED
L_BATT:
    s_and_b32 s60, s4, 7
    s_lshl_b32 s60, s60, 3
    s_lshr_b32 s7, s4, 3
    s_lshl_b32 s7, s7, 1
    s_add_u32 s60, s60, s7
    s_add_u32 s60, s60, s5
    s_sub_u32 s60, s60, 6
    s_lshr_b32 s61, s6, 1
    s_and_b32 s62, s6, 1
    s_mov_b32 s64, 0x3e0293ee
    v_lshlrev_b32 v4, 10, v3
    v_lshl_add_u32 v4, v2, 8, v4
    v_lshl_add_u32 v0, v3, 4, v4
    s_lshl_b32 s7, s62, 14
    s_add_u32 s7, s7, 0x1c000
    v_add_u32 v0, s7, v0
    v_and_b32 v162, 3, v1
    v_lshl_add_u32 v4, v162, 6, v4
    v_bfe_u32 v162, v1, 2, 2
    v_lshl_add_u32 v4, v162, 4, v4
    s_lshl_b32 s7, s6, 7
    s_add_u32 s7, s7, 0x24400
    v_lshl_add_u32 v5, v3, 3, s7
    s_lshl_b32 s7, s61, 10
    s_lshl_b32 s63, s62, 8
    s_add_u32 s7, s7, s63
    s_add_u32 s7, s7, 0x26000
    v_lshl_add_u32 v6, v3, 4, s7
    v_lshrrev_b32 v163, 5, v1
    v_lshl_add_u32 v6, v163, 9, v6
    v_and_b32 v162, 1, v2
    v_lshl_add_u32 v6, v162, 3, v6
    v_lshlrev_b32 v7, 4, v1
    v_add_u32 v7, 0x26000, v7
    v_and_b32 v162, 31, v1
    v_lshlrev_b32 v8, 3, v162
    v_add_u32 v8, 0x24400, v8
    v_bfe_u32 v162, v1, 2, 2
    v_lshl_add_u32 v164, v163, 3, v162
    v_lshlrev_b32 v164, 10, v164
    v_and_b32 v165, 1, v1
    v_lshl_add_u32 v164, v165, 3, v164
    s_lshl_b32 s7, s61, 8
    v_add_u32 v164, s7, v164
    v_bfe_u32 v165, v1, 4, 1
    v_lshlrev_b32 v165, 1, v165
    v_bfe_u32 v160, v1, 1, 1
    v_or_b32 v165, v165, v160
    s_lshl_b32 s7, s62, 3
    v_or_b32 v165, s7, v165
    v_lshlrev_b32 v162, 2, v162
    v_xor_b32 v165, v165, v162
    v_lshlrev_b32 v163, 1, v163
    v_xor_b32 v165, v165, v163
    v_xor_b32 v160, 0, v165
    v_lshl_add_u32 v9, v160, 4, v164
    v_xor_b32 v160, 4, v165
    v_lshl_add_u32 v10, v160, 4, v164
    v_xor_b32 v160, 1, v165
    v_lshl_add_u32 v11, v160, 4, v164
    v_add_u32 v11, 0x1000, v11
    v_xor_b32 v160, 5, v165
    v_lshl_add_u32 v12, v160, 4, v164
    v_add_u32 v12, 0x1000, v12
    v_mov_b32 v13, 0xff800000
    s_mov_b64 s[84:85], 0xffff
    s_lshl_b32 s7, s60, 15
    s_lshl_b32 s63, s6, 12
    s_add_u32 s7, s7, s63
    s_add_u32 s7, s7, 0x600000
    v_lshl_add_u32 v152, v1, 4, s7
    buffer_store_dwordx4 v[0:3], v152, s[36:39], 0 offen offset:0
    buffer_store_dwordx4 v[0:3], v152, s[36:39], 0 offen offset:1024
    buffer_store_dwordx4 v[0:3], v152, s[36:39], 0 offen offset:2048
    buffer_store_dwordx4 v[0:3], v152, s[36:39], 0 offen offset:3072
    s_lshl_b32 s7, s6, 9
    s_add_u32 s7, s7, 0x20000
    v_and_b32 v144, 1, v1
    v_lshl_add_u32 v144, v144, 3, s7
    v_lshrrev_b32 v145, 1, v1
    v_lshl_add_u32 v144, v145, 7, v144
    s_lshr_b32 s7, s60, 4
    s_lshl_b32 s7, s7, 15
    s_add_u32 s7, s7, s63
    v_lshl_add_u32 v145, v1, 4, s7
    s_and_b32 s7, s6, 3
    s_lshl_b32 s7, s7, 6
    v_lshlrev_b32 v146, 4, v1
    v_xor_b32 v146, s7, v146
    s_add_u32 s7, s63, 0x1c000
    v_add_u32 v146, s7, v146
    v_xor_b32 v147, 0x10, v146
    v_xor_b32 v148, 0x20, v146
    v_xor_b32 v149, 0x30, v146
    s_lshl_b32 s66, s61, 4
    s_add_u32 s66, s66, 16
    s_mov_b32 s70, 64
    s_mov_b32 s71, 0x800080
    s_lshl_b32 s67, s61, 2
    s_or_b32 s67, s67, 0x40000
    s_mov_b32 s72, 0x6543210
    s_mov_b32 s73, 0x65487321
    s_mov_b32 s69, 4
    s_lshr_b32 s7, s60, 3
    s_lshl_b32 s7, s7, 7
    s_add_u32 s7, s7, 0x22000
    v_lshl_add_u32 v153, v1, 3, s7
    v_mov_b32 v160, 0x24000
    s_mov_b32 s80, 1600000
LW_139:
    ds_read_b32 v161, v160
    s_waitcnt lgkmcnt(0)
    v_readfirstlane_b32 s79, v161
    s_cmp_ge_u32 s79, 48
    s_cbranch_scc1 LWD_140
    s_sleep 2
    s_sub_u32 s80, s80, 1
    s_cmp_lg_u32 s80, 0
    s_cbranch_scc1 LW_139
LWD_140:
    s_mov_b64 exec, 0xff
    buffer_load_dwordx2 v[16:17], v144, s[36:39], 0 offen sc1
    buffer_load_dwordx2 v[18:19], v153, s[36:39], 0 offen sc1 nt
    s_mov_b64 exec, -1
    s_lshl_b32 s7, s61, 14
    v_add_u32 v14, s7, v4
    v_mov_b32 v160, 0x24000
    s_mov_b32 s80, 1600000
LW_144:
    ds_read_b32 v161, v160
    s_waitcnt lgkmcnt(0)
    v_readfirstlane_b32 s79, v161
    s_cmp_ge_u32 s79, 64
    s_cbranch_scc1 LWD_145
    s_sleep 2
    s_sub_u32 s80, s80, 1
    s_cmp_lg_u32 s80, 0
    s_cbranch_scc1 LW_144
LWD_145:
    v_xor_b32 v160, 0x0, v14
    ds_read_b128 v[32:35], v160
    v_xor_b32 v161, 0x10, v14
    ds_read_b128 v[36:39], v161
    v_xor_b32 v160, 0x20, v14
    ds_read_b128 v[40:43], v160
    v_xor_b32 v161, 0x30, v14
    ds_read_b128 v[44:47], v161
    v_xor_b32 v160, 0x40, v14
    ds_read_b128 v[48:51], v160
    v_xor_b32 v161, 0x50, v14
    ds_read_b128 v[52:55], v161
    v_xor_b32 v160, 0x60, v14
    ds_read_b128 v[56:59], v160
    v_xor_b32 v161, 0x70, v14
    ds_read_b128 v[60:63], v161
    v_xor_b32 v160, 0x80, v14
    ds_read_b128 v[64:67], v160
    v_xor_b32 v161, 0x90, v14
    ds_read_b128 v[68:71], v161
    v_xor_b32 v160, 0xa0, v14
    ds_read_b128 v[72:75], v160
    v_xor_b32 v161, 0xb0, v14
    ds_read_b128 v[76:79], v161
    v_xor_b32 v160, 0xc0, v14
    ds_read_b128 v[80:83], v160
    v_xor_b32 v161, 0xd0, v14
    ds_read_b128 v[84:87], v161
    v_xor_b32 v160, 0xe0, v14
    ds_read_b128 v[88:91], v160
    v_xor_b32 v161, 0xf0, v14
    ds_read_b128 v[92:95], v161
    s_bfe_u32 s7, s72, 0x40000
    s_lshl_b32 s7, s7, 14
    v_add_u32 v20, s7, v9
    v_add_u32 v21, s7, v10
    v_add_u32 v22, s7, v11
    v_add_u32 v23, s7, v12
    ds_read_b64_tr_b16 v[96:97], v20
    ds_read_b64_tr_b16 v[98:99], v22
    ds_read_b64_tr_b16 v[100:101], v21
    ds_read_b64_tr_b16 v[102:103], v23
    s_bfe_u32 s7, s72, 0x40004
    s_lshl_b32 s7, s7, 14
    v_add_u32 v24, s7, v9
    v_add_u32 v25, s7, v10
    v_add_u32 v26, s7, v11
    v_add_u32 v27, s7, v12
    ds_read_b64_tr_b16 v[104:105], v24
    ds_read_b64_tr_b16 v[106:107], v26
    ds_read_b64_tr_b16 v[108:109], v25
    ds_read_b64_tr_b16 v[110:111], v27
    s_bfe_u32 s7, s72, 0x40008
    s_lshl_b32 s7, s7, 14
    v_add_u32 v28, s7, v9
    v_add_u32 v29, s7, v10
    v_add_u32 v30, s7, v11
    v_add_u32 v31, s7, v12
    ds_read_b64_tr_b16 v[112:113], v28
    ds_read_b64_tr_b16 v[114:115], v30
    ds_read_b64_tr_b16 v[116:117], v29
    ds_read_b64_tr_b16 v[118:119], v31
    s_bfe_u32 s7, s72, 0x4000c
    s_lshl_b32 s7, s7, 14
    v_add_u32 v20, s7, v9
    v_add_u32 v21, s7, v10
    v_add_u32 v22, s7, v11
    v_add_u32 v23, s7, v12
    ds_read_b64_tr_b16 v[120:121], v20
    ds_read_b64_tr_b16 v[122:123], v22
    ds_read_b64_tr_b16 v[124:125], v21
    ds_read_b64_tr_b16 v[126:127], v23
    v_mov_b32 v162, 0x24100
    v_mov_b32 v163, 1
    s_mov_b64 exec, 1
    ds_add_u32 v162, v163
    s_mov_b64 exec, -1
    v_mov_b32 v160, 0x24204
    s_mov_b32 s80, 1600000
LW_146:
    ds_read_b32 v161, v160
    s_waitcnt lgkmcnt(0)
    v_readfirstlane_b32 s79, v161
    s_cmp_ge_u32 s79, 1
    s_cbranch_scc1 LWD_147
    s_sleep 1
    s_sub_u32 s80, s80, 1
    s_cmp_lg_u32 s80, 0
    s_cbranch_scc1 LW_146
LWD_147:
    v_mov_b32 v160, 0x24248
    ds_read_b64 v[162:163], v160
    s_waitcnt lgkmcnt(0)
    v_readfirstlane_b32 s92, v162
    v_readfirstlane_b32 s93, v163
    s_mov_b32 s80, 200000
MC_142:
    s_mov_b64 exec, 0xff
    s_waitcnt vmcnt(0)
    v_cmp_ne_u64 s[44:45], s[92:93], v[16:17]
    s_cmp_lg_u64 s[44:45], 0
    s_cbranch_scc1 M_141
MD_143:
    s_mov_b64 exec, -1
    s_or_b32 s95, s95, s78
    s_add_u32 s88, s94, 0x10000
    s_addc_u32 s89, s95, 0
    s_mov_b32 s101, 4
    s_mov_b64 exec, 0xff
    s_branch UU_149
U_148:
    buffer_load_dwordx2 v[18:19], v153, s[36:39], 0 offen sc1 nt
UU_149:
    s_waitcnt vmcnt(0)
    v_cmp_gt_u64 s[90:91], s[94:95], v[18:19]
    v_cmp_le_u64 vcc, s[88:89], v[18:19]
    s_or_b64 vcc, vcc, s[90:91]
    s_cbranch_scc0 UD_150
    s_sleep 8
    s_sub_u32 s101, s101, 1
    s_cmp_lg_u32 s101, 0
    s_cbranch_scc1 U_148
UD_150:
    s_mov_b64 exec, -1
    s_cmp_ge_u32 s6, 4
    s_cbranch_scc1 XC_151
    s_and_b32 s7, s60, 7
    s_lshl_b32 s7, s7, 2
    s_add_u32 s7, s7, s6
    s_lshl_b32 s7, s7, 3
    s_lshr_b32 s65, s60, 3
    s_add_u32 s7, s7, s65
    s_lshl_b32 s7, s7, 7
    s_add_u32 s7, s7, 0x30010
    v_mov_b32 v160, s7
    s_waitcnt vmcnt(0)
    s_mov_b64 exec, 1
    buffer_store_dwordx2 v[162:163], v160, s[36:39], 0 offen sc1
    s_mov_b64 exec, -1
XC_151:
    v_mov_b32 v160, 0x24000
    s_mov_b32 s80, 1600000
LW_152:
    ds_read_b32 v161, v160
    s_waitcnt lgkmcnt(0)
    v_readfirstlane_b32 s79, v161
    s_cmp_ge_u32 s79, 120
    s_cbranch_scc1 LWD_153
    s_sleep 1
    s_sub_u32 s80, s80, 1
    s_cmp_lg_u32 s80, 0
    s_cbranch_scc1 LW_152
LWD_153:
    s_mov_b64 exec, -1
    buffer_load_dwordx4 v[128:131], v145, s[36:39], 0 offen offset:0 sc1
    buffer_load_dwordx4 v[132:135], v145, s[36:39], 0 offen offset:1024 sc1
    buffer_load_dwordx4 v[136:139], v145, s[36:39], 0 offen offset:2048 sc1
    buffer_load_dwordx4 v[140:143], v145, s[36:39], 0 offen offset:3072 sc1
    s_mov_b32 s80, 200000
MC_155:
    s_mov_b64 exec, -1
    s_waitcnt vmcnt(0)
    v_max3_u32 v160, v128, v129, v130
    v_max_u32 v160, v160, v131
    v_cmp_eq_u32 s[44:45], -1, v160
    v_max3_u32 v161, v132, v133, v134
    v_max_u32 v161, v161, v135
    v_cmp_eq_u32 s[46:47], -1, v161
    v_max3_u32 v162, v136, v137, v138
    v_max_u32 v162, v162, v139
    v_cmp_eq_u32 s[48:49], -1, v162
    v_max3_u32 v163, v140, v141, v142
    v_max_u32 v163, v163, v143
    v_cmp_eq_u32 s[50:51], -1, v163
    s_or_b64 s[90:91], s[44:45], s[46:47]
    s_or_b64 s[90:91], s[90:91], s[48:49]
    s_or_b64 s[90:91], s[90:91], s[50:51]
    s_cbranch_scc1 M_154
MD_156:
    s_mov_b64 exec, -1
    v_mov_b32 v160, 0x24108
    v_mov_b32 v161, 1
    s_mov_b64 exec, 1
    ds_add_u32 v160, v161
    s_mov_b64 exec, -1
    ds_write_b128 v146, v[128:131] offset:0
    ds_write_b128 v147, v[132:135] offset:1024
    ds_write_b128 v148, v[136:139] offset:2048
    ds_write_b128 v149, v[140:143] offset:3072
    v_xor_b32 v20, 0x0, v0
    v_xor_b32 v21, 0x10, v0
    v_xor_b32 v22, 0x20, v0
    v_xor_b32 v23, 0x30, v0
    v_xor_b32 v24, 0x40, v0
    v_xor_b32 v25, 0x50, v0
    v_xor_b32 v26, 0x60, v0
    v_xor_b32 v27, 0x70, v0
    v_mov_b32 v0, 0x24000
    s_add_u32 s81, s81, 8
    v_mov_b32 v162, 0x2420c
    v_mov_b32 v163, 1
    s_mov_b64 exec, 1
    ds_add_u32 v162, v163
    s_mov_b64 exec, -1
    v_mov_b32 v162, 0x2420c
    s_mov_b32 s80, 1600000
LW_157:
    ds_read_b32 v163, v162
    s_waitcnt lgkmcnt(0)
    v_readfirstlane_b32 s79, v163
    s_cmp_ge_u32 s79, s81
    s_cbranch_scc1 LWD_158
    s_sub_u32 s80, s80, 1
    s_cmp_lg_u32 s80, 0
    s_cbranch_scc1 LW_157
LWD_158:
    ds_read_b128 v[128:131], v20
    ds_read_b128 v[132:135], v21
    ds_read_b128 v[136:139], v22
    ds_read_b128 v[140:143], v23
    ds_read_b128 v[144:147], v24
    ds_read_b128 v[148:151], v25
    ds_read_b128 v[152:155], v26
    ds_read_b128 v[156:159], v27
    v_xor_b32 v20, 0x80, v20
    v_xor_b32 v21, 0x80, v21
    v_xor_b32 v22, 0x80, v22
    v_xor_b32 v23, 0x80, v23
    v_xor_b32 v24, 0x80, v24
    v_xor_b32 v25, 0x80, v25
    v_xor_b32 v26, 0x80, v26
    v_xor_b32 v27, 0x80, v27
    s_waitcnt lgkmcnt(7)
    v_mfma_f32_16x16x32_bf16 v[16:19], v[32:35], v[128:131], 0
    v_pk_mov_b32 v[32:33], v[128:129], v[128:129] op_sel:[0,1]
    v_pk_mov_b32 v[34:35], v[130:131], v[130:131] op_sel:[0,1]
    ds_read_b128 v[128:131], v20
    s_waitcnt lgkmcnt(7)
    v_mfma_f32_16x16x32_bf16 v[16:19], v[36:39], v[132:135], v[16:19]
    v_pk_mov_b32 v[36:37], v[132:133], v[132:133] op_sel:[0,1]
    v_pk_mov_b32 v[38:39], v[134:135], v[134:135] op_sel:[0,1]
    ds_read_b128 v[132:135], v21
    s_waitcnt lgkmcnt(7)
    v_mfma_f32_16x16x32_bf16 v[16:19], v[40:43], v[136:139], v[16:19]
    v_pk_mov_b32 v[40:41], v[136:137], v[136:137] op_sel:[0,1]
    v_pk_mov_b32 v[42:43], v[138:139], v[138:139] op_sel:[0,1]
    ds_read_b128 v[136:139], v22
    s_waitcnt lgkmcnt(7)
    v_mfma_f32_16x16x32_bf16 v[16:19], v[44:47], v[140:143], v[16:19]
    v_pk_mov_b32 v[44:45], v[140:141], v[140:141] op_sel:[0,1]
    v_pk_mov_b32 v[46:47], v[142:143], v[142:143] op_sel:[0,1]
    ds_read_b128 v[140:143], v23
    s_waitcnt lgkmcnt(7)
    v_mfma_f32_16x16x32_bf16 v[16:19], v[48:51], v[144:147], v[16:19]
    v_pk_mov_b32 v[48:49], v[144:145], v[144:145] op_sel:[0,1]
    v_pk_mov_b32 v[50:51], v[146:147], v[146:147] op_sel:[0,1]
    ds_read_b128 v[144:147], v24
    s_waitcnt lgkmcnt(7)
    v_mfma_f32_16x16x32_bf16 v[16:19], v[52:55], v[148:151], v[16:19]
    v_pk_mov_b32 v[52:53], v[148:149], v[148:149] op_sel:[0,1]
    v_pk_mov_b32 v[54:55], v[150:151], v[150:151] op_sel:[0,1]
    ds_read_b128 v[148:151], v25
    s_waitcnt lgkmcnt(7)
    v_mfma_f32_16x16x32_bf16 v[16:19], v[56:59], v[152:155], v[16:19]
    v_pk_mov_b32 v[56:57], v[152:153], v[152:153] op_sel:[0,1]
    v_pk_mov_b32 v[58:59], v[154:155], v[154:155] op_sel:[0,1]
    ds_read_b128 v[152:155], v26
    s_waitcnt lgkmcnt(7)
    v_mfma_f32_16x16x32_bf16 v[16:19], v[60:63], v[156:159], v[16:19]
    v_pk_mov_b32 v[60:61], v[156:157], v[156:157] op_sel:[0,1]
    v_pk_mov_b32 v[62:63], v[158:159], v[158:159] op_sel:[0,1]
    ds_read_b128 v[156:159], v27
    s_waitcnt lgkmcnt(7)
    v_mfma_f32_16x16x32_bf16 v[16:19], v[64:67], v[128:131], v[16:19]
    v_pk_mov_b32 v[64:65], v[128:129], v[128:129] op_sel:[0,1]
    v_pk_mov_b32 v[66:67], v[130:131], v[130:131] op_sel:[0,1]
    v_pk_mov_b32 v[128:129], 0, 0
    v_pk_mov_b32 v[130:131], 0, 0
    s_waitcnt lgkmcnt(6)
    v_mfma_f32_16x16x32_bf16 v[16:19], v[68:71], v[132:135], v[16:19]
    v_pk_mov_b32 v[68:69], v[132:133], v[132:133] op_sel:[0,1]
    v_pk_mov_b32 v[70:71], v[134:135], v[134:135] op_sel:[0,1]
    v_pk_mov_b32 v[132:133], 0, 0
    v_pk_mov_b32 v[134:135], 0, 0
    s_waitcnt lgkmcnt(5)
    v_mfma_f32_16x16x32_bf16 v[16:19], v[72:75], v[136:139], v[16:19]
    v_pk_mov_b32 v[72:73], v[136:137], v[136:137] op_sel:[0,1]
    v_pk_mov_b32 v[74:75], v[138:139], v[138:139] op_sel:[0,1]
    v_pk_mov_b32 v[136:137], 0, 0
    v_pk_mov_b32 v[138:139], 0, 0
    s_waitcnt lgkmcnt(4)
    v_mfma_f32_16x16x32_bf16 v[16:19], v[76:79], v[140:143], v[16:19]
    v_pk_mov_b32 v[76:77], v[140:141], v[140:141] op_sel:[0,1]
    v_pk_mov_b32 v[78:79], v[142:143], v[142:143] op_sel:[0,1]
    v_pk_mov_b32 v[140:141], 0, 0
    v_pk_mov_b32 v[142:143], 0, 0
    s_waitcnt lgkmcnt(3)
    v_mfma_f32_16x16x32_bf16 v[16:19], v[80:83], v[144:147], v[16:19]
    v_pk_mov_b32 v[80:81], v[144:145], v[144:145] op_sel:[0,1]
    v_pk_mov_b32 v[82:83], v[146:147], v[146:147] op_sel:[0,1]
    v_pk_mov_b32 v[144:145], 0, 0
    v_pk_mov_b32 v[146:147], 0, 0
    s_waitcnt lgkmcnt(2)
    v_mfma_f32_16x16x32_bf16 v[16:19], v[84:87], v[148:151], v[16:19]
    v_pk_mov_b32 v[84:85], v[148:149], v[148:149] op_sel:[0,1]
    v_pk_mov_b32 v[86:87], v[150:151], v[150:151] op_sel:[0,1]
    v_pk_mov_b32 v[148:149], 0, 0
    v_pk_mov_b32 v[150:151], 0, 0
    s_waitcnt lgkmcnt(1)
    v_mfma_f32_16x16x32_bf16 v[16:19], v[88:91], v[152:155], v[16:19]
    v_pk_mov_b32 v[88:89], v[152:153], v[152:153] op_sel:[0,1]
    v_pk_mov_b32 v[90:91], v[154:155], v[154:155] op_sel:[0,1]
    v_pk_mov_b32 v[152:153], 0, 0
    v_pk_mov_b32 v[154:155], 0, 0
    s_waitcnt lgkmcnt(0)
    v_mfma_f32_16x16x32_bf16 v[16:19], v[92:95], v[156:159], v[16:19]
    v_pk_mov_b32 v[92:93], v[156:157], v[156:157] op_sel:[0,1]
    v_pk_mov_b32 v[94:95], v[158:159], v[158:159] op_sel:[0,1]
    v_pk_mov_b32 v[156:157], 0, 0
    v_pk_mov_b32 v[158:159], 0, 0
    v_mov_b32 v162, 0x24104
    v_mov_b32 v163, 1
    s_mov_b64 exec, 1
    ds_add_u32 v162, v163
    s_mov_b64 exec, -1
    s_branch BM_159
BS_160:
    s_bfe_u32 s7, s72, s67
    s_lshl_b32 s7, s7, 14
    v_add_u32 v20, s7, v4
    v_xor_b32 v21, 0x10, v20
    v_xor_b32 v22, 0x20, v20
    v_xor_b32 v23, 0x30, v20
    v_xor_b32 v24, 0x40, v20
    v_xor_b32 v25, 0x50, v20
    v_xor_b32 v26, 0x60, v20
    v_xor_b32 v27, 0x70, v20
    v_readfirstlane_b32 s79, v15
    s_cmp_ge_u32 s79, s66
    s_cbranch_scc1 BK_161
    v_mov_b32 v162, 0x24000
    s_mov_b32 s80, 1600000
LW_162:
    ds_read_b32 v163, v162
    s_waitcnt lgkmcnt(0)
    v_readfirstlane_b32 s79, v163
    s_cmp_ge_u32 s79, s66
    s_cbranch_scc1 LWD_163
    s_sleep 1
    s_sub_u32 s80, s80, 1
    s_cmp_lg_u32 s80, 0
    s_cbranch_scc1 LW_162
LWD_163:
BK_161:
    ds_read_b128 v[96:99], v20
    ds_read_b128 v[100:103], v21
    ds_read_b128 v[104:107], v22
    ds_read_b128 v[108:111], v23
    ds_read_b128 v[112:115], v24
    ds_read_b128 v[116:119], v25
    ds_read_b128 v[120:123], v26
    ds_read_b128 v[124:127], v27
    v_xor_b32 v20, 0x80, v20
    v_xor_b32 v21, 0x80, v21
    v_xor_b32 v22, 0x80, v22
    v_xor_b32 v23, 0x80, v23
    v_xor_b32 v24, 0x80, v24
    v_xor_b32 v25, 0x80, v25
    v_xor_b32 v26, 0x80, v26
    v_xor_b32 v27, 0x80, v27
    s_waitcnt lgkmcnt(7)
    v_mfma_f32_16x16x32_bf16 v[16:19], v[96:99], v[32:35], 0
    ds_read_b128 v[96:99], v20
    s_waitcnt lgkmcnt(7)
    v_mfma_f32_16x16x32_bf16 v[16:19], v[100:103], v[36:39], v[16:19]
    ds_read_b128 v[100:103], v21
    s_waitcnt lgkmcnt(7)
    v_mfma_f32_16x16x32_bf16 v[16:19], v[104:107], v[40:43], v[16:19]
    ds_read_b128 v[104:107], v22
    s_waitcnt lgkmcnt(7)
    v_mfma_f32_16x16x32_bf16 v[16:19], v[108:111], v[44:47], v[16:19]
    ds_read_b128 v[108:111], v23
    s_waitcnt lgkmcnt(7)
    v_mfma_f32_16x16x32_bf16 v[16:19], v[112:115], v[48:51], v[16:19]
    ds_read_b128 v[112:115], v24
    s_waitcnt lgkmcnt(7)
    v_mfma_f32_16x16x32_bf16 v[16:19], v[116:119], v[52:55], v[16:19]
    ds_read_b128 v[116:119], v25
    s_waitcnt lgkmcnt(7)
    v_mfma_f32_16x16x32_bf16 v[16:19], v[120:123], v[56:59], v[16:19]
    ds_read_b128 v[120:123], v26
    s_waitcnt lgkmcnt(7)
    v_mfma_f32_16x16x32_bf16 v[16:19], v[124:127], v[60:63], v[16:19]
    ds_read_b128 v[124:127], v27
    s_waitcnt lgkmcnt(7)
    v_mfma_f32_16x16x32_bf16 v[16:19], v[96:99], v[64:67], v[16:19]
    s_waitcnt lgkmcnt(6)
    v_mfma_f32_16x16x32_bf16 v[16:19], v[100:103], v[68:71], v[16:19]
    s_bfe_u32 s7, s72, 0x40000
    s_lshl_b32 s7, s7, 14
    v_add_u32 v20, s7, v9
    v_add_u32 v21, s7, v10
    v_add_u32 v22, s7, v11
    v_add_u32 v23, s7, v12
    s_waitcnt lgkmcnt(5)
    v_mfma_f32_16x16x32_bf16 v[16:19], v[104:107], v[72:75], v[16:19]
    s_waitcnt lgkmcnt(4)
    v_mfma_f32_16x16x32_bf16 v[16:19], v[108:111], v[76:79], v[16:19]
    s_bfe_u32 s7, s72, 0x40004
    s_lshl_b32 s7, s7, 14
    v_add_u32 v24, s7, v9
    v_add_u32 v25, s7, v10
    v_add_u32 v26, s7, v11
    v_add_u32 v27, s7, v12
    s_waitcnt lgkmcnt(3)
    v_mfma_f32_16x16x32_bf16 v[16:19], v[112:115], v[80:83], v[16:19]
    s_waitcnt lgkmcnt(2)
    v_mfma_f32_16x16x32_bf16 v[16:19], v[116:119], v[84:87], v[16:19]
    s_bfe_u32 s7, s72, 0x40008
    s_lshl_b32 s7, s7, 14
    v_add_u32 v28, s7, v9
    v_add_u32 v29, s7, v10
    v_add_u32 v30, s7, v11
    v_add_u32 v31, s7, v12
    s_waitcnt lgkmcnt(1)
    v_mfma_f32_16x16x32_bf16 v[16:19], v[120:123], v[88:91], v[16:19]
    s_waitcnt lgkmcnt(0)
    v_mfma_f32_16x16x32_bf16 v[16:19], v[124:127], v[92:95], v[16:19]
    s_cmp_ge_u32 s79, s70
    s_cbranch_scc1 BA_164
    v_mov_b32 v162, 0x24000
    s_mov_b32 s80, 1600000
LW_165:
    ds_read_b32 v163, v162
    s_waitcnt lgkmcnt(0)
    v_readfirstlane_b32 s79, v163
    s_cmp_ge_u32 s79, s70
    s_cbranch_scc1 LWD_166
    s_sleep 1
    s_sub_u32 s80, s80, 1
    s_cmp_lg_u32 s80, 0
    s_cbranch_scc1 LW_165
LWD_166:
BA_164:
    ds_read_b64_tr_b16 v[96:97], v20
    ds_read_b64_tr_b16 v[98:99], v22
    ds_read_b64_tr_b16 v[100:101], v21
    ds_read_b64_tr_b16 v[102:103], v23
    ds_read_b64_tr_b16 v[104:105], v24
    ds_read_b64_tr_b16 v[106:107], v26
    ds_read_b64_tr_b16 v[108:109], v25
    ds_read_b64_tr_b16 v[110:111], v27
    ds_read_b64_tr_b16 v[112:113], v28
    ds_read_b64_tr_b16 v[114:115], v30
    ds_read_b64_tr_b16 v[116:117], v29
    ds_read_b64_tr_b16 v[118:119], v31
    s_bfe_u32 s7, s72, 0x4000c
    s_lshl_b32 s7, s7, 14
    v_add_u32 v20, s7, v9
    v_add_u32 v21, s7, v10
    v_add_u32 v22, s7, v11
    v_add_u32 v23, s7, v12
    ds_read_b64_tr_b16 v[120:121], v20
    ds_read_b64_tr_b16 v[122:123], v22
    ds_read_b64_tr_b16 v[124:125], v21
    ds_read_b64_tr_b16 v[126:127], v23
    v_mov_b32 v162, 0x24100
    v_mov_b32 v163, 1
    s_mov_b64 exec, 1
    ds_add_u32 v162, v163
    s_mov_b64 exec, -1
BM_159:
    v_max3_f32 v160, v16, v17, v18
    v_max_f32 v160, v160, v19
    v_mov_b32 v161, v160
    s_nop 1
    v_permlane32_swap_b32 v160, v161
    v_max_f32 v160, v160, v161
    v_mov_b32 v161, v160
    s_nop 1
    v_permlane16_swap_b32 v160, v161
    v_max_f32 v160, v160, v161
    v_mul_f32 v160, s64, v160
    v_ceil_f32 v160, v160
    v_fma_f32 v16, v16, s64, -v160
    v_fma_f32 v17, v17, s64, -v160
    v_fma_f32 v18, v18, s64, -v160
    v_fma_f32 v19, v19, s64, -v160
    v_exp_f32 v16, v16
    v_exp_f32 v17, v17
    v_exp_f32 v18, v18
    v_exp_f32 v19, v19
    v_cvt_pk_bf16_f32 v162, v16, v17
    v_cvt_pk_bf16_f32 v163, v18, v19
    ds_write_b64 v6, v[162:163]
    s_mov_b64 exec, s[84:85]
    ds_write_b32 v5, v160
    s_add_u32 s81, s81, 8
    v_mov_b32 v164, 0x2420c
    v_mov_b32 v165, 1
    s_mov_b64 exec, 1
    ds_add_u32 v164, v165
    s_mov_b64 exec, -1
    v_add_f32 v16, v16, v17
    v_add_f32 v18, v18, v19
    v_add_f32 v161, v16, v18
    v_mov_b32 v16, v161
    s_nop 1
    v_permlane32_swap_b32 v161, v16
    v_add_f32 v161, v161, v16
    v_mov_b32 v16, v161
    s_nop 1
    v_permlane16_swap_b32 v161, v16
    v_add_f32 v161, v161, v16
    s_mov_b64 exec, s[84:85]
    ds_write_b32 v5, v161 offset:4
    s_mov_b64 exec, 1
    ds_add_u32 v164, v165 offset:4
    s_mov_b64 exec, -1
    v_mov_b32 v164, 0x2420c
    s_mov_b32 s80, 1600000
LW_167:
    ds_read_b32 v165, v164
    s_waitcnt lgkmcnt(0)
    v_readfirstlane_b32 s79, v165
    s_cmp_ge_u32 s79, s81
    s_cbranch_scc1 LWD_168
    s_sub_u32 s80, s80, 1
    s_cmp_lg_u32 s80, 0
    s_cbranch_scc1 LW_167
LWD_168:
    ds_read_b32 v160, v8 offset:0
    ds_read_b32 v161, v8 offset:256
    ds_read_b32 v162, v8 offset:512
    ds_read_b32 v163, v8 offset:768
    ds_read_b32 v15, v0
    ds_read_b128 v[16:19], v7 offset:0
    ds_read_b128 v[20:23], v7 offset:1024
    ds_read_b128 v[24:27], v7 offset:2048
    ds_read_b128 v[28:31], v7 offset:3072
    v_xor_b32 v6, 0x1000, v6
    v_xor_b32 v7, 0x1000, v7
    v_add_u32 v5, 1024, v5
    v_add_u32 v8, 1024, v8
    s_waitcnt lgkmcnt(5)
    v_max3_f32 v14, v13, v160, v161
    v_max3_f32 v14, v14, v162, v163
    v_cmp_neq_f32 vcc, v14, v13
    v_sub_f32 v160, v14, v160
    v_sub_f32 v161, v14, v161
    v_sub_f32 v162, v14, v162
    v_sub_f32 v163, v14, v163
    v_cvt_u32_f32 v160, v160
    v_cvt_u32_f32 v161, v161
    v_cvt_u32_f32 v162, v162
    v_cvt_u32_f32 v163, v163
    v_min_u32 v160, 0xff, v160
    v_min_u32 v161, 0xff, v161
    v_min_u32 v162, 0xff, v162
    v_min_u32 v163, 0xff, v163
    v_mul_u32_u24 v160, s71, v160
    v_mul_u32_u24 v161, s71, v161
    v_mul_u32_u24 v162, s71, v162
    v_mul_u32_u24 v163, s71, v163
    s_cbranch_vccz BR_169
    v_sub_f32 v164, v13, v14
    v_exp_f32 v164, v164
    v_mov_b32 v13, v14
    v_pk_mul_f32 v[128:129], v[128:129], v[164:165] op_sel_hi:[1,0]
    v_pk_mul_f32 v[130:131], v[130:131], v[164:165] op_sel_hi:[1,0]
    v_pk_mul_f32 v[132:133], v[132:133], v[164:165] op_sel_hi:[1,0]
    v_pk_mul_f32 v[134:135], v[134:135], v[164:165] op_sel_hi:[1,0]
    v_pk_mul_f32 v[136:137], v[136:137], v[164:165] op_sel_hi:[1,0]
    v_pk_mul_f32 v[138:139], v[138:139], v[164:165] op_sel_hi:[1,0]
    v_pk_mul_f32 v[140:141], v[140:141], v[164:165] op_sel_hi:[1,0]
    v_pk_mul_f32 v[142:143], v[142:143], v[164:165] op_sel_hi:[1,0]
    v_pk_mul_f32 v[144:145], v[144:145], v[164:165] op_sel_hi:[1,0]
    v_pk_mul_f32 v[146:147], v[146:147], v[164:165] op_sel_hi:[1,0]
    v_pk_mul_f32 v[148:149], v[148:149], v[164:165] op_sel_hi:[1,0]
    v_pk_mul_f32 v[150:151], v[150:151], v[164:165] op_sel_hi:[1,0]
    v_pk_mul_f32 v[152:153], v[152:153], v[164:165] op_sel_hi:[1,0]
    v_pk_mul_f32 v[154:155], v[154:155], v[164:165] op_sel_hi:[1,0]
    v_pk_mul_f32 v[156:157], v[156:157], v[164:165] op_sel_hi:[1,0]
    v_pk_mul_f32 v[158:159], v[158:159], v[164:165] op_sel_hi:[1,0]
BR_169:
    s_waitcnt lgkmcnt(3)
    v_pk_sub_u16 v16, v16, v160 clamp
    v_pk_sub_u16 v17, v17, v160 clamp
    v_pk_sub_u16 v18, v18, v160 clamp
    v_pk_sub_u16 v19, v19, v160 clamp
    s_nop 1
    v_mfma_f32_32x32x16_bf16 v[128:143], v[96:99], v[16:19], v[128:143]
    v_mfma_f32_32x32x16_bf16 v[144:159], v[100:103], v[16:19], v[144:159]
    s_waitcnt lgkmcnt(2)
    v_pk_sub_u16 v20, v20, v161 clamp
    v_pk_sub_u16 v21, v21, v161 clamp
    v_pk_sub_u16 v22, v22, v161 clamp
    v_pk_sub_u16 v23, v23, v161 clamp
    s_nop 1
    v_mfma_f32_32x32x16_bf16 v[128:143], v[104:107], v[20:23], v[128:143]
    v_mfma_f32_32x32x16_bf16 v[144:159], v[108:111], v[20:23], v[144:159]
    s_waitcnt lgkmcnt(1)
    v_pk_sub_u16 v24, v24, v162 clamp
    v_pk_sub_u16 v25, v25, v162 clamp
    v_pk_sub_u16 v26, v26, v162 clamp
    v_pk_sub_u16 v27, v27, v162 clamp
    s_nop 1
    v_mfma_f32_32x32x16_bf16 v[128:143], v[112:115], v[24:27], v[128:143]
    v_mfma_f32_32x32x16_bf16 v[144:159], v[116:119], v[24:27], v[144:159]
    s_waitcnt lgkmcnt(0)
    v_pk_sub_u16 v28, v28, v163 clamp
    v_pk_sub_u16 v29, v29, v163 clamp
    v_pk_sub_u16 v30, v30, v163 clamp
    v_pk_sub_u16 v31, v31, v163 clamp
    s_nop 1
    v_mfma_f32_32x32x16_bf16 v[128:143], v[120:123], v[28:31], v[128:143]
    v_mfma_f32_32x32x16_bf16 v[144:159], v[124:127], v[28:31], v[144:159]
    s_lshr_b64 s[72:73], s[72:73], 16
    s_add_u32 s66, s66, 64
    s_add_u32 s70, s70, 64
    s_sub_u32 s69, s69, 1
    s_cmp_lg_u32 s69, 0
    s_cbranch_scc1 BS_160
    s_lshr_b32 s67, s60, 3
    s_and_b32 s68, s60, 7
    s_lshl_b32 s7, s60, 15
    s_lshl_b32 s63, s6, 12
    s_add_u32 s7, s7, s63
    s_add_u32 s7, s7, 0x600000
    v_lshl_add_u32 v5, v1, 4, s7
    v_mov_b32 v38, s92
    v_mov_b32 v39, s93
    s_cmp_lg_u32 s6, 7
    s_cbranch_scc1 B7_170
    v_lshrrev_b32 v45, 5, v1
    v_lshl_add_u32 v45, v45, 11, v8
    v_add_u32 v45, -4096, v45
    v_mov_b32 v46, 0x24210
    s_mov_b32 s80, 1600000
LW_171:
    ds_read_b32 v47, v46
    s_waitcnt lgkmcnt(0)
    v_readfirstlane_b32 s79, v47
    s_cmp_ge_u32 s79, 32
    s_cbranch_scc1 LWD_172
    s_sub_u32 s80, s80, 1
    s_cmp_lg_u32 s80, 0
    s_cbranch_scc1 LW_171
LWD_172:
    ds_read_b64 v[48:49], v45 offset:0
    ds_read_b64 v[50:51], v45 offset:256
    ds_read_b64 v[52:53], v45 offset:512
    ds_read_b64 v[54:55], v45 offset:768
    ds_read_b64 v[56:57], v45 offset:1024
    ds_read_b64 v[58:59], v45 offset:1280
    ds_read_b64 v[60:61], v45 offset:1536
    ds_read_b64 v[62:63], v45 offset:1792
    s_lshl_b32 s7, s60, 9
    s_add_u32 s7, s7, 0x28000
    v_lshl_add_u32 v44, v1, 4, s7
    v_mov_b32 v36, v13
    s_waitcnt lgkmcnt(0)
    v_sub_f32 v48, v48, v36
    v_sub_f32 v50, v50, v36
    v_sub_f32 v52, v52, v36
    v_sub_f32 v54, v54, v36
    v_sub_f32 v56, v56, v36
    v_sub_f32 v58, v58, v36
    v_sub_f32 v60, v60, v36
    v_sub_f32 v62, v62, v36
    v_exp_f32 v48, v48
    v_exp_f32 v50, v50
    v_exp_f32 v52, v52
    v_exp_f32 v54, v54
    v_exp_f32 v56, v56
    v_exp_f32 v58, v58
    v_exp_f32 v60, v60
    v_exp_f32 v62, v62
    v_mul_f32 v37, v48, v49
    v_fmac_f32 v37, v50, v51
    v_fmac_f32 v37, v52, v53
    v_fmac_f32 v37, v54, v55
    v_fmac_f32 v37, v56, v57
    v_fmac_f32 v37, v58, v59
    v_fmac_f32 v37, v60, v61
    v_fmac_f32 v37, v62, v63
    v_mov_b32 v48, v37
    s_nop 1
    v_permlane32_swap_b32 v37, v48
    v_add_f32 v37, v37, v48
    s_mov_b64 exec, 0xffffffff
    s_cmp_eq_u32 s101, 0
    s_cbranch_scc1 SU_173
    buffer_store_dwordx4 v[36:39], v44, s[36:39], 0 offen
SV_174:
    s_mov_b64 exec, -1
B7_170:
    v_permlane32_swap_b32 v128, v132
    v_permlane32_swap_b32 v129, v133
    v_permlane32_swap_b32 v130, v134
    v_permlane32_swap_b32 v131, v135
    v_cvt_pk_bf16_f32 v16, v128, v129
    v_cvt_pk_bf16_f32 v17, v130, v131
    v_cvt_pk_bf16_f32 v18, v132, v133
    v_cvt_pk_bf16_f32 v19, v134, v135
    v_permlane32_swap_b32 v136, v140
    v_permlane32_swap_b32 v137, v141
    v_permlane32_swap_b32 v138, v142
    v_permlane32_swap_b32 v139, v143
    v_cvt_pk_bf16_f32 v20, v136, v137
    v_cvt_pk_bf16_f32 v21, v138, v139
    v_cvt_pk_bf16_f32 v22, v140, v141
    v_cvt_pk_bf16_f32 v23, v142, v143
    v_permlane32_swap_b32 v144, v148
    v_permlane32_swap_b32 v145, v149
    v_permlane32_swap_b32 v146, v150
    v_permlane32_swap_b32 v147, v151
    v_cvt_pk_bf16_f32 v24, v144, v145
    v_cvt_pk_bf16_f32 v25, v146, v147
    v_cvt_pk_bf16_f32 v26, v148, v149
    v_cvt_pk_bf16_f32 v27, v150, v151
    v_permlane32_swap_b32 v152, v156
    v_permlane32_swap_b32 v153, v157
    v_permlane32_swap_b32 v154, v158
    v_permlane32_swap_b32 v155, v159
    v_cvt_pk_bf16_f32 v28, v152, v153
    v_cvt_pk_bf16_f32 v29, v154, v155
    v_cvt_pk_bf16_f32 v30, v156, v157
    v_cvt_pk_bf16_f32 v31, v158, v159
    s_lshl_b32 s7, s67, 9
    s_lshl_b32 s65, s6, 6
    s_add_u32 s7, s7, s65
    s_add_u32 s7, s7, 0x23000
    v_and_b32 v160, 7, v1
    v_lshl_add_u32 v7, v160, 3, s7
    s_lshl_b64 s[88:89], 1, s68
    s_cmp_eq_u32 s101, 0
    s_cbranch_scc1 SU_175
    buffer_store_dwordx4 v[16:19], v5, s[36:39], 0 offen offset:0
    buffer_store_dwordx4 v[20:23], v5, s[36:39], 0 offen offset:1024
    buffer_store_dwordx4 v[24:27], v5, s[36:39], 0 offen offset:2048
    buffer_store_dwordx4 v[28:31], v5, s[36:39], 0 offen offset:3072
    s_waitcnt vmcnt(0)
    s_mov_b64 exec, s[88:89]
    buffer_store_dwordx2 v[38:39], v7, s[36:39], 0 offen
    s_mov_b64 exec, -1
SV_176:
    s_lshl_b32 s7, s67, 18
    s_add_u32 s7, s7, s63
    s_lshl_b32 s65, s68, 6
    s_add_u32 s7, s7, s65
    s_add_u32 s7, s7, 0x600000
    v_and_b32 v160, 3, v1
    v_lshl_add_u32 v5, v160, 4, s7
    v_bfe_u32 v161, v1, 2, 3
    v_lshl_add_u32 v5, v161, 9, v5
    v_lshrrev_b32 v162, 5, v1
    v_lshl_add_u32 v5, v162, 15, v5
    s_lshl_b32 s7, s67, 12
    s_add_u32 s7, s7, s65
    s_add_u32 s7, s7, 0x28000
    v_lshl_add_u32 v6, v160, 4, s7
    v_lshl_add_u32 v6, v162, 9, v6
    s_lshl_b32 s7, s68, 15
    s_lshl_b32 s63, s67, 10
    s_add_u32 s7, s7, s63
    s_lshl_b32 s63, s6, 7
    s_add_u32 s7, s7, s63
    s_add_u32 s7, s7, 0x200000
    v_lshl_add_u32 v8, v160, 13, s7
    v_lshl_add_u32 v8, v161, 4, v8
    v_lshl_add_u32 v8, v162, 3, v8
    s_lshl_b32 s7, s67, 7
    s_lshl_b32 s63, s68, 12
    s_add_u32 s7, s7, s63
    s_add_u32 s7, s7, 0x30000
    v_lshl_add_u32 v9, v160, 10, s7
    s_mov_b64 exec, 0xff
    buffer_load_dwordx2 v[40:41], v7, s[36:39], 0 offen sc1 nt
    s_mov_b32 s80, 200000
MC_178:
    s_mov_b64 exec, 0xff
    s_waitcnt vmcnt(0)
    v_cmp_ne_u64 s[86:87], s[92:93], v[40:41]
    s_cmp_lg_u64 s[86:87], 0
    s_cbranch_scc1 M_177
MD_179:
    s_mov_b64 exec, -1
    buffer_load_dwordx4 v[64:67], v6, s[36:39], 0 offen offset:0 sc1 nt
    buffer_load_dwordx4 v[68:71], v6, s[36:39], 0 offen offset:1024 sc1 nt
    buffer_load_dwordx4 v[72:75], v6, s[36:39], 0 offen offset:2048 sc1 nt
    buffer_load_dwordx4 v[76:79], v6, s[36:39], 0 offen offset:3072 sc1 nt
    s_mov_b32 s63, 0
    buffer_load_dwordx4 v[48:51], v5, s[36:39], s63 offen sc1 nt
    s_add_u32 s63, s63, 65536
    buffer_load_dwordx4 v[52:55], v5, s[36:39], s63 offen sc1 nt
    s_add_u32 s63, s63, 65536
    buffer_load_dwordx4 v[56:59], v5, s[36:39], s63 offen sc1 nt
    s_add_u32 s63, s63, 65536
    buffer_load_dwordx4 v[60:63], v5, s[36:39], s63 offen sc1 nt
    s_add_u32 s63, s63, 65536
    s_waitcnt vmcnt(4)
    v_cmp_ne_u64 s[90:91], s[92:93], v[66:67]
    v_cmp_ne_u64 vcc, s[92:93], v[70:71]
    s_or_b64 s[90:91], s[90:91], vcc
    v_cmp_ne_u64 vcc, s[92:93], v[74:75]
    s_or_b64 s[90:91], s[90:91], vcc
    v_cmp_ne_u64 vcc, s[92:93], v[78:79]
    s_or_b64 s[90:91], s[90:91], vcc
    s_cmp_lg_u64 s[90:91], 0
    s_cbranch_scc1 BL_180
BLD_181:
    v_max3_f32 v36, v64, v68, v72
    v_max_f32 v36, v36, v76
    v_mov_b32 v37, v36
    s_nop 1
    v_permlane32_swap_b32 v36, v37
    v_max_f32 v36, v36, v37
    v_sub_f32 v80, v64, v36
    v_sub_f32 v81, v68, v36
    v_sub_f32 v82, v72, v36
    v_sub_f32 v83, v76, v36
    v_exp_f32 v80, v80
    v_exp_f32 v81, v81
    v_exp_f32 v82, v82
    v_exp_f32 v83, v83
    v_mul_f32 v37, v80, v65
    v_fmac_f32 v37, v81, v69
    v_fmac_f32 v37, v82, v73
    v_fmac_f32 v37, v83, v77
    v_mov_b32 v40, v37
    s_nop 1
    v_permlane32_swap_b32 v37, v40
    v_add_f32 v37, v37, v40
    s_waitcnt vmcnt(3)
    v_lshlrev_b32 v88, 16, v48
    v_and_b32 v89, 0xffff0000, v48
    v_lshlrev_b32 v90, 16, v49
    v_and_b32 v91, 0xffff0000, v49
    v_lshlrev_b32 v92, 16, v50
    v_and_b32 v93, 0xffff0000, v50
    v_lshlrev_b32 v94, 16, v51
    v_and_b32 v95, 0xffff0000, v51
    v_mul_f32 v16, v88, v80
    v_mul_f32 v17, v89, v80
    v_mul_f32 v18, v90, v80
    v_mul_f32 v19, v91, v80
    v_mul_f32 v20, v92, v80
    v_mul_f32 v21, v93, v80
    v_mul_f32 v22, v94, v80
    v_mul_f32 v23, v95, v80
    s_waitcnt vmcnt(2)
    v_lshlrev_b32 v88, 16, v52
    v_and_b32 v89, 0xffff0000, v52
    v_lshlrev_b32 v90, 16, v53
    v_and_b32 v91, 0xffff0000, v53
    v_lshlrev_b32 v92, 16, v54
    v_and_b32 v93, 0xffff0000, v54
    v_lshlrev_b32 v94, 16, v55
    v_and_b32 v95, 0xffff0000, v55
    v_fmac_f32 v16, v88, v81
    v_fmac_f32 v17, v89, v81
    v_fmac_f32 v18, v90, v81
    v_fmac_f32 v19, v91, v81
    v_fmac_f32 v20, v92, v81
    v_fmac_f32 v21, v93, v81
    v_fmac_f32 v22, v94, v81
    v_fmac_f32 v23, v95, v81
    s_waitcnt vmcnt(1)
    v_lshlrev_b32 v88, 16, v56
    v_and_b32 v89, 0xffff0000, v56
    v_lshlrev_b32 v90, 16, v57
    v_and_b32 v91, 0xffff0000, v57
    v_lshlrev_b32 v92, 16, v58
    v_and_b32 v93, 0xffff0000, v58
    v_lshlrev_b32 v94, 16, v59
    v_and_b32 v95, 0xffff0000, v59
    v_fmac_f32 v16, v88, v82
    v_fmac_f32 v17, v89, v82
    v_fmac_f32 v18, v90, v82
    v_fmac_f32 v19, v91, v82
    v_fmac_f32 v20, v92, v82
    v_fmac_f32 v21, v93, v82
    v_fmac_f32 v22, v94, v82
    v_fmac_f32 v23, v95, v82
    s_waitcnt vmcnt(0)
    v_mov_b32 v160, 0x24218
    v_mov_b32 v161, 1
    s_mov_b64 exec, 1
    ds_add_u32 v160, v161
    s_mov_b64 exec, -1
    v_lshlrev_b32 v88, 16, v60
    v_and_b32 v89, 0xffff0000, v60
    v_lshlrev_b32 v90, 16, v61
    v_and_b32 v91, 0xffff0000, v61
    v_lshlrev_b32 v92, 16, v62
    v_and_b32 v93, 0xffff0000, v62
    v_lshlrev_b32 v94, 16, v63
    v_and_b32 v95, 0xffff0000, v63
    v_fmac_f32 v16, v88, v83
    v_fmac_f32 v17, v89, v83
    v_fmac_f32 v18, v90, v83
    v_fmac_f32 v19, v91, v83
    v_fmac_f32 v20, v92, v83
    v_fmac_f32 v21, v93, v83
    v_fmac_f32 v22, v94, v83
    v_fmac_f32 v23, v95, v83
    v_permlane32_swap_b32 v16, v20
    v_permlane32_swap_b32 v17, v21
    v_permlane32_swap_b32 v18, v22
    v_permlane32_swap_b32 v19, v23
    v_add_f32 v16, v16, v20
    v_add_f32 v17, v17, v21
    v_add_f32 v18, v18, v22
    v_add_f32 v19, v19, v23
    v_cvt_pk_bf16_f32 v44, v16, v17
    v_cvt_pk_bf16_f32 v45, v18, v19
    v_mov_b32 v160, 0x24218
    s_mov_b32 s80, 1600000
LW_182:
    ds_read_b32 v161, v160
    s_waitcnt lgkmcnt(0)
    v_readfirstlane_b32 s79, v161
    s_cmp_ge_u32 s79, 8
    s_cbranch_scc1 LWD_183
    s_sub_u32 s80, s80, 1
    s_cmp_lg_u32 s80, 0
    s_cbranch_scc1 LW_182
LWD_183:
    buffer_store_dwordx2 v[44:45], v8, s[36:39], 0 offen sc1
    s_cmp_lg_u32 s6, 0
    s_cbranch_scc1 BM2_184
    s_mov_b64 exec, 15
    buffer_store_dwordx4 v[36:39], v9, s[36:39], 0 offen sc1
    s_mov_b64 exec, -1
BM2_184:
    v_mov_b32 v160, 0x24218
    v_mov_b32 v161, 1
    s_mov_b64 exec, 1
    ds_add_u32 v160, v161
    s_mov_b64 exec, -1
    s_lshr_b32 s65, s60, 2
    s_lshl_b32 s7, s65, 13
    s_lshl_b32 s63, s6, 10
    s_add_u32 s7, s7, s63
    s_add_u32 s7, s7, 0xc0000
    v_lshl_add_u32 v4, v1, 4, s7
    v_lshrrev_b32 v160, 2, v3
    v_mul_u32_u24 v5, 576, v160
    v_and_b32 v160, 3, v1
    v_lshl_add_u32 v5, v160, 4, v5
    v_lshrrev_b32 v161, 5, v1
    v_lshl_add_u32 v5, v161, 6, v5
    v_and_b32 v161, 1, v2
    v_lshl_add_u32 v5, v161, 3, v5
    s_and_b32 s7, s6, 2
    s_mul_i32 s7, s7, 1152
    s_and_b32 s63, s6, 4
    s_lshl_b32 s63, s63, 6
    s_add_u32 s7, s7, s63
    s_lshl_b32 s63, s62, 7
    s_add_u32 s7, s7, s63
    s_add_u32 s7, s7, 0x26000
    v_add_u32 v5, s7, v5
    v_and_b32 v6, 7, v1
    v_mul_u32_u24 v6, 576, v6
    v_lshl_add_u32 v6, v2, 4, v6
    v_add_u32 v6, 0x26000, v6
    s_and_b32 s7, s68, 3
    s_lshl_b32 s7, s7, 3
    s_add_u32 s7, s7, s6
    s_lshl_b32 s7, s7, 4
    s_add_u32 s7, s7, s65
    s_lshl_b32 s7, s7, 8
    s_add_u32 s7, s7, 0x2c0000
    v_lshl_add_u32 v7, v160, 6, s7
    v_lshl_add_u32 v7, v2, 4, v7
    v_cmp_gt_u32 s[84:85], 4, v3
    v_bfe_u32 v8, v1, 2, 3
    v_xor_b32 v8, s6, v8
    v_lshlrev_b32 v8, 5, v8
    v_lshrrev_b32 v161, 2, v1
    v_lshl_add_u32 v8, v161, 8, v8
    v_lshl_add_u32 v8, v160, 3, v8
    v_mov_b32 v162, 0x24000
    s_mov_b32 s80, 1600000
LW_185:
    ds_read_b32 v163, v162
    s_waitcnt lgkmcnt(0)
    v_readfirstlane_b32 s79, v163
    s_cmp_ge_u32 s79, 320
    s_cbranch_scc1 LWD_186
    s_sleep 1
    s_sub_u32 s80, s80, 1
    s_cmp_lg_u32 s80, 0
    s_cbranch_scc1 LW_185
LWD_186:
    ds_read_b64_tr_b16 v[48:49], v8 offset:0
    ds_read_b64_tr_b16 v[50:51], v8 offset:4096
    ds_read_b64_tr_b16 v[52:53], v8 offset:8192
    ds_read_b64_tr_b16 v[54:55], v8 offset:12288
    ds_read_b64_tr_b16 v[56:57], v8 offset:16384
    ds_read_b64_tr_b16 v[58:59], v8 offset:20480
    ds_read_b64_tr_b16 v[60:61], v8 offset:24576
    ds_read_b64_tr_b16 v[62:63], v8 offset:28672
    ds_read_b64_tr_b16 v[64:65], v8 offset:32768
    ds_read_b64_tr_b16 v[66:67], v8 offset:36864
    ds_read_b64_tr_b16 v[68:69], v8 offset:40960
    ds_read_b64_tr_b16 v[70:71], v8 offset:45056
    ds_read_b64_tr_b16 v[72:73], v8 offset:49152
    ds_read_b64_tr_b16 v[74:75], v8 offset:53248
    ds_read_b64_tr_b16 v[76:77], v8 offset:57344
    ds_read_b64_tr_b16 v[78:79], v8 offset:61440
    s_mov_b64 exec, -1
    buffer_load_dwordx4 v[16:19], v4, s[36:39], 0 offen sc1 nt
    s_mov_b32 s80, 200000
MC_188:
    s_mov_b64 exec, -1
    s_waitcnt vmcnt(0)
    v_cmp_ne_u64 s[86:87], s[92:93], v[18:19]
    s_cmp_lg_u64 s[86:87], 0
    s_cbranch_scc1 M_187
MD_189:
    s_mov_b64 exec, -1
    ds_write_b64 v5, v[16:17]
    s_add_u32 s81, s81, 8
    v_mov_b32 v160, 0x2420c
    v_mov_b32 v161, 1
    s_mov_b64 exec, 1
    ds_add_u32 v160, v161
    s_mov_b64 exec, -1
    v_mov_b32 v160, 0x2420c
    s_mov_b32 s80, 1600000
LW_190:
    ds_read_b32 v161, v160
    s_waitcnt lgkmcnt(0)
    v_readfirstlane_b32 s79, v161
    s_cmp_ge_u32 s79, s81
    s_cbranch_scc1 LWD_191
    s_sub_u32 s80, s80, 1
    s_cmp_lg_u32 s80, 0
    s_cbranch_scc1 LW_190
LWD_191:
    ds_read_b128 v[80:83], v6 offset:0
    ds_read_b128 v[84:87], v6 offset:64
    ds_read_b128 v[88:91], v6 offset:128
    ds_read_b128 v[92:95], v6 offset:192
    ds_read_b128 v[96:99], v6 offset:256
    ds_read_b128 v[100:103], v6 offset:320
    ds_read_b128 v[104:107], v6 offset:384
    ds_read_b128 v[108:111], v6 offset:448
    s_waitcnt lgkmcnt(7)
    v_mfma_f32_16x16x32_bf16 v[12:15], v[48:51], v[80:83], 0
    s_waitcnt lgkmcnt(6)
    v_mfma_f32_16x16x32_bf16 v[12:15], v[52:55], v[84:87], v[12:15]
    s_waitcnt lgkmcnt(5)
    v_mfma_f32_16x16x32_bf16 v[12:15], v[56:59], v[88:91], v[12:15]
    s_waitcnt lgkmcnt(4)
    v_mfma_f32_16x16x32_bf16 v[12:15], v[60:63], v[92:95], v[12:15]
    s_waitcnt lgkmcnt(3)
    v_mfma_f32_16x16x32_bf16 v[12:15], v[64:67], v[96:99], v[12:15]
    s_waitcnt lgkmcnt(2)
    v_mfma_f32_16x16x32_bf16 v[12:15], v[68:71], v[100:103], v[12:15]
    s_waitcnt lgkmcnt(1)
    v_mfma_f32_16x16x32_bf16 v[12:15], v[72:75], v[104:107], v[12:15]
    s_waitcnt lgkmcnt(0)
    v_mfma_f32_16x16x32_bf16 v[12:15], v[76:79], v[108:111], v[12:15]
    s_nop 7
    v_add_f32_dpp v12, v12, v12 row_ror:4 row_mask:0xf bank_mask:0xf
    v_add_f32_dpp v13, v13, v13 row_ror:4 row_mask:0xf bank_mask:0xf
    v_add_f32_dpp v14, v14, v14 row_ror:4 row_mask:0xf bank_mask:0xf
    v_add_f32_dpp v15, v15, v15 row_ror:4 row_mask:0xf bank_mask:0xf
    v_cvt_pk_bf16_f32 v16, v12, v13
    v_cvt_pk_bf16_f32 v17, v14, v15
    s_mov_b64 exec, s[84:85]
    buffer_store_dwordx4 v[16:19], v7, s[36:39], 0 offen sc1
    s_mov_b64 exec, -1
    s_cmp_lt_u32 s6, 4
    s_cbranch_scc1 L_END
    s_branch L_RED
SU_12:
    s_nop 3
    buffer_store_dwordx4 v[64:67], v5, s[36:39], 0 offen sc1
    buffer_store_dwordx4 v[72:75], v4, s[36:39], 0 offen sc1
    s_branch SV_13
ST_20:
    ds_read_b32 v18, v17
    s_waitcnt lgkmcnt(0)
    v_readlane_b32 s79, v18, s62
    s_cmp_ge_u32 s79, s63
    s_cbranch_scc1 GO_19
    s_waitcnt vmcnt(24)
    s_sub_u32 s7, s60, 24
    v_mov_b32 v19, s7
    ds_max_i32 v16, v19
    ds_read_b32 v18, v17
    s_waitcnt lgkmcnt(0)
    v_readlane_b32 s79, v18, s62
    s_cmp_ge_u32 s79, s63
    s_cbranch_scc1 GO_19
    s_waitcnt vmcnt(16)
    s_sub_u32 s7, s60, 16
    v_mov_b32 v19, s7
    ds_max_i32 v16, v19
    ds_read_b32 v18, v17
    s_waitcnt lgkmcnt(0)
    v_readlane_b32 s79, v18, s62
    s_cmp_ge_u32 s79, s63
    s_cbranch_scc1 GO_19
    s_waitcnt vmcnt(8)
    s_sub_u32 s7, s60, 8
    v_mov_b32 v19, s7
    ds_max_i32 v16, v19
    ds_read_b32 v18, v17
    s_waitcnt lgkmcnt(0)
    v_readlane_b32 s79, v18, s62
    s_cmp_ge_u32 s79, s63
    s_cbranch_scc1 GO_19
    s_waitcnt vmcnt(0)
    v_mov_b32 v19, s60
    ds_max_i32 v16, v19
    ds_read_b32 v18, v17
    s_waitcnt lgkmcnt(0)
    v_readlane_b32 s79, v18, s62
    s_cmp_ge_u32 s79, s63
    s_cbranch_scc1 GO_19
    s_mov_b32 s80, 1600000
SP_192:
    ds_read_b32 v18, v17
    s_waitcnt lgkmcnt(0)
    v_readlane_b32 s79, v18, s62
    s_cmp_ge_u32 s79, s63
    s_cbranch_scc1 GO_19
    s_sub_u32 s80, s80, 1
    s_cmp_lg_u32 s80, 0
    s_cbranch_scc1 SP_192
    s_branch GO_19
ST_29:
    ds_read_b32 v18, v17
    s_waitcnt lgkmcnt(0)
    v_readlane_b32 s79, v18, s62
    s_cmp_ge_u32 s79, s63
    s_cbranch_scc1 GO_28
    s_waitcnt vmcnt(40)
    s_sub_u32 s7, s60, 40
    v_mov_b32 v19, s7
    ds_max_i32 v16, v19
    ds_read_b32 v18, v17
    s_waitcnt lgkmcnt(0)
    v_readlane_b32 s79, v18, s62
    s_cmp_ge_u32 s79, s63
    s_cbranch_scc1 GO_28
    s_waitcnt vmcnt(32)
    s_sub_u32 s7, s60, 32
    v_mov_b32 v19, s7
    ds_max_i32 v16, v19
    ds_read_b32 v18, v17
    s_waitcnt lgkmcnt(0)
    v_readlane_b32 s79, v18, s62
    s_cmp_ge_u32 s79, s63
    s_cbranch_scc1 GO_28
    s_waitcnt vmcnt(24)
    s_sub_u32 s7, s60, 24
    v_mov_b32 v19, s7
    ds_max_i32 v16, v19
    ds_read_b32 v18, v17
    s_waitcnt lgkmcnt(0)
    v_readlane_b32 s79, v18, s62
    s_cmp_ge_u32 s79, s63
    s_cbranch_scc1 GO_28
    s_waitcnt vmcnt(16)
    s_sub_u32 s7, s60, 16
    v_mov_b32 v19, s7
    ds_max_i32 v16, v19
    ds_read_b32 v18, v17
    s_waitcnt lgkmcnt(0)
    v_readlane_b32 s79, v18, s62
    s_cmp_ge_u32 s79, s63
    s_cbranch_scc1 GO_28
    s_waitcnt vmcnt(8)
    s_sub_u32 s7, s60, 8
    v_mov_b32 v19, s7
    ds_max_i32 v16, v19
    ds_read_b32 v18, v17
    s_waitcnt lgkmcnt(0)
    v_readlane_b32 s79, v18, s62
    s_cmp_ge_u32 s79, s63
    s_cbranch_scc1 GO_28
    s_waitcnt vmcnt(0)
    v_mov_b32 v19, s60
    ds_max_i32 v16, v19
    ds_read_b32 v18, v17
    s_waitcnt lgkmcnt(0)
    v_readlane_b32 s79, v18, s62
    s_cmp_ge_u32 s79, s63
    s_cbranch_scc1 GO_28
    s_mov_b32 s80, 1600000
SP_193:
    ds_read_b32 v18, v17
    s_waitcnt lgkmcnt(0)
    v_readlane_b32 s79, v18, s62
    s_cmp_ge_u32 s79, s63
    s_cbranch_scc1 GO_28
    s_sub_u32 s80, s80, 1
    s_cmp_lg_u32 s80, 0
    s_cbranch_scc1 SP_193
    s_branch GO_28
ST_38:
    ds_read_b32 v18, v17
    s_waitcnt lgkmcnt(0)
    v_readlane_b32 s79, v18, s62
    s_cmp_ge_u32 s79, s63
    s_cbranch_scc1 GO_37
    s_waitcnt vmcnt(40)
    s_sub_u32 s7, s60, 40
    v_mov_b32 v19, s7
    ds_max_i32 v16, v19
    ds_read_b32 v18, v17
    s_waitcnt lgkmcnt(0)
    v_readlane_b32 s79, v18, s62
    s_cmp_ge_u32 s79, s63
    s_cbranch_scc1 GO_37
    s_waitcnt vmcnt(32)
    s_sub_u32 s7, s60, 32
    v_mov_b32 v19, s7
    ds_max_i32 v16, v19
    ds_read_b32 v18, v17
    s_waitcnt lgkmcnt(0)
    v_readlane_b32 s79, v18, s62
    s_cmp_ge_u32 s79, s63
    s_cbranch_scc1 GO_37
    s_waitcnt vmcnt(24)
    s_sub_u32 s7, s60, 24
    v_mov_b32 v19, s7
    ds_max_i32 v16, v19
    ds_read_b32 v18, v17
    s_waitcnt lgkmcnt(0)
    v_readlane_b32 s79, v18, s62
    s_cmp_ge_u32 s79, s63
    s_cbranch_scc1 GO_37
    s_waitcnt vmcnt(16)
    s_sub_u32 s7, s60, 16
    v_mov_b32 v19, s7
    ds_max_i32 v16, v19
    ds_read_b32 v18, v17
    s_waitcnt lgkmcnt(0)
    v_readlane_b32 s79, v18, s62
    s_cmp_ge_u32 s79, s63
    s_cbranch_scc1 GO_37
    s_waitcnt vmcnt(8)
    s_sub_u32 s7, s60, 8
    v_mov_b32 v19, s7
    ds_max_i32 v16, v19
    ds_read_b32 v18, v17
    s_waitcnt lgkmcnt(0)
    v_readlane_b32 s79, v18, s62
    s_cmp_ge_u32 s79, s63
    s_cbranch_scc1 GO_37
    s_waitcnt vmcnt(0)
    v_mov_b32 v19, s60
    ds_max_i32 v16, v19
    ds_read_b32 v18, v17
    s_waitcnt lgkmcnt(0)
    v_readlane_b32 s79, v18, s62
    s_cmp_ge_u32 s79, s63
    s_cbranch_scc1 GO_37
    s_mov_b32 s80, 1600000
SP_194:
    ds_read_b32 v18, v17
    s_waitcnt lgkmcnt(0)
    v_readlane_b32 s79, v18, s62
    s_cmp_ge_u32 s79, s63
    s_cbranch_scc1 GO_37
    s_sub_u32 s80, s80, 1
    s_cmp_lg_u32 s80, 0
    s_cbranch_scc1 SP_194
    s_branch GO_37
ST_49:
    ds_read_b32 v18, v17
    s_waitcnt lgkmcnt(0)
    v_readlane_b32 s79, v18, s62
    s_cmp_ge_u32 s79, s63
    s_cbranch_scc1 GO_48
    s_waitcnt vmcnt(16)
    s_sub_u32 s7, s60, 16
    v_mov_b32 v19, s7
    ds_max_i32 v16, v19
    ds_read_b32 v18, v17
    s_waitcnt lgkmcnt(0)
    v_readlane_b32 s79, v18, s62
    s_cmp_ge_u32 s79, s63
    s_cbranch_scc1 GO_48
    s_waitcnt vmcnt(8)
    s_sub_u32 s7, s60, 8
    v_mov_b32 v19, s7
    ds_max_i32 v16, v19
    ds_read_b32 v18, v17
    s_waitcnt lgkmcnt(0)
    v_readlane_b32 s79, v18, s62
    s_cmp_ge_u32 s79, s63
    s_cbranch_scc1 GO_48
    s_waitcnt vmcnt(0)
    v_mov_b32 v19, s60
    ds_max_i32 v16, v19
    ds_read_b32 v18, v17
    s_waitcnt lgkmcnt(0)
    v_readlane_b32 s79, v18, s62
    s_cmp_ge_u32 s79, s63
    s_cbranch_scc1 GO_48
    s_mov_b32 s80, 1600000
SP_195:
    ds_read_b32 v18, v17
    s_waitcnt lgkmcnt(0)
    v_readlane_b32 s79, v18, s62
    s_cmp_ge_u32 s79, s63
    s_cbranch_scc1 GO_48
    s_sub_u32 s80, s80, 1
    s_cmp_lg_u32 s80, 0
    s_cbranch_scc1 SP_195
    s_branch GO_48
ST_52:
    ds_read_b32 v18, v17
    s_waitcnt lgkmcnt(0)
    v_readlane_b32 s79, v18, s62
    s_cmp_ge_u32 s79, s63
    s_cbranch_scc1 GO_51
    s_waitcnt vmcnt(24)
    s_sub_u32 s7, s60, 24
    v_mov_b32 v19, s7
    ds_max_i32 v16, v19
    ds_read_b32 v18, v17
    s_waitcnt lgkmcnt(0)
    v_readlane_b32 s79, v18, s62
    s_cmp_ge_u32 s79, s63
    s_cbranch_scc1 GO_51
    s_waitcnt vmcnt(16)
    s_sub_u32 s7, s60, 16
    v_mov_b32 v19, s7
    ds_max_i32 v16, v19
    ds_read_b32 v18, v17
    s_waitcnt lgkmcnt(0)
    v_readlane_b32 s79, v18, s62
    s_cmp_ge_u32 s79, s63
    s_cbranch_scc1 GO_51
    s_waitcnt vmcnt(8)
    s_sub_u32 s7, s60, 8
    v_mov_b32 v19, s7
    ds_max_i32 v16, v19
    ds_read_b32 v18, v17
    s_waitcnt lgkmcnt(0)
    v_readlane_b32 s79, v18, s62
    s_cmp_ge_u32 s79, s63
    s_cbranch_scc1 GO_51
    s_waitcnt vmcnt(0)
    v_mov_b32 v19, s60
    ds_max_i32 v16, v19
    ds_read_b32 v18, v17
    s_waitcnt lgkmcnt(0)
    v_readlane_b32 s79, v18, s62
    s_cmp_ge_u32 s79, s63
    s_cbranch_scc1 GO_51
    s_mov_b32 s80, 1600000
SP_196:
    ds_read_b32 v18, v17
    s_waitcnt lgkmcnt(0)
    v_readlane_b32 s79, v18, s62
    s_cmp_ge_u32 s79, s63
    s_cbranch_scc1 GO_51
    s_sub_u32 s80, s80, 1
    s_cmp_lg_u32 s80, 0
    s_cbranch_scc1 SP_196
    s_branch GO_51
ST_54:
    ds_read_b32 v18, v17
    s_waitcnt lgkmcnt(0)
    v_readlane_b32 s79, v18, 0
    s_cmp_ge_u32 s79, s63
    s_cbranch_scc1 GO_53
    s_waitcnt vmcnt(24)
    s_sub_u32 s7, s60, 24
    v_mov_b32 v19, s7
    ds_max_i32 v16, v19
    ds_read_b32 v18, v17
    s_waitcnt lgkmcnt(0)
    v_readlane_b32 s79, v18, 0
    s_cmp_ge_u32 s79, s63
    s_cbranch_scc1 GO_53
    s_waitcnt vmcnt(16)
    s_sub_u32 s7, s60, 16
    v_mov_b32 v19, s7
    ds_max_i32 v16, v19
    ds_read_b32 v18, v17
    s_waitcnt lgkmcnt(0)
    v_readlane_b32 s79, v18, 0
    s_cmp_ge_u32 s79, s63
    s_cbranch_scc1 GO_53
    s_waitcnt vmcnt(8)
    s_sub_u32 s7, s60, 8
    v_mov_b32 v19, s7
    ds_max_i32 v16, v19
    ds_read_b32 v18, v17
    s_waitcnt lgkmcnt(0)
    v_readlane_b32 s79, v18, 0
    s_cmp_ge_u32 s79, s63
    s_cbranch_scc1 GO_53
    s_waitcnt vmcnt(0)
    v_mov_b32 v19, s60
    ds_max_i32 v16, v19
    ds_read_b32 v18, v17
    s_waitcnt lgkmcnt(0)
    v_readlane_b32 s79, v18, 0
    s_cmp_ge_u32 s79, s63
    s_cbranch_scc1 GO_53
    s_mov_b32 s80, 1600000
SP_197:
    ds_read_b32 v18, v17
    s_waitcnt lgkmcnt(0)
    v_readlane_b32 s79, v18, 0
    s_cmp_ge_u32 s79, s63
    s_cbranch_scc1 GO_53
    s_sub_u32 s80, s80, 1
    s_cmp_lg_u32 s80, 0
    s_cbranch_scc1 SP_197
    s_branch GO_53
M_58:
    s_sub_u32 s80, s80, 1
    s_cmp_le_u32 s80, 0
    s_cbranch_scc1 MD_60
    s_mov_b64 exec, s[62:63]
    s_cbranch_execz RS_198
    buffer_load_dwordx4 v[48:51], v36, s[36:39], 0 offen offset:0 sc1
RS_198:
    s_mov_b64 exec, s[64:65]
    s_cbranch_execz RS_199
    buffer_load_dwordx4 v[52:55], v36, s[36:39], 0 offen offset:1024 sc1
RS_199:
    s_mov_b64 exec, s[66:67]
    s_cbranch_execz RS_200
    buffer_load_dwordx4 v[56:59], v36, s[36:39], 0 offen offset:2048 sc1
RS_200:
    s_mov_b64 exec, s[68:69]
    s_cbranch_execz RS_201
    buffer_load_dwordx4 v[60:63], v36, s[36:39], 0 offen offset:3072 sc1
RS_201:
    s_branch MC_59
M_61:
    s_sub_u32 s80, s80, 1
    s_cmp_le_u32 s80, 0
    s_cbranch_scc1 MD_63
    s_mov_b64 exec, s[62:63]
    s_cbranch_execz RS_202
    buffer_load_dwordx4 v[48:51], v36, s[36:39], 0 offen offset:0 sc1
RS_202:
    s_mov_b64 exec, s[64:65]
    s_cbranch_execz RS_203
    buffer_load_dwordx4 v[52:55], v36, s[36:39], 0 offen offset:1024 sc1
RS_203:
    s_mov_b64 exec, s[66:67]
    s_cbranch_execz RS_204
    buffer_load_dwordx4 v[56:59], v36, s[36:39], 0 offen offset:2048 sc1
RS_204:
    s_mov_b64 exec, s[68:69]
    s_cbranch_execz RS_205
    buffer_load_dwordx4 v[60:63], v36, s[36:39], 0 offen offset:3072 sc1
RS_205:
    s_branch MC_62
M_78:
    s_sleep 4
    s_sub_u32 s80, s80, 1
    s_cmp_le_u32 s80, 0
    s_cbranch_scc1 MD_80
    s_mov_b64 exec, s[44:45]
    s_cbranch_execz RS_206
    buffer_load_dwordx4 v[48:51], v7, s[36:39], 0 offen sc1 nt
RS_206:
    s_mov_b64 exec, s[46:47]
    s_cbranch_execz RS_207
    buffer_load_dwordx4 v[52:55], v22, s[36:39], 0 offen sc1 nt
RS_207:
    s_branch MC_79
SU_86:
    s_nop 3
    buffer_store_dwordx4 v[64:67], v8, s[36:39], 0 offen sc1
    s_branch SV_87
AW_90:
    s_mov_b64 exec, 0x3f
    s_cmp_eq_u32 s71, 1
    s_cbranch_scc1 AX_208
    buffer_load_dwordx4 v[116:119], v12, s[36:39], 0 offen sc1 nt
    s_mov_b64 exec, -1
    s_branch AWB_91
AX_208:
    s_mov_b32 s80, 200000
    s_branch PP_210
P_209:
    buffer_load_dwordx4 v[116:119], v12, s[36:39], 0 offen sc1 nt
PP_210:
    s_waitcnt vmcnt(0)
    v_cmp_ne_u64 s[90:91], s[92:93], v[118:119]
    s_cmp_lg_u64 s[90:91], 0
    s_cbranch_scc0 PD_211
    s_sleep 2
    s_sub_u32 s80, s80, 1
    s_cmp_lg_u32 s80, 0
    s_cbranch_scc1 P_209
PD_211:
    s_mov_b64 exec, -1
    v_mov_b32 v118, v116
    s_nop 1
    v_max_f32_dpp v118, v118, v118 row_ror:1 row_mask:0xf bank_mask:0xf
    s_nop 1
    v_max_f32_dpp v118, v118, v118 row_ror:2 row_mask:0xf bank_mask:0xf
    s_nop 1
    v_max_f32_dpp v118, v118, v118 row_ror:4 row_mask:0xf bank_mask:0xf
    s_nop 1
    v_max_f32_dpp v118, v118, v118 row_ror:8 row_mask:0xf bank_mask:0xf
    v_sub_f32 v116, v116, v118
    v_sub_f32 v119, v64, v118
    v_exp_f32 v116, v116
    v_exp_f32 v119, v119
    v_mul_f32 v116, v116, v117
    s_nop 1
    v_add_f32_dpp v116, v116, v116 row_ror:1 row_mask:0xf bank_mask:0xf
    s_nop 1
    v_add_f32_dpp v116, v116, v116 row_ror:2 row_mask:0xf bank_mask:0xf
    s_nop 1
    v_add_f32_dpp v116, v116, v116 row_ror:4 row_mask:0xf bank_mask:0xf
    s_nop 1
    v_add_f32_dpp v116, v116, v116 row_ror:8 row_mask:0xf bank_mask:0xf
    v_rcp_f32 v116, v116
    s_nop 0
    v_mul_f32 v116, v116, v119
    s_nop 0
    v_readfirstlane_b32 s72, v116
    s_cmp_lt_u32 s5, 4
    s_cselect_b32 s7, 20, 0
    v_mov_b32 v8, 0x24210
    s_mov_b32 s80, 1600000
LW_212:
    ds_read_b32 v9, v8
    s_waitcnt lgkmcnt(0)
    v_readfirstlane_b32 s79, v9
    s_cmp_ge_u32 s79, s7
    s_cbranch_scc1 LWD_213
    s_sleep 1
    s_sub_u32 s80, s80, 1
    s_cmp_lg_u32 s80, 0
    s_cbranch_scc1 LW_212
LWD_213:
    s_branch AWB_91
SU_94:
    s_nop 3
    buffer_store_dwordx4 v[68:71], v6, s[36:39], 0 offen sc1
    s_branch SV_95
M_98:
    s_sub_u32 s80, s80, 1
    s_cmp_le_u32 s80, 0
    s_cbranch_scc1 MD_100
    s_mov_b64 exec, s[64:65]
    s_cbranch_execz RS_214
    buffer_load_dwordx4 v[112:115], v5, s[36:39], 0 offen sc1 nt
RS_214:
    s_mov_b64 exec, s[66:67]
    s_cbranch_execz RS_215
    buffer_load_dwordx4 v[116:119], v5, s[36:39], s62 offen sc1 nt
RS_215:
    s_mov_b64 exec, s[68:69]
    s_cbranch_execz RS_216
    buffer_load_dwordx4 v[120:123], v5, s[36:39], s63 offen sc1 nt
RS_216:
    s_branch MC_99
M_108:
    s_sub_u32 s80, s80, 1
    s_cmp_le_u32 s80, 199994
    s_cbranch_scc1 G2_105
    s_mov_b64 exec, s[44:45]
    s_cbranch_execz RS_217
    buffer_load_dwordx4 v[48:51], v7, s[36:39], 0 offen sc1 nt
RS_217:
    s_mov_b64 exec, s[46:47]
    s_cbranch_execz RS_218
    buffer_load_dwordx4 v[52:55], v22, s[36:39], 0 offen sc1 nt
RS_218:
    s_branch MC_109
G2_105:
    s_mov_b64 exec, -1
    v_mov_b32 v12, 0x24204
    s_mov_b32 s80, 1600000
LW_219:
    ds_read_b32 v13, v12
    s_waitcnt lgkmcnt(0)
    v_readfirstlane_b32 s79, v13
    s_cmp_ge_u32 s79, 1
    s_cbranch_scc1 LWD_220
    s_sleep 1
    s_sub_u32 s80, s80, 1
    s_cmp_lg_u32 s80, 0
    s_cbranch_scc1 LW_219
LWD_220:
    v_mov_b32 v12, 0x24248
    ds_read_b64 v[14:15], v12
    s_waitcnt lgkmcnt(0)
    v_readfirstlane_b32 s92, v14
    v_readfirstlane_b32 s93, v15
    s_mov_b32 s80, 200000
P_221:
    buffer_load_dwordx4 v[48:51], v7, s[36:39], 0 offen sc1 nt
    buffer_load_dwordx4 v[52:55], v22, s[36:39], 0 offen sc1 nt
PP_222:
    s_waitcnt vmcnt(0)
    s_mov_b64 s[90:91], 0
    v_cmp_gt_u64 s[88:89], s[94:95], v[50:51]
    v_cmp_le_u64 vcc, s[72:73], v[50:51]
    s_or_b64 s[88:89], s[88:89], vcc
    v_cmp_ne_u64 vcc, s[92:93], v[50:51]
    s_and_b64 vcc, vcc, s[88:89]
    s_or_b64 s[90:91], s[90:91], vcc
    v_cmp_gt_u64 s[88:89], s[94:95], v[54:55]
    v_cmp_le_u64 vcc, s[72:73], v[54:55]
    s_or_b64 s[88:89], s[88:89], vcc
    v_cmp_ne_u64 vcc, s[92:93], v[54:55]
    s_and_b64 vcc, vcc, s[88:89]
    s_or_b64 s[90:91], s[90:91], vcc
    s_cbranch_scc0 PD_223
    s_sleep 1
    s_sub_u32 s80, s80, 1
    s_cmp_lg_u32 s80, 0
    s_cbranch_scc1 P_221
PD_223:
    s_branch MD_110
M_125:
    s_sleep 8
    s_sub_u32 s80, s80, 1
    s_cmp_le_u32 s80, 0
    s_cbranch_scc1 MD_127
    s_mov_b64 exec, s[64:65]
    s_cbranch_execz RS_224
    buffer_load_dwordx2 v[12:13], v4, s[36:39], 0 offen offset:16 sc1
RS_224:
    s_branch MC_126
M_129:
    s_sleep 6
    s_sub_u32 s80, s80, 1
    s_cmp_le_u32 s80, 0
    s_cbranch_scc1 MD_131
    s_mov_b64 exec, s[64:65]
    s_cbranch_execz RS_225
    buffer_load_dwordx2 v[12:13], v9, s[36:39], 0 offen sc1 nt
RS_225:
    s_branch MC_130
M_132:
    s_sub_u32 s80, s80, 1
    s_cmp_le_u32 s80, 0
    s_cbranch_scc1 MD_134
    s_mov_b64 exec, s[64:65]
    s_cbranch_execz RS_226
    buffer_load_dwordx4 v[16:19], v5, s[36:39], 0 offen sc1
RS_226:
    s_mov_b64 exec, s[66:67]
    s_cbranch_execz RS_227
    buffer_load_dwordx4 v[12:15], v4, s[36:39], 0 offen sc1
RS_227:
    s_branch MC_133
SU_137:
    s_nop 3
    buffer_store_dwordx4 v[16:19], v10, s[36:39], 0 offen sc1
    s_branch SV_138
M_141:
    s_sleep 2
    s_sub_u32 s80, s80, 1
    s_cmp_le_u32 s80, 0
    s_cbranch_scc1 MD_143
    s_mov_b64 exec, s[44:45]
    s_cbranch_execz RS_228
    buffer_load_dwordx2 v[16:17], v144, s[36:39], 0 offen sc1
RS_228:
    s_branch MC_142
M_154:
    s_sleep 1
    s_sub_u32 s80, s80, 1
    s_cmp_le_u32 s80, 0
    s_cbranch_scc1 MD_156
    s_mov_b64 exec, s[44:45]
    s_cbranch_execz RS_229
    buffer_load_dwordx4 v[128:131], v145, s[36:39], 0 offen offset:0 sc1
RS_229:
    s_mov_b64 exec, s[46:47]
    s_cbranch_execz RS_230
    buffer_load_dwordx4 v[132:135], v145, s[36:39], 0 offen offset:1024 sc1
RS_230:
    s_mov_b64 exec, s[48:49]
    s_cbranch_execz RS_231
    buffer_load_dwordx4 v[136:139], v145, s[36:39], 0 offen offset:2048 sc1
RS_231:
    s_mov_b64 exec, s[50:51]
    s_cbranch_execz RS_232
    buffer_load_dwordx4 v[140:143], v145, s[36:39], 0 offen offset:3072 sc1
RS_232:
    s_branch MC_155
SU_173:
    s_nop 3
    buffer_store_dwordx4 v[36:39], v44, s[36:39], 0 offen sc1
    s_branch SV_174
SU_175:
    s_nop 3
    buffer_store_dwordx4 v[16:19], v5, s[36:39], 0 offen offset:0 sc1
    buffer_store_dwordx4 v[20:23], v5, s[36:39], 0 offen offset:1024 sc1
    buffer_store_dwordx4 v[24:27], v5, s[36:39], 0 offen offset:2048 sc1
    buffer_store_dwordx4 v[28:31], v5, s[36:39], 0 offen offset:3072 sc1
    s_waitcnt vmcnt(0)
    s_mov_b64 exec, s[88:89]
    buffer_store_dwordx2 v[38:39], v7, s[36:39], 0 offen sc1
    s_mov_b64 exec, -1
    s_branch SV_176
M_177:
    s_sub_u32 s80, s80, 1
    s_cmp_le_u32 s80, 0
    s_cbranch_scc1 MD_179
    s_mov_b64 exec, s[86:87]
    s_cbranch_execz RS_233
    buffer_load_dwordx2 v[40:41], v7, s[36:39], 0 offen sc1 nt
RS_233:
    s_branch MC_178
BL_180:
    s_mov_b32 s80, 200000
P_234:
    buffer_load_dwordx4 v[64:67], v6, s[36:39], 0 offen offset:0 sc1 nt
    buffer_load_dwordx4 v[68:71], v6, s[36:39], 0 offen offset:1024 sc1 nt
    buffer_load_dwordx4 v[72:75], v6, s[36:39], 0 offen offset:2048 sc1 nt
    buffer_load_dwordx4 v[76:79], v6, s[36:39], 0 offen offset:3072 sc1 nt
PP_235:
    s_waitcnt vmcnt(0)
    v_cmp_ne_u64 s[90:91], s[92:93], v[66:67]
    v_cmp_ne_u64 vcc, s[92:93], v[70:71]
    s_or_b64 s[90:91], s[90:91], vcc
    v_cmp_ne_u64 vcc, s[92:93], v[74:75]
    s_or_b64 s[90:91], s[90:91], vcc
    v_cmp_ne_u64 vcc, s[92:93], v[78:79]
    s_or_b64 s[90:91], s[90:91], vcc
    s_cmp_lg_u64 s[90:91], 0
    s_cbranch_scc0 PD_236
    s_sub_u32 s80, s80, 1
    s_cmp_lg_u32 s80, 0
    s_cbranch_scc1 P_234
PD_236:
    s_branch BLD_181
M_187:
    s_sleep 1
    s_sub_u32 s80, s80, 1
    s_cmp_le_u32 s80, 0
    s_cbranch_scc1 MD_189
    s_mov_b64 exec, s[86:87]
    s_cbranch_execz RS_237
    buffer_load_dwordx4 v[16:19], v4, s[36:39], 0 offen sc1 nt
RS_237:
    s_branch MC_188
L_END:
    s_endpgm
.section .rodata,"a"
.p2align 6
.amdhsa_kernel concat_heads__sliding_block_cached__compressed_kv_cla__decode_kernel
  .amdhsa_next_free_vgpr 168
  .amdhsa_next_free_sgpr 102
  .amdhsa_accum_offset 168
  .amdhsa_group_segment_fixed_size 0
  .amdhsa_kernarg_size 112
  .amdhsa_user_sgpr_count 2
  .amdhsa_user_sgpr_kernarg_segment_ptr 1
  .amdhsa_system_sgpr_workgroup_id_x 1
  .amdhsa_float_denorm_mode_32 3
.end_amdhsa_kernel
```
